```python
import torch

def _softmax(x, axis=-1):
    return torch.softmax(x, dim=axis)

def _gelu(x):
    return torch.nn.functional.gelu(x, approximate='tanh')

def _silu(x):
    return torch.nn.functional.silu(x)

def _sigmoid(x):
    return torch.sigmoid(x)

def _layernorm(x, axis=-1, eps=1e-05):
    m = x.mean(dim=axis, keepdim=True)
    v = x.var(dim=axis, keepdim=True, unbiased=False)
    return (x - m) / torch.sqrt(v + eps)

def _scatter_add(tgt, idx, src, axis=0):
    return tgt.clone().index_add_(axis, idx, src)

def _segment_sum(src, seg, n):
    out = torch.zeros((n,) + src.shape[1:], dtype=src.dtype)
    return out.index_add_(0, seg, src)

def _pad(x, pw):
    flat = tuple((v for pair in reversed(pw) for v in pair))
    return torch.nn.functional.pad(x, flat)
kernel_name = 'recurrent_scan__memory_aug_recurrent_mem_tr__moe_arch_mod__prompt'

def setup_inputs():

    _w = lambda a: (lambda t: t.to(torch.bfloat16) if t.is_floating_point() else t)(torch.as_tensor(a))

    def _A_setup():
        B, S, Dm = (1, 2048, 640)
        H, Dh = (32, 128)
        M, seg = (8, 32)
        seg = min(seg, S)
        S = S // seg * seg
        return {'x': _w((lambda *s: torch.randn(*s, dtype=torch.bfloat16) * 0.05)(B, S, Dm)), 'mem0': _w((lambda *s: torch.randn(*s, dtype=torch.bfloat16) * 0.2)(B, M, Dm)), 'Wq': _w((lambda *s: torch.randn(*s, dtype=torch.bfloat16) * 1.6)(Dm, H, Dh) * Dm ** (-0.5)), 'Wk': _w((lambda *s: torch.randn(*s, dtype=torch.bfloat16) * 1.6)(Dm, H, Dh) * Dm ** (-0.5)), 'Wv': _w((lambda *s: torch.randn(*s, dtype=torch.bfloat16) * 0.2)(Dm, H, Dh) * Dm ** (-0.5)), 'Wo': _w((lambda *s: torch.randn(*s, dtype=torch.bfloat16) * 0.2)(H, Dh, Dm) * (H * Dh) ** (-0.5)), 'seg_len': seg}
    _A_in = _A_setup()

    def _B_setup():
        B, S, D, F, C = (1, 2048, 640, 1728, 8)
        return {'x': _w((lambda *s: torch.randn(*s, dtype=torch.bfloat16) * 0.05)(B, S, D)), 'w_r': _w((lambda *s: torch.randn(*s, dtype=torch.bfloat16) * 0.2)(D)), 'w_gate': _w((lambda *s: torch.randn(*s, dtype=torch.bfloat16) * 0.1)(D, F)), 'w_up': _w((lambda *s: torch.randn(*s, dtype=torch.bfloat16) * 0.1)(D, F)), 'w_down': _w((lambda *s: torch.randn(*s, dtype=torch.bfloat16) * 0.1)(F, D))}
    _B_in = _B_setup()
    return {'A_x': _A_in['x'], 'A_mem0': _A_in['mem0'], 'A_Wq': _A_in['Wq'], 'A_Wk': _A_in['Wk'], 'A_Wv': _A_in['Wv'], 'A_Wo': _A_in['Wo'], 'A_seg_len': _A_in['seg_len'], 'B_x': _B_in['x'], 'B_w_r': _B_in['w_r'], 'B_w_gate': _B_in['w_gate'], 'B_w_up': _B_in['w_up'], 'B_w_down': _B_in['w_down']}

def reference(A_x, A_mem0, A_Wq, A_Wk, A_Wv, A_Wo, A_seg_len, B_x, B_w_r, B_w_gate, B_w_up, B_w_down):

    def _A_ref(x, mem0, Wq, Wk, Wv, Wo, seg_len):
        B, S, Dm = x.shape
        H, Dh = (Wq.shape[1], Wq.shape[2])
        M = mem0.shape[1]
        scale = Dh ** (-0.5)
        n_seg = S // seg_len
        L = M + seg_len
        idx = torch.arange(L)
        mask = (idx[:, None] < M) | (idx[:, None] >= idx[None, :])
        mem = mem0
        outs = []
        for s in range(n_seg):
            xs = x[:, s * seg_len:(s + 1) * seg_len, :].clone()
            h = torch.concatenate([mem, xs], axis=1)
            q = torch.einsum('btd,dhe->bhte', h, Wq)
            k = torch.einsum('btd,dhe->bhte', h, Wk)
            v = torch.einsum('btd,dhe->bhte', h, Wv)
            scores = torch.einsum('bhqe,bhke->bhqk', q, k) * scale
            scores = torch.where(mask[None, None], scores, -1000000000.0)
            p = _softmax(scores, axis=-1)
            o = torch.einsum('bhqk,bhke->bhqe', p, v)
            o = torch.einsum('bhte,hed->btd', o, Wo)
            mem = o[:, :M, :].clone()
            outs.append(o[:, M:, :])
        return torch.concatenate(outs, axis=1)

    def _B_ref(x, w_r, w_gate, w_up, w_down):
        B, S, D = x.shape
        C = 8
        r = x @ w_r
        idx = torch.argsort(-r, axis=-1)[:, :C]
        idx_e = (lambda x, n, axis: torch.repeat_interleave(x, n, dim=axis))(idx.reshape(B, C, 1), D, axis=2)
        x_sel = (lambda x, i, axis: torch.take_along_dim(x, i, dim=axis))(x, idx_e, axis=1)
        g = _silu(x_sel @ w_gate)
        u = x_sel @ w_up
        y = g * u @ w_down
        r_sel = _sigmoid((lambda x, i, axis: torch.take_along_dim(x, i, dim=axis))(r, idx, axis=1))
        y = y * r_sel.reshape(B, C, 1)
        b_off = (torch.arange(B) * S).reshape(B, 1)
        flat_idx = (idx + b_off).reshape(B * C)
        zero = (x * 0.0).reshape(B * S, D)
        upd = _scatter_add(zero, flat_idx, y.reshape(B * C, D), axis=0)
        return x + upd.reshape(B, S, D)
    x = A_x
    xn = _layernorm(x, axis=-1)
    s = _A_ref(xn, A_mem0, A_Wq, A_Wk, A_Wv, A_Wo, A_seg_len)
    g = _silu(_B_ref(xn, B_w_r, B_w_gate, B_w_up, B_w_down))
    return x + s * g
```

```asm
; @launch kernel=main_kernel grid=(256,1,1) block=(256,1,1) lds=163840
.amdgcn_target "amdgcn-amd-amdhsa--gfx950"
.text
.globl main_kernel
.p2align 8
.type main_kernel,@function
main_kernel:
    s_cmp_ge_u32 s2, 256
    s_cbranch_scc1 M_EXIT
    s_load_dwordx2 s[4:5], s[0:1], 112
    s_mov_b32 s6, 0x10000000
    s_mov_b32 s7, 0x00020000
    s_load_dwordx2 s[60:61], s[0:1], 104
    s_mov_b32 s62, 256
    s_mov_b32 s63, 0x00020000
    v_lshrrev_b32 v1, 6, v0
    v_and_b32 v0, 63, v0
    s_nop 0
    v_readfirstlane_b32 s14, v1
    s_getreg_b32 s98, hwreg(HW_REG_XCC_ID)
    s_and_b32 s98, s98, 7
    s_mov_b32 s97, 0
    s_mov_b32 s95, 4
    s_waitcnt lgkmcnt(0)
    s_cmp_lg_u32 s14, 0
    s_cbranch_scc1 NOMEAS_1
    s_and_b32 s64, s2, 0xfffffffd
    s_cmp_lg_u32 s64, 1
    s_cbranch_scc1 NOMEAS_1
    s_lshr_b32 s70, s2, 1
    s_mov_b32 s72, s60
    s_mov_b32 s73, s61
    s_mov_b32 s74, s62
    s_mov_b32 s75, s63
    s_lshl_b32 s60, s70, 21
    s_add_u32 s60, s60, 0x6001800
    v_mov_b32 v60, 0
    v_mov_b32 v61, -1
    s_mov_b32 s66, 0x7fffffff
    s_mov_b32 s67, 0x7fffffff
    s_mov_b32 s68, 0x7fffffff
    s_mov_b32 s69, 0x7fffffff
    s_mov_b64 exec, 1
    s_add_u32 s61, s60, 0
    s_memtime s[62:63]
    s_waitcnt lgkmcnt(0)
    buffer_store_dword v61, v60, s[4:7], s61 offen offset:0 sc1
    s_waitcnt vmcnt(0)
    s_memtime s[64:65]
    s_waitcnt lgkmcnt(0)
    s_sub_u32 s62, s64, s62
    s_min_u32 s66, s66, s62
    s_add_u32 s61, s60, 8192
    s_memtime s[62:63]
    s_waitcnt lgkmcnt(0)
    buffer_store_dword v61, v60, s[4:7], s61 offen offset:0 sc1
    s_waitcnt vmcnt(0)
    s_memtime s[64:65]
    s_waitcnt lgkmcnt(0)
    s_sub_u32 s62, s64, s62
    s_min_u32 s67, s67, s62
    s_add_u32 s61, s60, 16384
    s_memtime s[62:63]
    s_waitcnt lgkmcnt(0)
    buffer_store_dword v61, v60, s[4:7], s61 offen offset:0 sc1
    s_waitcnt vmcnt(0)
    s_memtime s[64:65]
    s_waitcnt lgkmcnt(0)
    s_sub_u32 s62, s64, s62
    s_min_u32 s68, s68, s62
    s_add_u32 s61, s60, 24576
    s_memtime s[62:63]
    s_waitcnt lgkmcnt(0)
    buffer_store_dword v61, v60, s[4:7], s61 offen offset:0 sc1
    s_waitcnt vmcnt(0)
    s_memtime s[64:65]
    s_waitcnt lgkmcnt(0)
    s_sub_u32 s62, s64, s62
    s_min_u32 s69, s69, s62
    s_add_u32 s61, s60, 0
    s_memtime s[62:63]
    s_waitcnt lgkmcnt(0)
    buffer_store_dword v61, v60, s[4:7], s61 offen offset:128 sc1
    s_waitcnt vmcnt(0)
    s_memtime s[64:65]
    s_waitcnt lgkmcnt(0)
    s_sub_u32 s62, s64, s62
    s_min_u32 s66, s66, s62
    s_add_u32 s61, s60, 8192
    s_memtime s[62:63]
    s_waitcnt lgkmcnt(0)
    buffer_store_dword v61, v60, s[4:7], s61 offen offset:128 sc1
    s_waitcnt vmcnt(0)
    s_memtime s[64:65]
    s_waitcnt lgkmcnt(0)
    s_sub_u32 s62, s64, s62
    s_min_u32 s67, s67, s62
    s_add_u32 s61, s60, 16384
    s_memtime s[62:63]
    s_waitcnt lgkmcnt(0)
    buffer_store_dword v61, v60, s[4:7], s61 offen offset:128 sc1
    s_waitcnt vmcnt(0)
    s_memtime s[64:65]
    s_waitcnt lgkmcnt(0)
    s_sub_u32 s62, s64, s62
    s_min_u32 s68, s68, s62
    s_add_u32 s61, s60, 24576
    s_memtime s[62:63]
    s_waitcnt lgkmcnt(0)
    buffer_store_dword v61, v60, s[4:7], s61 offen offset:128 sc1
    s_waitcnt vmcnt(0)
    s_memtime s[64:65]
    s_waitcnt lgkmcnt(0)
    s_sub_u32 s62, s64, s62
    s_min_u32 s69, s69, s62
    s_mov_b64 exec, -1
    s_mov_b32 s60, 0
    s_mov_b32 s61, s66
    s_cmp_lt_u32 s67, s61
    s_cselect_b32 s60, 1, s60
    s_min_u32 s61, s61, s67
    s_cmp_lt_u32 s68, s61
    s_cselect_b32 s60, 2, s60
    s_min_u32 s61, s61, s68
    s_cmp_lt_u32 s69, s61
    s_cselect_b32 s60, 3, s60
    s_min_u32 s61, s61, s69
    s_and_b32 s61, s98, 1
    s_lshl_b32 s61, s61, 1
    s_lshr_b32 s62, s98, 2
    s_add_u32 s61, s61, s62
    s_xor_b32 s60, s60, s61
    s_add_u32 s71, s60, 1
    s_mov_b32 s60, s72
    s_mov_b32 s61, s73
    s_mov_b32 s62, s74
    s_mov_b32 s63, s75
    s_lshl_b32 s70, s70, 2
    s_add_u32 s70, s70, 132
    v_mov_b32 v61, s71
    s_mov_b64 exec, 1
    buffer_store_dword v61, off, s[60:63], s70 sc1
    s_mov_b64 exec, -1
NOMEAS_1:
    s_cmp_lg_u32 s14, 0
    s_cbranch_scc1 M_TICKW
    s_mul_i32 s64, s98, 32
    s_add_u32 s64, s64, 0x0
    v_mov_b32 v1, 0
    v_mov_b32 v2, 1
    s_mov_b64 exec, 1
    buffer_atomic_add v2, v1, s[60:63], s64 offen sc0
    s_waitcnt vmcnt(0)
    ds_write_b32 v1, v2
    s_waitcnt lgkmcnt(0)
    s_mov_b64 exec, -1
M_TICKW:
    s_barrier
    v_mov_b32 v1, 0
    ds_read_b32 v2, v1
    s_waitcnt lgkmcnt(0)
    v_readfirstlane_b32 s99, v2
    s_barrier
    s_cmp_ge_u32 s99, 32
    s_cbranch_scc1 M_SLOW0
    s_mov_b32 s12, s98
    s_cmp_eq_u32 s12, 0
    s_cbranch_scc1 XOK_2
    s_cmp_eq_u32 s12, 2
    s_cbranch_scc0 M_FH
    s_mov_b32 s12, 1
XOK_2:
    s_mov_b32 s13, s99
    s_branch M_REC
M_FH:
    s_sub_u32 s96, s98, 1
    s_cmp_gt_u32 s98, 2
    s_cselect_b32 s64, 1, 0
    s_sub_u32 s96, s96, s64
    s_lshl_b32 s96, s96, 5
    s_add_u32 s96, s96, s99
    s_branch M_HELP
M_SLOW0:
    v_mbcnt_lo_u32_b32 v0, -1, 0
    v_mbcnt_hi_u32_b32 v0, -1, v0
    v_mul_u32_u24 v8, 32, v0
    s_mov_b32 s64, 0x0
    s_mov_b32 s65, 0
    s_mov_b64 exec, 0xff
TK_3:
    buffer_load_dword v9, v8, s[60:63], s64 offen sc1
    s_add_u32 s65, s65, 1
    s_waitcnt vmcnt(0)
    s_mov_b32 s66, 0
    v_readlane_b32 s67, v9, 0
    s_add_u32 s66, s66, s67
    v_readlane_b32 s67, v9, 1
    s_add_u32 s66, s66, s67
    v_readlane_b32 s67, v9, 2
    s_add_u32 s66, s66, s67
    v_readlane_b32 s67, v9, 3
    s_add_u32 s66, s66, s67
    v_readlane_b32 s67, v9, 4
    s_add_u32 s66, s66, s67
    v_readlane_b32 s67, v9, 5
    s_add_u32 s66, s66, s67
    v_readlane_b32 s67, v9, 6
    s_add_u32 s66, s66, s67
    v_readlane_b32 s67, v9, 7
    s_add_u32 s66, s66, s67
    s_cmp_ge_u32 s66, 256
    s_cbranch_scc1 TKD_4
    s_cmp_gt_u32 s65, 262144
    s_cbranch_scc0 TK_3
TKD_4:
    v_cmp_ne_u32 vcc, 32, v9
    s_mov_b64 exec, -1
M_SLOW:
    s_waitcnt vmcnt(0) lgkmcnt(0)
    s_barrier
    s_cmp_lg_u32 s14, 0
    s_cbranch_scc1 M_SLOWB
    v_mov_b32 v8, 1
    s_mov_b64 exec, 1
    buffer_atomic_add v8, off, s[60:63], 12 sc1
    s_mov_b64 exec, -1
M_SLOWB:
    s_mov_b32 s95, 12
    s_mov_b32 s65, 0
SB_5:
    buffer_load_dword v8, off, s[60:63], s95 sc1
    s_add_u32 s65, s65, 1
    s_waitcnt vmcnt(0)
    v_readfirstlane_b32 s64, v8
    s_cmp_ge_u32 s64, 256
    s_cbranch_scc1 SBD_6
    s_cmp_gt_u32 s65, 65536
    s_cbranch_scc1 SBD_6
    s_sleep 4
    s_branch SB_5
SBD_6:
    s_mov_b32 s95, 8
    s_mov_b32 s97, 1
    s_cmp_lt_u32 s2, 64
    s_cbranch_scc0 M_SH
    s_lshr_b32 s12, s2, 5
    s_and_b32 s13, s2, 31
    s_branch M_REC
M_SH:
    s_sub_u32 s96, s2, 64
    s_branch M_HELP
M_REC:
    v_mbcnt_lo_u32_b32 v0, -1, 0
    v_mbcnt_hi_u32_b32 v0, -1, v0
    s_load_dwordx2 s[44:45], s[0:1], 16
    s_mov_b32 s46, 0x500000
    s_mov_b32 s47, 0x00020000
    s_load_dwordx2 s[48:49], s[0:1], 24
    s_mov_b32 s50, 0x500000
    s_mov_b32 s51, 0x00020000
    s_load_dwordx2 s[52:53], s[0:1], 32
    s_mov_b32 s54, 0x500000
    s_mov_b32 s55, 0x00020000
    s_load_dwordx2 s[56:57], s[0:1], 40
    s_mov_b32 s58, 0x500000
    s_mov_b32 s59, 0x00020000
    s_waitcnt lgkmcnt(0)
    v_and_b32 v0, 63, v0
    v_lshlrev_b32 v1, 4, v0
    s_mul_i32 s64, s14, 36864
    s_add_u32 s64, s64, 16384
    v_add_u32 v2, s64, v1
    v_bfe_u32 v8, v0, 4, 1
    v_mul_u32_u24 v8, 1152, v8
    v_lshrrev_b32 v9, 5, v0
    v_lshlrev_b32 v9, 4, v9
    v_and_b32 v10, 15, v0
    v_add_u32 v9, v9, v10
    s_lshl_b32 s64, s14, 5
    v_add_u32 v9, s64, v9
    v_lshl_add_u32 v8, v9, 3, v8
    v_add_u32 v3, 8192, v8
    v_and_b32 v8, 1, v0
    v_mul_u32_u24 v8, 1152, v8
    v_lshrrev_b32 v9, 4, v0
    v_lshlrev_b32 v9, 2, v9
    v_bfe_u32 v10, v0, 2, 2
    v_add_u32 v9, v9, v10
    v_lshl_add_u32 v8, v9, 3, v8
    v_add_u32 v4, 8192, v8
    v_and_b32 v8, 7, v0
    v_mul_u32_u24 v8, 288, v8
    v_bfe_u32 v9, v0, 3, 1
    v_lshl_add_u32 v8, v9, 5, v8
    v_lshrrev_b32 v9, 4, v0
    v_lshl_add_u32 v8, v9, 3, v8
    s_lshl_b32 s64, s14, 6
    s_add_u32 s64, s64, 12800
    v_add_u32 v5, s64, v8
    s_mov_b32 s32, 0x00ff00ff
    s_mov_b32 s33, 0x00ff00ff
    s_mov_b32 s34, -1
    s_mov_b32 s35, 0
    s_mov_b32 s36, 0x00010001
    s_mov_b32 s37, 0x00010001
    v_mov_b32 v8, 0xeeee
    v_mov_b32 v9, 0x4444
    v_cndmask_b32 v6, v8, v9, s[32:33]
    v_lshrrev_b32 v8, 5, v0
    v_lshlrev_b32 v8, 13, v8
    v_bfe_u32 v9, v0, 3, 1
    v_lshl_add_u32 v8, v9, 12, v8
    v_and_b32 v9, 7, v0
    v_lshl_add_u32 v8, v9, 4, v8
    v_bfe_u32 v9, v0, 4, 1
    v_lshl_add_u32 v7, v9, 3, v8
    s_mov_b32 s10, 0x3e0293ee
    s_mov_b32 s11, 0x3e0293ee
    s_cmp_eq_u32 s14, 0
    s_cselect_b32 s42, 1, 0
    s_cmp_ge_u32 s13, 24
    s_cselect_b32 s65, 1, 0
    s_cmp_eq_u32 s14, 1
    s_cselect_b32 s65, s65, 0
    s_or_b32 s42, s42, s65
    s_lshl_b32 s65, s65, 3
    s_add_u32 s64, s13, s65
    s_cmp_eq_u32 s64, 39
    s_cselect_b32 s22, s42, 0
    s_mul_i32 s24, s12, 163840
    s_add_u32 s24, s24, 0x300000
    s_mul_i32 s23, s14, 40960
    s_add_u32 s23, s23, s24
    s_lshl_b32 s67, s13, 7
    s_add_u32 s23, s23, s67
    s_add_u32 s25, s23, 0x4000
    s_add_u32 s26, s23, 0x8000
    s_lshl_b32 s67, s64, 12
    s_add_u32 s24, s24, s67
    s_lshl_b32 s64, s64, 7
    s_lshl_b32 s65, s12, 13
    s_add_u32 s17, s65, 0x5900000
    s_add_u32 s18, s17, s64
    s_lshl_b32 s65, s12, 21
    s_add_u32 s66, s65, 0x6000000
    s_add_u32 s21, s66, s64
    s_xor_b32 s65, s65, 0x200000
    s_add_u32 s20, s65, 0x5ff8000
    s_and_b32 s64, s13, 1
    s_cmp_eq_u32 s64, s12
    s_cselect_b32 s43, 1, 0
    s_mov_b32 s43, 0
    s_lshl_b32 s64, s13, 4
    s_add_u32 s69, s64, 0x291000
    s_lshl_b32 s64, s13, 2
    s_add_u32 s70, s64, 0x294000
    s_lshl_b32 s64, s13, 14
    s_lshl_b32 s73, s14, 11
    s_lshl_b32 s65, s14, 12
    s_add_u32 s65, s65, s64
    s_add_u32 s3, s65, 0x1500000
    s_add_u32 s64, s64, s73
    s_add_u32 s28, s64, 0x1400000
    s_add_u32 s29, s64, 0x1402000
    s_lshl_b32 s64, s13, 11
    s_add_u32 s30, s64, 0x640000
    s_lshl_b32 s64, s13, 12
    s_lshl_b32 s65, s14, 10
    s_add_u32 s64, s64, s65
    s_add_u32 s31, s64, 0xa40000
    s_mul_i32 s40, s14, 36864
    s_add_u32 s40, s40, 16384
    v_bfe_u32 v95, v0, 2, 2
    v_lshlrev_b32 v88, 15, v95
    v_lshrrev_b32 v95, 5, v0
    v_lshl_add_u32 v88, v95, 14, v88
    v_bfe_u32 v95, v0, 4, 1
    v_lshl_add_u32 v88, v95, 13, v88
    v_lshlrev_b32 v95, 1, v95
    v_and_b32 v8, 3, v0
    v_xor_b32 v95, v95, v8
    v_lshl_add_u32 v88, v95, 4, v88
    v_bfe_u32 v95, v0, 2, 1
    v_mov_b32 v8, v95
    v_bfe_u32 v95, v0, 3, 1
    v_lshl_add_u32 v8, v95, 2, v8
    v_bfe_u32 v95, v0, 4, 1
    v_lshl_add_u32 v8, v95, 1, v8
    v_bfe_u32 v95, v0, 5, 1
    v_lshl_add_u32 v8, v95, 3, v8
    v_mul_u32_u24 v8, 1280, v8
    v_and_b32 v95, 3, v0
    v_lshl_add_u32 v89, v95, 4, v8
    v_lshrrev_b32 v95, 1, v0
    v_mul_u32_u24 v8, 1280, v95
    v_and_b32 v95, 1, v0
    v_lshl_add_u32 v90, v95, 4, v8
    v_lshrrev_b32 v95, 5, v0
    v_lshlrev_b32 v91, 10, v95
    v_bfe_u32 v95, v0, 2, 1
    v_lshl_add_u32 v91, v95, 8, v91
    v_bfe_u32 v95, v0, 4, 1
    v_lshl_add_u32 v91, v95, 6, v91
    v_bfe_u32 v95, v0, 3, 1
    v_lshl_add_u32 v91, v95, 7, v91
    v_and_b32 v95, 1, v0
    v_lshl_add_u32 v91, v95, 3, v91
    v_bfe_u32 v95, v0, 1, 1
    v_lshl_add_u32 v91, v95, 4, v91
    v_add_u32 v91, s40, v91
    v_bfe_u32 v95, v0, 2, 1
    v_lshlrev_b32 v95, 5, v95
    v_sub_u32 v92, 32, v95
    v_add_u32 v92, v92, v91
    v_add_u32 v91, v91, v95
    v_lshrrev_b32 v95, 5, v0
    v_lshlrev_b32 v93, 9, v95
    v_bfe_u32 v95, v0, 4, 1
    v_lshl_add_u32 v93, v95, 7, v93
    v_bfe_u32 v95, v0, 2, 1
    v_lshl_add_u32 v93, v95, 6, v93
    v_bfe_u32 v95, v0, 3, 1
    v_lshl_add_u32 v93, v95, 5, v93
    v_and_b32 v95, 3, v0
    v_lshl_add_u32 v93, v95, 3, v93
    v_add_u32 v93, s40, v93
    v_lshrrev_b32 v95, 4, v0
    v_lshlrev_b32 v94, 8, v95
    v_bfe_u32 v95, v0, 2, 2
    v_lshl_add_u32 v94, v95, 5, v94
    v_and_b32 v95, 3, v0
    v_lshl_add_u32 v94, v95, 3, v94
    v_add_u32 v94, s40, v94
    s_lshl_b32 s64, s13, 8
    s_lshl_b32 s65, s14, 6
    s_add_u32 s64, s64, s65
    s_mul_i32 s65, s12, 2621440
    s_add_u32 s71, s64, s65
    s_sub_u32 s65, 2621440, s65
    s_add_u32 s72, s64, s65
    s_mul_i32 s39, s13, 163840
    s_mul_i32 s64, s12, 640
    s_add_u32 s39, s39, s64
    s_mul_i32 s64, s14, 160
    s_add_u32 s39, s39, s64
    s_add_u32 m0, s40, 0
    s_add_u32 s64, s71, 0x0
    buffer_load_dwordx4 v88, s[44:47], s64 offen lds
    s_add_u32 m0, s40, 1024
    s_add_u32 s64, s71, 0x20000
    buffer_load_dwordx4 v88, s[44:47], s64 offen lds
    s_add_u32 m0, s40, 2048
    s_add_u32 s64, s71, 0x40000
    buffer_load_dwordx4 v88, s[44:47], s64 offen lds
    s_add_u32 m0, s40, 3072
    s_add_u32 s64, s71, 0x60000
    buffer_load_dwordx4 v88, s[44:47], s64 offen lds
    s_add_u32 m0, s40, 4096
    s_add_u32 s64, s71, 0x80000
    buffer_load_dwordx4 v88, s[44:47], s64 offen lds
    s_add_u32 m0, s40, 5120
    s_add_u32 s64, s71, 0xa0000
    buffer_load_dwordx4 v88, s[44:47], s64 offen lds
    s_add_u32 m0, s40, 6144
    s_add_u32 s64, s71, 0xc0000
    buffer_load_dwordx4 v88, s[44:47], s64 offen lds
    s_add_u32 m0, s40, 7168
    s_add_u32 s64, s71, 0xe0000
    buffer_load_dwordx4 v88, s[44:47], s64 offen lds
    s_add_u32 m0, s40, 8192
    s_add_u32 s64, s71, 0x100000
    buffer_load_dwordx4 v88, s[44:47], s64 offen lds
    s_add_u32 m0, s40, 9216
    s_add_u32 s64, s71, 0x120000
    buffer_load_dwordx4 v88, s[44:47], s64 offen lds
    s_add_u32 m0, s40, 10240
    s_add_u32 s64, s71, 0x140000
    buffer_load_dwordx4 v88, s[44:47], s64 offen lds
    s_add_u32 m0, s40, 11264
    s_add_u32 s64, s71, 0x160000
    buffer_load_dwordx4 v88, s[44:47], s64 offen lds
    s_add_u32 m0, s40, 12288
    s_add_u32 s64, s71, 0x180000
    buffer_load_dwordx4 v88, s[44:47], s64 offen lds
    s_add_u32 m0, s40, 13312
    s_add_u32 s64, s71, 0x1a0000
    buffer_load_dwordx4 v88, s[44:47], s64 offen lds
    s_add_u32 m0, s40, 14336
    s_add_u32 s64, s71, 0x1c0000
    buffer_load_dwordx4 v88, s[44:47], s64 offen lds
    s_add_u32 m0, s40, 15360
    s_add_u32 s64, s71, 0x1e0000
    buffer_load_dwordx4 v88, s[44:47], s64 offen lds
    s_add_u32 m0, s40, 16384
    s_add_u32 s64, s71, 0x200000
    buffer_load_dwordx4 v88, s[44:47], s64 offen lds
    s_add_u32 m0, s40, 17408
    s_add_u32 s64, s71, 0x220000
    buffer_load_dwordx4 v88, s[44:47], s64 offen lds
    s_add_u32 m0, s40, 18432
    s_add_u32 s64, s71, 0x240000
    buffer_load_dwordx4 v88, s[44:47], s64 offen lds
    s_add_u32 m0, s40, 19456
    s_add_u32 s64, s71, 0x260000
    buffer_load_dwordx4 v88, s[44:47], s64 offen lds
    s_add_u32 m0, s40, 20480
    s_add_u32 s64, s72, 0x0
    buffer_load_dwordx4 v88, s[44:47], s64 offen lds
    s_add_u32 m0, s40, 21504
    s_add_u32 s64, s72, 0x20000
    buffer_load_dwordx4 v88, s[44:47], s64 offen lds
    s_add_u32 m0, s40, 22528
    s_add_u32 s64, s72, 0x40000
    buffer_load_dwordx4 v88, s[44:47], s64 offen lds
    s_add_u32 m0, s40, 23552
    s_add_u32 s64, s72, 0x60000
    buffer_load_dwordx4 v88, s[44:47], s64 offen lds
    s_add_u32 m0, s40, 24576
    s_add_u32 s64, s72, 0x80000
    buffer_load_dwordx4 v88, s[44:47], s64 offen lds
    s_add_u32 m0, s40, 25600
    s_add_u32 s64, s72, 0xa0000
    buffer_load_dwordx4 v88, s[44:47], s64 offen lds
    s_add_u32 m0, s40, 26624
    s_add_u32 s64, s72, 0xc0000
    buffer_load_dwordx4 v88, s[44:47], s64 offen lds
    s_add_u32 m0, s40, 27648
    s_add_u32 s64, s72, 0xe0000
    buffer_load_dwordx4 v88, s[44:47], s64 offen lds
    s_add_u32 m0, s40, 28672
    s_add_u32 s64, s72, 0x100000
    buffer_load_dwordx4 v88, s[44:47], s64 offen lds
    s_add_u32 m0, s40, 29696
    s_add_u32 s64, s72, 0x120000
    buffer_load_dwordx4 v88, s[44:47], s64 offen lds
    s_add_u32 m0, s40, 30720
    s_add_u32 s64, s72, 0x140000
    buffer_load_dwordx4 v88, s[44:47], s64 offen lds
    s_add_u32 m0, s40, 31744
    s_add_u32 s64, s72, 0x160000
    buffer_load_dwordx4 v88, s[44:47], s64 offen lds
    s_add_u32 m0, s40, 32768
    s_add_u32 s64, s72, 0x180000
    buffer_load_dwordx4 v88, s[44:47], s64 offen lds
    s_add_u32 m0, s40, 33792
    s_add_u32 s64, s72, 0x1a0000
    buffer_load_dwordx4 v88, s[44:47], s64 offen lds
    s_add_u32 m0, s40, 34816
    s_add_u32 s64, s72, 0x1c0000
    buffer_load_dwordx4 v88, s[44:47], s64 offen lds
    s_add_u32 m0, s40, 35840
    s_add_u32 s64, s72, 0x1e0000
    buffer_load_dwordx4 v88, s[44:47], s64 offen lds
    s_waitcnt vmcnt(32)
    ds_read_b64_tr_b16 v[96:97], v91 offset:0
    ds_read_b64_tr_b16 v[98:99], v91 offset:512
    ds_read_b64_tr_b16 v[100:101], v91 offset:2048
    ds_read_b64_tr_b16 v[102:103], v91 offset:2560
    ds_read_b64_tr_b16 v[104:105], v92 offset:0
    ds_read_b64_tr_b16 v[106:107], v92 offset:512
    ds_read_b64_tr_b16 v[108:109], v92 offset:2048
    ds_read_b64_tr_b16 v[110:111], v92 offset:2560
    s_waitcnt lgkmcnt(0)
    s_add_u32 m0, s40, 0
    s_add_u32 s64, s72, 0x200000
    buffer_load_dwordx4 v88, s[44:47], s64 offen lds
    s_add_u32 m0, s40, 1024
    s_add_u32 s64, s72, 0x220000
    buffer_load_dwordx4 v88, s[44:47], s64 offen lds
    s_add_u32 m0, s40, 2048
    s_add_u32 s64, s72, 0x240000
    buffer_load_dwordx4 v88, s[44:47], s64 offen lds
    s_add_u32 m0, s40, 3072
    s_add_u32 s64, s72, 0x260000
    buffer_load_dwordx4 v88, s[44:47], s64 offen lds
    s_waitcnt vmcnt(32)
    ds_read_b64_tr_b16 v[112:113], v91 offset:4096
    ds_read_b64_tr_b16 v[114:115], v91 offset:4608
    ds_read_b64_tr_b16 v[116:117], v91 offset:6144
    ds_read_b64_tr_b16 v[118:119], v91 offset:6656
    ds_read_b64_tr_b16 v[120:121], v92 offset:4096
    ds_read_b64_tr_b16 v[122:123], v92 offset:4608
    ds_read_b64_tr_b16 v[124:125], v92 offset:6144
    ds_read_b64_tr_b16 v[126:127], v92 offset:6656
    s_waitcnt lgkmcnt(0)
    s_add_u32 m0, s40, 4096
    s_add_u32 s64, s72, 0x200000
    buffer_load_dwordx4 v88, s[48:51], s64 offen lds
    s_add_u32 m0, s40, 5120
    s_add_u32 s64, s72, 0x220000
    buffer_load_dwordx4 v88, s[48:51], s64 offen lds
    s_add_u32 m0, s40, 6144
    s_add_u32 s64, s72, 0x240000
    buffer_load_dwordx4 v88, s[48:51], s64 offen lds
    s_add_u32 m0, s40, 7168
    s_add_u32 s64, s72, 0x260000
    buffer_load_dwordx4 v88, s[48:51], s64 offen lds
    s_waitcnt vmcnt(32)
    ds_read_b64_tr_b16 v[128:129], v91 offset:8192
    ds_read_b64_tr_b16 v[130:131], v91 offset:8704
    ds_read_b64_tr_b16 v[132:133], v91 offset:10240
    ds_read_b64_tr_b16 v[134:135], v91 offset:10752
    ds_read_b64_tr_b16 v[136:137], v92 offset:8192
    ds_read_b64_tr_b16 v[138:139], v92 offset:8704
    ds_read_b64_tr_b16 v[140:141], v92 offset:10240
    ds_read_b64_tr_b16 v[142:143], v92 offset:10752
    s_waitcnt lgkmcnt(0)
    s_add_u32 m0, s40, 8192
    s_add_u32 s64, s71, 0x0
    buffer_load_dwordx4 v88, s[52:55], s64 offen lds
    s_add_u32 m0, s40, 9216
    s_add_u32 s64, s71, 0x20000
    buffer_load_dwordx4 v88, s[52:55], s64 offen lds
    s_add_u32 m0, s40, 10240
    s_add_u32 s64, s71, 0x40000
    buffer_load_dwordx4 v88, s[52:55], s64 offen lds
    s_add_u32 m0, s40, 11264
    s_add_u32 s64, s71, 0x60000
    buffer_load_dwordx4 v88, s[52:55], s64 offen lds
    s_waitcnt vmcnt(32)
    ds_read_b64_tr_b16 v[144:145], v91 offset:12288
    ds_read_b64_tr_b16 v[146:147], v91 offset:12800
    ds_read_b64_tr_b16 v[148:149], v91 offset:14336
    ds_read_b64_tr_b16 v[150:151], v91 offset:14848
    ds_read_b64_tr_b16 v[152:153], v92 offset:12288
    ds_read_b64_tr_b16 v[154:155], v92 offset:12800
    ds_read_b64_tr_b16 v[156:157], v92 offset:14336
    ds_read_b64_tr_b16 v[158:159], v92 offset:14848
    s_waitcnt lgkmcnt(0)
    s_add_u32 m0, s40, 12288
    s_add_u32 s64, s71, 0x80000
    buffer_load_dwordx4 v88, s[52:55], s64 offen lds
    s_add_u32 m0, s40, 13312
    s_add_u32 s64, s71, 0xa0000
    buffer_load_dwordx4 v88, s[52:55], s64 offen lds
    s_add_u32 m0, s40, 14336
    s_add_u32 s64, s71, 0xc0000
    buffer_load_dwordx4 v88, s[52:55], s64 offen lds
    s_add_u32 m0, s40, 15360
    s_add_u32 s64, s71, 0xe0000
    buffer_load_dwordx4 v88, s[52:55], s64 offen lds
    s_waitcnt vmcnt(32)
    ds_read_b64_tr_b16 v[160:161], v91 offset:16384
    ds_read_b64_tr_b16 v[162:163], v91 offset:16896
    ds_read_b64_tr_b16 v[164:165], v91 offset:18432
    ds_read_b64_tr_b16 v[166:167], v91 offset:18944
    ds_read_b64_tr_b16 v[168:169], v92 offset:16384
    ds_read_b64_tr_b16 v[170:171], v92 offset:16896
    ds_read_b64_tr_b16 v[172:173], v92 offset:18432
    ds_read_b64_tr_b16 v[174:175], v92 offset:18944
    s_waitcnt lgkmcnt(0)
    s_add_u32 m0, s40, 16384
    s_add_u32 s64, s71, 0x100000
    buffer_load_dwordx4 v88, s[52:55], s64 offen lds
    s_add_u32 m0, s40, 17408
    s_add_u32 s64, s71, 0x120000
    buffer_load_dwordx4 v88, s[52:55], s64 offen lds
    s_add_u32 m0, s40, 18432
    s_add_u32 s64, s71, 0x140000
    buffer_load_dwordx4 v88, s[52:55], s64 offen lds
    s_add_u32 m0, s40, 19456
    s_add_u32 s64, s71, 0x160000
    buffer_load_dwordx4 v88, s[52:55], s64 offen lds
    s_waitcnt vmcnt(32)
    ds_read_b64_tr_b16 v[176:177], v91 offset:20480
    ds_read_b64_tr_b16 v[178:179], v91 offset:20992
    ds_read_b64_tr_b16 v[180:181], v91 offset:22528
    ds_read_b64_tr_b16 v[182:183], v91 offset:23040
    ds_read_b64_tr_b16 v[184:185], v92 offset:20480
    ds_read_b64_tr_b16 v[186:187], v92 offset:20992
    ds_read_b64_tr_b16 v[188:189], v92 offset:22528
    ds_read_b64_tr_b16 v[190:191], v92 offset:23040
    s_waitcnt lgkmcnt(0)
    s_add_u32 m0, s40, 20480
    s_add_u32 s64, s71, 0x180000
    buffer_load_dwordx4 v88, s[52:55], s64 offen lds
    s_add_u32 m0, s40, 21504
    s_add_u32 s64, s71, 0x1a0000
    buffer_load_dwordx4 v88, s[52:55], s64 offen lds
    s_add_u32 m0, s40, 22528
    s_add_u32 s64, s71, 0x1c0000
    buffer_load_dwordx4 v88, s[52:55], s64 offen lds
    s_add_u32 m0, s40, 23552
    s_add_u32 s64, s71, 0x1e0000
    buffer_load_dwordx4 v88, s[52:55], s64 offen lds
    s_waitcnt vmcnt(32)
    ds_read_b64_tr_b16 v[192:193], v91 offset:24576
    ds_read_b64_tr_b16 v[194:195], v91 offset:25088
    ds_read_b64_tr_b16 v[196:197], v91 offset:26624
    ds_read_b64_tr_b16 v[198:199], v91 offset:27136
    ds_read_b64_tr_b16 v[200:201], v92 offset:24576
    ds_read_b64_tr_b16 v[202:203], v92 offset:25088
    ds_read_b64_tr_b16 v[204:205], v92 offset:26624
    ds_read_b64_tr_b16 v[206:207], v92 offset:27136
    s_waitcnt lgkmcnt(0)
    s_add_u32 m0, s40, 24576
    s_add_u32 s64, s71, 0x200000
    buffer_load_dwordx4 v88, s[52:55], s64 offen lds
    s_add_u32 m0, s40, 25600
    s_add_u32 s64, s71, 0x220000
    buffer_load_dwordx4 v88, s[52:55], s64 offen lds
    s_add_u32 m0, s40, 26624
    s_add_u32 s64, s71, 0x240000
    buffer_load_dwordx4 v88, s[52:55], s64 offen lds
    s_add_u32 m0, s40, 27648
    s_add_u32 s64, s71, 0x260000
    buffer_load_dwordx4 v88, s[52:55], s64 offen lds
    s_waitcnt vmcnt(32)
    ds_read_b64_tr_b16 v[208:209], v91 offset:28672
    ds_read_b64_tr_b16 v[210:211], v91 offset:29184
    ds_read_b64_tr_b16 v[212:213], v91 offset:30720
    ds_read_b64_tr_b16 v[214:215], v91 offset:31232
    ds_read_b64_tr_b16 v[216:217], v92 offset:28672
    ds_read_b64_tr_b16 v[218:219], v92 offset:29184
    ds_read_b64_tr_b16 v[220:221], v92 offset:30720
    ds_read_b64_tr_b16 v[222:223], v92 offset:31232
    s_waitcnt lgkmcnt(0)
    s_add_u32 m0, s40, 28672
    s_add_u32 s64, s72, 0x0
    buffer_load_dwordx4 v88, s[52:55], s64 offen lds
    s_add_u32 m0, s40, 29696
    s_add_u32 s64, s72, 0x20000
    buffer_load_dwordx4 v88, s[52:55], s64 offen lds
    s_add_u32 m0, s40, 30720
    s_add_u32 s64, s72, 0x40000
    buffer_load_dwordx4 v88, s[52:55], s64 offen lds
    s_add_u32 m0, s40, 31744
    s_add_u32 s64, s72, 0x60000
    buffer_load_dwordx4 v88, s[52:55], s64 offen lds
    s_waitcnt vmcnt(32)
    ds_read_b64_tr_b16 v[224:225], v91 offset:32768
    ds_read_b64_tr_b16 v[226:227], v91 offset:33280
    ds_read_b64_tr_b16 v[228:229], v91 offset:34816
    ds_read_b64_tr_b16 v[230:231], v91 offset:35328
    ds_read_b64_tr_b16 v[232:233], v92 offset:32768
    ds_read_b64_tr_b16 v[234:235], v92 offset:33280
    ds_read_b64_tr_b16 v[236:237], v92 offset:34816
    ds_read_b64_tr_b16 v[238:239], v92 offset:35328
    s_waitcnt lgkmcnt(0)
    s_add_u32 m0, s40, 32768
    s_add_u32 s64, s72, 0x80000
    buffer_load_dwordx4 v88, s[52:55], s64 offen lds
    s_add_u32 m0, s40, 33792
    s_add_u32 s64, s72, 0xa0000
    buffer_load_dwordx4 v88, s[52:55], s64 offen lds
    s_add_u32 m0, s40, 34816
    s_add_u32 s64, s72, 0xc0000
    buffer_load_dwordx4 v88, s[52:55], s64 offen lds
    s_add_u32 m0, s40, 35840
    s_add_u32 s64, s72, 0xe0000
    buffer_load_dwordx4 v88, s[52:55], s64 offen lds
    s_waitcnt vmcnt(32)
    ds_read_b64_tr_b16 v[240:241], v91 offset:0
    ds_read_b64_tr_b16 v[242:243], v91 offset:512
    ds_read_b64_tr_b16 v[244:245], v91 offset:2048
    ds_read_b64_tr_b16 v[246:247], v91 offset:2560
    ds_read_b64_tr_b16 v[248:249], v92 offset:0
    ds_read_b64_tr_b16 v[250:251], v92 offset:512
    ds_read_b64_tr_b16 v[252:253], v92 offset:2048
    ds_read_b64_tr_b16 v[254:255], v92 offset:2560
    s_waitcnt lgkmcnt(0)
    s_add_u32 m0, s40, 0
    s_add_u32 s64, s72, 0x100000
    buffer_load_dwordx4 v88, s[52:55], s64 offen lds
    s_add_u32 m0, s40, 1024
    s_add_u32 s64, s72, 0x120000
    buffer_load_dwordx4 v88, s[52:55], s64 offen lds
    s_add_u32 m0, s40, 2048
    s_add_u32 s64, s72, 0x140000
    buffer_load_dwordx4 v88, s[52:55], s64 offen lds
    s_add_u32 m0, s40, 3072
    s_add_u32 s64, s72, 0x160000
    buffer_load_dwordx4 v88, s[52:55], s64 offen lds
    s_waitcnt vmcnt(32)
    ds_read_b64_tr_b16 a[240:241], v91 offset:4096
    ds_read_b64_tr_b16 a[242:243], v91 offset:4608
    ds_read_b64_tr_b16 a[244:245], v91 offset:6144
    ds_read_b64_tr_b16 a[246:247], v91 offset:6656
    ds_read_b64_tr_b16 a[248:249], v92 offset:4096
    ds_read_b64_tr_b16 a[250:251], v92 offset:4608
    ds_read_b64_tr_b16 a[252:253], v92 offset:6144
    ds_read_b64_tr_b16 a[254:255], v92 offset:6656
    s_waitcnt lgkmcnt(0)
    s_add_u32 m0, s40, 4096
    s_add_u32 s64, s72, 0x180000
    buffer_load_dwordx4 v88, s[52:55], s64 offen lds
    s_add_u32 m0, s40, 5120
    s_add_u32 s64, s72, 0x1a0000
    buffer_load_dwordx4 v88, s[52:55], s64 offen lds
    s_add_u32 m0, s40, 6144
    s_add_u32 s64, s72, 0x1c0000
    buffer_load_dwordx4 v88, s[52:55], s64 offen lds
    s_add_u32 m0, s40, 7168
    s_add_u32 s64, s72, 0x1e0000
    buffer_load_dwordx4 v88, s[52:55], s64 offen lds
    s_waitcnt vmcnt(32)
    ds_read_b64_tr_b16 a[0:1], v91 offset:8192
    ds_read_b64_tr_b16 a[2:3], v91 offset:8704
    ds_read_b64_tr_b16 a[4:5], v91 offset:10240
    ds_read_b64_tr_b16 a[6:7], v91 offset:10752
    ds_read_b64_tr_b16 a[8:9], v92 offset:8192
    ds_read_b64_tr_b16 a[10:11], v92 offset:8704
    ds_read_b64_tr_b16 a[12:13], v92 offset:10240
    ds_read_b64_tr_b16 a[14:15], v92 offset:10752
    s_waitcnt lgkmcnt(0)
    s_add_u32 m0, s40, 8192
    s_add_u32 s64, s72, 0x200000
    buffer_load_dwordx4 v88, s[52:55], s64 offen lds
    s_add_u32 m0, s40, 9216
    s_add_u32 s64, s72, 0x220000
    buffer_load_dwordx4 v88, s[52:55], s64 offen lds
    s_add_u32 m0, s40, 10240
    s_add_u32 s64, s72, 0x240000
    buffer_load_dwordx4 v88, s[52:55], s64 offen lds
    s_add_u32 m0, s40, 11264
    s_add_u32 s64, s72, 0x260000
    buffer_load_dwordx4 v88, s[52:55], s64 offen lds
    s_waitcnt vmcnt(32)
    ds_read_b64_tr_b16 a[16:17], v91 offset:12288
    ds_read_b64_tr_b16 a[18:19], v91 offset:12800
    ds_read_b64_tr_b16 a[20:21], v91 offset:14336
    ds_read_b64_tr_b16 a[22:23], v91 offset:14848
    ds_read_b64_tr_b16 a[24:25], v92 offset:12288
    ds_read_b64_tr_b16 a[26:27], v92 offset:12800
    ds_read_b64_tr_b16 a[28:29], v92 offset:14336
    ds_read_b64_tr_b16 a[30:31], v92 offset:14848
    s_waitcnt lgkmcnt(0)
    s_add_u32 m0, s40, 12288
    s_add_u32 s64, s39, 0x0
    buffer_load_dwordx4 v89, s[56:59], s64 offen lds
    s_add_u32 m0, s40, 13312
    s_add_u32 s64, s39, 0x5000
    buffer_load_dwordx4 v89, s[56:59], s64 offen lds
    s_add_u32 m0, s40, 14336
    s_add_u32 s64, s39, 0xa000
    buffer_load_dwordx4 v89, s[56:59], s64 offen lds
    s_add_u32 m0, s40, 15360
    s_add_u32 s64, s39, 0xf000
    buffer_load_dwordx4 v89, s[56:59], s64 offen lds
    s_waitcnt vmcnt(32)
    ds_read_b64_tr_b16 a[32:33], v91 offset:16384
    ds_read_b64_tr_b16 a[34:35], v91 offset:16896
    ds_read_b64_tr_b16 a[36:37], v91 offset:18432
    ds_read_b64_tr_b16 a[38:39], v91 offset:18944
    ds_read_b64_tr_b16 a[40:41], v92 offset:16384
    ds_read_b64_tr_b16 a[42:43], v92 offset:16896
    ds_read_b64_tr_b16 a[44:45], v92 offset:18432
    ds_read_b64_tr_b16 a[46:47], v92 offset:18944
    s_waitcnt lgkmcnt(0)
    s_add_u32 m0, s40, 16384
    s_add_u32 s64, s39, 0x14000
    buffer_load_dwordx4 v89, s[56:59], s64 offen lds
    s_add_u32 m0, s40, 17408
    s_add_u32 s64, s39, 0x19000
    buffer_load_dwordx4 v89, s[56:59], s64 offen lds
    s_add_u32 m0, s40, 18432
    s_add_u32 s64, s39, 0x1e000
    buffer_load_dwordx4 v89, s[56:59], s64 offen lds
    s_add_u32 m0, s40, 19456
    s_add_u32 s64, s39, 0x23000
    buffer_load_dwordx4 v89, s[56:59], s64 offen lds
    s_waitcnt vmcnt(32)
    ds_read_b64_tr_b16 a[48:49], v91 offset:20480
    ds_read_b64_tr_b16 a[50:51], v91 offset:20992
    ds_read_b64_tr_b16 a[52:53], v91 offset:22528
    ds_read_b64_tr_b16 a[54:55], v91 offset:23040
    ds_read_b64_tr_b16 a[56:57], v92 offset:20480
    ds_read_b64_tr_b16 a[58:59], v92 offset:20992
    ds_read_b64_tr_b16 a[60:61], v92 offset:22528
    ds_read_b64_tr_b16 a[62:63], v92 offset:23040
    s_waitcnt lgkmcnt(0)
    s_add_u32 m0, s40, 20480
    s_add_u32 s64, s39, 0x40
    buffer_load_dwordx4 v89, s[56:59], s64 offen lds
    s_add_u32 m0, s40, 21504
    s_add_u32 s64, s39, 0x5040
    buffer_load_dwordx4 v89, s[56:59], s64 offen lds
    s_add_u32 m0, s40, 22528
    s_add_u32 s64, s39, 0xa040
    buffer_load_dwordx4 v89, s[56:59], s64 offen lds
    s_add_u32 m0, s40, 23552
    s_add_u32 s64, s39, 0xf040
    buffer_load_dwordx4 v89, s[56:59], s64 offen lds
    s_waitcnt vmcnt(32)
    ds_read_b64_tr_b16 a[64:65], v91 offset:24576
    ds_read_b64_tr_b16 a[66:67], v91 offset:25088
    ds_read_b64_tr_b16 a[68:69], v91 offset:26624
    ds_read_b64_tr_b16 a[70:71], v91 offset:27136
    ds_read_b64_tr_b16 a[72:73], v92 offset:24576
    ds_read_b64_tr_b16 a[74:75], v92 offset:25088
    ds_read_b64_tr_b16 a[76:77], v92 offset:26624
    ds_read_b64_tr_b16 a[78:79], v92 offset:27136
    s_waitcnt lgkmcnt(0)
    s_add_u32 m0, s40, 24576
    s_add_u32 s64, s39, 0x14040
    buffer_load_dwordx4 v89, s[56:59], s64 offen lds
    s_add_u32 m0, s40, 25600
    s_add_u32 s64, s39, 0x19040
    buffer_load_dwordx4 v89, s[56:59], s64 offen lds
    s_add_u32 m0, s40, 26624
    s_add_u32 s64, s39, 0x1e040
    buffer_load_dwordx4 v89, s[56:59], s64 offen lds
    s_add_u32 m0, s40, 27648
    s_add_u32 s64, s39, 0x23040
    buffer_load_dwordx4 v89, s[56:59], s64 offen lds
    s_waitcnt vmcnt(32)
    ds_read_b64_tr_b16 a[80:81], v91 offset:28672
    ds_read_b64_tr_b16 a[82:83], v91 offset:29184
    ds_read_b64_tr_b16 a[84:85], v91 offset:30720
    ds_read_b64_tr_b16 a[86:87], v91 offset:31232
    ds_read_b64_tr_b16 a[88:89], v92 offset:28672
    ds_read_b64_tr_b16 a[90:91], v92 offset:29184
    ds_read_b64_tr_b16 a[92:93], v92 offset:30720
    ds_read_b64_tr_b16 a[94:95], v92 offset:31232
    s_waitcnt lgkmcnt(0)
    s_add_u32 m0, s40, 28672
    s_add_u32 s64, s39, 0x80
    buffer_load_dwordx4 v90, s[56:59], s64 offen lds
    s_add_u32 m0, s40, 29696
    s_add_u32 s64, s39, 0xa080
    buffer_load_dwordx4 v90, s[56:59], s64 offen lds
    s_add_u32 m0, s40, 30720
    s_add_u32 s64, s39, 0x14080
    buffer_load_dwordx4 v90, s[56:59], s64 offen lds
    s_add_u32 m0, s40, 31744
    s_add_u32 s64, s39, 0x1e080
    buffer_load_dwordx4 v90, s[56:59], s64 offen lds
    s_waitcnt vmcnt(32)
    ds_read_b64_tr_b16 a[96:97], v91 offset:32768
    ds_read_b64_tr_b16 a[98:99], v91 offset:33280
    ds_read_b64_tr_b16 a[100:101], v91 offset:34816
    ds_read_b64_tr_b16 a[102:103], v91 offset:35328
    ds_read_b64_tr_b16 a[104:105], v92 offset:32768
    ds_read_b64_tr_b16 a[106:107], v92 offset:33280
    ds_read_b64_tr_b16 a[108:109], v92 offset:34816
    ds_read_b64_tr_b16 a[110:111], v92 offset:35328
    s_waitcnt lgkmcnt(0)
    s_add_u32 m0, s40, 32768
    s_add_u32 s64, s72, 0x180000
    buffer_load_dwordx4 v88, s[48:51], s64 offen lds
    s_add_u32 m0, s40, 33792
    s_add_u32 s64, s72, 0x1a0000
    buffer_load_dwordx4 v88, s[48:51], s64 offen lds
    s_add_u32 m0, s40, 34816
    s_add_u32 s64, s72, 0x1c0000
    buffer_load_dwordx4 v88, s[48:51], s64 offen lds
    s_add_u32 m0, s40, 35840
    s_add_u32 s64, s72, 0x1e0000
    buffer_load_dwordx4 v88, s[48:51], s64 offen lds
    s_waitcnt vmcnt(32)
    ds_read_b64_tr_b16 a[112:113], v91 offset:0
    ds_read_b64_tr_b16 a[114:115], v91 offset:512
    ds_read_b64_tr_b16 a[116:117], v91 offset:2048
    ds_read_b64_tr_b16 a[118:119], v91 offset:2560
    ds_read_b64_tr_b16 a[120:121], v92 offset:0
    ds_read_b64_tr_b16 a[122:123], v92 offset:512
    ds_read_b64_tr_b16 a[124:125], v92 offset:2048
    ds_read_b64_tr_b16 a[126:127], v92 offset:2560
    s_waitcnt lgkmcnt(0)
    s_add_u32 m0, s40, 0
    s_add_u32 s64, s71, 0x0
    buffer_load_dwordx4 v88, s[48:51], s64 offen lds
    s_add_u32 m0, s40, 1024
    s_add_u32 s64, s71, 0x20000
    buffer_load_dwordx4 v88, s[48:51], s64 offen lds
    s_add_u32 m0, s40, 2048
    s_add_u32 s64, s71, 0x40000
    buffer_load_dwordx4 v88, s[48:51], s64 offen lds
    s_add_u32 m0, s40, 3072
    s_add_u32 s64, s71, 0x60000
    buffer_load_dwordx4 v88, s[48:51], s64 offen lds
    s_waitcnt vmcnt(32)
    ds_read_b64_tr_b16 a[128:129], v91 offset:4096
    ds_read_b64_tr_b16 a[130:131], v91 offset:4608
    ds_read_b64_tr_b16 a[132:133], v91 offset:6144
    ds_read_b64_tr_b16 a[134:135], v91 offset:6656
    ds_read_b64_tr_b16 a[136:137], v92 offset:4096
    ds_read_b64_tr_b16 a[138:139], v92 offset:4608
    ds_read_b64_tr_b16 a[140:141], v92 offset:6144
    ds_read_b64_tr_b16 a[142:143], v92 offset:6656
    s_waitcnt lgkmcnt(0)
    s_add_u32 m0, s40, 4096
    s_add_u32 s64, s71, 0x80000
    buffer_load_dwordx4 v88, s[48:51], s64 offen lds
    s_add_u32 m0, s40, 5120
    s_add_u32 s64, s71, 0xa0000
    buffer_load_dwordx4 v88, s[48:51], s64 offen lds
    s_add_u32 m0, s40, 6144
    s_add_u32 s64, s71, 0xc0000
    buffer_load_dwordx4 v88, s[48:51], s64 offen lds
    s_add_u32 m0, s40, 7168
    s_add_u32 s64, s71, 0xe0000
    buffer_load_dwordx4 v88, s[48:51], s64 offen lds
    s_waitcnt vmcnt(32)
    ds_read_b64_tr_b16 a[144:145], v91 offset:8192
    ds_read_b64_tr_b16 a[146:147], v91 offset:8704
    ds_read_b64_tr_b16 a[148:149], v91 offset:10240
    ds_read_b64_tr_b16 a[150:151], v91 offset:10752
    ds_read_b64_tr_b16 a[152:153], v92 offset:8192
    ds_read_b64_tr_b16 a[154:155], v92 offset:8704
    ds_read_b64_tr_b16 a[156:157], v92 offset:10240
    ds_read_b64_tr_b16 a[158:159], v92 offset:10752
    s_waitcnt lgkmcnt(0)
    s_add_u32 m0, s40, 8192
    s_add_u32 s64, s71, 0x100000
    buffer_load_dwordx4 v88, s[48:51], s64 offen lds
    s_add_u32 m0, s40, 9216
    s_add_u32 s64, s71, 0x120000
    buffer_load_dwordx4 v88, s[48:51], s64 offen lds
    s_add_u32 m0, s40, 10240
    s_add_u32 s64, s71, 0x140000
    buffer_load_dwordx4 v88, s[48:51], s64 offen lds
    s_add_u32 m0, s40, 11264
    s_add_u32 s64, s71, 0x160000
    buffer_load_dwordx4 v88, s[48:51], s64 offen lds
    s_waitcnt vmcnt(32)
    ds_read_b64_tr_b16 a[160:161], v93 offset:12288
    ds_read_b64_tr_b16 a[162:163], v93 offset:12544
    ds_read_b64_tr_b16 a[164:165], v93 offset:13312
    ds_read_b64_tr_b16 a[166:167], v93 offset:13568
    ds_read_b64_tr_b16 a[168:169], v93 offset:14336
    ds_read_b64_tr_b16 a[170:171], v93 offset:14592
    ds_read_b64_tr_b16 a[172:173], v93 offset:15360
    ds_read_b64_tr_b16 a[174:175], v93 offset:15616
    s_waitcnt lgkmcnt(0)
    s_add_u32 m0, s40, 12288
    s_add_u32 s64, s71, 0x180000
    buffer_load_dwordx4 v88, s[48:51], s64 offen lds
    s_add_u32 m0, s40, 13312
    s_add_u32 s64, s71, 0x1a0000
    buffer_load_dwordx4 v88, s[48:51], s64 offen lds
    s_add_u32 m0, s40, 14336
    s_add_u32 s64, s71, 0x1c0000
    buffer_load_dwordx4 v88, s[48:51], s64 offen lds
    s_add_u32 m0, s40, 15360
    s_add_u32 s64, s71, 0x1e0000
    buffer_load_dwordx4 v88, s[48:51], s64 offen lds
    s_waitcnt vmcnt(32)
    ds_read_b64_tr_b16 a[176:177], v93 offset:16384
    ds_read_b64_tr_b16 a[178:179], v93 offset:16640
    ds_read_b64_tr_b16 a[180:181], v93 offset:17408
    ds_read_b64_tr_b16 a[182:183], v93 offset:17664
    ds_read_b64_tr_b16 a[184:185], v93 offset:18432
    ds_read_b64_tr_b16 a[186:187], v93 offset:18688
    ds_read_b64_tr_b16 a[188:189], v93 offset:19456
    ds_read_b64_tr_b16 a[190:191], v93 offset:19712
    s_waitcnt lgkmcnt(0)
    s_add_u32 m0, s40, 16384
    s_add_u32 s64, s71, 0x200000
    buffer_load_dwordx4 v88, s[48:51], s64 offen lds
    s_add_u32 m0, s40, 17408
    s_add_u32 s64, s71, 0x220000
    buffer_load_dwordx4 v88, s[48:51], s64 offen lds
    s_add_u32 m0, s40, 18432
    s_add_u32 s64, s71, 0x240000
    buffer_load_dwordx4 v88, s[48:51], s64 offen lds
    s_add_u32 m0, s40, 19456
    s_add_u32 s64, s71, 0x260000
    buffer_load_dwordx4 v88, s[48:51], s64 offen lds
    s_waitcnt vmcnt(32)
    ds_read_b64_tr_b16 a[192:193], v93 offset:20480
    ds_read_b64_tr_b16 a[194:195], v93 offset:20736
    ds_read_b64_tr_b16 a[196:197], v93 offset:21504
    ds_read_b64_tr_b16 a[198:199], v93 offset:21760
    ds_read_b64_tr_b16 a[200:201], v93 offset:22528
    ds_read_b64_tr_b16 a[202:203], v93 offset:22784
    ds_read_b64_tr_b16 a[204:205], v93 offset:23552
    ds_read_b64_tr_b16 a[206:207], v93 offset:23808
    s_waitcnt lgkmcnt(0)
    s_add_u32 m0, s40, 20480
    s_add_u32 s64, s72, 0x0
    buffer_load_dwordx4 v88, s[48:51], s64 offen lds
    s_add_u32 m0, s40, 21504
    s_add_u32 s64, s72, 0x20000
    buffer_load_dwordx4 v88, s[48:51], s64 offen lds
    s_add_u32 m0, s40, 22528
    s_add_u32 s64, s72, 0x40000
    buffer_load_dwordx4 v88, s[48:51], s64 offen lds
    s_add_u32 m0, s40, 23552
    s_add_u32 s64, s72, 0x60000
    buffer_load_dwordx4 v88, s[48:51], s64 offen lds
    s_waitcnt vmcnt(32)
    ds_read_b64_tr_b16 a[208:209], v93 offset:24576
    ds_read_b64_tr_b16 a[210:211], v93 offset:24832
    ds_read_b64_tr_b16 a[212:213], v93 offset:25600
    ds_read_b64_tr_b16 a[214:215], v93 offset:25856
    ds_read_b64_tr_b16 a[216:217], v93 offset:26624
    ds_read_b64_tr_b16 a[218:219], v93 offset:26880
    ds_read_b64_tr_b16 a[220:221], v93 offset:27648
    ds_read_b64_tr_b16 a[222:223], v93 offset:27904
    s_waitcnt lgkmcnt(0)
    s_add_u32 m0, s40, 24576
    s_add_u32 s64, s72, 0x80000
    buffer_load_dwordx4 v88, s[48:51], s64 offen lds
    s_add_u32 m0, s40, 25600
    s_add_u32 s64, s72, 0xa0000
    buffer_load_dwordx4 v88, s[48:51], s64 offen lds
    s_add_u32 m0, s40, 26624
    s_add_u32 s64, s72, 0xc0000
    buffer_load_dwordx4 v88, s[48:51], s64 offen lds
    s_add_u32 m0, s40, 27648
    s_add_u32 s64, s72, 0xe0000
    buffer_load_dwordx4 v88, s[48:51], s64 offen lds
    s_waitcnt vmcnt(32)
    ds_read_b64_tr_b16 a[224:225], v94 offset:28672
    ds_read_b64_tr_b16 a[226:227], v94 offset:28800
    ds_read_b64_tr_b16 a[228:229], v94 offset:29696
    ds_read_b64_tr_b16 a[230:231], v94 offset:29824
    ds_read_b64_tr_b16 a[232:233], v94 offset:30720
    ds_read_b64_tr_b16 a[234:235], v94 offset:30848
    ds_read_b64_tr_b16 a[236:237], v94 offset:31744
    ds_read_b64_tr_b16 a[238:239], v94 offset:31872
    s_waitcnt lgkmcnt(0)
    s_add_u32 m0, s40, 28672
    s_add_u32 s64, s72, 0x100000
    buffer_load_dwordx4 v88, s[48:51], s64 offen lds
    s_add_u32 m0, s40, 29696
    s_add_u32 s64, s72, 0x120000
    buffer_load_dwordx4 v88, s[48:51], s64 offen lds
    s_add_u32 m0, s40, 30720
    s_add_u32 s64, s72, 0x140000
    buffer_load_dwordx4 v88, s[48:51], s64 offen lds
    s_add_u32 m0, s40, 31744
    s_add_u32 s64, s72, 0x160000
    buffer_load_dwordx4 v88, s[48:51], s64 offen lds
    s_waitcnt vmcnt(32)
    ds_read_b64_tr_b16 v[12:13], v91 offset:32768
    ds_read_b64_tr_b16 v[14:15], v91 offset:33280
    ds_read_b64_tr_b16 v[16:17], v91 offset:34816
    ds_read_b64_tr_b16 v[18:19], v91 offset:35328
    ds_read_b64_tr_b16 v[20:21], v92 offset:32768
    ds_read_b64_tr_b16 v[22:23], v92 offset:33280
    ds_read_b64_tr_b16 v[24:25], v92 offset:34816
    ds_read_b64_tr_b16 v[26:27], v92 offset:35328
    s_waitcnt lgkmcnt(0)
    ds_write_b128 v2, v[12:15] offset:32768
    ds_write_b128 v2, v[16:19] offset:33792
    ds_write_b128 v2, v[20:23] offset:34816
    ds_write_b128 v2, v[24:27] offset:35840
    s_waitcnt lgkmcnt(0)
    s_waitcnt vmcnt(28)
    ds_read_b64_tr_b16 v[12:13], v91 offset:0
    ds_read_b64_tr_b16 v[14:15], v91 offset:512
    ds_read_b64_tr_b16 v[16:17], v91 offset:2048
    ds_read_b64_tr_b16 v[18:19], v91 offset:2560
    ds_read_b64_tr_b16 v[20:21], v92 offset:0
    ds_read_b64_tr_b16 v[22:23], v92 offset:512
    ds_read_b64_tr_b16 v[24:25], v92 offset:2048
    ds_read_b64_tr_b16 v[26:27], v92 offset:2560
    s_waitcnt lgkmcnt(0)
    ds_write_b128 v2, v[12:15] offset:0
    ds_write_b128 v2, v[16:19] offset:1024
    ds_write_b128 v2, v[20:23] offset:2048
    ds_write_b128 v2, v[24:27] offset:3072
    s_waitcnt lgkmcnt(0)
    s_waitcnt vmcnt(24)
    ds_read_b64_tr_b16 v[12:13], v91 offset:4096
    ds_read_b64_tr_b16 v[14:15], v91 offset:4608
    ds_read_b64_tr_b16 v[16:17], v91 offset:6144
    ds_read_b64_tr_b16 v[18:19], v91 offset:6656
    ds_read_b64_tr_b16 v[20:21], v92 offset:4096
    ds_read_b64_tr_b16 v[22:23], v92 offset:4608
    ds_read_b64_tr_b16 v[24:25], v92 offset:6144
    ds_read_b64_tr_b16 v[26:27], v92 offset:6656
    s_waitcnt lgkmcnt(0)
    ds_write_b128 v2, v[12:15] offset:4096
    ds_write_b128 v2, v[16:19] offset:5120
    ds_write_b128 v2, v[20:23] offset:6144
    ds_write_b128 v2, v[24:27] offset:7168
    s_waitcnt lgkmcnt(0)
    s_waitcnt vmcnt(20)
    ds_read_b64_tr_b16 v[12:13], v91 offset:8192
    ds_read_b64_tr_b16 v[14:15], v91 offset:8704
    ds_read_b64_tr_b16 v[16:17], v91 offset:10240
    ds_read_b64_tr_b16 v[18:19], v91 offset:10752
    ds_read_b64_tr_b16 v[20:21], v92 offset:8192
    ds_read_b64_tr_b16 v[22:23], v92 offset:8704
    ds_read_b64_tr_b16 v[24:25], v92 offset:10240
    ds_read_b64_tr_b16 v[26:27], v92 offset:10752
    s_waitcnt lgkmcnt(0)
    ds_write_b128 v2, v[12:15] offset:8192
    ds_write_b128 v2, v[16:19] offset:9216
    ds_write_b128 v2, v[20:23] offset:10240
    ds_write_b128 v2, v[24:27] offset:11264
    s_waitcnt lgkmcnt(0)
    s_waitcnt vmcnt(16)
    ds_read_b64_tr_b16 v[12:13], v91 offset:12288
    ds_read_b64_tr_b16 v[14:15], v91 offset:12800
    ds_read_b64_tr_b16 v[16:17], v91 offset:14336
    ds_read_b64_tr_b16 v[18:19], v91 offset:14848
    ds_read_b64_tr_b16 v[20:21], v92 offset:12288
    ds_read_b64_tr_b16 v[22:23], v92 offset:12800
    ds_read_b64_tr_b16 v[24:25], v92 offset:14336
    ds_read_b64_tr_b16 v[26:27], v92 offset:14848
    s_waitcnt lgkmcnt(0)
    ds_write_b128 v2, v[12:15] offset:12288
    ds_write_b128 v2, v[16:19] offset:13312
    ds_write_b128 v2, v[20:23] offset:14336
    ds_write_b128 v2, v[24:27] offset:15360
    s_waitcnt lgkmcnt(0)
    s_waitcnt vmcnt(12)
    ds_read_b64_tr_b16 v[12:13], v91 offset:16384
    ds_read_b64_tr_b16 v[14:15], v91 offset:16896
    ds_read_b64_tr_b16 v[16:17], v91 offset:18432
    ds_read_b64_tr_b16 v[18:19], v91 offset:18944
    ds_read_b64_tr_b16 v[20:21], v92 offset:16384
    ds_read_b64_tr_b16 v[22:23], v92 offset:16896
    ds_read_b64_tr_b16 v[24:25], v92 offset:18432
    ds_read_b64_tr_b16 v[26:27], v92 offset:18944
    s_waitcnt lgkmcnt(0)
    ds_write_b128 v2, v[12:15] offset:16384
    ds_write_b128 v2, v[16:19] offset:17408
    ds_write_b128 v2, v[20:23] offset:18432
    ds_write_b128 v2, v[24:27] offset:19456
    s_waitcnt lgkmcnt(0)
    s_waitcnt vmcnt(8)
    ds_read_b64_tr_b16 v[12:13], v91 offset:20480
    ds_read_b64_tr_b16 v[14:15], v91 offset:20992
    ds_read_b64_tr_b16 v[16:17], v91 offset:22528
    ds_read_b64_tr_b16 v[18:19], v91 offset:23040
    ds_read_b64_tr_b16 v[20:21], v92 offset:20480
    ds_read_b64_tr_b16 v[22:23], v92 offset:20992
    ds_read_b64_tr_b16 v[24:25], v92 offset:22528
    ds_read_b64_tr_b16 v[26:27], v92 offset:23040
    s_waitcnt lgkmcnt(0)
    ds_write_b128 v2, v[12:15] offset:20480
    ds_write_b128 v2, v[16:19] offset:21504
    ds_write_b128 v2, v[20:23] offset:22528
    ds_write_b128 v2, v[24:27] offset:23552
    s_waitcnt lgkmcnt(0)
    s_waitcnt vmcnt(4)
    ds_read_b64_tr_b16 v[12:13], v91 offset:24576
    ds_read_b64_tr_b16 v[14:15], v91 offset:25088
    ds_read_b64_tr_b16 v[16:17], v91 offset:26624
    ds_read_b64_tr_b16 v[18:19], v91 offset:27136
    ds_read_b64_tr_b16 v[20:21], v92 offset:24576
    ds_read_b64_tr_b16 v[22:23], v92 offset:25088
    ds_read_b64_tr_b16 v[24:25], v92 offset:26624
    ds_read_b64_tr_b16 v[26:27], v92 offset:27136
    s_waitcnt lgkmcnt(0)
    ds_write_b128 v2, v[12:15] offset:24576
    ds_write_b128 v2, v[16:19] offset:25600
    ds_write_b128 v2, v[20:23] offset:26624
    ds_write_b128 v2, v[24:27] offset:27648
    s_waitcnt lgkmcnt(0)
    s_waitcnt vmcnt(0)
    ds_read_b64_tr_b16 v[12:13], v91 offset:28672
    ds_read_b64_tr_b16 v[14:15], v91 offset:29184
    ds_read_b64_tr_b16 v[16:17], v91 offset:30720
    ds_read_b64_tr_b16 v[18:19], v91 offset:31232
    ds_read_b64_tr_b16 v[20:21], v92 offset:28672
    ds_read_b64_tr_b16 v[22:23], v92 offset:29184
    ds_read_b64_tr_b16 v[24:25], v92 offset:30720
    ds_read_b64_tr_b16 v[26:27], v92 offset:31232
    s_waitcnt lgkmcnt(0)
    ds_write_b128 v2, v[12:15] offset:28672
    ds_write_b128 v2, v[16:19] offset:29696
    ds_write_b128 v2, v[20:23] offset:30720
    ds_write_b128 v2, v[24:27] offset:31744
    s_waitcnt lgkmcnt(0)
    s_cmp_lg_u32 s97, 0
    s_cbranch_scc1 CM_7
    v_mbcnt_lo_u32_b32 v0, -1, 0
    v_mbcnt_hi_u32_b32 v0, -1, v0
    v_mul_u32_u24 v8, 32, v0
    s_mov_b32 s64, 0x0
    s_mov_b32 s65, 0
    s_mov_b64 exec, 0xff
TK_8:
    buffer_load_dword v9, v8, s[60:63], s64 offen sc1
    s_add_u32 s65, s65, 1
    s_waitcnt vmcnt(0)
    s_mov_b32 s66, 0
    v_readlane_b32 s67, v9, 0
    s_add_u32 s66, s66, s67
    v_readlane_b32 s67, v9, 1
    s_add_u32 s66, s66, s67
    v_readlane_b32 s67, v9, 2
    s_add_u32 s66, s66, s67
    v_readlane_b32 s67, v9, 3
    s_add_u32 s66, s66, s67
    v_readlane_b32 s67, v9, 4
    s_add_u32 s66, s66, s67
    v_readlane_b32 s67, v9, 5
    s_add_u32 s66, s66, s67
    v_readlane_b32 s67, v9, 6
    s_add_u32 s66, s66, s67
    v_readlane_b32 s67, v9, 7
    s_add_u32 s66, s66, s67
    s_cmp_ge_u32 s66, 256
    s_cbranch_scc1 TKD_9
    s_cmp_gt_u32 s65, 262144
    s_cbranch_scc0 TK_8
TKD_9:
    v_cmp_ne_u32 vcc, 32, v9
    s_mov_b64 exec, -1
    s_cbranch_vccnz M_SLOW
CM_7:
    s_mov_b32 s65, 0
RI_10:
    buffer_load_dword v8, off, s[60:63], s95 sc1
    s_add_u32 s65, s65, 1
    s_waitcnt vmcnt(0)
    v_readfirstlane_b32 s64, v8
    s_cmp_ge_u32 s64, 192
    s_cbranch_scc1 RID_11
    s_cmp_gt_u32 s65, 65536
    s_cbranch_scc1 RID_11
    s_sleep 4
    s_branch RI_10
RID_11:
    s_mov_b32 s38, 0x3f80
    s_mov_b32 s53, 0
    s_cmp_eq_u32 s14, 2
    s_cselect_b32 s52, 1024, 0
    s_mov_b32 s44, 0x3030303
    s_mov_b32 s45, 0x3030303
    s_mov_b32 s46, 0xc0c0c0c
    s_mov_b32 s47, 0xc0c0c0c
    s_mov_b32 s48, 0x30303030
    s_mov_b32 s49, 0x30303030
    s_mov_b32 s50, 0xc0c0c0c0
    s_mov_b32 s51, 0xc0c0c0c0
    v_and_b32 v8, 7, v0
    v_mul_u32_u24 v8, 288, v8
    v_lshrrev_b32 v9, 4, v0
    v_lshl_add_u32 v8, v9, 4, v8
    v_add_u32 v0, 12800, v8
    s_mov_b32 s68, 0
    s_mov_b32 s40, 0
    s_mov_b32 s65, 0
CW_12:
    buffer_load_dwordx2 v[8:9], off, s[60:63], 0 offset:132 sc1
    s_add_u32 s65, s65, 1
    s_waitcnt vmcnt(0)
    v_readfirstlane_b32 s66, v8
    v_readfirstlane_b32 s67, v9
    s_min_u32 s64, s66, s67
    s_cmp_lg_u32 s64, 0
    s_cbranch_scc1 CWD_13
    s_cmp_gt_u32 s65, 65536
    s_cbranch_scc1 CWD_13
    s_sleep 4
    s_branch CW_12
CWD_13:
    s_sub_u32 s66, s66, 1
    s_and_b32 s66, s66, 3
    s_sub_u32 s67, s67, 1
    s_and_b32 s67, s67, 3
    s_mov_b32 s64, s66
    s_mov_b32 s65, s67
    s_cmp_eq_u32 s12, 0
    s_cselect_b32 s66, s65, s64
    s_cselect_b32 s64, s64, s65
    s_and_b32 s64, s64, 3
    s_lshl_b32 s64, s64, 13
    s_and_b32 s66, s66, 3
    s_lshl_b32 s66, s66, 13
    s_add_u32 s21, s21, s64
    s_add_u32 s20, s20, s66
    s_cmp_eq_u32 s42, 0
    s_cselect_b32 s18, 0x40000000, s18
    s_cselect_b32 s21, 0x40000000, s21
    s_lshl_b32 s65, s12, 7
    s_add_u32 s65, s65, 0x29a000
    s_cmp_eq_u32 s22, 0
    s_cselect_b32 s22, 0x40000000, s65
    s_lshl_b32 s64, s13, 2
    s_add_u32 s64, s64, s14
    s_cmp_ge_u32 s64, 40
    s_cselect_b32 s65, 40, 0
    s_sub_u32 s64, s64, s65
    s_cmp_ge_u32 s64, 40
    s_cselect_b32 s65, 40, 0
    s_sub_u32 s64, s64, s65
    s_cmp_ge_u32 s64, 40
    s_cselect_b32 s65, 40, 0
    s_sub_u32 s64, s64, s65
    s_lshl_b32 s27, s64, 7
    s_add_u32 s19, s27, 0x4000
    v_mov_b32 v29, 0
FSPIN_14:
    buffer_load_dwordx2 v[12:13], v29, s[4:7], s69 offen sc1
    s_add_u32 s68, s68, 1
    s_waitcnt vmcnt(0)
    v_and_b32 v12, v12, v13
    v_cmp_eq_u32 vcc, 0, v12
    s_cbranch_vccz FDONE_15
    s_cmp_gt_u32 s68, 262144
    s_cbranch_scc0 FSPIN_14
FDONE_15:
    s_barrier
    s_mov_b32 m0, s73
    s_nop 0
    buffer_load_dwordx4 v1, s[4:7], s28 offen lds
    buffer_load_dwordx4 v1, s[4:7], s28 offen offset:1024 lds
    s_mov_b32 m0, 15360
    v_lshlrev_b32 v12, 2, v1
    s_add_u32 s65, s3, 0xfff80000
    buffer_load_dword v12, s[4:7], s65 offen lds
    s_mov_b32 s15, 0
    s_mov_b32 s16, 0
    s_add_u32 s66, s17, s52
    buffer_load_dwordx4 v[12:15], v1, s[4:7], s66 offen sc1
    v_add_u32 v29, s52, v1
    s_waitcnt vmcnt(0)
    ds_write_b128 v29, v[12:15] offset:12800
    s_waitcnt lgkmcnt(0)
    v_mov_b64 v[32:33], 0
    v_mov_b64 v[34:35], 0
    v_mov_b64 v[36:37], 0
    v_mov_b64 v[38:39], 0
    v_mov_b64 v[40:41], 0
    v_mov_b64 v[42:43], 0
    v_mov_b64 v[44:45], 0
    v_mov_b64 v[46:47], 0
    v_mov_b64 v[48:49], 0
    v_mov_b64 v[50:51], 0
    v_mov_b64 v[52:53], 0
    v_mov_b64 v[54:55], 0
    ds_read_b128 v[56:59], v2 offset:0
    ds_read_b128 v[60:63], v2 offset:1024
    ds_read_b128 v[64:67], v2 offset:2048
    ds_read_b128 v[68:71], v2 offset:3072
    s_cmp_eq_u32 s97, 0
    s_cbranch_scc1 REC_LOOP
    s_branch REC_LOOP_S
REC_POLL_S:
    s_cmp_lg_u32 s14, 3
    s_cbranch_scc1 NOFLG_16
    s_add_u32 s64, s15, 3
    s_and_b32 s65, s64, 0x43
    s_cmp_lg_u32 s65, 0
    s_cbranch_scc1 NOFLG_16
    s_lshl_b32 s64, s64, 7
    s_add_u32 s64, s64, s69
    v_mov_b32 v29, 0
FSPIN_17:
    buffer_load_dwordx2 v[12:13], v29, s[4:7], s64 offen sc1
    s_add_u32 s68, s68, 1
    s_waitcnt vmcnt(0)
    v_and_b32 v12, v12, v13
    v_cmp_eq_u32 vcc, 0, v12
    s_cbranch_vccz FDONE_18
    s_cmp_gt_u32 s68, 262144
    s_cbranch_scc0 FSPIN_17
FDONE_18:
NOFLG_16:
    s_add_u32 s66, s17, s52
    v_add_u32 v10, s52, v1
    s_add_u32 s3, s3, 0x80000
    s_add_u32 s29, s29, 0x80000
    s_add_u32 s18, s18, 0x4000
    s_add_u32 s21, s21, 0x8000
    s_add_u32 s15, s15, 1
    s_xor_b32 s16, s16, 1
    s_barrier
    s_cmp_lt_u32 s15, 63
    s_cbranch_scc0 REC_END
    s_nop 15
    s_nop 15
    s_nop 15
    s_nop 15
    s_nop 15
    s_nop 15
    s_nop 15
    s_nop 15
    s_nop 15
    s_nop 15
    buffer_load_dwordx4 v[20:23], v1, s[4:7], s66 offen sc1
    v_mov_b64 v[32:33], 0
    v_mov_b64 v[34:35], 0
    v_mov_b64 v[36:37], 0
    v_mov_b64 v[38:39], 0
    v_mov_b64 v[40:41], 0
    v_mov_b64 v[42:43], 0
    ds_read_b128 v[56:59], v2 offset:0
    ds_read_b128 v[60:63], v2 offset:1024
    buffer_load_dwordx4 v[24:27], v1, s[4:7], s66 offen sc1
    v_mov_b64 v[44:45], 0
    v_mov_b64 v[46:47], 0
    v_mov_b64 v[48:49], 0
    v_mov_b64 v[50:51], 0
    v_mov_b64 v[52:53], 0
    v_mov_b64 v[54:55], 0
    ds_read_b128 v[64:67], v2 offset:2048
    ds_read_b128 v[68:71], v2 offset:3072
    buffer_load_dwordx4 v[28:31], v1, s[4:7], s66 offen sc1
IPOLL_19:
    s_waitcnt vmcnt(2)
    ds_write_b128 v10, v[20:23] offset:12800
    v_max3_u32 v11, v20, v21, v22
    v_max_u32 v11, v11, v23
    v_cmp_eq_u32 vcc, -1, v11
    s_cbranch_vccz IOK_20
    buffer_load_dwordx4 v[20:23], v1, s[4:7], s66 offen sc1
    s_waitcnt vmcnt(2)
    ds_write_b128 v10, v[24:27] offset:12800
    v_max3_u32 v11, v24, v25, v26
    v_max_u32 v11, v11, v27
    v_cmp_eq_u32 vcc, -1, v11
    s_cbranch_vccz IOK_20
    buffer_load_dwordx4 v[24:27], v1, s[4:7], s66 offen sc1
    s_waitcnt vmcnt(2)
    ds_write_b128 v10, v[28:31] offset:12800
    v_max3_u32 v11, v28, v29, v30
    v_max_u32 v11, v11, v31
    v_cmp_eq_u32 vcc, -1, v11
    s_add_u32 s68, s68, 1
    s_add_u32 s53, s53, 1
    s_cmp_gt_u32 s68, 262144
    s_cbranch_scc1 IOK_20
    s_cbranch_vccz IOK_20
    buffer_load_dwordx4 v[28:31], v1, s[4:7], s66 offen sc1
    s_branch IPOLL_19
IOK_20:
    s_waitcnt lgkmcnt(0)
REC_LOOP_S:
    s_barrier
    ds_read_b128 v[12:15], v1 offset:12800
    ds_read_b128 v[16:19], v1 offset:13824
    buffer_load_dwordx4 v[20:23], v1, s[4:7], s17 offen offset:2048
    ds_read_b128 v[72:75], v2 offset:4096
    ds_read_b128 v[76:79], v2 offset:5120
    ds_read_b128 v[80:83], v2 offset:6144
    ds_read_b128 v[84:87], v2 offset:7168
    s_add_u32 s74, s17, 0x1000
    s_add_u32 s20, s20, 0x8000
    s_add_u32 s75, s20, 0x1000
    s_mov_b32 m0, 15360
    s_add_u32 s65, s20, s27
    s_waitcnt lgkmcnt(5)
    v_smfmac_f32_16x16x64_bf16 v[32:35], v[12:15], v[96:103], v6
    buffer_load_dwordx4 v[24:27], v1, s[4:7], s17 offen offset:3072
    v_smfmac_f32_16x16x64_bf16 v[36:39], v[12:15], v[104:111], v6
    v_smfmac_f32_16x16x64_bf16 v[40:43], v[12:15], v[56:63], v6
    buffer_load_dwordx4 v[28:31], v1, s[4:7], s74 offen offset:0
    ds_read_b128 v[56:59], v2 offset:8192
    ds_read_b128 v[60:63], v2 offset:9216
    v_smfmac_f32_16x16x64_bf16 v[44:47], v[12:15], v[64:71], v6
    ds_read_b128 v[64:67], v2 offset:10240
    ds_read_b128 v[68:71], v2 offset:11264
    s_waitcnt lgkmcnt(8)
    v_smfmac_f32_16x16x64_bf16 v[48:51], v[12:15], a[0:7], v6
    v_smfmac_f32_16x16x64_bf16 v[52:55], v[12:15], a[8:15], v6
    buffer_load_dwordx4 v[12:15], v1, s[4:7], s20 offen offset:0
    buffer_load_dword off, s[4:7], s65 lds
    v_smfmac_f32_16x16x64_bf16 v[32:35], v[16:19], v[112:119], v6
    v_smfmac_f32_16x16x64_bf16 v[36:39], v[16:19], v[120:127], v6
    s_waitcnt lgkmcnt(4)
    v_smfmac_f32_16x16x64_bf16 v[40:43], v[16:19], v[72:79], v6
    ds_read_b128 v[72:75], v2 offset:12288
    ds_read_b128 v[76:79], v2 offset:13312
    v_smfmac_f32_16x16x64_bf16 v[44:47], v[16:19], v[80:87], v6
    ds_read_b128 v[80:83], v2 offset:14336
    ds_read_b128 v[84:87], v2 offset:15360
    s_waitcnt vmcnt(4)
    v_cmp_eq_u32 vcc, -1, v23
    v_smfmac_f32_16x16x64_bf16 v[48:51], v[16:19], a[16:23], v6
    v_smfmac_f32_16x16x64_bf16 v[52:55], v[16:19], a[24:31], v6
    s_cbranch_vccnz RETRY_21
BACK_22:
    buffer_load_dwordx4 v[16:19], v1, s[4:7], s20 offen offset:1024
    v_smfmac_f32_16x16x64_bf16 v[32:35], v[20:23], v[128:135], v6
    v_smfmac_f32_16x16x64_bf16 v[36:39], v[20:23], v[136:143], v6
    s_waitcnt lgkmcnt(4)
    v_smfmac_f32_16x16x64_bf16 v[40:43], v[20:23], v[56:63], v6
    ds_read_b128 v[56:59], v2 offset:16384
    ds_read_b128 v[60:63], v2 offset:17408
    v_smfmac_f32_16x16x64_bf16 v[44:47], v[20:23], v[64:71], v6
    ds_read_b128 v[64:67], v2 offset:18432
    ds_read_b128 v[68:71], v2 offset:19456
    s_waitcnt vmcnt(4)
    v_cmp_eq_u32 vcc, -1, v27
    v_smfmac_f32_16x16x64_bf16 v[48:51], v[20:23], a[32:39], v6
    v_smfmac_f32_16x16x64_bf16 v[52:55], v[20:23], a[40:47], v6
    s_cbranch_vccnz RETRY_23
BACK_24:
    buffer_load_dwordx4 v[20:23], v1, s[4:7], s20 offen offset:2048
    v_smfmac_f32_16x16x64_bf16 v[32:35], v[24:27], v[144:151], v6
    v_smfmac_f32_16x16x64_bf16 v[36:39], v[24:27], v[152:159], v6
    s_waitcnt lgkmcnt(4)
    v_smfmac_f32_16x16x64_bf16 v[40:43], v[24:27], v[72:79], v6
    ds_read_b128 v[72:75], v2 offset:20480
    ds_read_b128 v[76:79], v2 offset:21504
    v_smfmac_f32_16x16x64_bf16 v[44:47], v[24:27], v[80:87], v6
    ds_read_b128 v[80:83], v2 offset:22528
    ds_read_b128 v[84:87], v2 offset:23552
    s_waitcnt vmcnt(4)
    v_cmp_eq_u32 vcc, -1, v31
    v_smfmac_f32_16x16x64_bf16 v[48:51], v[24:27], a[48:55], v6
    v_smfmac_f32_16x16x64_bf16 v[52:55], v[24:27], a[56:63], v6
    s_cbranch_vccnz RETRY_25
BACK_26:
    buffer_load_dwordx4 v[24:27], v1, s[4:7], s20 offen offset:3072
    v_smfmac_f32_16x16x64_bf16 v[32:35], v[28:31], v[160:167], v6
    v_smfmac_f32_16x16x64_bf16 v[36:39], v[28:31], v[168:175], v6
    s_waitcnt lgkmcnt(4)
    v_smfmac_f32_16x16x64_bf16 v[40:43], v[28:31], v[56:63], v6
    ds_read_b128 v[56:59], v2 offset:24576
    ds_read_b128 v[60:63], v2 offset:25600
    v_smfmac_f32_16x16x64_bf16 v[44:47], v[28:31], v[64:71], v6
    ds_read_b128 v[64:67], v2 offset:26624
    ds_read_b128 v[68:71], v2 offset:27648
    s_waitcnt vmcnt(4)
    v_cmp_eq_u32 vcc, -1, v15
    v_smfmac_f32_16x16x64_bf16 v[48:51], v[28:31], a[64:71], v6
    v_smfmac_f32_16x16x64_bf16 v[52:55], v[28:31], a[72:79], v6
    s_cbranch_vccnz RETRY_27
BACK_28:
    buffer_load_dwordx4 v[28:31], v1, s[4:7], s75 offen offset:0
    v_smfmac_f32_16x16x64_bf16 v[32:35], v[12:15], v[176:183], v6
    s_waitcnt vmcnt(3)
    v_cmp_eq_u32 vcc, -1, v19
    v_smfmac_f32_16x16x64_bf16 v[36:39], v[12:15], v[184:191], v6
    s_waitcnt lgkmcnt(4)
    v_smfmac_f32_16x16x64_bf16 v[40:43], v[12:15], v[72:79], v6
    ds_read_b128 v[72:75], v2 offset:28672
    ds_read_b128 v[76:79], v2 offset:29696
    v_smfmac_f32_16x16x64_bf16 v[44:47], v[12:15], v[80:87], v6
    ds_read_b128 v[80:83], v2 offset:30720
    ds_read_b128 v[84:87], v2 offset:31744
    buffer_load_dwordx4 v[88:91], v1, s[4:7], s29 offen offset:0
    s_cbranch_vccnz RETRY_29
BACK_30:
    v_smfmac_f32_16x16x64_bf16 v[32:35], v[16:19], v[192:199], v6
    s_waitcnt vmcnt(3)
    v_cmp_eq_u32 vcc, -1, v23
    v_smfmac_f32_16x16x64_bf16 v[36:39], v[16:19], v[200:207], v6
    s_waitcnt lgkmcnt(4)
    v_smfmac_f32_16x16x64_bf16 v[40:43], v[16:19], v[56:63], v6
    ds_read_b128 v[56:59], v2 offset:32768
    ds_read_b128 v[60:63], v2 offset:33792
    v_smfmac_f32_16x16x64_bf16 v[44:47], v[16:19], v[64:71], v6
    ds_read_b128 v[64:67], v2 offset:34816
    ds_read_b128 v[68:71], v2 offset:35840
    s_cbranch_vccnz RETRY_31
BACK_32:
    v_smfmac_f32_16x16x64_bf16 v[32:35], v[20:23], v[208:215], v6
    s_waitcnt vmcnt(2)
    v_cmp_eq_u32 vcc, -1, v27
    v_smfmac_f32_16x16x64_bf16 v[36:39], v[20:23], v[216:223], v6
    s_waitcnt lgkmcnt(4)
    v_smfmac_f32_16x16x64_bf16 v[40:43], v[20:23], v[72:79], v6
    ds_read_b128 v[72:75], v1 offset:0
    ds_read_b128 v[76:79], v1 offset:4096
    v_smfmac_f32_16x16x64_bf16 v[44:47], v[20:23], v[80:87], v6
    ds_read_b128 v[80:83], v1 offset:1024
    ds_read_b128 v[84:87], v1 offset:5120
    buffer_load_dwordx4 v[92:95], v1, s[4:7], s29 offen offset:1024
    s_cbranch_vccnz RETRY_33
BACK_34:
    v_smfmac_f32_16x16x64_bf16 v[32:35], v[24:27], v[224:231], v6
    s_waitcnt vmcnt(2)
    v_cmp_eq_u32 vcc, -1, v31
    v_smfmac_f32_16x16x64_bf16 v[36:39], v[24:27], v[232:239], v6
    s_waitcnt lgkmcnt(4)
    v_smfmac_f32_16x16x64_bf16 v[40:43], v[24:27], v[56:63], v6
    ds_read_b128 v[56:59], v1 offset:2048
    ds_read_b128 v[60:63], v1 offset:6144
    v_smfmac_f32_16x16x64_bf16 v[44:47], v[24:27], v[64:71], v6
    ds_read_b128 v[64:67], v1 offset:3072
    ds_read_b128 v[68:71], v1 offset:7168
    s_cbranch_vccnz RETRY_35
BACK_36:
    v_smfmac_f32_16x16x64_bf16 v[32:35], v[28:31], v[240:247], v6
    v_smfmac_f32_16x16x64_bf16 v[36:39], v[28:31], v[248:255], v6
    v_smfmac_f32_16x16x64_bf16 v[40:43], v[28:31], a[240:247], v6
    v_smfmac_f32_16x16x64_bf16 v[44:47], v[28:31], a[248:255], v6
    v_lshlrev_b32 v8, 2, v1
    s_add_u32 s65, s17, s19
    buffer_load_dword v8, s[4:7], s3 offen lds
    buffer_load_dword off, s[4:7], s65 sc1 lds
    buffer_store_dword v6, off, s[4:7], s22 sc1
    s_add_u32 s22, s22, 256
    v_permlane32_swap_b32 v32, v36
    v_permlane32_swap_b32 v33, v37
    v_permlane32_swap_b32 v34, v38
    v_permlane32_swap_b32 v35, v39
    v_pk_add_f32 v[32:33], v[32:33], v[36:37]
    v_pk_add_f32 v[34:35], v[34:35], v[38:39]
    v_cvt_pk_bf16_f32 v36, v32, v33
    v_cvt_pk_bf16_f32 v37, v34, v35
    ds_write_b64 v3, v[36:37] offset:0
    v_permlane32_swap_b32 v40, v44
    v_permlane32_swap_b32 v41, v45
    v_permlane32_swap_b32 v42, v46
    v_permlane32_swap_b32 v43, v47
    v_pk_add_f32 v[40:41], v[40:41], v[44:45]
    v_pk_add_f32 v[42:43], v[42:43], v[46:47]
    v_cvt_pk_bf16_f32 v44, v40, v41
    v_cvt_pk_bf16_f32 v45, v42, v43
    ds_write_b64 v3, v[44:45] offset:2304
    v_smfmac_f32_16x16x64_bf16 v[48:51], v[12:15], a[80:87], v6
    v_smfmac_f32_16x16x64_bf16 v[52:55], v[12:15], a[88:95], v6
    v_smfmac_f32_16x16x64_bf16 v[48:51], v[16:19], a[96:103], v6
    v_smfmac_f32_16x16x64_bf16 v[52:55], v[16:19], a[104:111], v6
    s_waitcnt lgkmcnt(0)
    s_barrier
    ds_read_b64_tr_b16 v[32:33], v4 offset:0
    ds_read_b64_tr_b16 v[34:35], v4 offset:128
    ds_read_b64_tr_b16 v[36:37], v4 offset:256
    ds_read_b64_tr_b16 v[38:39], v4 offset:384
    v_smfmac_f32_16x16x64_bf16 v[48:51], v[20:23], a[112:119], v6
    v_smfmac_f32_16x16x64_bf16 v[52:55], v[20:23], a[120:127], v6
    ds_read_b64_tr_b16 v[40:41], v4 offset:512
    ds_read_b64_tr_b16 v[42:43], v4 offset:640
    ds_read_b64_tr_b16 v[44:45], v4 offset:768
    ds_read_b64_tr_b16 v[46:47], v4 offset:896
    v_smfmac_f32_16x16x64_bf16 v[48:51], v[24:27], a[128:135], v6
    v_smfmac_f32_16x16x64_bf16 v[52:55], v[24:27], a[136:143], v6
    s_waitcnt lgkmcnt(4)
    v_mfma_f32_16x16x32_bf16 v[8:11], v[72:75], v[32:35], 0
    ds_read_b64_tr_b16 v[12:13], v4 offset:2304
    ds_read_b64_tr_b16 v[14:15], v4 offset:2432
    v_mfma_f32_16x16x32_bf16 v[8:11], v[80:83], v[36:39], v[8:11]
    ds_read_b64_tr_b16 v[16:17], v4 offset:2560
    ds_read_b64_tr_b16 v[18:19], v4 offset:2688
    s_waitcnt lgkmcnt(4)
    v_mfma_f32_16x16x32_bf16 v[8:11], v[56:59], v[40:43], v[8:11]
    ds_read_b64_tr_b16 v[56:57], v4 offset:2816
    ds_read_b64_tr_b16 v[58:59], v4 offset:2944
    v_mfma_f32_16x16x32_bf16 v[8:11], v[64:67], v[44:47], v[8:11]
    ds_read_b64_tr_b16 v[64:65], v4 offset:3072
    ds_read_b64_tr_b16 v[66:67], v4 offset:3200
    v_mfma_f32_16x16x32_bf16 v[72:75], v[76:79], v[32:35], 0
    v_mfma_f32_16x16x32_bf16 v[72:75], v[84:87], v[36:39], v[72:75]
    v_mfma_f32_16x16x32_bf16 v[72:75], v[60:63], v[40:43], v[72:75]
    v_mfma_f32_16x16x32_bf16 v[72:75], v[68:71], v[44:47], v[72:75]
    s_waitcnt lgkmcnt(4)
    v_mfma_f32_16x16x32_bf16 v[80:83], v[12:15], v[32:35], 0
    v_mfma_f32_16x16x32_bf16 v[80:83], v[16:19], v[36:39], v[80:83]
    s_waitcnt lgkmcnt(0)
    v_mfma_f32_16x16x32_bf16 v[80:83], v[56:59], v[40:43], v[80:83]
    v_mfma_f32_16x16x32_bf16 v[80:83], v[64:67], v[44:47], v[80:83]
    v_smfmac_f32_16x16x64_bf16 v[48:51], v[28:31], a[144:151], v6
    v_smfmac_f32_16x16x64_bf16 v[52:55], v[28:31], a[152:159], v6
    v_mov_b32 v24, 0x3f803f80
    v_mov_b32 v25, 0x3f803f80
    v_mov_b32 v26, 0x3f803f80
    v_mov_b32 v27, 0x3f803f80
    v_max3_f32 v20, v8, v9, v10
    v_max3_f32 v21, v11, v72, v73
    v_max3_f32 v20, v20, v21, v74
    v_max3_f32 v21, v80, v81, v82
    v_max3_f32 v20, v20, v75, v83
    v_max_f32 v20, v20, v21
    v_mov_b32 v21, v20
    v_cvt_pk_bf16_f32 v48, v48, v49
    v_cvt_pk_bf16_f32 v49, v50, v51
    v_permlane16_swap_b32 v20, v21
    v_max_f32 v20, v20, v21
    v_mov_b32 v21, v20
    v_cvt_pk_bf16_f32 v50, v52, v53
    v_cvt_pk_bf16_f32 v51, v54, v55
    v_permlane32_swap_b32 v20, v21
    v_max_f32 v20, v20, v21
    v_mul_f32 v22, s10, v20
    v_mul_f32 v23, s10, v20
    v_pk_fma_f32 v[8:9], v[8:9], s[10:11], v[22:23] neg_lo:[0,0,1] neg_hi:[0,0,1]
    v_pk_fma_f32 v[10:11], v[10:11], s[10:11], v[22:23] neg_lo:[0,0,1] neg_hi:[0,0,1]
    v_pk_fma_f32 v[72:73], v[72:73], s[10:11], v[22:23] neg_lo:[0,0,1] neg_hi:[0,0,1]
    v_pk_fma_f32 v[74:75], v[74:75], s[10:11], v[22:23] neg_lo:[0,0,1] neg_hi:[0,0,1]
    v_pk_fma_f32 v[80:81], v[80:81], s[10:11], v[22:23] neg_lo:[0,0,1] neg_hi:[0,0,1]
    v_pk_fma_f32 v[82:83], v[82:83], s[10:11], v[22:23] neg_lo:[0,0,1] neg_hi:[0,0,1]
    v_exp_f32 v8, v8
    v_exp_f32 v9, v9
    v_exp_f32 v10, v10
    v_exp_f32 v11, v11
    v_exp_f32 v72, v72
    v_exp_f32 v73, v73
    v_exp_f32 v74, v74
    v_exp_f32 v75, v75
    v_cvt_pk_bf16_f32 v32, v8, v9
    v_cvt_pk_bf16_f32 v33, v10, v11
    v_exp_f32 v80, v80
    v_exp_f32 v81, v81
    v_exp_f32 v82, v82
    v_exp_f32 v83, v83
    v_cvt_pk_bf16_f32 v34, v72, v73
    v_cvt_pk_bf16_f32 v35, v74, v75
    v_cndmask_b32 v12, 0, v24, s[34:35]
    v_cndmask_b32 v13, 0, v24, s[34:35]
    s_waitcnt vmcnt(3)
    v_mfma_f32_16x16x32_bf16 v[8:11], v[24:27], v[32:35], 0
    v_cvt_pk_bf16_f32 v36, v80, v81
    v_mfma_f32_16x16x32_bf16 v[40:43], v[88:91], v[32:35], 0
    v_cvt_pk_bf16_f32 v37, v82, v83
    v_mfma_f32_16x16x32_bf16 v[44:47], v[92:95], v[32:35], 0
    v_mfma_f32_16x16x16_bf16 v[8:11], v[12:13], v[36:37], v[8:11]
    v_mov_b64 v[72:73], 0
    v_mfma_f32_16x16x16_bf16 v[40:43], v[48:49], v[36:37], v[40:43]
    v_mov_b64 v[74:75], 0
    v_mfma_f32_16x16x16_bf16 v[44:47], v[50:51], v[36:37], v[44:47]
    v_mov_b64 v[76:77], 0
    v_mov_b64 v[78:79], 0
    v_mov_b64 v[80:81], 0
    v_mov_b64 v[82:83], 0
    v_rcp_f32 v22, v8
    s_nop 2
    v_cndmask_b32 v40, v44, v40, s[32:33]
    v_cndmask_b32 v41, v45, v41, s[32:33]
    v_cndmask_b32 v42, v46, v42, s[32:33]
    v_cndmask_b32 v43, v47, v43, s[32:33]
    v_mov_b32 v23, v22
    v_pk_mul_f32 v[40:41], v[40:41], v[22:23]
    v_pk_mul_f32 v[42:43], v[42:43], v[22:23]
    v_cvt_pk_bf16_f32 v44, v40, v41
    v_cvt_pk_bf16_f32 v45, v42, v43
    ds_write_b64 v5, v[44:45]
    s_mov_b32 m0, s73
    s_add_u32 s28, s28, 0x80000
    buffer_load_dwordx4 v1, s[4:7], s28 offen lds
    buffer_load_dwordx4 v1, s[4:7], s28 offen offset:1024 lds
    s_waitcnt lgkmcnt(0)
    s_barrier
    ds_read_b128 v[12:15], v0 offset:0
    ds_read_b128 v[16:19], v0 offset:64
    ds_read_b128 v[20:23], v0 offset:128
    ds_read_b128 v[24:27], v0 offset:192
    s_waitcnt lgkmcnt(3)
    v_smfmac_f32_16x16x64_bf16 v[72:75], v[12:15], a[160:167], v6
    s_waitcnt lgkmcnt(2)
    v_smfmac_f32_16x16x64_bf16 v[72:75], v[16:19], a[168:175], v6
    s_waitcnt lgkmcnt(1)
    v_smfmac_f32_16x16x64_bf16 v[72:75], v[20:23], a[176:183], v6
    s_waitcnt lgkmcnt(0)
    v_smfmac_f32_16x16x64_bf16 v[72:75], v[24:27], a[184:191], v6
    v_smfmac_f32_16x16x64_bf16 v[76:79], v[12:15], a[192:199], v6
    v_smfmac_f32_16x16x64_bf16 v[76:79], v[16:19], a[200:207], v6
    v_cvt_pk_bf16_f32 v72, v72, v73
    v_smfmac_f32_16x16x64_bf16 v[76:79], v[20:23], a[208:215], v6
    v_cvt_pk_bf16_f32 v73, v74, v75
    v_smfmac_f32_16x16x64_bf16 v[76:79], v[24:27], a[216:223], v6
    v_and_or_b32 v72, v72, -2, s16
    v_mfma_f32_16x16x32_bf16 v[80:83], v[12:15], a[224:227], 0
    buffer_store_dwordx2 v[72:73], v7, s[4:7], s23 offen sc1
    v_mfma_f32_16x16x32_bf16 v[80:83], v[16:19], a[228:231], v[80:83]
    v_mfma_f32_16x16x32_bf16 v[80:83], v[20:23], a[232:235], v[80:83]
    v_cvt_pk_bf16_f32 v76, v76, v77
    v_cvt_pk_bf16_f32 v77, v78, v79
    v_mfma_f32_16x16x32_bf16 v[80:83], v[24:27], a[236:239], v[80:83]
    v_and_or_b32 v76, v76, -2, s16
    buffer_store_dwordx2 v[76:77], v7, s[4:7], s25 offen sc1
    v_and_b32 v9, 0x70, v1
    v_bfe_u32 v29, v1, 8, 1
    v_lshl_add_u32 v9, v29, 3, v9
    v_bfe_u32 v29, v1, 9, 1
    v_lshl_add_u32 v9, v29, 2, v9
    v_mov_b32 v29, 0x40000000
    v_cvt_pk_bf16_f32 v80, v80, v81
    v_cvt_pk_bf16_f32 v81, v82, v83
    v_and_or_b32 v80, v80, -2, s16
    s_mov_b64 exec, s[34:35]
    buffer_store_dwordx2 v[80:81], v7, s[4:7], s26 offen sc1
    s_mov_b64 exec, -1
    s_add_u32 s17, s17, 0x4000
    s_cmp_lg_u32 s42, 0
    s_cbranch_scc1 OWN_38
    s_cmp_lt_u32 s14, 2
    s_cbranch_scc1 IDLE_37
    s_branch REC_POLL_S
OWN_38:
    v_cndmask_b32 v9, v29, v9, s[32:33]
    v_and_b32 v29, 16, v1
    v_lshlrev_b32 v29, v29, s38
    v_cndmask_b32 v88, 0, v29, s[44:45]
    v_cndmask_b32 v89, 0, v29, s[46:47]
    v_cndmask_b32 v90, 0, v29, s[48:49]
    v_cndmask_b32 v91, 0, v29, s[50:51]
    s_nop 15
    s_nop 15
    s_nop 15
    s_nop 1
    buffer_load_dwordx4 v[12:15], v1, s[4:7], s24 offen offset:0 sc1
    buffer_load_dwordx4 v[16:19], v1, s[4:7], s24 offen offset:1024 sc1
    buffer_load_dwordx4 v[20:23], v1, s[4:7], s24 offen offset:2048 sc1
    buffer_load_dwordx4 v[24:27], v1, s[4:7], s24 offen offset:3072 sc1
    s_barrier
    ds_read_b128 v[56:59], v2 offset:0
    ds_read_b128 v[60:63], v2 offset:1024
    ds_read_b128 v[64:67], v2 offset:2048
    ds_read_b128 v[68:71], v2 offset:3072
    v_mov_b64 v[32:33], 0
    v_mov_b64 v[34:35], 0
    v_mov_b64 v[36:37], 0
    v_mov_b64 v[38:39], 0
    v_mov_b64 v[40:41], 0
    v_mov_b64 v[42:43], 0
    v_mov_b64 v[44:45], 0
    v_mov_b64 v[46:47], 0
    v_mov_b64 v[48:49], 0
    v_mov_b64 v[50:51], 0
    v_mov_b64 v[52:53], 0
    v_mov_b64 v[54:55], 0
    s_add_u32 s3, s3, 0x80000
    s_add_u32 s29, s29, 0x80000
    s_add_u32 s18, s18, 0x4000
    s_add_u32 s21, s21, 0x8000
    s_add_u32 s15, s15, 1
OPOLL_40:
    s_waitcnt vmcnt(3)
    v_mfma_f32_16x16x32_bf16 v[92:95], v[12:15], v[88:91], 0
    v_bitop3_b32 v10, v12, v14, s16 bitop3:0x7e
    s_waitcnt vmcnt(2)
    v_mfma_f32_16x16x32_bf16 v[92:95], v[16:19], v[88:91], v[92:95]
    v_bitop3_b32 v11, v16, v18, s16 bitop3:0x7e
    s_waitcnt vmcnt(1)
    v_mfma_f32_16x16x32_bf16 v[92:95], v[20:23], v[88:91], v[92:95]
    v_bitop3_b32 v30, v20, v22, s16 bitop3:0x7e
    s_waitcnt vmcnt(0)
    v_mfma_f32_16x16x32_bf16 v[92:95], v[24:27], v[88:91], v[92:95]
    v_bitop3_b32 v31, v24, v26, s16 bitop3:0x7e
    v_or3_b32 v10, v10, v11, v30
    v_bitop3_b32 v10, v10, v31, 1 bitop3:0xa8
    v_cmp_ne_u32 vcc, 0, v10
    s_add_u32 s68, s68, 1
    s_cmp_gt_u32 s68, 262144
    s_cbranch_scc1 ODONE_39
    s_nop 0
    s_cbranch_vccz ODONE_39
    s_add_u32 s40, s40, 1
    buffer_load_dwordx4 v[12:15], v1, s[4:7], s24 offen offset:0 sc1
    buffer_load_dwordx4 v[16:19], v1, s[4:7], s24 offen offset:1024 sc1
    buffer_load_dwordx4 v[20:23], v1, s[4:7], s24 offen offset:2048 sc1
    buffer_load_dwordx4 v[24:27], v1, s[4:7], s24 offen offset:3072 sc1
    s_branch OPOLL_40
ODONE_39:
    v_permlane32_swap_b32 v92, v94
    v_permlane32_swap_b32 v93, v95
    v_add_f32 v92, v92, v94
    v_add_f32 v93, v93, v95
    v_cvt_pk_bf16_f32 v8, v92, v93
    buffer_store_dword v8, v9, s[4:7], s18 offen sc1
    buffer_store_dword v8, v9, s[4:7], s21 offen sc1
    s_xor_b32 s16, s16, 1
    s_waitcnt vmcnt(2) lgkmcnt(0)
    s_cmp_lt_u32 s15, 63
    s_cbranch_scc1 REC_LOOP_S
    s_branch REC_END
IDLE_37:
    s_barrier
    v_mov_b64 v[32:33], 0
    v_mov_b64 v[34:35], 0
    v_mov_b64 v[36:37], 0
    v_mov_b64 v[38:39], 0
    v_mov_b64 v[40:41], 0
    v_mov_b64 v[42:43], 0
    v_mov_b64 v[44:45], 0
    v_mov_b64 v[46:47], 0
    v_mov_b64 v[48:49], 0
    v_mov_b64 v[50:51], 0
    v_mov_b64 v[52:53], 0
    v_mov_b64 v[54:55], 0
    s_add_u32 s3, s3, 0x80000
    s_add_u32 s29, s29, 0x80000
    s_add_u32 s18, s18, 0x4000
    s_add_u32 s21, s21, 0x8000
    s_add_u32 s15, s15, 1
    ds_read_b128 v[56:59], v2 offset:0
    ds_read_b128 v[60:63], v2 offset:1024
    ds_read_b128 v[64:67], v2 offset:2048
    ds_read_b128 v[68:71], v2 offset:3072
    s_xor_b32 s16, s16, 1
    s_waitcnt vmcnt(0)
    s_cmp_lt_u32 s15, 63
    s_cbranch_scc1 REC_LOOP_S
    s_branch REC_END
REC_TAIL_S:
RETRY_21:
SPIN_41:
    buffer_load_dwordx4 v[20:23], v1, s[4:7], s17 offen offset:2048 sc1
    buffer_load_dwordx4 v[24:27], v1, s[4:7], s17 offen offset:3072 sc1
    buffer_load_dwordx4 v[28:31], v1, s[4:7], s74 offen offset:0 sc1
    s_add_u32 s68, s68, 1
    s_add_u32 s40, s40, 1024
    s_cmp_gt_u32 s68, 262144
    s_waitcnt vmcnt(0)
    s_cbranch_scc1 BACK_22
    v_cmp_eq_u32 vcc, -1, v23
    s_cbranch_vccnz SPIN_41
    s_branch BACK_22
RETRY_23:
SPIN_42:
    buffer_load_dwordx4 v[24:27], v1, s[4:7], s17 offen offset:3072 sc1
    buffer_load_dwordx4 v[28:31], v1, s[4:7], s74 offen offset:0 sc1
    s_add_u32 s68, s68, 1
    s_add_u32 s40, s40, 1024
    s_cmp_gt_u32 s68, 262144
    s_waitcnt vmcnt(0)
    s_cbranch_scc1 BACK_24
    v_cmp_eq_u32 vcc, -1, v27
    s_cbranch_vccnz SPIN_42
    s_branch BACK_24
RETRY_25:
SPIN_43:
    buffer_load_dwordx4 v[28:31], v1, s[4:7], s74 offen offset:0 sc1
    s_add_u32 s68, s68, 1
    s_add_u32 s40, s40, 1024
    s_cmp_gt_u32 s68, 262144
    s_waitcnt vmcnt(0)
    s_cbranch_scc1 BACK_26
    v_cmp_eq_u32 vcc, -1, v31
    s_cbranch_vccnz SPIN_43
    s_branch BACK_26
RETRY_27:
SPIN_44:
    buffer_load_dwordx4 v[12:15], v1, s[4:7], s20 offen offset:0 sc1
    buffer_load_dwordx4 v[16:19], v1, s[4:7], s20 offen offset:1024 sc1
    buffer_load_dwordx4 v[20:23], v1, s[4:7], s20 offen offset:2048 sc1
    buffer_load_dwordx4 v[24:27], v1, s[4:7], s20 offen offset:3072 sc1
    s_add_u32 s68, s68, 1
    s_add_u32 s40, s40, 1048576
    s_cmp_gt_u32 s68, 262144
    s_waitcnt vmcnt(0)
    s_cbranch_scc1 BACK_28
    v_cmp_eq_u32 vcc, -1, v15
    s_cbranch_vccnz SPIN_44
    s_branch BACK_28
RETRY_29:
SPIN_45:
    buffer_load_dwordx4 v[16:19], v1, s[4:7], s20 offen offset:1024 sc1
    buffer_load_dwordx4 v[20:23], v1, s[4:7], s20 offen offset:2048 sc1
    buffer_load_dwordx4 v[24:27], v1, s[4:7], s20 offen offset:3072 sc1
    buffer_load_dwordx4 v[28:31], v1, s[4:7], s75 offen offset:0 sc1
    s_add_u32 s68, s68, 1
    s_add_u32 s40, s40, 1048576
    s_cmp_gt_u32 s68, 262144
    s_waitcnt vmcnt(0)
    s_cbranch_scc1 BACK_30
    v_cmp_eq_u32 vcc, -1, v19
    s_cbranch_vccnz SPIN_45
    s_branch BACK_30
RETRY_31:
SPIN_46:
    buffer_load_dwordx4 v[20:23], v1, s[4:7], s20 offen offset:2048 sc1
    buffer_load_dwordx4 v[24:27], v1, s[4:7], s20 offen offset:3072 sc1
    buffer_load_dwordx4 v[28:31], v1, s[4:7], s75 offen offset:0 sc1
    s_add_u32 s68, s68, 1
    s_add_u32 s40, s40, 1048576
    s_cmp_gt_u32 s68, 262144
    s_waitcnt vmcnt(0)
    s_cbranch_scc1 BACK_32
    v_cmp_eq_u32 vcc, -1, v23
    s_cbranch_vccnz SPIN_46
    s_branch BACK_32
RETRY_33:
SPIN_47:
    buffer_load_dwordx4 v[24:27], v1, s[4:7], s20 offen offset:3072 sc1
    buffer_load_dwordx4 v[28:31], v1, s[4:7], s75 offen offset:0 sc1
    s_add_u32 s68, s68, 1
    s_add_u32 s40, s40, 1048576
    s_cmp_gt_u32 s68, 262144
    s_waitcnt vmcnt(0)
    s_cbranch_scc1 BACK_34
    v_cmp_eq_u32 vcc, -1, v27
    s_cbranch_vccnz SPIN_47
    s_branch BACK_34
RETRY_35:
SPIN_48:
    buffer_load_dwordx4 v[28:31], v1, s[4:7], s75 offen offset:0 sc1
    s_add_u32 s68, s68, 1
    s_add_u32 s40, s40, 1048576
    s_cmp_gt_u32 s68, 262144
    s_waitcnt vmcnt(0)
    s_cbranch_scc1 BACK_36
    v_cmp_eq_u32 vcc, -1, v31
    s_cbranch_vccnz SPIN_48
    s_branch BACK_36
REC_POLL:
    s_cmp_lg_u32 s14, 3
    s_cbranch_scc1 NOFLG_49
    s_add_u32 s64, s15, 3
    s_and_b32 s65, s64, 0x43
    s_cmp_lg_u32 s65, 0
    s_cbranch_scc1 NOFLG_49
    s_lshl_b32 s64, s64, 7
    s_add_u32 s64, s64, s69
    v_mov_b32 v29, 0
FSPIN_50:
    buffer_load_dwordx2 v[12:13], v29, s[4:7], s64 offen sc1
    s_add_u32 s68, s68, 1
    s_waitcnt vmcnt(0)
    v_and_b32 v12, v12, v13
    v_cmp_eq_u32 vcc, 0, v12
    s_cbranch_vccz FDONE_51
    s_cmp_gt_u32 s68, 262144
    s_cbranch_scc0 FSPIN_50
FDONE_51:
NOFLG_49:
    s_add_u32 s66, s17, s52
    v_add_u32 v10, s52, v1
    s_add_u32 s3, s3, 0x80000
    s_add_u32 s29, s29, 0x80000
    s_add_u32 s18, s18, 0x4000
    s_add_u32 s21, s21, 0x8000
    s_add_u32 s15, s15, 1
    s_xor_b32 s16, s16, 1
    s_barrier
    s_cmp_lt_u32 s15, 63
    s_cbranch_scc0 REC_END
    s_nop 15
    s_nop 15
    s_nop 15
    s_nop 15
    s_nop 15
    s_nop 15
    s_nop 15
    s_nop 15
    s_nop 15
    s_nop 15
    buffer_load_dwordx4 v[20:23], v1, s[4:7], s66 offen sc1
    v_mov_b64 v[32:33], 0
    v_mov_b64 v[34:35], 0
    v_mov_b64 v[36:37], 0
    v_mov_b64 v[38:39], 0
    v_mov_b64 v[40:41], 0
    v_mov_b64 v[42:43], 0
    ds_read_b128 v[56:59], v2 offset:0
    ds_read_b128 v[60:63], v2 offset:1024
    buffer_load_dwordx4 v[24:27], v1, s[4:7], s66 offen sc1
    v_mov_b64 v[44:45], 0
    v_mov_b64 v[46:47], 0
    v_mov_b64 v[48:49], 0
    v_mov_b64 v[50:51], 0
    v_mov_b64 v[52:53], 0
    v_mov_b64 v[54:55], 0
    ds_read_b128 v[64:67], v2 offset:2048
    ds_read_b128 v[68:71], v2 offset:3072
    buffer_load_dwordx4 v[28:31], v1, s[4:7], s66 offen sc1
IPOLL_52:
    s_waitcnt vmcnt(2)
    ds_write_b128 v10, v[20:23] offset:12800
    v_max3_u32 v11, v20, v21, v22
    v_max_u32 v11, v11, v23
    v_cmp_eq_u32 vcc, -1, v11
    s_cbranch_vccz IOK_53
    buffer_load_dwordx4 v[20:23], v1, s[4:7], s66 offen sc1
    s_waitcnt vmcnt(2)
    ds_write_b128 v10, v[24:27] offset:12800
    v_max3_u32 v11, v24, v25, v26
    v_max_u32 v11, v11, v27
    v_cmp_eq_u32 vcc, -1, v11
    s_cbranch_vccz IOK_53
    buffer_load_dwordx4 v[24:27], v1, s[4:7], s66 offen sc1
    s_waitcnt vmcnt(2)
    ds_write_b128 v10, v[28:31] offset:12800
    v_max3_u32 v11, v28, v29, v30
    v_max_u32 v11, v11, v31
    v_cmp_eq_u32 vcc, -1, v11
    s_add_u32 s68, s68, 1
    s_add_u32 s53, s53, 1
    s_cmp_gt_u32 s68, 262144
    s_cbranch_scc1 IOK_53
    s_cbranch_vccz IOK_53
    buffer_load_dwordx4 v[28:31], v1, s[4:7], s66 offen sc1
    s_branch IPOLL_52
IOK_53:
    s_waitcnt lgkmcnt(0)
REC_LOOP:
    s_barrier
    ds_read_b128 v[12:15], v1 offset:12800
    ds_read_b128 v[16:19], v1 offset:13824
    buffer_load_dwordx4 v[20:23], v1, s[4:7], s17 offen offset:2048
    ds_read_b128 v[72:75], v2 offset:4096
    ds_read_b128 v[76:79], v2 offset:5120
    ds_read_b128 v[80:83], v2 offset:6144
    ds_read_b128 v[84:87], v2 offset:7168
    s_add_u32 s74, s17, 0x1000
    s_add_u32 s20, s20, 0x8000
    s_add_u32 s75, s20, 0x1000
    s_mov_b32 m0, 15360
    s_add_u32 s65, s20, s27
    s_waitcnt lgkmcnt(5)
    v_smfmac_f32_16x16x64_bf16 v[32:35], v[12:15], v[96:103], v6
    buffer_load_dwordx4 v[24:27], v1, s[4:7], s17 offen offset:3072
    v_smfmac_f32_16x16x64_bf16 v[36:39], v[12:15], v[104:111], v6
    v_smfmac_f32_16x16x64_bf16 v[40:43], v[12:15], v[56:63], v6
    buffer_load_dwordx4 v[28:31], v1, s[4:7], s74 offen offset:0
    ds_read_b128 v[56:59], v2 offset:8192
    ds_read_b128 v[60:63], v2 offset:9216
    v_smfmac_f32_16x16x64_bf16 v[44:47], v[12:15], v[64:71], v6
    ds_read_b128 v[64:67], v2 offset:10240
    ds_read_b128 v[68:71], v2 offset:11264
    s_waitcnt lgkmcnt(8)
    v_smfmac_f32_16x16x64_bf16 v[48:51], v[12:15], a[0:7], v6
    v_smfmac_f32_16x16x64_bf16 v[52:55], v[12:15], a[8:15], v6
    buffer_load_dwordx4 v[12:15], v1, s[4:7], s20 offen offset:0
    buffer_load_dword off, s[4:7], s65 lds
    v_smfmac_f32_16x16x64_bf16 v[32:35], v[16:19], v[112:119], v6
    v_smfmac_f32_16x16x64_bf16 v[36:39], v[16:19], v[120:127], v6
    s_waitcnt lgkmcnt(4)
    v_smfmac_f32_16x16x64_bf16 v[40:43], v[16:19], v[72:79], v6
    ds_read_b128 v[72:75], v2 offset:12288
    ds_read_b128 v[76:79], v2 offset:13312
    v_smfmac_f32_16x16x64_bf16 v[44:47], v[16:19], v[80:87], v6
    ds_read_b128 v[80:83], v2 offset:14336
    ds_read_b128 v[84:87], v2 offset:15360
    s_waitcnt vmcnt(4)
    v_cmp_eq_u32 vcc, -1, v23
    v_smfmac_f32_16x16x64_bf16 v[48:51], v[16:19], a[16:23], v6
    v_smfmac_f32_16x16x64_bf16 v[52:55], v[16:19], a[24:31], v6
    s_cbranch_vccnz RETRY_54
BACK_55:
    buffer_load_dwordx4 v[16:19], v1, s[4:7], s20 offen offset:1024
    v_smfmac_f32_16x16x64_bf16 v[32:35], v[20:23], v[128:135], v6
    v_smfmac_f32_16x16x64_bf16 v[36:39], v[20:23], v[136:143], v6
    s_waitcnt lgkmcnt(4)
    v_smfmac_f32_16x16x64_bf16 v[40:43], v[20:23], v[56:63], v6
    ds_read_b128 v[56:59], v2 offset:16384
    ds_read_b128 v[60:63], v2 offset:17408
    v_smfmac_f32_16x16x64_bf16 v[44:47], v[20:23], v[64:71], v6
    ds_read_b128 v[64:67], v2 offset:18432
    ds_read_b128 v[68:71], v2 offset:19456
    s_waitcnt vmcnt(4)
    v_cmp_eq_u32 vcc, -1, v27
    v_smfmac_f32_16x16x64_bf16 v[48:51], v[20:23], a[32:39], v6
    v_smfmac_f32_16x16x64_bf16 v[52:55], v[20:23], a[40:47], v6
    s_cbranch_vccnz RETRY_56
BACK_57:
    buffer_load_dwordx4 v[20:23], v1, s[4:7], s20 offen offset:2048
    v_smfmac_f32_16x16x64_bf16 v[32:35], v[24:27], v[144:151], v6
    v_smfmac_f32_16x16x64_bf16 v[36:39], v[24:27], v[152:159], v6
    s_waitcnt lgkmcnt(4)
    v_smfmac_f32_16x16x64_bf16 v[40:43], v[24:27], v[72:79], v6
    ds_read_b128 v[72:75], v2 offset:20480
    ds_read_b128 v[76:79], v2 offset:21504
    v_smfmac_f32_16x16x64_bf16 v[44:47], v[24:27], v[80:87], v6
    ds_read_b128 v[80:83], v2 offset:22528
    ds_read_b128 v[84:87], v2 offset:23552
    s_waitcnt vmcnt(4)
    v_cmp_eq_u32 vcc, -1, v31
    v_smfmac_f32_16x16x64_bf16 v[48:51], v[24:27], a[48:55], v6
    v_smfmac_f32_16x16x64_bf16 v[52:55], v[24:27], a[56:63], v6
    s_cbranch_vccnz RETRY_58
BACK_59:
    buffer_load_dwordx4 v[24:27], v1, s[4:7], s20 offen offset:3072
    v_smfmac_f32_16x16x64_bf16 v[32:35], v[28:31], v[160:167], v6
    v_smfmac_f32_16x16x64_bf16 v[36:39], v[28:31], v[168:175], v6
    s_waitcnt lgkmcnt(4)
    v_smfmac_f32_16x16x64_bf16 v[40:43], v[28:31], v[56:63], v6
    ds_read_b128 v[56:59], v2 offset:24576
    ds_read_b128 v[60:63], v2 offset:25600
    v_smfmac_f32_16x16x64_bf16 v[44:47], v[28:31], v[64:71], v6
    ds_read_b128 v[64:67], v2 offset:26624
    ds_read_b128 v[68:71], v2 offset:27648
    s_waitcnt vmcnt(4)
    v_cmp_eq_u32 vcc, -1, v15
    v_smfmac_f32_16x16x64_bf16 v[48:51], v[28:31], a[64:71], v6
    v_smfmac_f32_16x16x64_bf16 v[52:55], v[28:31], a[72:79], v6
    s_cbranch_vccnz RETRY_60
BACK_61:
    buffer_load_dwordx4 v[28:31], v1, s[4:7], s75 offen offset:0
    v_smfmac_f32_16x16x64_bf16 v[32:35], v[12:15], v[176:183], v6
    s_waitcnt vmcnt(3)
    v_cmp_eq_u32 vcc, -1, v19
    v_smfmac_f32_16x16x64_bf16 v[36:39], v[12:15], v[184:191], v6
    s_waitcnt lgkmcnt(4)
    v_smfmac_f32_16x16x64_bf16 v[40:43], v[12:15], v[72:79], v6
    ds_read_b128 v[72:75], v2 offset:28672
    ds_read_b128 v[76:79], v2 offset:29696
    v_smfmac_f32_16x16x64_bf16 v[44:47], v[12:15], v[80:87], v6
    ds_read_b128 v[80:83], v2 offset:30720
    ds_read_b128 v[84:87], v2 offset:31744
    buffer_load_dwordx4 v[88:91], v1, s[4:7], s29 offen offset:0
    s_cbranch_vccnz RETRY_62
BACK_63:
    v_smfmac_f32_16x16x64_bf16 v[32:35], v[16:19], v[192:199], v6
    s_waitcnt vmcnt(3)
    v_cmp_eq_u32 vcc, -1, v23
    v_smfmac_f32_16x16x64_bf16 v[36:39], v[16:19], v[200:207], v6
    s_waitcnt lgkmcnt(4)
    v_smfmac_f32_16x16x64_bf16 v[40:43], v[16:19], v[56:63], v6
    ds_read_b128 v[56:59], v2 offset:32768
    ds_read_b128 v[60:63], v2 offset:33792
    v_smfmac_f32_16x16x64_bf16 v[44:47], v[16:19], v[64:71], v6
    ds_read_b128 v[64:67], v2 offset:34816
    ds_read_b128 v[68:71], v2 offset:35840
    s_cbranch_vccnz RETRY_64
BACK_65:
    v_smfmac_f32_16x16x64_bf16 v[32:35], v[20:23], v[208:215], v6
    s_waitcnt vmcnt(2)
    v_cmp_eq_u32 vcc, -1, v27
    v_smfmac_f32_16x16x64_bf16 v[36:39], v[20:23], v[216:223], v6
    s_waitcnt lgkmcnt(4)
    v_smfmac_f32_16x16x64_bf16 v[40:43], v[20:23], v[72:79], v6
    ds_read_b128 v[72:75], v1 offset:0
    ds_read_b128 v[76:79], v1 offset:4096
    v_smfmac_f32_16x16x64_bf16 v[44:47], v[20:23], v[80:87], v6
    ds_read_b128 v[80:83], v1 offset:1024
    ds_read_b128 v[84:87], v1 offset:5120
    buffer_load_dwordx4 v[92:95], v1, s[4:7], s29 offen offset:1024
    s_cbranch_vccnz RETRY_66
BACK_67:
    v_smfmac_f32_16x16x64_bf16 v[32:35], v[24:27], v[224:231], v6
    s_waitcnt vmcnt(2)
    v_cmp_eq_u32 vcc, -1, v31
    v_smfmac_f32_16x16x64_bf16 v[36:39], v[24:27], v[232:239], v6
    s_waitcnt lgkmcnt(4)
    v_smfmac_f32_16x16x64_bf16 v[40:43], v[24:27], v[56:63], v6
    ds_read_b128 v[56:59], v1 offset:2048
    ds_read_b128 v[60:63], v1 offset:6144
    v_smfmac_f32_16x16x64_bf16 v[44:47], v[24:27], v[64:71], v6
    ds_read_b128 v[64:67], v1 offset:3072
    ds_read_b128 v[68:71], v1 offset:7168
    s_cbranch_vccnz RETRY_68
BACK_69:
    v_smfmac_f32_16x16x64_bf16 v[32:35], v[28:31], v[240:247], v6
    v_smfmac_f32_16x16x64_bf16 v[36:39], v[28:31], v[248:255], v6
    v_smfmac_f32_16x16x64_bf16 v[40:43], v[28:31], a[240:247], v6
    v_smfmac_f32_16x16x64_bf16 v[44:47], v[28:31], a[248:255], v6
    v_lshlrev_b32 v8, 2, v1
    s_add_u32 s65, s17, s19
    buffer_load_dword v8, s[4:7], s3 offen lds
    buffer_load_dword off, s[4:7], s65 sc1 lds
    buffer_store_dword v6, off, s[4:7], s22 sc1
    s_add_u32 s22, s22, 256
    v_permlane32_swap_b32 v32, v36
    v_permlane32_swap_b32 v33, v37
    v_permlane32_swap_b32 v34, v38
    v_permlane32_swap_b32 v35, v39
    v_pk_add_f32 v[32:33], v[32:33], v[36:37]
    v_pk_add_f32 v[34:35], v[34:35], v[38:39]
    v_cvt_pk_bf16_f32 v36, v32, v33
    v_cvt_pk_bf16_f32 v37, v34, v35
    ds_write_b64 v3, v[36:37] offset:0
    v_permlane32_swap_b32 v40, v44
    v_permlane32_swap_b32 v41, v45
    v_permlane32_swap_b32 v42, v46
    v_permlane32_swap_b32 v43, v47
    v_pk_add_f32 v[40:41], v[40:41], v[44:45]
    v_pk_add_f32 v[42:43], v[42:43], v[46:47]
    v_cvt_pk_bf16_f32 v44, v40, v41
    v_cvt_pk_bf16_f32 v45, v42, v43
    ds_write_b64 v3, v[44:45] offset:2304
    v_smfmac_f32_16x16x64_bf16 v[48:51], v[12:15], a[80:87], v6
    v_smfmac_f32_16x16x64_bf16 v[52:55], v[12:15], a[88:95], v6
    v_smfmac_f32_16x16x64_bf16 v[48:51], v[16:19], a[96:103], v6
    v_smfmac_f32_16x16x64_bf16 v[52:55], v[16:19], a[104:111], v6
    s_waitcnt lgkmcnt(0)
    s_barrier
    ds_read_b64_tr_b16 v[32:33], v4 offset:0
    ds_read_b64_tr_b16 v[34:35], v4 offset:128
    ds_read_b64_tr_b16 v[36:37], v4 offset:256
    ds_read_b64_tr_b16 v[38:39], v4 offset:384
    v_smfmac_f32_16x16x64_bf16 v[48:51], v[20:23], a[112:119], v6
    v_smfmac_f32_16x16x64_bf16 v[52:55], v[20:23], a[120:127], v6
    ds_read_b64_tr_b16 v[40:41], v4 offset:512
    ds_read_b64_tr_b16 v[42:43], v4 offset:640
    ds_read_b64_tr_b16 v[44:45], v4 offset:768
    ds_read_b64_tr_b16 v[46:47], v4 offset:896
    v_smfmac_f32_16x16x64_bf16 v[48:51], v[24:27], a[128:135], v6
    v_smfmac_f32_16x16x64_bf16 v[52:55], v[24:27], a[136:143], v6
    s_waitcnt lgkmcnt(4)
    v_mfma_f32_16x16x32_bf16 v[8:11], v[72:75], v[32:35], 0
    ds_read_b64_tr_b16 v[12:13], v4 offset:2304
    ds_read_b64_tr_b16 v[14:15], v4 offset:2432
    v_mfma_f32_16x16x32_bf16 v[8:11], v[80:83], v[36:39], v[8:11]
    ds_read_b64_tr_b16 v[16:17], v4 offset:2560
    ds_read_b64_tr_b16 v[18:19], v4 offset:2688
    s_waitcnt lgkmcnt(4)
    v_mfma_f32_16x16x32_bf16 v[8:11], v[56:59], v[40:43], v[8:11]
    ds_read_b64_tr_b16 v[56:57], v4 offset:2816
    ds_read_b64_tr_b16 v[58:59], v4 offset:2944
    v_mfma_f32_16x16x32_bf16 v[8:11], v[64:67], v[44:47], v[8:11]
    ds_read_b64_tr_b16 v[64:65], v4 offset:3072
    ds_read_b64_tr_b16 v[66:67], v4 offset:3200
    v_mfma_f32_16x16x32_bf16 v[72:75], v[76:79], v[32:35], 0
    v_mfma_f32_16x16x32_bf16 v[72:75], v[84:87], v[36:39], v[72:75]
    v_mfma_f32_16x16x32_bf16 v[72:75], v[60:63], v[40:43], v[72:75]
    v_mfma_f32_16x16x32_bf16 v[72:75], v[68:71], v[44:47], v[72:75]
    s_waitcnt lgkmcnt(4)
    v_mfma_f32_16x16x32_bf16 v[80:83], v[12:15], v[32:35], 0
    v_mfma_f32_16x16x32_bf16 v[80:83], v[16:19], v[36:39], v[80:83]
    s_waitcnt lgkmcnt(0)
    v_mfma_f32_16x16x32_bf16 v[80:83], v[56:59], v[40:43], v[80:83]
    v_mfma_f32_16x16x32_bf16 v[80:83], v[64:67], v[44:47], v[80:83]
    v_smfmac_f32_16x16x64_bf16 v[48:51], v[28:31], a[144:151], v6
    v_smfmac_f32_16x16x64_bf16 v[52:55], v[28:31], a[152:159], v6
    v_mov_b32 v24, 0x3f803f80
    v_mov_b32 v25, 0x3f803f80
    v_mov_b32 v26, 0x3f803f80
    v_mov_b32 v27, 0x3f803f80
    v_max3_f32 v20, v8, v9, v10
    v_max3_f32 v21, v11, v72, v73
    v_max3_f32 v20, v20, v21, v74
    v_max3_f32 v21, v80, v81, v82
    v_max3_f32 v20, v20, v75, v83
    v_max_f32 v20, v20, v21
    v_mov_b32 v21, v20
    v_cvt_pk_bf16_f32 v48, v48, v49
    v_cvt_pk_bf16_f32 v49, v50, v51
    v_permlane16_swap_b32 v20, v21
    v_max_f32 v20, v20, v21
    v_mov_b32 v21, v20
    v_cvt_pk_bf16_f32 v50, v52, v53
    v_cvt_pk_bf16_f32 v51, v54, v55
    v_permlane32_swap_b32 v20, v21
    v_max_f32 v20, v20, v21
    v_mul_f32 v22, s10, v20
    v_mul_f32 v23, s10, v20
    v_pk_fma_f32 v[8:9], v[8:9], s[10:11], v[22:23] neg_lo:[0,0,1] neg_hi:[0,0,1]
    v_pk_fma_f32 v[10:11], v[10:11], s[10:11], v[22:23] neg_lo:[0,0,1] neg_hi:[0,0,1]
    v_pk_fma_f32 v[72:73], v[72:73], s[10:11], v[22:23] neg_lo:[0,0,1] neg_hi:[0,0,1]
    v_pk_fma_f32 v[74:75], v[74:75], s[10:11], v[22:23] neg_lo:[0,0,1] neg_hi:[0,0,1]
    v_pk_fma_f32 v[80:81], v[80:81], s[10:11], v[22:23] neg_lo:[0,0,1] neg_hi:[0,0,1]
    v_pk_fma_f32 v[82:83], v[82:83], s[10:11], v[22:23] neg_lo:[0,0,1] neg_hi:[0,0,1]
    v_exp_f32 v8, v8
    v_exp_f32 v9, v9
    v_exp_f32 v10, v10
    v_exp_f32 v11, v11
    v_exp_f32 v72, v72
    v_exp_f32 v73, v73
    v_exp_f32 v74, v74
    v_exp_f32 v75, v75
    v_cvt_pk_bf16_f32 v32, v8, v9
    v_cvt_pk_bf16_f32 v33, v10, v11
    v_exp_f32 v80, v80
    v_exp_f32 v81, v81
    v_exp_f32 v82, v82
    v_exp_f32 v83, v83
    v_cvt_pk_bf16_f32 v34, v72, v73
    v_cvt_pk_bf16_f32 v35, v74, v75
    v_cndmask_b32 v12, 0, v24, s[34:35]
    v_cndmask_b32 v13, 0, v24, s[34:35]
    s_waitcnt vmcnt(3)
    v_mfma_f32_16x16x32_bf16 v[8:11], v[24:27], v[32:35], 0
    v_cvt_pk_bf16_f32 v36, v80, v81
    v_mfma_f32_16x16x32_bf16 v[40:43], v[88:91], v[32:35], 0
    v_cvt_pk_bf16_f32 v37, v82, v83
    v_mfma_f32_16x16x32_bf16 v[44:47], v[92:95], v[32:35], 0
    v_mfma_f32_16x16x16_bf16 v[8:11], v[12:13], v[36:37], v[8:11]
    v_mov_b64 v[72:73], 0
    v_mfma_f32_16x16x16_bf16 v[40:43], v[48:49], v[36:37], v[40:43]
    v_mov_b64 v[74:75], 0
    v_mfma_f32_16x16x16_bf16 v[44:47], v[50:51], v[36:37], v[44:47]
    v_mov_b64 v[76:77], 0
    v_mov_b64 v[78:79], 0
    v_mov_b64 v[80:81], 0
    v_mov_b64 v[82:83], 0
    v_rcp_f32 v22, v8
    s_nop 2
    v_cndmask_b32 v40, v44, v40, s[32:33]
    v_cndmask_b32 v41, v45, v41, s[32:33]
    v_cndmask_b32 v42, v46, v42, s[32:33]
    v_cndmask_b32 v43, v47, v43, s[32:33]
    v_mov_b32 v23, v22
    v_pk_mul_f32 v[40:41], v[40:41], v[22:23]
    v_pk_mul_f32 v[42:43], v[42:43], v[22:23]
    v_cvt_pk_bf16_f32 v44, v40, v41
    v_cvt_pk_bf16_f32 v45, v42, v43
    ds_write_b64 v5, v[44:45]
    s_mov_b32 m0, s73
    s_add_u32 s28, s28, 0x80000
    buffer_load_dwordx4 v1, s[4:7], s28 offen lds
    buffer_load_dwordx4 v1, s[4:7], s28 offen offset:1024 lds
    s_waitcnt lgkmcnt(0)
    s_barrier
    ds_read_b128 v[12:15], v0 offset:0
    ds_read_b128 v[16:19], v0 offset:64
    ds_read_b128 v[20:23], v0 offset:128
    ds_read_b128 v[24:27], v0 offset:192
    s_waitcnt lgkmcnt(3)
    v_smfmac_f32_16x16x64_bf16 v[72:75], v[12:15], a[160:167], v6
    s_waitcnt lgkmcnt(2)
    v_smfmac_f32_16x16x64_bf16 v[72:75], v[16:19], a[168:175], v6
    s_waitcnt lgkmcnt(1)
    v_smfmac_f32_16x16x64_bf16 v[72:75], v[20:23], a[176:183], v6
    s_waitcnt lgkmcnt(0)
    v_smfmac_f32_16x16x64_bf16 v[72:75], v[24:27], a[184:191], v6
    v_smfmac_f32_16x16x64_bf16 v[76:79], v[12:15], a[192:199], v6
    v_smfmac_f32_16x16x64_bf16 v[76:79], v[16:19], a[200:207], v6
    v_cvt_pk_bf16_f32 v72, v72, v73
    v_smfmac_f32_16x16x64_bf16 v[76:79], v[20:23], a[208:215], v6
    v_cvt_pk_bf16_f32 v73, v74, v75
    v_smfmac_f32_16x16x64_bf16 v[76:79], v[24:27], a[216:223], v6
    v_and_or_b32 v72, v72, -2, s16
    v_mfma_f32_16x16x32_bf16 v[80:83], v[12:15], a[224:227], 0
    buffer_store_dwordx2 v[72:73], v7, s[4:7], s23 offen
    v_mfma_f32_16x16x32_bf16 v[80:83], v[16:19], a[228:231], v[80:83]
    v_mfma_f32_16x16x32_bf16 v[80:83], v[20:23], a[232:235], v[80:83]
    v_cvt_pk_bf16_f32 v76, v76, v77
    v_cvt_pk_bf16_f32 v77, v78, v79
    v_mfma_f32_16x16x32_bf16 v[80:83], v[24:27], a[236:239], v[80:83]
    v_and_or_b32 v76, v76, -2, s16
    buffer_store_dwordx2 v[76:77], v7, s[4:7], s25 offen
    v_and_b32 v9, 0x70, v1
    v_bfe_u32 v29, v1, 8, 1
    v_lshl_add_u32 v9, v29, 3, v9
    v_bfe_u32 v29, v1, 9, 1
    v_lshl_add_u32 v9, v29, 2, v9
    v_mov_b32 v29, 0x40000000
    v_cvt_pk_bf16_f32 v80, v80, v81
    v_cvt_pk_bf16_f32 v81, v82, v83
    v_and_or_b32 v80, v80, -2, s16
    s_mov_b64 exec, s[34:35]
    buffer_store_dwordx2 v[80:81], v7, s[4:7], s26 offen
    s_mov_b64 exec, -1
    s_add_u32 s17, s17, 0x4000
    s_cmp_lg_u32 s42, 0
    s_cbranch_scc1 OWN_71
    s_cmp_lt_u32 s14, 2
    s_cbranch_scc1 IDLE_70
    s_branch REC_POLL
OWN_71:
    v_cndmask_b32 v9, v29, v9, s[32:33]
    v_and_b32 v29, 16, v1
    v_lshlrev_b32 v29, v29, s38
    v_cndmask_b32 v88, 0, v29, s[44:45]
    v_cndmask_b32 v89, 0, v29, s[46:47]
    v_cndmask_b32 v90, 0, v29, s[48:49]
    v_cndmask_b32 v91, 0, v29, s[50:51]
    s_nop 15
    s_nop 15
    s_nop 15
    s_nop 1
    buffer_load_dwordx4 v[12:15], v1, s[4:7], s24 offen offset:0 sc1
    buffer_load_dwordx4 v[16:19], v1, s[4:7], s24 offen offset:1024 sc1
    buffer_load_dwordx4 v[20:23], v1, s[4:7], s24 offen offset:2048 sc1
    buffer_load_dwordx4 v[24:27], v1, s[4:7], s24 offen offset:3072 sc1
    s_barrier
    ds_read_b128 v[56:59], v2 offset:0
    ds_read_b128 v[60:63], v2 offset:1024
    ds_read_b128 v[64:67], v2 offset:2048
    ds_read_b128 v[68:71], v2 offset:3072
    v_mov_b64 v[32:33], 0
    v_mov_b64 v[34:35], 0
    v_mov_b64 v[36:37], 0
    v_mov_b64 v[38:39], 0
    v_mov_b64 v[40:41], 0
    v_mov_b64 v[42:43], 0
    v_mov_b64 v[44:45], 0
    v_mov_b64 v[46:47], 0
    v_mov_b64 v[48:49], 0
    v_mov_b64 v[50:51], 0
    v_mov_b64 v[52:53], 0
    v_mov_b64 v[54:55], 0
    s_add_u32 s3, s3, 0x80000
    s_add_u32 s29, s29, 0x80000
    s_add_u32 s18, s18, 0x4000
    s_add_u32 s21, s21, 0x8000
    s_add_u32 s15, s15, 1
OPOLL_73:
    s_waitcnt vmcnt(3)
    v_mfma_f32_16x16x32_bf16 v[92:95], v[12:15], v[88:91], 0
    v_bitop3_b32 v10, v12, v14, s16 bitop3:0x7e
    s_waitcnt vmcnt(2)
    v_mfma_f32_16x16x32_bf16 v[92:95], v[16:19], v[88:91], v[92:95]
    v_bitop3_b32 v11, v16, v18, s16 bitop3:0x7e
    s_waitcnt vmcnt(1)
    v_mfma_f32_16x16x32_bf16 v[92:95], v[20:23], v[88:91], v[92:95]
    v_bitop3_b32 v30, v20, v22, s16 bitop3:0x7e
    s_waitcnt vmcnt(0)
    v_mfma_f32_16x16x32_bf16 v[92:95], v[24:27], v[88:91], v[92:95]
    v_bitop3_b32 v31, v24, v26, s16 bitop3:0x7e
    v_or3_b32 v10, v10, v11, v30
    v_bitop3_b32 v10, v10, v31, 1 bitop3:0xa8
    v_cmp_ne_u32 vcc, 0, v10
    s_add_u32 s68, s68, 1
    s_cmp_gt_u32 s68, 262144
    s_cbranch_scc1 ODONE_72
    s_nop 0
    s_cbranch_vccz ODONE_72
    s_add_u32 s40, s40, 1
    buffer_load_dwordx4 v[12:15], v1, s[4:7], s24 offen offset:0 sc1
    buffer_load_dwordx4 v[16:19], v1, s[4:7], s24 offen offset:1024 sc1
    buffer_load_dwordx4 v[20:23], v1, s[4:7], s24 offen offset:2048 sc1
    buffer_load_dwordx4 v[24:27], v1, s[4:7], s24 offen offset:3072 sc1
    s_branch OPOLL_73
ODONE_72:
    v_permlane32_swap_b32 v92, v94
    v_permlane32_swap_b32 v93, v95
    v_add_f32 v92, v92, v94
    v_add_f32 v93, v93, v95
    v_cvt_pk_bf16_f32 v8, v92, v93
    buffer_store_dword v8, v9, s[4:7], s18 offen
    buffer_store_dword v8, v9, s[4:7], s21 offen sc1
    s_xor_b32 s16, s16, 1
    s_waitcnt vmcnt(2) lgkmcnt(0)
    s_cmp_lt_u32 s15, 63
    s_cbranch_scc1 REC_LOOP
    s_branch REC_END
IDLE_70:
    s_barrier
    v_mov_b64 v[32:33], 0
    v_mov_b64 v[34:35], 0
    v_mov_b64 v[36:37], 0
    v_mov_b64 v[38:39], 0
    v_mov_b64 v[40:41], 0
    v_mov_b64 v[42:43], 0
    v_mov_b64 v[44:45], 0
    v_mov_b64 v[46:47], 0
    v_mov_b64 v[48:49], 0
    v_mov_b64 v[50:51], 0
    v_mov_b64 v[52:53], 0
    v_mov_b64 v[54:55], 0
    s_add_u32 s3, s3, 0x80000
    s_add_u32 s29, s29, 0x80000
    s_add_u32 s18, s18, 0x4000
    s_add_u32 s21, s21, 0x8000
    s_add_u32 s15, s15, 1
    ds_read_b128 v[56:59], v2 offset:0
    ds_read_b128 v[60:63], v2 offset:1024
    ds_read_b128 v[64:67], v2 offset:2048
    ds_read_b128 v[68:71], v2 offset:3072
    s_xor_b32 s16, s16, 1
    s_waitcnt vmcnt(0)
    s_cmp_lt_u32 s15, 63
    s_cbranch_scc1 REC_LOOP
    s_branch REC_END
REC_TAIL:
RETRY_54:
SPIN_74:
    buffer_load_dwordx4 v[20:23], v1, s[4:7], s17 offen offset:2048 sc1
    buffer_load_dwordx4 v[24:27], v1, s[4:7], s17 offen offset:3072 sc1
    buffer_load_dwordx4 v[28:31], v1, s[4:7], s74 offen offset:0 sc1
    s_add_u32 s68, s68, 1
    s_add_u32 s40, s40, 1024
    s_cmp_gt_u32 s68, 262144
    s_waitcnt vmcnt(0)
    s_cbranch_scc1 BACK_55
    v_cmp_eq_u32 vcc, -1, v23
    s_cbranch_vccnz SPIN_74
    s_branch BACK_55
RETRY_56:
SPIN_75:
    buffer_load_dwordx4 v[24:27], v1, s[4:7], s17 offen offset:3072 sc1
    buffer_load_dwordx4 v[28:31], v1, s[4:7], s74 offen offset:0 sc1
    s_add_u32 s68, s68, 1
    s_add_u32 s40, s40, 1024
    s_cmp_gt_u32 s68, 262144
    s_waitcnt vmcnt(0)
    s_cbranch_scc1 BACK_57
    v_cmp_eq_u32 vcc, -1, v27
    s_cbranch_vccnz SPIN_75
    s_branch BACK_57
RETRY_58:
SPIN_76:
    buffer_load_dwordx4 v[28:31], v1, s[4:7], s74 offen offset:0 sc1
    s_add_u32 s68, s68, 1
    s_add_u32 s40, s40, 1024
    s_cmp_gt_u32 s68, 262144
    s_waitcnt vmcnt(0)
    s_cbranch_scc1 BACK_59
    v_cmp_eq_u32 vcc, -1, v31
    s_cbranch_vccnz SPIN_76
    s_branch BACK_59
RETRY_60:
SPIN_77:
    buffer_load_dwordx4 v[12:15], v1, s[4:7], s20 offen offset:0 sc1
    buffer_load_dwordx4 v[16:19], v1, s[4:7], s20 offen offset:1024 sc1
    buffer_load_dwordx4 v[20:23], v1, s[4:7], s20 offen offset:2048 sc1
    buffer_load_dwordx4 v[24:27], v1, s[4:7], s20 offen offset:3072 sc1
    s_add_u32 s68, s68, 1
    s_add_u32 s40, s40, 1048576
    s_cmp_gt_u32 s68, 262144
    s_waitcnt vmcnt(0)
    s_cbranch_scc1 BACK_61
    v_cmp_eq_u32 vcc, -1, v15
    s_cbranch_vccnz SPIN_77
    s_branch BACK_61
RETRY_62:
SPIN_78:
    buffer_load_dwordx4 v[16:19], v1, s[4:7], s20 offen offset:1024 sc1
    buffer_load_dwordx4 v[20:23], v1, s[4:7], s20 offen offset:2048 sc1
    buffer_load_dwordx4 v[24:27], v1, s[4:7], s20 offen offset:3072 sc1
    buffer_load_dwordx4 v[28:31], v1, s[4:7], s75 offen offset:0 sc1
    s_add_u32 s68, s68, 1
    s_add_u32 s40, s40, 1048576
    s_cmp_gt_u32 s68, 262144
    s_waitcnt vmcnt(0)
    s_cbranch_scc1 BACK_63
    v_cmp_eq_u32 vcc, -1, v19
    s_cbranch_vccnz SPIN_78
    s_branch BACK_63
RETRY_64:
SPIN_79:
    buffer_load_dwordx4 v[20:23], v1, s[4:7], s20 offen offset:2048 sc1
    buffer_load_dwordx4 v[24:27], v1, s[4:7], s20 offen offset:3072 sc1
    buffer_load_dwordx4 v[28:31], v1, s[4:7], s75 offen offset:0 sc1
    s_add_u32 s68, s68, 1
    s_add_u32 s40, s40, 1048576
    s_cmp_gt_u32 s68, 262144
    s_waitcnt vmcnt(0)
    s_cbranch_scc1 BACK_65
    v_cmp_eq_u32 vcc, -1, v23
    s_cbranch_vccnz SPIN_79
    s_branch BACK_65
RETRY_66:
SPIN_80:
    buffer_load_dwordx4 v[24:27], v1, s[4:7], s20 offen offset:3072 sc1
    buffer_load_dwordx4 v[28:31], v1, s[4:7], s75 offen offset:0 sc1
    s_add_u32 s68, s68, 1
    s_add_u32 s40, s40, 1048576
    s_cmp_gt_u32 s68, 262144
    s_waitcnt vmcnt(0)
    s_cbranch_scc1 BACK_67
    v_cmp_eq_u32 vcc, -1, v27
    s_cbranch_vccnz SPIN_80
    s_branch BACK_67
RETRY_68:
SPIN_81:
    buffer_load_dwordx4 v[28:31], v1, s[4:7], s75 offen offset:0 sc1
    s_add_u32 s68, s68, 1
    s_add_u32 s40, s40, 1048576
    s_cmp_gt_u32 s68, 262144
    s_waitcnt vmcnt(0)
    s_cbranch_scc1 BACK_69
    v_cmp_eq_u32 vcc, -1, v31
    s_cbranch_vccnz SPIN_81
    s_branch BACK_69
REC_END:
    buffer_store_dword v6, off, s[4:7], s22 sc1
    s_branch M_EXIT
M_HELP:
    v_mbcnt_lo_u32_b32 v0, -1, 0
    v_mbcnt_hi_u32_b32 v0, -1, v0
    s_load_dwordx2 s[16:17], s[0:1], 0
    s_mov_b32 s18, 2621440
    s_mov_b32 s19, 0x00020000
    s_load_dwordx2 s[20:21], s[0:1], 64
    s_mov_b32 s22, 1280
    s_mov_b32 s23, 0x00020000
    s_load_dwordx2 s[24:25], s[0:1], 8
    s_mov_b32 s26, 10240
    s_mov_b32 s27, 0x00020000
    s_lshl_b32 s28, s96, 2
    s_add_u32 s28, s28, s14
    s_mul_i32 s28, s28, 3
    v_lshlrev_b32 v3, 4, v0
    v_lshlrev_b32 v4, 2, v0
    s_waitcnt lgkmcnt(0)
    s_add_u32 s29, s28, 0
    s_mul_i32 s33, s29, 1280
    buffer_load_dwordx4 v[10:13], v3, s[16:19], s33 offen
    buffer_load_dword v14, v4, s[16:19], s33 offen offset:1024
    s_add_u32 s29, s28, 1
    s_mul_i32 s34, s29, 1280
    buffer_load_dwordx4 v[16:19], v3, s[16:19], s34 offen
    buffer_load_dword v20, v4, s[16:19], s34 offen offset:1024
    s_add_u32 s29, s28, 2
    s_mul_i32 s35, s29, 1280
    buffer_load_dwordx4 v[22:25], v3, s[16:19], s35 offen
    buffer_load_dword v26, v4, s[16:19], s35 offen offset:1024
    buffer_load_dwordx4 v[28:31], v3, s[20:23], 0 offen
    buffer_load_dword v32, v4, s[20:23], 0 offen offset:1024
    s_cmp_ge_u32 s96, 10
    s_cbranch_scc1 INM0_82
    v_and_b32 v5, 7, v0
    v_mul_u32_u24 v5, 1280, v5
    v_lshrrev_b32 v6, 4, v0
    v_lshl_add_u32 v5, v6, 5, v5
    v_bfe_u32 v6, v0, 3, 1
    v_lshl_add_u32 v5, v6, 4, v5
    s_lshl_b32 s29, s96, 7
    buffer_load_dwordx4 v[34:37], v5, s[24:27], s29 offen
INM0_82:
    s_waitcnt vmcnt(0)
    s_add_u32 s29, s28, 0
    s_cmp_ge_u32 s29, 2048
    s_cbranch_scc1 INR_83
    v_lshlrev_b32 v50, 16, v10
    v_and_b32 v60, 0xffff0000, v10
    v_lshlrev_b32 v51, 16, v11
    v_and_b32 v61, 0xffff0000, v11
    v_lshlrev_b32 v52, 16, v12
    v_and_b32 v62, 0xffff0000, v12
    v_lshlrev_b32 v53, 16, v13
    v_and_b32 v63, 0xffff0000, v13
    v_lshlrev_b32 v54, 16, v14
    v_and_b32 v64, 0xffff0000, v14
    v_add_f32 v70, v50, v60
    v_add_f32 v70, v70, v51
    v_add_f32 v70, v70, v61
    v_add_f32 v70, v70, v52
    v_add_f32 v70, v70, v62
    v_add_f32 v70, v70, v53
    v_add_f32 v70, v70, v63
    v_add_f32 v70, v70, v54
    v_add_f32 v70, v70, v64
    s_nop 1
    v_add_f32_dpp v70, v70, v70 quad_perm:[1,0,3,2] row_mask:0xf bank_mask:0xf
    s_nop 1
    v_add_f32_dpp v70, v70, v70 quad_perm:[2,3,0,1] row_mask:0xf bank_mask:0xf
    s_nop 1
    v_add_f32_dpp v70, v70, v70 row_half_mirror row_mask:0xf bank_mask:0xf
    s_nop 1
    v_add_f32_dpp v70, v70, v70 row_mirror row_mask:0xf bank_mask:0xf
    v_mov_b32 v71, v70
    s_nop 1
    v_permlane16_swap_b32 v70, v71
    v_add_f32 v70, v70, v71
    v_mov_b32 v71, v70
    s_nop 1
    v_permlane32_swap_b32 v70, v71
    v_add_f32 v70, v70, v71
    v_mul_f32 v72, 0x3acccccd, v70
    v_mov_b32 v73, 0
    v_sub_f32 v74, v50, v72
    v_fmac_f32 v73, v74, v74
    v_sub_f32 v74, v60, v72
    v_fmac_f32 v73, v74, v74
    v_sub_f32 v74, v51, v72
    v_fmac_f32 v73, v74, v74
    v_sub_f32 v74, v61, v72
    v_fmac_f32 v73, v74, v74
    v_sub_f32 v74, v52, v72
    v_fmac_f32 v73, v74, v74
    v_sub_f32 v74, v62, v72
    v_fmac_f32 v73, v74, v74
    v_sub_f32 v74, v53, v72
    v_fmac_f32 v73, v74, v74
    v_sub_f32 v74, v63, v72
    v_fmac_f32 v73, v74, v74
    v_sub_f32 v74, v54, v72
    v_fmac_f32 v73, v74, v74
    v_sub_f32 v74, v64, v72
    v_fmac_f32 v73, v74, v74
    s_nop 1
    v_add_f32_dpp v73, v73, v73 quad_perm:[1,0,3,2] row_mask:0xf bank_mask:0xf
    s_nop 1
    v_add_f32_dpp v73, v73, v73 quad_perm:[2,3,0,1] row_mask:0xf bank_mask:0xf
    s_nop 1
    v_add_f32_dpp v73, v73, v73 row_half_mirror row_mask:0xf bank_mask:0xf
    s_nop 1
    v_add_f32_dpp v73, v73, v73 row_mirror row_mask:0xf bank_mask:0xf
    v_mov_b32 v71, v73
    s_nop 1
    v_permlane16_swap_b32 v73, v71
    v_add_f32 v73, v73, v71
    v_mov_b32 v71, v73
    s_nop 1
    v_permlane32_swap_b32 v73, v71
    v_add_f32 v73, v73, v71
    v_mul_f32 v73, 0x3acccccd, v73
    v_cvt_pk_bf16_f32 v72, v72, v72
    v_lshlrev_b32 v72, 16, v72
    v_cvt_pk_bf16_f32 v73, v73, v73
    v_lshlrev_b32 v73, 16, v73
    v_add_f32 v73, 0x3727c5ac, v73
    v_cvt_pk_bf16_f32 v73, v73, v73
    v_lshlrev_b32 v73, 16, v73
    v_sqrt_f32 v73, v73
    s_nop 0
    v_cvt_pk_bf16_f32 v73, v73, v73
    v_lshlrev_b32 v73, 16, v73
    v_rcp_f32 v75, v73
    s_nop 0
    v_mov_b32 v76, 0
    v_sub_f32 v50, v50, v72
    v_cvt_pk_bf16_f32 v50, v50, v50
    v_lshlrev_b32 v50, 16, v50
    v_mul_f32 v74, v50, v75
    v_fma_f32 v77, -v74, v73, v50
    v_fma_f32 v50, v77, v75, v74
    v_sub_f32 v60, v60, v72
    v_cvt_pk_bf16_f32 v60, v60, v60
    v_lshlrev_b32 v60, 16, v60
    v_mul_f32 v74, v60, v75
    v_fma_f32 v77, -v74, v73, v60
    v_fma_f32 v60, v77, v75, v74
    v_cvt_pk_bf16_f32 v10, v50, v60
    v_lshlrev_b32 v74, 16, v10
    v_lshlrev_b32 v77, 16, v28
    v_fmac_f32 v76, v74, v77
    v_and_b32 v74, 0xffff0000, v10
    v_and_b32 v77, 0xffff0000, v28
    v_fmac_f32 v76, v74, v77
    v_sub_f32 v51, v51, v72
    v_cvt_pk_bf16_f32 v51, v51, v51
    v_lshlrev_b32 v51, 16, v51
    v_mul_f32 v74, v51, v75
    v_fma_f32 v77, -v74, v73, v51
    v_fma_f32 v51, v77, v75, v74
    v_sub_f32 v61, v61, v72
    v_cvt_pk_bf16_f32 v61, v61, v61
    v_lshlrev_b32 v61, 16, v61
    v_mul_f32 v74, v61, v75
    v_fma_f32 v77, -v74, v73, v61
    v_fma_f32 v61, v77, v75, v74
    v_cvt_pk_bf16_f32 v11, v51, v61
    v_lshlrev_b32 v74, 16, v11
    v_lshlrev_b32 v77, 16, v29
    v_fmac_f32 v76, v74, v77
    v_and_b32 v74, 0xffff0000, v11
    v_and_b32 v77, 0xffff0000, v29
    v_fmac_f32 v76, v74, v77
    v_sub_f32 v52, v52, v72
    v_cvt_pk_bf16_f32 v52, v52, v52
    v_lshlrev_b32 v52, 16, v52
    v_mul_f32 v74, v52, v75
    v_fma_f32 v77, -v74, v73, v52
    v_fma_f32 v52, v77, v75, v74
    v_sub_f32 v62, v62, v72
    v_cvt_pk_bf16_f32 v62, v62, v62
    v_lshlrev_b32 v62, 16, v62
    v_mul_f32 v74, v62, v75
    v_fma_f32 v77, -v74, v73, v62
    v_fma_f32 v62, v77, v75, v74
    v_cvt_pk_bf16_f32 v12, v52, v62
    v_lshlrev_b32 v74, 16, v12
    v_lshlrev_b32 v77, 16, v30
    v_fmac_f32 v76, v74, v77
    v_and_b32 v74, 0xffff0000, v12
    v_and_b32 v77, 0xffff0000, v30
    v_fmac_f32 v76, v74, v77
    v_sub_f32 v53, v53, v72
    v_cvt_pk_bf16_f32 v53, v53, v53
    v_lshlrev_b32 v53, 16, v53
    v_mul_f32 v74, v53, v75
    v_fma_f32 v77, -v74, v73, v53
    v_fma_f32 v53, v77, v75, v74
    v_sub_f32 v63, v63, v72
    v_cvt_pk_bf16_f32 v63, v63, v63
    v_lshlrev_b32 v63, 16, v63
    v_mul_f32 v74, v63, v75
    v_fma_f32 v77, -v74, v73, v63
    v_fma_f32 v63, v77, v75, v74
    v_cvt_pk_bf16_f32 v13, v53, v63
    v_lshlrev_b32 v74, 16, v13
    v_lshlrev_b32 v77, 16, v31
    v_fmac_f32 v76, v74, v77
    v_and_b32 v74, 0xffff0000, v13
    v_and_b32 v77, 0xffff0000, v31
    v_fmac_f32 v76, v74, v77
    v_sub_f32 v54, v54, v72
    v_cvt_pk_bf16_f32 v54, v54, v54
    v_lshlrev_b32 v54, 16, v54
    v_mul_f32 v74, v54, v75
    v_fma_f32 v77, -v74, v73, v54
    v_fma_f32 v54, v77, v75, v74
    v_sub_f32 v64, v64, v72
    v_cvt_pk_bf16_f32 v64, v64, v64
    v_lshlrev_b32 v64, 16, v64
    v_mul_f32 v74, v64, v75
    v_fma_f32 v77, -v74, v73, v64
    v_fma_f32 v64, v77, v75, v74
    v_cvt_pk_bf16_f32 v14, v54, v64
    v_lshlrev_b32 v74, 16, v14
    v_lshlrev_b32 v77, 16, v32
    v_fmac_f32 v76, v74, v77
    v_and_b32 v74, 0xffff0000, v14
    v_and_b32 v77, 0xffff0000, v32
    v_fmac_f32 v76, v74, v77
    s_add_u32 s30, s33, 0x0
    buffer_store_dwordx4 v[10:13], v3, s[4:7], s30 offen sc1
    buffer_store_dword v14, v4, s[4:7], s30 offen offset:1024 sc1
    s_nop 1
    v_add_f32_dpp v76, v76, v76 quad_perm:[1,0,3,2] row_mask:0xf bank_mask:0xf
    s_nop 1
    v_add_f32_dpp v76, v76, v76 quad_perm:[2,3,0,1] row_mask:0xf bank_mask:0xf
    s_nop 1
    v_add_f32_dpp v76, v76, v76 row_half_mirror row_mask:0xf bank_mask:0xf
    s_nop 1
    v_add_f32_dpp v76, v76, v76 row_mirror row_mask:0xf bank_mask:0xf
    v_mov_b32 v71, v76
    s_nop 1
    v_permlane16_swap_b32 v76, v71
    v_add_f32 v76, v76, v71
    v_mov_b32 v71, v76
    s_nop 1
    v_permlane32_swap_b32 v76, v71
    v_add_f32 v76, v76, v71
    v_cvt_pk_bf16_f32 v76, v76, v76
    v_lshlrev_b32 v76, 16, v76
    s_lshl_b32 s30, s29, 2
    s_add_u32 s30, s30, 0x280000
    s_mov_b64 exec, 1
    buffer_store_dword v76, off, s[4:7], s30 sc1
    s_mov_b64 exec, -1
INR_83:
    s_add_u32 s29, s28, 1
    s_cmp_ge_u32 s29, 2048
    s_cbranch_scc1 INR_84
    v_lshlrev_b32 v50, 16, v16
    v_and_b32 v60, 0xffff0000, v16
    v_lshlrev_b32 v51, 16, v17
    v_and_b32 v61, 0xffff0000, v17
    v_lshlrev_b32 v52, 16, v18
    v_and_b32 v62, 0xffff0000, v18
    v_lshlrev_b32 v53, 16, v19
    v_and_b32 v63, 0xffff0000, v19
    v_lshlrev_b32 v54, 16, v20
    v_and_b32 v64, 0xffff0000, v20
    v_add_f32 v70, v50, v60
    v_add_f32 v70, v70, v51
    v_add_f32 v70, v70, v61
    v_add_f32 v70, v70, v52
    v_add_f32 v70, v70, v62
    v_add_f32 v70, v70, v53
    v_add_f32 v70, v70, v63
    v_add_f32 v70, v70, v54
    v_add_f32 v70, v70, v64
    s_nop 1
    v_add_f32_dpp v70, v70, v70 quad_perm:[1,0,3,2] row_mask:0xf bank_mask:0xf
    s_nop 1
    v_add_f32_dpp v70, v70, v70 quad_perm:[2,3,0,1] row_mask:0xf bank_mask:0xf
    s_nop 1
    v_add_f32_dpp v70, v70, v70 row_half_mirror row_mask:0xf bank_mask:0xf
    s_nop 1
    v_add_f32_dpp v70, v70, v70 row_mirror row_mask:0xf bank_mask:0xf
    v_mov_b32 v71, v70
    s_nop 1
    v_permlane16_swap_b32 v70, v71
    v_add_f32 v70, v70, v71
    v_mov_b32 v71, v70
    s_nop 1
    v_permlane32_swap_b32 v70, v71
    v_add_f32 v70, v70, v71
    v_mul_f32 v72, 0x3acccccd, v70
    v_mov_b32 v73, 0
    v_sub_f32 v74, v50, v72
    v_fmac_f32 v73, v74, v74
    v_sub_f32 v74, v60, v72
    v_fmac_f32 v73, v74, v74
    v_sub_f32 v74, v51, v72
    v_fmac_f32 v73, v74, v74
    v_sub_f32 v74, v61, v72
    v_fmac_f32 v73, v74, v74
    v_sub_f32 v74, v52, v72
    v_fmac_f32 v73, v74, v74
    v_sub_f32 v74, v62, v72
    v_fmac_f32 v73, v74, v74
    v_sub_f32 v74, v53, v72
    v_fmac_f32 v73, v74, v74
    v_sub_f32 v74, v63, v72
    v_fmac_f32 v73, v74, v74
    v_sub_f32 v74, v54, v72
    v_fmac_f32 v73, v74, v74
    v_sub_f32 v74, v64, v72
    v_fmac_f32 v73, v74, v74
    s_nop 1
    v_add_f32_dpp v73, v73, v73 quad_perm:[1,0,3,2] row_mask:0xf bank_mask:0xf
    s_nop 1
    v_add_f32_dpp v73, v73, v73 quad_perm:[2,3,0,1] row_mask:0xf bank_mask:0xf
    s_nop 1
    v_add_f32_dpp v73, v73, v73 row_half_mirror row_mask:0xf bank_mask:0xf
    s_nop 1
    v_add_f32_dpp v73, v73, v73 row_mirror row_mask:0xf bank_mask:0xf
    v_mov_b32 v71, v73
    s_nop 1
    v_permlane16_swap_b32 v73, v71
    v_add_f32 v73, v73, v71
    v_mov_b32 v71, v73
    s_nop 1
    v_permlane32_swap_b32 v73, v71
    v_add_f32 v73, v73, v71
    v_mul_f32 v73, 0x3acccccd, v73
    v_cvt_pk_bf16_f32 v72, v72, v72
    v_lshlrev_b32 v72, 16, v72
    v_cvt_pk_bf16_f32 v73, v73, v73
    v_lshlrev_b32 v73, 16, v73
    v_add_f32 v73, 0x3727c5ac, v73
    v_cvt_pk_bf16_f32 v73, v73, v73
    v_lshlrev_b32 v73, 16, v73
    v_sqrt_f32 v73, v73
    s_nop 0
    v_cvt_pk_bf16_f32 v73, v73, v73
    v_lshlrev_b32 v73, 16, v73
    v_rcp_f32 v75, v73
    s_nop 0
    v_mov_b32 v76, 0
    v_sub_f32 v50, v50, v72
    v_cvt_pk_bf16_f32 v50, v50, v50
    v_lshlrev_b32 v50, 16, v50
    v_mul_f32 v74, v50, v75
    v_fma_f32 v77, -v74, v73, v50
    v_fma_f32 v50, v77, v75, v74
    v_sub_f32 v60, v60, v72
    v_cvt_pk_bf16_f32 v60, v60, v60
    v_lshlrev_b32 v60, 16, v60
    v_mul_f32 v74, v60, v75
    v_fma_f32 v77, -v74, v73, v60
    v_fma_f32 v60, v77, v75, v74
    v_cvt_pk_bf16_f32 v16, v50, v60
    v_lshlrev_b32 v74, 16, v16
    v_lshlrev_b32 v77, 16, v28
    v_fmac_f32 v76, v74, v77
    v_and_b32 v74, 0xffff0000, v16
    v_and_b32 v77, 0xffff0000, v28
    v_fmac_f32 v76, v74, v77
    v_sub_f32 v51, v51, v72
    v_cvt_pk_bf16_f32 v51, v51, v51
    v_lshlrev_b32 v51, 16, v51
    v_mul_f32 v74, v51, v75
    v_fma_f32 v77, -v74, v73, v51
    v_fma_f32 v51, v77, v75, v74
    v_sub_f32 v61, v61, v72
    v_cvt_pk_bf16_f32 v61, v61, v61
    v_lshlrev_b32 v61, 16, v61
    v_mul_f32 v74, v61, v75
    v_fma_f32 v77, -v74, v73, v61
    v_fma_f32 v61, v77, v75, v74
    v_cvt_pk_bf16_f32 v17, v51, v61
    v_lshlrev_b32 v74, 16, v17
    v_lshlrev_b32 v77, 16, v29
    v_fmac_f32 v76, v74, v77
    v_and_b32 v74, 0xffff0000, v17
    v_and_b32 v77, 0xffff0000, v29
    v_fmac_f32 v76, v74, v77
    v_sub_f32 v52, v52, v72
    v_cvt_pk_bf16_f32 v52, v52, v52
    v_lshlrev_b32 v52, 16, v52
    v_mul_f32 v74, v52, v75
    v_fma_f32 v77, -v74, v73, v52
    v_fma_f32 v52, v77, v75, v74
    v_sub_f32 v62, v62, v72
    v_cvt_pk_bf16_f32 v62, v62, v62
    v_lshlrev_b32 v62, 16, v62
    v_mul_f32 v74, v62, v75
    v_fma_f32 v77, -v74, v73, v62
    v_fma_f32 v62, v77, v75, v74
    v_cvt_pk_bf16_f32 v18, v52, v62
    v_lshlrev_b32 v74, 16, v18
    v_lshlrev_b32 v77, 16, v30
    v_fmac_f32 v76, v74, v77
    v_and_b32 v74, 0xffff0000, v18
    v_and_b32 v77, 0xffff0000, v30
    v_fmac_f32 v76, v74, v77
    v_sub_f32 v53, v53, v72
    v_cvt_pk_bf16_f32 v53, v53, v53
    v_lshlrev_b32 v53, 16, v53
    v_mul_f32 v74, v53, v75
    v_fma_f32 v77, -v74, v73, v53
    v_fma_f32 v53, v77, v75, v74
    v_sub_f32 v63, v63, v72
    v_cvt_pk_bf16_f32 v63, v63, v63
    v_lshlrev_b32 v63, 16, v63
    v_mul_f32 v74, v63, v75
    v_fma_f32 v77, -v74, v73, v63
    v_fma_f32 v63, v77, v75, v74
    v_cvt_pk_bf16_f32 v19, v53, v63
    v_lshlrev_b32 v74, 16, v19
    v_lshlrev_b32 v77, 16, v31
    v_fmac_f32 v76, v74, v77
    v_and_b32 v74, 0xffff0000, v19
    v_and_b32 v77, 0xffff0000, v31
    v_fmac_f32 v76, v74, v77
    v_sub_f32 v54, v54, v72
    v_cvt_pk_bf16_f32 v54, v54, v54
    v_lshlrev_b32 v54, 16, v54
    v_mul_f32 v74, v54, v75
    v_fma_f32 v77, -v74, v73, v54
    v_fma_f32 v54, v77, v75, v74
    v_sub_f32 v64, v64, v72
    v_cvt_pk_bf16_f32 v64, v64, v64
    v_lshlrev_b32 v64, 16, v64
    v_mul_f32 v74, v64, v75
    v_fma_f32 v77, -v74, v73, v64
    v_fma_f32 v64, v77, v75, v74
    v_cvt_pk_bf16_f32 v20, v54, v64
    v_lshlrev_b32 v74, 16, v20
    v_lshlrev_b32 v77, 16, v32
    v_fmac_f32 v76, v74, v77
    v_and_b32 v74, 0xffff0000, v20
    v_and_b32 v77, 0xffff0000, v32
    v_fmac_f32 v76, v74, v77
    s_add_u32 s30, s34, 0x0
    buffer_store_dwordx4 v[16:19], v3, s[4:7], s30 offen sc1
    buffer_store_dword v20, v4, s[4:7], s30 offen offset:1024 sc1
    s_nop 1
    v_add_f32_dpp v76, v76, v76 quad_perm:[1,0,3,2] row_mask:0xf bank_mask:0xf
    s_nop 1
    v_add_f32_dpp v76, v76, v76 quad_perm:[2,3,0,1] row_mask:0xf bank_mask:0xf
    s_nop 1
    v_add_f32_dpp v76, v76, v76 row_half_mirror row_mask:0xf bank_mask:0xf
    s_nop 1
    v_add_f32_dpp v76, v76, v76 row_mirror row_mask:0xf bank_mask:0xf
    v_mov_b32 v71, v76
    s_nop 1
    v_permlane16_swap_b32 v76, v71
    v_add_f32 v76, v76, v71
    v_mov_b32 v71, v76
    s_nop 1
    v_permlane32_swap_b32 v76, v71
    v_add_f32 v76, v76, v71
    v_cvt_pk_bf16_f32 v76, v76, v76
    v_lshlrev_b32 v76, 16, v76
    s_lshl_b32 s30, s29, 2
    s_add_u32 s30, s30, 0x280000
    s_mov_b64 exec, 1
    buffer_store_dword v76, off, s[4:7], s30 sc1
    s_mov_b64 exec, -1
INR_84:
    s_add_u32 s29, s28, 2
    s_cmp_ge_u32 s29, 2048
    s_cbranch_scc1 INR_85
    v_lshlrev_b32 v50, 16, v22
    v_and_b32 v60, 0xffff0000, v22
    v_lshlrev_b32 v51, 16, v23
    v_and_b32 v61, 0xffff0000, v23
    v_lshlrev_b32 v52, 16, v24
    v_and_b32 v62, 0xffff0000, v24
    v_lshlrev_b32 v53, 16, v25
    v_and_b32 v63, 0xffff0000, v25
    v_lshlrev_b32 v54, 16, v26
    v_and_b32 v64, 0xffff0000, v26
    v_add_f32 v70, v50, v60
    v_add_f32 v70, v70, v51
    v_add_f32 v70, v70, v61
    v_add_f32 v70, v70, v52
    v_add_f32 v70, v70, v62
    v_add_f32 v70, v70, v53
    v_add_f32 v70, v70, v63
    v_add_f32 v70, v70, v54
    v_add_f32 v70, v70, v64
    s_nop 1
    v_add_f32_dpp v70, v70, v70 quad_perm:[1,0,3,2] row_mask:0xf bank_mask:0xf
    s_nop 1
    v_add_f32_dpp v70, v70, v70 quad_perm:[2,3,0,1] row_mask:0xf bank_mask:0xf
    s_nop 1
    v_add_f32_dpp v70, v70, v70 row_half_mirror row_mask:0xf bank_mask:0xf
    s_nop 1
    v_add_f32_dpp v70, v70, v70 row_mirror row_mask:0xf bank_mask:0xf
    v_mov_b32 v71, v70
    s_nop 1
    v_permlane16_swap_b32 v70, v71
    v_add_f32 v70, v70, v71
    v_mov_b32 v71, v70
    s_nop 1
    v_permlane32_swap_b32 v70, v71
    v_add_f32 v70, v70, v71
    v_mul_f32 v72, 0x3acccccd, v70
    v_mov_b32 v73, 0
    v_sub_f32 v74, v50, v72
    v_fmac_f32 v73, v74, v74
    v_sub_f32 v74, v60, v72
    v_fmac_f32 v73, v74, v74
    v_sub_f32 v74, v51, v72
    v_fmac_f32 v73, v74, v74
    v_sub_f32 v74, v61, v72
    v_fmac_f32 v73, v74, v74
    v_sub_f32 v74, v52, v72
    v_fmac_f32 v73, v74, v74
    v_sub_f32 v74, v62, v72
    v_fmac_f32 v73, v74, v74
    v_sub_f32 v74, v53, v72
    v_fmac_f32 v73, v74, v74
    v_sub_f32 v74, v63, v72
    v_fmac_f32 v73, v74, v74
    v_sub_f32 v74, v54, v72
    v_fmac_f32 v73, v74, v74
    v_sub_f32 v74, v64, v72
    v_fmac_f32 v73, v74, v74
    s_nop 1
    v_add_f32_dpp v73, v73, v73 quad_perm:[1,0,3,2] row_mask:0xf bank_mask:0xf
    s_nop 1
    v_add_f32_dpp v73, v73, v73 quad_perm:[2,3,0,1] row_mask:0xf bank_mask:0xf
    s_nop 1
    v_add_f32_dpp v73, v73, v73 row_half_mirror row_mask:0xf bank_mask:0xf
    s_nop 1
    v_add_f32_dpp v73, v73, v73 row_mirror row_mask:0xf bank_mask:0xf
    v_mov_b32 v71, v73
    s_nop 1
    v_permlane16_swap_b32 v73, v71
    v_add_f32 v73, v73, v71
    v_mov_b32 v71, v73
    s_nop 1
    v_permlane32_swap_b32 v73, v71
    v_add_f32 v73, v73, v71
    v_mul_f32 v73, 0x3acccccd, v73
    v_cvt_pk_bf16_f32 v72, v72, v72
    v_lshlrev_b32 v72, 16, v72
    v_cvt_pk_bf16_f32 v73, v73, v73
    v_lshlrev_b32 v73, 16, v73
    v_add_f32 v73, 0x3727c5ac, v73
    v_cvt_pk_bf16_f32 v73, v73, v73
    v_lshlrev_b32 v73, 16, v73
    v_sqrt_f32 v73, v73
    s_nop 0
    v_cvt_pk_bf16_f32 v73, v73, v73
    v_lshlrev_b32 v73, 16, v73
    v_rcp_f32 v75, v73
    s_nop 0
    v_mov_b32 v76, 0
    v_sub_f32 v50, v50, v72
    v_cvt_pk_bf16_f32 v50, v50, v50
    v_lshlrev_b32 v50, 16, v50
    v_mul_f32 v74, v50, v75
    v_fma_f32 v77, -v74, v73, v50
    v_fma_f32 v50, v77, v75, v74
    v_sub_f32 v60, v60, v72
    v_cvt_pk_bf16_f32 v60, v60, v60
    v_lshlrev_b32 v60, 16, v60
    v_mul_f32 v74, v60, v75
    v_fma_f32 v77, -v74, v73, v60
    v_fma_f32 v60, v77, v75, v74
    v_cvt_pk_bf16_f32 v22, v50, v60
    v_lshlrev_b32 v74, 16, v22
    v_lshlrev_b32 v77, 16, v28
    v_fmac_f32 v76, v74, v77
    v_and_b32 v74, 0xffff0000, v22
    v_and_b32 v77, 0xffff0000, v28
    v_fmac_f32 v76, v74, v77
    v_sub_f32 v51, v51, v72
    v_cvt_pk_bf16_f32 v51, v51, v51
    v_lshlrev_b32 v51, 16, v51
    v_mul_f32 v74, v51, v75
    v_fma_f32 v77, -v74, v73, v51
    v_fma_f32 v51, v77, v75, v74
    v_sub_f32 v61, v61, v72
    v_cvt_pk_bf16_f32 v61, v61, v61
    v_lshlrev_b32 v61, 16, v61
    v_mul_f32 v74, v61, v75
    v_fma_f32 v77, -v74, v73, v61
    v_fma_f32 v61, v77, v75, v74
    v_cvt_pk_bf16_f32 v23, v51, v61
    v_lshlrev_b32 v74, 16, v23
    v_lshlrev_b32 v77, 16, v29
    v_fmac_f32 v76, v74, v77
    v_and_b32 v74, 0xffff0000, v23
    v_and_b32 v77, 0xffff0000, v29
    v_fmac_f32 v76, v74, v77
    v_sub_f32 v52, v52, v72
    v_cvt_pk_bf16_f32 v52, v52, v52
    v_lshlrev_b32 v52, 16, v52
    v_mul_f32 v74, v52, v75
    v_fma_f32 v77, -v74, v73, v52
    v_fma_f32 v52, v77, v75, v74
    v_sub_f32 v62, v62, v72
    v_cvt_pk_bf16_f32 v62, v62, v62
    v_lshlrev_b32 v62, 16, v62
    v_mul_f32 v74, v62, v75
    v_fma_f32 v77, -v74, v73, v62
    v_fma_f32 v62, v77, v75, v74
    v_cvt_pk_bf16_f32 v24, v52, v62
    v_lshlrev_b32 v74, 16, v24
    v_lshlrev_b32 v77, 16, v30
    v_fmac_f32 v76, v74, v77
    v_and_b32 v74, 0xffff0000, v24
    v_and_b32 v77, 0xffff0000, v30
    v_fmac_f32 v76, v74, v77
    v_sub_f32 v53, v53, v72
    v_cvt_pk_bf16_f32 v53, v53, v53
    v_lshlrev_b32 v53, 16, v53
    v_mul_f32 v74, v53, v75
    v_fma_f32 v77, -v74, v73, v53
    v_fma_f32 v53, v77, v75, v74
    v_sub_f32 v63, v63, v72
    v_cvt_pk_bf16_f32 v63, v63, v63
    v_lshlrev_b32 v63, 16, v63
    v_mul_f32 v74, v63, v75
    v_fma_f32 v77, -v74, v73, v63
    v_fma_f32 v63, v77, v75, v74
    v_cvt_pk_bf16_f32 v25, v53, v63
    v_lshlrev_b32 v74, 16, v25
    v_lshlrev_b32 v77, 16, v31
    v_fmac_f32 v76, v74, v77
    v_and_b32 v74, 0xffff0000, v25
    v_and_b32 v77, 0xffff0000, v31
    v_fmac_f32 v76, v74, v77
    v_sub_f32 v54, v54, v72
    v_cvt_pk_bf16_f32 v54, v54, v54
    v_lshlrev_b32 v54, 16, v54
    v_mul_f32 v74, v54, v75
    v_fma_f32 v77, -v74, v73, v54
    v_fma_f32 v54, v77, v75, v74
    v_sub_f32 v64, v64, v72
    v_cvt_pk_bf16_f32 v64, v64, v64
    v_lshlrev_b32 v64, 16, v64
    v_mul_f32 v74, v64, v75
    v_fma_f32 v77, -v74, v73, v64
    v_fma_f32 v64, v77, v75, v74
    v_cvt_pk_bf16_f32 v26, v54, v64
    v_lshlrev_b32 v74, 16, v26
    v_lshlrev_b32 v77, 16, v32
    v_fmac_f32 v76, v74, v77
    v_and_b32 v74, 0xffff0000, v26
    v_and_b32 v77, 0xffff0000, v32
    v_fmac_f32 v76, v74, v77
    s_add_u32 s30, s35, 0x0
    buffer_store_dwordx4 v[22:25], v3, s[4:7], s30 offen sc1
    buffer_store_dword v26, v4, s[4:7], s30 offen offset:1024 sc1
    s_nop 1
    v_add_f32_dpp v76, v76, v76 quad_perm:[1,0,3,2] row_mask:0xf bank_mask:0xf
    s_nop 1
    v_add_f32_dpp v76, v76, v76 quad_perm:[2,3,0,1] row_mask:0xf bank_mask:0xf
    s_nop 1
    v_add_f32_dpp v76, v76, v76 row_half_mirror row_mask:0xf bank_mask:0xf
    s_nop 1
    v_add_f32_dpp v76, v76, v76 row_mirror row_mask:0xf bank_mask:0xf
    v_mov_b32 v71, v76
    s_nop 1
    v_permlane16_swap_b32 v76, v71
    v_add_f32 v76, v76, v71
    v_mov_b32 v71, v76
    s_nop 1
    v_permlane32_swap_b32 v76, v71
    v_add_f32 v76, v76, v71
    v_cvt_pk_bf16_f32 v76, v76, v76
    v_lshlrev_b32 v76, 16, v76
    s_lshl_b32 s30, s29, 2
    s_add_u32 s30, s30, 0x280000
    s_mov_b64 exec, 1
    buffer_store_dword v76, off, s[4:7], s30 sc1
    s_mov_b64 exec, -1
INR_85:
    s_lshl_b32 s29, s96, 2
    s_add_u32 s29, s29, s14
    s_lshl_b32 s29, s29, 6
    v_add_u32 v5, s29, v0
    v_lshlrev_b32 v6, 4, v5
    v_mov_b32 v40, -1
    v_mov_b32 v44, 0
    v_mov_b32 v41, -1
    v_mov_b32 v45, 0
    v_mov_b32 v42, -1
    v_mov_b32 v46, 0
    v_mov_b32 v43, -1
    v_mov_b32 v47, 0
    v_cmp_gt_u32 vcc, 0x1000, v5
    s_nop 0
    s_and_saveexec_b64 s[38:39], vcc
    s_cbranch_execz INF_86
    s_mov_b32 s30, 0x290000
    buffer_store_dwordx4 v[44:47], v6, s[4:7], s30 offen sc1
INF_86:
    s_mov_b64 exec, s[38:39]
    v_cmp_gt_u32 vcc, 0x5000, v5
    s_nop 0
    s_and_saveexec_b64 s[38:39], vcc
    s_cbranch_execz INF_87
    s_mov_b32 s30, 0x300000
    buffer_store_dwordx4 v[40:43], v6, s[4:7], s30 offen sc1
INF_87:
    s_mov_b64 exec, s[38:39]
    v_lshrrev_b32 v7, 6, v5
    v_mul_u32_u24 v7, 52429, v7
    v_lshrrev_b32 v7, 18, v7
    v_mul_u32_u24 v8, 320, v7
    v_sub_u32 v8, v5, v8
    v_lshlrev_b32 v48, 4, v8
    v_lshl_add_u32 v49, v7, 13, v48
    v_cmp_gt_u32 vcc, 0xa000, v5
    s_nop 0
    s_and_saveexec_b64 s[38:39], vcc
    s_cbranch_execz INF_88
    s_mov_b32 s30, 0x5904000
    buffer_store_dwordx4 v[40:43], v49, s[4:7], s30 offen sc1
INF_88:
    s_mov_b64 exec, s[38:39]
    s_mov_b32 s65, 0
CW_89:
    buffer_load_dwordx2 v[8:9], off, s[60:63], 0 offset:132 sc1
    s_add_u32 s65, s65, 1
    s_waitcnt vmcnt(0)
    v_readfirstlane_b32 s31, v8
    v_readfirstlane_b32 s32, v9
    s_min_u32 s64, s31, s32
    s_cmp_lg_u32 s64, 0
    s_cbranch_scc1 CWD_90
    s_cmp_gt_u32 s65, 65536
    s_cbranch_scc1 CWD_90
    s_sleep 4
    s_branch CW_89
CWD_90:
    s_sub_u32 s31, s31, 1
    s_and_b32 s31, s31, 3
    s_sub_u32 s32, s32, 1
    s_and_b32 s32, s32, 3
    s_lshl_b32 s31, s31, 13
    s_lshl_b32 s32, s32, 13
    s_add_u32 s32, s32, 0x200000
    v_and_b32 v8, 1, v7
    v_cmp_eq_u32 vcc, 1, v8
    v_mov_b32 v8, s31
    v_mov_b32 v9, s32
    v_cndmask_b32 v8, v8, v9, vcc
    v_lshrrev_b32 v9, 1, v7
    v_lshl_add_u32 v8, v9, 15, v8
    v_add_u32 v49, v8, v48
    v_cmp_le_u32 vcc, 640, v5
    v_mov_b32 v9, 0x40000000
    s_nop 0
    v_cndmask_b32 v49, v9, v49, vcc
    v_cmp_gt_u32 vcc, 0xa000, v5
    s_nop 0
    s_and_saveexec_b64 s[38:39], vcc
    s_cbranch_execz INF_91
    s_mov_b32 s30, 0x6000000
    buffer_store_dwordx4 v[40:43], v49, s[4:7], s30 offen sc1
INF_91:
    s_mov_b64 exec, s[38:39]
    s_cmp_ge_u32 s96, 10
    s_cbranch_scc1 INM1_92
    s_cmp_ge_u32 s14, 2
    s_cbranch_scc1 INM1_92
    s_cmp_ge_u32 s96, 5
    s_cselect_b32 s36, 1, 0
    s_mul_i32 s29, s36, 5
    s_sub_u32 s29, s96, s29
    s_lshl_b32 s29, s29, 10
    s_lshl_b32 s30, s36, 13
    s_add_u32 s30, s30, 0x5900000
    s_cmp_eq_u32 s36, 0
    s_cselect_b32 s37, s31, s32
    s_add_u32 s37, s37, 0x6000000
    s_cmp_eq_u32 s14, 0
    s_cselect_b32 s30, s30, s37
    s_add_u32 s30, s30, s29
    buffer_store_dwordx4 v[34:37], v3, s[4:7], s30 offen sc1
INM1_92:
    s_waitcnt vmcnt(0)
    s_barrier
    s_cmp_lg_u32 s14, 0
    s_cbranch_scc1 INE_93
    s_cmp_lg_u32 s96, 10
    s_cbranch_scc1 ING_94
    v_mov_b32 v44, 1
    v_lshlrev_b32 v6, 7, v0
    s_mov_b32 s30, 0x29a000
    s_mov_b64 exec, 3
    buffer_store_dword v44, v6, s[4:7], s30 offen sc1
    s_mov_b64 exec, -1
    s_waitcnt vmcnt(0)
ING_94:
    v_mov_b32 v8, 1
    s_mov_b64 exec, 1
    buffer_atomic_add v8, off, s[60:63], s95 sc1
    s_mov_b64 exec, -1
INE_93:
    v_mbcnt_lo_u32_b32 v0, -1, 0
    v_mbcnt_hi_u32_b32 v0, -1, v0
    s_and_b32 s12, s96, 1
    s_lshr_b32 s3, s96, 1
    s_and_b32 s13, s3, 31
    s_lshr_b32 s3, s3, 5
    s_load_dwordx4 s[48:51], s[0:1], 16
    s_load_dwordx2 s[52:53], s[0:1], 32
    s_waitcnt lgkmcnt(0)
    s_mov_b32 s46, 5242880
    s_mov_b32 s47, 0x00020000
    s_cmp_eq_u32 s3, 0
    s_cbranch_scc1 H_E0
    s_cmp_eq_u32 s3, 1
    s_cbranch_scc1 H_E1
    s_cmp_eq_u32 s3, 2
    s_cbranch_scc1 H_E2
    s_branch M_EXIT
H_E0:
    s_mov_b32 s44, s50
    s_mov_b32 s45, s51
    s_lshl_b32 s16, s13, 14
    s_mov_b32 s17, 0x80000
    s_lshl_b32 s64, s14, 10
    s_add_u32 s16, s16, 0x1400000
    s_add_u32 s16, s16, s64
    s_mul_i32 s64, s12, s17
    s_lshl_b32 s64, s64, 2
    s_add_u32 s16, s16, s64
    s_lshl_b32 s18, s13, 4
    s_add_u32 s18, s18, 0x291000
    s_branch G_T
H_E1:
    s_mov_b32 s44, s52
    s_mov_b32 s45, s53
    s_lshl_b32 s16, s13, 14
    s_mov_b32 s17, 0x80000
    s_lshl_b32 s64, s14, 11
    s_add_u32 s16, s16, 0x1402000
    s_add_u32 s16, s16, s64
    s_mul_i32 s64, s12, s17
    s_lshl_b32 s64, s64, 2
    s_add_u32 s16, s16, s64
    s_lshl_b32 s18, s13, 4
    s_add_u32 s18, s18, 0x291004
    s_branch G_N
H_E2:
    s_mov_b32 s44, s48
    s_mov_b32 s45, s49
    s_lshl_b32 s16, s13, 13
    s_mov_b32 s17, 0x40000
    s_lshl_b32 s64, s14, 10
    s_add_u32 s16, s16, 0x3400000
    s_add_u32 s16, s16, s64
    s_mul_i32 s64, s12, s17
    s_lshl_b32 s64, s64, 2
    s_add_u32 s16, s16, s64
    s_lshl_b32 s18, s13, 4
    s_add_u32 s18, s18, 0x291008
    s_branch G_T
G_T:
    s_lshl_b32 s65, s13, 8
    s_lshl_b32 s66, s14, 6
    s_add_u32 s20, s65, s66
    s_mul_i32 s21, s14, 36864
    v_lshrrev_b32 v6, 2, v0
    v_mul_u32_u24 v5, 8192, v6
    v_lshrrev_b32 v6, 5, v0
    v_lshlrev_b32 v6, 1, v6
    v_and_b32 v7, 3, v0
    v_xor_b32 v6, v6, v7
    v_lshl_add_u32 v5, v6, 4, v5
    v_lshrrev_b32 v6, 5, v0
    v_lshlrev_b32 v3, 10, v6
    v_bfe_u32 v6, v0, 2, 2
    v_lshl_add_u32 v3, v6, 6, v3
    v_and_b32 v6, 3, v0
    v_lshl_add_u32 v3, v6, 3, v3
    v_bfe_u32 v6, v0, 4, 1
    v_lshl_add_u32 v3, v6, 9, v3
    v_add_u32 v3, s21, v3
    v_lshlrev_b32 v6, 5, v6
    v_sub_u32 v4, 32, v6
    v_add_u32 v4, v4, v3
    v_add_u32 v3, v3, v6
    s_add_u32 m0, s21, 0
    s_add_u32 s64, s20, 0x0
    buffer_load_dwordx4 v5, s[44:47], s64 offen lds
    s_add_u32 m0, s21, 1024
    s_add_u32 s64, s20, 0x20000
    buffer_load_dwordx4 v5, s[44:47], s64 offen lds
    s_add_u32 m0, s21, 2048
    s_add_u32 s64, s20, 0x40000
    buffer_load_dwordx4 v5, s[44:47], s64 offen lds
    s_add_u32 m0, s21, 3072
    s_add_u32 s64, s20, 0x60000
    buffer_load_dwordx4 v5, s[44:47], s64 offen lds
    s_add_u32 m0, s21, 4096
    s_add_u32 s64, s20, 0x80000
    buffer_load_dwordx4 v5, s[44:47], s64 offen lds
    s_add_u32 m0, s21, 5120
    s_add_u32 s64, s20, 0xa0000
    buffer_load_dwordx4 v5, s[44:47], s64 offen lds
    s_add_u32 m0, s21, 6144
    s_add_u32 s64, s20, 0xc0000
    buffer_load_dwordx4 v5, s[44:47], s64 offen lds
    s_add_u32 m0, s21, 7168
    s_add_u32 s64, s20, 0xe0000
    buffer_load_dwordx4 v5, s[44:47], s64 offen lds
    s_add_u32 m0, s21, 8192
    s_add_u32 s64, s20, 0x100000
    buffer_load_dwordx4 v5, s[44:47], s64 offen lds
    s_add_u32 m0, s21, 9216
    s_add_u32 s64, s20, 0x120000
    buffer_load_dwordx4 v5, s[44:47], s64 offen lds
    s_add_u32 m0, s21, 10240
    s_add_u32 s64, s20, 0x140000
    buffer_load_dwordx4 v5, s[44:47], s64 offen lds
    s_add_u32 m0, s21, 11264
    s_add_u32 s64, s20, 0x160000
    buffer_load_dwordx4 v5, s[44:47], s64 offen lds
    s_add_u32 m0, s21, 12288
    s_add_u32 s64, s20, 0x180000
    buffer_load_dwordx4 v5, s[44:47], s64 offen lds
    s_add_u32 m0, s21, 13312
    s_add_u32 s64, s20, 0x1a0000
    buffer_load_dwordx4 v5, s[44:47], s64 offen lds
    s_add_u32 m0, s21, 14336
    s_add_u32 s64, s20, 0x1c0000
    buffer_load_dwordx4 v5, s[44:47], s64 offen lds
    s_add_u32 m0, s21, 15360
    s_add_u32 s64, s20, 0x1e0000
    buffer_load_dwordx4 v5, s[44:47], s64 offen lds
    s_add_u32 m0, s21, 16384
    s_add_u32 s64, s20, 0x200000
    buffer_load_dwordx4 v5, s[44:47], s64 offen lds
    s_add_u32 m0, s21, 17408
    s_add_u32 s64, s20, 0x220000
    buffer_load_dwordx4 v5, s[44:47], s64 offen lds
    s_add_u32 m0, s21, 18432
    s_add_u32 s64, s20, 0x240000
    buffer_load_dwordx4 v5, s[44:47], s64 offen lds
    s_add_u32 m0, s21, 19456
    s_add_u32 s64, s20, 0x260000
    buffer_load_dwordx4 v5, s[44:47], s64 offen lds
    s_add_u32 m0, s21, 20480
    s_add_u32 s64, s20, 0x280000
    buffer_load_dwordx4 v5, s[44:47], s64 offen lds
    s_add_u32 m0, s21, 21504
    s_add_u32 s64, s20, 0x2a0000
    buffer_load_dwordx4 v5, s[44:47], s64 offen lds
    s_add_u32 m0, s21, 22528
    s_add_u32 s64, s20, 0x2c0000
    buffer_load_dwordx4 v5, s[44:47], s64 offen lds
    s_add_u32 m0, s21, 23552
    s_add_u32 s64, s20, 0x2e0000
    buffer_load_dwordx4 v5, s[44:47], s64 offen lds
    s_add_u32 m0, s21, 24576
    s_add_u32 s64, s20, 0x300000
    buffer_load_dwordx4 v5, s[44:47], s64 offen lds
    s_add_u32 m0, s21, 25600
    s_add_u32 s64, s20, 0x320000
    buffer_load_dwordx4 v5, s[44:47], s64 offen lds
    s_add_u32 m0, s21, 26624
    s_add_u32 s64, s20, 0x340000
    buffer_load_dwordx4 v5, s[44:47], s64 offen lds
    s_add_u32 m0, s21, 27648
    s_add_u32 s64, s20, 0x360000
    buffer_load_dwordx4 v5, s[44:47], s64 offen lds
    s_add_u32 m0, s21, 28672
    s_add_u32 s64, s20, 0x380000
    buffer_load_dwordx4 v5, s[44:47], s64 offen lds
    s_add_u32 m0, s21, 29696
    s_add_u32 s64, s20, 0x3a0000
    buffer_load_dwordx4 v5, s[44:47], s64 offen lds
    s_add_u32 m0, s21, 30720
    s_add_u32 s64, s20, 0x3c0000
    buffer_load_dwordx4 v5, s[44:47], s64 offen lds
    s_add_u32 m0, s21, 31744
    s_add_u32 s64, s20, 0x3e0000
    buffer_load_dwordx4 v5, s[44:47], s64 offen lds
    s_add_u32 m0, s21, 32768
    s_add_u32 s64, s20, 0x400000
    buffer_load_dwordx4 v5, s[44:47], s64 offen lds
    s_add_u32 m0, s21, 33792
    s_add_u32 s64, s20, 0x420000
    buffer_load_dwordx4 v5, s[44:47], s64 offen lds
    s_add_u32 m0, s21, 34816
    s_add_u32 s64, s20, 0x440000
    buffer_load_dwordx4 v5, s[44:47], s64 offen lds
    s_add_u32 m0, s21, 35840
    s_add_u32 s64, s20, 0x460000
    buffer_load_dwordx4 v5, s[44:47], s64 offen lds
    s_waitcnt vmcnt(32)
    ds_read_b64_tr_b16 v[96:97], v3 offset:0
    ds_read_b64_tr_b16 v[98:99], v3 offset:256
    ds_read_b64_tr_b16 v[100:101], v4 offset:0
    ds_read_b64_tr_b16 v[102:103], v4 offset:256
    ds_read_b64_tr_b16 v[104:105], v3 offset:2048
    ds_read_b64_tr_b16 v[106:107], v3 offset:2304
    ds_read_b64_tr_b16 v[108:109], v4 offset:2048
    ds_read_b64_tr_b16 v[110:111], v4 offset:2304
    s_waitcnt lgkmcnt(0)
    s_add_u32 m0, s21, 0
    s_add_u32 s64, s20, 0x480000
    buffer_load_dwordx4 v5, s[44:47], s64 offen lds
    s_add_u32 m0, s21, 1024
    s_add_u32 s64, s20, 0x4a0000
    buffer_load_dwordx4 v5, s[44:47], s64 offen lds
    s_add_u32 m0, s21, 2048
    s_add_u32 s64, s20, 0x4c0000
    buffer_load_dwordx4 v5, s[44:47], s64 offen lds
    s_add_u32 m0, s21, 3072
    s_add_u32 s64, s20, 0x4e0000
    buffer_load_dwordx4 v5, s[44:47], s64 offen lds
    s_waitcnt vmcnt(32)
    ds_read_b64_tr_b16 v[112:113], v3 offset:4096
    ds_read_b64_tr_b16 v[114:115], v3 offset:4352
    ds_read_b64_tr_b16 v[116:117], v4 offset:4096
    ds_read_b64_tr_b16 v[118:119], v4 offset:4352
    ds_read_b64_tr_b16 v[120:121], v3 offset:6144
    ds_read_b64_tr_b16 v[122:123], v3 offset:6400
    ds_read_b64_tr_b16 v[124:125], v4 offset:6144
    ds_read_b64_tr_b16 v[126:127], v4 offset:6400
    s_waitcnt lgkmcnt(0)
    s_waitcnt vmcnt(28)
    ds_read_b64_tr_b16 v[128:129], v3 offset:8192
    ds_read_b64_tr_b16 v[130:131], v3 offset:8448
    ds_read_b64_tr_b16 v[132:133], v4 offset:8192
    ds_read_b64_tr_b16 v[134:135], v4 offset:8448
    ds_read_b64_tr_b16 v[136:137], v3 offset:10240
    ds_read_b64_tr_b16 v[138:139], v3 offset:10496
    ds_read_b64_tr_b16 v[140:141], v4 offset:10240
    ds_read_b64_tr_b16 v[142:143], v4 offset:10496
    s_waitcnt lgkmcnt(0)
    s_waitcnt vmcnt(24)
    ds_read_b64_tr_b16 v[144:145], v3 offset:12288
    ds_read_b64_tr_b16 v[146:147], v3 offset:12544
    ds_read_b64_tr_b16 v[148:149], v4 offset:12288
    ds_read_b64_tr_b16 v[150:151], v4 offset:12544
    ds_read_b64_tr_b16 v[152:153], v3 offset:14336
    ds_read_b64_tr_b16 v[154:155], v3 offset:14592
    ds_read_b64_tr_b16 v[156:157], v4 offset:14336
    ds_read_b64_tr_b16 v[158:159], v4 offset:14592
    s_waitcnt lgkmcnt(0)
    s_waitcnt vmcnt(20)
    ds_read_b64_tr_b16 v[160:161], v3 offset:16384
    ds_read_b64_tr_b16 v[162:163], v3 offset:16640
    ds_read_b64_tr_b16 v[164:165], v4 offset:16384
    ds_read_b64_tr_b16 v[166:167], v4 offset:16640
    ds_read_b64_tr_b16 v[168:169], v3 offset:18432
    ds_read_b64_tr_b16 v[170:171], v3 offset:18688
    ds_read_b64_tr_b16 v[172:173], v4 offset:18432
    ds_read_b64_tr_b16 v[174:175], v4 offset:18688
    s_waitcnt lgkmcnt(0)
    s_waitcnt vmcnt(16)
    ds_read_b64_tr_b16 v[176:177], v3 offset:20480
    ds_read_b64_tr_b16 v[178:179], v3 offset:20736
    ds_read_b64_tr_b16 v[180:181], v4 offset:20480
    ds_read_b64_tr_b16 v[182:183], v4 offset:20736
    ds_read_b64_tr_b16 v[184:185], v3 offset:22528
    ds_read_b64_tr_b16 v[186:187], v3 offset:22784
    ds_read_b64_tr_b16 v[188:189], v4 offset:22528
    ds_read_b64_tr_b16 v[190:191], v4 offset:22784
    s_waitcnt lgkmcnt(0)
    s_waitcnt vmcnt(12)
    ds_read_b64_tr_b16 v[192:193], v3 offset:24576
    ds_read_b64_tr_b16 v[194:195], v3 offset:24832
    ds_read_b64_tr_b16 v[196:197], v4 offset:24576
    ds_read_b64_tr_b16 v[198:199], v4 offset:24832
    ds_read_b64_tr_b16 v[200:201], v3 offset:26624
    ds_read_b64_tr_b16 v[202:203], v3 offset:26880
    ds_read_b64_tr_b16 v[204:205], v4 offset:26624
    ds_read_b64_tr_b16 v[206:207], v4 offset:26880
    s_waitcnt lgkmcnt(0)
    s_waitcnt vmcnt(8)
    ds_read_b64_tr_b16 v[208:209], v3 offset:28672
    ds_read_b64_tr_b16 v[210:211], v3 offset:28928
    ds_read_b64_tr_b16 v[212:213], v4 offset:28672
    ds_read_b64_tr_b16 v[214:215], v4 offset:28928
    ds_read_b64_tr_b16 v[216:217], v3 offset:30720
    ds_read_b64_tr_b16 v[218:219], v3 offset:30976
    ds_read_b64_tr_b16 v[220:221], v4 offset:30720
    ds_read_b64_tr_b16 v[222:223], v4 offset:30976
    s_waitcnt lgkmcnt(0)
    s_waitcnt vmcnt(4)
    ds_read_b64_tr_b16 v[224:225], v3 offset:32768
    ds_read_b64_tr_b16 v[226:227], v3 offset:33024
    ds_read_b64_tr_b16 v[228:229], v4 offset:32768
    ds_read_b64_tr_b16 v[230:231], v4 offset:33024
    ds_read_b64_tr_b16 v[232:233], v3 offset:34816
    ds_read_b64_tr_b16 v[234:235], v3 offset:35072
    ds_read_b64_tr_b16 v[236:237], v4 offset:34816
    ds_read_b64_tr_b16 v[238:239], v4 offset:35072
    s_waitcnt lgkmcnt(0)
    s_waitcnt vmcnt(0)
    ds_read_b64_tr_b16 v[240:241], v3 offset:0
    ds_read_b64_tr_b16 v[242:243], v3 offset:256
    ds_read_b64_tr_b16 v[244:245], v4 offset:0
    ds_read_b64_tr_b16 v[246:247], v4 offset:256
    ds_read_b64_tr_b16 v[248:249], v3 offset:2048
    ds_read_b64_tr_b16 v[250:251], v3 offset:2304
    ds_read_b64_tr_b16 v[252:253], v4 offset:2048
    ds_read_b64_tr_b16 v[254:255], v4 offset:2304
    s_waitcnt lgkmcnt(0)
    s_cmp_lg_u32 s97, 0
    s_cbranch_scc1 CM_95
    v_mbcnt_lo_u32_b32 v0, -1, 0
    v_mbcnt_hi_u32_b32 v0, -1, v0
    v_mul_u32_u24 v8, 32, v0
    s_mov_b32 s64, 0x0
    s_mov_b32 s65, 0
    s_mov_b64 exec, 0xff
TK_96:
    buffer_load_dword v9, v8, s[60:63], s64 offen sc1
    s_add_u32 s65, s65, 1
    s_waitcnt vmcnt(0)
    s_mov_b32 s66, 0
    v_readlane_b32 s67, v9, 0
    s_add_u32 s66, s66, s67
    v_readlane_b32 s67, v9, 1
    s_add_u32 s66, s66, s67
    v_readlane_b32 s67, v9, 2
    s_add_u32 s66, s66, s67
    v_readlane_b32 s67, v9, 3
    s_add_u32 s66, s66, s67
    v_readlane_b32 s67, v9, 4
    s_add_u32 s66, s66, s67
    v_readlane_b32 s67, v9, 5
    s_add_u32 s66, s66, s67
    v_readlane_b32 s67, v9, 6
    s_add_u32 s66, s66, s67
    v_readlane_b32 s67, v9, 7
    s_add_u32 s66, s66, s67
    s_cmp_ge_u32 s66, 256
    s_cbranch_scc1 TKD_97
    s_cmp_gt_u32 s65, 262144
    s_cbranch_scc0 TK_96
TKD_97:
    v_cmp_ne_u32 vcc, 32, v9
    s_mov_b64 exec, -1
    s_cbranch_vccnz M_SLOW
CM_95:
    s_mov_b32 s65, 0
GI_98:
    buffer_load_dword v8, off, s[60:63], s95 sc1
    s_add_u32 s65, s65, 1
    s_waitcnt vmcnt(0)
    v_readfirstlane_b32 s64, v8
    s_cmp_ge_u32 s64, 192
    s_cbranch_scc1 GID_99
    s_cmp_gt_u32 s65, 65536
    s_cbranch_scc1 GID_99
    s_sleep 4
    s_branch GI_98
GID_99:
    v_mbcnt_lo_u32_b32 v0, -1, 0
    v_mbcnt_hi_u32_b32 v0, -1, v0
    s_cmp_lg_u32 s3, 2
    s_cbranch_scc1 NOSEL_100
    s_or_b32 s64, s13, s12
    s_or_b32 s64, s64, s14
    s_cmp_lg_u32 s64, 0
    s_cbranch_scc1 NOSEL_100
    s_mov_b32 s29, 0
    v_lshlrev_b32 v1, 4, v0
    s_mov_b32 s64, 0x280000
    buffer_load_dwordx4 v[16:19], v1, s[4:7], s64 offen offset:0 sc1
    buffer_load_dwordx4 v[20:23], v1, s[4:7], s64 offen offset:1024 sc1
    buffer_load_dwordx4 v[24:27], v1, s[4:7], s64 offen offset:2048 sc1
    buffer_load_dwordx4 v[28:31], v1, s[4:7], s64 offen offset:3072 sc1
    s_add_u32 s64, s64, 4096
    buffer_load_dwordx4 v[32:35], v1, s[4:7], s64 offen offset:0 sc1
    buffer_load_dwordx4 v[36:39], v1, s[4:7], s64 offen offset:1024 sc1
    buffer_load_dwordx4 v[40:43], v1, s[4:7], s64 offen offset:2048 sc1
    buffer_load_dwordx4 v[44:47], v1, s[4:7], s64 offen offset:3072 sc1
    s_waitcnt vmcnt(0)
    v_lshlrev_b32 v2, 2, v0
    v_ashrrev_i32 v3, 31, v16
    v_or_b32 v3, 0x80000000, v3
    v_xor_b32 v16, v16, v3
    v_and_b32 v16, 0xffff0000, v16
    v_sub_u32 v3, 65535, v2
    v_or_b32 v16, v16, v3
    v_ashrrev_i32 v3, 31, v17
    v_or_b32 v3, 0x80000000, v3
    v_xor_b32 v17, v17, v3
    v_and_b32 v17, 0xffff0000, v17
    v_sub_u32 v3, 65534, v2
    v_or_b32 v17, v17, v3
    v_ashrrev_i32 v3, 31, v18
    v_or_b32 v3, 0x80000000, v3
    v_xor_b32 v18, v18, v3
    v_and_b32 v18, 0xffff0000, v18
    v_sub_u32 v3, 65533, v2
    v_or_b32 v18, v18, v3
    v_ashrrev_i32 v3, 31, v19
    v_or_b32 v3, 0x80000000, v3
    v_xor_b32 v19, v19, v3
    v_and_b32 v19, 0xffff0000, v19
    v_sub_u32 v3, 65532, v2
    v_or_b32 v19, v19, v3
    v_ashrrev_i32 v3, 31, v20
    v_or_b32 v3, 0x80000000, v3
    v_xor_b32 v20, v20, v3
    v_and_b32 v20, 0xffff0000, v20
    v_sub_u32 v3, 65279, v2
    v_or_b32 v20, v20, v3
    v_ashrrev_i32 v3, 31, v21
    v_or_b32 v3, 0x80000000, v3
    v_xor_b32 v21, v21, v3
    v_and_b32 v21, 0xffff0000, v21
    v_sub_u32 v3, 65278, v2
    v_or_b32 v21, v21, v3
    v_ashrrev_i32 v3, 31, v22
    v_or_b32 v3, 0x80000000, v3
    v_xor_b32 v22, v22, v3
    v_and_b32 v22, 0xffff0000, v22
    v_sub_u32 v3, 65277, v2
    v_or_b32 v22, v22, v3
    v_ashrrev_i32 v3, 31, v23
    v_or_b32 v3, 0x80000000, v3
    v_xor_b32 v23, v23, v3
    v_and_b32 v23, 0xffff0000, v23
    v_sub_u32 v3, 65276, v2
    v_or_b32 v23, v23, v3
    v_ashrrev_i32 v3, 31, v24
    v_or_b32 v3, 0x80000000, v3
    v_xor_b32 v24, v24, v3
    v_and_b32 v24, 0xffff0000, v24
    v_sub_u32 v3, 65023, v2
    v_or_b32 v24, v24, v3
    v_ashrrev_i32 v3, 31, v25
    v_or_b32 v3, 0x80000000, v3
    v_xor_b32 v25, v25, v3
    v_and_b32 v25, 0xffff0000, v25
    v_sub_u32 v3, 65022, v2
    v_or_b32 v25, v25, v3
    v_ashrrev_i32 v3, 31, v26
    v_or_b32 v3, 0x80000000, v3
    v_xor_b32 v26, v26, v3
    v_and_b32 v26, 0xffff0000, v26
    v_sub_u32 v3, 65021, v2
    v_or_b32 v26, v26, v3
    v_ashrrev_i32 v3, 31, v27
    v_or_b32 v3, 0x80000000, v3
    v_xor_b32 v27, v27, v3
    v_and_b32 v27, 0xffff0000, v27
    v_sub_u32 v3, 65020, v2
    v_or_b32 v27, v27, v3
    v_ashrrev_i32 v3, 31, v28
    v_or_b32 v3, 0x80000000, v3
    v_xor_b32 v28, v28, v3
    v_and_b32 v28, 0xffff0000, v28
    v_sub_u32 v3, 64767, v2
    v_or_b32 v28, v28, v3
    v_ashrrev_i32 v3, 31, v29
    v_or_b32 v3, 0x80000000, v3
    v_xor_b32 v29, v29, v3
    v_and_b32 v29, 0xffff0000, v29
    v_sub_u32 v3, 64766, v2
    v_or_b32 v29, v29, v3
    v_ashrrev_i32 v3, 31, v30
    v_or_b32 v3, 0x80000000, v3
    v_xor_b32 v30, v30, v3
    v_and_b32 v30, 0xffff0000, v30
    v_sub_u32 v3, 64765, v2
    v_or_b32 v30, v30, v3
    v_ashrrev_i32 v3, 31, v31
    v_or_b32 v3, 0x80000000, v3
    v_xor_b32 v31, v31, v3
    v_and_b32 v31, 0xffff0000, v31
    v_sub_u32 v3, 64764, v2
    v_or_b32 v31, v31, v3
    v_ashrrev_i32 v3, 31, v32
    v_or_b32 v3, 0x80000000, v3
    v_xor_b32 v32, v32, v3
    v_and_b32 v32, 0xffff0000, v32
    v_sub_u32 v3, 64511, v2
    v_or_b32 v32, v32, v3
    v_ashrrev_i32 v3, 31, v33
    v_or_b32 v3, 0x80000000, v3
    v_xor_b32 v33, v33, v3
    v_and_b32 v33, 0xffff0000, v33
    v_sub_u32 v3, 64510, v2
    v_or_b32 v33, v33, v3
    v_ashrrev_i32 v3, 31, v34
    v_or_b32 v3, 0x80000000, v3
    v_xor_b32 v34, v34, v3
    v_and_b32 v34, 0xffff0000, v34
    v_sub_u32 v3, 64509, v2
    v_or_b32 v34, v34, v3
    v_ashrrev_i32 v3, 31, v35
    v_or_b32 v3, 0x80000000, v3
    v_xor_b32 v35, v35, v3
    v_and_b32 v35, 0xffff0000, v35
    v_sub_u32 v3, 64508, v2
    v_or_b32 v35, v35, v3
    v_ashrrev_i32 v3, 31, v36
    v_or_b32 v3, 0x80000000, v3
    v_xor_b32 v36, v36, v3
    v_and_b32 v36, 0xffff0000, v36
    v_sub_u32 v3, 64255, v2
    v_or_b32 v36, v36, v3
    v_ashrrev_i32 v3, 31, v37
    v_or_b32 v3, 0x80000000, v3
    v_xor_b32 v37, v37, v3
    v_and_b32 v37, 0xffff0000, v37
    v_sub_u32 v3, 64254, v2
    v_or_b32 v37, v37, v3
    v_ashrrev_i32 v3, 31, v38
    v_or_b32 v3, 0x80000000, v3
    v_xor_b32 v38, v38, v3
    v_and_b32 v38, 0xffff0000, v38
    v_sub_u32 v3, 64253, v2
    v_or_b32 v38, v38, v3
    v_ashrrev_i32 v3, 31, v39
    v_or_b32 v3, 0x80000000, v3
    v_xor_b32 v39, v39, v3
    v_and_b32 v39, 0xffff0000, v39
    v_sub_u32 v3, 64252, v2
    v_or_b32 v39, v39, v3
    v_ashrrev_i32 v3, 31, v40
    v_or_b32 v3, 0x80000000, v3
    v_xor_b32 v40, v40, v3
    v_and_b32 v40, 0xffff0000, v40
    v_sub_u32 v3, 63999, v2
    v_or_b32 v40, v40, v3
    v_ashrrev_i32 v3, 31, v41
    v_or_b32 v3, 0x80000000, v3
    v_xor_b32 v41, v41, v3
    v_and_b32 v41, 0xffff0000, v41
    v_sub_u32 v3, 63998, v2
    v_or_b32 v41, v41, v3
    v_ashrrev_i32 v3, 31, v42
    v_or_b32 v3, 0x80000000, v3
    v_xor_b32 v42, v42, v3
    v_and_b32 v42, 0xffff0000, v42
    v_sub_u32 v3, 63997, v2
    v_or_b32 v42, v42, v3
    v_ashrrev_i32 v3, 31, v43
    v_or_b32 v3, 0x80000000, v3
    v_xor_b32 v43, v43, v3
    v_and_b32 v43, 0xffff0000, v43
    v_sub_u32 v3, 63996, v2
    v_or_b32 v43, v43, v3
    v_ashrrev_i32 v3, 31, v44
    v_or_b32 v3, 0x80000000, v3
    v_xor_b32 v44, v44, v3
    v_and_b32 v44, 0xffff0000, v44
    v_sub_u32 v3, 63743, v2
    v_or_b32 v44, v44, v3
    v_ashrrev_i32 v3, 31, v45
    v_or_b32 v3, 0x80000000, v3
    v_xor_b32 v45, v45, v3
    v_and_b32 v45, 0xffff0000, v45
    v_sub_u32 v3, 63742, v2
    v_or_b32 v45, v45, v3
    v_ashrrev_i32 v3, 31, v46
    v_or_b32 v3, 0x80000000, v3
    v_xor_b32 v46, v46, v3
    v_and_b32 v46, 0xffff0000, v46
    v_sub_u32 v3, 63741, v2
    v_or_b32 v46, v46, v3
    v_ashrrev_i32 v3, 31, v47
    v_or_b32 v3, 0x80000000, v3
    v_xor_b32 v47, v47, v3
    v_and_b32 v47, 0xffff0000, v47
    v_sub_u32 v3, 63740, v2
    v_or_b32 v47, v47, v3
    v_max3_u32 v4, v16, v17, v18
    v_max3_u32 v4, v4, v19, v20
    v_max3_u32 v4, v4, v21, v22
    v_max3_u32 v4, v4, v23, v24
    v_max3_u32 v4, v4, v25, v26
    v_max3_u32 v4, v4, v27, v28
    v_max3_u32 v4, v4, v29, v30
    v_max3_u32 v4, v4, v31, v32
    v_max3_u32 v4, v4, v33, v34
    v_max3_u32 v4, v4, v35, v36
    v_max3_u32 v4, v4, v37, v38
    v_max3_u32 v4, v4, v39, v40
    v_max3_u32 v4, v4, v41, v42
    v_max3_u32 v4, v4, v43, v44
    v_max3_u32 v4, v4, v45, v46
    v_max_u32 v4, v4, v47
    s_nop 1
    v_max_u32_dpp v4, v4, v4 quad_perm:[1,0,3,2] row_mask:0xf bank_mask:0xf
    s_nop 1
    v_max_u32_dpp v4, v4, v4 quad_perm:[2,3,0,1] row_mask:0xf bank_mask:0xf
    s_nop 1
    v_max_u32_dpp v4, v4, v4 row_half_mirror row_mask:0xf bank_mask:0xf
    s_nop 1
    v_max_u32_dpp v4, v4, v4 row_mirror row_mask:0xf bank_mask:0xf
    v_mov_b32 v5, v4
    s_nop 1
    v_permlane16_swap_b32 v4, v5
    v_max_u32 v4, v4, v5
    v_mov_b32 v5, v4
    s_nop 1
    v_permlane32_swap_b32 v4, v5
    v_max_u32 v4, v4, v5
    v_mov_b32 v56, v4
    v_cmp_eq_u32 vcc, v4, v16
    s_nop 1
    v_cndmask_b32 v16, v16, 0, vcc
    v_cmp_eq_u32 vcc, v4, v17
    s_nop 1
    v_cndmask_b32 v17, v17, 0, vcc
    v_cmp_eq_u32 vcc, v4, v18
    s_nop 1
    v_cndmask_b32 v18, v18, 0, vcc
    v_cmp_eq_u32 vcc, v4, v19
    s_nop 1
    v_cndmask_b32 v19, v19, 0, vcc
    v_cmp_eq_u32 vcc, v4, v20
    s_nop 1
    v_cndmask_b32 v20, v20, 0, vcc
    v_cmp_eq_u32 vcc, v4, v21
    s_nop 1
    v_cndmask_b32 v21, v21, 0, vcc
    v_cmp_eq_u32 vcc, v4, v22
    s_nop 1
    v_cndmask_b32 v22, v22, 0, vcc
    v_cmp_eq_u32 vcc, v4, v23
    s_nop 1
    v_cndmask_b32 v23, v23, 0, vcc
    v_cmp_eq_u32 vcc, v4, v24
    s_nop 1
    v_cndmask_b32 v24, v24, 0, vcc
    v_cmp_eq_u32 vcc, v4, v25
    s_nop 1
    v_cndmask_b32 v25, v25, 0, vcc
    v_cmp_eq_u32 vcc, v4, v26
    s_nop 1
    v_cndmask_b32 v26, v26, 0, vcc
    v_cmp_eq_u32 vcc, v4, v27
    s_nop 1
    v_cndmask_b32 v27, v27, 0, vcc
    v_cmp_eq_u32 vcc, v4, v28
    s_nop 1
    v_cndmask_b32 v28, v28, 0, vcc
    v_cmp_eq_u32 vcc, v4, v29
    s_nop 1
    v_cndmask_b32 v29, v29, 0, vcc
    v_cmp_eq_u32 vcc, v4, v30
    s_nop 1
    v_cndmask_b32 v30, v30, 0, vcc
    v_cmp_eq_u32 vcc, v4, v31
    s_nop 1
    v_cndmask_b32 v31, v31, 0, vcc
    v_cmp_eq_u32 vcc, v4, v32
    s_nop 1
    v_cndmask_b32 v32, v32, 0, vcc
    v_cmp_eq_u32 vcc, v4, v33
    s_nop 1
    v_cndmask_b32 v33, v33, 0, vcc
    v_cmp_eq_u32 vcc, v4, v34
    s_nop 1
    v_cndmask_b32 v34, v34, 0, vcc
    v_cmp_eq_u32 vcc, v4, v35
    s_nop 1
    v_cndmask_b32 v35, v35, 0, vcc
    v_cmp_eq_u32 vcc, v4, v36
    s_nop 1
    v_cndmask_b32 v36, v36, 0, vcc
    v_cmp_eq_u32 vcc, v4, v37
    s_nop 1
    v_cndmask_b32 v37, v37, 0, vcc
    v_cmp_eq_u32 vcc, v4, v38
    s_nop 1
    v_cndmask_b32 v38, v38, 0, vcc
    v_cmp_eq_u32 vcc, v4, v39
    s_nop 1
    v_cndmask_b32 v39, v39, 0, vcc
    v_cmp_eq_u32 vcc, v4, v40
    s_nop 1
    v_cndmask_b32 v40, v40, 0, vcc
    v_cmp_eq_u32 vcc, v4, v41
    s_nop 1
    v_cndmask_b32 v41, v41, 0, vcc
    v_cmp_eq_u32 vcc, v4, v42
    s_nop 1
    v_cndmask_b32 v42, v42, 0, vcc
    v_cmp_eq_u32 vcc, v4, v43
    s_nop 1
    v_cndmask_b32 v43, v43, 0, vcc
    v_cmp_eq_u32 vcc, v4, v44
    s_nop 1
    v_cndmask_b32 v44, v44, 0, vcc
    v_cmp_eq_u32 vcc, v4, v45
    s_nop 1
    v_cndmask_b32 v45, v45, 0, vcc
    v_cmp_eq_u32 vcc, v4, v46
    s_nop 1
    v_cndmask_b32 v46, v46, 0, vcc
    v_cmp_eq_u32 vcc, v4, v47
    s_nop 1
    v_cndmask_b32 v47, v47, 0, vcc
    v_max3_u32 v4, v16, v17, v18
    v_max3_u32 v4, v4, v19, v20
    v_max3_u32 v4, v4, v21, v22
    v_max3_u32 v4, v4, v23, v24
    v_max3_u32 v4, v4, v25, v26
    v_max3_u32 v4, v4, v27, v28
    v_max3_u32 v4, v4, v29, v30
    v_max3_u32 v4, v4, v31, v32
    v_max3_u32 v4, v4, v33, v34
    v_max3_u32 v4, v4, v35, v36
    v_max3_u32 v4, v4, v37, v38
    v_max3_u32 v4, v4, v39, v40
    v_max3_u32 v4, v4, v41, v42
    v_max3_u32 v4, v4, v43, v44
    v_max3_u32 v4, v4, v45, v46
    v_max_u32 v4, v4, v47
    s_nop 1
    v_max_u32_dpp v4, v4, v4 quad_perm:[1,0,3,2] row_mask:0xf bank_mask:0xf
    s_nop 1
    v_max_u32_dpp v4, v4, v4 quad_perm:[2,3,0,1] row_mask:0xf bank_mask:0xf
    s_nop 1
    v_max_u32_dpp v4, v4, v4 row_half_mirror row_mask:0xf bank_mask:0xf
    s_nop 1
    v_max_u32_dpp v4, v4, v4 row_mirror row_mask:0xf bank_mask:0xf
    v_mov_b32 v5, v4
    s_nop 1
    v_permlane16_swap_b32 v4, v5
    v_max_u32 v4, v4, v5
    v_mov_b32 v5, v4
    s_nop 1
    v_permlane32_swap_b32 v4, v5
    v_max_u32 v4, v4, v5
    v_mov_b32 v57, v4
    v_cmp_eq_u32 vcc, v4, v16
    s_nop 1
    v_cndmask_b32 v16, v16, 0, vcc
    v_cmp_eq_u32 vcc, v4, v17
    s_nop 1
    v_cndmask_b32 v17, v17, 0, vcc
    v_cmp_eq_u32 vcc, v4, v18
    s_nop 1
    v_cndmask_b32 v18, v18, 0, vcc
    v_cmp_eq_u32 vcc, v4, v19
    s_nop 1
    v_cndmask_b32 v19, v19, 0, vcc
    v_cmp_eq_u32 vcc, v4, v20
    s_nop 1
    v_cndmask_b32 v20, v20, 0, vcc
    v_cmp_eq_u32 vcc, v4, v21
    s_nop 1
    v_cndmask_b32 v21, v21, 0, vcc
    v_cmp_eq_u32 vcc, v4, v22
    s_nop 1
    v_cndmask_b32 v22, v22, 0, vcc
    v_cmp_eq_u32 vcc, v4, v23
    s_nop 1
    v_cndmask_b32 v23, v23, 0, vcc
    v_cmp_eq_u32 vcc, v4, v24
    s_nop 1
    v_cndmask_b32 v24, v24, 0, vcc
    v_cmp_eq_u32 vcc, v4, v25
    s_nop 1
    v_cndmask_b32 v25, v25, 0, vcc
    v_cmp_eq_u32 vcc, v4, v26
    s_nop 1
    v_cndmask_b32 v26, v26, 0, vcc
    v_cmp_eq_u32 vcc, v4, v27
    s_nop 1
    v_cndmask_b32 v27, v27, 0, vcc
    v_cmp_eq_u32 vcc, v4, v28
    s_nop 1
    v_cndmask_b32 v28, v28, 0, vcc
    v_cmp_eq_u32 vcc, v4, v29
    s_nop 1
    v_cndmask_b32 v29, v29, 0, vcc
    v_cmp_eq_u32 vcc, v4, v30
    s_nop 1
    v_cndmask_b32 v30, v30, 0, vcc
    v_cmp_eq_u32 vcc, v4, v31
    s_nop 1
    v_cndmask_b32 v31, v31, 0, vcc
    v_cmp_eq_u32 vcc, v4, v32
    s_nop 1
    v_cndmask_b32 v32, v32, 0, vcc
    v_cmp_eq_u32 vcc, v4, v33
    s_nop 1
    v_cndmask_b32 v33, v33, 0, vcc
    v_cmp_eq_u32 vcc, v4, v34
    s_nop 1
    v_cndmask_b32 v34, v34, 0, vcc
    v_cmp_eq_u32 vcc, v4, v35
    s_nop 1
    v_cndmask_b32 v35, v35, 0, vcc
    v_cmp_eq_u32 vcc, v4, v36
    s_nop 1
    v_cndmask_b32 v36, v36, 0, vcc
    v_cmp_eq_u32 vcc, v4, v37
    s_nop 1
    v_cndmask_b32 v37, v37, 0, vcc
    v_cmp_eq_u32 vcc, v4, v38
    s_nop 1
    v_cndmask_b32 v38, v38, 0, vcc
    v_cmp_eq_u32 vcc, v4, v39
    s_nop 1
    v_cndmask_b32 v39, v39, 0, vcc
    v_cmp_eq_u32 vcc, v4, v40
    s_nop 1
    v_cndmask_b32 v40, v40, 0, vcc
    v_cmp_eq_u32 vcc, v4, v41
    s_nop 1
    v_cndmask_b32 v41, v41, 0, vcc
    v_cmp_eq_u32 vcc, v4, v42
    s_nop 1
    v_cndmask_b32 v42, v42, 0, vcc
    v_cmp_eq_u32 vcc, v4, v43
    s_nop 1
    v_cndmask_b32 v43, v43, 0, vcc
    v_cmp_eq_u32 vcc, v4, v44
    s_nop 1
    v_cndmask_b32 v44, v44, 0, vcc
    v_cmp_eq_u32 vcc, v4, v45
    s_nop 1
    v_cndmask_b32 v45, v45, 0, vcc
    v_cmp_eq_u32 vcc, v4, v46
    s_nop 1
    v_cndmask_b32 v46, v46, 0, vcc
    v_cmp_eq_u32 vcc, v4, v47
    s_nop 1
    v_cndmask_b32 v47, v47, 0, vcc
    v_max3_u32 v4, v16, v17, v18
    v_max3_u32 v4, v4, v19, v20
    v_max3_u32 v4, v4, v21, v22
    v_max3_u32 v4, v4, v23, v24
    v_max3_u32 v4, v4, v25, v26
    v_max3_u32 v4, v4, v27, v28
    v_max3_u32 v4, v4, v29, v30
    v_max3_u32 v4, v4, v31, v32
    v_max3_u32 v4, v4, v33, v34
    v_max3_u32 v4, v4, v35, v36
    v_max3_u32 v4, v4, v37, v38
    v_max3_u32 v4, v4, v39, v40
    v_max3_u32 v4, v4, v41, v42
    v_max3_u32 v4, v4, v43, v44
    v_max3_u32 v4, v4, v45, v46
    v_max_u32 v4, v4, v47
    s_nop 1
    v_max_u32_dpp v4, v4, v4 quad_perm:[1,0,3,2] row_mask:0xf bank_mask:0xf
    s_nop 1
    v_max_u32_dpp v4, v4, v4 quad_perm:[2,3,0,1] row_mask:0xf bank_mask:0xf
    s_nop 1
    v_max_u32_dpp v4, v4, v4 row_half_mirror row_mask:0xf bank_mask:0xf
    s_nop 1
    v_max_u32_dpp v4, v4, v4 row_mirror row_mask:0xf bank_mask:0xf
    v_mov_b32 v5, v4
    s_nop 1
    v_permlane16_swap_b32 v4, v5
    v_max_u32 v4, v4, v5
    v_mov_b32 v5, v4
    s_nop 1
    v_permlane32_swap_b32 v4, v5
    v_max_u32 v4, v4, v5
    v_mov_b32 v58, v4
    v_cmp_eq_u32 vcc, v4, v16
    s_nop 1
    v_cndmask_b32 v16, v16, 0, vcc
    v_cmp_eq_u32 vcc, v4, v17
    s_nop 1
    v_cndmask_b32 v17, v17, 0, vcc
    v_cmp_eq_u32 vcc, v4, v18
    s_nop 1
    v_cndmask_b32 v18, v18, 0, vcc
    v_cmp_eq_u32 vcc, v4, v19
    s_nop 1
    v_cndmask_b32 v19, v19, 0, vcc
    v_cmp_eq_u32 vcc, v4, v20
    s_nop 1
    v_cndmask_b32 v20, v20, 0, vcc
    v_cmp_eq_u32 vcc, v4, v21
    s_nop 1
    v_cndmask_b32 v21, v21, 0, vcc
    v_cmp_eq_u32 vcc, v4, v22
    s_nop 1
    v_cndmask_b32 v22, v22, 0, vcc
    v_cmp_eq_u32 vcc, v4, v23
    s_nop 1
    v_cndmask_b32 v23, v23, 0, vcc
    v_cmp_eq_u32 vcc, v4, v24
    s_nop 1
    v_cndmask_b32 v24, v24, 0, vcc
    v_cmp_eq_u32 vcc, v4, v25
    s_nop 1
    v_cndmask_b32 v25, v25, 0, vcc
    v_cmp_eq_u32 vcc, v4, v26
    s_nop 1
    v_cndmask_b32 v26, v26, 0, vcc
    v_cmp_eq_u32 vcc, v4, v27
    s_nop 1
    v_cndmask_b32 v27, v27, 0, vcc
    v_cmp_eq_u32 vcc, v4, v28
    s_nop 1
    v_cndmask_b32 v28, v28, 0, vcc
    v_cmp_eq_u32 vcc, v4, v29
    s_nop 1
    v_cndmask_b32 v29, v29, 0, vcc
    v_cmp_eq_u32 vcc, v4, v30
    s_nop 1
    v_cndmask_b32 v30, v30, 0, vcc
    v_cmp_eq_u32 vcc, v4, v31
    s_nop 1
    v_cndmask_b32 v31, v31, 0, vcc
    v_cmp_eq_u32 vcc, v4, v32
    s_nop 1
    v_cndmask_b32 v32, v32, 0, vcc
    v_cmp_eq_u32 vcc, v4, v33
    s_nop 1
    v_cndmask_b32 v33, v33, 0, vcc
    v_cmp_eq_u32 vcc, v4, v34
    s_nop 1
    v_cndmask_b32 v34, v34, 0, vcc
    v_cmp_eq_u32 vcc, v4, v35
    s_nop 1
    v_cndmask_b32 v35, v35, 0, vcc
    v_cmp_eq_u32 vcc, v4, v36
    s_nop 1
    v_cndmask_b32 v36, v36, 0, vcc
    v_cmp_eq_u32 vcc, v4, v37
    s_nop 1
    v_cndmask_b32 v37, v37, 0, vcc
    v_cmp_eq_u32 vcc, v4, v38
    s_nop 1
    v_cndmask_b32 v38, v38, 0, vcc
    v_cmp_eq_u32 vcc, v4, v39
    s_nop 1
    v_cndmask_b32 v39, v39, 0, vcc
    v_cmp_eq_u32 vcc, v4, v40
    s_nop 1
    v_cndmask_b32 v40, v40, 0, vcc
    v_cmp_eq_u32 vcc, v4, v41
    s_nop 1
    v_cndmask_b32 v41, v41, 0, vcc
    v_cmp_eq_u32 vcc, v4, v42
    s_nop 1
    v_cndmask_b32 v42, v42, 0, vcc
    v_cmp_eq_u32 vcc, v4, v43
    s_nop 1
    v_cndmask_b32 v43, v43, 0, vcc
    v_cmp_eq_u32 vcc, v4, v44
    s_nop 1
    v_cndmask_b32 v44, v44, 0, vcc
    v_cmp_eq_u32 vcc, v4, v45
    s_nop 1
    v_cndmask_b32 v45, v45, 0, vcc
    v_cmp_eq_u32 vcc, v4, v46
    s_nop 1
    v_cndmask_b32 v46, v46, 0, vcc
    v_cmp_eq_u32 vcc, v4, v47
    s_nop 1
    v_cndmask_b32 v47, v47, 0, vcc
    v_max3_u32 v4, v16, v17, v18
    v_max3_u32 v4, v4, v19, v20
    v_max3_u32 v4, v4, v21, v22
    v_max3_u32 v4, v4, v23, v24
    v_max3_u32 v4, v4, v25, v26
    v_max3_u32 v4, v4, v27, v28
    v_max3_u32 v4, v4, v29, v30
    v_max3_u32 v4, v4, v31, v32
    v_max3_u32 v4, v4, v33, v34
    v_max3_u32 v4, v4, v35, v36
    v_max3_u32 v4, v4, v37, v38
    v_max3_u32 v4, v4, v39, v40
    v_max3_u32 v4, v4, v41, v42
    v_max3_u32 v4, v4, v43, v44
    v_max3_u32 v4, v4, v45, v46
    v_max_u32 v4, v4, v47
    s_nop 1
    v_max_u32_dpp v4, v4, v4 quad_perm:[1,0,3,2] row_mask:0xf bank_mask:0xf
    s_nop 1
    v_max_u32_dpp v4, v4, v4 quad_perm:[2,3,0,1] row_mask:0xf bank_mask:0xf
    s_nop 1
    v_max_u32_dpp v4, v4, v4 row_half_mirror row_mask:0xf bank_mask:0xf
    s_nop 1
    v_max_u32_dpp v4, v4, v4 row_mirror row_mask:0xf bank_mask:0xf
    v_mov_b32 v5, v4
    s_nop 1
    v_permlane16_swap_b32 v4, v5
    v_max_u32 v4, v4, v5
    v_mov_b32 v5, v4
    s_nop 1
    v_permlane32_swap_b32 v4, v5
    v_max_u32 v4, v4, v5
    v_mov_b32 v59, v4
    v_cmp_eq_u32 vcc, v4, v16
    s_nop 1
    v_cndmask_b32 v16, v16, 0, vcc
    v_cmp_eq_u32 vcc, v4, v17
    s_nop 1
    v_cndmask_b32 v17, v17, 0, vcc
    v_cmp_eq_u32 vcc, v4, v18
    s_nop 1
    v_cndmask_b32 v18, v18, 0, vcc
    v_cmp_eq_u32 vcc, v4, v19
    s_nop 1
    v_cndmask_b32 v19, v19, 0, vcc
    v_cmp_eq_u32 vcc, v4, v20
    s_nop 1
    v_cndmask_b32 v20, v20, 0, vcc
    v_cmp_eq_u32 vcc, v4, v21
    s_nop 1
    v_cndmask_b32 v21, v21, 0, vcc
    v_cmp_eq_u32 vcc, v4, v22
    s_nop 1
    v_cndmask_b32 v22, v22, 0, vcc
    v_cmp_eq_u32 vcc, v4, v23
    s_nop 1
    v_cndmask_b32 v23, v23, 0, vcc
    v_cmp_eq_u32 vcc, v4, v24
    s_nop 1
    v_cndmask_b32 v24, v24, 0, vcc
    v_cmp_eq_u32 vcc, v4, v25
    s_nop 1
    v_cndmask_b32 v25, v25, 0, vcc
    v_cmp_eq_u32 vcc, v4, v26
    s_nop 1
    v_cndmask_b32 v26, v26, 0, vcc
    v_cmp_eq_u32 vcc, v4, v27
    s_nop 1
    v_cndmask_b32 v27, v27, 0, vcc
    v_cmp_eq_u32 vcc, v4, v28
    s_nop 1
    v_cndmask_b32 v28, v28, 0, vcc
    v_cmp_eq_u32 vcc, v4, v29
    s_nop 1
    v_cndmask_b32 v29, v29, 0, vcc
    v_cmp_eq_u32 vcc, v4, v30
    s_nop 1
    v_cndmask_b32 v30, v30, 0, vcc
    v_cmp_eq_u32 vcc, v4, v31
    s_nop 1
    v_cndmask_b32 v31, v31, 0, vcc
    v_cmp_eq_u32 vcc, v4, v32
    s_nop 1
    v_cndmask_b32 v32, v32, 0, vcc
    v_cmp_eq_u32 vcc, v4, v33
    s_nop 1
    v_cndmask_b32 v33, v33, 0, vcc
    v_cmp_eq_u32 vcc, v4, v34
    s_nop 1
    v_cndmask_b32 v34, v34, 0, vcc
    v_cmp_eq_u32 vcc, v4, v35
    s_nop 1
    v_cndmask_b32 v35, v35, 0, vcc
    v_cmp_eq_u32 vcc, v4, v36
    s_nop 1
    v_cndmask_b32 v36, v36, 0, vcc
    v_cmp_eq_u32 vcc, v4, v37
    s_nop 1
    v_cndmask_b32 v37, v37, 0, vcc
    v_cmp_eq_u32 vcc, v4, v38
    s_nop 1
    v_cndmask_b32 v38, v38, 0, vcc
    v_cmp_eq_u32 vcc, v4, v39
    s_nop 1
    v_cndmask_b32 v39, v39, 0, vcc
    v_cmp_eq_u32 vcc, v4, v40
    s_nop 1
    v_cndmask_b32 v40, v40, 0, vcc
    v_cmp_eq_u32 vcc, v4, v41
    s_nop 1
    v_cndmask_b32 v41, v41, 0, vcc
    v_cmp_eq_u32 vcc, v4, v42
    s_nop 1
    v_cndmask_b32 v42, v42, 0, vcc
    v_cmp_eq_u32 vcc, v4, v43
    s_nop 1
    v_cndmask_b32 v43, v43, 0, vcc
    v_cmp_eq_u32 vcc, v4, v44
    s_nop 1
    v_cndmask_b32 v44, v44, 0, vcc
    v_cmp_eq_u32 vcc, v4, v45
    s_nop 1
    v_cndmask_b32 v45, v45, 0, vcc
    v_cmp_eq_u32 vcc, v4, v46
    s_nop 1
    v_cndmask_b32 v46, v46, 0, vcc
    v_cmp_eq_u32 vcc, v4, v47
    s_nop 1
    v_cndmask_b32 v47, v47, 0, vcc
    v_max3_u32 v4, v16, v17, v18
    v_max3_u32 v4, v4, v19, v20
    v_max3_u32 v4, v4, v21, v22
    v_max3_u32 v4, v4, v23, v24
    v_max3_u32 v4, v4, v25, v26
    v_max3_u32 v4, v4, v27, v28
    v_max3_u32 v4, v4, v29, v30
    v_max3_u32 v4, v4, v31, v32
    v_max3_u32 v4, v4, v33, v34
    v_max3_u32 v4, v4, v35, v36
    v_max3_u32 v4, v4, v37, v38
    v_max3_u32 v4, v4, v39, v40
    v_max3_u32 v4, v4, v41, v42
    v_max3_u32 v4, v4, v43, v44
    v_max3_u32 v4, v4, v45, v46
    v_max_u32 v4, v4, v47
    s_nop 1
    v_max_u32_dpp v4, v4, v4 quad_perm:[1,0,3,2] row_mask:0xf bank_mask:0xf
    s_nop 1
    v_max_u32_dpp v4, v4, v4 quad_perm:[2,3,0,1] row_mask:0xf bank_mask:0xf
    s_nop 1
    v_max_u32_dpp v4, v4, v4 row_half_mirror row_mask:0xf bank_mask:0xf
    s_nop 1
    v_max_u32_dpp v4, v4, v4 row_mirror row_mask:0xf bank_mask:0xf
    v_mov_b32 v5, v4
    s_nop 1
    v_permlane16_swap_b32 v4, v5
    v_max_u32 v4, v4, v5
    v_mov_b32 v5, v4
    s_nop 1
    v_permlane32_swap_b32 v4, v5
    v_max_u32 v4, v4, v5
    v_mov_b32 v60, v4
    v_cmp_eq_u32 vcc, v4, v16
    s_nop 1
    v_cndmask_b32 v16, v16, 0, vcc
    v_cmp_eq_u32 vcc, v4, v17
    s_nop 1
    v_cndmask_b32 v17, v17, 0, vcc
    v_cmp_eq_u32 vcc, v4, v18
    s_nop 1
    v_cndmask_b32 v18, v18, 0, vcc
    v_cmp_eq_u32 vcc, v4, v19
    s_nop 1
    v_cndmask_b32 v19, v19, 0, vcc
    v_cmp_eq_u32 vcc, v4, v20
    s_nop 1
    v_cndmask_b32 v20, v20, 0, vcc
    v_cmp_eq_u32 vcc, v4, v21
    s_nop 1
    v_cndmask_b32 v21, v21, 0, vcc
    v_cmp_eq_u32 vcc, v4, v22
    s_nop 1
    v_cndmask_b32 v22, v22, 0, vcc
    v_cmp_eq_u32 vcc, v4, v23
    s_nop 1
    v_cndmask_b32 v23, v23, 0, vcc
    v_cmp_eq_u32 vcc, v4, v24
    s_nop 1
    v_cndmask_b32 v24, v24, 0, vcc
    v_cmp_eq_u32 vcc, v4, v25
    s_nop 1
    v_cndmask_b32 v25, v25, 0, vcc
    v_cmp_eq_u32 vcc, v4, v26
    s_nop 1
    v_cndmask_b32 v26, v26, 0, vcc
    v_cmp_eq_u32 vcc, v4, v27
    s_nop 1
    v_cndmask_b32 v27, v27, 0, vcc
    v_cmp_eq_u32 vcc, v4, v28
    s_nop 1
    v_cndmask_b32 v28, v28, 0, vcc
    v_cmp_eq_u32 vcc, v4, v29
    s_nop 1
    v_cndmask_b32 v29, v29, 0, vcc
    v_cmp_eq_u32 vcc, v4, v30
    s_nop 1
    v_cndmask_b32 v30, v30, 0, vcc
    v_cmp_eq_u32 vcc, v4, v31
    s_nop 1
    v_cndmask_b32 v31, v31, 0, vcc
    v_cmp_eq_u32 vcc, v4, v32
    s_nop 1
    v_cndmask_b32 v32, v32, 0, vcc
    v_cmp_eq_u32 vcc, v4, v33
    s_nop 1
    v_cndmask_b32 v33, v33, 0, vcc
    v_cmp_eq_u32 vcc, v4, v34
    s_nop 1
    v_cndmask_b32 v34, v34, 0, vcc
    v_cmp_eq_u32 vcc, v4, v35
    s_nop 1
    v_cndmask_b32 v35, v35, 0, vcc
    v_cmp_eq_u32 vcc, v4, v36
    s_nop 1
    v_cndmask_b32 v36, v36, 0, vcc
    v_cmp_eq_u32 vcc, v4, v37
    s_nop 1
    v_cndmask_b32 v37, v37, 0, vcc
    v_cmp_eq_u32 vcc, v4, v38
    s_nop 1
    v_cndmask_b32 v38, v38, 0, vcc
    v_cmp_eq_u32 vcc, v4, v39
    s_nop 1
    v_cndmask_b32 v39, v39, 0, vcc
    v_cmp_eq_u32 vcc, v4, v40
    s_nop 1
    v_cndmask_b32 v40, v40, 0, vcc
    v_cmp_eq_u32 vcc, v4, v41
    s_nop 1
    v_cndmask_b32 v41, v41, 0, vcc
    v_cmp_eq_u32 vcc, v4, v42
    s_nop 1
    v_cndmask_b32 v42, v42, 0, vcc
    v_cmp_eq_u32 vcc, v4, v43
    s_nop 1
    v_cndmask_b32 v43, v43, 0, vcc
    v_cmp_eq_u32 vcc, v4, v44
    s_nop 1
    v_cndmask_b32 v44, v44, 0, vcc
    v_cmp_eq_u32 vcc, v4, v45
    s_nop 1
    v_cndmask_b32 v45, v45, 0, vcc
    v_cmp_eq_u32 vcc, v4, v46
    s_nop 1
    v_cndmask_b32 v46, v46, 0, vcc
    v_cmp_eq_u32 vcc, v4, v47
    s_nop 1
    v_cndmask_b32 v47, v47, 0, vcc
    v_max3_u32 v4, v16, v17, v18
    v_max3_u32 v4, v4, v19, v20
    v_max3_u32 v4, v4, v21, v22
    v_max3_u32 v4, v4, v23, v24
    v_max3_u32 v4, v4, v25, v26
    v_max3_u32 v4, v4, v27, v28
    v_max3_u32 v4, v4, v29, v30
    v_max3_u32 v4, v4, v31, v32
    v_max3_u32 v4, v4, v33, v34
    v_max3_u32 v4, v4, v35, v36
    v_max3_u32 v4, v4, v37, v38
    v_max3_u32 v4, v4, v39, v40
    v_max3_u32 v4, v4, v41, v42
    v_max3_u32 v4, v4, v43, v44
    v_max3_u32 v4, v4, v45, v46
    v_max_u32 v4, v4, v47
    s_nop 1
    v_max_u32_dpp v4, v4, v4 quad_perm:[1,0,3,2] row_mask:0xf bank_mask:0xf
    s_nop 1
    v_max_u32_dpp v4, v4, v4 quad_perm:[2,3,0,1] row_mask:0xf bank_mask:0xf
    s_nop 1
    v_max_u32_dpp v4, v4, v4 row_half_mirror row_mask:0xf bank_mask:0xf
    s_nop 1
    v_max_u32_dpp v4, v4, v4 row_mirror row_mask:0xf bank_mask:0xf
    v_mov_b32 v5, v4
    s_nop 1
    v_permlane16_swap_b32 v4, v5
    v_max_u32 v4, v4, v5
    v_mov_b32 v5, v4
    s_nop 1
    v_permlane32_swap_b32 v4, v5
    v_max_u32 v4, v4, v5
    v_mov_b32 v61, v4
    v_cmp_eq_u32 vcc, v4, v16
    s_nop 1
    v_cndmask_b32 v16, v16, 0, vcc
    v_cmp_eq_u32 vcc, v4, v17
    s_nop 1
    v_cndmask_b32 v17, v17, 0, vcc
    v_cmp_eq_u32 vcc, v4, v18
    s_nop 1
    v_cndmask_b32 v18, v18, 0, vcc
    v_cmp_eq_u32 vcc, v4, v19
    s_nop 1
    v_cndmask_b32 v19, v19, 0, vcc
    v_cmp_eq_u32 vcc, v4, v20
    s_nop 1
    v_cndmask_b32 v20, v20, 0, vcc
    v_cmp_eq_u32 vcc, v4, v21
    s_nop 1
    v_cndmask_b32 v21, v21, 0, vcc
    v_cmp_eq_u32 vcc, v4, v22
    s_nop 1
    v_cndmask_b32 v22, v22, 0, vcc
    v_cmp_eq_u32 vcc, v4, v23
    s_nop 1
    v_cndmask_b32 v23, v23, 0, vcc
    v_cmp_eq_u32 vcc, v4, v24
    s_nop 1
    v_cndmask_b32 v24, v24, 0, vcc
    v_cmp_eq_u32 vcc, v4, v25
    s_nop 1
    v_cndmask_b32 v25, v25, 0, vcc
    v_cmp_eq_u32 vcc, v4, v26
    s_nop 1
    v_cndmask_b32 v26, v26, 0, vcc
    v_cmp_eq_u32 vcc, v4, v27
    s_nop 1
    v_cndmask_b32 v27, v27, 0, vcc
    v_cmp_eq_u32 vcc, v4, v28
    s_nop 1
    v_cndmask_b32 v28, v28, 0, vcc
    v_cmp_eq_u32 vcc, v4, v29
    s_nop 1
    v_cndmask_b32 v29, v29, 0, vcc
    v_cmp_eq_u32 vcc, v4, v30
    s_nop 1
    v_cndmask_b32 v30, v30, 0, vcc
    v_cmp_eq_u32 vcc, v4, v31
    s_nop 1
    v_cndmask_b32 v31, v31, 0, vcc
    v_cmp_eq_u32 vcc, v4, v32
    s_nop 1
    v_cndmask_b32 v32, v32, 0, vcc
    v_cmp_eq_u32 vcc, v4, v33
    s_nop 1
    v_cndmask_b32 v33, v33, 0, vcc
    v_cmp_eq_u32 vcc, v4, v34
    s_nop 1
    v_cndmask_b32 v34, v34, 0, vcc
    v_cmp_eq_u32 vcc, v4, v35
    s_nop 1
    v_cndmask_b32 v35, v35, 0, vcc
    v_cmp_eq_u32 vcc, v4, v36
    s_nop 1
    v_cndmask_b32 v36, v36, 0, vcc
    v_cmp_eq_u32 vcc, v4, v37
    s_nop 1
    v_cndmask_b32 v37, v37, 0, vcc
    v_cmp_eq_u32 vcc, v4, v38
    s_nop 1
    v_cndmask_b32 v38, v38, 0, vcc
    v_cmp_eq_u32 vcc, v4, v39
    s_nop 1
    v_cndmask_b32 v39, v39, 0, vcc
    v_cmp_eq_u32 vcc, v4, v40
    s_nop 1
    v_cndmask_b32 v40, v40, 0, vcc
    v_cmp_eq_u32 vcc, v4, v41
    s_nop 1
    v_cndmask_b32 v41, v41, 0, vcc
    v_cmp_eq_u32 vcc, v4, v42
    s_nop 1
    v_cndmask_b32 v42, v42, 0, vcc
    v_cmp_eq_u32 vcc, v4, v43
    s_nop 1
    v_cndmask_b32 v43, v43, 0, vcc
    v_cmp_eq_u32 vcc, v4, v44
    s_nop 1
    v_cndmask_b32 v44, v44, 0, vcc
    v_cmp_eq_u32 vcc, v4, v45
    s_nop 1
    v_cndmask_b32 v45, v45, 0, vcc
    v_cmp_eq_u32 vcc, v4, v46
    s_nop 1
    v_cndmask_b32 v46, v46, 0, vcc
    v_cmp_eq_u32 vcc, v4, v47
    s_nop 1
    v_cndmask_b32 v47, v47, 0, vcc
    v_max3_u32 v4, v16, v17, v18
    v_max3_u32 v4, v4, v19, v20
    v_max3_u32 v4, v4, v21, v22
    v_max3_u32 v4, v4, v23, v24
    v_max3_u32 v4, v4, v25, v26
    v_max3_u32 v4, v4, v27, v28
    v_max3_u32 v4, v4, v29, v30
    v_max3_u32 v4, v4, v31, v32
    v_max3_u32 v4, v4, v33, v34
    v_max3_u32 v4, v4, v35, v36
    v_max3_u32 v4, v4, v37, v38
    v_max3_u32 v4, v4, v39, v40
    v_max3_u32 v4, v4, v41, v42
    v_max3_u32 v4, v4, v43, v44
    v_max3_u32 v4, v4, v45, v46
    v_max_u32 v4, v4, v47
    s_nop 1
    v_max_u32_dpp v4, v4, v4 quad_perm:[1,0,3,2] row_mask:0xf bank_mask:0xf
    s_nop 1
    v_max_u32_dpp v4, v4, v4 quad_perm:[2,3,0,1] row_mask:0xf bank_mask:0xf
    s_nop 1
    v_max_u32_dpp v4, v4, v4 row_half_mirror row_mask:0xf bank_mask:0xf
    s_nop 1
    v_max_u32_dpp v4, v4, v4 row_mirror row_mask:0xf bank_mask:0xf
    v_mov_b32 v5, v4
    s_nop 1
    v_permlane16_swap_b32 v4, v5
    v_max_u32 v4, v4, v5
    v_mov_b32 v5, v4
    s_nop 1
    v_permlane32_swap_b32 v4, v5
    v_max_u32 v4, v4, v5
    v_mov_b32 v62, v4
    v_cmp_eq_u32 vcc, v4, v16
    s_nop 1
    v_cndmask_b32 v16, v16, 0, vcc
    v_cmp_eq_u32 vcc, v4, v17
    s_nop 1
    v_cndmask_b32 v17, v17, 0, vcc
    v_cmp_eq_u32 vcc, v4, v18
    s_nop 1
    v_cndmask_b32 v18, v18, 0, vcc
    v_cmp_eq_u32 vcc, v4, v19
    s_nop 1
    v_cndmask_b32 v19, v19, 0, vcc
    v_cmp_eq_u32 vcc, v4, v20
    s_nop 1
    v_cndmask_b32 v20, v20, 0, vcc
    v_cmp_eq_u32 vcc, v4, v21
    s_nop 1
    v_cndmask_b32 v21, v21, 0, vcc
    v_cmp_eq_u32 vcc, v4, v22
    s_nop 1
    v_cndmask_b32 v22, v22, 0, vcc
    v_cmp_eq_u32 vcc, v4, v23
    s_nop 1
    v_cndmask_b32 v23, v23, 0, vcc
    v_cmp_eq_u32 vcc, v4, v24
    s_nop 1
    v_cndmask_b32 v24, v24, 0, vcc
    v_cmp_eq_u32 vcc, v4, v25
    s_nop 1
    v_cndmask_b32 v25, v25, 0, vcc
    v_cmp_eq_u32 vcc, v4, v26
    s_nop 1
    v_cndmask_b32 v26, v26, 0, vcc
    v_cmp_eq_u32 vcc, v4, v27
    s_nop 1
    v_cndmask_b32 v27, v27, 0, vcc
    v_cmp_eq_u32 vcc, v4, v28
    s_nop 1
    v_cndmask_b32 v28, v28, 0, vcc
    v_cmp_eq_u32 vcc, v4, v29
    s_nop 1
    v_cndmask_b32 v29, v29, 0, vcc
    v_cmp_eq_u32 vcc, v4, v30
    s_nop 1
    v_cndmask_b32 v30, v30, 0, vcc
    v_cmp_eq_u32 vcc, v4, v31
    s_nop 1
    v_cndmask_b32 v31, v31, 0, vcc
    v_cmp_eq_u32 vcc, v4, v32
    s_nop 1
    v_cndmask_b32 v32, v32, 0, vcc
    v_cmp_eq_u32 vcc, v4, v33
    s_nop 1
    v_cndmask_b32 v33, v33, 0, vcc
    v_cmp_eq_u32 vcc, v4, v34
    s_nop 1
    v_cndmask_b32 v34, v34, 0, vcc
    v_cmp_eq_u32 vcc, v4, v35
    s_nop 1
    v_cndmask_b32 v35, v35, 0, vcc
    v_cmp_eq_u32 vcc, v4, v36
    s_nop 1
    v_cndmask_b32 v36, v36, 0, vcc
    v_cmp_eq_u32 vcc, v4, v37
    s_nop 1
    v_cndmask_b32 v37, v37, 0, vcc
    v_cmp_eq_u32 vcc, v4, v38
    s_nop 1
    v_cndmask_b32 v38, v38, 0, vcc
    v_cmp_eq_u32 vcc, v4, v39
    s_nop 1
    v_cndmask_b32 v39, v39, 0, vcc
    v_cmp_eq_u32 vcc, v4, v40
    s_nop 1
    v_cndmask_b32 v40, v40, 0, vcc
    v_cmp_eq_u32 vcc, v4, v41
    s_nop 1
    v_cndmask_b32 v41, v41, 0, vcc
    v_cmp_eq_u32 vcc, v4, v42
    s_nop 1
    v_cndmask_b32 v42, v42, 0, vcc
    v_cmp_eq_u32 vcc, v4, v43
    s_nop 1
    v_cndmask_b32 v43, v43, 0, vcc
    v_cmp_eq_u32 vcc, v4, v44
    s_nop 1
    v_cndmask_b32 v44, v44, 0, vcc
    v_cmp_eq_u32 vcc, v4, v45
    s_nop 1
    v_cndmask_b32 v45, v45, 0, vcc
    v_cmp_eq_u32 vcc, v4, v46
    s_nop 1
    v_cndmask_b32 v46, v46, 0, vcc
    v_cmp_eq_u32 vcc, v4, v47
    s_nop 1
    v_cndmask_b32 v47, v47, 0, vcc
    v_max3_u32 v4, v16, v17, v18
    v_max3_u32 v4, v4, v19, v20
    v_max3_u32 v4, v4, v21, v22
    v_max3_u32 v4, v4, v23, v24
    v_max3_u32 v4, v4, v25, v26
    v_max3_u32 v4, v4, v27, v28
    v_max3_u32 v4, v4, v29, v30
    v_max3_u32 v4, v4, v31, v32
    v_max3_u32 v4, v4, v33, v34
    v_max3_u32 v4, v4, v35, v36
    v_max3_u32 v4, v4, v37, v38
    v_max3_u32 v4, v4, v39, v40
    v_max3_u32 v4, v4, v41, v42
    v_max3_u32 v4, v4, v43, v44
    v_max3_u32 v4, v4, v45, v46
    v_max_u32 v4, v4, v47
    s_nop 1
    v_max_u32_dpp v4, v4, v4 quad_perm:[1,0,3,2] row_mask:0xf bank_mask:0xf
    s_nop 1
    v_max_u32_dpp v4, v4, v4 quad_perm:[2,3,0,1] row_mask:0xf bank_mask:0xf
    s_nop 1
    v_max_u32_dpp v4, v4, v4 row_half_mirror row_mask:0xf bank_mask:0xf
    s_nop 1
    v_max_u32_dpp v4, v4, v4 row_mirror row_mask:0xf bank_mask:0xf
    v_mov_b32 v5, v4
    s_nop 1
    v_permlane16_swap_b32 v4, v5
    v_max_u32 v4, v4, v5
    v_mov_b32 v5, v4
    s_nop 1
    v_permlane32_swap_b32 v4, v5
    v_max_u32 v4, v4, v5
    v_mov_b32 v63, v4
    v_mov_b32 v4, v56
    v_cmp_eq_u32 vcc, 1, v0
    s_nop 1
    v_cndmask_b32 v4, v4, v57, vcc
    v_cmp_eq_u32 vcc, 2, v0
    s_nop 1
    v_cndmask_b32 v4, v4, v58, vcc
    v_cmp_eq_u32 vcc, 3, v0
    s_nop 1
    v_cndmask_b32 v4, v4, v59, vcc
    v_cmp_eq_u32 vcc, 4, v0
    s_nop 1
    v_cndmask_b32 v4, v4, v60, vcc
    v_cmp_eq_u32 vcc, 5, v0
    s_nop 1
    v_cndmask_b32 v4, v4, v61, vcc
    v_cmp_eq_u32 vcc, 6, v0
    s_nop 1
    v_cndmask_b32 v4, v4, v62, vcc
    v_cmp_eq_u32 vcc, 7, v0
    s_nop 1
    v_cndmask_b32 v4, v4, v63, vcc
    v_and_b32 v5, 0xffff, v4
    v_sub_u32 v5, 0xffff, v5
    v_and_b32 v4, 0xffff0000, v4
    v_ashrrev_i32 v3, 31, v4
    v_not_b32 v3, v3
    v_or_b32 v3, 0x80000000, v3
    v_xor_b32 v4, v4, v3
    v_and_b32 v4, 0xffff0000, v4
    v_mul_f32 v4, 0xbfb8aa3b, v4
    v_exp_f32 v4, v4
    s_nop 0
    v_add_f32 v4, 1.0, v4
    v_rcp_f32 v4, v4
    s_nop 0
    v_cvt_pk_bf16_f32 v4, v4, v4
    v_lshlrev_b32 v4, 16, v4
    v_lshlrev_b32 v6, 2, v0
    s_mov_b32 s64, 0x5400000
    s_mov_b64 exec, 0xff
    buffer_store_dword v5, v6, s[4:7], s64 offen sc1
    buffer_store_dword v4, v6, s[4:7], s64 offen offset:32 sc1
    s_mov_b64 exec, -1
    s_waitcnt vmcnt(0)
    v_mov_b32 v7, 1
    v_mov_b32 v8, 0
    s_mov_b32 s64, 0x298000
    s_mov_b64 exec, 1
    buffer_atomic_add v7, v8, s[4:7], s64 offen sc1
    s_mov_b64 exec, -1
    v_mbcnt_lo_u32_b32 v0, -1, 0
    v_mbcnt_hi_u32_b32 v0, -1, v0
NOSEL_100:
    v_lshlrev_b32 v1, 4, v0
    v_lshrrev_b32 v6, 3, v0
    v_mul_u32_u24 v2, 1280, v6
    v_and_b32 v7, 7, v0
    v_xor_b32 v7, v7, v6
    v_lshl_add_u32 v2, v7, 4, v2
    v_bfe_u32 v6, v0, 3, 1
    v_lshlrev_b32 v9, 10, v6
    v_and_b32 v6, 7, v0
    v_lshl_add_u32 v9, v6, 7, v9
    v_lshrrev_b32 v7, 4, v0
    v_xor_b32 v7, v7, v6
    v_lshl_add_u32 v3, v7, 4, v9
    v_xor_b32 v7, 4, v7
    v_lshl_add_u32 v4, v7, 4, v9
    v_add_u32 v6, 0x10000, v3
    v_add_u32 v9, 0x10000, v4
    s_barrier
    s_mul_i32 s20, s12, 163840
    s_mul_i32 s64, s14, 40960
    s_add_u32 s20, s20, s64
    s_add_u32 s20, s20, 0x0
    s_lshl_b32 s21, s14, 12
    s_add_u32 m0, s21, 0
    s_add_u32 s64, s20, 0x0
    buffer_load_dwordx4 v2, s[4:7], s64 offen lds
    s_add_u32 m0, s21, 1024
    s_add_u32 s64, s20, 0x2800
    buffer_load_dwordx4 v2, s[4:7], s64 offen lds
    s_add_u32 m0, s21, 2048
    s_add_u32 s64, s20, 0x5000
    buffer_load_dwordx4 v2, s[4:7], s64 offen lds
    s_add_u32 m0, s21, 3072
    s_add_u32 s64, s20, 0x7800
    buffer_load_dwordx4 v2, s[4:7], s64 offen lds
    s_add_u32 m0, s21, 16384
    s_add_u32 s64, s20, 0x80
    buffer_load_dwordx4 v2, s[4:7], s64 offen lds
    s_add_u32 m0, s21, 17408
    s_add_u32 s64, s20, 0x2880
    buffer_load_dwordx4 v2, s[4:7], s64 offen lds
    s_add_u32 m0, s21, 18432
    s_add_u32 s64, s20, 0x5080
    buffer_load_dwordx4 v2, s[4:7], s64 offen lds
    s_add_u32 m0, s21, 19456
    s_add_u32 s64, s20, 0x7880
    buffer_load_dwordx4 v2, s[4:7], s64 offen lds
    s_add_u32 m0, s21, 32768
    s_add_u32 s64, s20, 0x100
    buffer_load_dwordx4 v2, s[4:7], s64 offen lds
    s_add_u32 m0, s21, 33792
    s_add_u32 s64, s20, 0x2900
    buffer_load_dwordx4 v2, s[4:7], s64 offen lds
    s_add_u32 m0, s21, 34816
    s_add_u32 s64, s20, 0x5100
    buffer_load_dwordx4 v2, s[4:7], s64 offen lds
    s_add_u32 m0, s21, 35840
    s_add_u32 s64, s20, 0x7900
    buffer_load_dwordx4 v2, s[4:7], s64 offen lds
    s_add_u32 m0, s21, 49152
    s_add_u32 s64, s20, 0x180
    buffer_load_dwordx4 v2, s[4:7], s64 offen lds
    s_add_u32 m0, s21, 50176
    s_add_u32 s64, s20, 0x2980
    buffer_load_dwordx4 v2, s[4:7], s64 offen lds
    s_add_u32 m0, s21, 51200
    s_add_u32 s64, s20, 0x5180
    buffer_load_dwordx4 v2, s[4:7], s64 offen lds
    s_add_u32 m0, s21, 52224
    s_add_u32 s64, s20, 0x7980
    buffer_load_dwordx4 v2, s[4:7], s64 offen lds
    s_mov_b32 s64, 0x40000000
    buffer_store_dword v7, v1, s[4:7], s64 offen
    buffer_store_dword v7, v1, s[4:7], s64 offen
    buffer_store_dword v7, v1, s[4:7], s64 offen
    buffer_store_dword v7, v1, s[4:7], s64 offen
    buffer_store_dword v7, v1, s[4:7], s64 offen
    buffer_store_dword v7, v1, s[4:7], s64 offen
    buffer_store_dword v7, v1, s[4:7], s64 offen
    buffer_store_dword v7, v1, s[4:7], s64 offen
    s_waitcnt vmcnt(20)
    s_barrier
    ds_read_b128 a[0:3], v3 offset:0
    ds_read_b128 a[4:7], v3 offset:2048
    ds_read_b128 a[8:11], v3 offset:4096
    ds_read_b128 a[12:15], v3 offset:6144
    ds_read_b128 a[16:19], v3 offset:8192
    ds_read_b128 a[20:23], v3 offset:10240
    ds_read_b128 a[24:27], v3 offset:12288
    ds_read_b128 a[28:31], v3 offset:14336
    s_mov_b32 s19, 0
    s_mov_b32 s22, s16
    s_mov_b32 s23, 0x40000000
G_T_LOOP:
    s_waitcnt lgkmcnt(4)
    v_mfma_f32_16x16x32_bf16 v[16:19], v[96:99], a[0:3], 0
    v_mfma_f32_16x16x32_bf16 v[20:23], v[100:103], a[0:3], 0
    ds_read_b128 a[32:35], v4 offset:0
    v_mfma_f32_16x16x32_bf16 v[24:27], v[96:99], a[4:7], 0
    v_mfma_f32_16x16x32_bf16 v[28:31], v[100:103], a[4:7], 0
    ds_read_b128 a[36:39], v4 offset:2048
    v_mfma_f32_16x16x32_bf16 v[32:35], v[96:99], a[8:11], 0
    v_mfma_f32_16x16x32_bf16 v[36:39], v[100:103], a[8:11], 0
    ds_read_b128 a[40:43], v4 offset:4096
    v_mfma_f32_16x16x32_bf16 v[40:43], v[96:99], a[12:15], 0
    v_mfma_f32_16x16x32_bf16 v[44:47], v[100:103], a[12:15], 0
    ds_read_b128 a[44:47], v4 offset:6144
    s_waitcnt lgkmcnt(4)
    v_mfma_f32_16x16x32_bf16 v[48:51], v[96:99], a[16:19], 0
    v_mfma_f32_16x16x32_bf16 v[52:55], v[100:103], a[16:19], 0
    ds_read_b128 a[48:51], v4 offset:8192
    v_mfma_f32_16x16x32_bf16 v[56:59], v[96:99], a[20:23], 0
    v_mfma_f32_16x16x32_bf16 v[60:63], v[100:103], a[20:23], 0
    ds_read_b128 a[52:55], v4 offset:10240
    v_mfma_f32_16x16x32_bf16 v[64:67], v[96:99], a[24:27], 0
    v_mfma_f32_16x16x32_bf16 v[68:71], v[100:103], a[24:27], 0
    ds_read_b128 a[56:59], v4 offset:12288
    v_mfma_f32_16x16x32_bf16 v[72:75], v[96:99], a[28:31], 0
    v_mfma_f32_16x16x32_bf16 v[76:79], v[100:103], a[28:31], 0
    ds_read_b128 a[60:63], v4 offset:14336
    s_waitcnt vmcnt(16)
    s_barrier
    s_waitcnt lgkmcnt(4)
    v_mfma_f32_16x16x32_bf16 v[16:19], v[104:107], a[32:35], v[16:19]
    v_mfma_f32_16x16x32_bf16 v[20:23], v[108:111], a[32:35], v[20:23]
    ds_read_b128 a[0:3], v3 offset:16384
    s_add_u32 m0, s21, 65536
    v_mfma_f32_16x16x32_bf16 v[24:27], v[104:107], a[36:39], v[24:27]
    v_mfma_f32_16x16x32_bf16 v[28:31], v[108:111], a[36:39], v[28:31]
    ds_read_b128 a[4:7], v3 offset:18432
    s_add_u32 s64, s20, 0x200
    buffer_load_dwordx4 v2, s[4:7], s64 offen lds
    v_mfma_f32_16x16x32_bf16 v[32:35], v[104:107], a[40:43], v[32:35]
    v_mfma_f32_16x16x32_bf16 v[36:39], v[108:111], a[40:43], v[36:39]
    ds_read_b128 a[8:11], v3 offset:20480
    s_add_u32 m0, s21, 66560
    v_mfma_f32_16x16x32_bf16 v[40:43], v[104:107], a[44:47], v[40:43]
    v_mfma_f32_16x16x32_bf16 v[44:47], v[108:111], a[44:47], v[44:47]
    ds_read_b128 a[12:15], v3 offset:22528
    s_add_u32 s64, s20, 0x2a00
    buffer_load_dwordx4 v2, s[4:7], s64 offen lds
    s_waitcnt lgkmcnt(4)
    v_mfma_f32_16x16x32_bf16 v[48:51], v[104:107], a[48:51], v[48:51]
    v_mfma_f32_16x16x32_bf16 v[52:55], v[108:111], a[48:51], v[52:55]
    ds_read_b128 a[16:19], v3 offset:24576
    s_add_u32 m0, s21, 67584
    v_mfma_f32_16x16x32_bf16 v[56:59], v[104:107], a[52:55], v[56:59]
    v_mfma_f32_16x16x32_bf16 v[60:63], v[108:111], a[52:55], v[60:63]
    ds_read_b128 a[20:23], v3 offset:26624
    s_add_u32 s64, s20, 0x5200
    buffer_load_dwordx4 v2, s[4:7], s64 offen lds
    v_mfma_f32_16x16x32_bf16 v[64:67], v[104:107], a[56:59], v[64:67]
    v_mfma_f32_16x16x32_bf16 v[68:71], v[108:111], a[56:59], v[68:71]
    ds_read_b128 a[24:27], v3 offset:28672
    s_add_u32 m0, s21, 68608
    v_mfma_f32_16x16x32_bf16 v[72:75], v[104:107], a[60:63], v[72:75]
    v_mfma_f32_16x16x32_bf16 v[76:79], v[108:111], a[60:63], v[76:79]
    ds_read_b128 a[28:31], v3 offset:30720
    s_add_u32 s64, s20, 0x7a00
    buffer_load_dwordx4 v2, s[4:7], s64 offen lds
    s_waitcnt lgkmcnt(4)
    v_mfma_f32_16x16x32_bf16 v[16:19], v[112:115], a[0:3], v[16:19]
    v_mfma_f32_16x16x32_bf16 v[20:23], v[116:119], a[0:3], v[20:23]
    ds_read_b128 a[32:35], v4 offset:16384
    v_mfma_f32_16x16x32_bf16 v[24:27], v[112:115], a[4:7], v[24:27]
    v_mfma_f32_16x16x32_bf16 v[28:31], v[116:119], a[4:7], v[28:31]
    ds_read_b128 a[36:39], v4 offset:18432
    v_mfma_f32_16x16x32_bf16 v[32:35], v[112:115], a[8:11], v[32:35]
    v_mfma_f32_16x16x32_bf16 v[36:39], v[116:119], a[8:11], v[36:39]
    ds_read_b128 a[40:43], v4 offset:20480
    v_mfma_f32_16x16x32_bf16 v[40:43], v[112:115], a[12:15], v[40:43]
    v_mfma_f32_16x16x32_bf16 v[44:47], v[116:119], a[12:15], v[44:47]
    ds_read_b128 a[44:47], v4 offset:22528
    s_waitcnt lgkmcnt(4)
    v_mfma_f32_16x16x32_bf16 v[48:51], v[112:115], a[16:19], v[48:51]
    v_mfma_f32_16x16x32_bf16 v[52:55], v[116:119], a[16:19], v[52:55]
    ds_read_b128 a[48:51], v4 offset:24576
    v_mfma_f32_16x16x32_bf16 v[56:59], v[112:115], a[20:23], v[56:59]
    v_mfma_f32_16x16x32_bf16 v[60:63], v[116:119], a[20:23], v[60:63]
    ds_read_b128 a[52:55], v4 offset:26624
    v_mfma_f32_16x16x32_bf16 v[64:67], v[112:115], a[24:27], v[64:67]
    v_mfma_f32_16x16x32_bf16 v[68:71], v[116:119], a[24:27], v[68:71]
    ds_read_b128 a[56:59], v4 offset:28672
    v_mfma_f32_16x16x32_bf16 v[72:75], v[112:115], a[28:31], v[72:75]
    v_mfma_f32_16x16x32_bf16 v[76:79], v[116:119], a[28:31], v[76:79]
    ds_read_b128 a[60:63], v4 offset:30720
    s_waitcnt vmcnt(16)
    s_barrier
    s_waitcnt lgkmcnt(4)
    v_mfma_f32_16x16x32_bf16 v[16:19], v[120:123], a[32:35], v[16:19]
    v_mfma_f32_16x16x32_bf16 v[20:23], v[124:127], a[32:35], v[20:23]
    ds_read_b128 a[0:3], v3 offset:32768
    s_add_u32 m0, s21, 0
    v_mfma_f32_16x16x32_bf16 v[24:27], v[120:123], a[36:39], v[24:27]
    v_mfma_f32_16x16x32_bf16 v[28:31], v[124:127], a[36:39], v[28:31]
    ds_read_b128 a[4:7], v3 offset:34816
    s_add_u32 s64, s20, 0x280
    buffer_load_dwordx4 v2, s[4:7], s64 offen lds
    v_mfma_f32_16x16x32_bf16 v[32:35], v[120:123], a[40:43], v[32:35]
    v_mfma_f32_16x16x32_bf16 v[36:39], v[124:127], a[40:43], v[36:39]
    ds_read_b128 a[8:11], v3 offset:36864
    s_add_u32 m0, s21, 1024
    v_mfma_f32_16x16x32_bf16 v[40:43], v[120:123], a[44:47], v[40:43]
    v_mfma_f32_16x16x32_bf16 v[44:47], v[124:127], a[44:47], v[44:47]
    ds_read_b128 a[12:15], v3 offset:38912
    s_add_u32 s64, s20, 0x2a80
    buffer_load_dwordx4 v2, s[4:7], s64 offen lds
    s_waitcnt lgkmcnt(4)
    v_mfma_f32_16x16x32_bf16 v[48:51], v[120:123], a[48:51], v[48:51]
    v_mfma_f32_16x16x32_bf16 v[52:55], v[124:127], a[48:51], v[52:55]
    ds_read_b128 a[16:19], v3 offset:40960
    s_add_u32 m0, s21, 2048
    v_mfma_f32_16x16x32_bf16 v[56:59], v[120:123], a[52:55], v[56:59]
    v_mfma_f32_16x16x32_bf16 v[60:63], v[124:127], a[52:55], v[60:63]
    ds_read_b128 a[20:23], v3 offset:43008
    s_add_u32 s64, s20, 0x5280
    buffer_load_dwordx4 v2, s[4:7], s64 offen lds
    v_mfma_f32_16x16x32_bf16 v[64:67], v[120:123], a[56:59], v[64:67]
    v_mfma_f32_16x16x32_bf16 v[68:71], v[124:127], a[56:59], v[68:71]
    ds_read_b128 a[24:27], v3 offset:45056
    s_add_u32 m0, s21, 3072
    v_mfma_f32_16x16x32_bf16 v[72:75], v[120:123], a[60:63], v[72:75]
    v_mfma_f32_16x16x32_bf16 v[76:79], v[124:127], a[60:63], v[76:79]
    ds_read_b128 a[28:31], v3 offset:47104
    s_add_u32 s64, s20, 0x7a80
    buffer_load_dwordx4 v2, s[4:7], s64 offen lds
    s_waitcnt lgkmcnt(4)
    v_mfma_f32_16x16x32_bf16 v[16:19], v[128:131], a[0:3], v[16:19]
    v_mfma_f32_16x16x32_bf16 v[20:23], v[132:135], a[0:3], v[20:23]
    ds_read_b128 a[32:35], v4 offset:32768
    v_mfma_f32_16x16x32_bf16 v[24:27], v[128:131], a[4:7], v[24:27]
    v_mfma_f32_16x16x32_bf16 v[28:31], v[132:135], a[4:7], v[28:31]
    ds_read_b128 a[36:39], v4 offset:34816
    v_mfma_f32_16x16x32_bf16 v[32:35], v[128:131], a[8:11], v[32:35]
    v_mfma_f32_16x16x32_bf16 v[36:39], v[132:135], a[8:11], v[36:39]
    ds_read_b128 a[40:43], v4 offset:36864
    v_mfma_f32_16x16x32_bf16 v[40:43], v[128:131], a[12:15], v[40:43]
    v_mfma_f32_16x16x32_bf16 v[44:47], v[132:135], a[12:15], v[44:47]
    ds_read_b128 a[44:47], v4 offset:38912
    s_waitcnt lgkmcnt(4)
    v_mfma_f32_16x16x32_bf16 v[48:51], v[128:131], a[16:19], v[48:51]
    v_mfma_f32_16x16x32_bf16 v[52:55], v[132:135], a[16:19], v[52:55]
    ds_read_b128 a[48:51], v4 offset:40960
    v_mfma_f32_16x16x32_bf16 v[56:59], v[128:131], a[20:23], v[56:59]
    v_mfma_f32_16x16x32_bf16 v[60:63], v[132:135], a[20:23], v[60:63]
    ds_read_b128 a[52:55], v4 offset:43008
    v_mfma_f32_16x16x32_bf16 v[64:67], v[128:131], a[24:27], v[64:67]
    v_mfma_f32_16x16x32_bf16 v[68:71], v[132:135], a[24:27], v[68:71]
    ds_read_b128 a[56:59], v4 offset:45056
    v_mfma_f32_16x16x32_bf16 v[72:75], v[128:131], a[28:31], v[72:75]
    v_mfma_f32_16x16x32_bf16 v[76:79], v[132:135], a[28:31], v[76:79]
    ds_read_b128 a[60:63], v4 offset:47104
    s_waitcnt vmcnt(16)
    s_barrier
    s_waitcnt lgkmcnt(4)
    v_mfma_f32_16x16x32_bf16 v[16:19], v[136:139], a[32:35], v[16:19]
    v_mfma_f32_16x16x32_bf16 v[20:23], v[140:143], a[32:35], v[20:23]
    ds_read_b128 a[0:3], v3 offset:49152
    s_add_u32 m0, s21, 16384
    v_mfma_f32_16x16x32_bf16 v[24:27], v[136:139], a[36:39], v[24:27]
    v_mfma_f32_16x16x32_bf16 v[28:31], v[140:143], a[36:39], v[28:31]
    ds_read_b128 a[4:7], v3 offset:51200
    s_add_u32 s64, s20, 0x300
    buffer_load_dwordx4 v2, s[4:7], s64 offen lds
    v_mfma_f32_16x16x32_bf16 v[32:35], v[136:139], a[40:43], v[32:35]
    v_mfma_f32_16x16x32_bf16 v[36:39], v[140:143], a[40:43], v[36:39]
    ds_read_b128 a[8:11], v3 offset:53248
    s_add_u32 m0, s21, 17408
    v_mfma_f32_16x16x32_bf16 v[40:43], v[136:139], a[44:47], v[40:43]
    v_mfma_f32_16x16x32_bf16 v[44:47], v[140:143], a[44:47], v[44:47]
    ds_read_b128 a[12:15], v3 offset:55296
    s_add_u32 s64, s20, 0x2b00
    buffer_load_dwordx4 v2, s[4:7], s64 offen lds
    s_waitcnt lgkmcnt(4)
    v_mfma_f32_16x16x32_bf16 v[48:51], v[136:139], a[48:51], v[48:51]
    v_mfma_f32_16x16x32_bf16 v[52:55], v[140:143], a[48:51], v[52:55]
    ds_read_b128 a[16:19], v3 offset:57344
    s_add_u32 m0, s21, 18432
    v_mfma_f32_16x16x32_bf16 v[56:59], v[136:139], a[52:55], v[56:59]
    v_mfma_f32_16x16x32_bf16 v[60:63], v[140:143], a[52:55], v[60:63]
    ds_read_b128 a[20:23], v3 offset:59392
    s_add_u32 s64, s20, 0x5300
    buffer_load_dwordx4 v2, s[4:7], s64 offen lds
    v_mfma_f32_16x16x32_bf16 v[64:67], v[136:139], a[56:59], v[64:67]
    v_mfma_f32_16x16x32_bf16 v[68:71], v[140:143], a[56:59], v[68:71]
    ds_read_b128 a[24:27], v3 offset:61440
    s_add_u32 m0, s21, 19456
    v_mfma_f32_16x16x32_bf16 v[72:75], v[136:139], a[60:63], v[72:75]
    v_mfma_f32_16x16x32_bf16 v[76:79], v[140:143], a[60:63], v[76:79]
    ds_read_b128 a[28:31], v3 offset:63488
    s_add_u32 s64, s20, 0x7b00
    buffer_load_dwordx4 v2, s[4:7], s64 offen lds
    s_waitcnt lgkmcnt(4)
    v_mfma_f32_16x16x32_bf16 v[16:19], v[144:147], a[0:3], v[16:19]
    v_mfma_f32_16x16x32_bf16 v[20:23], v[148:151], a[0:3], v[20:23]
    ds_read_b128 a[32:35], v4 offset:49152
    v_mfma_f32_16x16x32_bf16 v[24:27], v[144:147], a[4:7], v[24:27]
    v_mfma_f32_16x16x32_bf16 v[28:31], v[148:151], a[4:7], v[28:31]
    ds_read_b128 a[36:39], v4 offset:51200
    v_mfma_f32_16x16x32_bf16 v[32:35], v[144:147], a[8:11], v[32:35]
    v_mfma_f32_16x16x32_bf16 v[36:39], v[148:151], a[8:11], v[36:39]
    ds_read_b128 a[40:43], v4 offset:53248
    v_mfma_f32_16x16x32_bf16 v[40:43], v[144:147], a[12:15], v[40:43]
    v_mfma_f32_16x16x32_bf16 v[44:47], v[148:151], a[12:15], v[44:47]
    ds_read_b128 a[44:47], v4 offset:55296
    s_waitcnt lgkmcnt(4)
    v_mfma_f32_16x16x32_bf16 v[48:51], v[144:147], a[16:19], v[48:51]
    v_mfma_f32_16x16x32_bf16 v[52:55], v[148:151], a[16:19], v[52:55]
    ds_read_b128 a[48:51], v4 offset:57344
    v_mfma_f32_16x16x32_bf16 v[56:59], v[144:147], a[20:23], v[56:59]
    v_mfma_f32_16x16x32_bf16 v[60:63], v[148:151], a[20:23], v[60:63]
    ds_read_b128 a[52:55], v4 offset:59392
    v_mfma_f32_16x16x32_bf16 v[64:67], v[144:147], a[24:27], v[64:67]
    v_mfma_f32_16x16x32_bf16 v[68:71], v[148:151], a[24:27], v[68:71]
    ds_read_b128 a[56:59], v4 offset:61440
    v_mfma_f32_16x16x32_bf16 v[72:75], v[144:147], a[28:31], v[72:75]
    v_mfma_f32_16x16x32_bf16 v[76:79], v[148:151], a[28:31], v[76:79]
    ds_read_b128 a[60:63], v4 offset:63488
    s_waitcnt vmcnt(8)
    s_barrier
    s_cmp_lg_u32 s14, 0
    s_cbranch_scc1 GF_101
    v_mov_b32 v7, 1
    v_mov_b32 v8, 0
    s_mov_b64 exec, 1
    buffer_store_dword v7, v8, s[4:7], s23 offen sc1
    s_mov_b64 exec, -1
GF_101:
    s_waitcnt lgkmcnt(4)
    v_mfma_f32_16x16x32_bf16 v[16:19], v[152:155], a[32:35], v[16:19]
    v_mfma_f32_16x16x32_bf16 v[20:23], v[156:159], a[32:35], v[20:23]
    ds_read_b128 a[0:3], v6 offset:0
    s_add_u32 m0, s21, 32768
    v_mfma_f32_16x16x32_bf16 v[24:27], v[152:155], a[36:39], v[24:27]
    v_mfma_f32_16x16x32_bf16 v[28:31], v[156:159], a[36:39], v[28:31]
    ds_read_b128 a[4:7], v6 offset:2048
    s_add_u32 s64, s20, 0x380
    buffer_load_dwordx4 v2, s[4:7], s64 offen lds
    v_mfma_f32_16x16x32_bf16 v[32:35], v[152:155], a[40:43], v[32:35]
    v_mfma_f32_16x16x32_bf16 v[36:39], v[156:159], a[40:43], v[36:39]
    ds_read_b128 a[8:11], v6 offset:4096
    s_add_u32 m0, s21, 33792
    v_mfma_f32_16x16x32_bf16 v[40:43], v[152:155], a[44:47], v[40:43]
    v_mfma_f32_16x16x32_bf16 v[44:47], v[156:159], a[44:47], v[44:47]
    ds_read_b128 a[12:15], v6 offset:6144
    s_add_u32 s64, s20, 0x2b80
    buffer_load_dwordx4 v2, s[4:7], s64 offen lds
    s_waitcnt lgkmcnt(4)
    v_mfma_f32_16x16x32_bf16 v[48:51], v[152:155], a[48:51], v[48:51]
    v_mfma_f32_16x16x32_bf16 v[52:55], v[156:159], a[48:51], v[52:55]
    ds_read_b128 a[16:19], v6 offset:8192
    s_add_u32 m0, s21, 34816
    v_mfma_f32_16x16x32_bf16 v[56:59], v[152:155], a[52:55], v[56:59]
    v_mfma_f32_16x16x32_bf16 v[60:63], v[156:159], a[52:55], v[60:63]
    ds_read_b128 a[20:23], v6 offset:10240
    s_add_u32 s64, s20, 0x5380
    buffer_load_dwordx4 v2, s[4:7], s64 offen lds
    v_mfma_f32_16x16x32_bf16 v[64:67], v[152:155], a[56:59], v[64:67]
    v_mfma_f32_16x16x32_bf16 v[68:71], v[156:159], a[56:59], v[68:71]
    ds_read_b128 a[24:27], v6 offset:12288
    s_add_u32 m0, s21, 35840
    v_mfma_f32_16x16x32_bf16 v[72:75], v[152:155], a[60:63], v[72:75]
    v_mfma_f32_16x16x32_bf16 v[76:79], v[156:159], a[60:63], v[76:79]
    ds_read_b128 a[28:31], v6 offset:14336
    s_add_u32 s64, s20, 0x7b80
    buffer_load_dwordx4 v2, s[4:7], s64 offen lds
    s_waitcnt lgkmcnt(4)
    v_mfma_f32_16x16x32_bf16 v[16:19], v[160:163], a[0:3], v[16:19]
    v_mfma_f32_16x16x32_bf16 v[20:23], v[164:167], a[0:3], v[20:23]
    ds_read_b128 a[32:35], v9 offset:0
    v_mfma_f32_16x16x32_bf16 v[24:27], v[160:163], a[4:7], v[24:27]
    v_mfma_f32_16x16x32_bf16 v[28:31], v[164:167], a[4:7], v[28:31]
    ds_read_b128 a[36:39], v9 offset:2048
    v_mfma_f32_16x16x32_bf16 v[32:35], v[160:163], a[8:11], v[32:35]
    v_mfma_f32_16x16x32_bf16 v[36:39], v[164:167], a[8:11], v[36:39]
    ds_read_b128 a[40:43], v9 offset:4096
    v_mfma_f32_16x16x32_bf16 v[40:43], v[160:163], a[12:15], v[40:43]
    v_mfma_f32_16x16x32_bf16 v[44:47], v[164:167], a[12:15], v[44:47]
    ds_read_b128 a[44:47], v9 offset:6144
    s_waitcnt lgkmcnt(4)
    v_mfma_f32_16x16x32_bf16 v[48:51], v[160:163], a[16:19], v[48:51]
    v_mfma_f32_16x16x32_bf16 v[52:55], v[164:167], a[16:19], v[52:55]
    ds_read_b128 a[48:51], v9 offset:8192
    v_mfma_f32_16x16x32_bf16 v[56:59], v[160:163], a[20:23], v[56:59]
    v_mfma_f32_16x16x32_bf16 v[60:63], v[164:167], a[20:23], v[60:63]
    ds_read_b128 a[52:55], v9 offset:10240
    v_mfma_f32_16x16x32_bf16 v[64:67], v[160:163], a[24:27], v[64:67]
    v_mfma_f32_16x16x32_bf16 v[68:71], v[164:167], a[24:27], v[68:71]
    ds_read_b128 a[56:59], v9 offset:12288
    v_mfma_f32_16x16x32_bf16 v[72:75], v[160:163], a[28:31], v[72:75]
    v_mfma_f32_16x16x32_bf16 v[76:79], v[164:167], a[28:31], v[76:79]
    ds_read_b128 a[60:63], v9 offset:14336
    s_waitcnt vmcnt(8)
    s_barrier
    s_waitcnt lgkmcnt(4)
    v_mfma_f32_16x16x32_bf16 v[16:19], v[168:171], a[32:35], v[16:19]
    v_mfma_f32_16x16x32_bf16 v[20:23], v[172:175], a[32:35], v[20:23]
    ds_read_b128 a[0:3], v3 offset:0
    s_add_u32 m0, s21, 49152
    v_mfma_f32_16x16x32_bf16 v[24:27], v[168:171], a[36:39], v[24:27]
    v_mfma_f32_16x16x32_bf16 v[28:31], v[172:175], a[36:39], v[28:31]
    ds_read_b128 a[4:7], v3 offset:2048
    s_add_u32 s64, s20, 0x400
    buffer_load_dwordx4 v2, s[4:7], s64 offen lds
    v_mfma_f32_16x16x32_bf16 v[32:35], v[168:171], a[40:43], v[32:35]
    v_mfma_f32_16x16x32_bf16 v[36:39], v[172:175], a[40:43], v[36:39]
    ds_read_b128 a[8:11], v3 offset:4096
    s_add_u32 m0, s21, 50176
    v_mfma_f32_16x16x32_bf16 v[40:43], v[168:171], a[44:47], v[40:43]
    v_mfma_f32_16x16x32_bf16 v[44:47], v[172:175], a[44:47], v[44:47]
    ds_read_b128 a[12:15], v3 offset:6144
    s_add_u32 s64, s20, 0x2c00
    buffer_load_dwordx4 v2, s[4:7], s64 offen lds
    s_waitcnt lgkmcnt(4)
    v_mfma_f32_16x16x32_bf16 v[48:51], v[168:171], a[48:51], v[48:51]
    v_mfma_f32_16x16x32_bf16 v[52:55], v[172:175], a[48:51], v[52:55]
    ds_read_b128 a[16:19], v3 offset:8192
    s_add_u32 m0, s21, 51200
    v_mfma_f32_16x16x32_bf16 v[56:59], v[168:171], a[52:55], v[56:59]
    v_mfma_f32_16x16x32_bf16 v[60:63], v[172:175], a[52:55], v[60:63]
    ds_read_b128 a[20:23], v3 offset:10240
    s_add_u32 s64, s20, 0x5400
    buffer_load_dwordx4 v2, s[4:7], s64 offen lds
    v_mfma_f32_16x16x32_bf16 v[64:67], v[168:171], a[56:59], v[64:67]
    v_mfma_f32_16x16x32_bf16 v[68:71], v[172:175], a[56:59], v[68:71]
    ds_read_b128 a[24:27], v3 offset:12288
    s_add_u32 m0, s21, 52224
    v_mfma_f32_16x16x32_bf16 v[72:75], v[168:171], a[60:63], v[72:75]
    v_mfma_f32_16x16x32_bf16 v[76:79], v[172:175], a[60:63], v[76:79]
    ds_read_b128 a[28:31], v3 offset:14336
    s_add_u32 s64, s20, 0x7c00
    buffer_load_dwordx4 v2, s[4:7], s64 offen lds
    s_waitcnt lgkmcnt(4)
    v_mfma_f32_16x16x32_bf16 v[16:19], v[176:179], a[0:3], v[16:19]
    v_mfma_f32_16x16x32_bf16 v[20:23], v[180:183], a[0:3], v[20:23]
    ds_read_b128 a[32:35], v4 offset:0
    v_mfma_f32_16x16x32_bf16 v[24:27], v[176:179], a[4:7], v[24:27]
    v_mfma_f32_16x16x32_bf16 v[28:31], v[180:183], a[4:7], v[28:31]
    ds_read_b128 a[36:39], v4 offset:2048
    v_mfma_f32_16x16x32_bf16 v[32:35], v[176:179], a[8:11], v[32:35]
    v_mfma_f32_16x16x32_bf16 v[36:39], v[180:183], a[8:11], v[36:39]
    ds_read_b128 a[40:43], v4 offset:4096
    v_mfma_f32_16x16x32_bf16 v[40:43], v[176:179], a[12:15], v[40:43]
    v_mfma_f32_16x16x32_bf16 v[44:47], v[180:183], a[12:15], v[44:47]
    ds_read_b128 a[44:47], v4 offset:6144
    s_waitcnt lgkmcnt(4)
    v_mfma_f32_16x16x32_bf16 v[48:51], v[176:179], a[16:19], v[48:51]
    v_mfma_f32_16x16x32_bf16 v[52:55], v[180:183], a[16:19], v[52:55]
    ds_read_b128 a[48:51], v4 offset:8192
    v_mfma_f32_16x16x32_bf16 v[56:59], v[176:179], a[20:23], v[56:59]
    v_mfma_f32_16x16x32_bf16 v[60:63], v[180:183], a[20:23], v[60:63]
    ds_read_b128 a[52:55], v4 offset:10240
    v_mfma_f32_16x16x32_bf16 v[64:67], v[176:179], a[24:27], v[64:67]
    v_mfma_f32_16x16x32_bf16 v[68:71], v[180:183], a[24:27], v[68:71]
    ds_read_b128 a[56:59], v4 offset:12288
    v_mfma_f32_16x16x32_bf16 v[72:75], v[176:179], a[28:31], v[72:75]
    v_mfma_f32_16x16x32_bf16 v[76:79], v[180:183], a[28:31], v[76:79]
    ds_read_b128 a[60:63], v4 offset:14336
    s_waitcnt vmcnt(8)
    s_barrier
    s_waitcnt lgkmcnt(4)
    v_mfma_f32_16x16x32_bf16 v[16:19], v[184:187], a[32:35], v[16:19]
    v_mfma_f32_16x16x32_bf16 v[20:23], v[188:191], a[32:35], v[20:23]
    ds_read_b128 a[0:3], v3 offset:16384
    s_add_u32 m0, s21, 65536
    v_mfma_f32_16x16x32_bf16 v[24:27], v[184:187], a[36:39], v[24:27]
    v_mfma_f32_16x16x32_bf16 v[28:31], v[188:191], a[36:39], v[28:31]
    ds_read_b128 a[4:7], v3 offset:18432
    s_add_u32 s64, s20, 0x480
    buffer_load_dwordx4 v2, s[4:7], s64 offen lds
    v_mfma_f32_16x16x32_bf16 v[32:35], v[184:187], a[40:43], v[32:35]
    v_mfma_f32_16x16x32_bf16 v[36:39], v[188:191], a[40:43], v[36:39]
    ds_read_b128 a[8:11], v3 offset:20480
    s_add_u32 m0, s21, 66560
    v_mfma_f32_16x16x32_bf16 v[40:43], v[184:187], a[44:47], v[40:43]
    v_mfma_f32_16x16x32_bf16 v[44:47], v[188:191], a[44:47], v[44:47]
    ds_read_b128 a[12:15], v3 offset:22528
    s_add_u32 s64, s20, 0x2c80
    buffer_load_dwordx4 v2, s[4:7], s64 offen lds
    s_waitcnt lgkmcnt(4)
    v_mfma_f32_16x16x32_bf16 v[48:51], v[184:187], a[48:51], v[48:51]
    v_mfma_f32_16x16x32_bf16 v[52:55], v[188:191], a[48:51], v[52:55]
    ds_read_b128 a[16:19], v3 offset:24576
    s_add_u32 m0, s21, 67584
    v_mfma_f32_16x16x32_bf16 v[56:59], v[184:187], a[52:55], v[56:59]
    v_mfma_f32_16x16x32_bf16 v[60:63], v[188:191], a[52:55], v[60:63]
    ds_read_b128 a[20:23], v3 offset:26624
    s_add_u32 s64, s20, 0x5480
    buffer_load_dwordx4 v2, s[4:7], s64 offen lds
    v_mfma_f32_16x16x32_bf16 v[64:67], v[184:187], a[56:59], v[64:67]
    v_mfma_f32_16x16x32_bf16 v[68:71], v[188:191], a[56:59], v[68:71]
    ds_read_b128 a[24:27], v3 offset:28672
    s_add_u32 m0, s21, 68608
    v_mfma_f32_16x16x32_bf16 v[72:75], v[184:187], a[60:63], v[72:75]
    v_mfma_f32_16x16x32_bf16 v[76:79], v[188:191], a[60:63], v[76:79]
    ds_read_b128 a[28:31], v3 offset:30720
    s_add_u32 s64, s20, 0x7c80
    buffer_load_dwordx4 v2, s[4:7], s64 offen lds
    s_waitcnt lgkmcnt(4)
    v_mfma_f32_16x16x32_bf16 v[16:19], v[192:195], a[0:3], v[16:19]
    v_mfma_f32_16x16x32_bf16 v[20:23], v[196:199], a[0:3], v[20:23]
    ds_read_b128 a[32:35], v4 offset:16384
    v_mfma_f32_16x16x32_bf16 v[24:27], v[192:195], a[4:7], v[24:27]
    v_mfma_f32_16x16x32_bf16 v[28:31], v[196:199], a[4:7], v[28:31]
    ds_read_b128 a[36:39], v4 offset:18432
    v_mfma_f32_16x16x32_bf16 v[32:35], v[192:195], a[8:11], v[32:35]
    v_mfma_f32_16x16x32_bf16 v[36:39], v[196:199], a[8:11], v[36:39]
    ds_read_b128 a[40:43], v4 offset:20480
    v_mfma_f32_16x16x32_bf16 v[40:43], v[192:195], a[12:15], v[40:43]
    v_mfma_f32_16x16x32_bf16 v[44:47], v[196:199], a[12:15], v[44:47]
    ds_read_b128 a[44:47], v4 offset:22528
    s_waitcnt lgkmcnt(4)
    v_mfma_f32_16x16x32_bf16 v[48:51], v[192:195], a[16:19], v[48:51]
    v_mfma_f32_16x16x32_bf16 v[52:55], v[196:199], a[16:19], v[52:55]
    ds_read_b128 a[48:51], v4 offset:24576
    v_mfma_f32_16x16x32_bf16 v[56:59], v[192:195], a[20:23], v[56:59]
    v_mfma_f32_16x16x32_bf16 v[60:63], v[196:199], a[20:23], v[60:63]
    ds_read_b128 a[52:55], v4 offset:26624
    v_mfma_f32_16x16x32_bf16 v[64:67], v[192:195], a[24:27], v[64:67]
    v_mfma_f32_16x16x32_bf16 v[68:71], v[196:199], a[24:27], v[68:71]
    ds_read_b128 a[56:59], v4 offset:28672
    v_mfma_f32_16x16x32_bf16 v[72:75], v[192:195], a[28:31], v[72:75]
    v_mfma_f32_16x16x32_bf16 v[76:79], v[196:199], a[28:31], v[76:79]
    ds_read_b128 a[60:63], v4 offset:30720
    s_waitcnt vmcnt(8)
    s_barrier
    s_waitcnt lgkmcnt(4)
    v_mfma_f32_16x16x32_bf16 v[16:19], v[200:203], a[32:35], v[16:19]
    v_mfma_f32_16x16x32_bf16 v[20:23], v[204:207], a[32:35], v[20:23]
    ds_read_b128 a[0:3], v3 offset:32768
    s_add_u32 m0, s21, 0
    v_mfma_f32_16x16x32_bf16 v[24:27], v[200:203], a[36:39], v[24:27]
    v_mfma_f32_16x16x32_bf16 v[28:31], v[204:207], a[36:39], v[28:31]
    ds_read_b128 a[4:7], v3 offset:34816
    s_add_u32 s64, s20, 0x50000
    buffer_load_dwordx4 v2, s[4:7], s64 offen lds
    v_mfma_f32_16x16x32_bf16 v[32:35], v[200:203], a[40:43], v[32:35]
    v_mfma_f32_16x16x32_bf16 v[36:39], v[204:207], a[40:43], v[36:39]
    ds_read_b128 a[8:11], v3 offset:36864
    s_add_u32 m0, s21, 1024
    v_mfma_f32_16x16x32_bf16 v[40:43], v[200:203], a[44:47], v[40:43]
    v_mfma_f32_16x16x32_bf16 v[44:47], v[204:207], a[44:47], v[44:47]
    ds_read_b128 a[12:15], v3 offset:38912
    s_add_u32 s64, s20, 0x52800
    buffer_load_dwordx4 v2, s[4:7], s64 offen lds
    s_waitcnt lgkmcnt(4)
    v_mfma_f32_16x16x32_bf16 v[48:51], v[200:203], a[48:51], v[48:51]
    v_mfma_f32_16x16x32_bf16 v[52:55], v[204:207], a[48:51], v[52:55]
    ds_read_b128 a[16:19], v3 offset:40960
    s_add_u32 m0, s21, 2048
    v_mfma_f32_16x16x32_bf16 v[56:59], v[200:203], a[52:55], v[56:59]
    v_mfma_f32_16x16x32_bf16 v[60:63], v[204:207], a[52:55], v[60:63]
    ds_read_b128 a[20:23], v3 offset:43008
    s_add_u32 s64, s20, 0x55000
    buffer_load_dwordx4 v2, s[4:7], s64 offen lds
    v_mfma_f32_16x16x32_bf16 v[64:67], v[200:203], a[56:59], v[64:67]
    v_mfma_f32_16x16x32_bf16 v[68:71], v[204:207], a[56:59], v[68:71]
    ds_read_b128 a[24:27], v3 offset:45056
    s_add_u32 m0, s21, 3072
    v_mfma_f32_16x16x32_bf16 v[72:75], v[200:203], a[60:63], v[72:75]
    v_mfma_f32_16x16x32_bf16 v[76:79], v[204:207], a[60:63], v[76:79]
    ds_read_b128 a[28:31], v3 offset:47104
    s_add_u32 s64, s20, 0x57800
    buffer_load_dwordx4 v2, s[4:7], s64 offen lds
    s_waitcnt lgkmcnt(4)
    v_mfma_f32_16x16x32_bf16 v[16:19], v[208:211], a[0:3], v[16:19]
    v_mfma_f32_16x16x32_bf16 v[20:23], v[212:215], a[0:3], v[20:23]
    ds_read_b128 a[32:35], v4 offset:32768
    v_mfma_f32_16x16x32_bf16 v[24:27], v[208:211], a[4:7], v[24:27]
    v_mfma_f32_16x16x32_bf16 v[28:31], v[212:215], a[4:7], v[28:31]
    ds_read_b128 a[36:39], v4 offset:34816
    v_mfma_f32_16x16x32_bf16 v[32:35], v[208:211], a[8:11], v[32:35]
    v_mfma_f32_16x16x32_bf16 v[36:39], v[212:215], a[8:11], v[36:39]
    ds_read_b128 a[40:43], v4 offset:36864
    v_mfma_f32_16x16x32_bf16 v[40:43], v[208:211], a[12:15], v[40:43]
    v_mfma_f32_16x16x32_bf16 v[44:47], v[212:215], a[12:15], v[44:47]
    ds_read_b128 a[44:47], v4 offset:38912
    s_waitcnt lgkmcnt(4)
    v_mfma_f32_16x16x32_bf16 v[48:51], v[208:211], a[16:19], v[48:51]
    v_mfma_f32_16x16x32_bf16 v[52:55], v[212:215], a[16:19], v[52:55]
    ds_read_b128 a[48:51], v4 offset:40960
    v_mfma_f32_16x16x32_bf16 v[56:59], v[208:211], a[20:23], v[56:59]
    v_mfma_f32_16x16x32_bf16 v[60:63], v[212:215], a[20:23], v[60:63]
    ds_read_b128 a[52:55], v4 offset:43008
    v_mfma_f32_16x16x32_bf16 v[64:67], v[208:211], a[24:27], v[64:67]
    v_mfma_f32_16x16x32_bf16 v[68:71], v[212:215], a[24:27], v[68:71]
    ds_read_b128 a[56:59], v4 offset:45056
    v_mfma_f32_16x16x32_bf16 v[72:75], v[208:211], a[28:31], v[72:75]
    v_mfma_f32_16x16x32_bf16 v[76:79], v[212:215], a[28:31], v[76:79]
    ds_read_b128 a[60:63], v4 offset:47104
    s_waitcnt vmcnt(8)
    s_barrier
    s_waitcnt lgkmcnt(4)
    v_mfma_f32_16x16x32_bf16 v[16:19], v[216:219], a[32:35], v[16:19]
    v_mfma_f32_16x16x32_bf16 v[20:23], v[220:223], a[32:35], v[20:23]
    ds_read_b128 a[0:3], v3 offset:49152
    s_add_u32 m0, s21, 16384
    v_mfma_f32_16x16x32_bf16 v[24:27], v[216:219], a[36:39], v[24:27]
    v_mfma_f32_16x16x32_bf16 v[28:31], v[220:223], a[36:39], v[28:31]
    ds_read_b128 a[4:7], v3 offset:51200
    s_add_u32 s64, s20, 0x50080
    buffer_load_dwordx4 v2, s[4:7], s64 offen lds
    v_mfma_f32_16x16x32_bf16 v[32:35], v[216:219], a[40:43], v[32:35]
    v_mfma_f32_16x16x32_bf16 v[36:39], v[220:223], a[40:43], v[36:39]
    ds_read_b128 a[8:11], v3 offset:53248
    s_add_u32 m0, s21, 17408
    v_mfma_f32_16x16x32_bf16 v[40:43], v[216:219], a[44:47], v[40:43]
    v_mfma_f32_16x16x32_bf16 v[44:47], v[220:223], a[44:47], v[44:47]
    ds_read_b128 a[12:15], v3 offset:55296
    s_add_u32 s64, s20, 0x52880
    buffer_load_dwordx4 v2, s[4:7], s64 offen lds
    s_waitcnt lgkmcnt(4)
    v_mfma_f32_16x16x32_bf16 v[48:51], v[216:219], a[48:51], v[48:51]
    v_mfma_f32_16x16x32_bf16 v[52:55], v[220:223], a[48:51], v[52:55]
    ds_read_b128 a[16:19], v3 offset:57344
    s_add_u32 m0, s21, 18432
    v_mfma_f32_16x16x32_bf16 v[56:59], v[216:219], a[52:55], v[56:59]
    v_mfma_f32_16x16x32_bf16 v[60:63], v[220:223], a[52:55], v[60:63]
    ds_read_b128 a[20:23], v3 offset:59392
    s_add_u32 s64, s20, 0x55080
    buffer_load_dwordx4 v2, s[4:7], s64 offen lds
    v_mfma_f32_16x16x32_bf16 v[64:67], v[216:219], a[56:59], v[64:67]
    v_mfma_f32_16x16x32_bf16 v[68:71], v[220:223], a[56:59], v[68:71]
    ds_read_b128 a[24:27], v3 offset:61440
    s_add_u32 m0, s21, 19456
    v_mfma_f32_16x16x32_bf16 v[72:75], v[216:219], a[60:63], v[72:75]
    v_mfma_f32_16x16x32_bf16 v[76:79], v[220:223], a[60:63], v[76:79]
    ds_read_b128 a[28:31], v3 offset:63488
    s_add_u32 s64, s20, 0x57880
    buffer_load_dwordx4 v2, s[4:7], s64 offen lds
    s_waitcnt lgkmcnt(4)
    v_mfma_f32_16x16x32_bf16 v[16:19], v[224:227], a[0:3], v[16:19]
    v_mfma_f32_16x16x32_bf16 v[20:23], v[228:231], a[0:3], v[20:23]
    ds_read_b128 a[32:35], v4 offset:49152
    v_mfma_f32_16x16x32_bf16 v[24:27], v[224:227], a[4:7], v[24:27]
    v_mfma_f32_16x16x32_bf16 v[28:31], v[228:231], a[4:7], v[28:31]
    ds_read_b128 a[36:39], v4 offset:51200
    v_mfma_f32_16x16x32_bf16 v[32:35], v[224:227], a[8:11], v[32:35]
    v_mfma_f32_16x16x32_bf16 v[36:39], v[228:231], a[8:11], v[36:39]
    ds_read_b128 a[40:43], v4 offset:53248
    v_mfma_f32_16x16x32_bf16 v[40:43], v[224:227], a[12:15], v[40:43]
    v_mfma_f32_16x16x32_bf16 v[44:47], v[228:231], a[12:15], v[44:47]
    ds_read_b128 a[44:47], v4 offset:55296
    s_waitcnt lgkmcnt(4)
    v_mfma_f32_16x16x32_bf16 v[48:51], v[224:227], a[16:19], v[48:51]
    v_mfma_f32_16x16x32_bf16 v[52:55], v[228:231], a[16:19], v[52:55]
    ds_read_b128 a[48:51], v4 offset:57344
    v_mfma_f32_16x16x32_bf16 v[56:59], v[224:227], a[20:23], v[56:59]
    v_mfma_f32_16x16x32_bf16 v[60:63], v[228:231], a[20:23], v[60:63]
    ds_read_b128 a[52:55], v4 offset:59392
    v_mfma_f32_16x16x32_bf16 v[64:67], v[224:227], a[24:27], v[64:67]
    v_mfma_f32_16x16x32_bf16 v[68:71], v[228:231], a[24:27], v[68:71]
    ds_read_b128 a[56:59], v4 offset:61440
    v_mfma_f32_16x16x32_bf16 v[72:75], v[224:227], a[28:31], v[72:75]
    v_mfma_f32_16x16x32_bf16 v[76:79], v[228:231], a[28:31], v[76:79]
    ds_read_b128 a[60:63], v4 offset:63488
    s_waitcnt vmcnt(8)
    s_barrier
    s_waitcnt lgkmcnt(4)
    v_mfma_f32_16x16x32_bf16 v[16:19], v[232:235], a[32:35], v[16:19]
    v_mfma_f32_16x16x32_bf16 v[20:23], v[236:239], a[32:35], v[20:23]
    ds_read_b128 a[0:3], v6 offset:0
    s_add_u32 m0, s21, 32768
    v_mfma_f32_16x16x32_bf16 v[24:27], v[232:235], a[36:39], v[24:27]
    v_mfma_f32_16x16x32_bf16 v[28:31], v[236:239], a[36:39], v[28:31]
    ds_read_b128 a[4:7], v6 offset:2048
    s_add_u32 s64, s20, 0x50100
    buffer_load_dwordx4 v2, s[4:7], s64 offen lds
    v_mfma_f32_16x16x32_bf16 v[32:35], v[232:235], a[40:43], v[32:35]
    v_mfma_f32_16x16x32_bf16 v[36:39], v[236:239], a[40:43], v[36:39]
    ds_read_b128 a[8:11], v6 offset:4096
    s_add_u32 m0, s21, 33792
    v_mfma_f32_16x16x32_bf16 v[40:43], v[232:235], a[44:47], v[40:43]
    v_mfma_f32_16x16x32_bf16 v[44:47], v[236:239], a[44:47], v[44:47]
    ds_read_b128 a[12:15], v6 offset:6144
    s_add_u32 s64, s20, 0x52900
    buffer_load_dwordx4 v2, s[4:7], s64 offen lds
    s_waitcnt lgkmcnt(4)
    v_mfma_f32_16x16x32_bf16 v[48:51], v[232:235], a[48:51], v[48:51]
    v_mfma_f32_16x16x32_bf16 v[52:55], v[236:239], a[48:51], v[52:55]
    ds_read_b128 a[16:19], v6 offset:8192
    s_add_u32 m0, s21, 34816
    v_mfma_f32_16x16x32_bf16 v[56:59], v[232:235], a[52:55], v[56:59]
    v_mfma_f32_16x16x32_bf16 v[60:63], v[236:239], a[52:55], v[60:63]
    ds_read_b128 a[20:23], v6 offset:10240
    s_add_u32 s64, s20, 0x55100
    buffer_load_dwordx4 v2, s[4:7], s64 offen lds
    v_mfma_f32_16x16x32_bf16 v[64:67], v[232:235], a[56:59], v[64:67]
    v_mfma_f32_16x16x32_bf16 v[68:71], v[236:239], a[56:59], v[68:71]
    ds_read_b128 a[24:27], v6 offset:12288
    s_add_u32 m0, s21, 35840
    v_mfma_f32_16x16x32_bf16 v[72:75], v[232:235], a[60:63], v[72:75]
    v_mfma_f32_16x16x32_bf16 v[76:79], v[236:239], a[60:63], v[76:79]
    ds_read_b128 a[28:31], v6 offset:14336
    s_add_u32 s64, s20, 0x57900
    buffer_load_dwordx4 v2, s[4:7], s64 offen lds
    s_waitcnt lgkmcnt(4)
    v_mfma_f32_16x16x32_bf16 v[16:19], v[240:243], a[0:3], v[16:19]
    v_mfma_f32_16x16x32_bf16 v[20:23], v[244:247], a[0:3], v[20:23]
    ds_read_b128 a[32:35], v9 offset:0
    v_mfma_f32_16x16x32_bf16 v[24:27], v[240:243], a[4:7], v[24:27]
    v_mfma_f32_16x16x32_bf16 v[28:31], v[244:247], a[4:7], v[28:31]
    ds_read_b128 a[36:39], v9 offset:2048
    v_mfma_f32_16x16x32_bf16 v[32:35], v[240:243], a[8:11], v[32:35]
    v_mfma_f32_16x16x32_bf16 v[36:39], v[244:247], a[8:11], v[36:39]
    ds_read_b128 a[40:43], v9 offset:4096
    v_mfma_f32_16x16x32_bf16 v[40:43], v[240:243], a[12:15], v[40:43]
    v_mfma_f32_16x16x32_bf16 v[44:47], v[244:247], a[12:15], v[44:47]
    ds_read_b128 a[44:47], v9 offset:6144
    s_waitcnt lgkmcnt(4)
    v_mfma_f32_16x16x32_bf16 v[48:51], v[240:243], a[16:19], v[48:51]
    v_mfma_f32_16x16x32_bf16 v[52:55], v[244:247], a[16:19], v[52:55]
    ds_read_b128 a[48:51], v9 offset:8192
    v_mfma_f32_16x16x32_bf16 v[56:59], v[240:243], a[20:23], v[56:59]
    v_mfma_f32_16x16x32_bf16 v[60:63], v[244:247], a[20:23], v[60:63]
    ds_read_b128 a[52:55], v9 offset:10240
    v_mfma_f32_16x16x32_bf16 v[64:67], v[240:243], a[24:27], v[64:67]
    v_mfma_f32_16x16x32_bf16 v[68:71], v[244:247], a[24:27], v[68:71]
    ds_read_b128 a[56:59], v9 offset:12288
    v_mfma_f32_16x16x32_bf16 v[72:75], v[240:243], a[28:31], v[72:75]
    v_mfma_f32_16x16x32_bf16 v[76:79], v[244:247], a[28:31], v[76:79]
    ds_read_b128 a[60:63], v9 offset:14336
    s_waitcnt vmcnt(8)
    s_barrier
    s_waitcnt lgkmcnt(4)
    v_mfma_f32_16x16x32_bf16 v[16:19], v[248:251], a[32:35], v[16:19]
    v_mfma_f32_16x16x32_bf16 v[20:23], v[252:255], a[32:35], v[20:23]
    ds_read_b128 a[0:3], v3 offset:0
    s_add_u32 m0, s21, 49152
    v_mfma_f32_16x16x32_bf16 v[24:27], v[248:251], a[36:39], v[24:27]
    v_mfma_f32_16x16x32_bf16 v[28:31], v[252:255], a[36:39], v[28:31]
    ds_read_b128 a[4:7], v3 offset:2048
    s_add_u32 s64, s20, 0x50180
    buffer_load_dwordx4 v2, s[4:7], s64 offen lds
    v_mfma_f32_16x16x32_bf16 v[32:35], v[248:251], a[40:43], v[32:35]
    v_mfma_f32_16x16x32_bf16 v[36:39], v[252:255], a[40:43], v[36:39]
    ds_read_b128 a[8:11], v3 offset:4096
    s_add_u32 m0, s21, 50176
    v_mfma_f32_16x16x32_bf16 v[40:43], v[248:251], a[44:47], v[40:43]
    v_mfma_f32_16x16x32_bf16 v[44:47], v[252:255], a[44:47], v[44:47]
    ds_read_b128 a[12:15], v3 offset:6144
    s_add_u32 s64, s20, 0x52980
    buffer_load_dwordx4 v2, s[4:7], s64 offen lds
    s_waitcnt lgkmcnt(4)
    v_mfma_f32_16x16x32_bf16 v[48:51], v[248:251], a[48:51], v[48:51]
    v_mfma_f32_16x16x32_bf16 v[52:55], v[252:255], a[48:51], v[52:55]
    ds_read_b128 a[16:19], v3 offset:8192
    s_add_u32 m0, s21, 51200
    v_mfma_f32_16x16x32_bf16 v[56:59], v[248:251], a[52:55], v[56:59]
    v_mfma_f32_16x16x32_bf16 v[60:63], v[252:255], a[52:55], v[60:63]
    ds_read_b128 a[20:23], v3 offset:10240
    s_add_u32 s64, s20, 0x55180
    buffer_load_dwordx4 v2, s[4:7], s64 offen lds
    v_mfma_f32_16x16x32_bf16 v[64:67], v[248:251], a[56:59], v[64:67]
    v_mfma_f32_16x16x32_bf16 v[68:71], v[252:255], a[56:59], v[68:71]
    ds_read_b128 a[24:27], v3 offset:12288
    s_add_u32 m0, s21, 52224
    v_mfma_f32_16x16x32_bf16 v[72:75], v[248:251], a[60:63], v[72:75]
    v_mfma_f32_16x16x32_bf16 v[76:79], v[252:255], a[60:63], v[76:79]
    ds_read_b128 a[28:31], v3 offset:14336
    s_add_u32 s64, s20, 0x57980
    buffer_load_dwordx4 v2, s[4:7], s64 offen lds
    s_nop 5
    s_mul_i32 s65, s17, 0
    s_add_u32 s65, s65, s22
    s_add_u32 s64, s65, 0
    v_cvt_pk_bf16_f32 v80, v16, v17
    v_cvt_pk_bf16_f32 v81, v18, v19
    v_cvt_pk_bf16_f32 v82, v20, v21
    v_cvt_pk_bf16_f32 v83, v22, v23
    buffer_store_dwordx4 v[80:83], v1, s[4:7], s64 offen sc1
    s_add_u32 s64, s65, 4096
    v_cvt_pk_bf16_f32 v84, v24, v25
    v_cvt_pk_bf16_f32 v85, v26, v27
    v_cvt_pk_bf16_f32 v86, v28, v29
    v_cvt_pk_bf16_f32 v87, v30, v31
    buffer_store_dwordx4 v[84:87], v1, s[4:7], s64 offen sc1
    s_mul_i32 s65, s17, 1
    s_add_u32 s65, s65, s22
    s_add_u32 s64, s65, 0
    v_cvt_pk_bf16_f32 v88, v32, v33
    v_cvt_pk_bf16_f32 v89, v34, v35
    v_cvt_pk_bf16_f32 v90, v36, v37
    v_cvt_pk_bf16_f32 v91, v38, v39
    buffer_store_dwordx4 v[88:91], v1, s[4:7], s64 offen sc1
    s_add_u32 s64, s65, 4096
    v_cvt_pk_bf16_f32 v92, v40, v41
    v_cvt_pk_bf16_f32 v93, v42, v43
    v_cvt_pk_bf16_f32 v94, v44, v45
    v_cvt_pk_bf16_f32 v95, v46, v47
    buffer_store_dwordx4 v[92:95], v1, s[4:7], s64 offen sc1
    s_mul_i32 s65, s17, 2
    s_add_u32 s65, s65, s22
    s_add_u32 s64, s65, 0
    v_cvt_pk_bf16_f32 v80, v48, v49
    v_cvt_pk_bf16_f32 v81, v50, v51
    v_cvt_pk_bf16_f32 v82, v52, v53
    v_cvt_pk_bf16_f32 v83, v54, v55
    buffer_store_dwordx4 v[80:83], v1, s[4:7], s64 offen sc1
    s_add_u32 s64, s65, 4096
    v_cvt_pk_bf16_f32 v84, v56, v57
    v_cvt_pk_bf16_f32 v85, v58, v59
    v_cvt_pk_bf16_f32 v86, v60, v61
    v_cvt_pk_bf16_f32 v87, v62, v63
    buffer_store_dwordx4 v[84:87], v1, s[4:7], s64 offen sc1
    s_mul_i32 s65, s17, 3
    s_add_u32 s65, s65, s22
    s_add_u32 s64, s65, 0
    v_cvt_pk_bf16_f32 v88, v64, v65
    v_cvt_pk_bf16_f32 v89, v66, v67
    v_cvt_pk_bf16_f32 v90, v68, v69
    v_cvt_pk_bf16_f32 v91, v70, v71
    buffer_store_dwordx4 v[88:91], v1, s[4:7], s64 offen sc1
    s_add_u32 s64, s65, 4096
    v_cvt_pk_bf16_f32 v92, v72, v73
    v_cvt_pk_bf16_f32 v93, v74, v75
    v_cvt_pk_bf16_f32 v94, v76, v77
    v_cvt_pk_bf16_f32 v95, v78, v79
    buffer_store_dwordx4 v[92:95], v1, s[4:7], s64 offen sc1
    s_lshl_b32 s64, s19, 1
    s_add_u32 s64, s64, s12
    s_lshl_b32 s64, s64, 9
    s_add_u32 s23, s18, s64
    s_lshl_b32 s64, s17, 3
    s_add_u32 s22, s22, s64
    s_add_u32 s19, s19, 1
    s_add_u32 s20, s20, 0x50000
    s_cmp_lt_u32 s19, 8
    s_cbranch_scc1 G_T_LOOP
    s_waitcnt vmcnt(0) lgkmcnt(0)
    s_barrier
    s_cmp_lg_u32 s14, 0
    s_cbranch_scc1 GF_102
    v_mov_b32 v7, 1
    v_mov_b32 v8, 0
    s_mov_b64 exec, 1
    buffer_store_dword v7, v8, s[4:7], s23 offen sc1
    s_mov_b64 exec, -1
GF_102:
    s_cmp_eq_u32 s3, 2
    s_cbranch_scc1 H_Q
    s_cmp_eq_u32 s12, 1
    s_cbranch_scc1 H_OUT
    s_mov_b32 s29, 0
    v_lshlrev_b32 v1, 4, v0
    s_mov_b32 s65, 0
CW_103:
    buffer_load_dwordx2 v[8:9], off, s[60:63], 0 offset:132 sc1
    s_add_u32 s65, s65, 1
    s_waitcnt vmcnt(0)
    v_readfirstlane_b32 s66, v8
    v_readfirstlane_b32 s67, v9
    s_min_u32 s64, s66, s67
    s_cmp_lg_u32 s64, 0
    s_cbranch_scc1 CWD_104
    s_cmp_gt_u32 s65, 65536
    s_cbranch_scc1 CWD_104
    s_sleep 4
    s_branch CW_103
CWD_104:
    s_sub_u32 s66, s66, 1
    s_and_b32 s66, s66, 3
    s_sub_u32 s67, s67, 1
    s_and_b32 s67, s67, 3
    s_mov_b32 s64, s66
    s_mov_b32 s65, s67
    s_and_b32 s64, s64, 3
    s_lshl_b32 s64, s64, 13
    s_and_b32 s65, s65, 3
    s_lshl_b32 s65, s65, 13
    s_add_u32 s25, s64, 0x6000000
    s_add_u32 s30, s65, 0x6200000
    v_bfe_u32 v4, v0, 3, 1
    v_mul_u32_u24 v2, 0x8000, v4
    v_lshrrev_b32 v4, 5, v0
    v_lshl_add_u32 v2, v4, 8, v2
    v_bfe_u32 v4, v0, 4, 1
    v_lshl_add_u32 v2, v4, 7, v2
    v_and_b32 v4, 7, v0
    v_lshl_add_u32 v2, v4, 4, v2
    v_bfe_u32 v4, v0, 3, 1
    v_lshlrev_b32 v3, 16, v4
    v_lshrrev_b32 v4, 4, v0
    v_lshl_add_u32 v3, v4, 7, v3
    v_and_b32 v4, 7, v0
    v_lshl_add_u32 v3, v4, 4, v3
    s_lshl_b32 s26, s13, 11
    s_lshl_b32 s64, s14, 9
    s_add_u32 s26, s26, s64
    s_add_u32 s26, s26, 0x640000
    s_lshl_b32 s27, s13, 3
    s_add_u32 s27, s27, 0x294000
    s_mov_b32 s28, 0x29a000
    s_mov_b32 s24, 0
    v_lshlrev_b32 v6, 7, v0
MKT_LOOP:
    s_mov_b64 exec, 0xf
MKT_M_105:
    buffer_load_dword v5, v6, s[4:7], s28 offen sc1
    s_add_u32 s29, s29, 1
    s_waitcnt vmcnt(0)
    v_cmp_eq_u32 vcc, 0, v5
    s_cbranch_vccz MKT_MD_106
    s_cmp_gt_u32 s29, 262144
    s_cbranch_scc1 MKT_MD_106
    s_sleep 4
    s_branch MKT_M_105
MKT_MD_106:
    s_mov_b64 exec, -1
MKR_107:
    s_add_u32 s64, s25, 0x0
    buffer_load_dwordx4 v[16:19], v2, s[4:7], s64 offen sc1
    s_add_u32 s64, s25, 0x200
    buffer_load_dwordx4 v[20:23], v2, s[4:7], s64 offen sc1
    s_add_u32 s64, s25, 0x400
    buffer_load_dwordx4 v[24:27], v2, s[4:7], s64 offen sc1
    s_add_u32 s64, s25, 0x600
    buffer_load_dwordx4 v[28:31], v2, s[4:7], s64 offen sc1
    s_add_u32 s64, s25, 0x800
    buffer_load_dwordx4 v[32:35], v2, s[4:7], s64 offen sc1
    s_add_u32 s64, s25, 0xa00
    buffer_load_dwordx4 v[36:39], v2, s[4:7], s64 offen sc1
    s_add_u32 s64, s25, 0xc00
    buffer_load_dwordx4 v[40:43], v2, s[4:7], s64 offen sc1
    s_add_u32 s64, s25, 0xe00
    buffer_load_dwordx4 v[44:47], v2, s[4:7], s64 offen sc1
    s_add_u32 s64, s25, 0x1000
    buffer_load_dwordx4 v[48:51], v2, s[4:7], s64 offen sc1
    s_add_u32 s64, s25, 0x1200
    buffer_load_dwordx4 v[52:55], v2, s[4:7], s64 offen sc1
    s_add_u32 s64, s30, 0x0
    buffer_load_dwordx4 v[56:59], v2, s[4:7], s64 offen sc1
    s_add_u32 s64, s30, 0x200
    buffer_load_dwordx4 v[60:63], v2, s[4:7], s64 offen sc1
    s_add_u32 s64, s30, 0x400
    buffer_load_dwordx4 v[64:67], v2, s[4:7], s64 offen sc1
    s_add_u32 s64, s30, 0x600
    buffer_load_dwordx4 v[68:71], v2, s[4:7], s64 offen sc1
    s_add_u32 s64, s30, 0x800
    buffer_load_dwordx4 v[72:75], v2, s[4:7], s64 offen sc1
    s_add_u32 s64, s30, 0xa00
    buffer_load_dwordx4 v[76:79], v2, s[4:7], s64 offen sc1
    s_add_u32 s64, s30, 0xc00
    buffer_load_dwordx4 v[80:83], v2, s[4:7], s64 offen sc1
    s_add_u32 s64, s30, 0xe00
    buffer_load_dwordx4 v[84:87], v2, s[4:7], s64 offen sc1
    s_add_u32 s64, s30, 0x1000
    buffer_load_dwordx4 v[88:91], v2, s[4:7], s64 offen sc1
    s_add_u32 s64, s30, 0x1200
    buffer_load_dwordx4 v[92:95], v2, s[4:7], s64 offen sc1
    s_add_u32 s29, s29, 1
    s_waitcnt vmcnt(0)
    v_max3_u32 v4, v19, v23, v27
    v_max3_u32 v4, v4, v31, v35
    v_max3_u32 v4, v4, v39, v43
    v_max3_u32 v4, v4, v47, v51
    v_max3_u32 v4, v4, v55, v59
    v_max3_u32 v4, v4, v63, v67
    v_max3_u32 v4, v4, v71, v75
    v_max3_u32 v4, v4, v79, v83
    v_max3_u32 v4, v4, v87, v91
    v_max_u32 v4, v4, v95
    v_cmp_eq_u32 vcc, -1, v4
    s_cbranch_vccz MKO_108
    s_cmp_gt_u32 s29, 262144
    s_cbranch_scc0 MKR_107
MKO_108:
    v_mfma_f32_16x16x32_bf16 v[8:11], v[96:99], v[16:19], 0
    v_mfma_f32_16x16x32_bf16 v[12:15], v[100:103], v[16:19], 0
    v_mfma_f32_16x16x32_bf16 v[8:11], v[104:107], v[20:23], v[8:11]
    v_mfma_f32_16x16x32_bf16 v[12:15], v[108:111], v[20:23], v[12:15]
    v_mfma_f32_16x16x32_bf16 v[8:11], v[112:115], v[24:27], v[8:11]
    v_mfma_f32_16x16x32_bf16 v[12:15], v[116:119], v[24:27], v[12:15]
    v_mfma_f32_16x16x32_bf16 v[8:11], v[120:123], v[28:31], v[8:11]
    v_mfma_f32_16x16x32_bf16 v[12:15], v[124:127], v[28:31], v[12:15]
    v_mfma_f32_16x16x32_bf16 v[8:11], v[128:131], v[32:35], v[8:11]
    v_mfma_f32_16x16x32_bf16 v[12:15], v[132:135], v[32:35], v[12:15]
    v_mfma_f32_16x16x32_bf16 v[8:11], v[136:139], v[36:39], v[8:11]
    v_mfma_f32_16x16x32_bf16 v[12:15], v[140:143], v[36:39], v[12:15]
    v_mfma_f32_16x16x32_bf16 v[8:11], v[144:147], v[40:43], v[8:11]
    v_mfma_f32_16x16x32_bf16 v[12:15], v[148:151], v[40:43], v[12:15]
    v_mfma_f32_16x16x32_bf16 v[8:11], v[152:155], v[44:47], v[8:11]
    v_mfma_f32_16x16x32_bf16 v[12:15], v[156:159], v[44:47], v[12:15]
    v_mfma_f32_16x16x32_bf16 v[8:11], v[160:163], v[48:51], v[8:11]
    v_mfma_f32_16x16x32_bf16 v[12:15], v[164:167], v[48:51], v[12:15]
    v_mfma_f32_16x16x32_bf16 v[8:11], v[168:171], v[52:55], v[8:11]
    v_mfma_f32_16x16x32_bf16 v[12:15], v[172:175], v[52:55], v[12:15]
    v_mfma_f32_16x16x32_bf16 v[8:11], v[176:179], v[56:59], v[8:11]
    v_mfma_f32_16x16x32_bf16 v[12:15], v[180:183], v[56:59], v[12:15]
    v_mfma_f32_16x16x32_bf16 v[8:11], v[184:187], v[60:63], v[8:11]
    v_mfma_f32_16x16x32_bf16 v[12:15], v[188:191], v[60:63], v[12:15]
    v_mfma_f32_16x16x32_bf16 v[8:11], v[192:195], v[64:67], v[8:11]
    v_mfma_f32_16x16x32_bf16 v[12:15], v[196:199], v[64:67], v[12:15]
    v_mfma_f32_16x16x32_bf16 v[8:11], v[200:203], v[68:71], v[8:11]
    v_mfma_f32_16x16x32_bf16 v[12:15], v[204:207], v[68:71], v[12:15]
    v_mfma_f32_16x16x32_bf16 v[8:11], v[208:211], v[72:75], v[8:11]
    v_mfma_f32_16x16x32_bf16 v[12:15], v[212:215], v[72:75], v[12:15]
    v_mfma_f32_16x16x32_bf16 v[8:11], v[216:219], v[76:79], v[8:11]
    v_mfma_f32_16x16x32_bf16 v[12:15], v[220:223], v[76:79], v[12:15]
    v_mfma_f32_16x16x32_bf16 v[8:11], v[224:227], v[80:83], v[8:11]
    v_mfma_f32_16x16x32_bf16 v[12:15], v[228:231], v[80:83], v[12:15]
    v_mfma_f32_16x16x32_bf16 v[8:11], v[232:235], v[84:87], v[8:11]
    v_mfma_f32_16x16x32_bf16 v[12:15], v[236:239], v[84:87], v[12:15]
    v_mfma_f32_16x16x32_bf16 v[8:11], v[240:243], v[88:91], v[8:11]
    v_mfma_f32_16x16x32_bf16 v[12:15], v[244:247], v[88:91], v[12:15]
    v_mfma_f32_16x16x32_bf16 v[8:11], v[248:251], v[92:95], v[8:11]
    v_mfma_f32_16x16x32_bf16 v[12:15], v[252:255], v[92:95], v[12:15]
    s_nop 7
    v_cvt_pk_bf16_f32 v16, v8, v9
    v_cvt_pk_bf16_f32 v17, v10, v11
    v_cvt_pk_bf16_f32 v18, v12, v13
    v_cvt_pk_bf16_f32 v19, v14, v15
    buffer_store_dwordx4 v[16:19], v3, s[4:7], s26 offen sc1
    s_waitcnt vmcnt(0)
    s_barrier
    s_cmp_lg_u32 s14, 0
    s_cbranch_scc1 GF_109
    v_mov_b32 v7, 1
    v_mov_b32 v8, 0
    s_mov_b64 exec, 1
    buffer_store_dword v7, v8, s[4:7], s27 offen sc1
    s_mov_b64 exec, -1
GF_109:
    s_add_u32 s25, s25, 0x10000
    s_add_u32 s30, s30, 0x10000
    s_add_u32 s26, s26, 0x20000
    s_add_u32 s27, s27, 256
    s_add_u32 s28, s28, 512
    s_add_u32 s24, s24, 1
    s_cmp_lt_u32 s24, 32
    s_cbranch_scc1 MKT_LOOP
    s_branch M_EXIT
G_N:
    s_lshl_b32 s65, s13, 8
    s_lshl_b32 s66, s14, 6
    s_add_u32 s20, s65, s66
    s_mul_i32 s21, s14, 36864
    v_lshrrev_b32 v6, 2, v0
    v_mul_u32_u24 v5, 8192, v6
    v_lshrrev_b32 v6, 5, v0
    v_lshlrev_b32 v6, 1, v6
    v_and_b32 v7, 3, v0
    v_xor_b32 v6, v6, v7
    v_lshl_add_u32 v5, v6, 4, v5
    v_lshrrev_b32 v6, 5, v0
    v_lshlrev_b32 v3, 10, v6
    v_bfe_u32 v6, v0, 2, 2
    v_lshl_add_u32 v3, v6, 6, v3
    v_and_b32 v6, 3, v0
    v_lshl_add_u32 v3, v6, 3, v3
    v_bfe_u32 v6, v0, 4, 1
    v_lshl_add_u32 v3, v6, 9, v3
    v_add_u32 v3, s21, v3
    v_lshlrev_b32 v6, 5, v6
    v_sub_u32 v4, 32, v6
    v_add_u32 v4, v4, v3
    v_add_u32 v3, v3, v6
    s_add_u32 m0, s21, 0
    s_add_u32 s64, s20, 0x0
    buffer_load_dwordx4 v5, s[44:47], s64 offen lds
    s_add_u32 m0, s21, 1024
    s_add_u32 s64, s20, 0x20000
    buffer_load_dwordx4 v5, s[44:47], s64 offen lds
    s_add_u32 m0, s21, 2048
    s_add_u32 s64, s20, 0x40000
    buffer_load_dwordx4 v5, s[44:47], s64 offen lds
    s_add_u32 m0, s21, 3072
    s_add_u32 s64, s20, 0x60000
    buffer_load_dwordx4 v5, s[44:47], s64 offen lds
    s_add_u32 m0, s21, 4096
    s_add_u32 s64, s20, 0x80000
    buffer_load_dwordx4 v5, s[44:47], s64 offen lds
    s_add_u32 m0, s21, 5120
    s_add_u32 s64, s20, 0xa0000
    buffer_load_dwordx4 v5, s[44:47], s64 offen lds
    s_add_u32 m0, s21, 6144
    s_add_u32 s64, s20, 0xc0000
    buffer_load_dwordx4 v5, s[44:47], s64 offen lds
    s_add_u32 m0, s21, 7168
    s_add_u32 s64, s20, 0xe0000
    buffer_load_dwordx4 v5, s[44:47], s64 offen lds
    s_add_u32 m0, s21, 8192
    s_add_u32 s64, s20, 0x100000
    buffer_load_dwordx4 v5, s[44:47], s64 offen lds
    s_add_u32 m0, s21, 9216
    s_add_u32 s64, s20, 0x120000
    buffer_load_dwordx4 v5, s[44:47], s64 offen lds
    s_add_u32 m0, s21, 10240
    s_add_u32 s64, s20, 0x140000
    buffer_load_dwordx4 v5, s[44:47], s64 offen lds
    s_add_u32 m0, s21, 11264
    s_add_u32 s64, s20, 0x160000
    buffer_load_dwordx4 v5, s[44:47], s64 offen lds
    s_add_u32 m0, s21, 12288
    s_add_u32 s64, s20, 0x180000
    buffer_load_dwordx4 v5, s[44:47], s64 offen lds
    s_add_u32 m0, s21, 13312
    s_add_u32 s64, s20, 0x1a0000
    buffer_load_dwordx4 v5, s[44:47], s64 offen lds
    s_add_u32 m0, s21, 14336
    s_add_u32 s64, s20, 0x1c0000
    buffer_load_dwordx4 v5, s[44:47], s64 offen lds
    s_add_u32 m0, s21, 15360
    s_add_u32 s64, s20, 0x1e0000
    buffer_load_dwordx4 v5, s[44:47], s64 offen lds
    s_add_u32 m0, s21, 16384
    s_add_u32 s64, s20, 0x200000
    buffer_load_dwordx4 v5, s[44:47], s64 offen lds
    s_add_u32 m0, s21, 17408
    s_add_u32 s64, s20, 0x220000
    buffer_load_dwordx4 v5, s[44:47], s64 offen lds
    s_add_u32 m0, s21, 18432
    s_add_u32 s64, s20, 0x240000
    buffer_load_dwordx4 v5, s[44:47], s64 offen lds
    s_add_u32 m0, s21, 19456
    s_add_u32 s64, s20, 0x260000
    buffer_load_dwordx4 v5, s[44:47], s64 offen lds
    s_add_u32 m0, s21, 20480
    s_add_u32 s64, s20, 0x280000
    buffer_load_dwordx4 v5, s[44:47], s64 offen lds
    s_add_u32 m0, s21, 21504
    s_add_u32 s64, s20, 0x2a0000
    buffer_load_dwordx4 v5, s[44:47], s64 offen lds
    s_add_u32 m0, s21, 22528
    s_add_u32 s64, s20, 0x2c0000
    buffer_load_dwordx4 v5, s[44:47], s64 offen lds
    s_add_u32 m0, s21, 23552
    s_add_u32 s64, s20, 0x2e0000
    buffer_load_dwordx4 v5, s[44:47], s64 offen lds
    s_add_u32 m0, s21, 24576
    s_add_u32 s64, s20, 0x300000
    buffer_load_dwordx4 v5, s[44:47], s64 offen lds
    s_add_u32 m0, s21, 25600
    s_add_u32 s64, s20, 0x320000
    buffer_load_dwordx4 v5, s[44:47], s64 offen lds
    s_add_u32 m0, s21, 26624
    s_add_u32 s64, s20, 0x340000
    buffer_load_dwordx4 v5, s[44:47], s64 offen lds
    s_add_u32 m0, s21, 27648
    s_add_u32 s64, s20, 0x360000
    buffer_load_dwordx4 v5, s[44:47], s64 offen lds
    s_add_u32 m0, s21, 28672
    s_add_u32 s64, s20, 0x380000
    buffer_load_dwordx4 v5, s[44:47], s64 offen lds
    s_add_u32 m0, s21, 29696
    s_add_u32 s64, s20, 0x3a0000
    buffer_load_dwordx4 v5, s[44:47], s64 offen lds
    s_add_u32 m0, s21, 30720
    s_add_u32 s64, s20, 0x3c0000
    buffer_load_dwordx4 v5, s[44:47], s64 offen lds
    s_add_u32 m0, s21, 31744
    s_add_u32 s64, s20, 0x3e0000
    buffer_load_dwordx4 v5, s[44:47], s64 offen lds
    s_add_u32 m0, s21, 32768
    s_add_u32 s64, s20, 0x400000
    buffer_load_dwordx4 v5, s[44:47], s64 offen lds
    s_add_u32 m0, s21, 33792
    s_add_u32 s64, s20, 0x420000
    buffer_load_dwordx4 v5, s[44:47], s64 offen lds
    s_add_u32 m0, s21, 34816
    s_add_u32 s64, s20, 0x440000
    buffer_load_dwordx4 v5, s[44:47], s64 offen lds
    s_add_u32 m0, s21, 35840
    s_add_u32 s64, s20, 0x460000
    buffer_load_dwordx4 v5, s[44:47], s64 offen lds
    s_waitcnt vmcnt(32)
    ds_read_b64_tr_b16 v[96:97], v3 offset:0
    ds_read_b64_tr_b16 v[98:99], v3 offset:256
    ds_read_b64_tr_b16 v[100:101], v4 offset:0
    ds_read_b64_tr_b16 v[102:103], v4 offset:256
    ds_read_b64_tr_b16 v[104:105], v3 offset:2048
    ds_read_b64_tr_b16 v[106:107], v3 offset:2304
    ds_read_b64_tr_b16 v[108:109], v4 offset:2048
    ds_read_b64_tr_b16 v[110:111], v4 offset:2304
    s_waitcnt lgkmcnt(0)
    s_add_u32 m0, s21, 0
    s_add_u32 s64, s20, 0x480000
    buffer_load_dwordx4 v5, s[44:47], s64 offen lds
    s_add_u32 m0, s21, 1024
    s_add_u32 s64, s20, 0x4a0000
    buffer_load_dwordx4 v5, s[44:47], s64 offen lds
    s_add_u32 m0, s21, 2048
    s_add_u32 s64, s20, 0x4c0000
    buffer_load_dwordx4 v5, s[44:47], s64 offen lds
    s_add_u32 m0, s21, 3072
    s_add_u32 s64, s20, 0x4e0000
    buffer_load_dwordx4 v5, s[44:47], s64 offen lds
    s_waitcnt vmcnt(32)
    ds_read_b64_tr_b16 v[112:113], v3 offset:4096
    ds_read_b64_tr_b16 v[114:115], v3 offset:4352
    ds_read_b64_tr_b16 v[116:117], v4 offset:4096
    ds_read_b64_tr_b16 v[118:119], v4 offset:4352
    ds_read_b64_tr_b16 v[120:121], v3 offset:6144
    ds_read_b64_tr_b16 v[122:123], v3 offset:6400
    ds_read_b64_tr_b16 v[124:125], v4 offset:6144
    ds_read_b64_tr_b16 v[126:127], v4 offset:6400
    s_waitcnt lgkmcnt(0)
    s_waitcnt vmcnt(28)
    ds_read_b64_tr_b16 v[128:129], v3 offset:8192
    ds_read_b64_tr_b16 v[130:131], v3 offset:8448
    ds_read_b64_tr_b16 v[132:133], v4 offset:8192
    ds_read_b64_tr_b16 v[134:135], v4 offset:8448
    ds_read_b64_tr_b16 v[136:137], v3 offset:10240
    ds_read_b64_tr_b16 v[138:139], v3 offset:10496
    ds_read_b64_tr_b16 v[140:141], v4 offset:10240
    ds_read_b64_tr_b16 v[142:143], v4 offset:10496
    s_waitcnt lgkmcnt(0)
    s_waitcnt vmcnt(24)
    ds_read_b64_tr_b16 v[144:145], v3 offset:12288
    ds_read_b64_tr_b16 v[146:147], v3 offset:12544
    ds_read_b64_tr_b16 v[148:149], v4 offset:12288
    ds_read_b64_tr_b16 v[150:151], v4 offset:12544
    ds_read_b64_tr_b16 v[152:153], v3 offset:14336
    ds_read_b64_tr_b16 v[154:155], v3 offset:14592
    ds_read_b64_tr_b16 v[156:157], v4 offset:14336
    ds_read_b64_tr_b16 v[158:159], v4 offset:14592
    s_waitcnt lgkmcnt(0)
    s_waitcnt vmcnt(20)
    ds_read_b64_tr_b16 v[160:161], v3 offset:16384
    ds_read_b64_tr_b16 v[162:163], v3 offset:16640
    ds_read_b64_tr_b16 v[164:165], v4 offset:16384
    ds_read_b64_tr_b16 v[166:167], v4 offset:16640
    ds_read_b64_tr_b16 v[168:169], v3 offset:18432
    ds_read_b64_tr_b16 v[170:171], v3 offset:18688
    ds_read_b64_tr_b16 v[172:173], v4 offset:18432
    ds_read_b64_tr_b16 v[174:175], v4 offset:18688
    s_waitcnt lgkmcnt(0)
    s_waitcnt vmcnt(16)
    ds_read_b64_tr_b16 v[176:177], v3 offset:20480
    ds_read_b64_tr_b16 v[178:179], v3 offset:20736
    ds_read_b64_tr_b16 v[180:181], v4 offset:20480
    ds_read_b64_tr_b16 v[182:183], v4 offset:20736
    ds_read_b64_tr_b16 v[184:185], v3 offset:22528
    ds_read_b64_tr_b16 v[186:187], v3 offset:22784
    ds_read_b64_tr_b16 v[188:189], v4 offset:22528
    ds_read_b64_tr_b16 v[190:191], v4 offset:22784
    s_waitcnt lgkmcnt(0)
    s_waitcnt vmcnt(12)
    ds_read_b64_tr_b16 v[192:193], v3 offset:24576
    ds_read_b64_tr_b16 v[194:195], v3 offset:24832
    ds_read_b64_tr_b16 v[196:197], v4 offset:24576
    ds_read_b64_tr_b16 v[198:199], v4 offset:24832
    ds_read_b64_tr_b16 v[200:201], v3 offset:26624
    ds_read_b64_tr_b16 v[202:203], v3 offset:26880
    ds_read_b64_tr_b16 v[204:205], v4 offset:26624
    ds_read_b64_tr_b16 v[206:207], v4 offset:26880
    s_waitcnt lgkmcnt(0)
    s_waitcnt vmcnt(8)
    ds_read_b64_tr_b16 v[208:209], v3 offset:28672
    ds_read_b64_tr_b16 v[210:211], v3 offset:28928
    ds_read_b64_tr_b16 v[212:213], v4 offset:28672
    ds_read_b64_tr_b16 v[214:215], v4 offset:28928
    ds_read_b64_tr_b16 v[216:217], v3 offset:30720
    ds_read_b64_tr_b16 v[218:219], v3 offset:30976
    ds_read_b64_tr_b16 v[220:221], v4 offset:30720
    ds_read_b64_tr_b16 v[222:223], v4 offset:30976
    s_waitcnt lgkmcnt(0)
    s_waitcnt vmcnt(4)
    ds_read_b64_tr_b16 v[224:225], v3 offset:32768
    ds_read_b64_tr_b16 v[226:227], v3 offset:33024
    ds_read_b64_tr_b16 v[228:229], v4 offset:32768
    ds_read_b64_tr_b16 v[230:231], v4 offset:33024
    ds_read_b64_tr_b16 v[232:233], v3 offset:34816
    ds_read_b64_tr_b16 v[234:235], v3 offset:35072
    ds_read_b64_tr_b16 v[236:237], v4 offset:34816
    ds_read_b64_tr_b16 v[238:239], v4 offset:35072
    s_waitcnt lgkmcnt(0)
    s_waitcnt vmcnt(0)
    ds_read_b64_tr_b16 v[240:241], v3 offset:0
    ds_read_b64_tr_b16 v[242:243], v3 offset:256
    ds_read_b64_tr_b16 v[244:245], v4 offset:0
    ds_read_b64_tr_b16 v[246:247], v4 offset:256
    ds_read_b64_tr_b16 v[248:249], v3 offset:2048
    ds_read_b64_tr_b16 v[250:251], v3 offset:2304
    ds_read_b64_tr_b16 v[252:253], v4 offset:2048
    ds_read_b64_tr_b16 v[254:255], v4 offset:2304
    s_waitcnt lgkmcnt(0)
    s_cmp_lg_u32 s97, 0
    s_cbranch_scc1 CM_110
    v_mbcnt_lo_u32_b32 v0, -1, 0
    v_mbcnt_hi_u32_b32 v0, -1, v0
    v_mul_u32_u24 v8, 32, v0
    s_mov_b32 s64, 0x0
    s_mov_b32 s65, 0
    s_mov_b64 exec, 0xff
TK_111:
    buffer_load_dword v9, v8, s[60:63], s64 offen sc1
    s_add_u32 s65, s65, 1
    s_waitcnt vmcnt(0)
    s_mov_b32 s66, 0
    v_readlane_b32 s67, v9, 0
    s_add_u32 s66, s66, s67
    v_readlane_b32 s67, v9, 1
    s_add_u32 s66, s66, s67
    v_readlane_b32 s67, v9, 2
    s_add_u32 s66, s66, s67
    v_readlane_b32 s67, v9, 3
    s_add_u32 s66, s66, s67
    v_readlane_b32 s67, v9, 4
    s_add_u32 s66, s66, s67
    v_readlane_b32 s67, v9, 5
    s_add_u32 s66, s66, s67
    v_readlane_b32 s67, v9, 6
    s_add_u32 s66, s66, s67
    v_readlane_b32 s67, v9, 7
    s_add_u32 s66, s66, s67
    s_cmp_ge_u32 s66, 256
    s_cbranch_scc1 TKD_112
    s_cmp_gt_u32 s65, 262144
    s_cbranch_scc0 TK_111
TKD_112:
    v_cmp_ne_u32 vcc, 32, v9
    s_mov_b64 exec, -1
    s_cbranch_vccnz M_SLOW
CM_110:
    s_mov_b32 s65, 0
GI_113:
    buffer_load_dword v8, off, s[60:63], s95 sc1
    s_add_u32 s65, s65, 1
    s_waitcnt vmcnt(0)
    v_readfirstlane_b32 s64, v8
    s_cmp_ge_u32 s64, 192
    s_cbranch_scc1 GID_114
    s_cmp_gt_u32 s65, 65536
    s_cbranch_scc1 GID_114
    s_sleep 4
    s_branch GI_113
GID_114:
    v_mbcnt_lo_u32_b32 v0, -1, 0
    v_mbcnt_hi_u32_b32 v0, -1, v0
    v_lshlrev_b32 v1, 4, v0
    v_lshrrev_b32 v6, 3, v0
    v_mul_u32_u24 v2, 1280, v6
    v_and_b32 v7, 7, v0
    v_xor_b32 v7, v7, v6
    v_lshl_add_u32 v2, v7, 4, v2
    v_bfe_u32 v6, v0, 3, 1
    v_lshlrev_b32 v9, 10, v6
    v_and_b32 v6, 7, v0
    v_lshl_add_u32 v9, v6, 7, v9
    v_lshrrev_b32 v7, 4, v0
    v_xor_b32 v7, v7, v6
    v_lshl_add_u32 v3, v7, 4, v9
    v_xor_b32 v7, 4, v7
    v_lshl_add_u32 v4, v7, 4, v9
    v_add_u32 v6, 0x10000, v3
    v_add_u32 v9, 0x10000, v4
    s_barrier
    s_mul_i32 s20, s12, 163840
    s_mul_i32 s64, s14, 40960
    s_add_u32 s20, s20, s64
    s_add_u32 s20, s20, 0x0
    s_lshl_b32 s21, s14, 12
    s_add_u32 m0, s21, 0
    s_add_u32 s64, s20, 0x0
    buffer_load_dwordx4 v2, s[4:7], s64 offen lds
    s_add_u32 m0, s21, 1024
    s_add_u32 s64, s20, 0x2800
    buffer_load_dwordx4 v2, s[4:7], s64 offen lds
    s_add_u32 m0, s21, 2048
    s_add_u32 s64, s20, 0x5000
    buffer_load_dwordx4 v2, s[4:7], s64 offen lds
    s_add_u32 m0, s21, 3072
    s_add_u32 s64, s20, 0x7800
    buffer_load_dwordx4 v2, s[4:7], s64 offen lds
    s_add_u32 m0, s21, 16384
    s_add_u32 s64, s20, 0x80
    buffer_load_dwordx4 v2, s[4:7], s64 offen lds
    s_add_u32 m0, s21, 17408
    s_add_u32 s64, s20, 0x2880
    buffer_load_dwordx4 v2, s[4:7], s64 offen lds
    s_add_u32 m0, s21, 18432
    s_add_u32 s64, s20, 0x5080
    buffer_load_dwordx4 v2, s[4:7], s64 offen lds
    s_add_u32 m0, s21, 19456
    s_add_u32 s64, s20, 0x7880
    buffer_load_dwordx4 v2, s[4:7], s64 offen lds
    s_add_u32 m0, s21, 32768
    s_add_u32 s64, s20, 0x100
    buffer_load_dwordx4 v2, s[4:7], s64 offen lds
    s_add_u32 m0, s21, 33792
    s_add_u32 s64, s20, 0x2900
    buffer_load_dwordx4 v2, s[4:7], s64 offen lds
    s_add_u32 m0, s21, 34816
    s_add_u32 s64, s20, 0x5100
    buffer_load_dwordx4 v2, s[4:7], s64 offen lds
    s_add_u32 m0, s21, 35840
    s_add_u32 s64, s20, 0x7900
    buffer_load_dwordx4 v2, s[4:7], s64 offen lds
    s_add_u32 m0, s21, 49152
    s_add_u32 s64, s20, 0x180
    buffer_load_dwordx4 v2, s[4:7], s64 offen lds
    s_add_u32 m0, s21, 50176
    s_add_u32 s64, s20, 0x2980
    buffer_load_dwordx4 v2, s[4:7], s64 offen lds
    s_add_u32 m0, s21, 51200
    s_add_u32 s64, s20, 0x5180
    buffer_load_dwordx4 v2, s[4:7], s64 offen lds
    s_add_u32 m0, s21, 52224
    s_add_u32 s64, s20, 0x7980
    buffer_load_dwordx4 v2, s[4:7], s64 offen lds
    s_mov_b32 s64, 0x40000000
    buffer_store_dword v7, v1, s[4:7], s64 offen
    buffer_store_dword v7, v1, s[4:7], s64 offen
    buffer_store_dword v7, v1, s[4:7], s64 offen
    buffer_store_dword v7, v1, s[4:7], s64 offen
    buffer_store_dword v7, v1, s[4:7], s64 offen
    buffer_store_dword v7, v1, s[4:7], s64 offen
    buffer_store_dword v7, v1, s[4:7], s64 offen
    buffer_store_dword v7, v1, s[4:7], s64 offen
    s_waitcnt vmcnt(20)
    s_barrier
    ds_read_b128 a[0:3], v3 offset:0
    ds_read_b128 a[4:7], v3 offset:2048
    ds_read_b128 a[8:11], v3 offset:4096
    ds_read_b128 a[12:15], v3 offset:6144
    ds_read_b128 a[16:19], v3 offset:8192
    ds_read_b128 a[20:23], v3 offset:10240
    ds_read_b128 a[24:27], v3 offset:12288
    ds_read_b128 a[28:31], v3 offset:14336
    s_mov_b32 s19, 0
    s_mov_b32 s22, s16
    s_mov_b32 s23, 0x40000000
G_N_LOOP:
    s_waitcnt lgkmcnt(4)
    v_mfma_f32_16x16x32_bf16 v[16:19], a[0:3], v[96:99], 0
    v_mfma_f32_16x16x32_bf16 v[20:23], a[0:3], v[100:103], 0
    ds_read_b128 a[32:35], v4 offset:0
    v_mfma_f32_16x16x32_bf16 v[24:27], a[4:7], v[96:99], 0
    v_mfma_f32_16x16x32_bf16 v[28:31], a[4:7], v[100:103], 0
    ds_read_b128 a[36:39], v4 offset:2048
    v_mfma_f32_16x16x32_bf16 v[32:35], a[8:11], v[96:99], 0
    v_mfma_f32_16x16x32_bf16 v[36:39], a[8:11], v[100:103], 0
    ds_read_b128 a[40:43], v4 offset:4096
    v_mfma_f32_16x16x32_bf16 v[40:43], a[12:15], v[96:99], 0
    v_mfma_f32_16x16x32_bf16 v[44:47], a[12:15], v[100:103], 0
    ds_read_b128 a[44:47], v4 offset:6144
    s_waitcnt lgkmcnt(4)
    v_mfma_f32_16x16x32_bf16 v[48:51], a[16:19], v[96:99], 0
    v_mfma_f32_16x16x32_bf16 v[52:55], a[16:19], v[100:103], 0
    ds_read_b128 a[48:51], v4 offset:8192
    v_mfma_f32_16x16x32_bf16 v[56:59], a[20:23], v[96:99], 0
    v_mfma_f32_16x16x32_bf16 v[60:63], a[20:23], v[100:103], 0
    ds_read_b128 a[52:55], v4 offset:10240
    v_mfma_f32_16x16x32_bf16 v[64:67], a[24:27], v[96:99], 0
    v_mfma_f32_16x16x32_bf16 v[68:71], a[24:27], v[100:103], 0
    ds_read_b128 a[56:59], v4 offset:12288
    v_mfma_f32_16x16x32_bf16 v[72:75], a[28:31], v[96:99], 0
    v_mfma_f32_16x16x32_bf16 v[76:79], a[28:31], v[100:103], 0
    ds_read_b128 a[60:63], v4 offset:14336
    s_waitcnt vmcnt(16)
    s_barrier
    s_waitcnt lgkmcnt(4)
    v_mfma_f32_16x16x32_bf16 v[16:19], a[32:35], v[104:107], v[16:19]
    v_mfma_f32_16x16x32_bf16 v[20:23], a[32:35], v[108:111], v[20:23]
    ds_read_b128 a[0:3], v3 offset:16384
    s_add_u32 m0, s21, 65536
    v_mfma_f32_16x16x32_bf16 v[24:27], a[36:39], v[104:107], v[24:27]
    v_mfma_f32_16x16x32_bf16 v[28:31], a[36:39], v[108:111], v[28:31]
    ds_read_b128 a[4:7], v3 offset:18432
    s_add_u32 s64, s20, 0x200
    buffer_load_dwordx4 v2, s[4:7], s64 offen lds
    v_mfma_f32_16x16x32_bf16 v[32:35], a[40:43], v[104:107], v[32:35]
    v_mfma_f32_16x16x32_bf16 v[36:39], a[40:43], v[108:111], v[36:39]
    ds_read_b128 a[8:11], v3 offset:20480
    s_add_u32 m0, s21, 66560
    v_mfma_f32_16x16x32_bf16 v[40:43], a[44:47], v[104:107], v[40:43]
    v_mfma_f32_16x16x32_bf16 v[44:47], a[44:47], v[108:111], v[44:47]
    ds_read_b128 a[12:15], v3 offset:22528
    s_add_u32 s64, s20, 0x2a00
    buffer_load_dwordx4 v2, s[4:7], s64 offen lds
    s_waitcnt lgkmcnt(4)
    v_mfma_f32_16x16x32_bf16 v[48:51], a[48:51], v[104:107], v[48:51]
    v_mfma_f32_16x16x32_bf16 v[52:55], a[48:51], v[108:111], v[52:55]
    ds_read_b128 a[16:19], v3 offset:24576
    s_add_u32 m0, s21, 67584
    v_mfma_f32_16x16x32_bf16 v[56:59], a[52:55], v[104:107], v[56:59]
    v_mfma_f32_16x16x32_bf16 v[60:63], a[52:55], v[108:111], v[60:63]
    ds_read_b128 a[20:23], v3 offset:26624
    s_add_u32 s64, s20, 0x5200
    buffer_load_dwordx4 v2, s[4:7], s64 offen lds
    v_mfma_f32_16x16x32_bf16 v[64:67], a[56:59], v[104:107], v[64:67]
    v_mfma_f32_16x16x32_bf16 v[68:71], a[56:59], v[108:111], v[68:71]
    ds_read_b128 a[24:27], v3 offset:28672
    s_add_u32 m0, s21, 68608
    v_mfma_f32_16x16x32_bf16 v[72:75], a[60:63], v[104:107], v[72:75]
    v_mfma_f32_16x16x32_bf16 v[76:79], a[60:63], v[108:111], v[76:79]
    ds_read_b128 a[28:31], v3 offset:30720
    s_add_u32 s64, s20, 0x7a00
    buffer_load_dwordx4 v2, s[4:7], s64 offen lds
    s_waitcnt lgkmcnt(4)
    v_mfma_f32_16x16x32_bf16 v[16:19], a[0:3], v[112:115], v[16:19]
    v_mfma_f32_16x16x32_bf16 v[20:23], a[0:3], v[116:119], v[20:23]
    ds_read_b128 a[32:35], v4 offset:16384
    v_mfma_f32_16x16x32_bf16 v[24:27], a[4:7], v[112:115], v[24:27]
    v_mfma_f32_16x16x32_bf16 v[28:31], a[4:7], v[116:119], v[28:31]
    ds_read_b128 a[36:39], v4 offset:18432
    v_mfma_f32_16x16x32_bf16 v[32:35], a[8:11], v[112:115], v[32:35]
    v_mfma_f32_16x16x32_bf16 v[36:39], a[8:11], v[116:119], v[36:39]
    ds_read_b128 a[40:43], v4 offset:20480
    v_mfma_f32_16x16x32_bf16 v[40:43], a[12:15], v[112:115], v[40:43]
    v_mfma_f32_16x16x32_bf16 v[44:47], a[12:15], v[116:119], v[44:47]
    ds_read_b128 a[44:47], v4 offset:22528
    s_waitcnt lgkmcnt(4)
    v_mfma_f32_16x16x32_bf16 v[48:51], a[16:19], v[112:115], v[48:51]
    v_mfma_f32_16x16x32_bf16 v[52:55], a[16:19], v[116:119], v[52:55]
    ds_read_b128 a[48:51], v4 offset:24576
    v_mfma_f32_16x16x32_bf16 v[56:59], a[20:23], v[112:115], v[56:59]
    v_mfma_f32_16x16x32_bf16 v[60:63], a[20:23], v[116:119], v[60:63]
    ds_read_b128 a[52:55], v4 offset:26624
    v_mfma_f32_16x16x32_bf16 v[64:67], a[24:27], v[112:115], v[64:67]
    v_mfma_f32_16x16x32_bf16 v[68:71], a[24:27], v[116:119], v[68:71]
    ds_read_b128 a[56:59], v4 offset:28672
    v_mfma_f32_16x16x32_bf16 v[72:75], a[28:31], v[112:115], v[72:75]
    v_mfma_f32_16x16x32_bf16 v[76:79], a[28:31], v[116:119], v[76:79]
    ds_read_b128 a[60:63], v4 offset:30720
    s_waitcnt vmcnt(16)
    s_barrier
    s_waitcnt lgkmcnt(4)
    v_mfma_f32_16x16x32_bf16 v[16:19], a[32:35], v[120:123], v[16:19]
    v_mfma_f32_16x16x32_bf16 v[20:23], a[32:35], v[124:127], v[20:23]
    ds_read_b128 a[0:3], v3 offset:32768
    s_add_u32 m0, s21, 0
    v_mfma_f32_16x16x32_bf16 v[24:27], a[36:39], v[120:123], v[24:27]
    v_mfma_f32_16x16x32_bf16 v[28:31], a[36:39], v[124:127], v[28:31]
    ds_read_b128 a[4:7], v3 offset:34816
    s_add_u32 s64, s20, 0x280
    buffer_load_dwordx4 v2, s[4:7], s64 offen lds
    v_mfma_f32_16x16x32_bf16 v[32:35], a[40:43], v[120:123], v[32:35]
    v_mfma_f32_16x16x32_bf16 v[36:39], a[40:43], v[124:127], v[36:39]
    ds_read_b128 a[8:11], v3 offset:36864
    s_add_u32 m0, s21, 1024
    v_mfma_f32_16x16x32_bf16 v[40:43], a[44:47], v[120:123], v[40:43]
    v_mfma_f32_16x16x32_bf16 v[44:47], a[44:47], v[124:127], v[44:47]
    ds_read_b128 a[12:15], v3 offset:38912
    s_add_u32 s64, s20, 0x2a80
    buffer_load_dwordx4 v2, s[4:7], s64 offen lds
    s_waitcnt lgkmcnt(4)
    v_mfma_f32_16x16x32_bf16 v[48:51], a[48:51], v[120:123], v[48:51]
    v_mfma_f32_16x16x32_bf16 v[52:55], a[48:51], v[124:127], v[52:55]
    ds_read_b128 a[16:19], v3 offset:40960
    s_add_u32 m0, s21, 2048
    v_mfma_f32_16x16x32_bf16 v[56:59], a[52:55], v[120:123], v[56:59]
    v_mfma_f32_16x16x32_bf16 v[60:63], a[52:55], v[124:127], v[60:63]
    ds_read_b128 a[20:23], v3 offset:43008
    s_add_u32 s64, s20, 0x5280
    buffer_load_dwordx4 v2, s[4:7], s64 offen lds
    v_mfma_f32_16x16x32_bf16 v[64:67], a[56:59], v[120:123], v[64:67]
    v_mfma_f32_16x16x32_bf16 v[68:71], a[56:59], v[124:127], v[68:71]
    ds_read_b128 a[24:27], v3 offset:45056
    s_add_u32 m0, s21, 3072
    v_mfma_f32_16x16x32_bf16 v[72:75], a[60:63], v[120:123], v[72:75]
    v_mfma_f32_16x16x32_bf16 v[76:79], a[60:63], v[124:127], v[76:79]
    ds_read_b128 a[28:31], v3 offset:47104
    s_add_u32 s64, s20, 0x7a80
    buffer_load_dwordx4 v2, s[4:7], s64 offen lds
    s_waitcnt lgkmcnt(4)
    v_mfma_f32_16x16x32_bf16 v[16:19], a[0:3], v[128:131], v[16:19]
    v_mfma_f32_16x16x32_bf16 v[20:23], a[0:3], v[132:135], v[20:23]
    ds_read_b128 a[32:35], v4 offset:32768
    v_mfma_f32_16x16x32_bf16 v[24:27], a[4:7], v[128:131], v[24:27]
    v_mfma_f32_16x16x32_bf16 v[28:31], a[4:7], v[132:135], v[28:31]
    ds_read_b128 a[36:39], v4 offset:34816
    v_mfma_f32_16x16x32_bf16 v[32:35], a[8:11], v[128:131], v[32:35]
    v_mfma_f32_16x16x32_bf16 v[36:39], a[8:11], v[132:135], v[36:39]
    ds_read_b128 a[40:43], v4 offset:36864
    v_mfma_f32_16x16x32_bf16 v[40:43], a[12:15], v[128:131], v[40:43]
    v_mfma_f32_16x16x32_bf16 v[44:47], a[12:15], v[132:135], v[44:47]
    ds_read_b128 a[44:47], v4 offset:38912
    s_waitcnt lgkmcnt(4)
    v_mfma_f32_16x16x32_bf16 v[48:51], a[16:19], v[128:131], v[48:51]
    v_mfma_f32_16x16x32_bf16 v[52:55], a[16:19], v[132:135], v[52:55]
    ds_read_b128 a[48:51], v4 offset:40960
    v_mfma_f32_16x16x32_bf16 v[56:59], a[20:23], v[128:131], v[56:59]
    v_mfma_f32_16x16x32_bf16 v[60:63], a[20:23], v[132:135], v[60:63]
    ds_read_b128 a[52:55], v4 offset:43008
    v_mfma_f32_16x16x32_bf16 v[64:67], a[24:27], v[128:131], v[64:67]
    v_mfma_f32_16x16x32_bf16 v[68:71], a[24:27], v[132:135], v[68:71]
    ds_read_b128 a[56:59], v4 offset:45056
    v_mfma_f32_16x16x32_bf16 v[72:75], a[28:31], v[128:131], v[72:75]
    v_mfma_f32_16x16x32_bf16 v[76:79], a[28:31], v[132:135], v[76:79]
    ds_read_b128 a[60:63], v4 offset:47104
    s_waitcnt vmcnt(16)
    s_barrier
    s_waitcnt lgkmcnt(4)
    v_mfma_f32_16x16x32_bf16 v[16:19], a[32:35], v[136:139], v[16:19]
    v_mfma_f32_16x16x32_bf16 v[20:23], a[32:35], v[140:143], v[20:23]
    ds_read_b128 a[0:3], v3 offset:49152
    s_add_u32 m0, s21, 16384
    v_mfma_f32_16x16x32_bf16 v[24:27], a[36:39], v[136:139], v[24:27]
    v_mfma_f32_16x16x32_bf16 v[28:31], a[36:39], v[140:143], v[28:31]
    ds_read_b128 a[4:7], v3 offset:51200
    s_add_u32 s64, s20, 0x300
    buffer_load_dwordx4 v2, s[4:7], s64 offen lds
    v_mfma_f32_16x16x32_bf16 v[32:35], a[40:43], v[136:139], v[32:35]
    v_mfma_f32_16x16x32_bf16 v[36:39], a[40:43], v[140:143], v[36:39]
    ds_read_b128 a[8:11], v3 offset:53248
    s_add_u32 m0, s21, 17408
    v_mfma_f32_16x16x32_bf16 v[40:43], a[44:47], v[136:139], v[40:43]
    v_mfma_f32_16x16x32_bf16 v[44:47], a[44:47], v[140:143], v[44:47]
    ds_read_b128 a[12:15], v3 offset:55296
    s_add_u32 s64, s20, 0x2b00
    buffer_load_dwordx4 v2, s[4:7], s64 offen lds
    s_waitcnt lgkmcnt(4)
    v_mfma_f32_16x16x32_bf16 v[48:51], a[48:51], v[136:139], v[48:51]
    v_mfma_f32_16x16x32_bf16 v[52:55], a[48:51], v[140:143], v[52:55]
    ds_read_b128 a[16:19], v3 offset:57344
    s_add_u32 m0, s21, 18432
    v_mfma_f32_16x16x32_bf16 v[56:59], a[52:55], v[136:139], v[56:59]
    v_mfma_f32_16x16x32_bf16 v[60:63], a[52:55], v[140:143], v[60:63]
    ds_read_b128 a[20:23], v3 offset:59392
    s_add_u32 s64, s20, 0x5300
    buffer_load_dwordx4 v2, s[4:7], s64 offen lds
    v_mfma_f32_16x16x32_bf16 v[64:67], a[56:59], v[136:139], v[64:67]
    v_mfma_f32_16x16x32_bf16 v[68:71], a[56:59], v[140:143], v[68:71]
    ds_read_b128 a[24:27], v3 offset:61440
    s_add_u32 m0, s21, 19456
    v_mfma_f32_16x16x32_bf16 v[72:75], a[60:63], v[136:139], v[72:75]
    v_mfma_f32_16x16x32_bf16 v[76:79], a[60:63], v[140:143], v[76:79]
    ds_read_b128 a[28:31], v3 offset:63488
    s_add_u32 s64, s20, 0x7b00
    buffer_load_dwordx4 v2, s[4:7], s64 offen lds
    s_waitcnt lgkmcnt(4)
    v_mfma_f32_16x16x32_bf16 v[16:19], a[0:3], v[144:147], v[16:19]
    v_mfma_f32_16x16x32_bf16 v[20:23], a[0:3], v[148:151], v[20:23]
    ds_read_b128 a[32:35], v4 offset:49152
    v_mfma_f32_16x16x32_bf16 v[24:27], a[4:7], v[144:147], v[24:27]
    v_mfma_f32_16x16x32_bf16 v[28:31], a[4:7], v[148:151], v[28:31]
    ds_read_b128 a[36:39], v4 offset:51200
    v_mfma_f32_16x16x32_bf16 v[32:35], a[8:11], v[144:147], v[32:35]
    v_mfma_f32_16x16x32_bf16 v[36:39], a[8:11], v[148:151], v[36:39]
    ds_read_b128 a[40:43], v4 offset:53248
    v_mfma_f32_16x16x32_bf16 v[40:43], a[12:15], v[144:147], v[40:43]
    v_mfma_f32_16x16x32_bf16 v[44:47], a[12:15], v[148:151], v[44:47]
    ds_read_b128 a[44:47], v4 offset:55296
    s_waitcnt lgkmcnt(4)
    v_mfma_f32_16x16x32_bf16 v[48:51], a[16:19], v[144:147], v[48:51]
    v_mfma_f32_16x16x32_bf16 v[52:55], a[16:19], v[148:151], v[52:55]
    ds_read_b128 a[48:51], v4 offset:57344
    v_mfma_f32_16x16x32_bf16 v[56:59], a[20:23], v[144:147], v[56:59]
    v_mfma_f32_16x16x32_bf16 v[60:63], a[20:23], v[148:151], v[60:63]
    ds_read_b128 a[52:55], v4 offset:59392
    v_mfma_f32_16x16x32_bf16 v[64:67], a[24:27], v[144:147], v[64:67]
    v_mfma_f32_16x16x32_bf16 v[68:71], a[24:27], v[148:151], v[68:71]
    ds_read_b128 a[56:59], v4 offset:61440
    v_mfma_f32_16x16x32_bf16 v[72:75], a[28:31], v[144:147], v[72:75]
    v_mfma_f32_16x16x32_bf16 v[76:79], a[28:31], v[148:151], v[76:79]
    ds_read_b128 a[60:63], v4 offset:63488
    s_waitcnt vmcnt(8)
    s_barrier
    s_cmp_lg_u32 s14, 0
    s_cbranch_scc1 GF_115
    v_mov_b32 v7, 1
    v_mov_b32 v8, 0
    s_mov_b64 exec, 1
    buffer_store_dword v7, v8, s[4:7], s23 offen sc1
    s_mov_b64 exec, -1
GF_115:
    s_waitcnt lgkmcnt(4)
    v_mfma_f32_16x16x32_bf16 v[16:19], a[32:35], v[152:155], v[16:19]
    v_mfma_f32_16x16x32_bf16 v[20:23], a[32:35], v[156:159], v[20:23]
    ds_read_b128 a[0:3], v6 offset:0
    s_add_u32 m0, s21, 32768
    v_mfma_f32_16x16x32_bf16 v[24:27], a[36:39], v[152:155], v[24:27]
    v_mfma_f32_16x16x32_bf16 v[28:31], a[36:39], v[156:159], v[28:31]
    ds_read_b128 a[4:7], v6 offset:2048
    s_add_u32 s64, s20, 0x380
    buffer_load_dwordx4 v2, s[4:7], s64 offen lds
    v_mfma_f32_16x16x32_bf16 v[32:35], a[40:43], v[152:155], v[32:35]
    v_mfma_f32_16x16x32_bf16 v[36:39], a[40:43], v[156:159], v[36:39]
    ds_read_b128 a[8:11], v6 offset:4096
    s_add_u32 m0, s21, 33792
    v_mfma_f32_16x16x32_bf16 v[40:43], a[44:47], v[152:155], v[40:43]
    v_mfma_f32_16x16x32_bf16 v[44:47], a[44:47], v[156:159], v[44:47]
    ds_read_b128 a[12:15], v6 offset:6144
    s_add_u32 s64, s20, 0x2b80
    buffer_load_dwordx4 v2, s[4:7], s64 offen lds
    s_waitcnt lgkmcnt(4)
    v_mfma_f32_16x16x32_bf16 v[48:51], a[48:51], v[152:155], v[48:51]
    v_mfma_f32_16x16x32_bf16 v[52:55], a[48:51], v[156:159], v[52:55]
    ds_read_b128 a[16:19], v6 offset:8192
    s_add_u32 m0, s21, 34816
    v_mfma_f32_16x16x32_bf16 v[56:59], a[52:55], v[152:155], v[56:59]
    v_mfma_f32_16x16x32_bf16 v[60:63], a[52:55], v[156:159], v[60:63]
    ds_read_b128 a[20:23], v6 offset:10240
    s_add_u32 s64, s20, 0x5380
    buffer_load_dwordx4 v2, s[4:7], s64 offen lds
    v_mfma_f32_16x16x32_bf16 v[64:67], a[56:59], v[152:155], v[64:67]
    v_mfma_f32_16x16x32_bf16 v[68:71], a[56:59], v[156:159], v[68:71]
    ds_read_b128 a[24:27], v6 offset:12288
    s_add_u32 m0, s21, 35840
    v_mfma_f32_16x16x32_bf16 v[72:75], a[60:63], v[152:155], v[72:75]
    v_mfma_f32_16x16x32_bf16 v[76:79], a[60:63], v[156:159], v[76:79]
    ds_read_b128 a[28:31], v6 offset:14336
    s_add_u32 s64, s20, 0x7b80
    buffer_load_dwordx4 v2, s[4:7], s64 offen lds
    s_waitcnt lgkmcnt(4)
    v_mfma_f32_16x16x32_bf16 v[16:19], a[0:3], v[160:163], v[16:19]
    v_mfma_f32_16x16x32_bf16 v[20:23], a[0:3], v[164:167], v[20:23]
    ds_read_b128 a[32:35], v9 offset:0
    v_mfma_f32_16x16x32_bf16 v[24:27], a[4:7], v[160:163], v[24:27]
    v_mfma_f32_16x16x32_bf16 v[28:31], a[4:7], v[164:167], v[28:31]
    ds_read_b128 a[36:39], v9 offset:2048
    v_mfma_f32_16x16x32_bf16 v[32:35], a[8:11], v[160:163], v[32:35]
    v_mfma_f32_16x16x32_bf16 v[36:39], a[8:11], v[164:167], v[36:39]
    ds_read_b128 a[40:43], v9 offset:4096
    v_mfma_f32_16x16x32_bf16 v[40:43], a[12:15], v[160:163], v[40:43]
    v_mfma_f32_16x16x32_bf16 v[44:47], a[12:15], v[164:167], v[44:47]
    ds_read_b128 a[44:47], v9 offset:6144
    s_waitcnt lgkmcnt(4)
    v_mfma_f32_16x16x32_bf16 v[48:51], a[16:19], v[160:163], v[48:51]
    v_mfma_f32_16x16x32_bf16 v[52:55], a[16:19], v[164:167], v[52:55]
    ds_read_b128 a[48:51], v9 offset:8192
    v_mfma_f32_16x16x32_bf16 v[56:59], a[20:23], v[160:163], v[56:59]
    v_mfma_f32_16x16x32_bf16 v[60:63], a[20:23], v[164:167], v[60:63]
    ds_read_b128 a[52:55], v9 offset:10240
    v_mfma_f32_16x16x32_bf16 v[64:67], a[24:27], v[160:163], v[64:67]
    v_mfma_f32_16x16x32_bf16 v[68:71], a[24:27], v[164:167], v[68:71]
    ds_read_b128 a[56:59], v9 offset:12288
    v_mfma_f32_16x16x32_bf16 v[72:75], a[28:31], v[160:163], v[72:75]
    v_mfma_f32_16x16x32_bf16 v[76:79], a[28:31], v[164:167], v[76:79]
    ds_read_b128 a[60:63], v9 offset:14336
    s_waitcnt vmcnt(8)
    s_barrier
    s_waitcnt lgkmcnt(4)
    v_mfma_f32_16x16x32_bf16 v[16:19], a[32:35], v[168:171], v[16:19]
    v_mfma_f32_16x16x32_bf16 v[20:23], a[32:35], v[172:175], v[20:23]
    ds_read_b128 a[0:3], v3 offset:0
    s_add_u32 m0, s21, 49152
    v_mfma_f32_16x16x32_bf16 v[24:27], a[36:39], v[168:171], v[24:27]
    v_mfma_f32_16x16x32_bf16 v[28:31], a[36:39], v[172:175], v[28:31]
    ds_read_b128 a[4:7], v3 offset:2048
    s_add_u32 s64, s20, 0x400
    buffer_load_dwordx4 v2, s[4:7], s64 offen lds
    v_mfma_f32_16x16x32_bf16 v[32:35], a[40:43], v[168:171], v[32:35]
    v_mfma_f32_16x16x32_bf16 v[36:39], a[40:43], v[172:175], v[36:39]
    ds_read_b128 a[8:11], v3 offset:4096
    s_add_u32 m0, s21, 50176
    v_mfma_f32_16x16x32_bf16 v[40:43], a[44:47], v[168:171], v[40:43]
    v_mfma_f32_16x16x32_bf16 v[44:47], a[44:47], v[172:175], v[44:47]
    ds_read_b128 a[12:15], v3 offset:6144
    s_add_u32 s64, s20, 0x2c00
    buffer_load_dwordx4 v2, s[4:7], s64 offen lds
    s_waitcnt lgkmcnt(4)
    v_mfma_f32_16x16x32_bf16 v[48:51], a[48:51], v[168:171], v[48:51]
    v_mfma_f32_16x16x32_bf16 v[52:55], a[48:51], v[172:175], v[52:55]
    ds_read_b128 a[16:19], v3 offset:8192
    s_add_u32 m0, s21, 51200
    v_mfma_f32_16x16x32_bf16 v[56:59], a[52:55], v[168:171], v[56:59]
    v_mfma_f32_16x16x32_bf16 v[60:63], a[52:55], v[172:175], v[60:63]
    ds_read_b128 a[20:23], v3 offset:10240
    s_add_u32 s64, s20, 0x5400
    buffer_load_dwordx4 v2, s[4:7], s64 offen lds
    v_mfma_f32_16x16x32_bf16 v[64:67], a[56:59], v[168:171], v[64:67]
    v_mfma_f32_16x16x32_bf16 v[68:71], a[56:59], v[172:175], v[68:71]
    ds_read_b128 a[24:27], v3 offset:12288
    s_add_u32 m0, s21, 52224
    v_mfma_f32_16x16x32_bf16 v[72:75], a[60:63], v[168:171], v[72:75]
    v_mfma_f32_16x16x32_bf16 v[76:79], a[60:63], v[172:175], v[76:79]
    ds_read_b128 a[28:31], v3 offset:14336
    s_add_u32 s64, s20, 0x7c00
    buffer_load_dwordx4 v2, s[4:7], s64 offen lds
    s_waitcnt lgkmcnt(4)
    v_mfma_f32_16x16x32_bf16 v[16:19], a[0:3], v[176:179], v[16:19]
    v_mfma_f32_16x16x32_bf16 v[20:23], a[0:3], v[180:183], v[20:23]
    ds_read_b128 a[32:35], v4 offset:0
    v_mfma_f32_16x16x32_bf16 v[24:27], a[4:7], v[176:179], v[24:27]
    v_mfma_f32_16x16x32_bf16 v[28:31], a[4:7], v[180:183], v[28:31]
    ds_read_b128 a[36:39], v4 offset:2048
    v_mfma_f32_16x16x32_bf16 v[32:35], a[8:11], v[176:179], v[32:35]
    v_mfma_f32_16x16x32_bf16 v[36:39], a[8:11], v[180:183], v[36:39]
    ds_read_b128 a[40:43], v4 offset:4096
    v_mfma_f32_16x16x32_bf16 v[40:43], a[12:15], v[176:179], v[40:43]
    v_mfma_f32_16x16x32_bf16 v[44:47], a[12:15], v[180:183], v[44:47]
    ds_read_b128 a[44:47], v4 offset:6144
    s_waitcnt lgkmcnt(4)
    v_mfma_f32_16x16x32_bf16 v[48:51], a[16:19], v[176:179], v[48:51]
    v_mfma_f32_16x16x32_bf16 v[52:55], a[16:19], v[180:183], v[52:55]
    ds_read_b128 a[48:51], v4 offset:8192
    v_mfma_f32_16x16x32_bf16 v[56:59], a[20:23], v[176:179], v[56:59]
    v_mfma_f32_16x16x32_bf16 v[60:63], a[20:23], v[180:183], v[60:63]
    ds_read_b128 a[52:55], v4 offset:10240
    v_mfma_f32_16x16x32_bf16 v[64:67], a[24:27], v[176:179], v[64:67]
    v_mfma_f32_16x16x32_bf16 v[68:71], a[24:27], v[180:183], v[68:71]
    ds_read_b128 a[56:59], v4 offset:12288
    v_mfma_f32_16x16x32_bf16 v[72:75], a[28:31], v[176:179], v[72:75]
    v_mfma_f32_16x16x32_bf16 v[76:79], a[28:31], v[180:183], v[76:79]
    ds_read_b128 a[60:63], v4 offset:14336
    s_waitcnt vmcnt(8)
    s_barrier
    s_waitcnt lgkmcnt(4)
    v_mfma_f32_16x16x32_bf16 v[16:19], a[32:35], v[184:187], v[16:19]
    v_mfma_f32_16x16x32_bf16 v[20:23], a[32:35], v[188:191], v[20:23]
    ds_read_b128 a[0:3], v3 offset:16384
    s_add_u32 m0, s21, 65536
    v_mfma_f32_16x16x32_bf16 v[24:27], a[36:39], v[184:187], v[24:27]
    v_mfma_f32_16x16x32_bf16 v[28:31], a[36:39], v[188:191], v[28:31]
    ds_read_b128 a[4:7], v3 offset:18432
    s_add_u32 s64, s20, 0x480
    buffer_load_dwordx4 v2, s[4:7], s64 offen lds
    v_mfma_f32_16x16x32_bf16 v[32:35], a[40:43], v[184:187], v[32:35]
    v_mfma_f32_16x16x32_bf16 v[36:39], a[40:43], v[188:191], v[36:39]
    ds_read_b128 a[8:11], v3 offset:20480
    s_add_u32 m0, s21, 66560
    v_mfma_f32_16x16x32_bf16 v[40:43], a[44:47], v[184:187], v[40:43]
    v_mfma_f32_16x16x32_bf16 v[44:47], a[44:47], v[188:191], v[44:47]
    ds_read_b128 a[12:15], v3 offset:22528
    s_add_u32 s64, s20, 0x2c80
    buffer_load_dwordx4 v2, s[4:7], s64 offen lds
    s_waitcnt lgkmcnt(4)
    v_mfma_f32_16x16x32_bf16 v[48:51], a[48:51], v[184:187], v[48:51]
    v_mfma_f32_16x16x32_bf16 v[52:55], a[48:51], v[188:191], v[52:55]
    ds_read_b128 a[16:19], v3 offset:24576
    s_add_u32 m0, s21, 67584
    v_mfma_f32_16x16x32_bf16 v[56:59], a[52:55], v[184:187], v[56:59]
    v_mfma_f32_16x16x32_bf16 v[60:63], a[52:55], v[188:191], v[60:63]
    ds_read_b128 a[20:23], v3 offset:26624
    s_add_u32 s64, s20, 0x5480
    buffer_load_dwordx4 v2, s[4:7], s64 offen lds
    v_mfma_f32_16x16x32_bf16 v[64:67], a[56:59], v[184:187], v[64:67]
    v_mfma_f32_16x16x32_bf16 v[68:71], a[56:59], v[188:191], v[68:71]
    ds_read_b128 a[24:27], v3 offset:28672
    s_add_u32 m0, s21, 68608
    v_mfma_f32_16x16x32_bf16 v[72:75], a[60:63], v[184:187], v[72:75]
    v_mfma_f32_16x16x32_bf16 v[76:79], a[60:63], v[188:191], v[76:79]
    ds_read_b128 a[28:31], v3 offset:30720
    s_add_u32 s64, s20, 0x7c80
    buffer_load_dwordx4 v2, s[4:7], s64 offen lds
    s_waitcnt lgkmcnt(4)
    v_mfma_f32_16x16x32_bf16 v[16:19], a[0:3], v[192:195], v[16:19]
    v_mfma_f32_16x16x32_bf16 v[20:23], a[0:3], v[196:199], v[20:23]
    ds_read_b128 a[32:35], v4 offset:16384
    v_mfma_f32_16x16x32_bf16 v[24:27], a[4:7], v[192:195], v[24:27]
    v_mfma_f32_16x16x32_bf16 v[28:31], a[4:7], v[196:199], v[28:31]
    ds_read_b128 a[36:39], v4 offset:18432
    v_mfma_f32_16x16x32_bf16 v[32:35], a[8:11], v[192:195], v[32:35]
    v_mfma_f32_16x16x32_bf16 v[36:39], a[8:11], v[196:199], v[36:39]
    ds_read_b128 a[40:43], v4 offset:20480
    v_mfma_f32_16x16x32_bf16 v[40:43], a[12:15], v[192:195], v[40:43]
    v_mfma_f32_16x16x32_bf16 v[44:47], a[12:15], v[196:199], v[44:47]
    ds_read_b128 a[44:47], v4 offset:22528
    s_waitcnt lgkmcnt(4)
    v_mfma_f32_16x16x32_bf16 v[48:51], a[16:19], v[192:195], v[48:51]
    v_mfma_f32_16x16x32_bf16 v[52:55], a[16:19], v[196:199], v[52:55]
    ds_read_b128 a[48:51], v4 offset:24576
    v_mfma_f32_16x16x32_bf16 v[56:59], a[20:23], v[192:195], v[56:59]
    v_mfma_f32_16x16x32_bf16 v[60:63], a[20:23], v[196:199], v[60:63]
    ds_read_b128 a[52:55], v4 offset:26624
    v_mfma_f32_16x16x32_bf16 v[64:67], a[24:27], v[192:195], v[64:67]
    v_mfma_f32_16x16x32_bf16 v[68:71], a[24:27], v[196:199], v[68:71]
    ds_read_b128 a[56:59], v4 offset:28672
    v_mfma_f32_16x16x32_bf16 v[72:75], a[28:31], v[192:195], v[72:75]
    v_mfma_f32_16x16x32_bf16 v[76:79], a[28:31], v[196:199], v[76:79]
    ds_read_b128 a[60:63], v4 offset:30720
    s_waitcnt vmcnt(8)
    s_barrier
    s_waitcnt lgkmcnt(4)
    v_mfma_f32_16x16x32_bf16 v[16:19], a[32:35], v[200:203], v[16:19]
    v_mfma_f32_16x16x32_bf16 v[20:23], a[32:35], v[204:207], v[20:23]
    ds_read_b128 a[0:3], v3 offset:32768
    s_add_u32 m0, s21, 0
    v_mfma_f32_16x16x32_bf16 v[24:27], a[36:39], v[200:203], v[24:27]
    v_mfma_f32_16x16x32_bf16 v[28:31], a[36:39], v[204:207], v[28:31]
    ds_read_b128 a[4:7], v3 offset:34816
    s_add_u32 s64, s20, 0x50000
    buffer_load_dwordx4 v2, s[4:7], s64 offen lds
    v_mfma_f32_16x16x32_bf16 v[32:35], a[40:43], v[200:203], v[32:35]
    v_mfma_f32_16x16x32_bf16 v[36:39], a[40:43], v[204:207], v[36:39]
    ds_read_b128 a[8:11], v3 offset:36864
    s_add_u32 m0, s21, 1024
    v_mfma_f32_16x16x32_bf16 v[40:43], a[44:47], v[200:203], v[40:43]
    v_mfma_f32_16x16x32_bf16 v[44:47], a[44:47], v[204:207], v[44:47]
    ds_read_b128 a[12:15], v3 offset:38912
    s_add_u32 s64, s20, 0x52800
    buffer_load_dwordx4 v2, s[4:7], s64 offen lds
    s_waitcnt lgkmcnt(4)
    v_mfma_f32_16x16x32_bf16 v[48:51], a[48:51], v[200:203], v[48:51]
    v_mfma_f32_16x16x32_bf16 v[52:55], a[48:51], v[204:207], v[52:55]
    ds_read_b128 a[16:19], v3 offset:40960
    s_add_u32 m0, s21, 2048
    v_mfma_f32_16x16x32_bf16 v[56:59], a[52:55], v[200:203], v[56:59]
    v_mfma_f32_16x16x32_bf16 v[60:63], a[52:55], v[204:207], v[60:63]
    ds_read_b128 a[20:23], v3 offset:43008
    s_add_u32 s64, s20, 0x55000
    buffer_load_dwordx4 v2, s[4:7], s64 offen lds
    v_mfma_f32_16x16x32_bf16 v[64:67], a[56:59], v[200:203], v[64:67]
    v_mfma_f32_16x16x32_bf16 v[68:71], a[56:59], v[204:207], v[68:71]
    ds_read_b128 a[24:27], v3 offset:45056
    s_add_u32 m0, s21, 3072
    v_mfma_f32_16x16x32_bf16 v[72:75], a[60:63], v[200:203], v[72:75]
    v_mfma_f32_16x16x32_bf16 v[76:79], a[60:63], v[204:207], v[76:79]
    ds_read_b128 a[28:31], v3 offset:47104
    s_add_u32 s64, s20, 0x57800
    buffer_load_dwordx4 v2, s[4:7], s64 offen lds
    s_waitcnt lgkmcnt(4)
    v_mfma_f32_16x16x32_bf16 v[16:19], a[0:3], v[208:211], v[16:19]
    v_mfma_f32_16x16x32_bf16 v[20:23], a[0:3], v[212:215], v[20:23]
    ds_read_b128 a[32:35], v4 offset:32768
    v_mfma_f32_16x16x32_bf16 v[24:27], a[4:7], v[208:211], v[24:27]
    v_mfma_f32_16x16x32_bf16 v[28:31], a[4:7], v[212:215], v[28:31]
    ds_read_b128 a[36:39], v4 offset:34816
    v_mfma_f32_16x16x32_bf16 v[32:35], a[8:11], v[208:211], v[32:35]
    v_mfma_f32_16x16x32_bf16 v[36:39], a[8:11], v[212:215], v[36:39]
    ds_read_b128 a[40:43], v4 offset:36864
    v_mfma_f32_16x16x32_bf16 v[40:43], a[12:15], v[208:211], v[40:43]
    v_mfma_f32_16x16x32_bf16 v[44:47], a[12:15], v[212:215], v[44:47]
    ds_read_b128 a[44:47], v4 offset:38912
    s_waitcnt lgkmcnt(4)
    v_mfma_f32_16x16x32_bf16 v[48:51], a[16:19], v[208:211], v[48:51]
    v_mfma_f32_16x16x32_bf16 v[52:55], a[16:19], v[212:215], v[52:55]
    ds_read_b128 a[48:51], v4 offset:40960
    v_mfma_f32_16x16x32_bf16 v[56:59], a[20:23], v[208:211], v[56:59]
    v_mfma_f32_16x16x32_bf16 v[60:63], a[20:23], v[212:215], v[60:63]
    ds_read_b128 a[52:55], v4 offset:43008
    v_mfma_f32_16x16x32_bf16 v[64:67], a[24:27], v[208:211], v[64:67]
    v_mfma_f32_16x16x32_bf16 v[68:71], a[24:27], v[212:215], v[68:71]
    ds_read_b128 a[56:59], v4 offset:45056
    v_mfma_f32_16x16x32_bf16 v[72:75], a[28:31], v[208:211], v[72:75]
    v_mfma_f32_16x16x32_bf16 v[76:79], a[28:31], v[212:215], v[76:79]
    ds_read_b128 a[60:63], v4 offset:47104
    s_waitcnt vmcnt(8)
    s_barrier
    s_waitcnt lgkmcnt(4)
    v_mfma_f32_16x16x32_bf16 v[16:19], a[32:35], v[216:219], v[16:19]
    v_mfma_f32_16x16x32_bf16 v[20:23], a[32:35], v[220:223], v[20:23]
    ds_read_b128 a[0:3], v3 offset:49152
    s_add_u32 m0, s21, 16384
    v_mfma_f32_16x16x32_bf16 v[24:27], a[36:39], v[216:219], v[24:27]
    v_mfma_f32_16x16x32_bf16 v[28:31], a[36:39], v[220:223], v[28:31]
    ds_read_b128 a[4:7], v3 offset:51200
    s_add_u32 s64, s20, 0x50080
    buffer_load_dwordx4 v2, s[4:7], s64 offen lds
    v_mfma_f32_16x16x32_bf16 v[32:35], a[40:43], v[216:219], v[32:35]
    v_mfma_f32_16x16x32_bf16 v[36:39], a[40:43], v[220:223], v[36:39]
    ds_read_b128 a[8:11], v3 offset:53248
    s_add_u32 m0, s21, 17408
    v_mfma_f32_16x16x32_bf16 v[40:43], a[44:47], v[216:219], v[40:43]
    v_mfma_f32_16x16x32_bf16 v[44:47], a[44:47], v[220:223], v[44:47]
    ds_read_b128 a[12:15], v3 offset:55296
    s_add_u32 s64, s20, 0x52880
    buffer_load_dwordx4 v2, s[4:7], s64 offen lds
    s_waitcnt lgkmcnt(4)
    v_mfma_f32_16x16x32_bf16 v[48:51], a[48:51], v[216:219], v[48:51]
    v_mfma_f32_16x16x32_bf16 v[52:55], a[48:51], v[220:223], v[52:55]
    ds_read_b128 a[16:19], v3 offset:57344
    s_add_u32 m0, s21, 18432
    v_mfma_f32_16x16x32_bf16 v[56:59], a[52:55], v[216:219], v[56:59]
    v_mfma_f32_16x16x32_bf16 v[60:63], a[52:55], v[220:223], v[60:63]
    ds_read_b128 a[20:23], v3 offset:59392
    s_add_u32 s64, s20, 0x55080
    buffer_load_dwordx4 v2, s[4:7], s64 offen lds
    v_mfma_f32_16x16x32_bf16 v[64:67], a[56:59], v[216:219], v[64:67]
    v_mfma_f32_16x16x32_bf16 v[68:71], a[56:59], v[220:223], v[68:71]
    ds_read_b128 a[24:27], v3 offset:61440
    s_add_u32 m0, s21, 19456
    v_mfma_f32_16x16x32_bf16 v[72:75], a[60:63], v[216:219], v[72:75]
    v_mfma_f32_16x16x32_bf16 v[76:79], a[60:63], v[220:223], v[76:79]
    ds_read_b128 a[28:31], v3 offset:63488
    s_add_u32 s64, s20, 0x57880
    buffer_load_dwordx4 v2, s[4:7], s64 offen lds
    s_waitcnt lgkmcnt(4)
    v_mfma_f32_16x16x32_bf16 v[16:19], a[0:3], v[224:227], v[16:19]
    v_mfma_f32_16x16x32_bf16 v[20:23], a[0:3], v[228:231], v[20:23]
    ds_read_b128 a[32:35], v4 offset:49152
    v_mfma_f32_16x16x32_bf16 v[24:27], a[4:7], v[224:227], v[24:27]
    v_mfma_f32_16x16x32_bf16 v[28:31], a[4:7], v[228:231], v[28:31]
    ds_read_b128 a[36:39], v4 offset:51200
    v_mfma_f32_16x16x32_bf16 v[32:35], a[8:11], v[224:227], v[32:35]
    v_mfma_f32_16x16x32_bf16 v[36:39], a[8:11], v[228:231], v[36:39]
    ds_read_b128 a[40:43], v4 offset:53248
    v_mfma_f32_16x16x32_bf16 v[40:43], a[12:15], v[224:227], v[40:43]
    v_mfma_f32_16x16x32_bf16 v[44:47], a[12:15], v[228:231], v[44:47]
    ds_read_b128 a[44:47], v4 offset:55296
    s_waitcnt lgkmcnt(4)
    v_mfma_f32_16x16x32_bf16 v[48:51], a[16:19], v[224:227], v[48:51]
    v_mfma_f32_16x16x32_bf16 v[52:55], a[16:19], v[228:231], v[52:55]
    ds_read_b128 a[48:51], v4 offset:57344
    v_mfma_f32_16x16x32_bf16 v[56:59], a[20:23], v[224:227], v[56:59]
    v_mfma_f32_16x16x32_bf16 v[60:63], a[20:23], v[228:231], v[60:63]
    ds_read_b128 a[52:55], v4 offset:59392
    v_mfma_f32_16x16x32_bf16 v[64:67], a[24:27], v[224:227], v[64:67]
    v_mfma_f32_16x16x32_bf16 v[68:71], a[24:27], v[228:231], v[68:71]
    ds_read_b128 a[56:59], v4 offset:61440
    v_mfma_f32_16x16x32_bf16 v[72:75], a[28:31], v[224:227], v[72:75]
    v_mfma_f32_16x16x32_bf16 v[76:79], a[28:31], v[228:231], v[76:79]
    ds_read_b128 a[60:63], v4 offset:63488
    s_waitcnt vmcnt(8)
    s_barrier
    s_waitcnt lgkmcnt(4)
    v_mfma_f32_16x16x32_bf16 v[16:19], a[32:35], v[232:235], v[16:19]
    v_mfma_f32_16x16x32_bf16 v[20:23], a[32:35], v[236:239], v[20:23]
    ds_read_b128 a[0:3], v6 offset:0
    s_add_u32 m0, s21, 32768
    v_mfma_f32_16x16x32_bf16 v[24:27], a[36:39], v[232:235], v[24:27]
    v_mfma_f32_16x16x32_bf16 v[28:31], a[36:39], v[236:239], v[28:31]
    ds_read_b128 a[4:7], v6 offset:2048
    s_add_u32 s64, s20, 0x50100
    buffer_load_dwordx4 v2, s[4:7], s64 offen lds
    v_mfma_f32_16x16x32_bf16 v[32:35], a[40:43], v[232:235], v[32:35]
    v_mfma_f32_16x16x32_bf16 v[36:39], a[40:43], v[236:239], v[36:39]
    ds_read_b128 a[8:11], v6 offset:4096
    s_add_u32 m0, s21, 33792
    v_mfma_f32_16x16x32_bf16 v[40:43], a[44:47], v[232:235], v[40:43]
    v_mfma_f32_16x16x32_bf16 v[44:47], a[44:47], v[236:239], v[44:47]
    ds_read_b128 a[12:15], v6 offset:6144
    s_add_u32 s64, s20, 0x52900
    buffer_load_dwordx4 v2, s[4:7], s64 offen lds
    s_waitcnt lgkmcnt(4)
    v_mfma_f32_16x16x32_bf16 v[48:51], a[48:51], v[232:235], v[48:51]
    v_mfma_f32_16x16x32_bf16 v[52:55], a[48:51], v[236:239], v[52:55]
    ds_read_b128 a[16:19], v6 offset:8192
    s_add_u32 m0, s21, 34816
    v_mfma_f32_16x16x32_bf16 v[56:59], a[52:55], v[232:235], v[56:59]
    v_mfma_f32_16x16x32_bf16 v[60:63], a[52:55], v[236:239], v[60:63]
    ds_read_b128 a[20:23], v6 offset:10240
    s_add_u32 s64, s20, 0x55100
    buffer_load_dwordx4 v2, s[4:7], s64 offen lds
    v_mfma_f32_16x16x32_bf16 v[64:67], a[56:59], v[232:235], v[64:67]
    v_mfma_f32_16x16x32_bf16 v[68:71], a[56:59], v[236:239], v[68:71]
    ds_read_b128 a[24:27], v6 offset:12288
    s_add_u32 m0, s21, 35840
    v_mfma_f32_16x16x32_bf16 v[72:75], a[60:63], v[232:235], v[72:75]
    v_mfma_f32_16x16x32_bf16 v[76:79], a[60:63], v[236:239], v[76:79]
    ds_read_b128 a[28:31], v6 offset:14336
    s_add_u32 s64, s20, 0x57900
    buffer_load_dwordx4 v2, s[4:7], s64 offen lds
    s_waitcnt lgkmcnt(4)
    v_mfma_f32_16x16x32_bf16 v[16:19], a[0:3], v[240:243], v[16:19]
    v_mfma_f32_16x16x32_bf16 v[20:23], a[0:3], v[244:247], v[20:23]
    ds_read_b128 a[32:35], v9 offset:0
    v_mfma_f32_16x16x32_bf16 v[24:27], a[4:7], v[240:243], v[24:27]
    v_mfma_f32_16x16x32_bf16 v[28:31], a[4:7], v[244:247], v[28:31]
    ds_read_b128 a[36:39], v9 offset:2048
    v_mfma_f32_16x16x32_bf16 v[32:35], a[8:11], v[240:243], v[32:35]
    v_mfma_f32_16x16x32_bf16 v[36:39], a[8:11], v[244:247], v[36:39]
    ds_read_b128 a[40:43], v9 offset:4096
    v_mfma_f32_16x16x32_bf16 v[40:43], a[12:15], v[240:243], v[40:43]
    v_mfma_f32_16x16x32_bf16 v[44:47], a[12:15], v[244:247], v[44:47]
    ds_read_b128 a[44:47], v9 offset:6144
    s_waitcnt lgkmcnt(4)
    v_mfma_f32_16x16x32_bf16 v[48:51], a[16:19], v[240:243], v[48:51]
    v_mfma_f32_16x16x32_bf16 v[52:55], a[16:19], v[244:247], v[52:55]
    ds_read_b128 a[48:51], v9 offset:8192
    v_mfma_f32_16x16x32_bf16 v[56:59], a[20:23], v[240:243], v[56:59]
    v_mfma_f32_16x16x32_bf16 v[60:63], a[20:23], v[244:247], v[60:63]
    ds_read_b128 a[52:55], v9 offset:10240
    v_mfma_f32_16x16x32_bf16 v[64:67], a[24:27], v[240:243], v[64:67]
    v_mfma_f32_16x16x32_bf16 v[68:71], a[24:27], v[244:247], v[68:71]
    ds_read_b128 a[56:59], v9 offset:12288
    v_mfma_f32_16x16x32_bf16 v[72:75], a[28:31], v[240:243], v[72:75]
    v_mfma_f32_16x16x32_bf16 v[76:79], a[28:31], v[244:247], v[76:79]
    ds_read_b128 a[60:63], v9 offset:14336
    s_waitcnt vmcnt(8)
    s_barrier
    s_waitcnt lgkmcnt(4)
    v_mfma_f32_16x16x32_bf16 v[16:19], a[32:35], v[248:251], v[16:19]
    v_mfma_f32_16x16x32_bf16 v[20:23], a[32:35], v[252:255], v[20:23]
    ds_read_b128 a[0:3], v3 offset:0
    s_add_u32 m0, s21, 49152
    v_mfma_f32_16x16x32_bf16 v[24:27], a[36:39], v[248:251], v[24:27]
    v_mfma_f32_16x16x32_bf16 v[28:31], a[36:39], v[252:255], v[28:31]
    ds_read_b128 a[4:7], v3 offset:2048
    s_add_u32 s64, s20, 0x50180
    buffer_load_dwordx4 v2, s[4:7], s64 offen lds
    v_mfma_f32_16x16x32_bf16 v[32:35], a[40:43], v[248:251], v[32:35]
    v_mfma_f32_16x16x32_bf16 v[36:39], a[40:43], v[252:255], v[36:39]
    ds_read_b128 a[8:11], v3 offset:4096
    s_add_u32 m0, s21, 50176
    v_mfma_f32_16x16x32_bf16 v[40:43], a[44:47], v[248:251], v[40:43]
    v_mfma_f32_16x16x32_bf16 v[44:47], a[44:47], v[252:255], v[44:47]
    ds_read_b128 a[12:15], v3 offset:6144
    s_add_u32 s64, s20, 0x52980
    buffer_load_dwordx4 v2, s[4:7], s64 offen lds
    s_waitcnt lgkmcnt(4)
    v_mfma_f32_16x16x32_bf16 v[48:51], a[48:51], v[248:251], v[48:51]
    v_mfma_f32_16x16x32_bf16 v[52:55], a[48:51], v[252:255], v[52:55]
    ds_read_b128 a[16:19], v3 offset:8192
    s_add_u32 m0, s21, 51200
    v_mfma_f32_16x16x32_bf16 v[56:59], a[52:55], v[248:251], v[56:59]
    v_mfma_f32_16x16x32_bf16 v[60:63], a[52:55], v[252:255], v[60:63]
    ds_read_b128 a[20:23], v3 offset:10240
    s_add_u32 s64, s20, 0x55180
    buffer_load_dwordx4 v2, s[4:7], s64 offen lds
    v_mfma_f32_16x16x32_bf16 v[64:67], a[56:59], v[248:251], v[64:67]
    v_mfma_f32_16x16x32_bf16 v[68:71], a[56:59], v[252:255], v[68:71]
    ds_read_b128 a[24:27], v3 offset:12288
    s_add_u32 m0, s21, 52224
    v_mfma_f32_16x16x32_bf16 v[72:75], a[60:63], v[248:251], v[72:75]
    v_mfma_f32_16x16x32_bf16 v[76:79], a[60:63], v[252:255], v[76:79]
    ds_read_b128 a[28:31], v3 offset:14336
    s_add_u32 s64, s20, 0x57980
    buffer_load_dwordx4 v2, s[4:7], s64 offen lds
    s_nop 5
    s_mul_i32 s65, s17, 0
    s_add_u32 s65, s65, s22
    s_add_u32 s64, s65, 0
    v_cvt_pk_bf16_f32 v80, v16, v17
    v_cvt_pk_bf16_f32 v81, v18, v19
    v_cvt_pk_bf16_f32 v82, v24, v25
    v_cvt_pk_bf16_f32 v83, v26, v27
    buffer_store_dwordx4 v[80:83], v1, s[4:7], s64 offen sc1
    s_add_u32 s64, s65, 1024
    v_cvt_pk_bf16_f32 v84, v20, v21
    v_cvt_pk_bf16_f32 v85, v22, v23
    v_cvt_pk_bf16_f32 v86, v28, v29
    v_cvt_pk_bf16_f32 v87, v30, v31
    buffer_store_dwordx4 v[84:87], v1, s[4:7], s64 offen sc1
    s_mul_i32 s65, s17, 1
    s_add_u32 s65, s65, s22
    s_add_u32 s64, s65, 0
    v_cvt_pk_bf16_f32 v88, v32, v33
    v_cvt_pk_bf16_f32 v89, v34, v35
    v_cvt_pk_bf16_f32 v90, v40, v41
    v_cvt_pk_bf16_f32 v91, v42, v43
    buffer_store_dwordx4 v[88:91], v1, s[4:7], s64 offen sc1
    s_add_u32 s64, s65, 1024
    v_cvt_pk_bf16_f32 v92, v36, v37
    v_cvt_pk_bf16_f32 v93, v38, v39
    v_cvt_pk_bf16_f32 v94, v44, v45
    v_cvt_pk_bf16_f32 v95, v46, v47
    buffer_store_dwordx4 v[92:95], v1, s[4:7], s64 offen sc1
    s_mul_i32 s65, s17, 2
    s_add_u32 s65, s65, s22
    s_add_u32 s64, s65, 0
    v_cvt_pk_bf16_f32 v80, v48, v49
    v_cvt_pk_bf16_f32 v81, v50, v51
    v_cvt_pk_bf16_f32 v82, v56, v57
    v_cvt_pk_bf16_f32 v83, v58, v59
    buffer_store_dwordx4 v[80:83], v1, s[4:7], s64 offen sc1
    s_add_u32 s64, s65, 1024
    v_cvt_pk_bf16_f32 v84, v52, v53
    v_cvt_pk_bf16_f32 v85, v54, v55
    v_cvt_pk_bf16_f32 v86, v60, v61
    v_cvt_pk_bf16_f32 v87, v62, v63
    buffer_store_dwordx4 v[84:87], v1, s[4:7], s64 offen sc1
    s_mul_i32 s65, s17, 3
    s_add_u32 s65, s65, s22
    s_add_u32 s64, s65, 0
    v_cvt_pk_bf16_f32 v88, v64, v65
    v_cvt_pk_bf16_f32 v89, v66, v67
    v_cvt_pk_bf16_f32 v90, v72, v73
    v_cvt_pk_bf16_f32 v91, v74, v75
    buffer_store_dwordx4 v[88:91], v1, s[4:7], s64 offen sc1
    s_add_u32 s64, s65, 1024
    v_cvt_pk_bf16_f32 v92, v68, v69
    v_cvt_pk_bf16_f32 v93, v70, v71
    v_cvt_pk_bf16_f32 v94, v76, v77
    v_cvt_pk_bf16_f32 v95, v78, v79
    buffer_store_dwordx4 v[92:95], v1, s[4:7], s64 offen sc1
    s_lshl_b32 s64, s19, 1
    s_add_u32 s64, s64, s12
    s_lshl_b32 s64, s64, 9
    s_add_u32 s23, s18, s64
    s_lshl_b32 s64, s17, 3
    s_add_u32 s22, s22, s64
    s_add_u32 s19, s19, 1
    s_add_u32 s20, s20, 0x50000
    s_cmp_lt_u32 s19, 8
    s_cbranch_scc1 G_N_LOOP
    s_waitcnt vmcnt(0) lgkmcnt(0)
    s_barrier
    s_cmp_lg_u32 s14, 0
    s_cbranch_scc1 GF_116
    v_mov_b32 v7, 1
    v_mov_b32 v8, 0
    s_mov_b64 exec, 1
    buffer_store_dword v7, v8, s[4:7], s23 offen sc1
    s_mov_b64 exec, -1
GF_116:
    s_cmp_eq_u32 s12, 1
    s_cbranch_scc1 H_OUT
    s_mov_b32 s29, 0
    v_lshlrev_b32 v1, 4, v0
    s_mov_b32 s65, 0
CW_117:
    buffer_load_dwordx2 v[8:9], off, s[60:63], 0 offset:132 sc1
    s_add_u32 s65, s65, 1
    s_waitcnt vmcnt(0)
    v_readfirstlane_b32 s66, v8
    v_readfirstlane_b32 s67, v9
    s_min_u32 s64, s66, s67
    s_cmp_lg_u32 s64, 0
    s_cbranch_scc1 CWD_118
    s_cmp_gt_u32 s65, 65536
    s_cbranch_scc1 CWD_118
    s_sleep 4
    s_branch CW_117
CWD_118:
    s_sub_u32 s66, s66, 1
    s_and_b32 s66, s66, 3
    s_sub_u32 s67, s67, 1
    s_and_b32 s67, s67, 3
    s_mov_b32 s64, s66
    s_mov_b32 s65, s67
    s_and_b32 s64, s64, 3
    s_lshl_b32 s64, s64, 13
    s_and_b32 s65, s65, 3
    s_lshl_b32 s65, s65, 13
    s_add_u32 s25, s64, 0x6000000
    s_add_u32 s30, s65, 0x6200000
    v_bfe_u32 v4, v0, 3, 1
    v_mul_u32_u24 v2, 0x8000, v4
    v_lshrrev_b32 v4, 5, v0
    v_lshl_add_u32 v2, v4, 8, v2
    v_bfe_u32 v4, v0, 4, 1
    v_lshl_add_u32 v2, v4, 7, v2
    v_and_b32 v4, 7, v0
    v_lshl_add_u32 v2, v4, 4, v2
    v_lshrrev_b32 v4, 5, v0
    v_lshlrev_b32 v3, 16, v4
    v_bfe_u32 v4, v0, 4, 1
    v_lshl_add_u32 v3, v4, 7, v3
    v_and_b32 v4, 15, v0
    v_lshl_add_u32 v3, v4, 3, v3
    s_lshl_b32 s26, s13, 11
    s_lshl_b32 s64, s14, 9
    s_add_u32 s26, s26, s64
    s_add_u32 s26, s26, 0xa40000
    s_lshl_b32 s27, s13, 3
    s_add_u32 s27, s27, 0x294004
    s_mov_b32 s28, 0x29a000
    s_mov_b32 s24, 0
    v_lshlrev_b32 v6, 7, v0
MKN_LOOP:
    s_mov_b64 exec, 0xf
MKN_M_119:
    buffer_load_dword v5, v6, s[4:7], s28 offen sc1
    s_add_u32 s29, s29, 1
    s_waitcnt vmcnt(0)
    v_cmp_eq_u32 vcc, 0, v5
    s_cbranch_vccz MKN_MD_120
    s_cmp_gt_u32 s29, 262144
    s_cbranch_scc1 MKN_MD_120
    s_sleep 4
    s_branch MKN_M_119
MKN_MD_120:
    s_mov_b64 exec, -1
MKR_121:
    s_add_u32 s64, s25, 0x0
    buffer_load_dwordx4 v[16:19], v2, s[4:7], s64 offen sc1
    s_add_u32 s64, s25, 0x200
    buffer_load_dwordx4 v[20:23], v2, s[4:7], s64 offen sc1
    s_add_u32 s64, s25, 0x400
    buffer_load_dwordx4 v[24:27], v2, s[4:7], s64 offen sc1
    s_add_u32 s64, s25, 0x600
    buffer_load_dwordx4 v[28:31], v2, s[4:7], s64 offen sc1
    s_add_u32 s64, s25, 0x800
    buffer_load_dwordx4 v[32:35], v2, s[4:7], s64 offen sc1
    s_add_u32 s64, s25, 0xa00
    buffer_load_dwordx4 v[36:39], v2, s[4:7], s64 offen sc1
    s_add_u32 s64, s25, 0xc00
    buffer_load_dwordx4 v[40:43], v2, s[4:7], s64 offen sc1
    s_add_u32 s64, s25, 0xe00
    buffer_load_dwordx4 v[44:47], v2, s[4:7], s64 offen sc1
    s_add_u32 s64, s25, 0x1000
    buffer_load_dwordx4 v[48:51], v2, s[4:7], s64 offen sc1
    s_add_u32 s64, s25, 0x1200
    buffer_load_dwordx4 v[52:55], v2, s[4:7], s64 offen sc1
    s_add_u32 s64, s30, 0x0
    buffer_load_dwordx4 v[56:59], v2, s[4:7], s64 offen sc1
    s_add_u32 s64, s30, 0x200
    buffer_load_dwordx4 v[60:63], v2, s[4:7], s64 offen sc1
    s_add_u32 s64, s30, 0x400
    buffer_load_dwordx4 v[64:67], v2, s[4:7], s64 offen sc1
    s_add_u32 s64, s30, 0x600
    buffer_load_dwordx4 v[68:71], v2, s[4:7], s64 offen sc1
    s_add_u32 s64, s30, 0x800
    buffer_load_dwordx4 v[72:75], v2, s[4:7], s64 offen sc1
    s_add_u32 s64, s30, 0xa00
    buffer_load_dwordx4 v[76:79], v2, s[4:7], s64 offen sc1
    s_add_u32 s64, s30, 0xc00
    buffer_load_dwordx4 v[80:83], v2, s[4:7], s64 offen sc1
    s_add_u32 s64, s30, 0xe00
    buffer_load_dwordx4 v[84:87], v2, s[4:7], s64 offen sc1
    s_add_u32 s64, s30, 0x1000
    buffer_load_dwordx4 v[88:91], v2, s[4:7], s64 offen sc1
    s_add_u32 s64, s30, 0x1200
    buffer_load_dwordx4 v[92:95], v2, s[4:7], s64 offen sc1
    s_add_u32 s29, s29, 1
    s_waitcnt vmcnt(0)
    v_max3_u32 v4, v19, v23, v27
    v_max3_u32 v4, v4, v31, v35
    v_max3_u32 v4, v4, v39, v43
    v_max3_u32 v4, v4, v47, v51
    v_max3_u32 v4, v4, v55, v59
    v_max3_u32 v4, v4, v63, v67
    v_max3_u32 v4, v4, v71, v75
    v_max3_u32 v4, v4, v79, v83
    v_max3_u32 v4, v4, v87, v91
    v_max_u32 v4, v4, v95
    v_cmp_eq_u32 vcc, -1, v4
    s_cbranch_vccz MKO_122
    s_cmp_gt_u32 s29, 262144
    s_cbranch_scc0 MKR_121
MKO_122:
    v_mfma_f32_16x16x32_bf16 v[8:11], v[16:19], v[96:99], 0
    v_mfma_f32_16x16x32_bf16 v[12:15], v[16:19], v[100:103], 0
    v_mfma_f32_16x16x32_bf16 v[8:11], v[20:23], v[104:107], v[8:11]
    v_mfma_f32_16x16x32_bf16 v[12:15], v[20:23], v[108:111], v[12:15]
    v_mfma_f32_16x16x32_bf16 v[8:11], v[24:27], v[112:115], v[8:11]
    v_mfma_f32_16x16x32_bf16 v[12:15], v[24:27], v[116:119], v[12:15]
    v_mfma_f32_16x16x32_bf16 v[8:11], v[28:31], v[120:123], v[8:11]
    v_mfma_f32_16x16x32_bf16 v[12:15], v[28:31], v[124:127], v[12:15]
    v_mfma_f32_16x16x32_bf16 v[8:11], v[32:35], v[128:131], v[8:11]
    v_mfma_f32_16x16x32_bf16 v[12:15], v[32:35], v[132:135], v[12:15]
    v_mfma_f32_16x16x32_bf16 v[8:11], v[36:39], v[136:139], v[8:11]
    v_mfma_f32_16x16x32_bf16 v[12:15], v[36:39], v[140:143], v[12:15]
    v_mfma_f32_16x16x32_bf16 v[8:11], v[40:43], v[144:147], v[8:11]
    v_mfma_f32_16x16x32_bf16 v[12:15], v[40:43], v[148:151], v[12:15]
    v_mfma_f32_16x16x32_bf16 v[8:11], v[44:47], v[152:155], v[8:11]
    v_mfma_f32_16x16x32_bf16 v[12:15], v[44:47], v[156:159], v[12:15]
    v_mfma_f32_16x16x32_bf16 v[8:11], v[48:51], v[160:163], v[8:11]
    v_mfma_f32_16x16x32_bf16 v[12:15], v[48:51], v[164:167], v[12:15]
    v_mfma_f32_16x16x32_bf16 v[8:11], v[52:55], v[168:171], v[8:11]
    v_mfma_f32_16x16x32_bf16 v[12:15], v[52:55], v[172:175], v[12:15]
    v_mfma_f32_16x16x32_bf16 v[8:11], v[56:59], v[176:179], v[8:11]
    v_mfma_f32_16x16x32_bf16 v[12:15], v[56:59], v[180:183], v[12:15]
    v_mfma_f32_16x16x32_bf16 v[8:11], v[60:63], v[184:187], v[8:11]
    v_mfma_f32_16x16x32_bf16 v[12:15], v[60:63], v[188:191], v[12:15]
    v_mfma_f32_16x16x32_bf16 v[8:11], v[64:67], v[192:195], v[8:11]
    v_mfma_f32_16x16x32_bf16 v[12:15], v[64:67], v[196:199], v[12:15]
    v_mfma_f32_16x16x32_bf16 v[8:11], v[68:71], v[200:203], v[8:11]
    v_mfma_f32_16x16x32_bf16 v[12:15], v[68:71], v[204:207], v[12:15]
    v_mfma_f32_16x16x32_bf16 v[8:11], v[72:75], v[208:211], v[8:11]
    v_mfma_f32_16x16x32_bf16 v[12:15], v[72:75], v[212:215], v[12:15]
    v_mfma_f32_16x16x32_bf16 v[8:11], v[76:79], v[216:219], v[8:11]
    v_mfma_f32_16x16x32_bf16 v[12:15], v[76:79], v[220:223], v[12:15]
    v_mfma_f32_16x16x32_bf16 v[8:11], v[80:83], v[224:227], v[8:11]
    v_mfma_f32_16x16x32_bf16 v[12:15], v[80:83], v[228:231], v[12:15]
    v_mfma_f32_16x16x32_bf16 v[8:11], v[84:87], v[232:235], v[8:11]
    v_mfma_f32_16x16x32_bf16 v[12:15], v[84:87], v[236:239], v[12:15]
    v_mfma_f32_16x16x32_bf16 v[8:11], v[88:91], v[240:243], v[8:11]
    v_mfma_f32_16x16x32_bf16 v[12:15], v[88:91], v[244:247], v[12:15]
    v_mfma_f32_16x16x32_bf16 v[8:11], v[92:95], v[248:251], v[8:11]
    v_mfma_f32_16x16x32_bf16 v[12:15], v[92:95], v[252:255], v[12:15]
    s_nop 7
    v_cvt_pk_bf16_f32 v16, v8, v9
    v_cvt_pk_bf16_f32 v17, v10, v11
    v_cvt_pk_bf16_f32 v18, v12, v13
    v_cvt_pk_bf16_f32 v19, v14, v15
    buffer_store_dwordx2 v[16:17], v3, s[4:7], s26 offen sc1
    buffer_store_dwordx2 v[18:19], v3, s[4:7], s26 offen offset:256 sc1
    s_waitcnt vmcnt(0)
    s_barrier
    s_cmp_lg_u32 s14, 0
    s_cbranch_scc1 GF_123
    v_mov_b32 v7, 1
    v_mov_b32 v8, 0
    s_mov_b64 exec, 1
    buffer_store_dword v7, v8, s[4:7], s27 offen sc1
    s_mov_b64 exec, -1
GF_123:
    s_add_u32 s25, s25, 0x10000
    s_add_u32 s30, s30, 0x10000
    s_add_u32 s26, s26, 0x20000
    s_add_u32 s27, s27, 256
    s_add_u32 s28, s28, 512
    s_add_u32 s24, s24, 1
    s_cmp_lt_u32 s24, 32
    s_cbranch_scc1 MKN_LOOP
    s_branch M_EXIT
H_OUT:
    s_lshl_b32 s64, s3, 5
    s_add_u32 s64, s64, s13
    s_cmp_ge_u32 s64, 60
    s_cbranch_scc1 M_EXIT
    s_mul_hi_u32 s12, s64, 0xccccccd
    s_mul_i32 s65, s12, 20
    s_sub_u32 s13, s64, s65
    s_load_dwordx2 s[44:45], s[0:1], 40
    s_mov_b32 s46, 0x500000
    s_mov_b32 s47, 0x00020000
    s_load_dwordx2 s[48:49], s[0:1], 0
    s_mov_b32 s50, 0x280000
    s_mov_b32 s51, 0x00020000
    s_load_dwordx2 s[52:53], s[0:1], 96
    s_mov_b32 s54, 0x280000
    s_mov_b32 s55, 0x00020000
    s_mov_b32 s36, -1
    s_mov_b32 s37, 0
    s_waitcnt lgkmcnt(0)
    s_mul_i32 s21, s14, 36864
    v_lshrrev_b32 v7, 2, v0
    v_mul_u32_u24 v4, 1280, v7
    v_bfe_u32 v7, v0, 4, 1
    v_lshlrev_b32 v7, 1, v7
    v_and_b32 v8, 3, v0
    v_xor_b32 v7, v7, v8
    v_lshl_add_u32 v4, v7, 4, v4
    v_lshrrev_b32 v7, 4, v0
    v_lshlrev_b32 v2, 8, v7
    v_bfe_u32 v7, v0, 2, 2
    v_lshl_add_u32 v2, v7, 6, v2
    v_and_b32 v7, 3, v0
    v_lshl_add_u32 v2, v7, 3, v2
    v_add_u32 v2, s21, v2
    v_bfe_u32 v7, v0, 4, 1
    v_lshlrev_b32 v7, 5, v7
    v_sub_u32 v3, 32, v7
    v_add_u32 v3, v3, v2
    v_add_u32 v2, v2, v7
    s_mul_i32 s65, s14, 1310720
    s_lshl_b32 s66, s13, 6
    s_add_u32 s65, s65, s66
    s_add_u32 m0, s21, 0
    s_add_u32 s64, s65, 0x0
    buffer_load_dwordx4 v4, s[44:47], s64 offen lds
    s_add_u32 m0, s21, 1024
    s_add_u32 s64, s65, 0x5000
    buffer_load_dwordx4 v4, s[44:47], s64 offen lds
    s_add_u32 m0, s21, 2048
    s_add_u32 s64, s65, 0xa000
    buffer_load_dwordx4 v4, s[44:47], s64 offen lds
    s_add_u32 m0, s21, 3072
    s_add_u32 s64, s65, 0xf000
    buffer_load_dwordx4 v4, s[44:47], s64 offen lds
    s_add_u32 m0, s21, 4096
    s_add_u32 s64, s65, 0x14000
    buffer_load_dwordx4 v4, s[44:47], s64 offen lds
    s_add_u32 m0, s21, 5120
    s_add_u32 s64, s65, 0x19000
    buffer_load_dwordx4 v4, s[44:47], s64 offen lds
    s_add_u32 m0, s21, 6144
    s_add_u32 s64, s65, 0x1e000
    buffer_load_dwordx4 v4, s[44:47], s64 offen lds
    s_add_u32 m0, s21, 7168
    s_add_u32 s64, s65, 0x23000
    buffer_load_dwordx4 v4, s[44:47], s64 offen lds
    s_add_u32 m0, s21, 8192
    s_add_u32 s64, s65, 0x28000
    buffer_load_dwordx4 v4, s[44:47], s64 offen lds
    s_add_u32 m0, s21, 9216
    s_add_u32 s64, s65, 0x2d000
    buffer_load_dwordx4 v4, s[44:47], s64 offen lds
    s_add_u32 m0, s21, 10240
    s_add_u32 s64, s65, 0x32000
    buffer_load_dwordx4 v4, s[44:47], s64 offen lds
    s_add_u32 m0, s21, 11264
    s_add_u32 s64, s65, 0x37000
    buffer_load_dwordx4 v4, s[44:47], s64 offen lds
    s_add_u32 m0, s21, 12288
    s_add_u32 s64, s65, 0x3c000
    buffer_load_dwordx4 v4, s[44:47], s64 offen lds
    s_add_u32 m0, s21, 13312
    s_add_u32 s64, s65, 0x41000
    buffer_load_dwordx4 v4, s[44:47], s64 offen lds
    s_add_u32 m0, s21, 14336
    s_add_u32 s64, s65, 0x46000
    buffer_load_dwordx4 v4, s[44:47], s64 offen lds
    s_add_u32 m0, s21, 15360
    s_add_u32 s64, s65, 0x4b000
    buffer_load_dwordx4 v4, s[44:47], s64 offen lds
    s_add_u32 m0, s21, 16384
    s_add_u32 s64, s65, 0x50000
    buffer_load_dwordx4 v4, s[44:47], s64 offen lds
    s_add_u32 m0, s21, 17408
    s_add_u32 s64, s65, 0x55000
    buffer_load_dwordx4 v4, s[44:47], s64 offen lds
    s_add_u32 m0, s21, 18432
    s_add_u32 s64, s65, 0x5a000
    buffer_load_dwordx4 v4, s[44:47], s64 offen lds
    s_add_u32 m0, s21, 19456
    s_add_u32 s64, s65, 0x5f000
    buffer_load_dwordx4 v4, s[44:47], s64 offen lds
    s_add_u32 m0, s21, 20480
    s_add_u32 s64, s65, 0x64000
    buffer_load_dwordx4 v4, s[44:47], s64 offen lds
    s_add_u32 m0, s21, 21504
    s_add_u32 s64, s65, 0x69000
    buffer_load_dwordx4 v4, s[44:47], s64 offen lds
    s_add_u32 m0, s21, 22528
    s_add_u32 s64, s65, 0x6e000
    buffer_load_dwordx4 v4, s[44:47], s64 offen lds
    s_add_u32 m0, s21, 23552
    s_add_u32 s64, s65, 0x73000
    buffer_load_dwordx4 v4, s[44:47], s64 offen lds
    s_add_u32 m0, s21, 24576
    s_add_u32 s64, s65, 0x78000
    buffer_load_dwordx4 v4, s[44:47], s64 offen lds
    s_add_u32 m0, s21, 25600
    s_add_u32 s64, s65, 0x7d000
    buffer_load_dwordx4 v4, s[44:47], s64 offen lds
    s_add_u32 m0, s21, 26624
    s_add_u32 s64, s65, 0x82000
    buffer_load_dwordx4 v4, s[44:47], s64 offen lds
    s_add_u32 m0, s21, 27648
    s_add_u32 s64, s65, 0x87000
    buffer_load_dwordx4 v4, s[44:47], s64 offen lds
    s_add_u32 m0, s21, 28672
    s_add_u32 s64, s65, 0x8c000
    buffer_load_dwordx4 v4, s[44:47], s64 offen lds
    s_add_u32 m0, s21, 29696
    s_add_u32 s64, s65, 0x91000
    buffer_load_dwordx4 v4, s[44:47], s64 offen lds
    s_add_u32 m0, s21, 30720
    s_add_u32 s64, s65, 0x96000
    buffer_load_dwordx4 v4, s[44:47], s64 offen lds
    s_add_u32 m0, s21, 31744
    s_add_u32 s64, s65, 0x9b000
    buffer_load_dwordx4 v4, s[44:47], s64 offen lds
    s_add_u32 m0, s21, 32768
    s_add_u32 s64, s65, 0xa0000
    buffer_load_dwordx4 v4, s[44:47], s64 offen lds
    s_add_u32 m0, s21, 33792
    s_add_u32 s64, s65, 0xa5000
    buffer_load_dwordx4 v4, s[44:47], s64 offen lds
    s_add_u32 m0, s21, 34816
    s_add_u32 s64, s65, 0xaa000
    buffer_load_dwordx4 v4, s[44:47], s64 offen lds
    s_add_u32 m0, s21, 35840
    s_add_u32 s64, s65, 0xaf000
    buffer_load_dwordx4 v4, s[44:47], s64 offen lds
    s_waitcnt vmcnt(32)
    ds_read_b64_tr_b16 a[0:1], v2 offset:0
    ds_read_b64_tr_b16 a[2:3], v2 offset:1024
    ds_read_b64_tr_b16 a[4:5], v3 offset:0
    ds_read_b64_tr_b16 a[6:7], v3 offset:1024
    ds_read_b64_tr_b16 a[8:9], v2 offset:2048
    ds_read_b64_tr_b16 a[10:11], v2 offset:3072
    ds_read_b64_tr_b16 a[12:13], v3 offset:2048
    ds_read_b64_tr_b16 a[14:15], v3 offset:3072
    s_waitcnt lgkmcnt(0)
    s_add_u32 m0, s21, 0
    s_add_u32 s64, s65, 0xb4000
    buffer_load_dwordx4 v4, s[44:47], s64 offen lds
    s_add_u32 m0, s21, 1024
    s_add_u32 s64, s65, 0xb9000
    buffer_load_dwordx4 v4, s[44:47], s64 offen lds
    s_add_u32 m0, s21, 2048
    s_add_u32 s64, s65, 0xbe000
    buffer_load_dwordx4 v4, s[44:47], s64 offen lds
    s_add_u32 m0, s21, 3072
    s_add_u32 s64, s65, 0xc3000
    buffer_load_dwordx4 v4, s[44:47], s64 offen lds
    s_waitcnt vmcnt(32)
    ds_read_b64_tr_b16 a[16:17], v2 offset:4096
    ds_read_b64_tr_b16 a[18:19], v2 offset:5120
    ds_read_b64_tr_b16 a[20:21], v3 offset:4096
    ds_read_b64_tr_b16 a[22:23], v3 offset:5120
    ds_read_b64_tr_b16 a[24:25], v2 offset:6144
    ds_read_b64_tr_b16 a[26:27], v2 offset:7168
    ds_read_b64_tr_b16 a[28:29], v3 offset:6144
    ds_read_b64_tr_b16 a[30:31], v3 offset:7168
    s_waitcnt lgkmcnt(0)
    s_add_u32 m0, s21, 4096
    s_add_u32 s64, s65, 0xc8000
    buffer_load_dwordx4 v4, s[44:47], s64 offen lds
    s_add_u32 m0, s21, 5120
    s_add_u32 s64, s65, 0xcd000
    buffer_load_dwordx4 v4, s[44:47], s64 offen lds
    s_add_u32 m0, s21, 6144
    s_add_u32 s64, s65, 0xd2000
    buffer_load_dwordx4 v4, s[44:47], s64 offen lds
    s_add_u32 m0, s21, 7168
    s_add_u32 s64, s65, 0xd7000
    buffer_load_dwordx4 v4, s[44:47], s64 offen lds
    s_waitcnt vmcnt(32)
    ds_read_b64_tr_b16 a[32:33], v2 offset:8192
    ds_read_b64_tr_b16 a[34:35], v2 offset:9216
    ds_read_b64_tr_b16 a[36:37], v3 offset:8192
    ds_read_b64_tr_b16 a[38:39], v3 offset:9216
    ds_read_b64_tr_b16 a[40:41], v2 offset:10240
    ds_read_b64_tr_b16 a[42:43], v2 offset:11264
    ds_read_b64_tr_b16 a[44:45], v3 offset:10240
    ds_read_b64_tr_b16 a[46:47], v3 offset:11264
    s_waitcnt lgkmcnt(0)
    s_add_u32 m0, s21, 8192
    s_add_u32 s64, s65, 0xdc000
    buffer_load_dwordx4 v4, s[44:47], s64 offen lds
    s_add_u32 m0, s21, 9216
    s_add_u32 s64, s65, 0xe1000
    buffer_load_dwordx4 v4, s[44:47], s64 offen lds
    s_add_u32 m0, s21, 10240
    s_add_u32 s64, s65, 0xe6000
    buffer_load_dwordx4 v4, s[44:47], s64 offen lds
    s_add_u32 m0, s21, 11264
    s_add_u32 s64, s65, 0xeb000
    buffer_load_dwordx4 v4, s[44:47], s64 offen lds
    s_waitcnt vmcnt(32)
    ds_read_b64_tr_b16 a[48:49], v2 offset:12288
    ds_read_b64_tr_b16 a[50:51], v2 offset:13312
    ds_read_b64_tr_b16 a[52:53], v3 offset:12288
    ds_read_b64_tr_b16 a[54:55], v3 offset:13312
    ds_read_b64_tr_b16 a[56:57], v2 offset:14336
    ds_read_b64_tr_b16 a[58:59], v2 offset:15360
    ds_read_b64_tr_b16 a[60:61], v3 offset:14336
    ds_read_b64_tr_b16 a[62:63], v3 offset:15360
    s_waitcnt lgkmcnt(0)
    s_add_u32 m0, s21, 12288
    s_add_u32 s64, s65, 0xf0000
    buffer_load_dwordx4 v4, s[44:47], s64 offen lds
    s_add_u32 m0, s21, 13312
    s_add_u32 s64, s65, 0xf5000
    buffer_load_dwordx4 v4, s[44:47], s64 offen lds
    s_add_u32 m0, s21, 14336
    s_add_u32 s64, s65, 0xfa000
    buffer_load_dwordx4 v4, s[44:47], s64 offen lds
    s_add_u32 m0, s21, 15360
    s_add_u32 s64, s65, 0xff000
    buffer_load_dwordx4 v4, s[44:47], s64 offen lds
    s_waitcnt vmcnt(32)
    ds_read_b64_tr_b16 a[64:65], v2 offset:16384
    ds_read_b64_tr_b16 a[66:67], v2 offset:17408
    ds_read_b64_tr_b16 a[68:69], v3 offset:16384
    ds_read_b64_tr_b16 a[70:71], v3 offset:17408
    ds_read_b64_tr_b16 a[72:73], v2 offset:18432
    ds_read_b64_tr_b16 a[74:75], v2 offset:19456
    ds_read_b64_tr_b16 a[76:77], v3 offset:18432
    ds_read_b64_tr_b16 a[78:79], v3 offset:19456
    s_waitcnt lgkmcnt(0)
    s_add_u32 m0, s21, 16384
    s_add_u32 s64, s65, 0x104000
    buffer_load_dwordx4 v4, s[44:47], s64 offen lds
    s_add_u32 m0, s21, 17408
    s_add_u32 s64, s65, 0x109000
    buffer_load_dwordx4 v4, s[44:47], s64 offen lds
    s_add_u32 m0, s21, 18432
    s_add_u32 s64, s65, 0x10e000
    buffer_load_dwordx4 v4, s[44:47], s64 offen lds
    s_add_u32 m0, s21, 19456
    s_add_u32 s64, s65, 0x113000
    buffer_load_dwordx4 v4, s[44:47], s64 offen lds
    s_waitcnt vmcnt(32)
    ds_read_b64_tr_b16 a[80:81], v2 offset:20480
    ds_read_b64_tr_b16 a[82:83], v2 offset:21504
    ds_read_b64_tr_b16 a[84:85], v3 offset:20480
    ds_read_b64_tr_b16 a[86:87], v3 offset:21504
    ds_read_b64_tr_b16 a[88:89], v2 offset:22528
    ds_read_b64_tr_b16 a[90:91], v2 offset:23552
    ds_read_b64_tr_b16 a[92:93], v3 offset:22528
    ds_read_b64_tr_b16 a[94:95], v3 offset:23552
    s_waitcnt lgkmcnt(0)
    s_add_u32 m0, s21, 20480
    s_add_u32 s64, s65, 0x118000
    buffer_load_dwordx4 v4, s[44:47], s64 offen lds
    s_add_u32 m0, s21, 21504
    s_add_u32 s64, s65, 0x11d000
    buffer_load_dwordx4 v4, s[44:47], s64 offen lds
    s_add_u32 m0, s21, 22528
    s_add_u32 s64, s65, 0x122000
    buffer_load_dwordx4 v4, s[44:47], s64 offen lds
    s_add_u32 m0, s21, 23552
    s_add_u32 s64, s65, 0x127000
    buffer_load_dwordx4 v4, s[44:47], s64 offen lds
    s_waitcnt vmcnt(32)
    ds_read_b64_tr_b16 a[96:97], v2 offset:24576
    ds_read_b64_tr_b16 a[98:99], v2 offset:25600
    ds_read_b64_tr_b16 a[100:101], v3 offset:24576
    ds_read_b64_tr_b16 a[102:103], v3 offset:25600
    ds_read_b64_tr_b16 a[104:105], v2 offset:26624
    ds_read_b64_tr_b16 a[106:107], v2 offset:27648
    ds_read_b64_tr_b16 a[108:109], v3 offset:26624
    ds_read_b64_tr_b16 a[110:111], v3 offset:27648
    s_waitcnt lgkmcnt(0)
    s_add_u32 m0, s21, 24576
    s_add_u32 s64, s65, 0x12c000
    buffer_load_dwordx4 v4, s[44:47], s64 offen lds
    s_add_u32 m0, s21, 25600
    s_add_u32 s64, s65, 0x131000
    buffer_load_dwordx4 v4, s[44:47], s64 offen lds
    s_add_u32 m0, s21, 26624
    s_add_u32 s64, s65, 0x136000
    buffer_load_dwordx4 v4, s[44:47], s64 offen lds
    s_add_u32 m0, s21, 27648
    s_add_u32 s64, s65, 0x13b000
    buffer_load_dwordx4 v4, s[44:47], s64 offen lds
    s_waitcnt vmcnt(32)
    ds_read_b64_tr_b16 a[112:113], v2 offset:28672
    ds_read_b64_tr_b16 a[114:115], v2 offset:29696
    ds_read_b64_tr_b16 a[116:117], v3 offset:28672
    ds_read_b64_tr_b16 a[118:119], v3 offset:29696
    ds_read_b64_tr_b16 a[120:121], v2 offset:30720
    ds_read_b64_tr_b16 a[122:123], v2 offset:31744
    ds_read_b64_tr_b16 a[124:125], v3 offset:30720
    ds_read_b64_tr_b16 a[126:127], v3 offset:31744
    s_waitcnt lgkmcnt(0)
    s_waitcnt vmcnt(28)
    ds_read_b64_tr_b16 a[128:129], v2 offset:32768
    ds_read_b64_tr_b16 a[130:131], v2 offset:33792
    ds_read_b64_tr_b16 a[132:133], v3 offset:32768
    ds_read_b64_tr_b16 a[134:135], v3 offset:33792
    ds_read_b64_tr_b16 a[136:137], v2 offset:34816
    ds_read_b64_tr_b16 a[138:139], v2 offset:35840
    ds_read_b64_tr_b16 a[140:141], v3 offset:34816
    ds_read_b64_tr_b16 a[142:143], v3 offset:35840
    s_waitcnt lgkmcnt(0)
    s_waitcnt vmcnt(24)
    ds_read_b64_tr_b16 a[144:145], v2 offset:0
    ds_read_b64_tr_b16 a[146:147], v2 offset:1024
    ds_read_b64_tr_b16 a[148:149], v3 offset:0
    ds_read_b64_tr_b16 a[150:151], v3 offset:1024
    ds_read_b64_tr_b16 a[152:153], v2 offset:2048
    ds_read_b64_tr_b16 a[154:155], v2 offset:3072
    ds_read_b64_tr_b16 a[156:157], v3 offset:2048
    ds_read_b64_tr_b16 a[158:159], v3 offset:3072
    s_waitcnt lgkmcnt(0)
    s_waitcnt vmcnt(20)
    ds_read_b64_tr_b16 a[160:161], v2 offset:4096
    ds_read_b64_tr_b16 a[162:163], v2 offset:5120
    ds_read_b64_tr_b16 a[164:165], v3 offset:4096
    ds_read_b64_tr_b16 a[166:167], v3 offset:5120
    ds_read_b64_tr_b16 a[168:169], v2 offset:6144
    ds_read_b64_tr_b16 a[170:171], v2 offset:7168
    ds_read_b64_tr_b16 a[172:173], v3 offset:6144
    ds_read_b64_tr_b16 a[174:175], v3 offset:7168
    s_waitcnt lgkmcnt(0)
    s_waitcnt vmcnt(16)
    ds_read_b64_tr_b16 a[176:177], v2 offset:8192
    ds_read_b64_tr_b16 a[178:179], v2 offset:9216
    ds_read_b64_tr_b16 a[180:181], v3 offset:8192
    ds_read_b64_tr_b16 a[182:183], v3 offset:9216
    ds_read_b64_tr_b16 a[184:185], v2 offset:10240
    ds_read_b64_tr_b16 a[186:187], v2 offset:11264
    ds_read_b64_tr_b16 a[188:189], v3 offset:10240
    ds_read_b64_tr_b16 a[190:191], v3 offset:11264
    s_waitcnt lgkmcnt(0)
    s_waitcnt vmcnt(12)
    ds_read_b64_tr_b16 a[192:193], v2 offset:12288
    ds_read_b64_tr_b16 a[194:195], v2 offset:13312
    ds_read_b64_tr_b16 a[196:197], v3 offset:12288
    ds_read_b64_tr_b16 a[198:199], v3 offset:13312
    ds_read_b64_tr_b16 a[200:201], v2 offset:14336
    ds_read_b64_tr_b16 a[202:203], v2 offset:15360
    ds_read_b64_tr_b16 a[204:205], v3 offset:14336
    ds_read_b64_tr_b16 a[206:207], v3 offset:15360
    s_waitcnt lgkmcnt(0)
    s_waitcnt vmcnt(8)
    ds_read_b64_tr_b16 a[208:209], v2 offset:16384
    ds_read_b64_tr_b16 a[210:211], v2 offset:17408
    ds_read_b64_tr_b16 a[212:213], v3 offset:16384
    ds_read_b64_tr_b16 a[214:215], v3 offset:17408
    ds_read_b64_tr_b16 a[216:217], v2 offset:18432
    ds_read_b64_tr_b16 a[218:219], v2 offset:19456
    ds_read_b64_tr_b16 a[220:221], v3 offset:18432
    ds_read_b64_tr_b16 a[222:223], v3 offset:19456
    s_waitcnt lgkmcnt(0)
    s_waitcnt vmcnt(4)
    ds_read_b64_tr_b16 a[224:225], v2 offset:20480
    ds_read_b64_tr_b16 a[226:227], v2 offset:21504
    ds_read_b64_tr_b16 a[228:229], v3 offset:20480
    ds_read_b64_tr_b16 a[230:231], v3 offset:21504
    ds_read_b64_tr_b16 a[232:233], v2 offset:22528
    ds_read_b64_tr_b16 a[234:235], v2 offset:23552
    ds_read_b64_tr_b16 a[236:237], v3 offset:22528
    ds_read_b64_tr_b16 a[238:239], v3 offset:23552
    s_waitcnt lgkmcnt(0)
    s_waitcnt vmcnt(0)
    ds_read_b64_tr_b16 a[240:241], v2 offset:24576
    ds_read_b64_tr_b16 a[242:243], v2 offset:25600
    ds_read_b64_tr_b16 a[244:245], v3 offset:24576
    ds_read_b64_tr_b16 a[246:247], v3 offset:25600
    ds_read_b64_tr_b16 a[248:249], v2 offset:26624
    ds_read_b64_tr_b16 a[250:251], v2 offset:27648
    ds_read_b64_tr_b16 a[252:253], v3 offset:26624
    ds_read_b64_tr_b16 a[254:255], v3 offset:27648
    s_waitcnt lgkmcnt(0)
    s_barrier
    s_mov_b32 s29, 0
    v_lshlrev_b32 v1, 4, v0
    v_mov_b32 v8, 0
    s_mov_b32 s64, 0x298000
OUS_124:
    buffer_load_dword v7, v8, s[4:7], s64 offen sc1
    s_add_u32 s29, s29, 1
    s_waitcnt vmcnt(0)
    v_cmp_gt_u32 vcc, 1, v7
    s_cbranch_vccz OUSD_125
    s_cmp_gt_u32 s29, 262144
    s_cbranch_scc1 OUSD_125
    s_sleep 8
    s_branch OUS_124
OUSD_125:
    v_lshlrev_b32 v6, 2, v0
    s_mov_b32 s64, 0x5400000
    buffer_load_dword v7, v6, s[4:7], s64 offen sc1
    s_waitcnt vmcnt(0)
    v_readlane_b32 s72, v7, 0
    v_readlane_b32 s73, v7, 1
    v_readlane_b32 s74, v7, 2
    v_readlane_b32 s75, v7, 3
    v_readlane_b32 s76, v7, 4
    v_readlane_b32 s77, v7, 5
    v_readlane_b32 s78, v7, 6
    v_readlane_b32 s79, v7, 7
    s_and_b32 s64, s14, 1
    s_lshl_b32 s64, s64, 4
    v_and_b32 v6, 15, v0
    v_add_u32 v6, s64, v6
    v_mov_b32 v9, v6
    v_mul_u32_u24 v5, 1280, v6
    v_lshrrev_b32 v6, 4, v0
    v_lshl_add_u32 v5, v6, 3, v5
    s_lshr_b32 s64, s14, 1
    s_lshl_b32 s64, s64, 5
    s_lshl_b32 s65, s13, 6
    s_add_u32 s64, s64, s65
    v_add_u32 v5, s64, v5
    v_lshlrev_b32 v6, 2, v0
    s_mov_b32 s80, 0x49249249
    s_mov_b32 s81, 0x92492492
    s_lshl_b64 s[80:81], s[80:81], s12
    s_mov_b64 s[82:83], 0
    s_lshr_b32 s64, s72, 5
    s_bitset1_b64 s[82:83], s64
    s_lshr_b32 s64, s73, 5
    s_bitset1_b64 s[82:83], s64
    s_lshr_b32 s64, s74, 5
    s_bitset1_b64 s[82:83], s64
    s_lshr_b32 s64, s75, 5
    s_bitset1_b64 s[82:83], s64
    s_lshr_b32 s64, s76, 5
    s_bitset1_b64 s[82:83], s64
    s_lshr_b32 s64, s77, 5
    s_bitset1_b64 s[82:83], s64
    s_lshr_b32 s64, s78, 5
    s_bitset1_b64 s[82:83], s64
    s_lshr_b32 s64, s79, 5
    s_bitset1_b64 s[82:83], s64
OU_LOOP:
    s_cmp_eq_u64 s[80:81], 0
    s_cbranch_scc1 OU_END
    s_andn2_b64 s[84:85], s[80:81], s[82:83]
    s_cbranch_scc0 OU_WM
    s_ff1_i32_b64 s24, s[84:85]
    s_cmp_lt_u32 s24, 40
    s_cbranch_scc1 OU_GO
    s_cmp_eq_u64 s[82:83], 0
    s_cbranch_scc1 OU_GO
OU_WM:
    v_mov_b32 v8, 0
    s_mov_b32 s64, 0x298100
OUW_126:
    buffer_load_dword v7, v8, s[4:7], s64 offen sc1
    s_add_u32 s29, s29, 1
    s_waitcnt vmcnt(0)
    v_cmp_gt_u32 vcc, 40, v7
    s_cbranch_vccz OUWD_127
    s_cmp_gt_u32 s29, 262144
    s_cbranch_scc1 OUWD_127
    s_sleep 8
    s_branch OUW_126
OUWD_127:
    s_mov_b64 s[82:83], 0
    s_branch OU_LOOP
OU_GO:
    s_bitset0_b64 s[80:81], s24
    s_mul_i32 s67, s24, 40960
    buffer_load_dwordx2 v[160:161], v5, s[48:51], s67 offen
    s_add_u32 s64, s67, 0x0
    buffer_load_dwordx2 v[162:163], v5, s[4:7], s64 offen
    s_lshl_b32 s64, s24, 7
    s_add_u32 s64, s64, 0x296000
    s_mov_b64 exec, s[36:37]
OU_F_128:
    buffer_load_dword v7, v6, s[4:7], s64 offen sc1
    s_add_u32 s29, s29, 1
    s_waitcnt vmcnt(0)
    v_cmp_eq_u32 vcc, 0, v7
    s_cbranch_vccz OU_FD_129
    s_cmp_gt_u32 s29, 262144
    s_cbranch_scc1 OU_FD_129
    s_sleep 4
    s_branch OU_F_128
OU_FD_129:
    s_mov_b64 exec, -1
    s_lshl_b32 s25, s24, 18
    s_lshl_b32 s64, s14, 15
    s_add_u32 s25, s25, s64
    s_add_u32 s25, s25, 0x4400000
    s_add_u32 s64, s25, 0x0
    buffer_load_dwordx4 v[16:19], v1, s[4:7], s64 offen
    s_add_u32 s64, s25, 0x20000
    buffer_load_dwordx4 v[20:23], v1, s[4:7], s64 offen
    s_add_u32 s64, s25, 0x400
    buffer_load_dwordx4 v[24:27], v1, s[4:7], s64 offen
    s_add_u32 s64, s25, 0x20400
    buffer_load_dwordx4 v[28:31], v1, s[4:7], s64 offen
    s_add_u32 s64, s25, 0x800
    buffer_load_dwordx4 v[32:35], v1, s[4:7], s64 offen
    s_add_u32 s64, s25, 0x20800
    buffer_load_dwordx4 v[36:39], v1, s[4:7], s64 offen
    s_add_u32 s64, s25, 0xc00
    buffer_load_dwordx4 v[40:43], v1, s[4:7], s64 offen
    s_add_u32 s64, s25, 0x20c00
    buffer_load_dwordx4 v[44:47], v1, s[4:7], s64 offen
    s_add_u32 s64, s25, 0x1000
    buffer_load_dwordx4 v[48:51], v1, s[4:7], s64 offen
    s_add_u32 s64, s25, 0x21000
    buffer_load_dwordx4 v[52:55], v1, s[4:7], s64 offen
    s_add_u32 s64, s25, 0x1400
    buffer_load_dwordx4 v[56:59], v1, s[4:7], s64 offen
    s_add_u32 s64, s25, 0x21400
    buffer_load_dwordx4 v[60:63], v1, s[4:7], s64 offen
    s_add_u32 s64, s25, 0x1800
    buffer_load_dwordx4 v[64:67], v1, s[4:7], s64 offen
    s_add_u32 s64, s25, 0x21800
    buffer_load_dwordx4 v[68:71], v1, s[4:7], s64 offen
    s_add_u32 s64, s25, 0x1c00
    buffer_load_dwordx4 v[72:75], v1, s[4:7], s64 offen
    s_add_u32 s64, s25, 0x21c00
    buffer_load_dwordx4 v[76:79], v1, s[4:7], s64 offen
    s_add_u32 s64, s25, 0x2000
    buffer_load_dwordx4 v[80:83], v1, s[4:7], s64 offen
    s_add_u32 s64, s25, 0x22000
    buffer_load_dwordx4 v[84:87], v1, s[4:7], s64 offen
    s_add_u32 s64, s25, 0x2400
    buffer_load_dwordx4 v[88:91], v1, s[4:7], s64 offen
    s_add_u32 s64, s25, 0x22400
    buffer_load_dwordx4 v[92:95], v1, s[4:7], s64 offen
    s_add_u32 s64, s25, 0x2800
    buffer_load_dwordx4 v[96:99], v1, s[4:7], s64 offen
    s_add_u32 s64, s25, 0x22800
    buffer_load_dwordx4 v[100:103], v1, s[4:7], s64 offen
    s_add_u32 s64, s25, 0x2c00
    buffer_load_dwordx4 v[104:107], v1, s[4:7], s64 offen
    s_add_u32 s64, s25, 0x22c00
    buffer_load_dwordx4 v[108:111], v1, s[4:7], s64 offen
    s_add_u32 s64, s25, 0x3000
    buffer_load_dwordx4 v[112:115], v1, s[4:7], s64 offen
    s_add_u32 s64, s25, 0x23000
    buffer_load_dwordx4 v[116:119], v1, s[4:7], s64 offen
    s_add_u32 s64, s25, 0x3400
    buffer_load_dwordx4 v[120:123], v1, s[4:7], s64 offen
    s_add_u32 s64, s25, 0x23400
    buffer_load_dwordx4 v[124:127], v1, s[4:7], s64 offen
    s_add_u32 s64, s25, 0x3800
    buffer_load_dwordx4 v[128:131], v1, s[4:7], s64 offen
    s_add_u32 s64, s25, 0x23800
    buffer_load_dwordx4 v[132:135], v1, s[4:7], s64 offen
    s_add_u32 s64, s25, 0x3c00
    buffer_load_dwordx4 v[136:139], v1, s[4:7], s64 offen
    s_add_u32 s64, s25, 0x23c00
    buffer_load_dwordx4 v[140:143], v1, s[4:7], s64 offen
    s_waitcnt vmcnt(30)
    v_mfma_f32_16x16x32_bf16 v[144:147], a[0:3], v[16:19], 0
    v_mfma_f32_16x16x32_bf16 v[148:151], a[0:3], v[20:23], 0
    v_mfma_f32_16x16x32_bf16 v[152:155], a[4:7], v[16:19], 0
    v_mfma_f32_16x16x32_bf16 v[156:159], a[4:7], v[20:23], 0
    s_add_u32 s64, s25, 0x4000
    buffer_load_dwordx4 v[16:19], v1, s[4:7], s64 offen
    s_add_u32 s64, s25, 0x24000
    buffer_load_dwordx4 v[20:23], v1, s[4:7], s64 offen
    s_waitcnt vmcnt(30)
    v_mfma_f32_16x16x32_bf16 v[144:147], a[8:11], v[24:27], v[144:147]
    v_mfma_f32_16x16x32_bf16 v[148:151], a[8:11], v[28:31], v[148:151]
    v_mfma_f32_16x16x32_bf16 v[152:155], a[12:15], v[24:27], v[152:155]
    v_mfma_f32_16x16x32_bf16 v[156:159], a[12:15], v[28:31], v[156:159]
    s_add_u32 s64, s25, 0x4400
    buffer_load_dwordx4 v[24:27], v1, s[4:7], s64 offen
    s_add_u32 s64, s25, 0x24400
    buffer_load_dwordx4 v[28:31], v1, s[4:7], s64 offen
    s_waitcnt vmcnt(30)
    v_mfma_f32_16x16x32_bf16 v[144:147], a[16:19], v[32:35], v[144:147]
    v_mfma_f32_16x16x32_bf16 v[148:151], a[16:19], v[36:39], v[148:151]
    v_mfma_f32_16x16x32_bf16 v[152:155], a[20:23], v[32:35], v[152:155]
    v_mfma_f32_16x16x32_bf16 v[156:159], a[20:23], v[36:39], v[156:159]
    s_add_u32 s64, s25, 0x4800
    buffer_load_dwordx4 v[32:35], v1, s[4:7], s64 offen
    s_add_u32 s64, s25, 0x24800
    buffer_load_dwordx4 v[36:39], v1, s[4:7], s64 offen
    s_waitcnt vmcnt(30)
    v_mfma_f32_16x16x32_bf16 v[144:147], a[24:27], v[40:43], v[144:147]
    v_mfma_f32_16x16x32_bf16 v[148:151], a[24:27], v[44:47], v[148:151]
    v_mfma_f32_16x16x32_bf16 v[152:155], a[28:31], v[40:43], v[152:155]
    v_mfma_f32_16x16x32_bf16 v[156:159], a[28:31], v[44:47], v[156:159]
    s_add_u32 s64, s25, 0x4c00
    buffer_load_dwordx4 v[40:43], v1, s[4:7], s64 offen
    s_add_u32 s64, s25, 0x24c00
    buffer_load_dwordx4 v[44:47], v1, s[4:7], s64 offen
    s_waitcnt vmcnt(30)
    v_mfma_f32_16x16x32_bf16 v[144:147], a[32:35], v[48:51], v[144:147]
    v_mfma_f32_16x16x32_bf16 v[148:151], a[32:35], v[52:55], v[148:151]
    v_mfma_f32_16x16x32_bf16 v[152:155], a[36:39], v[48:51], v[152:155]
    v_mfma_f32_16x16x32_bf16 v[156:159], a[36:39], v[52:55], v[156:159]
    s_add_u32 s64, s25, 0x5000
    buffer_load_dwordx4 v[48:51], v1, s[4:7], s64 offen
    s_add_u32 s64, s25, 0x25000
    buffer_load_dwordx4 v[52:55], v1, s[4:7], s64 offen
    s_waitcnt vmcnt(30)
    v_mfma_f32_16x16x32_bf16 v[144:147], a[40:43], v[56:59], v[144:147]
    v_mfma_f32_16x16x32_bf16 v[148:151], a[40:43], v[60:63], v[148:151]
    v_mfma_f32_16x16x32_bf16 v[152:155], a[44:47], v[56:59], v[152:155]
    v_mfma_f32_16x16x32_bf16 v[156:159], a[44:47], v[60:63], v[156:159]
    s_add_u32 s64, s25, 0x5400
    buffer_load_dwordx4 v[56:59], v1, s[4:7], s64 offen
    s_add_u32 s64, s25, 0x25400
    buffer_load_dwordx4 v[60:63], v1, s[4:7], s64 offen
    s_waitcnt vmcnt(30)
    v_mfma_f32_16x16x32_bf16 v[144:147], a[48:51], v[64:67], v[144:147]
    v_mfma_f32_16x16x32_bf16 v[148:151], a[48:51], v[68:71], v[148:151]
    v_mfma_f32_16x16x32_bf16 v[152:155], a[52:55], v[64:67], v[152:155]
    v_mfma_f32_16x16x32_bf16 v[156:159], a[52:55], v[68:71], v[156:159]
    s_add_u32 s64, s25, 0x5800
    buffer_load_dwordx4 v[64:67], v1, s[4:7], s64 offen
    s_add_u32 s64, s25, 0x25800
    buffer_load_dwordx4 v[68:71], v1, s[4:7], s64 offen
    s_waitcnt vmcnt(30)
    v_mfma_f32_16x16x32_bf16 v[144:147], a[56:59], v[72:75], v[144:147]
    v_mfma_f32_16x16x32_bf16 v[148:151], a[56:59], v[76:79], v[148:151]
    v_mfma_f32_16x16x32_bf16 v[152:155], a[60:63], v[72:75], v[152:155]
    v_mfma_f32_16x16x32_bf16 v[156:159], a[60:63], v[76:79], v[156:159]
    s_add_u32 s64, s25, 0x5c00
    buffer_load_dwordx4 v[72:75], v1, s[4:7], s64 offen
    s_add_u32 s64, s25, 0x25c00
    buffer_load_dwordx4 v[76:79], v1, s[4:7], s64 offen
    s_waitcnt vmcnt(30)
    v_mfma_f32_16x16x32_bf16 v[144:147], a[64:67], v[80:83], v[144:147]
    v_mfma_f32_16x16x32_bf16 v[148:151], a[64:67], v[84:87], v[148:151]
    v_mfma_f32_16x16x32_bf16 v[152:155], a[68:71], v[80:83], v[152:155]
    v_mfma_f32_16x16x32_bf16 v[156:159], a[68:71], v[84:87], v[156:159]
    s_add_u32 s64, s25, 0x6000
    buffer_load_dwordx4 v[80:83], v1, s[4:7], s64 offen
    s_add_u32 s64, s25, 0x26000
    buffer_load_dwordx4 v[84:87], v1, s[4:7], s64 offen
    s_waitcnt vmcnt(30)
    v_mfma_f32_16x16x32_bf16 v[144:147], a[72:75], v[88:91], v[144:147]
    v_mfma_f32_16x16x32_bf16 v[148:151], a[72:75], v[92:95], v[148:151]
    v_mfma_f32_16x16x32_bf16 v[152:155], a[76:79], v[88:91], v[152:155]
    v_mfma_f32_16x16x32_bf16 v[156:159], a[76:79], v[92:95], v[156:159]
    s_add_u32 s64, s25, 0x6400
    buffer_load_dwordx4 v[88:91], v1, s[4:7], s64 offen
    s_add_u32 s64, s25, 0x26400
    buffer_load_dwordx4 v[92:95], v1, s[4:7], s64 offen
    s_waitcnt vmcnt(30)
    v_mfma_f32_16x16x32_bf16 v[144:147], a[80:83], v[96:99], v[144:147]
    v_mfma_f32_16x16x32_bf16 v[148:151], a[80:83], v[100:103], v[148:151]
    v_mfma_f32_16x16x32_bf16 v[152:155], a[84:87], v[96:99], v[152:155]
    v_mfma_f32_16x16x32_bf16 v[156:159], a[84:87], v[100:103], v[156:159]
    s_add_u32 s64, s25, 0x6800
    buffer_load_dwordx4 v[96:99], v1, s[4:7], s64 offen
    s_add_u32 s64, s25, 0x26800
    buffer_load_dwordx4 v[100:103], v1, s[4:7], s64 offen
    s_waitcnt vmcnt(30)
    v_mfma_f32_16x16x32_bf16 v[144:147], a[88:91], v[104:107], v[144:147]
    v_mfma_f32_16x16x32_bf16 v[148:151], a[88:91], v[108:111], v[148:151]
    v_mfma_f32_16x16x32_bf16 v[152:155], a[92:95], v[104:107], v[152:155]
    v_mfma_f32_16x16x32_bf16 v[156:159], a[92:95], v[108:111], v[156:159]
    s_add_u32 s64, s25, 0x6c00
    buffer_load_dwordx4 v[104:107], v1, s[4:7], s64 offen
    s_add_u32 s64, s25, 0x26c00
    buffer_load_dwordx4 v[108:111], v1, s[4:7], s64 offen
    s_waitcnt vmcnt(30)
    v_mfma_f32_16x16x32_bf16 v[144:147], a[96:99], v[112:115], v[144:147]
    v_mfma_f32_16x16x32_bf16 v[148:151], a[96:99], v[116:119], v[148:151]
    v_mfma_f32_16x16x32_bf16 v[152:155], a[100:103], v[112:115], v[152:155]
    v_mfma_f32_16x16x32_bf16 v[156:159], a[100:103], v[116:119], v[156:159]
    s_add_u32 s64, s25, 0x7000
    buffer_load_dwordx4 v[112:115], v1, s[4:7], s64 offen
    s_add_u32 s64, s25, 0x27000
    buffer_load_dwordx4 v[116:119], v1, s[4:7], s64 offen
    s_waitcnt vmcnt(30)
    v_mfma_f32_16x16x32_bf16 v[144:147], a[104:107], v[120:123], v[144:147]
    v_mfma_f32_16x16x32_bf16 v[148:151], a[104:107], v[124:127], v[148:151]
    v_mfma_f32_16x16x32_bf16 v[152:155], a[108:111], v[120:123], v[152:155]
    v_mfma_f32_16x16x32_bf16 v[156:159], a[108:111], v[124:127], v[156:159]
    s_add_u32 s64, s25, 0x7400
    buffer_load_dwordx4 v[120:123], v1, s[4:7], s64 offen
    s_add_u32 s64, s25, 0x27400
    buffer_load_dwordx4 v[124:127], v1, s[4:7], s64 offen
    s_waitcnt vmcnt(30)
    v_mfma_f32_16x16x32_bf16 v[144:147], a[112:115], v[128:131], v[144:147]
    v_mfma_f32_16x16x32_bf16 v[148:151], a[112:115], v[132:135], v[148:151]
    v_mfma_f32_16x16x32_bf16 v[152:155], a[116:119], v[128:131], v[152:155]
    v_mfma_f32_16x16x32_bf16 v[156:159], a[116:119], v[132:135], v[156:159]
    s_add_u32 s64, s25, 0x7800
    buffer_load_dwordx4 v[128:131], v1, s[4:7], s64 offen
    s_add_u32 s64, s25, 0x27800
    buffer_load_dwordx4 v[132:135], v1, s[4:7], s64 offen
    s_waitcnt vmcnt(30)
    v_mfma_f32_16x16x32_bf16 v[144:147], a[120:123], v[136:139], v[144:147]
    v_mfma_f32_16x16x32_bf16 v[148:151], a[120:123], v[140:143], v[148:151]
    v_mfma_f32_16x16x32_bf16 v[152:155], a[124:127], v[136:139], v[152:155]
    v_mfma_f32_16x16x32_bf16 v[156:159], a[124:127], v[140:143], v[156:159]
    s_add_u32 s64, s25, 0x7c00
    buffer_load_dwordx4 v[136:139], v1, s[4:7], s64 offen
    s_add_u32 s64, s25, 0x27c00
    buffer_load_dwordx4 v[140:143], v1, s[4:7], s64 offen
    s_waitcnt vmcnt(30)
    v_mfma_f32_16x16x32_bf16 v[144:147], a[128:131], v[16:19], v[144:147]
    v_mfma_f32_16x16x32_bf16 v[148:151], a[128:131], v[20:23], v[148:151]
    v_mfma_f32_16x16x32_bf16 v[152:155], a[132:135], v[16:19], v[152:155]
    v_mfma_f32_16x16x32_bf16 v[156:159], a[132:135], v[20:23], v[156:159]
    s_waitcnt vmcnt(28)
    v_mfma_f32_16x16x32_bf16 v[144:147], a[136:139], v[24:27], v[144:147]
    v_mfma_f32_16x16x32_bf16 v[148:151], a[136:139], v[28:31], v[148:151]
    v_mfma_f32_16x16x32_bf16 v[152:155], a[140:143], v[24:27], v[152:155]
    v_mfma_f32_16x16x32_bf16 v[156:159], a[140:143], v[28:31], v[156:159]
    s_waitcnt vmcnt(26)
    v_mfma_f32_16x16x32_bf16 v[144:147], a[144:147], v[32:35], v[144:147]
    v_mfma_f32_16x16x32_bf16 v[148:151], a[144:147], v[36:39], v[148:151]
    v_mfma_f32_16x16x32_bf16 v[152:155], a[148:151], v[32:35], v[152:155]
    v_mfma_f32_16x16x32_bf16 v[156:159], a[148:151], v[36:39], v[156:159]
    s_waitcnt vmcnt(24)
    v_mfma_f32_16x16x32_bf16 v[144:147], a[152:155], v[40:43], v[144:147]
    v_mfma_f32_16x16x32_bf16 v[148:151], a[152:155], v[44:47], v[148:151]
    v_mfma_f32_16x16x32_bf16 v[152:155], a[156:159], v[40:43], v[152:155]
    v_mfma_f32_16x16x32_bf16 v[156:159], a[156:159], v[44:47], v[156:159]
    s_waitcnt vmcnt(22)
    v_mfma_f32_16x16x32_bf16 v[144:147], a[160:163], v[48:51], v[144:147]
    v_mfma_f32_16x16x32_bf16 v[148:151], a[160:163], v[52:55], v[148:151]
    v_mfma_f32_16x16x32_bf16 v[152:155], a[164:167], v[48:51], v[152:155]
    v_mfma_f32_16x16x32_bf16 v[156:159], a[164:167], v[52:55], v[156:159]
    s_waitcnt vmcnt(20)
    v_mfma_f32_16x16x32_bf16 v[144:147], a[168:171], v[56:59], v[144:147]
    v_mfma_f32_16x16x32_bf16 v[148:151], a[168:171], v[60:63], v[148:151]
    v_mfma_f32_16x16x32_bf16 v[152:155], a[172:175], v[56:59], v[152:155]
    v_mfma_f32_16x16x32_bf16 v[156:159], a[172:175], v[60:63], v[156:159]
    s_waitcnt vmcnt(18)
    v_mfma_f32_16x16x32_bf16 v[144:147], a[176:179], v[64:67], v[144:147]
    v_mfma_f32_16x16x32_bf16 v[148:151], a[176:179], v[68:71], v[148:151]
    v_mfma_f32_16x16x32_bf16 v[152:155], a[180:183], v[64:67], v[152:155]
    v_mfma_f32_16x16x32_bf16 v[156:159], a[180:183], v[68:71], v[156:159]
    s_waitcnt vmcnt(16)
    v_mfma_f32_16x16x32_bf16 v[144:147], a[184:187], v[72:75], v[144:147]
    v_mfma_f32_16x16x32_bf16 v[148:151], a[184:187], v[76:79], v[148:151]
    v_mfma_f32_16x16x32_bf16 v[152:155], a[188:191], v[72:75], v[152:155]
    v_mfma_f32_16x16x32_bf16 v[156:159], a[188:191], v[76:79], v[156:159]
    s_waitcnt vmcnt(14)
    v_mfma_f32_16x16x32_bf16 v[144:147], a[192:195], v[80:83], v[144:147]
    v_mfma_f32_16x16x32_bf16 v[148:151], a[192:195], v[84:87], v[148:151]
    v_mfma_f32_16x16x32_bf16 v[152:155], a[196:199], v[80:83], v[152:155]
    v_mfma_f32_16x16x32_bf16 v[156:159], a[196:199], v[84:87], v[156:159]
    s_waitcnt vmcnt(12)
    v_mfma_f32_16x16x32_bf16 v[144:147], a[200:203], v[88:91], v[144:147]
    v_mfma_f32_16x16x32_bf16 v[148:151], a[200:203], v[92:95], v[148:151]
    v_mfma_f32_16x16x32_bf16 v[152:155], a[204:207], v[88:91], v[152:155]
    v_mfma_f32_16x16x32_bf16 v[156:159], a[204:207], v[92:95], v[156:159]
    s_waitcnt vmcnt(10)
    v_mfma_f32_16x16x32_bf16 v[144:147], a[208:211], v[96:99], v[144:147]
    v_mfma_f32_16x16x32_bf16 v[148:151], a[208:211], v[100:103], v[148:151]
    v_mfma_f32_16x16x32_bf16 v[152:155], a[212:215], v[96:99], v[152:155]
    v_mfma_f32_16x16x32_bf16 v[156:159], a[212:215], v[100:103], v[156:159]
    s_waitcnt vmcnt(8)
    v_mfma_f32_16x16x32_bf16 v[144:147], a[216:219], v[104:107], v[144:147]
    v_mfma_f32_16x16x32_bf16 v[148:151], a[216:219], v[108:111], v[148:151]
    v_mfma_f32_16x16x32_bf16 v[152:155], a[220:223], v[104:107], v[152:155]
    v_mfma_f32_16x16x32_bf16 v[156:159], a[220:223], v[108:111], v[156:159]
    s_waitcnt vmcnt(6)
    v_mfma_f32_16x16x32_bf16 v[144:147], a[224:227], v[112:115], v[144:147]
    v_mfma_f32_16x16x32_bf16 v[148:151], a[224:227], v[116:119], v[148:151]
    v_mfma_f32_16x16x32_bf16 v[152:155], a[228:231], v[112:115], v[152:155]
    v_mfma_f32_16x16x32_bf16 v[156:159], a[228:231], v[116:119], v[156:159]
    s_waitcnt vmcnt(4)
    v_mfma_f32_16x16x32_bf16 v[144:147], a[232:235], v[120:123], v[144:147]
    v_mfma_f32_16x16x32_bf16 v[148:151], a[232:235], v[124:127], v[148:151]
    v_mfma_f32_16x16x32_bf16 v[152:155], a[236:239], v[120:123], v[152:155]
    v_mfma_f32_16x16x32_bf16 v[156:159], a[236:239], v[124:127], v[156:159]
    s_waitcnt vmcnt(2)
    v_mfma_f32_16x16x32_bf16 v[144:147], a[240:243], v[128:131], v[144:147]
    v_mfma_f32_16x16x32_bf16 v[148:151], a[240:243], v[132:135], v[148:151]
    v_mfma_f32_16x16x32_bf16 v[152:155], a[244:247], v[128:131], v[152:155]
    v_mfma_f32_16x16x32_bf16 v[156:159], a[244:247], v[132:135], v[156:159]
    s_waitcnt vmcnt(0)
    v_mfma_f32_16x16x32_bf16 v[144:147], a[248:251], v[136:139], v[144:147]
    v_mfma_f32_16x16x32_bf16 v[148:151], a[248:251], v[140:143], v[148:151]
    v_mfma_f32_16x16x32_bf16 v[152:155], a[252:255], v[136:139], v[152:155]
    v_mfma_f32_16x16x32_bf16 v[156:159], a[252:255], v[140:143], v[156:159]
    s_lshl_b32 s64, s14, 12
    v_add_u32 v7, s64, v1
    s_barrier
    s_nop 3
    ds_write_b128 v7, v[144:147] offset:0
    ds_write_b128 v7, v[148:151] offset:1024
    ds_write_b128 v7, v[152:155] offset:2048
    ds_write_b128 v7, v[156:159] offset:3072
    s_waitcnt lgkmcnt(0)
    s_barrier
    s_lshl_b32 s64, s14, 10
    v_add_u32 v7, s64, v1
    ds_read_b128 v[16:19], v7 offset:0
    ds_read_b128 v[20:23], v7 offset:4096
    ds_read_b128 v[24:27], v7 offset:8192
    ds_read_b128 v[28:31], v7 offset:12288
    s_waitcnt lgkmcnt(0)
    v_add_f32 v16, v16, v20
    v_add_f32 v24, v24, v28
    v_add_f32 v16, v16, v24
    v_add_f32 v17, v17, v21
    v_add_f32 v25, v25, v29
    v_add_f32 v17, v17, v25
    v_add_f32 v18, v18, v22
    v_add_f32 v26, v26, v30
    v_add_f32 v18, v18, v26
    v_add_f32 v19, v19, v23
    v_add_f32 v27, v27, v31
    v_add_f32 v19, v19, v27
    v_cvt_pk_bf16_f32 v16, v16, v16
    v_lshlrev_b32 v16, 16, v16
    v_cvt_pk_bf16_f32 v17, v17, v17
    v_lshlrev_b32 v17, 16, v17
    v_cvt_pk_bf16_f32 v18, v18, v18
    v_lshlrev_b32 v18, 16, v18
    v_cvt_pk_bf16_f32 v19, v19, v19
    v_lshlrev_b32 v19, 16, v19
    v_lshlrev_b32 v20, 16, v162
    v_and_b32 v21, 0xffff0000, v162
    v_lshlrev_b32 v24, 16, v160
    v_and_b32 v25, 0xffff0000, v160
    v_lshlrev_b32 v22, 16, v163
    v_and_b32 v23, 0xffff0000, v163
    v_lshlrev_b32 v26, 16, v161
    v_and_b32 v27, 0xffff0000, v161
    s_lshl_b32 s64, s24, 5
    v_add_u32 v8, s64, v9
    v_mov_b32 v10, -1
    v_cmp_eq_u32 vcc, s72, v8
    s_nop 1
    v_cndmask_b32 v10, v10, 0, vcc
    v_cmp_eq_u32 vcc, s73, v8
    s_nop 1
    v_cndmask_b32 v10, v10, 1, vcc
    v_cmp_eq_u32 vcc, s74, v8
    s_nop 1
    v_cndmask_b32 v10, v10, 2, vcc
    v_cmp_eq_u32 vcc, s75, v8
    s_nop 1
    v_cndmask_b32 v10, v10, 3, vcc
    v_cmp_eq_u32 vcc, s76, v8
    s_nop 1
    v_cndmask_b32 v10, v10, 4, vcc
    v_cmp_eq_u32 vcc, s77, v8
    s_nop 1
    v_cndmask_b32 v10, v10, 5, vcc
    v_cmp_eq_u32 vcc, s78, v8
    s_nop 1
    v_cndmask_b32 v10, v10, 6, vcc
    v_cmp_eq_u32 vcc, s79, v8
    s_nop 1
    v_cndmask_b32 v10, v10, 7, vcc
    v_cmp_le_i32 vcc, 0, v10
    s_and_saveexec_b64 s[68:69], vcc
    s_cbranch_execz NOUPD_130
    v_mul_u32_u24 v10, 2560, v10
    v_lshrrev_b32 v11, 4, v0
    v_lshl_add_u32 v10, v11, 4, v10
    s_lshr_b32 s64, s14, 1
    s_lshl_b32 s64, s64, 6
    s_lshl_b32 s65, s13, 7
    s_add_u32 s64, s64, s65
    s_add_u32 s64, s64, 0x5410000
    buffer_load_dwordx4 v[164:167], v10, s[4:7], s64 offen sc1
    s_waitcnt vmcnt(0)
    v_add_f32 v20, v20, v164
    v_cvt_pk_bf16_f32 v20, v20, v20
    v_lshlrev_b32 v20, 16, v20
    v_add_f32 v21, v21, v165
    v_cvt_pk_bf16_f32 v21, v21, v21
    v_lshlrev_b32 v21, 16, v21
    v_add_f32 v22, v22, v166
    v_cvt_pk_bf16_f32 v22, v22, v22
    v_lshlrev_b32 v22, 16, v22
    v_add_f32 v23, v23, v167
    v_cvt_pk_bf16_f32 v23, v23, v23
    v_lshlrev_b32 v23, 16, v23
NOUPD_130:
    s_mov_b64 exec, -1
    v_mul_f32 v28, 0xbfb8aa3b, v20
    v_exp_f32 v28, v28
    s_nop 0
    v_add_f32 v28, 1.0, v28
    v_rcp_f32 v28, v28
    s_nop 0
    v_mul_f32 v28, v28, v20
    v_cvt_pk_bf16_f32 v28, v28, v28
    v_lshlrev_b32 v28, 16, v28
    v_mul_f32 v28, v28, v16
    v_cvt_pk_bf16_f32 v28, v28, v28
    v_lshlrev_b32 v28, 16, v28
    v_add_f32 v28, v28, v24
    v_mul_f32 v29, 0xbfb8aa3b, v21
    v_exp_f32 v29, v29
    s_nop 0
    v_add_f32 v29, 1.0, v29
    v_rcp_f32 v29, v29
    s_nop 0
    v_mul_f32 v29, v29, v21
    v_cvt_pk_bf16_f32 v29, v29, v29
    v_lshlrev_b32 v29, 16, v29
    v_mul_f32 v29, v29, v17
    v_cvt_pk_bf16_f32 v29, v29, v29
    v_lshlrev_b32 v29, 16, v29
    v_add_f32 v29, v29, v25
    v_mul_f32 v30, 0xbfb8aa3b, v22
    v_exp_f32 v30, v30
    s_nop 0
    v_add_f32 v30, 1.0, v30
    v_rcp_f32 v30, v30
    s_nop 0
    v_mul_f32 v30, v30, v22
    v_cvt_pk_bf16_f32 v30, v30, v30
    v_lshlrev_b32 v30, 16, v30
    v_mul_f32 v30, v30, v18
    v_cvt_pk_bf16_f32 v30, v30, v30
    v_lshlrev_b32 v30, 16, v30
    v_add_f32 v30, v30, v26
    v_mul_f32 v31, 0xbfb8aa3b, v23
    v_exp_f32 v31, v31
    s_nop 0
    v_add_f32 v31, 1.0, v31
    v_rcp_f32 v31, v31
    s_nop 0
    v_mul_f32 v31, v31, v23
    v_cvt_pk_bf16_f32 v31, v31, v31
    v_lshlrev_b32 v31, 16, v31
    v_mul_f32 v31, v31, v19
    v_cvt_pk_bf16_f32 v31, v31, v31
    v_lshlrev_b32 v31, 16, v31
    v_add_f32 v31, v31, v27
    v_cvt_pk_bf16_f32 v164, v28, v29
    v_cvt_pk_bf16_f32 v165, v30, v31
    buffer_store_dwordx2 v[164:165], v5, s[52:55], s67 offen
    s_branch OU_LOOP
OU_END:
    s_branch M_EXIT
H_Q:
    s_mov_b32 s29, 0
    v_lshlrev_b32 v1, 4, v0
    v_lshrrev_b32 v5, 4, v0
    v_lshlrev_b32 v2, 7, v5
    v_and_b32 v5, 7, v0
    v_lshl_add_u32 v2, v5, 4, v2
    v_bfe_u32 v5, v0, 4, 1
    v_lshlrev_b32 v3, 7, v5
    v_and_b32 v5, 15, v0
    v_lshl_add_u32 v3, v5, 3, v3
    s_mov_b32 s34, 0x3e0293ee
    s_mov_b32 s35, 0x3e0293ee
    s_mov_b32 s36, -1
    s_mov_b32 s37, 0
    v_lshrrev_b32 v5, 4, v0
    v_lshlrev_b32 v5, 2, v5
    v_and_b32 v6, 15, v0
    v_add_u32 v7, 0, v5
    v_cmp_le_u32 s[38:39], v7, v6
    v_add_u32 v7, 1, v5
    v_cmp_le_u32 s[40:41], v7, v6
    v_add_u32 v7, 2, v5
    v_cmp_le_u32 s[42:43], v7, v6
    v_add_u32 v7, 3, v5
    v_cmp_le_u32 s[44:45], v7, v6
    v_mov_b32 v248, 0x3f803f80
    v_mov_b32 v249, 0x3f803f80
    v_mov_b32 v250, 0x3f803f80
    v_mov_b32 v251, 0x3f803f80
    s_lshl_b32 s24, s12, 2
    s_add_u32 s24, s24, s14
    s_mov_b32 s25, 0
AT0_LOOP:
    s_lshl_b32 s64, s24, 5
    s_add_u32 s64, s64, s13
    s_lshl_b32 s26, s64, 13
    s_add_u32 s26, s26, 0x3400000
    s_lshl_b32 s27, s64, 14
    s_add_u32 s27, s27, 0x1400000
    s_lshl_b32 s65, s64, 11
    s_add_u32 s30, s65, 0x640000
    s_add_u32 s31, s65, 0xa40000
    s_lshl_b32 s33, s64, 2
    s_add_u32 s33, s33, 0x296000
    s_lshl_b32 s32, s24, 18
    s_lshl_b32 s65, s13, 12
    s_add_u32 s32, s32, s65
    s_add_u32 s32, s32, 0x4400000
    s_lshr_b32 s65, s24, 2
    s_lshl_b32 s65, s65, 9
    s_lshl_b32 s66, s13, 4
    s_add_u32 s65, s65, s66
    s_add_u32 s65, s65, 0x291000
    s_lshr_b32 s66, s24, 1
    s_lshl_b32 s66, s66, 8
    s_lshl_b32 s64, s13, 3
    s_add_u32 s66, s66, s64
    s_add_u32 s66, s66, 0x293ff4
    v_lshlrev_b32 v5, 2, v0
    v_mov_b32 v6, s65
    v_mov_b32 v7, s66
    v_cmp_gt_u32 vcc, 3, v0
    s_nop 1
    v_cndmask_b32 v6, v7, v6, vcc
    v_add_u32 v4, v5, v6
    s_mov_b32 s64, 0
    s_mov_b64 exec, 7
AT0_F_131:
    buffer_load_dword v5, v4, s[4:7], s64 offen sc1
    s_add_u32 s29, s29, 1
    s_waitcnt vmcnt(0)
    v_cmp_eq_u32 vcc, 0, v5
    s_cbranch_vccz AT0_FD_132
    s_cmp_gt_u32 s29, 262144
    s_cbranch_scc1 AT0_FD_132
    s_sleep 4
    s_branch AT0_F_131
AT0_FD_132:
    s_mov_b64 exec, -1
    buffer_load_dwordx4 v[16:19], v1, s[4:7], s26 offen offset:0
    buffer_load_dwordx4 v[20:23], v1, s[4:7], s26 offen offset:1024
    buffer_load_dwordx4 v[24:27], v1, s[4:7], s26 offen offset:2048
    buffer_load_dwordx4 v[28:31], v1, s[4:7], s26 offen offset:3072
    s_add_u32 s26, s26, 4096
    buffer_load_dwordx4 v[32:35], v1, s[4:7], s26 offen offset:0
    buffer_load_dwordx4 v[36:39], v1, s[4:7], s26 offen offset:1024
    buffer_load_dwordx4 v[40:43], v1, s[4:7], s26 offen offset:2048
    buffer_load_dwordx4 v[44:47], v1, s[4:7], s26 offen offset:3072
    buffer_load_dwordx4 v[48:51], v1, s[4:7], s27 offen offset:0
    buffer_load_dwordx4 v[52:55], v1, s[4:7], s27 offen offset:1024
    buffer_load_dwordx4 v[56:59], v1, s[4:7], s27 offen offset:2048
    buffer_load_dwordx4 v[60:63], v1, s[4:7], s27 offen offset:3072
    s_add_u32 s27, s27, 4096
    buffer_load_dwordx4 v[64:67], v1, s[4:7], s27 offen offset:0
    buffer_load_dwordx4 v[68:71], v1, s[4:7], s27 offen offset:1024
    buffer_load_dwordx4 v[72:75], v1, s[4:7], s27 offen offset:2048
    buffer_load_dwordx4 v[76:79], v1, s[4:7], s27 offen offset:3072
    s_add_u32 s27, s27, 4096
    buffer_load_dwordx4 v[80:83], v1, s[4:7], s27 offen offset:0
    buffer_load_dwordx4 v[84:87], v1, s[4:7], s27 offen offset:1024
    buffer_load_dwordx4 v[88:91], v1, s[4:7], s27 offen offset:2048
    buffer_load_dwordx4 v[92:95], v1, s[4:7], s27 offen offset:3072
    s_add_u32 s27, s27, 4096
    buffer_load_dwordx4 v[96:99], v1, s[4:7], s27 offen offset:0
    buffer_load_dwordx4 v[100:103], v1, s[4:7], s27 offen offset:1024
    buffer_load_dwordx4 v[104:107], v1, s[4:7], s27 offen offset:2048
    buffer_load_dwordx4 v[108:111], v1, s[4:7], s27 offen offset:3072
    s_mov_b64 exec, 0x18
AT0_G_133:
    buffer_load_dword v5, v4, s[4:7], s64 offen sc1
    s_add_u32 s29, s29, 1
    s_waitcnt vmcnt(0)
    v_cmp_eq_u32 vcc, 0, v5
    s_cbranch_vccz AT0_GD_134
    s_cmp_gt_u32 s29, 262144
    s_cbranch_scc1 AT0_GD_134
    s_sleep 4
    s_branch AT0_G_133
AT0_GD_134:
    s_mov_b64 exec, -1
    buffer_load_dwordx4 v[112:115], v2, s[4:7], s30 offen offset:0
    buffer_load_dwordx4 v[116:119], v2, s[4:7], s30 offen offset:512
    buffer_load_dwordx4 v[120:123], v2, s[4:7], s30 offen offset:1024
    buffer_load_dwordx4 v[124:127], v2, s[4:7], s30 offen offset:1536
    buffer_load_dwordx2 v[128:129], v3, s[4:7], s31 offen offset:0
    buffer_load_dwordx2 v[130:131], v3, s[4:7], s31 offen offset:256
    buffer_load_dwordx2 v[132:133], v3, s[4:7], s31 offen offset:512
    buffer_load_dwordx2 v[134:135], v3, s[4:7], s31 offen offset:768
    buffer_load_dwordx2 v[136:137], v3, s[4:7], s31 offen offset:1024
    buffer_load_dwordx2 v[138:139], v3, s[4:7], s31 offen offset:1280
    buffer_load_dwordx2 v[140:141], v3, s[4:7], s31 offen offset:1536
    buffer_load_dwordx2 v[142:143], v3, s[4:7], s31 offen offset:1792
    v_mfma_f32_16x16x32_bf16 v[148:151], v[48:51], v[16:19], 0
    v_mfma_f32_16x16x32_bf16 v[156:159], v[48:51], v[32:35], 0
    v_mfma_f32_16x16x32_bf16 v[160:163], v[64:67], v[32:35], 0
    v_mfma_f32_16x16x32_bf16 v[148:151], v[52:55], v[20:23], v[148:151]
    v_mfma_f32_16x16x32_bf16 v[156:159], v[52:55], v[36:39], v[156:159]
    v_mfma_f32_16x16x32_bf16 v[160:163], v[68:71], v[36:39], v[160:163]
    v_mfma_f32_16x16x32_bf16 v[148:151], v[56:59], v[24:27], v[148:151]
    v_mfma_f32_16x16x32_bf16 v[156:159], v[56:59], v[40:43], v[156:159]
    v_mfma_f32_16x16x32_bf16 v[160:163], v[72:75], v[40:43], v[160:163]
    v_mfma_f32_16x16x32_bf16 v[148:151], v[60:63], v[28:31], v[148:151]
    v_mfma_f32_16x16x32_bf16 v[156:159], v[60:63], v[44:47], v[156:159]
    v_mfma_f32_16x16x32_bf16 v[160:163], v[76:79], v[44:47], v[160:163]
    s_waitcnt vmcnt(8)
    v_mfma_f32_16x16x32_bf16 v[144:147], v[112:115], v[16:19], 0
    v_mfma_f32_16x16x32_bf16 v[152:155], v[112:115], v[32:35], 0
    v_mfma_f32_16x16x32_bf16 v[144:147], v[116:119], v[20:23], v[144:147]
    v_mfma_f32_16x16x32_bf16 v[152:155], v[116:119], v[36:39], v[152:155]
    v_mfma_f32_16x16x32_bf16 v[144:147], v[120:123], v[24:27], v[144:147]
    v_mfma_f32_16x16x32_bf16 v[152:155], v[120:123], v[40:43], v[152:155]
    v_mfma_f32_16x16x32_bf16 v[144:147], v[124:127], v[28:31], v[144:147]
    v_mfma_f32_16x16x32_bf16 v[152:155], v[124:127], v[44:47], v[152:155]
    v_mov_b32 v11, 0xff800000
    s_nop 7
    v_cndmask_b32 v148, v11, v148, s[38:39]
    v_cndmask_b32 v160, v11, v160, s[38:39]
    v_cndmask_b32 v144, v11, v144, s[36:37]
    v_cndmask_b32 v152, v11, v152, s[36:37]
    v_cndmask_b32 v149, v11, v149, s[40:41]
    v_cndmask_b32 v161, v11, v161, s[40:41]
    v_cndmask_b32 v145, v11, v145, s[36:37]
    v_cndmask_b32 v153, v11, v153, s[36:37]
    v_cndmask_b32 v150, v11, v150, s[42:43]
    v_cndmask_b32 v162, v11, v162, s[42:43]
    v_cndmask_b32 v146, v11, v146, s[36:37]
    v_cndmask_b32 v154, v11, v154, s[36:37]
    v_cndmask_b32 v151, v11, v151, s[44:45]
    v_cndmask_b32 v163, v11, v163, s[44:45]
    v_cndmask_b32 v147, v11, v147, s[36:37]
    v_cndmask_b32 v155, v11, v155, s[36:37]
    v_max3_f32 v8, v144, v145, v146
    v_max3_f32 v8, v8, v147, v148
    v_max3_f32 v8, v8, v149, v150
    v_max_f32 v8, v8, v151
    v_mov_b32 v9, v8
    s_nop 1
    v_permlane16_swap_b32 v8, v9
    v_max_f32 v8, v8, v9
    v_mov_b32 v9, v8
    s_nop 1
    v_permlane32_swap_b32 v8, v9
    v_max_f32 v8, v8, v9
    v_mul_f32 v8, s34, v8
    v_fma_f32 v144, v144, s34, -v8
    v_fma_f32 v145, v145, s34, -v8
    v_fma_f32 v146, v146, s34, -v8
    v_fma_f32 v147, v147, s34, -v8
    v_fma_f32 v148, v148, s34, -v8
    v_fma_f32 v149, v149, s34, -v8
    v_fma_f32 v150, v150, s34, -v8
    v_fma_f32 v151, v151, s34, -v8
    v_exp_f32 v144, v144
    v_exp_f32 v145, v145
    v_exp_f32 v146, v146
    v_exp_f32 v147, v147
    v_exp_f32 v148, v148
    v_exp_f32 v149, v149
    v_exp_f32 v150, v150
    v_exp_f32 v151, v151
    s_nop 0
    v_cvt_pk_bf16_f32 v164, v148, v149
    v_cvt_pk_bf16_f32 v165, v150, v151
    v_mov_b32 v166, 0
    v_mov_b32 v167, 0
    v_cvt_pk_bf16_f32 v168, v144, v145
    v_cvt_pk_bf16_f32 v169, v146, v147
    v_max3_f32 v8, v152, v153, v154
    v_max3_f32 v8, v8, v155, v156
    v_max3_f32 v8, v8, v157, v158
    v_max3_f32 v8, v8, v159, v160
    v_max3_f32 v8, v8, v161, v162
    v_max_f32 v8, v8, v163
    v_mov_b32 v9, v8
    s_nop 1
    v_permlane16_swap_b32 v8, v9
    v_max_f32 v8, v8, v9
    v_mov_b32 v9, v8
    s_nop 1
    v_permlane32_swap_b32 v8, v9
    v_max_f32 v8, v8, v9
    v_mul_f32 v8, s34, v8
    v_fma_f32 v152, v152, s34, -v8
    v_fma_f32 v153, v153, s34, -v8
    v_fma_f32 v154, v154, s34, -v8
    v_fma_f32 v155, v155, s34, -v8
    v_fma_f32 v156, v156, s34, -v8
    v_fma_f32 v157, v157, s34, -v8
    v_fma_f32 v158, v158, s34, -v8
    v_fma_f32 v159, v159, s34, -v8
    v_fma_f32 v160, v160, s34, -v8
    v_fma_f32 v161, v161, s34, -v8
    v_fma_f32 v162, v162, s34, -v8
    v_fma_f32 v163, v163, s34, -v8
    v_exp_f32 v152, v152
    v_exp_f32 v153, v153
    v_exp_f32 v154, v154
    v_exp_f32 v155, v155
    v_exp_f32 v156, v156
    v_exp_f32 v157, v157
    v_exp_f32 v158, v158
    v_exp_f32 v159, v159
    v_exp_f32 v160, v160
    v_exp_f32 v161, v161
    v_exp_f32 v162, v162
    v_exp_f32 v163, v163
    s_nop 0
    v_cvt_pk_bf16_f32 v170, v156, v157
    v_cvt_pk_bf16_f32 v171, v158, v159
    v_cvt_pk_bf16_f32 v172, v160, v161
    v_cvt_pk_bf16_f32 v173, v162, v163
    v_cvt_pk_bf16_f32 v174, v152, v153
    v_cvt_pk_bf16_f32 v175, v154, v155
    s_waitcnt vmcnt(0)
    v_mfma_f32_16x16x32_bf16 v[240:243], v[248:251], v[164:167], 0
    v_mfma_f32_16x16x32_bf16 v[244:247], v[248:251], v[170:173], 0
    v_mfma_f32_16x16x32_bf16 v[176:179], v[80:83], v[164:167], 0
    v_mfma_f32_16x16x32_bf16 v[180:183], v[80:83], v[170:173], 0
    v_mfma_f32_16x16x32_bf16 v[184:187], v[84:87], v[164:167], 0
    v_mfma_f32_16x16x32_bf16 v[188:191], v[84:87], v[170:173], 0
    v_mfma_f32_16x16x32_bf16 v[192:195], v[88:91], v[164:167], 0
    v_mfma_f32_16x16x32_bf16 v[196:199], v[88:91], v[170:173], 0
    v_mfma_f32_16x16x32_bf16 v[200:203], v[92:95], v[164:167], 0
    v_mfma_f32_16x16x32_bf16 v[204:207], v[92:95], v[170:173], 0
    v_mfma_f32_16x16x32_bf16 v[208:211], v[96:99], v[164:167], 0
    v_mfma_f32_16x16x32_bf16 v[212:215], v[96:99], v[170:173], 0
    v_mfma_f32_16x16x32_bf16 v[216:219], v[100:103], v[164:167], 0
    v_mfma_f32_16x16x32_bf16 v[220:223], v[100:103], v[170:173], 0
    v_mfma_f32_16x16x32_bf16 v[224:227], v[104:107], v[164:167], 0
    v_mfma_f32_16x16x32_bf16 v[228:231], v[104:107], v[170:173], 0
    v_mfma_f32_16x16x32_bf16 v[232:235], v[108:111], v[164:167], 0
    v_mfma_f32_16x16x32_bf16 v[236:239], v[108:111], v[170:173], 0
    v_mfma_f32_16x16x16_bf16 v[240:243], v[248:249], v[168:169], v[240:243]
    v_mfma_f32_16x16x16_bf16 v[244:247], v[248:249], v[174:175], v[244:247]
    v_mfma_f32_16x16x16_bf16 v[176:179], v[128:129], v[168:169], v[176:179]
    v_mfma_f32_16x16x16_bf16 v[180:183], v[128:129], v[174:175], v[180:183]
    v_mfma_f32_16x16x16_bf16 v[184:187], v[130:131], v[168:169], v[184:187]
    v_mfma_f32_16x16x16_bf16 v[188:191], v[130:131], v[174:175], v[188:191]
    v_mfma_f32_16x16x16_bf16 v[192:195], v[132:133], v[168:169], v[192:195]
    v_mfma_f32_16x16x16_bf16 v[196:199], v[132:133], v[174:175], v[196:199]
    v_mfma_f32_16x16x16_bf16 v[200:203], v[134:135], v[168:169], v[200:203]
    v_mfma_f32_16x16x16_bf16 v[204:207], v[134:135], v[174:175], v[204:207]
    v_mfma_f32_16x16x16_bf16 v[208:211], v[136:137], v[168:169], v[208:211]
    v_mfma_f32_16x16x16_bf16 v[212:215], v[136:137], v[174:175], v[212:215]
    v_mfma_f32_16x16x16_bf16 v[216:219], v[138:139], v[168:169], v[216:219]
    v_mfma_f32_16x16x16_bf16 v[220:223], v[138:139], v[174:175], v[220:223]
    v_mfma_f32_16x16x16_bf16 v[224:227], v[140:141], v[168:169], v[224:227]
    v_mfma_f32_16x16x16_bf16 v[228:231], v[140:141], v[174:175], v[228:231]
    v_mfma_f32_16x16x16_bf16 v[232:235], v[142:143], v[168:169], v[232:235]
    v_mfma_f32_16x16x16_bf16 v[236:239], v[142:143], v[174:175], v[236:239]
    v_rcp_f32 v8, v240
    v_rcp_f32 v9, v244
    s_nop 7
    v_mul_f32 v176, v176, v8
    v_mul_f32 v177, v177, v8
    v_mul_f32 v178, v178, v8
    v_mul_f32 v179, v179, v8
    v_cvt_pk_bf16_f32 v16, v176, v177
    v_cvt_pk_bf16_f32 v17, v178, v179
    v_mul_f32 v184, v184, v8
    v_mul_f32 v185, v185, v8
    v_mul_f32 v186, v186, v8
    v_mul_f32 v187, v187, v8
    v_cvt_pk_bf16_f32 v18, v184, v185
    v_cvt_pk_bf16_f32 v19, v186, v187
    s_add_u32 s64, s32, 0x0
    buffer_store_dwordx4 v[16:19], v1, s[4:7], s64 offen offset:0 sc1
    v_mul_f32 v192, v192, v8
    v_mul_f32 v193, v193, v8
    v_mul_f32 v194, v194, v8
    v_mul_f32 v195, v195, v8
    v_cvt_pk_bf16_f32 v20, v192, v193
    v_cvt_pk_bf16_f32 v21, v194, v195
    v_mul_f32 v200, v200, v8
    v_mul_f32 v201, v201, v8
    v_mul_f32 v202, v202, v8
    v_mul_f32 v203, v203, v8
    v_cvt_pk_bf16_f32 v22, v200, v201
    v_cvt_pk_bf16_f32 v23, v202, v203
    s_add_u32 s64, s32, 0x0
    buffer_store_dwordx4 v[20:23], v1, s[4:7], s64 offen offset:1024 sc1
    v_mul_f32 v208, v208, v8
    v_mul_f32 v209, v209, v8
    v_mul_f32 v210, v210, v8
    v_mul_f32 v211, v211, v8
    v_cvt_pk_bf16_f32 v24, v208, v209
    v_cvt_pk_bf16_f32 v25, v210, v211
    v_mul_f32 v216, v216, v8
    v_mul_f32 v217, v217, v8
    v_mul_f32 v218, v218, v8
    v_mul_f32 v219, v219, v8
    v_cvt_pk_bf16_f32 v26, v216, v217
    v_cvt_pk_bf16_f32 v27, v218, v219
    s_add_u32 s64, s32, 0x0
    buffer_store_dwordx4 v[24:27], v1, s[4:7], s64 offen offset:2048 sc1
    v_mul_f32 v224, v224, v8
    v_mul_f32 v225, v225, v8
    v_mul_f32 v226, v226, v8
    v_mul_f32 v227, v227, v8
    v_cvt_pk_bf16_f32 v28, v224, v225
    v_cvt_pk_bf16_f32 v29, v226, v227
    v_mul_f32 v232, v232, v8
    v_mul_f32 v233, v233, v8
    v_mul_f32 v234, v234, v8
    v_mul_f32 v235, v235, v8
    v_cvt_pk_bf16_f32 v30, v232, v233
    v_cvt_pk_bf16_f32 v31, v234, v235
    s_add_u32 s64, s32, 0x0
    buffer_store_dwordx4 v[28:31], v1, s[4:7], s64 offen offset:3072 sc1
    v_mul_f32 v180, v180, v9
    v_mul_f32 v181, v181, v9
    v_mul_f32 v182, v182, v9
    v_mul_f32 v183, v183, v9
    v_cvt_pk_bf16_f32 v32, v180, v181
    v_cvt_pk_bf16_f32 v33, v182, v183
    v_mul_f32 v188, v188, v9
    v_mul_f32 v189, v189, v9
    v_mul_f32 v190, v190, v9
    v_mul_f32 v191, v191, v9
    v_cvt_pk_bf16_f32 v34, v188, v189
    v_cvt_pk_bf16_f32 v35, v190, v191
    s_add_u32 s64, s32, 0x20000
    buffer_store_dwordx4 v[32:35], v1, s[4:7], s64 offen offset:0 sc1
    v_mul_f32 v196, v196, v9
    v_mul_f32 v197, v197, v9
    v_mul_f32 v198, v198, v9
    v_mul_f32 v199, v199, v9
    v_cvt_pk_bf16_f32 v36, v196, v197
    v_cvt_pk_bf16_f32 v37, v198, v199
    v_mul_f32 v204, v204, v9
    v_mul_f32 v205, v205, v9
    v_mul_f32 v206, v206, v9
    v_mul_f32 v207, v207, v9
    v_cvt_pk_bf16_f32 v38, v204, v205
    v_cvt_pk_bf16_f32 v39, v206, v207
    s_add_u32 s64, s32, 0x20000
    buffer_store_dwordx4 v[36:39], v1, s[4:7], s64 offen offset:1024 sc1
    v_mul_f32 v212, v212, v9
    v_mul_f32 v213, v213, v9
    v_mul_f32 v214, v214, v9
    v_mul_f32 v215, v215, v9
    v_cvt_pk_bf16_f32 v40, v212, v213
    v_cvt_pk_bf16_f32 v41, v214, v215
    v_mul_f32 v220, v220, v9
    v_mul_f32 v221, v221, v9
    v_mul_f32 v222, v222, v9
    v_mul_f32 v223, v223, v9
    v_cvt_pk_bf16_f32 v42, v220, v221
    v_cvt_pk_bf16_f32 v43, v222, v223
    s_add_u32 s64, s32, 0x20000
    buffer_store_dwordx4 v[40:43], v1, s[4:7], s64 offen offset:2048 sc1
    v_mul_f32 v228, v228, v9
    v_mul_f32 v229, v229, v9
    v_mul_f32 v230, v230, v9
    v_mul_f32 v231, v231, v9
    v_cvt_pk_bf16_f32 v44, v228, v229
    v_cvt_pk_bf16_f32 v45, v230, v231
    v_mul_f32 v236, v236, v9
    v_mul_f32 v237, v237, v9
    v_mul_f32 v238, v238, v9
    v_mul_f32 v239, v239, v9
    v_cvt_pk_bf16_f32 v46, v236, v237
    v_cvt_pk_bf16_f32 v47, v238, v239
    s_add_u32 s64, s32, 0x20000
    buffer_store_dwordx4 v[44:47], v1, s[4:7], s64 offen offset:3072 sc1
    s_waitcnt vmcnt(0)
    v_mov_b32 v7, 1
    v_mov_b32 v8, 0
    s_mov_b64 exec, 1
    buffer_store_dword v7, v8, s[4:7], s33 offen sc1
    s_mov_b64 exec, -1
    s_add_u32 s24, s24, 8
    s_add_u32 s25, s25, 1
    s_cmp_lt_u32 s25, 1
    s_cbranch_scc1 AT0_LOOP
    s_lshl_b32 s70, s13, 1
    s_add_u32 s70, s70, s12
    s_load_dwordx2 s[44:45], s[0:1], 72
    s_mov_b32 s46, 0x21c000
    s_mov_b32 s47, 0x00020000
    s_load_dwordx2 s[48:49], s[0:1], 80
    s_mov_b32 s50, 0x21c000
    s_mov_b32 s51, 0x00020000
    s_load_dwordx2 s[52:53], s[0:1], 88
    s_mov_b32 s54, 0x21c000
    s_mov_b32 s55, 0x00020000
    s_mov_b32 s29, 0
    s_waitcnt lgkmcnt(0)
    v_mbcnt_lo_u32_b32 v0, -1, 0
    v_mbcnt_hi_u32_b32 v0, -1, v0
    s_lshl_b32 s24, s70, 2
    s_add_u32 s24, s24, s14
    s_cmp_ge_u32 s24, 108
    s_cbranch_scc1 H_A1
    v_mov_b32 v8, 0
    s_mov_b32 s64, 0x298000
F1W_135:
    buffer_load_dword v7, v8, s[4:7], s64 offen sc1
    s_add_u32 s29, s29, 1
    s_waitcnt vmcnt(0)
    v_cmp_gt_u32 vcc, 1, v7
    s_cbranch_vccz F1WD_136
    s_cmp_gt_u32 s29, 262144
    s_cbranch_scc1 F1WD_136
    s_sleep 8
    s_branch F1W_135
F1WD_136:
    s_mul_i32 s25, s14, 40960
    v_lshrrev_b32 v7, 1, v0
    v_mul_u32_u24 v2, 3456, v7
    v_and_b32 v7, 1, v0
    v_lshl_add_u32 v2, v7, 4, v2
    v_lshrrev_b32 v7, 4, v0
    v_lshlrev_b32 v3, 8, v7
    v_bfe_u32 v7, v0, 2, 2
    v_lshl_add_u32 v3, v7, 5, v3
    v_and_b32 v7, 3, v0
    v_lshl_add_u32 v3, v7, 3, v3
    v_add_u32 v3, s25, v3
    v_and_b32 v7, 7, v0
    v_lshlrev_b32 v7, 2, v7
    s_mov_b32 s64, 0x5400000
    buffer_load_dword v4, v7, s[4:7], s64 offen sc1
    s_waitcnt vmcnt(0)
    v_mul_u32_u24 v4, 1280, v4
    v_lshrrev_b32 v7, 4, v0
    v_lshl_add_u32 v4, v7, 4, v4
    s_mov_b32 s65, 0x0
    buffer_load_dwordx4 v[16:19], v4, s[4:7], s65 offen offset:0 sc1
    buffer_load_dwordx4 v[20:23], v4, s[4:7], s65 offen offset:64 sc1
    buffer_load_dwordx4 v[24:27], v4, s[4:7], s65 offen offset:128 sc1
    buffer_load_dwordx4 v[28:31], v4, s[4:7], s65 offen offset:192 sc1
    buffer_load_dwordx4 v[32:35], v4, s[4:7], s65 offen offset:256 sc1
    buffer_load_dwordx4 v[36:39], v4, s[4:7], s65 offen offset:320 sc1
    buffer_load_dwordx4 v[40:43], v4, s[4:7], s65 offen offset:384 sc1
    buffer_load_dwordx4 v[44:47], v4, s[4:7], s65 offen offset:448 sc1
    buffer_load_dwordx4 v[48:51], v4, s[4:7], s65 offen offset:512 sc1
    buffer_load_dwordx4 v[52:55], v4, s[4:7], s65 offen offset:576 sc1
    buffer_load_dwordx4 v[56:59], v4, s[4:7], s65 offen offset:640 sc1
    buffer_load_dwordx4 v[60:63], v4, s[4:7], s65 offen offset:704 sc1
    buffer_load_dwordx4 v[64:67], v4, s[4:7], s65 offen offset:768 sc1
    buffer_load_dwordx4 v[68:71], v4, s[4:7], s65 offen offset:832 sc1
    buffer_load_dwordx4 v[72:75], v4, s[4:7], s65 offen offset:896 sc1
    buffer_load_dwordx4 v[76:79], v4, s[4:7], s65 offen offset:960 sc1
    buffer_load_dwordx4 v[80:83], v4, s[4:7], s65 offen offset:1024 sc1
    buffer_load_dwordx4 v[84:87], v4, s[4:7], s65 offen offset:1088 sc1
    buffer_load_dwordx4 v[88:91], v4, s[4:7], s65 offen offset:1152 sc1
    buffer_load_dwordx4 v[92:95], v4, s[4:7], s65 offen offset:1216 sc1
    s_lshl_b32 s26, s24, 5
    s_add_u32 m0, s25, 0
    s_add_u32 s64, s26, 0x0
    buffer_load_dwordx4 v2, s[44:47], s64 offen lds
    s_add_u32 m0, s25, 1024
    s_add_u32 s64, s26, 0x1b000
    buffer_load_dwordx4 v2, s[44:47], s64 offen lds
    s_add_u32 m0, s25, 2048
    s_add_u32 s64, s26, 0x36000
    buffer_load_dwordx4 v2, s[44:47], s64 offen lds
    s_add_u32 m0, s25, 3072
    s_add_u32 s64, s26, 0x51000
    buffer_load_dwordx4 v2, s[44:47], s64 offen lds
    s_add_u32 m0, s25, 4096
    s_add_u32 s64, s26, 0x6c000
    buffer_load_dwordx4 v2, s[44:47], s64 offen lds
    s_add_u32 m0, s25, 5120
    s_add_u32 s64, s26, 0x87000
    buffer_load_dwordx4 v2, s[44:47], s64 offen lds
    s_add_u32 m0, s25, 6144
    s_add_u32 s64, s26, 0xa2000
    buffer_load_dwordx4 v2, s[44:47], s64 offen lds
    s_add_u32 m0, s25, 7168
    s_add_u32 s64, s26, 0xbd000
    buffer_load_dwordx4 v2, s[44:47], s64 offen lds
    s_add_u32 m0, s25, 8192
    s_add_u32 s64, s26, 0xd8000
    buffer_load_dwordx4 v2, s[44:47], s64 offen lds
    s_add_u32 m0, s25, 9216
    s_add_u32 s64, s26, 0xf3000
    buffer_load_dwordx4 v2, s[44:47], s64 offen lds
    s_add_u32 m0, s25, 10240
    s_add_u32 s64, s26, 0x10e000
    buffer_load_dwordx4 v2, s[44:47], s64 offen lds
    s_add_u32 m0, s25, 11264
    s_add_u32 s64, s26, 0x129000
    buffer_load_dwordx4 v2, s[44:47], s64 offen lds
    s_add_u32 m0, s25, 12288
    s_add_u32 s64, s26, 0x144000
    buffer_load_dwordx4 v2, s[44:47], s64 offen lds
    s_add_u32 m0, s25, 13312
    s_add_u32 s64, s26, 0x15f000
    buffer_load_dwordx4 v2, s[44:47], s64 offen lds
    s_add_u32 m0, s25, 14336
    s_add_u32 s64, s26, 0x17a000
    buffer_load_dwordx4 v2, s[44:47], s64 offen lds
    s_add_u32 m0, s25, 15360
    s_add_u32 s64, s26, 0x195000
    buffer_load_dwordx4 v2, s[44:47], s64 offen lds
    s_add_u32 m0, s25, 16384
    s_add_u32 s64, s26, 0x1b0000
    buffer_load_dwordx4 v2, s[44:47], s64 offen lds
    s_add_u32 m0, s25, 17408
    s_add_u32 s64, s26, 0x1cb000
    buffer_load_dwordx4 v2, s[44:47], s64 offen lds
    s_add_u32 m0, s25, 18432
    s_add_u32 s64, s26, 0x1e6000
    buffer_load_dwordx4 v2, s[44:47], s64 offen lds
    s_add_u32 m0, s25, 19456
    s_add_u32 s64, s26, 0x201000
    buffer_load_dwordx4 v2, s[44:47], s64 offen lds
    s_waitcnt vmcnt(0)
    ds_read_b64_tr_b16 v[96:97], v3 offset:0
    ds_read_b64_tr_b16 v[98:99], v3 offset:128
    ds_read_b64_tr_b16 v[100:101], v3 offset:1024
    ds_read_b64_tr_b16 v[102:103], v3 offset:1152
    ds_read_b64_tr_b16 v[104:105], v3 offset:2048
    ds_read_b64_tr_b16 v[106:107], v3 offset:2176
    ds_read_b64_tr_b16 v[108:109], v3 offset:3072
    ds_read_b64_tr_b16 v[110:111], v3 offset:3200
    ds_read_b64_tr_b16 v[112:113], v3 offset:4096
    ds_read_b64_tr_b16 v[114:115], v3 offset:4224
    ds_read_b64_tr_b16 v[116:117], v3 offset:5120
    ds_read_b64_tr_b16 v[118:119], v3 offset:5248
    s_waitcnt lgkmcnt(4)
    ds_read_b64_tr_b16 v[120:121], v3 offset:6144
    ds_read_b64_tr_b16 v[122:123], v3 offset:6272
    ds_read_b64_tr_b16 v[124:125], v3 offset:7168
    ds_read_b64_tr_b16 v[126:127], v3 offset:7296
    ds_read_b64_tr_b16 v[128:129], v3 offset:8192
    ds_read_b64_tr_b16 v[130:131], v3 offset:8320
    ds_read_b64_tr_b16 v[132:133], v3 offset:9216
    ds_read_b64_tr_b16 v[134:135], v3 offset:9344
    ds_read_b64_tr_b16 v[136:137], v3 offset:10240
    ds_read_b64_tr_b16 v[138:139], v3 offset:10368
    ds_read_b64_tr_b16 v[140:141], v3 offset:11264
    ds_read_b64_tr_b16 v[142:143], v3 offset:11392
    s_waitcnt lgkmcnt(4)
    ds_read_b64_tr_b16 v[144:145], v3 offset:12288
    ds_read_b64_tr_b16 v[146:147], v3 offset:12416
    ds_read_b64_tr_b16 v[148:149], v3 offset:13312
    ds_read_b64_tr_b16 v[150:151], v3 offset:13440
    ds_read_b64_tr_b16 v[152:153], v3 offset:14336
    ds_read_b64_tr_b16 v[154:155], v3 offset:14464
    ds_read_b64_tr_b16 v[156:157], v3 offset:15360
    ds_read_b64_tr_b16 v[158:159], v3 offset:15488
    ds_read_b64_tr_b16 v[160:161], v3 offset:16384
    ds_read_b64_tr_b16 v[162:163], v3 offset:16512
    ds_read_b64_tr_b16 v[164:165], v3 offset:17408
    ds_read_b64_tr_b16 v[166:167], v3 offset:17536
    s_waitcnt lgkmcnt(4)
    ds_read_b64_tr_b16 v[168:169], v3 offset:18432
    ds_read_b64_tr_b16 v[170:171], v3 offset:18560
    ds_read_b64_tr_b16 v[172:173], v3 offset:19456
    ds_read_b64_tr_b16 v[174:175], v3 offset:19584
    s_waitcnt lgkmcnt(0)
    s_add_u32 s25, s25, 20480
    v_add_u32 v3, 20480, v3
    s_add_u32 m0, s25, 0
    s_add_u32 s64, s26, 0x0
    buffer_load_dwordx4 v2, s[48:51], s64 offen lds
    s_add_u32 m0, s25, 1024
    s_add_u32 s64, s26, 0x1b000
    buffer_load_dwordx4 v2, s[48:51], s64 offen lds
    s_add_u32 m0, s25, 2048
    s_add_u32 s64, s26, 0x36000
    buffer_load_dwordx4 v2, s[48:51], s64 offen lds
    s_add_u32 m0, s25, 3072
    s_add_u32 s64, s26, 0x51000
    buffer_load_dwordx4 v2, s[48:51], s64 offen lds
    s_add_u32 m0, s25, 4096
    s_add_u32 s64, s26, 0x6c000
    buffer_load_dwordx4 v2, s[48:51], s64 offen lds
    s_add_u32 m0, s25, 5120
    s_add_u32 s64, s26, 0x87000
    buffer_load_dwordx4 v2, s[48:51], s64 offen lds
    s_add_u32 m0, s25, 6144
    s_add_u32 s64, s26, 0xa2000
    buffer_load_dwordx4 v2, s[48:51], s64 offen lds
    s_add_u32 m0, s25, 7168
    s_add_u32 s64, s26, 0xbd000
    buffer_load_dwordx4 v2, s[48:51], s64 offen lds
    s_add_u32 m0, s25, 8192
    s_add_u32 s64, s26, 0xd8000
    buffer_load_dwordx4 v2, s[48:51], s64 offen lds
    s_add_u32 m0, s25, 9216
    s_add_u32 s64, s26, 0xf3000
    buffer_load_dwordx4 v2, s[48:51], s64 offen lds
    s_add_u32 m0, s25, 10240
    s_add_u32 s64, s26, 0x10e000
    buffer_load_dwordx4 v2, s[48:51], s64 offen lds
    s_add_u32 m0, s25, 11264
    s_add_u32 s64, s26, 0x129000
    buffer_load_dwordx4 v2, s[48:51], s64 offen lds
    s_add_u32 m0, s25, 12288
    s_add_u32 s64, s26, 0x144000
    buffer_load_dwordx4 v2, s[48:51], s64 offen lds
    s_add_u32 m0, s25, 13312
    s_add_u32 s64, s26, 0x15f000
    buffer_load_dwordx4 v2, s[48:51], s64 offen lds
    s_add_u32 m0, s25, 14336
    s_add_u32 s64, s26, 0x17a000
    buffer_load_dwordx4 v2, s[48:51], s64 offen lds
    s_add_u32 m0, s25, 15360
    s_add_u32 s64, s26, 0x195000
    buffer_load_dwordx4 v2, s[48:51], s64 offen lds
    s_add_u32 m0, s25, 16384
    s_add_u32 s64, s26, 0x1b0000
    buffer_load_dwordx4 v2, s[48:51], s64 offen lds
    s_add_u32 m0, s25, 17408
    s_add_u32 s64, s26, 0x1cb000
    buffer_load_dwordx4 v2, s[48:51], s64 offen lds
    s_add_u32 m0, s25, 18432
    s_add_u32 s64, s26, 0x1e6000
    buffer_load_dwordx4 v2, s[48:51], s64 offen lds
    s_add_u32 m0, s25, 19456
    s_add_u32 s64, s26, 0x201000
    buffer_load_dwordx4 v2, s[48:51], s64 offen lds
    s_waitcnt vmcnt(0)
    ds_read_b64_tr_b16 v[176:177], v3 offset:0
    ds_read_b64_tr_b16 v[178:179], v3 offset:128
    ds_read_b64_tr_b16 v[180:181], v3 offset:1024
    ds_read_b64_tr_b16 v[182:183], v3 offset:1152
    ds_read_b64_tr_b16 v[184:185], v3 offset:2048
    ds_read_b64_tr_b16 v[186:187], v3 offset:2176
    ds_read_b64_tr_b16 v[188:189], v3 offset:3072
    ds_read_b64_tr_b16 v[190:191], v3 offset:3200
    ds_read_b64_tr_b16 v[192:193], v3 offset:4096
    ds_read_b64_tr_b16 v[194:195], v3 offset:4224
    ds_read_b64_tr_b16 v[196:197], v3 offset:5120
    ds_read_b64_tr_b16 v[198:199], v3 offset:5248
    s_waitcnt lgkmcnt(4)
    ds_read_b64_tr_b16 v[200:201], v3 offset:6144
    ds_read_b64_tr_b16 v[202:203], v3 offset:6272
    ds_read_b64_tr_b16 v[204:205], v3 offset:7168
    ds_read_b64_tr_b16 v[206:207], v3 offset:7296
    ds_read_b64_tr_b16 v[208:209], v3 offset:8192
    ds_read_b64_tr_b16 v[210:211], v3 offset:8320
    ds_read_b64_tr_b16 v[212:213], v3 offset:9216
    ds_read_b64_tr_b16 v[214:215], v3 offset:9344
    ds_read_b64_tr_b16 v[216:217], v3 offset:10240
    ds_read_b64_tr_b16 v[218:219], v3 offset:10368
    ds_read_b64_tr_b16 v[220:221], v3 offset:11264
    ds_read_b64_tr_b16 v[222:223], v3 offset:11392
    s_waitcnt lgkmcnt(4)
    ds_read_b64_tr_b16 v[224:225], v3 offset:12288
    ds_read_b64_tr_b16 v[226:227], v3 offset:12416
    ds_read_b64_tr_b16 v[228:229], v3 offset:13312
    ds_read_b64_tr_b16 v[230:231], v3 offset:13440
    ds_read_b64_tr_b16 v[232:233], v3 offset:14336
    ds_read_b64_tr_b16 v[234:235], v3 offset:14464
    ds_read_b64_tr_b16 v[236:237], v3 offset:15360
    ds_read_b64_tr_b16 v[238:239], v3 offset:15488
    ds_read_b64_tr_b16 v[240:241], v3 offset:16384
    ds_read_b64_tr_b16 v[242:243], v3 offset:16512
    ds_read_b64_tr_b16 v[244:245], v3 offset:17408
    ds_read_b64_tr_b16 v[246:247], v3 offset:17536
    s_waitcnt lgkmcnt(4)
    ds_read_b64_tr_b16 v[248:249], v3 offset:18432
    ds_read_b64_tr_b16 v[250:251], v3 offset:18560
    ds_read_b64_tr_b16 v[252:253], v3 offset:19456
    ds_read_b64_tr_b16 v[254:255], v3 offset:19584
    s_waitcnt lgkmcnt(0)
    v_mfma_f32_16x16x32_bf16 v[8:11], v[96:99], v[16:19], 0
    v_mfma_f32_16x16x32_bf16 v[12:15], v[176:179], v[16:19], 0
    v_mfma_f32_16x16x32_bf16 v[8:11], v[100:103], v[20:23], v[8:11]
    v_mfma_f32_16x16x32_bf16 v[12:15], v[180:183], v[20:23], v[12:15]
    v_mfma_f32_16x16x32_bf16 v[8:11], v[104:107], v[24:27], v[8:11]
    v_mfma_f32_16x16x32_bf16 v[12:15], v[184:187], v[24:27], v[12:15]
    v_mfma_f32_16x16x32_bf16 v[8:11], v[108:111], v[28:31], v[8:11]
    v_mfma_f32_16x16x32_bf16 v[12:15], v[188:191], v[28:31], v[12:15]
    v_mfma_f32_16x16x32_bf16 v[8:11], v[112:115], v[32:35], v[8:11]
    v_mfma_f32_16x16x32_bf16 v[12:15], v[192:195], v[32:35], v[12:15]
    v_mfma_f32_16x16x32_bf16 v[8:11], v[116:119], v[36:39], v[8:11]
    v_mfma_f32_16x16x32_bf16 v[12:15], v[196:199], v[36:39], v[12:15]
    v_mfma_f32_16x16x32_bf16 v[8:11], v[120:123], v[40:43], v[8:11]
    v_mfma_f32_16x16x32_bf16 v[12:15], v[200:203], v[40:43], v[12:15]
    v_mfma_f32_16x16x32_bf16 v[8:11], v[124:127], v[44:47], v[8:11]
    v_mfma_f32_16x16x32_bf16 v[12:15], v[204:207], v[44:47], v[12:15]
    v_mfma_f32_16x16x32_bf16 v[8:11], v[128:131], v[48:51], v[8:11]
    v_mfma_f32_16x16x32_bf16 v[12:15], v[208:211], v[48:51], v[12:15]
    v_mfma_f32_16x16x32_bf16 v[8:11], v[132:135], v[52:55], v[8:11]
    v_mfma_f32_16x16x32_bf16 v[12:15], v[212:215], v[52:55], v[12:15]
    v_mfma_f32_16x16x32_bf16 v[8:11], v[136:139], v[56:59], v[8:11]
    v_mfma_f32_16x16x32_bf16 v[12:15], v[216:219], v[56:59], v[12:15]
    v_mfma_f32_16x16x32_bf16 v[8:11], v[140:143], v[60:63], v[8:11]
    v_mfma_f32_16x16x32_bf16 v[12:15], v[220:223], v[60:63], v[12:15]
    v_mfma_f32_16x16x32_bf16 v[8:11], v[144:147], v[64:67], v[8:11]
    v_mfma_f32_16x16x32_bf16 v[12:15], v[224:227], v[64:67], v[12:15]
    v_mfma_f32_16x16x32_bf16 v[8:11], v[148:151], v[68:71], v[8:11]
    v_mfma_f32_16x16x32_bf16 v[12:15], v[228:231], v[68:71], v[12:15]
    v_mfma_f32_16x16x32_bf16 v[8:11], v[152:155], v[72:75], v[8:11]
    v_mfma_f32_16x16x32_bf16 v[12:15], v[232:235], v[72:75], v[12:15]
    v_mfma_f32_16x16x32_bf16 v[8:11], v[156:159], v[76:79], v[8:11]
    v_mfma_f32_16x16x32_bf16 v[12:15], v[236:239], v[76:79], v[12:15]
    v_mfma_f32_16x16x32_bf16 v[8:11], v[160:163], v[80:83], v[8:11]
    v_mfma_f32_16x16x32_bf16 v[12:15], v[240:243], v[80:83], v[12:15]
    v_mfma_f32_16x16x32_bf16 v[8:11], v[164:167], v[84:87], v[8:11]
    v_mfma_f32_16x16x32_bf16 v[12:15], v[244:247], v[84:87], v[12:15]
    v_mfma_f32_16x16x32_bf16 v[8:11], v[168:171], v[88:91], v[8:11]
    v_mfma_f32_16x16x32_bf16 v[12:15], v[248:251], v[88:91], v[12:15]
    v_mfma_f32_16x16x32_bf16 v[8:11], v[172:175], v[92:95], v[8:11]
    v_mfma_f32_16x16x32_bf16 v[12:15], v[252:255], v[92:95], v[12:15]
    s_nop 7
    v_cvt_pk_bf16_f32 v8, v8, v8
    v_lshlrev_b32 v8, 16, v8
    v_cvt_pk_bf16_f32 v12, v12, v12
    v_lshlrev_b32 v12, 16, v12
    v_mul_f32 v16, 0xbfb8aa3b, v8
    v_exp_f32 v16, v16
    s_nop 0
    v_add_f32 v16, 1.0, v16
    v_rcp_f32 v16, v16
    s_nop 0
    v_mul_f32 v8, v8, v16
    v_cvt_pk_bf16_f32 v8, v8, v8
    v_lshlrev_b32 v8, 16, v8
    v_mul_f32 v8, v8, v12
    v_cvt_pk_bf16_f32 v9, v9, v9
    v_lshlrev_b32 v9, 16, v9
    v_cvt_pk_bf16_f32 v13, v13, v13
    v_lshlrev_b32 v13, 16, v13
    v_mul_f32 v17, 0xbfb8aa3b, v9
    v_exp_f32 v17, v17
    s_nop 0
    v_add_f32 v17, 1.0, v17
    v_rcp_f32 v17, v17
    s_nop 0
    v_mul_f32 v9, v9, v17
    v_cvt_pk_bf16_f32 v9, v9, v9
    v_lshlrev_b32 v9, 16, v9
    v_mul_f32 v9, v9, v13
    v_cvt_pk_bf16_f32 v10, v10, v10
    v_lshlrev_b32 v10, 16, v10
    v_cvt_pk_bf16_f32 v14, v14, v14
    v_lshlrev_b32 v14, 16, v14
    v_mul_f32 v18, 0xbfb8aa3b, v10
    v_exp_f32 v18, v18
    s_nop 0
    v_add_f32 v18, 1.0, v18
    v_rcp_f32 v18, v18
    s_nop 0
    v_mul_f32 v10, v10, v18
    v_cvt_pk_bf16_f32 v10, v10, v10
    v_lshlrev_b32 v10, 16, v10
    v_mul_f32 v10, v10, v14
    v_cvt_pk_bf16_f32 v11, v11, v11
    v_lshlrev_b32 v11, 16, v11
    v_cvt_pk_bf16_f32 v15, v15, v15
    v_lshlrev_b32 v15, 16, v15
    v_mul_f32 v19, 0xbfb8aa3b, v11
    v_exp_f32 v19, v19
    s_nop 0
    v_add_f32 v19, 1.0, v19
    v_rcp_f32 v19, v19
    s_nop 0
    v_mul_f32 v11, v11, v19
    v_cvt_pk_bf16_f32 v11, v11, v11
    v_lshlrev_b32 v11, 16, v11
    v_mul_f32 v11, v11, v15
    v_cvt_pk_bf16_f32 v16, v8, v9
    v_cvt_pk_bf16_f32 v17, v10, v11
    s_lshr_b32 s65, s24, 1
    s_lshl_b32 s65, s65, 10
    s_and_b32 s66, s24, 1
    s_lshl_b32 s66, s66, 3
    s_add_u32 s65, s65, s66
    s_add_u32 s65, s65, 0x5401000
    v_lshlrev_b32 v4, 4, v0
    buffer_store_dwordx2 v[16:17], v4, s[4:7], s65 offen sc1
    s_waitcnt vmcnt(0)
    v_mov_b32 v7, 1
    v_mov_b32 v8, 0
    s_mov_b32 s64, 0x298080
    s_mov_b64 exec, 1
    buffer_atomic_add v7, v8, s[4:7], s64 offen sc1
    s_mov_b64 exec, -1
H_A1:
    v_mbcnt_lo_u32_b32 v0, -1, 0
    v_mbcnt_hi_u32_b32 v0, -1, v0
    s_mov_b32 s29, 0
    v_lshlrev_b32 v1, 4, v0
    v_lshrrev_b32 v5, 4, v0
    v_lshlrev_b32 v2, 7, v5
    v_and_b32 v5, 7, v0
    v_lshl_add_u32 v2, v5, 4, v2
    v_bfe_u32 v5, v0, 4, 1
    v_lshlrev_b32 v3, 7, v5
    v_and_b32 v5, 15, v0
    v_lshl_add_u32 v3, v5, 3, v3
    s_mov_b32 s34, 0x3e0293ee
    s_mov_b32 s35, 0x3e0293ee
    s_mov_b32 s36, -1
    s_mov_b32 s37, 0
    v_lshrrev_b32 v5, 4, v0
    v_lshlrev_b32 v5, 2, v5
    v_and_b32 v6, 15, v0
    v_add_u32 v7, 0, v5
    v_cmp_le_u32 s[38:39], v7, v6
    v_add_u32 v7, 1, v5
    v_cmp_le_u32 s[40:41], v7, v6
    v_add_u32 v7, 2, v5
    v_cmp_le_u32 s[42:43], v7, v6
    v_add_u32 v7, 3, v5
    v_cmp_le_u32 s[44:45], v7, v6
    v_mov_b32 v248, 0x3f803f80
    v_mov_b32 v249, 0x3f803f80
    v_mov_b32 v250, 0x3f803f80
    v_mov_b32 v251, 0x3f803f80
    s_lshl_b32 s24, s12, 2
    s_add_u32 s24, s24, s14
    s_add_u32 s24, s24, 8
    s_mov_b32 s25, 1
AT1_LOOP:
    s_lshl_b32 s64, s24, 5
    s_add_u32 s64, s64, s13
    s_lshl_b32 s26, s64, 13
    s_add_u32 s26, s26, 0x3400000
    s_lshl_b32 s27, s64, 14
    s_add_u32 s27, s27, 0x1400000
    s_lshl_b32 s65, s64, 11
    s_add_u32 s30, s65, 0x640000
    s_add_u32 s31, s65, 0xa40000
    s_lshl_b32 s33, s64, 2
    s_add_u32 s33, s33, 0x296000
    s_lshl_b32 s32, s24, 18
    s_lshl_b32 s65, s13, 12
    s_add_u32 s32, s32, s65
    s_add_u32 s32, s32, 0x4400000
    s_lshr_b32 s65, s24, 2
    s_lshl_b32 s65, s65, 9
    s_lshl_b32 s66, s13, 4
    s_add_u32 s65, s65, s66
    s_add_u32 s65, s65, 0x291000
    s_lshr_b32 s66, s24, 1
    s_lshl_b32 s66, s66, 8
    s_lshl_b32 s64, s13, 3
    s_add_u32 s66, s66, s64
    s_add_u32 s66, s66, 0x293ff4
    v_lshlrev_b32 v5, 2, v0
    v_mov_b32 v6, s65
    v_mov_b32 v7, s66
    v_cmp_gt_u32 vcc, 3, v0
    s_nop 1
    v_cndmask_b32 v6, v7, v6, vcc
    v_add_u32 v4, v5, v6
    s_mov_b32 s64, 0
    s_mov_b64 exec, 7
AT1_F_137:
    buffer_load_dword v5, v4, s[4:7], s64 offen sc1
    s_add_u32 s29, s29, 1
    s_waitcnt vmcnt(0)
    v_cmp_eq_u32 vcc, 0, v5
    s_cbranch_vccz AT1_FD_138
    s_cmp_gt_u32 s29, 262144
    s_cbranch_scc1 AT1_FD_138
    s_sleep 4
    s_branch AT1_F_137
AT1_FD_138:
    s_mov_b64 exec, -1
    buffer_load_dwordx4 v[16:19], v1, s[4:7], s26 offen offset:0
    buffer_load_dwordx4 v[20:23], v1, s[4:7], s26 offen offset:1024
    buffer_load_dwordx4 v[24:27], v1, s[4:7], s26 offen offset:2048
    buffer_load_dwordx4 v[28:31], v1, s[4:7], s26 offen offset:3072
    s_add_u32 s26, s26, 4096
    buffer_load_dwordx4 v[32:35], v1, s[4:7], s26 offen offset:0
    buffer_load_dwordx4 v[36:39], v1, s[4:7], s26 offen offset:1024
    buffer_load_dwordx4 v[40:43], v1, s[4:7], s26 offen offset:2048
    buffer_load_dwordx4 v[44:47], v1, s[4:7], s26 offen offset:3072
    buffer_load_dwordx4 v[48:51], v1, s[4:7], s27 offen offset:0
    buffer_load_dwordx4 v[52:55], v1, s[4:7], s27 offen offset:1024
    buffer_load_dwordx4 v[56:59], v1, s[4:7], s27 offen offset:2048
    buffer_load_dwordx4 v[60:63], v1, s[4:7], s27 offen offset:3072
    s_add_u32 s27, s27, 4096
    buffer_load_dwordx4 v[64:67], v1, s[4:7], s27 offen offset:0
    buffer_load_dwordx4 v[68:71], v1, s[4:7], s27 offen offset:1024
    buffer_load_dwordx4 v[72:75], v1, s[4:7], s27 offen offset:2048
    buffer_load_dwordx4 v[76:79], v1, s[4:7], s27 offen offset:3072
    s_add_u32 s27, s27, 4096
    buffer_load_dwordx4 v[80:83], v1, s[4:7], s27 offen offset:0
    buffer_load_dwordx4 v[84:87], v1, s[4:7], s27 offen offset:1024
    buffer_load_dwordx4 v[88:91], v1, s[4:7], s27 offen offset:2048
    buffer_load_dwordx4 v[92:95], v1, s[4:7], s27 offen offset:3072
    s_add_u32 s27, s27, 4096
    buffer_load_dwordx4 v[96:99], v1, s[4:7], s27 offen offset:0
    buffer_load_dwordx4 v[100:103], v1, s[4:7], s27 offen offset:1024
    buffer_load_dwordx4 v[104:107], v1, s[4:7], s27 offen offset:2048
    buffer_load_dwordx4 v[108:111], v1, s[4:7], s27 offen offset:3072
    s_mov_b64 exec, 0x18
AT1_G_139:
    buffer_load_dword v5, v4, s[4:7], s64 offen sc1
    s_add_u32 s29, s29, 1
    s_waitcnt vmcnt(0)
    v_cmp_eq_u32 vcc, 0, v5
    s_cbranch_vccz AT1_GD_140
    s_cmp_gt_u32 s29, 262144
    s_cbranch_scc1 AT1_GD_140
    s_sleep 4
    s_branch AT1_G_139
AT1_GD_140:
    s_mov_b64 exec, -1
    buffer_load_dwordx4 v[112:115], v2, s[4:7], s30 offen offset:0
    buffer_load_dwordx4 v[116:119], v2, s[4:7], s30 offen offset:512
    buffer_load_dwordx4 v[120:123], v2, s[4:7], s30 offen offset:1024
    buffer_load_dwordx4 v[124:127], v2, s[4:7], s30 offen offset:1536
    buffer_load_dwordx2 v[128:129], v3, s[4:7], s31 offen offset:0
    buffer_load_dwordx2 v[130:131], v3, s[4:7], s31 offen offset:256
    buffer_load_dwordx2 v[132:133], v3, s[4:7], s31 offen offset:512
    buffer_load_dwordx2 v[134:135], v3, s[4:7], s31 offen offset:768
    buffer_load_dwordx2 v[136:137], v3, s[4:7], s31 offen offset:1024
    buffer_load_dwordx2 v[138:139], v3, s[4:7], s31 offen offset:1280
    buffer_load_dwordx2 v[140:141], v3, s[4:7], s31 offen offset:1536
    buffer_load_dwordx2 v[142:143], v3, s[4:7], s31 offen offset:1792
    v_mfma_f32_16x16x32_bf16 v[148:151], v[48:51], v[16:19], 0
    v_mfma_f32_16x16x32_bf16 v[156:159], v[48:51], v[32:35], 0
    v_mfma_f32_16x16x32_bf16 v[160:163], v[64:67], v[32:35], 0
    v_mfma_f32_16x16x32_bf16 v[148:151], v[52:55], v[20:23], v[148:151]
    v_mfma_f32_16x16x32_bf16 v[156:159], v[52:55], v[36:39], v[156:159]
    v_mfma_f32_16x16x32_bf16 v[160:163], v[68:71], v[36:39], v[160:163]
    v_mfma_f32_16x16x32_bf16 v[148:151], v[56:59], v[24:27], v[148:151]
    v_mfma_f32_16x16x32_bf16 v[156:159], v[56:59], v[40:43], v[156:159]
    v_mfma_f32_16x16x32_bf16 v[160:163], v[72:75], v[40:43], v[160:163]
    v_mfma_f32_16x16x32_bf16 v[148:151], v[60:63], v[28:31], v[148:151]
    v_mfma_f32_16x16x32_bf16 v[156:159], v[60:63], v[44:47], v[156:159]
    v_mfma_f32_16x16x32_bf16 v[160:163], v[76:79], v[44:47], v[160:163]
    s_waitcnt vmcnt(8)
    v_mfma_f32_16x16x32_bf16 v[144:147], v[112:115], v[16:19], 0
    v_mfma_f32_16x16x32_bf16 v[152:155], v[112:115], v[32:35], 0
    v_mfma_f32_16x16x32_bf16 v[144:147], v[116:119], v[20:23], v[144:147]
    v_mfma_f32_16x16x32_bf16 v[152:155], v[116:119], v[36:39], v[152:155]
    v_mfma_f32_16x16x32_bf16 v[144:147], v[120:123], v[24:27], v[144:147]
    v_mfma_f32_16x16x32_bf16 v[152:155], v[120:123], v[40:43], v[152:155]
    v_mfma_f32_16x16x32_bf16 v[144:147], v[124:127], v[28:31], v[144:147]
    v_mfma_f32_16x16x32_bf16 v[152:155], v[124:127], v[44:47], v[152:155]
    v_mov_b32 v11, 0xff800000
    s_nop 7
    v_cndmask_b32 v148, v11, v148, s[38:39]
    v_cndmask_b32 v160, v11, v160, s[38:39]
    v_cndmask_b32 v144, v11, v144, s[36:37]
    v_cndmask_b32 v152, v11, v152, s[36:37]
    v_cndmask_b32 v149, v11, v149, s[40:41]
    v_cndmask_b32 v161, v11, v161, s[40:41]
    v_cndmask_b32 v145, v11, v145, s[36:37]
    v_cndmask_b32 v153, v11, v153, s[36:37]
    v_cndmask_b32 v150, v11, v150, s[42:43]
    v_cndmask_b32 v162, v11, v162, s[42:43]
    v_cndmask_b32 v146, v11, v146, s[36:37]
    v_cndmask_b32 v154, v11, v154, s[36:37]
    v_cndmask_b32 v151, v11, v151, s[44:45]
    v_cndmask_b32 v163, v11, v163, s[44:45]
    v_cndmask_b32 v147, v11, v147, s[36:37]
    v_cndmask_b32 v155, v11, v155, s[36:37]
    v_max3_f32 v8, v144, v145, v146
    v_max3_f32 v8, v8, v147, v148
    v_max3_f32 v8, v8, v149, v150
    v_max_f32 v8, v8, v151
    v_mov_b32 v9, v8
    s_nop 1
    v_permlane16_swap_b32 v8, v9
    v_max_f32 v8, v8, v9
    v_mov_b32 v9, v8
    s_nop 1
    v_permlane32_swap_b32 v8, v9
    v_max_f32 v8, v8, v9
    v_mul_f32 v8, s34, v8
    v_fma_f32 v144, v144, s34, -v8
    v_fma_f32 v145, v145, s34, -v8
    v_fma_f32 v146, v146, s34, -v8
    v_fma_f32 v147, v147, s34, -v8
    v_fma_f32 v148, v148, s34, -v8
    v_fma_f32 v149, v149, s34, -v8
    v_fma_f32 v150, v150, s34, -v8
    v_fma_f32 v151, v151, s34, -v8
    v_exp_f32 v144, v144
    v_exp_f32 v145, v145
    v_exp_f32 v146, v146
    v_exp_f32 v147, v147
    v_exp_f32 v148, v148
    v_exp_f32 v149, v149
    v_exp_f32 v150, v150
    v_exp_f32 v151, v151
    s_nop 0
    v_cvt_pk_bf16_f32 v164, v148, v149
    v_cvt_pk_bf16_f32 v165, v150, v151
    v_mov_b32 v166, 0
    v_mov_b32 v167, 0
    v_cvt_pk_bf16_f32 v168, v144, v145
    v_cvt_pk_bf16_f32 v169, v146, v147
    v_max3_f32 v8, v152, v153, v154
    v_max3_f32 v8, v8, v155, v156
    v_max3_f32 v8, v8, v157, v158
    v_max3_f32 v8, v8, v159, v160
    v_max3_f32 v8, v8, v161, v162
    v_max_f32 v8, v8, v163
    v_mov_b32 v9, v8
    s_nop 1
    v_permlane16_swap_b32 v8, v9
    v_max_f32 v8, v8, v9
    v_mov_b32 v9, v8
    s_nop 1
    v_permlane32_swap_b32 v8, v9
    v_max_f32 v8, v8, v9
    v_mul_f32 v8, s34, v8
    v_fma_f32 v152, v152, s34, -v8
    v_fma_f32 v153, v153, s34, -v8
    v_fma_f32 v154, v154, s34, -v8
    v_fma_f32 v155, v155, s34, -v8
    v_fma_f32 v156, v156, s34, -v8
    v_fma_f32 v157, v157, s34, -v8
    v_fma_f32 v158, v158, s34, -v8
    v_fma_f32 v159, v159, s34, -v8
    v_fma_f32 v160, v160, s34, -v8
    v_fma_f32 v161, v161, s34, -v8
    v_fma_f32 v162, v162, s34, -v8
    v_fma_f32 v163, v163, s34, -v8
    v_exp_f32 v152, v152
    v_exp_f32 v153, v153
    v_exp_f32 v154, v154
    v_exp_f32 v155, v155
    v_exp_f32 v156, v156
    v_exp_f32 v157, v157
    v_exp_f32 v158, v158
    v_exp_f32 v159, v159
    v_exp_f32 v160, v160
    v_exp_f32 v161, v161
    v_exp_f32 v162, v162
    v_exp_f32 v163, v163
    s_nop 0
    v_cvt_pk_bf16_f32 v170, v156, v157
    v_cvt_pk_bf16_f32 v171, v158, v159
    v_cvt_pk_bf16_f32 v172, v160, v161
    v_cvt_pk_bf16_f32 v173, v162, v163
    v_cvt_pk_bf16_f32 v174, v152, v153
    v_cvt_pk_bf16_f32 v175, v154, v155
    s_waitcnt vmcnt(0)
    v_mfma_f32_16x16x32_bf16 v[240:243], v[248:251], v[164:167], 0
    v_mfma_f32_16x16x32_bf16 v[244:247], v[248:251], v[170:173], 0
    v_mfma_f32_16x16x32_bf16 v[176:179], v[80:83], v[164:167], 0
    v_mfma_f32_16x16x32_bf16 v[180:183], v[80:83], v[170:173], 0
    v_mfma_f32_16x16x32_bf16 v[184:187], v[84:87], v[164:167], 0
    v_mfma_f32_16x16x32_bf16 v[188:191], v[84:87], v[170:173], 0
    v_mfma_f32_16x16x32_bf16 v[192:195], v[88:91], v[164:167], 0
    v_mfma_f32_16x16x32_bf16 v[196:199], v[88:91], v[170:173], 0
    v_mfma_f32_16x16x32_bf16 v[200:203], v[92:95], v[164:167], 0
    v_mfma_f32_16x16x32_bf16 v[204:207], v[92:95], v[170:173], 0
    v_mfma_f32_16x16x32_bf16 v[208:211], v[96:99], v[164:167], 0
    v_mfma_f32_16x16x32_bf16 v[212:215], v[96:99], v[170:173], 0
    v_mfma_f32_16x16x32_bf16 v[216:219], v[100:103], v[164:167], 0
    v_mfma_f32_16x16x32_bf16 v[220:223], v[100:103], v[170:173], 0
    v_mfma_f32_16x16x32_bf16 v[224:227], v[104:107], v[164:167], 0
    v_mfma_f32_16x16x32_bf16 v[228:231], v[104:107], v[170:173], 0
    v_mfma_f32_16x16x32_bf16 v[232:235], v[108:111], v[164:167], 0
    v_mfma_f32_16x16x32_bf16 v[236:239], v[108:111], v[170:173], 0
    v_mfma_f32_16x16x16_bf16 v[240:243], v[248:249], v[168:169], v[240:243]
    v_mfma_f32_16x16x16_bf16 v[244:247], v[248:249], v[174:175], v[244:247]
    v_mfma_f32_16x16x16_bf16 v[176:179], v[128:129], v[168:169], v[176:179]
    v_mfma_f32_16x16x16_bf16 v[180:183], v[128:129], v[174:175], v[180:183]
    v_mfma_f32_16x16x16_bf16 v[184:187], v[130:131], v[168:169], v[184:187]
    v_mfma_f32_16x16x16_bf16 v[188:191], v[130:131], v[174:175], v[188:191]
    v_mfma_f32_16x16x16_bf16 v[192:195], v[132:133], v[168:169], v[192:195]
    v_mfma_f32_16x16x16_bf16 v[196:199], v[132:133], v[174:175], v[196:199]
    v_mfma_f32_16x16x16_bf16 v[200:203], v[134:135], v[168:169], v[200:203]
    v_mfma_f32_16x16x16_bf16 v[204:207], v[134:135], v[174:175], v[204:207]
    v_mfma_f32_16x16x16_bf16 v[208:211], v[136:137], v[168:169], v[208:211]
    v_mfma_f32_16x16x16_bf16 v[212:215], v[136:137], v[174:175], v[212:215]
    v_mfma_f32_16x16x16_bf16 v[216:219], v[138:139], v[168:169], v[216:219]
    v_mfma_f32_16x16x16_bf16 v[220:223], v[138:139], v[174:175], v[220:223]
    v_mfma_f32_16x16x16_bf16 v[224:227], v[140:141], v[168:169], v[224:227]
    v_mfma_f32_16x16x16_bf16 v[228:231], v[140:141], v[174:175], v[228:231]
    v_mfma_f32_16x16x16_bf16 v[232:235], v[142:143], v[168:169], v[232:235]
    v_mfma_f32_16x16x16_bf16 v[236:239], v[142:143], v[174:175], v[236:239]
    v_rcp_f32 v8, v240
    v_rcp_f32 v9, v244
    s_nop 7
    v_mul_f32 v176, v176, v8
    v_mul_f32 v177, v177, v8
    v_mul_f32 v178, v178, v8
    v_mul_f32 v179, v179, v8
    v_cvt_pk_bf16_f32 v16, v176, v177
    v_cvt_pk_bf16_f32 v17, v178, v179
    v_mul_f32 v184, v184, v8
    v_mul_f32 v185, v185, v8
    v_mul_f32 v186, v186, v8
    v_mul_f32 v187, v187, v8
    v_cvt_pk_bf16_f32 v18, v184, v185
    v_cvt_pk_bf16_f32 v19, v186, v187
    s_add_u32 s64, s32, 0x0
    buffer_store_dwordx4 v[16:19], v1, s[4:7], s64 offen offset:0 sc1
    v_mul_f32 v192, v192, v8
    v_mul_f32 v193, v193, v8
    v_mul_f32 v194, v194, v8
    v_mul_f32 v195, v195, v8
    v_cvt_pk_bf16_f32 v20, v192, v193
    v_cvt_pk_bf16_f32 v21, v194, v195
    v_mul_f32 v200, v200, v8
    v_mul_f32 v201, v201, v8
    v_mul_f32 v202, v202, v8
    v_mul_f32 v203, v203, v8
    v_cvt_pk_bf16_f32 v22, v200, v201
    v_cvt_pk_bf16_f32 v23, v202, v203
    s_add_u32 s64, s32, 0x0
    buffer_store_dwordx4 v[20:23], v1, s[4:7], s64 offen offset:1024 sc1
    v_mul_f32 v208, v208, v8
    v_mul_f32 v209, v209, v8
    v_mul_f32 v210, v210, v8
    v_mul_f32 v211, v211, v8
    v_cvt_pk_bf16_f32 v24, v208, v209
    v_cvt_pk_bf16_f32 v25, v210, v211
    v_mul_f32 v216, v216, v8
    v_mul_f32 v217, v217, v8
    v_mul_f32 v218, v218, v8
    v_mul_f32 v219, v219, v8
    v_cvt_pk_bf16_f32 v26, v216, v217
    v_cvt_pk_bf16_f32 v27, v218, v219
    s_add_u32 s64, s32, 0x0
    buffer_store_dwordx4 v[24:27], v1, s[4:7], s64 offen offset:2048 sc1
    v_mul_f32 v224, v224, v8
    v_mul_f32 v225, v225, v8
    v_mul_f32 v226, v226, v8
    v_mul_f32 v227, v227, v8
    v_cvt_pk_bf16_f32 v28, v224, v225
    v_cvt_pk_bf16_f32 v29, v226, v227
    v_mul_f32 v232, v232, v8
    v_mul_f32 v233, v233, v8
    v_mul_f32 v234, v234, v8
    v_mul_f32 v235, v235, v8
    v_cvt_pk_bf16_f32 v30, v232, v233
    v_cvt_pk_bf16_f32 v31, v234, v235
    s_add_u32 s64, s32, 0x0
    buffer_store_dwordx4 v[28:31], v1, s[4:7], s64 offen offset:3072 sc1
    v_mul_f32 v180, v180, v9
    v_mul_f32 v181, v181, v9
    v_mul_f32 v182, v182, v9
    v_mul_f32 v183, v183, v9
    v_cvt_pk_bf16_f32 v32, v180, v181
    v_cvt_pk_bf16_f32 v33, v182, v183
    v_mul_f32 v188, v188, v9
    v_mul_f32 v189, v189, v9
    v_mul_f32 v190, v190, v9
    v_mul_f32 v191, v191, v9
    v_cvt_pk_bf16_f32 v34, v188, v189
    v_cvt_pk_bf16_f32 v35, v190, v191
    s_add_u32 s64, s32, 0x20000
    buffer_store_dwordx4 v[32:35], v1, s[4:7], s64 offen offset:0 sc1
    v_mul_f32 v196, v196, v9
    v_mul_f32 v197, v197, v9
    v_mul_f32 v198, v198, v9
    v_mul_f32 v199, v199, v9
    v_cvt_pk_bf16_f32 v36, v196, v197
    v_cvt_pk_bf16_f32 v37, v198, v199
    v_mul_f32 v204, v204, v9
    v_mul_f32 v205, v205, v9
    v_mul_f32 v206, v206, v9
    v_mul_f32 v207, v207, v9
    v_cvt_pk_bf16_f32 v38, v204, v205
    v_cvt_pk_bf16_f32 v39, v206, v207
    s_add_u32 s64, s32, 0x20000
    buffer_store_dwordx4 v[36:39], v1, s[4:7], s64 offen offset:1024 sc1
    v_mul_f32 v212, v212, v9
    v_mul_f32 v213, v213, v9
    v_mul_f32 v214, v214, v9
    v_mul_f32 v215, v215, v9
    v_cvt_pk_bf16_f32 v40, v212, v213
    v_cvt_pk_bf16_f32 v41, v214, v215
    v_mul_f32 v220, v220, v9
    v_mul_f32 v221, v221, v9
    v_mul_f32 v222, v222, v9
    v_mul_f32 v223, v223, v9
    v_cvt_pk_bf16_f32 v42, v220, v221
    v_cvt_pk_bf16_f32 v43, v222, v223
    s_add_u32 s64, s32, 0x20000
    buffer_store_dwordx4 v[40:43], v1, s[4:7], s64 offen offset:2048 sc1
    v_mul_f32 v228, v228, v9
    v_mul_f32 v229, v229, v9
    v_mul_f32 v230, v230, v9
    v_mul_f32 v231, v231, v9
    v_cvt_pk_bf16_f32 v44, v228, v229
    v_cvt_pk_bf16_f32 v45, v230, v231
    v_mul_f32 v236, v236, v9
    v_mul_f32 v237, v237, v9
    v_mul_f32 v238, v238, v9
    v_mul_f32 v239, v239, v9
    v_cvt_pk_bf16_f32 v46, v236, v237
    v_cvt_pk_bf16_f32 v47, v238, v239
    s_add_u32 s64, s32, 0x20000
    buffer_store_dwordx4 v[44:47], v1, s[4:7], s64 offen offset:3072 sc1
    s_waitcnt vmcnt(0)
    v_mov_b32 v7, 1
    v_mov_b32 v8, 0
    s_mov_b64 exec, 1
    buffer_store_dword v7, v8, s[4:7], s33 offen sc1
    s_mov_b64 exec, -1
    s_add_u32 s24, s24, 8
    s_add_u32 s25, s25, 1
    s_cmp_lt_u32 s25, 2
    s_cbranch_scc1 AT1_LOOP
    s_lshl_b32 s70, s13, 1
    s_add_u32 s70, s70, s12
    s_load_dwordx2 s[44:45], s[0:1], 72
    s_mov_b32 s46, 0x21c000
    s_mov_b32 s47, 0x00020000
    s_load_dwordx2 s[48:49], s[0:1], 80
    s_mov_b32 s50, 0x21c000
    s_mov_b32 s51, 0x00020000
    s_load_dwordx2 s[52:53], s[0:1], 88
    s_mov_b32 s54, 0x21c000
    s_mov_b32 s55, 0x00020000
    s_mov_b32 s29, 0
    s_waitcnt lgkmcnt(0)
    v_mbcnt_lo_u32_b32 v0, -1, 0
    v_mbcnt_hi_u32_b32 v0, -1, v0
    s_cmp_lg_u32 s14, 0
    s_cbranch_scc1 H_ATT
    s_cmp_ge_u32 s70, 40
    s_cbranch_scc1 H_ATT
    s_mov_b32 s24, s70
    v_mov_b32 v8, 0
    s_mov_b32 s64, 0x298080
F2W_141:
    buffer_load_dword v7, v8, s[4:7], s64 offen sc1
    s_add_u32 s29, s29, 1
    s_waitcnt vmcnt(0)
    v_mov_b32 v9, 108
    v_cmp_gt_u32 vcc, v9, v7
    s_cbranch_vccz F2WD_142
    s_cmp_gt_u32 s29, 262144
    s_cbranch_scc1 F2WD_142
    s_sleep 8
    s_branch F2W_141
F2WD_142:
    s_mov_b32 s25, 0
    v_lshrrev_b32 v7, 1, v0
    v_mul_u32_u24 v2, 1280, v7
    v_and_b32 v7, 1, v0
    v_lshl_add_u32 v2, v7, 4, v2
    v_lshrrev_b32 v7, 4, v0
    v_lshlrev_b32 v3, 7, v7
    v_bfe_u32 v7, v0, 2, 2
    v_lshl_add_u32 v3, v7, 5, v3
    v_and_b32 v7, 3, v0
    v_lshl_add_u32 v3, v7, 3, v3
    v_add_u32 v3, s25, v3
    v_lshlrev_b32 v4, 4, v0
    s_mov_b32 s65, 0x5401000
    buffer_load_dwordx4 v[16:19], v4, s[4:7], s65 offen offset:0 sc1
    buffer_load_dwordx4 v[20:23], v4, s[4:7], s65 offen offset:1024 sc1
    buffer_load_dwordx4 v[24:27], v4, s[4:7], s65 offen offset:2048 sc1
    buffer_load_dwordx4 v[28:31], v4, s[4:7], s65 offen offset:3072 sc1
    s_add_u32 s65, s65, 4096
    buffer_load_dwordx4 v[32:35], v4, s[4:7], s65 offen offset:0 sc1
    buffer_load_dwordx4 v[36:39], v4, s[4:7], s65 offen offset:1024 sc1
    buffer_load_dwordx4 v[40:43], v4, s[4:7], s65 offen offset:2048 sc1
    buffer_load_dwordx4 v[44:47], v4, s[4:7], s65 offen offset:3072 sc1
    s_add_u32 s65, s65, 4096
    buffer_load_dwordx4 v[48:51], v4, s[4:7], s65 offen offset:0 sc1
    buffer_load_dwordx4 v[52:55], v4, s[4:7], s65 offen offset:1024 sc1
    buffer_load_dwordx4 v[56:59], v4, s[4:7], s65 offen offset:2048 sc1
    buffer_load_dwordx4 v[60:63], v4, s[4:7], s65 offen offset:3072 sc1
    s_add_u32 s65, s65, 4096
    buffer_load_dwordx4 v[64:67], v4, s[4:7], s65 offen offset:0 sc1
    buffer_load_dwordx4 v[68:71], v4, s[4:7], s65 offen offset:1024 sc1
    buffer_load_dwordx4 v[72:75], v4, s[4:7], s65 offen offset:2048 sc1
    buffer_load_dwordx4 v[76:79], v4, s[4:7], s65 offen offset:3072 sc1
    s_add_u32 s65, s65, 4096
    buffer_load_dwordx4 v[80:83], v4, s[4:7], s65 offen offset:0 sc1
    buffer_load_dwordx4 v[84:87], v4, s[4:7], s65 offen offset:1024 sc1
    buffer_load_dwordx4 v[88:91], v4, s[4:7], s65 offen offset:2048 sc1
    buffer_load_dwordx4 v[92:95], v4, s[4:7], s65 offen offset:3072 sc1
    s_add_u32 s65, s65, 4096
    buffer_load_dwordx4 v[96:99], v4, s[4:7], s65 offen offset:0 sc1
    buffer_load_dwordx4 v[100:103], v4, s[4:7], s65 offen offset:1024 sc1
    buffer_load_dwordx4 v[104:107], v4, s[4:7], s65 offen offset:2048 sc1
    buffer_load_dwordx4 v[108:111], v4, s[4:7], s65 offen offset:3072 sc1
    s_add_u32 s65, s65, 4096
    buffer_load_dwordx4 v[112:115], v4, s[4:7], s65 offen offset:0 sc1
    buffer_load_dwordx4 v[116:119], v4, s[4:7], s65 offen offset:1024 sc1
    buffer_load_dwordx4 v[120:123], v4, s[4:7], s65 offen offset:2048 sc1
    buffer_load_dwordx4 v[124:127], v4, s[4:7], s65 offen offset:3072 sc1
    s_add_u32 s65, s65, 4096
    buffer_load_dwordx4 v[128:131], v4, s[4:7], s65 offen offset:0 sc1
    buffer_load_dwordx4 v[132:135], v4, s[4:7], s65 offen offset:1024 sc1
    buffer_load_dwordx4 v[136:139], v4, s[4:7], s65 offen offset:2048 sc1
    buffer_load_dwordx4 v[140:143], v4, s[4:7], s65 offen offset:3072 sc1
    s_add_u32 s65, s65, 4096
    buffer_load_dwordx4 v[144:147], v4, s[4:7], s65 offen offset:0 sc1
    buffer_load_dwordx4 v[148:151], v4, s[4:7], s65 offen offset:1024 sc1
    buffer_load_dwordx4 v[152:155], v4, s[4:7], s65 offen offset:2048 sc1
    buffer_load_dwordx4 v[156:159], v4, s[4:7], s65 offen offset:3072 sc1
    s_add_u32 s65, s65, 4096
    buffer_load_dwordx4 v[160:163], v4, s[4:7], s65 offen offset:0 sc1
    buffer_load_dwordx4 v[164:167], v4, s[4:7], s65 offen offset:1024 sc1
    buffer_load_dwordx4 v[168:171], v4, s[4:7], s65 offen offset:2048 sc1
    buffer_load_dwordx4 v[172:175], v4, s[4:7], s65 offen offset:3072 sc1
    s_add_u32 s65, s65, 4096
    buffer_load_dwordx4 v[176:179], v4, s[4:7], s65 offen offset:0 sc1
    s_waitcnt vmcnt(20)
    buffer_load_dwordx4 v[180:183], v4, s[4:7], s65 offen offset:1024 sc1
    buffer_load_dwordx4 v[184:187], v4, s[4:7], s65 offen offset:2048 sc1
    buffer_load_dwordx4 v[188:191], v4, s[4:7], s65 offen offset:3072 sc1
    s_add_u32 s65, s65, 4096
    buffer_load_dwordx4 v[192:195], v4, s[4:7], s65 offen offset:0 sc1
    buffer_load_dwordx4 v[196:199], v4, s[4:7], s65 offen offset:1024 sc1
    buffer_load_dwordx4 v[200:203], v4, s[4:7], s65 offen offset:2048 sc1
    buffer_load_dwordx4 v[204:207], v4, s[4:7], s65 offen offset:3072 sc1
    s_add_u32 s65, s65, 4096
    buffer_load_dwordx4 v[208:211], v4, s[4:7], s65 offen offset:0 sc1
    buffer_load_dwordx4 v[212:215], v4, s[4:7], s65 offen offset:1024 sc1
    buffer_load_dwordx4 v[216:219], v4, s[4:7], s65 offen offset:2048 sc1
    buffer_load_dwordx4 v[220:223], v4, s[4:7], s65 offen offset:3072 sc1
    s_add_u32 s65, s65, 4096
    buffer_load_dwordx4 v[224:227], v4, s[4:7], s65 offen offset:0 sc1
    buffer_load_dwordx4 v[228:231], v4, s[4:7], s65 offen offset:1024 sc1
    s_waitcnt vmcnt(0)
    s_lshl_b32 s26, s24, 5
    s_add_u32 m0, s25, 0
    s_add_u32 s64, s26, 0x0
    buffer_load_dwordx4 v2, s[52:55], s64 offen lds
    s_add_u32 m0, s25, 1024
    s_add_u32 s64, s26, 0xa000
    buffer_load_dwordx4 v2, s[52:55], s64 offen lds
    s_add_u32 m0, s25, 2048
    s_add_u32 s64, s26, 0x14000
    buffer_load_dwordx4 v2, s[52:55], s64 offen lds
    s_add_u32 m0, s25, 3072
    s_add_u32 s64, s26, 0x1e000
    buffer_load_dwordx4 v2, s[52:55], s64 offen lds
    s_add_u32 m0, s25, 4096
    s_add_u32 s64, s26, 0x28000
    buffer_load_dwordx4 v2, s[52:55], s64 offen lds
    s_add_u32 m0, s25, 5120
    s_add_u32 s64, s26, 0x32000
    buffer_load_dwordx4 v2, s[52:55], s64 offen lds
    s_add_u32 m0, s25, 6144
    s_add_u32 s64, s26, 0x3c000
    buffer_load_dwordx4 v2, s[52:55], s64 offen lds
    s_add_u32 m0, s25, 7168
    s_add_u32 s64, s26, 0x46000
    buffer_load_dwordx4 v2, s[52:55], s64 offen lds
    s_add_u32 m0, s25, 8192
    s_add_u32 s64, s26, 0x50000
    buffer_load_dwordx4 v2, s[52:55], s64 offen lds
    s_add_u32 m0, s25, 9216
    s_add_u32 s64, s26, 0x5a000
    buffer_load_dwordx4 v2, s[52:55], s64 offen lds
    s_add_u32 m0, s25, 10240
    s_add_u32 s64, s26, 0x64000
    buffer_load_dwordx4 v2, s[52:55], s64 offen lds
    s_add_u32 m0, s25, 11264
    s_add_u32 s64, s26, 0x6e000
    buffer_load_dwordx4 v2, s[52:55], s64 offen lds
    s_add_u32 m0, s25, 12288
    s_add_u32 s64, s26, 0x78000
    buffer_load_dwordx4 v2, s[52:55], s64 offen lds
    s_add_u32 m0, s25, 13312
    s_add_u32 s64, s26, 0x82000
    buffer_load_dwordx4 v2, s[52:55], s64 offen lds
    s_add_u32 m0, s25, 14336
    s_add_u32 s64, s26, 0x8c000
    buffer_load_dwordx4 v2, s[52:55], s64 offen lds
    s_add_u32 m0, s25, 15360
    s_add_u32 s64, s26, 0x96000
    buffer_load_dwordx4 v2, s[52:55], s64 offen lds
    s_add_u32 m0, s25, 16384
    s_add_u32 s64, s26, 0xa0000
    buffer_load_dwordx4 v2, s[52:55], s64 offen lds
    s_add_u32 m0, s25, 17408
    s_add_u32 s64, s26, 0xaa000
    buffer_load_dwordx4 v2, s[52:55], s64 offen lds
    s_add_u32 m0, s25, 18432
    s_add_u32 s64, s26, 0xb4000
    buffer_load_dwordx4 v2, s[52:55], s64 offen lds
    s_add_u32 m0, s25, 19456
    s_add_u32 s64, s26, 0xbe000
    buffer_load_dwordx4 v2, s[52:55], s64 offen lds
    s_add_u32 m0, s25, 20480
    s_add_u32 s64, s26, 0xc8000
    buffer_load_dwordx4 v2, s[52:55], s64 offen lds
    s_add_u32 m0, s25, 21504
    s_add_u32 s64, s26, 0xd2000
    buffer_load_dwordx4 v2, s[52:55], s64 offen lds
    s_add_u32 m0, s25, 22528
    s_add_u32 s64, s26, 0xdc000
    buffer_load_dwordx4 v2, s[52:55], s64 offen lds
    s_add_u32 m0, s25, 23552
    s_add_u32 s64, s26, 0xe6000
    buffer_load_dwordx4 v2, s[52:55], s64 offen lds
    s_add_u32 m0, s25, 24576
    s_add_u32 s64, s26, 0xf0000
    buffer_load_dwordx4 v2, s[52:55], s64 offen lds
    s_add_u32 m0, s25, 25600
    s_add_u32 s64, s26, 0xfa000
    buffer_load_dwordx4 v2, s[52:55], s64 offen lds
    s_add_u32 m0, s25, 26624
    s_add_u32 s64, s26, 0x104000
    buffer_load_dwordx4 v2, s[52:55], s64 offen lds
    s_add_u32 m0, s25, 27648
    s_add_u32 s64, s26, 0x10e000
    buffer_load_dwordx4 v2, s[52:55], s64 offen lds
    s_add_u32 m0, s25, 28672
    s_add_u32 s64, s26, 0x118000
    buffer_load_dwordx4 v2, s[52:55], s64 offen lds
    s_add_u32 m0, s25, 29696
    s_add_u32 s64, s26, 0x122000
    buffer_load_dwordx4 v2, s[52:55], s64 offen lds
    s_add_u32 m0, s25, 30720
    s_add_u32 s64, s26, 0x12c000
    buffer_load_dwordx4 v2, s[52:55], s64 offen lds
    s_add_u32 m0, s25, 31744
    s_add_u32 s64, s26, 0x136000
    buffer_load_dwordx4 v2, s[52:55], s64 offen lds
    s_add_u32 m0, s25, 32768
    s_add_u32 s64, s26, 0x140000
    buffer_load_dwordx4 v2, s[52:55], s64 offen lds
    s_add_u32 m0, s25, 33792
    s_add_u32 s64, s26, 0x14a000
    buffer_load_dwordx4 v2, s[52:55], s64 offen lds
    s_add_u32 m0, s25, 34816
    s_add_u32 s64, s26, 0x154000
    buffer_load_dwordx4 v2, s[52:55], s64 offen lds
    s_add_u32 m0, s25, 35840
    s_add_u32 s64, s26, 0x15e000
    buffer_load_dwordx4 v2, s[52:55], s64 offen lds
    s_add_u32 m0, s25, 36864
    s_add_u32 s64, s26, 0x168000
    buffer_load_dwordx4 v2, s[52:55], s64 offen lds
    s_add_u32 m0, s25, 37888
    s_add_u32 s64, s26, 0x172000
    buffer_load_dwordx4 v2, s[52:55], s64 offen lds
    s_add_u32 m0, s25, 38912
    s_add_u32 s64, s26, 0x17c000
    buffer_load_dwordx4 v2, s[52:55], s64 offen lds
    s_add_u32 m0, s25, 39936
    s_add_u32 s64, s26, 0x186000
    buffer_load_dwordx4 v2, s[52:55], s64 offen lds
    s_add_u32 m0, s25, 40960
    s_add_u32 s64, s26, 0x190000
    buffer_load_dwordx4 v2, s[52:55], s64 offen lds
    s_waitcnt vmcnt(20)
    s_add_u32 m0, s25, 41984
    s_add_u32 s64, s26, 0x19a000
    buffer_load_dwordx4 v2, s[52:55], s64 offen lds
    s_add_u32 m0, s25, 43008
    s_add_u32 s64, s26, 0x1a4000
    buffer_load_dwordx4 v2, s[52:55], s64 offen lds
    s_add_u32 m0, s25, 44032
    s_add_u32 s64, s26, 0x1ae000
    buffer_load_dwordx4 v2, s[52:55], s64 offen lds
    s_add_u32 m0, s25, 45056
    s_add_u32 s64, s26, 0x1b8000
    buffer_load_dwordx4 v2, s[52:55], s64 offen lds
    s_add_u32 m0, s25, 46080
    s_add_u32 s64, s26, 0x1c2000
    buffer_load_dwordx4 v2, s[52:55], s64 offen lds
    s_add_u32 m0, s25, 47104
    s_add_u32 s64, s26, 0x1cc000
    buffer_load_dwordx4 v2, s[52:55], s64 offen lds
    s_add_u32 m0, s25, 48128
    s_add_u32 s64, s26, 0x1d6000
    buffer_load_dwordx4 v2, s[52:55], s64 offen lds
    s_add_u32 m0, s25, 49152
    s_add_u32 s64, s26, 0x1e0000
    buffer_load_dwordx4 v2, s[52:55], s64 offen lds
    s_add_u32 m0, s25, 50176
    s_add_u32 s64, s26, 0x1ea000
    buffer_load_dwordx4 v2, s[52:55], s64 offen lds
    s_add_u32 m0, s25, 51200
    s_add_u32 s64, s26, 0x1f4000
    buffer_load_dwordx4 v2, s[52:55], s64 offen lds
    s_add_u32 m0, s25, 52224
    s_add_u32 s64, s26, 0x1fe000
    buffer_load_dwordx4 v2, s[52:55], s64 offen lds
    s_add_u32 m0, s25, 53248
    s_add_u32 s64, s26, 0x208000
    buffer_load_dwordx4 v2, s[52:55], s64 offen lds
    s_add_u32 m0, s25, 54272
    s_add_u32 s64, s26, 0x212000
    buffer_load_dwordx4 v2, s[52:55], s64 offen lds
    s_waitcnt vmcnt(0)
    ds_read_b64_tr_b16 v[232:233], v3 offset:0
    ds_read_b64_tr_b16 v[234:235], v3 offset:512
    s_waitcnt lgkmcnt(0)
    v_mfma_f32_16x16x32_bf16 v[8:11], v[232:235], v[16:19], 0
    ds_read_b64_tr_b16 v[236:237], v3 offset:1024
    ds_read_b64_tr_b16 v[238:239], v3 offset:1536
    s_waitcnt lgkmcnt(0)
    v_mfma_f32_16x16x32_bf16 v[8:11], v[236:239], v[20:23], v[8:11]
    ds_read_b64_tr_b16 v[240:241], v3 offset:2048
    ds_read_b64_tr_b16 v[242:243], v3 offset:2560
    s_waitcnt lgkmcnt(0)
    v_mfma_f32_16x16x32_bf16 v[8:11], v[240:243], v[24:27], v[8:11]
    ds_read_b64_tr_b16 v[244:245], v3 offset:3072
    ds_read_b64_tr_b16 v[246:247], v3 offset:3584
    s_waitcnt lgkmcnt(0)
    v_mfma_f32_16x16x32_bf16 v[8:11], v[244:247], v[28:31], v[8:11]
    ds_read_b64_tr_b16 v[232:233], v3 offset:4096
    ds_read_b64_tr_b16 v[234:235], v3 offset:4608
    s_waitcnt lgkmcnt(0)
    v_mfma_f32_16x16x32_bf16 v[8:11], v[232:235], v[32:35], v[8:11]
    ds_read_b64_tr_b16 v[236:237], v3 offset:5120
    ds_read_b64_tr_b16 v[238:239], v3 offset:5632
    s_waitcnt lgkmcnt(0)
    v_mfma_f32_16x16x32_bf16 v[8:11], v[236:239], v[36:39], v[8:11]
    ds_read_b64_tr_b16 v[240:241], v3 offset:6144
    ds_read_b64_tr_b16 v[242:243], v3 offset:6656
    s_waitcnt lgkmcnt(0)
    v_mfma_f32_16x16x32_bf16 v[8:11], v[240:243], v[40:43], v[8:11]
    ds_read_b64_tr_b16 v[244:245], v3 offset:7168
    ds_read_b64_tr_b16 v[246:247], v3 offset:7680
    s_waitcnt lgkmcnt(0)
    v_mfma_f32_16x16x32_bf16 v[8:11], v[244:247], v[44:47], v[8:11]
    ds_read_b64_tr_b16 v[232:233], v3 offset:8192
    ds_read_b64_tr_b16 v[234:235], v3 offset:8704
    s_waitcnt lgkmcnt(0)
    v_mfma_f32_16x16x32_bf16 v[8:11], v[232:235], v[48:51], v[8:11]
    ds_read_b64_tr_b16 v[236:237], v3 offset:9216
    ds_read_b64_tr_b16 v[238:239], v3 offset:9728
    s_waitcnt lgkmcnt(0)
    v_mfma_f32_16x16x32_bf16 v[8:11], v[236:239], v[52:55], v[8:11]
    ds_read_b64_tr_b16 v[240:241], v3 offset:10240
    ds_read_b64_tr_b16 v[242:243], v3 offset:10752
    s_waitcnt lgkmcnt(0)
    v_mfma_f32_16x16x32_bf16 v[8:11], v[240:243], v[56:59], v[8:11]
    ds_read_b64_tr_b16 v[244:245], v3 offset:11264
    ds_read_b64_tr_b16 v[246:247], v3 offset:11776
    s_waitcnt lgkmcnt(0)
    v_mfma_f32_16x16x32_bf16 v[8:11], v[244:247], v[60:63], v[8:11]
    ds_read_b64_tr_b16 v[232:233], v3 offset:12288
    ds_read_b64_tr_b16 v[234:235], v3 offset:12800
    s_waitcnt lgkmcnt(0)
    v_mfma_f32_16x16x32_bf16 v[8:11], v[232:235], v[64:67], v[8:11]
    ds_read_b64_tr_b16 v[236:237], v3 offset:13312
    ds_read_b64_tr_b16 v[238:239], v3 offset:13824
    s_waitcnt lgkmcnt(0)
    v_mfma_f32_16x16x32_bf16 v[8:11], v[236:239], v[68:71], v[8:11]
    ds_read_b64_tr_b16 v[240:241], v3 offset:14336
    ds_read_b64_tr_b16 v[242:243], v3 offset:14848
    s_waitcnt lgkmcnt(0)
    v_mfma_f32_16x16x32_bf16 v[8:11], v[240:243], v[72:75], v[8:11]
    ds_read_b64_tr_b16 v[244:245], v3 offset:15360
    ds_read_b64_tr_b16 v[246:247], v3 offset:15872
    s_waitcnt lgkmcnt(0)
    v_mfma_f32_16x16x32_bf16 v[8:11], v[244:247], v[76:79], v[8:11]
    ds_read_b64_tr_b16 v[232:233], v3 offset:16384
    ds_read_b64_tr_b16 v[234:235], v3 offset:16896
    s_waitcnt lgkmcnt(0)
    v_mfma_f32_16x16x32_bf16 v[8:11], v[232:235], v[80:83], v[8:11]
    ds_read_b64_tr_b16 v[236:237], v3 offset:17408
    ds_read_b64_tr_b16 v[238:239], v3 offset:17920
    s_waitcnt lgkmcnt(0)
    v_mfma_f32_16x16x32_bf16 v[8:11], v[236:239], v[84:87], v[8:11]
    ds_read_b64_tr_b16 v[240:241], v3 offset:18432
    ds_read_b64_tr_b16 v[242:243], v3 offset:18944
    s_waitcnt lgkmcnt(0)
    v_mfma_f32_16x16x32_bf16 v[8:11], v[240:243], v[88:91], v[8:11]
    ds_read_b64_tr_b16 v[244:245], v3 offset:19456
    ds_read_b64_tr_b16 v[246:247], v3 offset:19968
    s_waitcnt lgkmcnt(0)
    v_mfma_f32_16x16x32_bf16 v[8:11], v[244:247], v[92:95], v[8:11]
    ds_read_b64_tr_b16 v[232:233], v3 offset:20480
    ds_read_b64_tr_b16 v[234:235], v3 offset:20992
    s_waitcnt lgkmcnt(0)
    v_mfma_f32_16x16x32_bf16 v[8:11], v[232:235], v[96:99], v[8:11]
    ds_read_b64_tr_b16 v[236:237], v3 offset:21504
    ds_read_b64_tr_b16 v[238:239], v3 offset:22016
    s_waitcnt lgkmcnt(0)
    v_mfma_f32_16x16x32_bf16 v[8:11], v[236:239], v[100:103], v[8:11]
    ds_read_b64_tr_b16 v[240:241], v3 offset:22528
    ds_read_b64_tr_b16 v[242:243], v3 offset:23040
    s_waitcnt lgkmcnt(0)
    v_mfma_f32_16x16x32_bf16 v[8:11], v[240:243], v[104:107], v[8:11]
    ds_read_b64_tr_b16 v[244:245], v3 offset:23552
    ds_read_b64_tr_b16 v[246:247], v3 offset:24064
    s_waitcnt lgkmcnt(0)
    v_mfma_f32_16x16x32_bf16 v[8:11], v[244:247], v[108:111], v[8:11]
    ds_read_b64_tr_b16 v[232:233], v3 offset:24576
    ds_read_b64_tr_b16 v[234:235], v3 offset:25088
    s_waitcnt lgkmcnt(0)
    v_mfma_f32_16x16x32_bf16 v[8:11], v[232:235], v[112:115], v[8:11]
    ds_read_b64_tr_b16 v[236:237], v3 offset:25600
    ds_read_b64_tr_b16 v[238:239], v3 offset:26112
    s_waitcnt lgkmcnt(0)
    v_mfma_f32_16x16x32_bf16 v[8:11], v[236:239], v[116:119], v[8:11]
    ds_read_b64_tr_b16 v[240:241], v3 offset:26624
    ds_read_b64_tr_b16 v[242:243], v3 offset:27136
    s_waitcnt lgkmcnt(0)
    v_mfma_f32_16x16x32_bf16 v[8:11], v[240:243], v[120:123], v[8:11]
    ds_read_b64_tr_b16 v[244:245], v3 offset:27648
    ds_read_b64_tr_b16 v[246:247], v3 offset:28160
    s_waitcnt lgkmcnt(0)
    v_mfma_f32_16x16x32_bf16 v[8:11], v[244:247], v[124:127], v[8:11]
    ds_read_b64_tr_b16 v[232:233], v3 offset:28672
    ds_read_b64_tr_b16 v[234:235], v3 offset:29184
    s_waitcnt lgkmcnt(0)
    v_mfma_f32_16x16x32_bf16 v[8:11], v[232:235], v[128:131], v[8:11]
    ds_read_b64_tr_b16 v[236:237], v3 offset:29696
    ds_read_b64_tr_b16 v[238:239], v3 offset:30208
    s_waitcnt lgkmcnt(0)
    v_mfma_f32_16x16x32_bf16 v[8:11], v[236:239], v[132:135], v[8:11]
    ds_read_b64_tr_b16 v[240:241], v3 offset:30720
    ds_read_b64_tr_b16 v[242:243], v3 offset:31232
    s_waitcnt lgkmcnt(0)
    v_mfma_f32_16x16x32_bf16 v[8:11], v[240:243], v[136:139], v[8:11]
    ds_read_b64_tr_b16 v[244:245], v3 offset:31744
    ds_read_b64_tr_b16 v[246:247], v3 offset:32256
    s_waitcnt lgkmcnt(0)
    v_mfma_f32_16x16x32_bf16 v[8:11], v[244:247], v[140:143], v[8:11]
    ds_read_b64_tr_b16 v[232:233], v3 offset:32768
    ds_read_b64_tr_b16 v[234:235], v3 offset:33280
    s_waitcnt lgkmcnt(0)
    v_mfma_f32_16x16x32_bf16 v[8:11], v[232:235], v[144:147], v[8:11]
    ds_read_b64_tr_b16 v[236:237], v3 offset:33792
    ds_read_b64_tr_b16 v[238:239], v3 offset:34304
    s_waitcnt lgkmcnt(0)
    v_mfma_f32_16x16x32_bf16 v[8:11], v[236:239], v[148:151], v[8:11]
    ds_read_b64_tr_b16 v[240:241], v3 offset:34816
    ds_read_b64_tr_b16 v[242:243], v3 offset:35328
    s_waitcnt lgkmcnt(0)
    v_mfma_f32_16x16x32_bf16 v[8:11], v[240:243], v[152:155], v[8:11]
    ds_read_b64_tr_b16 v[244:245], v3 offset:35840
    ds_read_b64_tr_b16 v[246:247], v3 offset:36352
    s_waitcnt lgkmcnt(0)
    v_mfma_f32_16x16x32_bf16 v[8:11], v[244:247], v[156:159], v[8:11]
    ds_read_b64_tr_b16 v[232:233], v3 offset:36864
    ds_read_b64_tr_b16 v[234:235], v3 offset:37376
    s_waitcnt lgkmcnt(0)
    v_mfma_f32_16x16x32_bf16 v[8:11], v[232:235], v[160:163], v[8:11]
    ds_read_b64_tr_b16 v[236:237], v3 offset:37888
    ds_read_b64_tr_b16 v[238:239], v3 offset:38400
    s_waitcnt lgkmcnt(0)
    v_mfma_f32_16x16x32_bf16 v[8:11], v[236:239], v[164:167], v[8:11]
    ds_read_b64_tr_b16 v[240:241], v3 offset:38912
    ds_read_b64_tr_b16 v[242:243], v3 offset:39424
    s_waitcnt lgkmcnt(0)
    v_mfma_f32_16x16x32_bf16 v[8:11], v[240:243], v[168:171], v[8:11]
    ds_read_b64_tr_b16 v[244:245], v3 offset:39936
    ds_read_b64_tr_b16 v[246:247], v3 offset:40448
    s_waitcnt lgkmcnt(0)
    v_mfma_f32_16x16x32_bf16 v[8:11], v[244:247], v[172:175], v[8:11]
    ds_read_b64_tr_b16 v[232:233], v3 offset:40960
    ds_read_b64_tr_b16 v[234:235], v3 offset:41472
    s_waitcnt lgkmcnt(0)
    v_mfma_f32_16x16x32_bf16 v[8:11], v[232:235], v[176:179], v[8:11]
    ds_read_b64_tr_b16 v[236:237], v3 offset:41984
    ds_read_b64_tr_b16 v[238:239], v3 offset:42496
    s_waitcnt lgkmcnt(0)
    v_mfma_f32_16x16x32_bf16 v[8:11], v[236:239], v[180:183], v[8:11]
    ds_read_b64_tr_b16 v[240:241], v3 offset:43008
    ds_read_b64_tr_b16 v[242:243], v3 offset:43520
    s_waitcnt lgkmcnt(0)
    v_mfma_f32_16x16x32_bf16 v[8:11], v[240:243], v[184:187], v[8:11]
    ds_read_b64_tr_b16 v[244:245], v3 offset:44032
    ds_read_b64_tr_b16 v[246:247], v3 offset:44544
    s_waitcnt lgkmcnt(0)
    v_mfma_f32_16x16x32_bf16 v[8:11], v[244:247], v[188:191], v[8:11]
    ds_read_b64_tr_b16 v[232:233], v3 offset:45056
    ds_read_b64_tr_b16 v[234:235], v3 offset:45568
    s_waitcnt lgkmcnt(0)
    v_mfma_f32_16x16x32_bf16 v[8:11], v[232:235], v[192:195], v[8:11]
    ds_read_b64_tr_b16 v[236:237], v3 offset:46080
    ds_read_b64_tr_b16 v[238:239], v3 offset:46592
    s_waitcnt lgkmcnt(0)
    v_mfma_f32_16x16x32_bf16 v[8:11], v[236:239], v[196:199], v[8:11]
    ds_read_b64_tr_b16 v[240:241], v3 offset:47104
    ds_read_b64_tr_b16 v[242:243], v3 offset:47616
    s_waitcnt lgkmcnt(0)
    v_mfma_f32_16x16x32_bf16 v[8:11], v[240:243], v[200:203], v[8:11]
    ds_read_b64_tr_b16 v[244:245], v3 offset:48128
    ds_read_b64_tr_b16 v[246:247], v3 offset:48640
    s_waitcnt lgkmcnt(0)
    v_mfma_f32_16x16x32_bf16 v[8:11], v[244:247], v[204:207], v[8:11]
    ds_read_b64_tr_b16 v[232:233], v3 offset:49152
    ds_read_b64_tr_b16 v[234:235], v3 offset:49664
    s_waitcnt lgkmcnt(0)
    v_mfma_f32_16x16x32_bf16 v[8:11], v[232:235], v[208:211], v[8:11]
    ds_read_b64_tr_b16 v[236:237], v3 offset:50176
    ds_read_b64_tr_b16 v[238:239], v3 offset:50688
    s_waitcnt lgkmcnt(0)
    v_mfma_f32_16x16x32_bf16 v[8:11], v[236:239], v[212:215], v[8:11]
    ds_read_b64_tr_b16 v[240:241], v3 offset:51200
    ds_read_b64_tr_b16 v[242:243], v3 offset:51712
    s_waitcnt lgkmcnt(0)
    v_mfma_f32_16x16x32_bf16 v[8:11], v[240:243], v[216:219], v[8:11]
    ds_read_b64_tr_b16 v[244:245], v3 offset:52224
    ds_read_b64_tr_b16 v[246:247], v3 offset:52736
    s_waitcnt lgkmcnt(0)
    v_mfma_f32_16x16x32_bf16 v[8:11], v[244:247], v[220:223], v[8:11]
    ds_read_b64_tr_b16 v[232:233], v3 offset:53248
    ds_read_b64_tr_b16 v[234:235], v3 offset:53760
    s_waitcnt lgkmcnt(0)
    v_mfma_f32_16x16x32_bf16 v[8:11], v[232:235], v[224:227], v[8:11]
    ds_read_b64_tr_b16 v[236:237], v3 offset:54272
    ds_read_b64_tr_b16 v[238:239], v3 offset:54784
    s_waitcnt lgkmcnt(0)
    v_mfma_f32_16x16x32_bf16 v[8:11], v[236:239], v[228:231], v[8:11]
    v_and_b32 v7, 7, v0
    v_lshlrev_b32 v7, 2, v7
    s_mov_b32 s64, 0x5400020
    buffer_load_dword v12, v7, s[4:7], s64 offen sc1
    s_waitcnt vmcnt(0)
    s_nop 7
    v_cvt_pk_bf16_f32 v8, v8, v8
    v_lshlrev_b32 v8, 16, v8
    v_mul_f32 v8, v8, v12
    v_cvt_pk_bf16_f32 v8, v8, v8
    v_lshlrev_b32 v8, 16, v8
    v_cvt_pk_bf16_f32 v9, v9, v9
    v_lshlrev_b32 v9, 16, v9
    v_mul_f32 v9, v9, v12
    v_cvt_pk_bf16_f32 v9, v9, v9
    v_lshlrev_b32 v9, 16, v9
    v_cvt_pk_bf16_f32 v10, v10, v10
    v_lshlrev_b32 v10, 16, v10
    v_mul_f32 v10, v10, v12
    v_cvt_pk_bf16_f32 v10, v10, v10
    v_lshlrev_b32 v10, 16, v10
    v_cvt_pk_bf16_f32 v11, v11, v11
    v_lshlrev_b32 v11, 16, v11
    v_mul_f32 v11, v11, v12
    v_cvt_pk_bf16_f32 v11, v11, v11
    v_lshlrev_b32 v11, 16, v11
    v_and_b32 v7, 7, v0
    v_mul_u32_u24 v7, 2560, v7
    v_lshrrev_b32 v13, 4, v0
    v_lshl_add_u32 v7, v13, 4, v7
    s_lshl_b32 s64, s24, 6
    s_add_u32 s64, s64, 0x5410000
    s_mov_b32 s68, 0x00ff00ff
    s_mov_b32 s69, 0x00ff00ff
    s_mov_b64 exec, s[68:69]
    buffer_store_dwordx4 v[8:11], v7, s[4:7], s64 offen sc1
    s_mov_b64 exec, -1
    s_waitcnt vmcnt(0)
    v_mov_b32 v7, 1
    v_mov_b32 v8, 0
    s_mov_b32 s64, 0x298100
    s_mov_b64 exec, 1
    buffer_atomic_add v7, v8, s[4:7], s64 offen sc1
    s_mov_b64 exec, -1
H_ATT:
    v_mbcnt_lo_u32_b32 v0, -1, 0
    v_mbcnt_hi_u32_b32 v0, -1, v0
    s_mov_b32 s29, 0
    v_lshlrev_b32 v1, 4, v0
    v_lshrrev_b32 v5, 4, v0
    v_lshlrev_b32 v2, 7, v5
    v_and_b32 v5, 7, v0
    v_lshl_add_u32 v2, v5, 4, v2
    v_bfe_u32 v5, v0, 4, 1
    v_lshlrev_b32 v3, 7, v5
    v_and_b32 v5, 15, v0
    v_lshl_add_u32 v3, v5, 3, v3
    s_mov_b32 s34, 0x3e0293ee
    s_mov_b32 s35, 0x3e0293ee
    s_mov_b32 s36, -1
    s_mov_b32 s37, 0
    v_lshrrev_b32 v5, 4, v0
    v_lshlrev_b32 v5, 2, v5
    v_and_b32 v6, 15, v0
    v_add_u32 v7, 0, v5
    v_cmp_le_u32 s[38:39], v7, v6
    v_add_u32 v7, 1, v5
    v_cmp_le_u32 s[40:41], v7, v6
    v_add_u32 v7, 2, v5
    v_cmp_le_u32 s[42:43], v7, v6
    v_add_u32 v7, 3, v5
    v_cmp_le_u32 s[44:45], v7, v6
    v_mov_b32 v248, 0x3f803f80
    v_mov_b32 v249, 0x3f803f80
    v_mov_b32 v250, 0x3f803f80
    v_mov_b32 v251, 0x3f803f80
    s_lshl_b32 s24, s12, 2
    s_add_u32 s24, s24, s14
    s_add_u32 s24, s24, 16
    s_mov_b32 s25, 2
AT2_LOOP:
    s_lshl_b32 s64, s24, 5
    s_add_u32 s64, s64, s13
    s_lshl_b32 s26, s64, 13
    s_add_u32 s26, s26, 0x3400000
    s_lshl_b32 s27, s64, 14
    s_add_u32 s27, s27, 0x1400000
    s_lshl_b32 s65, s64, 11
    s_add_u32 s30, s65, 0x640000
    s_add_u32 s31, s65, 0xa40000
    s_lshl_b32 s33, s64, 2
    s_add_u32 s33, s33, 0x296000
    s_lshl_b32 s32, s24, 18
    s_lshl_b32 s65, s13, 12
    s_add_u32 s32, s32, s65
    s_add_u32 s32, s32, 0x4400000
    s_lshr_b32 s65, s24, 2
    s_lshl_b32 s65, s65, 9
    s_lshl_b32 s66, s13, 4
    s_add_u32 s65, s65, s66
    s_add_u32 s65, s65, 0x291000
    s_lshr_b32 s66, s24, 1
    s_lshl_b32 s66, s66, 8
    s_lshl_b32 s64, s13, 3
    s_add_u32 s66, s66, s64
    s_add_u32 s66, s66, 0x293ff4
    v_lshlrev_b32 v5, 2, v0
    v_mov_b32 v6, s65
    v_mov_b32 v7, s66
    v_cmp_gt_u32 vcc, 3, v0
    s_nop 1
    v_cndmask_b32 v6, v7, v6, vcc
    v_add_u32 v4, v5, v6
    s_mov_b32 s64, 0
    s_mov_b64 exec, 7
AT2_F_143:
    buffer_load_dword v5, v4, s[4:7], s64 offen sc1
    s_add_u32 s29, s29, 1
    s_waitcnt vmcnt(0)
    v_cmp_eq_u32 vcc, 0, v5
    s_cbranch_vccz AT2_FD_144
    s_cmp_gt_u32 s29, 262144
    s_cbranch_scc1 AT2_FD_144
    s_sleep 4
    s_branch AT2_F_143
AT2_FD_144:
    s_mov_b64 exec, -1
    buffer_load_dwordx4 v[16:19], v1, s[4:7], s26 offen offset:0
    buffer_load_dwordx4 v[20:23], v1, s[4:7], s26 offen offset:1024
    buffer_load_dwordx4 v[24:27], v1, s[4:7], s26 offen offset:2048
    buffer_load_dwordx4 v[28:31], v1, s[4:7], s26 offen offset:3072
    s_add_u32 s26, s26, 4096
    buffer_load_dwordx4 v[32:35], v1, s[4:7], s26 offen offset:0
    buffer_load_dwordx4 v[36:39], v1, s[4:7], s26 offen offset:1024
    buffer_load_dwordx4 v[40:43], v1, s[4:7], s26 offen offset:2048
    buffer_load_dwordx4 v[44:47], v1, s[4:7], s26 offen offset:3072
    buffer_load_dwordx4 v[48:51], v1, s[4:7], s27 offen offset:0
    buffer_load_dwordx4 v[52:55], v1, s[4:7], s27 offen offset:1024
    buffer_load_dwordx4 v[56:59], v1, s[4:7], s27 offen offset:2048
    buffer_load_dwordx4 v[60:63], v1, s[4:7], s27 offen offset:3072
    s_add_u32 s27, s27, 4096
    buffer_load_dwordx4 v[64:67], v1, s[4:7], s27 offen offset:0
    buffer_load_dwordx4 v[68:71], v1, s[4:7], s27 offen offset:1024
    buffer_load_dwordx4 v[72:75], v1, s[4:7], s27 offen offset:2048
    buffer_load_dwordx4 v[76:79], v1, s[4:7], s27 offen offset:3072
    s_add_u32 s27, s27, 4096
    buffer_load_dwordx4 v[80:83], v1, s[4:7], s27 offen offset:0
    buffer_load_dwordx4 v[84:87], v1, s[4:7], s27 offen offset:1024
    buffer_load_dwordx4 v[88:91], v1, s[4:7], s27 offen offset:2048
    buffer_load_dwordx4 v[92:95], v1, s[4:7], s27 offen offset:3072
    s_add_u32 s27, s27, 4096
    buffer_load_dwordx4 v[96:99], v1, s[4:7], s27 offen offset:0
    buffer_load_dwordx4 v[100:103], v1, s[4:7], s27 offen offset:1024
    buffer_load_dwordx4 v[104:107], v1, s[4:7], s27 offen offset:2048
    buffer_load_dwordx4 v[108:111], v1, s[4:7], s27 offen offset:3072
    s_mov_b64 exec, 0x18
AT2_G_145:
    buffer_load_dword v5, v4, s[4:7], s64 offen sc1
    s_add_u32 s29, s29, 1
    s_waitcnt vmcnt(0)
    v_cmp_eq_u32 vcc, 0, v5
    s_cbranch_vccz AT2_GD_146
    s_cmp_gt_u32 s29, 262144
    s_cbranch_scc1 AT2_GD_146
    s_sleep 4
    s_branch AT2_G_145
AT2_GD_146:
    s_mov_b64 exec, -1
    buffer_load_dwordx4 v[112:115], v2, s[4:7], s30 offen offset:0
    buffer_load_dwordx4 v[116:119], v2, s[4:7], s30 offen offset:512
    buffer_load_dwordx4 v[120:123], v2, s[4:7], s30 offen offset:1024
    buffer_load_dwordx4 v[124:127], v2, s[4:7], s30 offen offset:1536
    buffer_load_dwordx2 v[128:129], v3, s[4:7], s31 offen offset:0
    buffer_load_dwordx2 v[130:131], v3, s[4:7], s31 offen offset:256
    buffer_load_dwordx2 v[132:133], v3, s[4:7], s31 offen offset:512
    buffer_load_dwordx2 v[134:135], v3, s[4:7], s31 offen offset:768
    buffer_load_dwordx2 v[136:137], v3, s[4:7], s31 offen offset:1024
    buffer_load_dwordx2 v[138:139], v3, s[4:7], s31 offen offset:1280
    buffer_load_dwordx2 v[140:141], v3, s[4:7], s31 offen offset:1536
    buffer_load_dwordx2 v[142:143], v3, s[4:7], s31 offen offset:1792
    v_mfma_f32_16x16x32_bf16 v[148:151], v[48:51], v[16:19], 0
    v_mfma_f32_16x16x32_bf16 v[156:159], v[48:51], v[32:35], 0
    v_mfma_f32_16x16x32_bf16 v[160:163], v[64:67], v[32:35], 0
    v_mfma_f32_16x16x32_bf16 v[148:151], v[52:55], v[20:23], v[148:151]
    v_mfma_f32_16x16x32_bf16 v[156:159], v[52:55], v[36:39], v[156:159]
    v_mfma_f32_16x16x32_bf16 v[160:163], v[68:71], v[36:39], v[160:163]
    v_mfma_f32_16x16x32_bf16 v[148:151], v[56:59], v[24:27], v[148:151]
    v_mfma_f32_16x16x32_bf16 v[156:159], v[56:59], v[40:43], v[156:159]
    v_mfma_f32_16x16x32_bf16 v[160:163], v[72:75], v[40:43], v[160:163]
    v_mfma_f32_16x16x32_bf16 v[148:151], v[60:63], v[28:31], v[148:151]
    v_mfma_f32_16x16x32_bf16 v[156:159], v[60:63], v[44:47], v[156:159]
    v_mfma_f32_16x16x32_bf16 v[160:163], v[76:79], v[44:47], v[160:163]
    s_waitcnt vmcnt(8)
    v_mfma_f32_16x16x32_bf16 v[144:147], v[112:115], v[16:19], 0
    v_mfma_f32_16x16x32_bf16 v[152:155], v[112:115], v[32:35], 0
    v_mfma_f32_16x16x32_bf16 v[144:147], v[116:119], v[20:23], v[144:147]
    v_mfma_f32_16x16x32_bf16 v[152:155], v[116:119], v[36:39], v[152:155]
    v_mfma_f32_16x16x32_bf16 v[144:147], v[120:123], v[24:27], v[144:147]
    v_mfma_f32_16x16x32_bf16 v[152:155], v[120:123], v[40:43], v[152:155]
    v_mfma_f32_16x16x32_bf16 v[144:147], v[124:127], v[28:31], v[144:147]
    v_mfma_f32_16x16x32_bf16 v[152:155], v[124:127], v[44:47], v[152:155]
    v_mov_b32 v11, 0xff800000
    s_nop 7
    v_cndmask_b32 v148, v11, v148, s[38:39]
    v_cndmask_b32 v160, v11, v160, s[38:39]
    v_cndmask_b32 v144, v11, v144, s[36:37]
    v_cndmask_b32 v152, v11, v152, s[36:37]
    v_cndmask_b32 v149, v11, v149, s[40:41]
    v_cndmask_b32 v161, v11, v161, s[40:41]
    v_cndmask_b32 v145, v11, v145, s[36:37]
    v_cndmask_b32 v153, v11, v153, s[36:37]
    v_cndmask_b32 v150, v11, v150, s[42:43]
    v_cndmask_b32 v162, v11, v162, s[42:43]
    v_cndmask_b32 v146, v11, v146, s[36:37]
    v_cndmask_b32 v154, v11, v154, s[36:37]
    v_cndmask_b32 v151, v11, v151, s[44:45]
    v_cndmask_b32 v163, v11, v163, s[44:45]
    v_cndmask_b32 v147, v11, v147, s[36:37]
    v_cndmask_b32 v155, v11, v155, s[36:37]
    v_max3_f32 v8, v144, v145, v146
    v_max3_f32 v8, v8, v147, v148
    v_max3_f32 v8, v8, v149, v150
    v_max_f32 v8, v8, v151
    v_mov_b32 v9, v8
    s_nop 1
    v_permlane16_swap_b32 v8, v9
    v_max_f32 v8, v8, v9
    v_mov_b32 v9, v8
    s_nop 1
    v_permlane32_swap_b32 v8, v9
    v_max_f32 v8, v8, v9
    v_mul_f32 v8, s34, v8
    v_fma_f32 v144, v144, s34, -v8
    v_fma_f32 v145, v145, s34, -v8
    v_fma_f32 v146, v146, s34, -v8
    v_fma_f32 v147, v147, s34, -v8
    v_fma_f32 v148, v148, s34, -v8
    v_fma_f32 v149, v149, s34, -v8
    v_fma_f32 v150, v150, s34, -v8
    v_fma_f32 v151, v151, s34, -v8
    v_exp_f32 v144, v144
    v_exp_f32 v145, v145
    v_exp_f32 v146, v146
    v_exp_f32 v147, v147
    v_exp_f32 v148, v148
    v_exp_f32 v149, v149
    v_exp_f32 v150, v150
    v_exp_f32 v151, v151
    s_nop 0
    v_cvt_pk_bf16_f32 v164, v148, v149
    v_cvt_pk_bf16_f32 v165, v150, v151
    v_mov_b32 v166, 0
    v_mov_b32 v167, 0
    v_cvt_pk_bf16_f32 v168, v144, v145
    v_cvt_pk_bf16_f32 v169, v146, v147
    v_max3_f32 v8, v152, v153, v154
    v_max3_f32 v8, v8, v155, v156
    v_max3_f32 v8, v8, v157, v158
    v_max3_f32 v8, v8, v159, v160
    v_max3_f32 v8, v8, v161, v162
    v_max_f32 v8, v8, v163
    v_mov_b32 v9, v8
    s_nop 1
    v_permlane16_swap_b32 v8, v9
    v_max_f32 v8, v8, v9
    v_mov_b32 v9, v8
    s_nop 1
    v_permlane32_swap_b32 v8, v9
    v_max_f32 v8, v8, v9
    v_mul_f32 v8, s34, v8
    v_fma_f32 v152, v152, s34, -v8
    v_fma_f32 v153, v153, s34, -v8
    v_fma_f32 v154, v154, s34, -v8
    v_fma_f32 v155, v155, s34, -v8
    v_fma_f32 v156, v156, s34, -v8
    v_fma_f32 v157, v157, s34, -v8
    v_fma_f32 v158, v158, s34, -v8
    v_fma_f32 v159, v159, s34, -v8
    v_fma_f32 v160, v160, s34, -v8
    v_fma_f32 v161, v161, s34, -v8
    v_fma_f32 v162, v162, s34, -v8
    v_fma_f32 v163, v163, s34, -v8
    v_exp_f32 v152, v152
    v_exp_f32 v153, v153
    v_exp_f32 v154, v154
    v_exp_f32 v155, v155
    v_exp_f32 v156, v156
    v_exp_f32 v157, v157
    v_exp_f32 v158, v158
    v_exp_f32 v159, v159
    v_exp_f32 v160, v160
    v_exp_f32 v161, v161
    v_exp_f32 v162, v162
    v_exp_f32 v163, v163
    s_nop 0
    v_cvt_pk_bf16_f32 v170, v156, v157
    v_cvt_pk_bf16_f32 v171, v158, v159
    v_cvt_pk_bf16_f32 v172, v160, v161
    v_cvt_pk_bf16_f32 v173, v162, v163
    v_cvt_pk_bf16_f32 v174, v152, v153
    v_cvt_pk_bf16_f32 v175, v154, v155
    s_waitcnt vmcnt(0)
    v_mfma_f32_16x16x32_bf16 v[240:243], v[248:251], v[164:167], 0
    v_mfma_f32_16x16x32_bf16 v[244:247], v[248:251], v[170:173], 0
    v_mfma_f32_16x16x32_bf16 v[176:179], v[80:83], v[164:167], 0
    v_mfma_f32_16x16x32_bf16 v[180:183], v[80:83], v[170:173], 0
    v_mfma_f32_16x16x32_bf16 v[184:187], v[84:87], v[164:167], 0
    v_mfma_f32_16x16x32_bf16 v[188:191], v[84:87], v[170:173], 0
    v_mfma_f32_16x16x32_bf16 v[192:195], v[88:91], v[164:167], 0
    v_mfma_f32_16x16x32_bf16 v[196:199], v[88:91], v[170:173], 0
    v_mfma_f32_16x16x32_bf16 v[200:203], v[92:95], v[164:167], 0
    v_mfma_f32_16x16x32_bf16 v[204:207], v[92:95], v[170:173], 0
    v_mfma_f32_16x16x32_bf16 v[208:211], v[96:99], v[164:167], 0
    v_mfma_f32_16x16x32_bf16 v[212:215], v[96:99], v[170:173], 0
    v_mfma_f32_16x16x32_bf16 v[216:219], v[100:103], v[164:167], 0
    v_mfma_f32_16x16x32_bf16 v[220:223], v[100:103], v[170:173], 0
    v_mfma_f32_16x16x32_bf16 v[224:227], v[104:107], v[164:167], 0
    v_mfma_f32_16x16x32_bf16 v[228:231], v[104:107], v[170:173], 0
    v_mfma_f32_16x16x32_bf16 v[232:235], v[108:111], v[164:167], 0
    v_mfma_f32_16x16x32_bf16 v[236:239], v[108:111], v[170:173], 0
    v_mfma_f32_16x16x16_bf16 v[240:243], v[248:249], v[168:169], v[240:243]
    v_mfma_f32_16x16x16_bf16 v[244:247], v[248:249], v[174:175], v[244:247]
    v_mfma_f32_16x16x16_bf16 v[176:179], v[128:129], v[168:169], v[176:179]
    v_mfma_f32_16x16x16_bf16 v[180:183], v[128:129], v[174:175], v[180:183]
    v_mfma_f32_16x16x16_bf16 v[184:187], v[130:131], v[168:169], v[184:187]
    v_mfma_f32_16x16x16_bf16 v[188:191], v[130:131], v[174:175], v[188:191]
    v_mfma_f32_16x16x16_bf16 v[192:195], v[132:133], v[168:169], v[192:195]
    v_mfma_f32_16x16x16_bf16 v[196:199], v[132:133], v[174:175], v[196:199]
    v_mfma_f32_16x16x16_bf16 v[200:203], v[134:135], v[168:169], v[200:203]
    v_mfma_f32_16x16x16_bf16 v[204:207], v[134:135], v[174:175], v[204:207]
    v_mfma_f32_16x16x16_bf16 v[208:211], v[136:137], v[168:169], v[208:211]
    v_mfma_f32_16x16x16_bf16 v[212:215], v[136:137], v[174:175], v[212:215]
    v_mfma_f32_16x16x16_bf16 v[216:219], v[138:139], v[168:169], v[216:219]
    v_mfma_f32_16x16x16_bf16 v[220:223], v[138:139], v[174:175], v[220:223]
    v_mfma_f32_16x16x16_bf16 v[224:227], v[140:141], v[168:169], v[224:227]
    v_mfma_f32_16x16x16_bf16 v[228:231], v[140:141], v[174:175], v[228:231]
    v_mfma_f32_16x16x16_bf16 v[232:235], v[142:143], v[168:169], v[232:235]
    v_mfma_f32_16x16x16_bf16 v[236:239], v[142:143], v[174:175], v[236:239]
    v_rcp_f32 v8, v240
    v_rcp_f32 v9, v244
    s_nop 7
    v_mul_f32 v176, v176, v8
    v_mul_f32 v177, v177, v8
    v_mul_f32 v178, v178, v8
    v_mul_f32 v179, v179, v8
    v_cvt_pk_bf16_f32 v16, v176, v177
    v_cvt_pk_bf16_f32 v17, v178, v179
    v_mul_f32 v184, v184, v8
    v_mul_f32 v185, v185, v8
    v_mul_f32 v186, v186, v8
    v_mul_f32 v187, v187, v8
    v_cvt_pk_bf16_f32 v18, v184, v185
    v_cvt_pk_bf16_f32 v19, v186, v187
    s_add_u32 s64, s32, 0x0
    buffer_store_dwordx4 v[16:19], v1, s[4:7], s64 offen offset:0 sc1
    v_mul_f32 v192, v192, v8
    v_mul_f32 v193, v193, v8
    v_mul_f32 v194, v194, v8
    v_mul_f32 v195, v195, v8
    v_cvt_pk_bf16_f32 v20, v192, v193
    v_cvt_pk_bf16_f32 v21, v194, v195
    v_mul_f32 v200, v200, v8
    v_mul_f32 v201, v201, v8
    v_mul_f32 v202, v202, v8
    v_mul_f32 v203, v203, v8
    v_cvt_pk_bf16_f32 v22, v200, v201
    v_cvt_pk_bf16_f32 v23, v202, v203
    s_add_u32 s64, s32, 0x0
    buffer_store_dwordx4 v[20:23], v1, s[4:7], s64 offen offset:1024 sc1
    v_mul_f32 v208, v208, v8
    v_mul_f32 v209, v209, v8
    v_mul_f32 v210, v210, v8
    v_mul_f32 v211, v211, v8
    v_cvt_pk_bf16_f32 v24, v208, v209
    v_cvt_pk_bf16_f32 v25, v210, v211
    v_mul_f32 v216, v216, v8
    v_mul_f32 v217, v217, v8
    v_mul_f32 v218, v218, v8
    v_mul_f32 v219, v219, v8
    v_cvt_pk_bf16_f32 v26, v216, v217
    v_cvt_pk_bf16_f32 v27, v218, v219
    s_add_u32 s64, s32, 0x0
    buffer_store_dwordx4 v[24:27], v1, s[4:7], s64 offen offset:2048 sc1
    v_mul_f32 v224, v224, v8
    v_mul_f32 v225, v225, v8
    v_mul_f32 v226, v226, v8
    v_mul_f32 v227, v227, v8
    v_cvt_pk_bf16_f32 v28, v224, v225
    v_cvt_pk_bf16_f32 v29, v226, v227
    v_mul_f32 v232, v232, v8
    v_mul_f32 v233, v233, v8
    v_mul_f32 v234, v234, v8
    v_mul_f32 v235, v235, v8
    v_cvt_pk_bf16_f32 v30, v232, v233
    v_cvt_pk_bf16_f32 v31, v234, v235
    s_add_u32 s64, s32, 0x0
    buffer_store_dwordx4 v[28:31], v1, s[4:7], s64 offen offset:3072 sc1
    v_mul_f32 v180, v180, v9
    v_mul_f32 v181, v181, v9
    v_mul_f32 v182, v182, v9
    v_mul_f32 v183, v183, v9
    v_cvt_pk_bf16_f32 v32, v180, v181
    v_cvt_pk_bf16_f32 v33, v182, v183
    v_mul_f32 v188, v188, v9
    v_mul_f32 v189, v189, v9
    v_mul_f32 v190, v190, v9
    v_mul_f32 v191, v191, v9
    v_cvt_pk_bf16_f32 v34, v188, v189
    v_cvt_pk_bf16_f32 v35, v190, v191
    s_add_u32 s64, s32, 0x20000
    buffer_store_dwordx4 v[32:35], v1, s[4:7], s64 offen offset:0 sc1
    v_mul_f32 v196, v196, v9
    v_mul_f32 v197, v197, v9
    v_mul_f32 v198, v198, v9
    v_mul_f32 v199, v199, v9
    v_cvt_pk_bf16_f32 v36, v196, v197
    v_cvt_pk_bf16_f32 v37, v198, v199
    v_mul_f32 v204, v204, v9
    v_mul_f32 v205, v205, v9
    v_mul_f32 v206, v206, v9
    v_mul_f32 v207, v207, v9
    v_cvt_pk_bf16_f32 v38, v204, v205
    v_cvt_pk_bf16_f32 v39, v206, v207
    s_add_u32 s64, s32, 0x20000
    buffer_store_dwordx4 v[36:39], v1, s[4:7], s64 offen offset:1024 sc1
    v_mul_f32 v212, v212, v9
    v_mul_f32 v213, v213, v9
    v_mul_f32 v214, v214, v9
    v_mul_f32 v215, v215, v9
    v_cvt_pk_bf16_f32 v40, v212, v213
    v_cvt_pk_bf16_f32 v41, v214, v215
    v_mul_f32 v220, v220, v9
    v_mul_f32 v221, v221, v9
    v_mul_f32 v222, v222, v9
    v_mul_f32 v223, v223, v9
    v_cvt_pk_bf16_f32 v42, v220, v221
    v_cvt_pk_bf16_f32 v43, v222, v223
    s_add_u32 s64, s32, 0x20000
    buffer_store_dwordx4 v[40:43], v1, s[4:7], s64 offen offset:2048 sc1
    v_mul_f32 v228, v228, v9
    v_mul_f32 v229, v229, v9
    v_mul_f32 v230, v230, v9
    v_mul_f32 v231, v231, v9
    v_cvt_pk_bf16_f32 v44, v228, v229
    v_cvt_pk_bf16_f32 v45, v230, v231
    v_mul_f32 v236, v236, v9
    v_mul_f32 v237, v237, v9
    v_mul_f32 v238, v238, v9
    v_mul_f32 v239, v239, v9
    v_cvt_pk_bf16_f32 v46, v236, v237
    v_cvt_pk_bf16_f32 v47, v238, v239
    s_add_u32 s64, s32, 0x20000
    buffer_store_dwordx4 v[44:47], v1, s[4:7], s64 offen offset:3072 sc1
    s_waitcnt vmcnt(0)
    v_mov_b32 v7, 1
    v_mov_b32 v8, 0
    s_mov_b64 exec, 1
    buffer_store_dword v7, v8, s[4:7], s33 offen sc1
    s_mov_b64 exec, -1
    s_add_u32 s24, s24, 8
    s_add_u32 s25, s25, 1
    s_cmp_lt_u32 s25, 8
    s_cbranch_scc1 AT2_LOOP
M_EXIT:
    s_endpgm
.section .rodata,"a"
.p2align 6
.amdhsa_kernel main_kernel
  .amdhsa_next_free_vgpr 512
  .amdhsa_next_free_sgpr 102
  .amdhsa_accum_offset 256
  .amdhsa_group_segment_fixed_size 0
  .amdhsa_kernarg_size 120
  .amdhsa_user_sgpr_count 2
  .amdhsa_user_sgpr_kernarg_segment_ptr 1
  .amdhsa_system_sgpr_workgroup_id_x 1
.end_amdhsa_kernel
```

```asm
; @launch kernel=main_kernel grid=(256,1,1) block=(256,1,1) lds=163840
.amdgcn_target "amdgcn-amd-amdhsa--gfx950"
.text
.globl main_kernel
.p2align 8
.type main_kernel,@function
main_kernel:
    s_cmp_ge_u32 s2, 256
    s_cbranch_scc1 M_EXIT
    s_load_dwordx2 s[4:5], s[0:1], 112
    s_mov_b32 s6, 0x10000000
    s_mov_b32 s7, 0x00020000
    s_load_dwordx2 s[60:61], s[0:1], 104
    s_mov_b32 s62, 256
    s_mov_b32 s63, 0x00020000
    v_lshrrev_b32 v1, 6, v0
    v_and_b32 v0, 63, v0
    s_nop 0
    v_readfirstlane_b32 s14, v1
    s_getreg_b32 s98, hwreg(HW_REG_XCC_ID)
    s_and_b32 s98, s98, 7
    s_mov_b32 s97, 0
    s_mov_b32 s95, 4
    s_waitcnt lgkmcnt(0)
    s_cmp_lg_u32 s14, 0
    s_cbranch_scc1 NOMEAS_1
    s_and_b32 s64, s2, 0xfffffffd
    s_cmp_lg_u32 s64, 1
    s_cbranch_scc1 NOMEAS_1
    s_lshr_b32 s70, s2, 1
    s_mov_b32 s72, s60
    s_mov_b32 s73, s61
    s_mov_b32 s74, s62
    s_mov_b32 s75, s63
    s_lshl_b32 s60, s70, 21
    s_add_u32 s60, s60, 0x6001800
    v_mov_b32 v60, 0
    v_mov_b32 v61, -1
    s_mov_b32 s66, 0x7fffffff
    s_mov_b32 s67, 0x7fffffff
    s_mov_b32 s68, 0x7fffffff
    s_mov_b32 s69, 0x7fffffff
    s_mov_b64 exec, 1
    s_add_u32 s61, s60, 0
    s_memtime s[62:63]
    s_waitcnt lgkmcnt(0)
    buffer_store_dword v61, v60, s[4:7], s61 offen offset:0 sc1
    s_waitcnt vmcnt(0)
    s_memtime s[64:65]
    s_waitcnt lgkmcnt(0)
    s_sub_u32 s62, s64, s62
    s_min_u32 s66, s66, s62
    s_add_u32 s61, s60, 8192
    s_memtime s[62:63]
    s_waitcnt lgkmcnt(0)
    buffer_store_dword v61, v60, s[4:7], s61 offen offset:0 sc1
    s_waitcnt vmcnt(0)
    s_memtime s[64:65]
    s_waitcnt lgkmcnt(0)
    s_sub_u32 s62, s64, s62
    s_min_u32 s67, s67, s62
    s_add_u32 s61, s60, 16384
    s_memtime s[62:63]
    s_waitcnt lgkmcnt(0)
    buffer_store_dword v61, v60, s[4:7], s61 offen offset:0 sc1
    s_waitcnt vmcnt(0)
    s_memtime s[64:65]
    s_waitcnt lgkmcnt(0)
    s_sub_u32 s62, s64, s62
    s_min_u32 s68, s68, s62
    s_add_u32 s61, s60, 24576
    s_memtime s[62:63]
    s_waitcnt lgkmcnt(0)
    buffer_store_dword v61, v60, s[4:7], s61 offen offset:0 sc1
    s_waitcnt vmcnt(0)
    s_memtime s[64:65]
    s_waitcnt lgkmcnt(0)
    s_sub_u32 s62, s64, s62
    s_min_u32 s69, s69, s62
    s_add_u32 s61, s60, 0
    s_memtime s[62:63]
    s_waitcnt lgkmcnt(0)
    buffer_store_dword v61, v60, s[4:7], s61 offen offset:128 sc1
    s_waitcnt vmcnt(0)
    s_memtime s[64:65]
    s_waitcnt lgkmcnt(0)
    s_sub_u32 s62, s64, s62
    s_min_u32 s66, s66, s62
    s_add_u32 s61, s60, 8192
    s_memtime s[62:63]
    s_waitcnt lgkmcnt(0)
    buffer_store_dword v61, v60, s[4:7], s61 offen offset:128 sc1
    s_waitcnt vmcnt(0)
    s_memtime s[64:65]
    s_waitcnt lgkmcnt(0)
    s_sub_u32 s62, s64, s62
    s_min_u32 s67, s67, s62
    s_add_u32 s61, s60, 16384
    s_memtime s[62:63]
    s_waitcnt lgkmcnt(0)
    buffer_store_dword v61, v60, s[4:7], s61 offen offset:128 sc1
    s_waitcnt vmcnt(0)
    s_memtime s[64:65]
    s_waitcnt lgkmcnt(0)
    s_sub_u32 s62, s64, s62
    s_min_u32 s68, s68, s62
    s_add_u32 s61, s60, 24576
    s_memtime s[62:63]
    s_waitcnt lgkmcnt(0)
    buffer_store_dword v61, v60, s[4:7], s61 offen offset:128 sc1
    s_waitcnt vmcnt(0)
    s_memtime s[64:65]
    s_waitcnt lgkmcnt(0)
    s_sub_u32 s62, s64, s62
    s_min_u32 s69, s69, s62
    s_mov_b64 exec, -1
    s_mov_b32 s60, 0
    s_mov_b32 s61, s66
    s_cmp_lt_u32 s67, s61
    s_cselect_b32 s60, 1, s60
    s_min_u32 s61, s61, s67
    s_cmp_lt_u32 s68, s61
    s_cselect_b32 s60, 2, s60
    s_min_u32 s61, s61, s68
    s_cmp_lt_u32 s69, s61
    s_cselect_b32 s60, 3, s60
    s_min_u32 s61, s61, s69
    s_and_b32 s61, s98, 1
    s_lshl_b32 s61, s61, 1
    s_lshr_b32 s62, s98, 2
    s_add_u32 s61, s61, s62
    s_xor_b32 s60, s60, s61
    s_add_u32 s71, s60, 1
    s_mov_b32 s60, s72
    s_mov_b32 s61, s73
    s_mov_b32 s62, s74
    s_mov_b32 s63, s75
    s_lshl_b32 s70, s70, 2
    s_add_u32 s70, s70, 132
    v_mov_b32 v61, s71
    s_mov_b64 exec, 1
    buffer_store_dword v61, off, s[60:63], s70 sc1
    s_mov_b64 exec, -1
NOMEAS_1:
    s_cmp_lg_u32 s14, 0
    s_cbranch_scc1 M_TICKW
    s_mul_i32 s64, s98, 32
    s_add_u32 s64, s64, 0x0
    v_mov_b32 v1, 0
    v_mov_b32 v2, 1
    s_mov_b64 exec, 1
    buffer_atomic_add v2, v1, s[60:63], s64 offen sc0
    s_waitcnt vmcnt(0)
    ds_write_b32 v1, v2
    s_waitcnt lgkmcnt(0)
    s_mov_b64 exec, -1
M_TICKW:
    s_barrier
    v_mov_b32 v1, 0
    ds_read_b32 v2, v1
    s_waitcnt lgkmcnt(0)
    v_readfirstlane_b32 s99, v2
    s_barrier
    s_cmp_ge_u32 s99, 32
    s_cbranch_scc1 M_SLOW0
    s_mov_b32 s12, s98
    s_cmp_eq_u32 s12, 0
    s_cbranch_scc1 XOK_2
    s_cmp_eq_u32 s12, 2
    s_cbranch_scc0 M_FH
    s_mov_b32 s12, 1
XOK_2:
    s_mov_b32 s13, s99
    s_branch M_REC
M_FH:
    s_sub_u32 s96, s98, 1
    s_cmp_gt_u32 s98, 2
    s_cselect_b32 s64, 1, 0
    s_sub_u32 s96, s96, s64
    s_lshl_b32 s96, s96, 5
    s_add_u32 s96, s96, s99
    s_branch M_HELP
M_SLOW0:
    v_mbcnt_lo_u32_b32 v0, -1, 0
    v_mbcnt_hi_u32_b32 v0, -1, v0
    v_mul_u32_u24 v8, 32, v0
    s_mov_b32 s64, 0x0
    s_mov_b32 s65, 0
    s_mov_b64 exec, 0xff
TK_3:
    buffer_load_dword v9, v8, s[60:63], s64 offen sc1
    s_add_u32 s65, s65, 1
    s_waitcnt vmcnt(0)
    s_mov_b32 s66, 0
    v_readlane_b32 s67, v9, 0
    s_add_u32 s66, s66, s67
    v_readlane_b32 s67, v9, 1
    s_add_u32 s66, s66, s67
    v_readlane_b32 s67, v9, 2
    s_add_u32 s66, s66, s67
    v_readlane_b32 s67, v9, 3
    s_add_u32 s66, s66, s67
    v_readlane_b32 s67, v9, 4
    s_add_u32 s66, s66, s67
    v_readlane_b32 s67, v9, 5
    s_add_u32 s66, s66, s67
    v_readlane_b32 s67, v9, 6
    s_add_u32 s66, s66, s67
    v_readlane_b32 s67, v9, 7
    s_add_u32 s66, s66, s67
    s_cmp_ge_u32 s66, 256
    s_cbranch_scc1 TKD_4
    s_cmp_gt_u32 s65, 262144
    s_cbranch_scc0 TK_3
TKD_4:
    v_cmp_ne_u32 vcc, 32, v9
    s_mov_b64 exec, -1
M_SLOW:
    s_waitcnt vmcnt(0) lgkmcnt(0)
    s_barrier
    s_cmp_lg_u32 s14, 0
    s_cbranch_scc1 M_SLOWB
    v_mov_b32 v8, 1
    s_mov_b64 exec, 1
    buffer_atomic_add v8, off, s[60:63], 12 sc1
    s_mov_b64 exec, -1
M_SLOWB:
    s_mov_b32 s95, 12
    s_mov_b32 s65, 0
SB_5:
    buffer_load_dword v8, off, s[60:63], s95 sc1
    s_add_u32 s65, s65, 1
    s_waitcnt vmcnt(0)
    v_readfirstlane_b32 s64, v8
    s_cmp_ge_u32 s64, 256
    s_cbranch_scc1 SBD_6
    s_cmp_gt_u32 s65, 65536
    s_cbranch_scc1 SBD_6
    s_sleep 4
    s_branch SB_5
SBD_6:
    s_mov_b32 s95, 8
    s_mov_b32 s97, 1
    s_cmp_lt_u32 s2, 64
    s_cbranch_scc0 M_SH
    s_lshr_b32 s12, s2, 5
    s_and_b32 s13, s2, 31
    s_branch M_REC
M_SH:
    s_sub_u32 s96, s2, 64
    s_branch M_HELP
M_REC:
    v_mbcnt_lo_u32_b32 v0, -1, 0
    v_mbcnt_hi_u32_b32 v0, -1, v0
    s_load_dwordx2 s[44:45], s[0:1], 16
    s_mov_b32 s46, 0x500000
    s_mov_b32 s47, 0x00020000
    s_load_dwordx2 s[48:49], s[0:1], 24
    s_mov_b32 s50, 0x500000
    s_mov_b32 s51, 0x00020000
    s_load_dwordx2 s[52:53], s[0:1], 32
    s_mov_b32 s54, 0x500000
    s_mov_b32 s55, 0x00020000
    s_load_dwordx2 s[56:57], s[0:1], 40
    s_mov_b32 s58, 0x500000
    s_mov_b32 s59, 0x00020000
    s_waitcnt lgkmcnt(0)
    v_and_b32 v0, 63, v0
    v_lshlrev_b32 v1, 4, v0
    s_mul_i32 s64, s14, 36864
    s_add_u32 s64, s64, 16384
    v_add_u32 v2, s64, v1
    v_bfe_u32 v8, v0, 4, 1
    v_mul_u32_u24 v8, 1152, v8
    v_lshrrev_b32 v9, 5, v0
    v_lshlrev_b32 v9, 4, v9
    v_and_b32 v10, 15, v0
    v_add_u32 v9, v9, v10
    s_lshl_b32 s64, s14, 5
    v_add_u32 v9, s64, v9
    v_lshl_add_u32 v8, v9, 3, v8
    v_add_u32 v3, 8192, v8
    v_and_b32 v8, 1, v0
    v_mul_u32_u24 v8, 1152, v8
    v_lshrrev_b32 v9, 4, v0
    v_lshlrev_b32 v9, 2, v9
    v_bfe_u32 v10, v0, 2, 2
    v_add_u32 v9, v9, v10
    v_lshl_add_u32 v8, v9, 3, v8
    v_add_u32 v4, 8192, v8
    v_and_b32 v8, 7, v0
    v_mul_u32_u24 v8, 288, v8
    v_bfe_u32 v9, v0, 3, 1
    v_lshl_add_u32 v8, v9, 5, v8
    v_lshrrev_b32 v9, 4, v0
    v_lshl_add_u32 v8, v9, 3, v8
    s_lshl_b32 s64, s14, 6
    s_add_u32 s64, s64, 12800
    v_add_u32 v5, s64, v8
    s_mov_b32 s32, 0x00ff00ff
    s_mov_b32 s33, 0x00ff00ff
    s_mov_b32 s34, -1
    s_mov_b32 s35, 0
    s_mov_b32 s36, 0x00010001
    s_mov_b32 s37, 0x00010001
    v_mov_b32 v8, 0xeeee
    v_mov_b32 v9, 0x4444
    v_cndmask_b32 v6, v8, v9, s[32:33]
    v_lshrrev_b32 v8, 5, v0
    v_lshlrev_b32 v8, 13, v8
    v_bfe_u32 v9, v0, 3, 1
    v_lshl_add_u32 v8, v9, 12, v8
    v_and_b32 v9, 7, v0
    v_lshl_add_u32 v8, v9, 4, v8
    v_bfe_u32 v9, v0, 4, 1
    v_lshl_add_u32 v7, v9, 3, v8
    s_mov_b32 s10, 0x3e0293ee
    s_mov_b32 s11, 0x3e0293ee
    s_cmp_eq_u32 s14, 0
    s_cselect_b32 s42, 1, 0
    s_cmp_ge_u32 s13, 24
    s_cselect_b32 s65, 1, 0
    s_cmp_eq_u32 s14, 1
    s_cselect_b32 s65, s65, 0
    s_or_b32 s42, s42, s65
    s_lshl_b32 s65, s65, 3
    s_add_u32 s64, s13, s65
    s_cmp_eq_u32 s64, 39
    s_cselect_b32 s22, s42, 0
    s_mul_i32 s24, s12, 163840
    s_add_u32 s24, s24, 0x300000
    s_lshl_b32 s67, s13, 7
    s_add_u32 s26, s24, s67
    s_lshl_b32 s67, s14, 14
    s_add_u32 s23, s26, s67
    s_add_u32 s25, s23, 0x10000
    s_lshl_b32 s67, s14, 13
    s_add_u32 s26, s26, s67
    s_add_u32 s26, s26, 0x20000
    s_lshl_b32 s67, s64, 12
    s_add_u32 s24, s24, s67
    s_lshl_b32 s64, s64, 7
    s_lshl_b32 s65, s12, 13
    s_add_u32 s17, s65, 0x5900000
    s_add_u32 s18, s17, s64
    s_lshl_b32 s65, s12, 21
    s_add_u32 s66, s65, 0x6000000
    s_add_u32 s21, s66, s64
    s_xor_b32 s65, s65, 0x200000
    s_add_u32 s20, s65, 0x5ff8000
    s_and_b32 s64, s13, 1
    s_cmp_eq_u32 s64, s12
    s_cselect_b32 s43, 1, 0
    s_mov_b32 s43, 0
    s_lshl_b32 s64, s13, 4
    s_add_u32 s69, s64, 0x291000
    s_lshl_b32 s64, s13, 2
    s_add_u32 s70, s64, 0x294000
    s_lshl_b32 s64, s13, 14
    s_lshl_b32 s73, s14, 11
    s_lshl_b32 s65, s14, 12
    s_add_u32 s65, s65, s64
    s_add_u32 s3, s65, 0x1500000
    s_add_u32 s64, s64, s73
    s_add_u32 s28, s64, 0x1400000
    s_add_u32 s29, s64, 0x1402000
    s_lshl_b32 s64, s13, 11
    s_add_u32 s30, s64, 0x640000
    s_lshl_b32 s64, s13, 12
    s_lshl_b32 s65, s14, 10
    s_add_u32 s64, s64, s65
    s_add_u32 s31, s64, 0xa40000
    s_mul_i32 s40, s14, 36864
    s_add_u32 s40, s40, 16384
    v_bfe_u32 v95, v0, 2, 2
    v_lshlrev_b32 v88, 15, v95
    v_lshrrev_b32 v95, 5, v0
    v_lshl_add_u32 v88, v95, 14, v88
    v_bfe_u32 v95, v0, 4, 1
    v_lshl_add_u32 v88, v95, 13, v88
    v_lshlrev_b32 v95, 1, v95
    v_and_b32 v8, 3, v0
    v_xor_b32 v95, v95, v8
    v_lshl_add_u32 v88, v95, 4, v88
    v_bfe_u32 v95, v0, 2, 1
    v_mov_b32 v8, v95
    v_bfe_u32 v95, v0, 3, 1
    v_lshl_add_u32 v8, v95, 2, v8
    v_bfe_u32 v95, v0, 4, 1
    v_lshl_add_u32 v8, v95, 1, v8
    v_bfe_u32 v95, v0, 5, 1
    v_lshl_add_u32 v8, v95, 3, v8
    v_mul_u32_u24 v8, 1280, v8
    v_and_b32 v95, 3, v0
    v_lshl_add_u32 v89, v95, 4, v8
    v_lshrrev_b32 v95, 1, v0
    v_mul_u32_u24 v8, 1280, v95
    v_and_b32 v95, 1, v0
    v_lshl_add_u32 v90, v95, 4, v8
    v_lshrrev_b32 v95, 5, v0
    v_lshlrev_b32 v91, 10, v95
    v_bfe_u32 v95, v0, 2, 1
    v_lshl_add_u32 v91, v95, 8, v91
    v_bfe_u32 v95, v0, 4, 1
    v_lshl_add_u32 v91, v95, 6, v91
    v_bfe_u32 v95, v0, 3, 1
    v_lshl_add_u32 v91, v95, 7, v91
    v_and_b32 v95, 1, v0
    v_lshl_add_u32 v91, v95, 3, v91
    v_bfe_u32 v95, v0, 1, 1
    v_lshl_add_u32 v91, v95, 4, v91
    v_add_u32 v91, s40, v91
    v_bfe_u32 v95, v0, 2, 1
    v_lshlrev_b32 v95, 5, v95
    v_sub_u32 v92, 32, v95
    v_add_u32 v92, v92, v91
    v_add_u32 v91, v91, v95
    v_lshrrev_b32 v95, 5, v0
    v_lshlrev_b32 v93, 9, v95
    v_bfe_u32 v95, v0, 4, 1
    v_lshl_add_u32 v93, v95, 7, v93
    v_bfe_u32 v95, v0, 2, 1
    v_lshl_add_u32 v93, v95, 6, v93
    v_bfe_u32 v95, v0, 3, 1
    v_lshl_add_u32 v93, v95, 5, v93
    v_and_b32 v95, 3, v0
    v_lshl_add_u32 v93, v95, 3, v93
    v_add_u32 v93, s40, v93
    v_lshrrev_b32 v95, 4, v0
    v_lshlrev_b32 v94, 8, v95
    v_bfe_u32 v95, v0, 2, 2
    v_lshl_add_u32 v94, v95, 5, v94
    v_and_b32 v95, 3, v0
    v_lshl_add_u32 v94, v95, 3, v94
    v_add_u32 v94, s40, v94
    s_lshl_b32 s64, s13, 8
    s_lshl_b32 s65, s14, 6
    s_add_u32 s64, s64, s65
    s_mul_i32 s65, s12, 2621440
    s_add_u32 s71, s64, s65
    s_sub_u32 s65, 2621440, s65
    s_add_u32 s72, s64, s65
    s_mul_i32 s39, s13, 163840
    s_mul_i32 s64, s12, 640
    s_add_u32 s39, s39, s64
    s_lshl_b32 s64, s14, 5
    s_add_u32 s41, s39, s64
    s_add_u32 s41, s41, 0x200
    s_lshl_b32 s64, s14, 6
    s_add_u32 s39, s39, s64
    s_add_u32 m0, s40, 0
    s_add_u32 s64, s71, 0x0
    buffer_load_dwordx4 v88, s[44:47], s64 offen lds
    s_add_u32 m0, s40, 1024
    s_add_u32 s64, s71, 0x20000
    buffer_load_dwordx4 v88, s[44:47], s64 offen lds
    s_add_u32 m0, s40, 2048
    s_add_u32 s64, s71, 0x40000
    buffer_load_dwordx4 v88, s[44:47], s64 offen lds
    s_add_u32 m0, s40, 3072
    s_add_u32 s64, s71, 0x60000
    buffer_load_dwordx4 v88, s[44:47], s64 offen lds
    s_add_u32 m0, s40, 4096
    s_add_u32 s64, s71, 0x80000
    buffer_load_dwordx4 v88, s[44:47], s64 offen lds
    s_add_u32 m0, s40, 5120
    s_add_u32 s64, s71, 0xa0000
    buffer_load_dwordx4 v88, s[44:47], s64 offen lds
    s_add_u32 m0, s40, 6144
    s_add_u32 s64, s71, 0xc0000
    buffer_load_dwordx4 v88, s[44:47], s64 offen lds
    s_add_u32 m0, s40, 7168
    s_add_u32 s64, s71, 0xe0000
    buffer_load_dwordx4 v88, s[44:47], s64 offen lds
    s_add_u32 m0, s40, 8192
    s_add_u32 s64, s71, 0x100000
    buffer_load_dwordx4 v88, s[44:47], s64 offen lds
    s_add_u32 m0, s40, 9216
    s_add_u32 s64, s71, 0x120000
    buffer_load_dwordx4 v88, s[44:47], s64 offen lds
    s_add_u32 m0, s40, 10240
    s_add_u32 s64, s71, 0x140000
    buffer_load_dwordx4 v88, s[44:47], s64 offen lds
    s_add_u32 m0, s40, 11264
    s_add_u32 s64, s71, 0x160000
    buffer_load_dwordx4 v88, s[44:47], s64 offen lds
    s_add_u32 m0, s40, 12288
    s_add_u32 s64, s71, 0x180000
    buffer_load_dwordx4 v88, s[44:47], s64 offen lds
    s_add_u32 m0, s40, 13312
    s_add_u32 s64, s71, 0x1a0000
    buffer_load_dwordx4 v88, s[44:47], s64 offen lds
    s_add_u32 m0, s40, 14336
    s_add_u32 s64, s71, 0x1c0000
    buffer_load_dwordx4 v88, s[44:47], s64 offen lds
    s_add_u32 m0, s40, 15360
    s_add_u32 s64, s71, 0x1e0000
    buffer_load_dwordx4 v88, s[44:47], s64 offen lds
    s_add_u32 m0, s40, 16384
    s_add_u32 s64, s71, 0x200000
    buffer_load_dwordx4 v88, s[44:47], s64 offen lds
    s_add_u32 m0, s40, 17408
    s_add_u32 s64, s71, 0x220000
    buffer_load_dwordx4 v88, s[44:47], s64 offen lds
    s_add_u32 m0, s40, 18432
    s_add_u32 s64, s71, 0x240000
    buffer_load_dwordx4 v88, s[44:47], s64 offen lds
    s_add_u32 m0, s40, 19456
    s_add_u32 s64, s71, 0x260000
    buffer_load_dwordx4 v88, s[44:47], s64 offen lds
    s_add_u32 m0, s40, 20480
    s_add_u32 s64, s72, 0x0
    buffer_load_dwordx4 v88, s[44:47], s64 offen lds
    s_add_u32 m0, s40, 21504
    s_add_u32 s64, s72, 0x20000
    buffer_load_dwordx4 v88, s[44:47], s64 offen lds
    s_add_u32 m0, s40, 22528
    s_add_u32 s64, s72, 0x40000
    buffer_load_dwordx4 v88, s[44:47], s64 offen lds
    s_add_u32 m0, s40, 23552
    s_add_u32 s64, s72, 0x60000
    buffer_load_dwordx4 v88, s[44:47], s64 offen lds
    s_add_u32 m0, s40, 24576
    s_add_u32 s64, s72, 0x80000
    buffer_load_dwordx4 v88, s[44:47], s64 offen lds
    s_add_u32 m0, s40, 25600
    s_add_u32 s64, s72, 0xa0000
    buffer_load_dwordx4 v88, s[44:47], s64 offen lds
    s_add_u32 m0, s40, 26624
    s_add_u32 s64, s72, 0xc0000
    buffer_load_dwordx4 v88, s[44:47], s64 offen lds
    s_add_u32 m0, s40, 27648
    s_add_u32 s64, s72, 0xe0000
    buffer_load_dwordx4 v88, s[44:47], s64 offen lds
    s_add_u32 m0, s40, 28672
    s_add_u32 s64, s72, 0x100000
    buffer_load_dwordx4 v88, s[44:47], s64 offen lds
    s_add_u32 m0, s40, 29696
    s_add_u32 s64, s72, 0x120000
    buffer_load_dwordx4 v88, s[44:47], s64 offen lds
    s_add_u32 m0, s40, 30720
    s_add_u32 s64, s72, 0x140000
    buffer_load_dwordx4 v88, s[44:47], s64 offen lds
    s_add_u32 m0, s40, 31744
    s_add_u32 s64, s72, 0x160000
    buffer_load_dwordx4 v88, s[44:47], s64 offen lds
    s_add_u32 m0, s40, 32768
    s_add_u32 s64, s72, 0x180000
    buffer_load_dwordx4 v88, s[44:47], s64 offen lds
    s_add_u32 m0, s40, 33792
    s_add_u32 s64, s72, 0x1a0000
    buffer_load_dwordx4 v88, s[44:47], s64 offen lds
    s_add_u32 m0, s40, 34816
    s_add_u32 s64, s72, 0x1c0000
    buffer_load_dwordx4 v88, s[44:47], s64 offen lds
    s_add_u32 m0, s40, 35840
    s_add_u32 s64, s72, 0x1e0000
    buffer_load_dwordx4 v88, s[44:47], s64 offen lds
    s_waitcnt vmcnt(32)
    ds_read_b64_tr_b16 v[96:97], v91 offset:0
    ds_read_b64_tr_b16 v[98:99], v91 offset:512
    ds_read_b64_tr_b16 v[100:101], v91 offset:2048
    ds_read_b64_tr_b16 v[102:103], v91 offset:2560
    ds_read_b64_tr_b16 v[104:105], v92 offset:0
    ds_read_b64_tr_b16 v[106:107], v92 offset:512
    ds_read_b64_tr_b16 v[108:109], v92 offset:2048
    ds_read_b64_tr_b16 v[110:111], v92 offset:2560
    s_waitcnt lgkmcnt(0)
    s_add_u32 m0, s40, 0
    s_add_u32 s64, s72, 0x200000
    buffer_load_dwordx4 v88, s[44:47], s64 offen lds
    s_add_u32 m0, s40, 1024
    s_add_u32 s64, s72, 0x220000
    buffer_load_dwordx4 v88, s[44:47], s64 offen lds
    s_add_u32 m0, s40, 2048
    s_add_u32 s64, s72, 0x240000
    buffer_load_dwordx4 v88, s[44:47], s64 offen lds
    s_add_u32 m0, s40, 3072
    s_add_u32 s64, s72, 0x260000
    buffer_load_dwordx4 v88, s[44:47], s64 offen lds
    s_waitcnt vmcnt(32)
    ds_read_b64_tr_b16 v[112:113], v91 offset:4096
    ds_read_b64_tr_b16 v[114:115], v91 offset:4608
    ds_read_b64_tr_b16 v[116:117], v91 offset:6144
    ds_read_b64_tr_b16 v[118:119], v91 offset:6656
    ds_read_b64_tr_b16 v[120:121], v92 offset:4096
    ds_read_b64_tr_b16 v[122:123], v92 offset:4608
    ds_read_b64_tr_b16 v[124:125], v92 offset:6144
    ds_read_b64_tr_b16 v[126:127], v92 offset:6656
    s_waitcnt lgkmcnt(0)
    s_add_u32 m0, s40, 4096
    s_add_u32 s64, s72, 0x200000
    buffer_load_dwordx4 v88, s[48:51], s64 offen lds
    s_add_u32 m0, s40, 5120
    s_add_u32 s64, s72, 0x220000
    buffer_load_dwordx4 v88, s[48:51], s64 offen lds
    s_add_u32 m0, s40, 6144
    s_add_u32 s64, s72, 0x240000
    buffer_load_dwordx4 v88, s[48:51], s64 offen lds
    s_add_u32 m0, s40, 7168
    s_add_u32 s64, s72, 0x260000
    buffer_load_dwordx4 v88, s[48:51], s64 offen lds
    s_waitcnt vmcnt(32)
    ds_read_b64_tr_b16 v[128:129], v91 offset:8192
    ds_read_b64_tr_b16 v[130:131], v91 offset:8704
    ds_read_b64_tr_b16 v[132:133], v91 offset:10240
    ds_read_b64_tr_b16 v[134:135], v91 offset:10752
    ds_read_b64_tr_b16 v[136:137], v92 offset:8192
    ds_read_b64_tr_b16 v[138:139], v92 offset:8704
    ds_read_b64_tr_b16 v[140:141], v92 offset:10240
    ds_read_b64_tr_b16 v[142:143], v92 offset:10752
    s_waitcnt lgkmcnt(0)
    s_add_u32 m0, s40, 8192
    s_add_u32 s64, s71, 0x0
    buffer_load_dwordx4 v88, s[52:55], s64 offen lds
    s_add_u32 m0, s40, 9216
    s_add_u32 s64, s71, 0x20000
    buffer_load_dwordx4 v88, s[52:55], s64 offen lds
    s_add_u32 m0, s40, 10240
    s_add_u32 s64, s71, 0x40000
    buffer_load_dwordx4 v88, s[52:55], s64 offen lds
    s_add_u32 m0, s40, 11264
    s_add_u32 s64, s71, 0x60000
    buffer_load_dwordx4 v88, s[52:55], s64 offen lds
    s_waitcnt vmcnt(32)
    ds_read_b64_tr_b16 v[144:145], v91 offset:12288
    ds_read_b64_tr_b16 v[146:147], v91 offset:12800
    ds_read_b64_tr_b16 v[148:149], v91 offset:14336
    ds_read_b64_tr_b16 v[150:151], v91 offset:14848
    ds_read_b64_tr_b16 v[152:153], v92 offset:12288
    ds_read_b64_tr_b16 v[154:155], v92 offset:12800
    ds_read_b64_tr_b16 v[156:157], v92 offset:14336
    ds_read_b64_tr_b16 v[158:159], v92 offset:14848
    s_waitcnt lgkmcnt(0)
    s_add_u32 m0, s40, 12288
    s_add_u32 s64, s71, 0x80000
    buffer_load_dwordx4 v88, s[52:55], s64 offen lds
    s_add_u32 m0, s40, 13312
    s_add_u32 s64, s71, 0xa0000
    buffer_load_dwordx4 v88, s[52:55], s64 offen lds
    s_add_u32 m0, s40, 14336
    s_add_u32 s64, s71, 0xc0000
    buffer_load_dwordx4 v88, s[52:55], s64 offen lds
    s_add_u32 m0, s40, 15360
    s_add_u32 s64, s71, 0xe0000
    buffer_load_dwordx4 v88, s[52:55], s64 offen lds
    s_waitcnt vmcnt(32)
    ds_read_b64_tr_b16 v[160:161], v91 offset:16384
    ds_read_b64_tr_b16 v[162:163], v91 offset:16896
    ds_read_b64_tr_b16 v[164:165], v91 offset:18432
    ds_read_b64_tr_b16 v[166:167], v91 offset:18944
    ds_read_b64_tr_b16 v[168:169], v92 offset:16384
    ds_read_b64_tr_b16 v[170:171], v92 offset:16896
    ds_read_b64_tr_b16 v[172:173], v92 offset:18432
    ds_read_b64_tr_b16 v[174:175], v92 offset:18944
    s_waitcnt lgkmcnt(0)
    s_add_u32 m0, s40, 16384
    s_add_u32 s64, s71, 0x100000
    buffer_load_dwordx4 v88, s[52:55], s64 offen lds
    s_add_u32 m0, s40, 17408
    s_add_u32 s64, s71, 0x120000
    buffer_load_dwordx4 v88, s[52:55], s64 offen lds
    s_add_u32 m0, s40, 18432
    s_add_u32 s64, s71, 0x140000
    buffer_load_dwordx4 v88, s[52:55], s64 offen lds
    s_add_u32 m0, s40, 19456
    s_add_u32 s64, s71, 0x160000
    buffer_load_dwordx4 v88, s[52:55], s64 offen lds
    s_waitcnt vmcnt(32)
    ds_read_b64_tr_b16 v[176:177], v91 offset:20480
    ds_read_b64_tr_b16 v[178:179], v91 offset:20992
    ds_read_b64_tr_b16 v[180:181], v91 offset:22528
    ds_read_b64_tr_b16 v[182:183], v91 offset:23040
    ds_read_b64_tr_b16 v[184:185], v92 offset:20480
    ds_read_b64_tr_b16 v[186:187], v92 offset:20992
    ds_read_b64_tr_b16 v[188:189], v92 offset:22528
    ds_read_b64_tr_b16 v[190:191], v92 offset:23040
    s_waitcnt lgkmcnt(0)
    s_add_u32 m0, s40, 20480
    s_add_u32 s64, s71, 0x180000
    buffer_load_dwordx4 v88, s[52:55], s64 offen lds
    s_add_u32 m0, s40, 21504
    s_add_u32 s64, s71, 0x1a0000
    buffer_load_dwordx4 v88, s[52:55], s64 offen lds
    s_add_u32 m0, s40, 22528
    s_add_u32 s64, s71, 0x1c0000
    buffer_load_dwordx4 v88, s[52:55], s64 offen lds
    s_add_u32 m0, s40, 23552
    s_add_u32 s64, s71, 0x1e0000
    buffer_load_dwordx4 v88, s[52:55], s64 offen lds
    s_waitcnt vmcnt(32)
    ds_read_b64_tr_b16 v[192:193], v91 offset:24576
    ds_read_b64_tr_b16 v[194:195], v91 offset:25088
    ds_read_b64_tr_b16 v[196:197], v91 offset:26624
    ds_read_b64_tr_b16 v[198:199], v91 offset:27136
    ds_read_b64_tr_b16 v[200:201], v92 offset:24576
    ds_read_b64_tr_b16 v[202:203], v92 offset:25088
    ds_read_b64_tr_b16 v[204:205], v92 offset:26624
    ds_read_b64_tr_b16 v[206:207], v92 offset:27136
    s_waitcnt lgkmcnt(0)
    s_add_u32 m0, s40, 24576
    s_add_u32 s64, s71, 0x200000
    buffer_load_dwordx4 v88, s[52:55], s64 offen lds
    s_add_u32 m0, s40, 25600
    s_add_u32 s64, s71, 0x220000
    buffer_load_dwordx4 v88, s[52:55], s64 offen lds
    s_add_u32 m0, s40, 26624
    s_add_u32 s64, s71, 0x240000
    buffer_load_dwordx4 v88, s[52:55], s64 offen lds
    s_add_u32 m0, s40, 27648
    s_add_u32 s64, s71, 0x260000
    buffer_load_dwordx4 v88, s[52:55], s64 offen lds
    s_waitcnt vmcnt(32)
    ds_read_b64_tr_b16 v[208:209], v91 offset:28672
    ds_read_b64_tr_b16 v[210:211], v91 offset:29184
    ds_read_b64_tr_b16 v[212:213], v91 offset:30720
    ds_read_b64_tr_b16 v[214:215], v91 offset:31232
    ds_read_b64_tr_b16 v[216:217], v92 offset:28672
    ds_read_b64_tr_b16 v[218:219], v92 offset:29184
    ds_read_b64_tr_b16 v[220:221], v92 offset:30720
    ds_read_b64_tr_b16 v[222:223], v92 offset:31232
    s_waitcnt lgkmcnt(0)
    s_add_u32 m0, s40, 28672
    s_add_u32 s64, s72, 0x0
    buffer_load_dwordx4 v88, s[52:55], s64 offen lds
    s_add_u32 m0, s40, 29696
    s_add_u32 s64, s72, 0x20000
    buffer_load_dwordx4 v88, s[52:55], s64 offen lds
    s_add_u32 m0, s40, 30720
    s_add_u32 s64, s72, 0x40000
    buffer_load_dwordx4 v88, s[52:55], s64 offen lds
    s_add_u32 m0, s40, 31744
    s_add_u32 s64, s72, 0x60000
    buffer_load_dwordx4 v88, s[52:55], s64 offen lds
    s_waitcnt vmcnt(32)
    ds_read_b64_tr_b16 v[224:225], v91 offset:32768
    ds_read_b64_tr_b16 v[226:227], v91 offset:33280
    ds_read_b64_tr_b16 v[228:229], v91 offset:34816
    ds_read_b64_tr_b16 v[230:231], v91 offset:35328
    ds_read_b64_tr_b16 v[232:233], v92 offset:32768
    ds_read_b64_tr_b16 v[234:235], v92 offset:33280
    ds_read_b64_tr_b16 v[236:237], v92 offset:34816
    ds_read_b64_tr_b16 v[238:239], v92 offset:35328
    s_waitcnt lgkmcnt(0)
    s_add_u32 m0, s40, 32768
    s_add_u32 s64, s72, 0x80000
    buffer_load_dwordx4 v88, s[52:55], s64 offen lds
    s_add_u32 m0, s40, 33792
    s_add_u32 s64, s72, 0xa0000
    buffer_load_dwordx4 v88, s[52:55], s64 offen lds
    s_add_u32 m0, s40, 34816
    s_add_u32 s64, s72, 0xc0000
    buffer_load_dwordx4 v88, s[52:55], s64 offen lds
    s_add_u32 m0, s40, 35840
    s_add_u32 s64, s72, 0xe0000
    buffer_load_dwordx4 v88, s[52:55], s64 offen lds
    s_waitcnt vmcnt(32)
    ds_read_b64_tr_b16 v[240:241], v91 offset:0
    ds_read_b64_tr_b16 v[242:243], v91 offset:512
    ds_read_b64_tr_b16 v[244:245], v91 offset:2048
    ds_read_b64_tr_b16 v[246:247], v91 offset:2560
    ds_read_b64_tr_b16 v[248:249], v92 offset:0
    ds_read_b64_tr_b16 v[250:251], v92 offset:512
    ds_read_b64_tr_b16 v[252:253], v92 offset:2048
    ds_read_b64_tr_b16 v[254:255], v92 offset:2560
    s_waitcnt lgkmcnt(0)
    s_add_u32 m0, s40, 0
    s_add_u32 s64, s72, 0x100000
    buffer_load_dwordx4 v88, s[52:55], s64 offen lds
    s_add_u32 m0, s40, 1024
    s_add_u32 s64, s72, 0x120000
    buffer_load_dwordx4 v88, s[52:55], s64 offen lds
    s_add_u32 m0, s40, 2048
    s_add_u32 s64, s72, 0x140000
    buffer_load_dwordx4 v88, s[52:55], s64 offen lds
    s_add_u32 m0, s40, 3072
    s_add_u32 s64, s72, 0x160000
    buffer_load_dwordx4 v88, s[52:55], s64 offen lds
    s_waitcnt vmcnt(32)
    ds_read_b64_tr_b16 a[240:241], v91 offset:4096
    ds_read_b64_tr_b16 a[242:243], v91 offset:4608
    ds_read_b64_tr_b16 a[244:245], v91 offset:6144
    ds_read_b64_tr_b16 a[246:247], v91 offset:6656
    ds_read_b64_tr_b16 a[248:249], v92 offset:4096
    ds_read_b64_tr_b16 a[250:251], v92 offset:4608
    ds_read_b64_tr_b16 a[252:253], v92 offset:6144
    ds_read_b64_tr_b16 a[254:255], v92 offset:6656
    s_waitcnt lgkmcnt(0)
    s_add_u32 m0, s40, 4096
    s_add_u32 s64, s72, 0x180000
    buffer_load_dwordx4 v88, s[52:55], s64 offen lds
    s_add_u32 m0, s40, 5120
    s_add_u32 s64, s72, 0x1a0000
    buffer_load_dwordx4 v88, s[52:55], s64 offen lds
    s_add_u32 m0, s40, 6144
    s_add_u32 s64, s72, 0x1c0000
    buffer_load_dwordx4 v88, s[52:55], s64 offen lds
    s_add_u32 m0, s40, 7168
    s_add_u32 s64, s72, 0x1e0000
    buffer_load_dwordx4 v88, s[52:55], s64 offen lds
    s_waitcnt vmcnt(32)
    ds_read_b64_tr_b16 a[0:1], v91 offset:8192
    ds_read_b64_tr_b16 a[2:3], v91 offset:8704
    ds_read_b64_tr_b16 a[4:5], v91 offset:10240
    ds_read_b64_tr_b16 a[6:7], v91 offset:10752
    ds_read_b64_tr_b16 a[8:9], v92 offset:8192
    ds_read_b64_tr_b16 a[10:11], v92 offset:8704
    ds_read_b64_tr_b16 a[12:13], v92 offset:10240
    ds_read_b64_tr_b16 a[14:15], v92 offset:10752
    s_waitcnt lgkmcnt(0)
    s_add_u32 m0, s40, 8192
    s_add_u32 s64, s72, 0x200000
    buffer_load_dwordx4 v88, s[52:55], s64 offen lds
    s_add_u32 m0, s40, 9216
    s_add_u32 s64, s72, 0x220000
    buffer_load_dwordx4 v88, s[52:55], s64 offen lds
    s_add_u32 m0, s40, 10240
    s_add_u32 s64, s72, 0x240000
    buffer_load_dwordx4 v88, s[52:55], s64 offen lds
    s_add_u32 m0, s40, 11264
    s_add_u32 s64, s72, 0x260000
    buffer_load_dwordx4 v88, s[52:55], s64 offen lds
    s_waitcnt vmcnt(32)
    ds_read_b64_tr_b16 a[16:17], v91 offset:12288
    ds_read_b64_tr_b16 a[18:19], v91 offset:12800
    ds_read_b64_tr_b16 a[20:21], v91 offset:14336
    ds_read_b64_tr_b16 a[22:23], v91 offset:14848
    ds_read_b64_tr_b16 a[24:25], v92 offset:12288
    ds_read_b64_tr_b16 a[26:27], v92 offset:12800
    ds_read_b64_tr_b16 a[28:29], v92 offset:14336
    ds_read_b64_tr_b16 a[30:31], v92 offset:14848
    s_waitcnt lgkmcnt(0)
    s_add_u32 m0, s40, 12288
    s_add_u32 s64, s39, 0x0
    buffer_load_dwordx4 v89, s[56:59], s64 offen lds
    s_add_u32 m0, s40, 13312
    s_add_u32 s64, s39, 0x5000
    buffer_load_dwordx4 v89, s[56:59], s64 offen lds
    s_add_u32 m0, s40, 14336
    s_add_u32 s64, s39, 0xa000
    buffer_load_dwordx4 v89, s[56:59], s64 offen lds
    s_add_u32 m0, s40, 15360
    s_add_u32 s64, s39, 0xf000
    buffer_load_dwordx4 v89, s[56:59], s64 offen lds
    s_waitcnt vmcnt(32)
    ds_read_b64_tr_b16 a[32:33], v91 offset:16384
    ds_read_b64_tr_b16 a[34:35], v91 offset:16896
    ds_read_b64_tr_b16 a[36:37], v91 offset:18432
    ds_read_b64_tr_b16 a[38:39], v91 offset:18944
    ds_read_b64_tr_b16 a[40:41], v92 offset:16384
    ds_read_b64_tr_b16 a[42:43], v92 offset:16896
    ds_read_b64_tr_b16 a[44:45], v92 offset:18432
    ds_read_b64_tr_b16 a[46:47], v92 offset:18944
    s_waitcnt lgkmcnt(0)
    s_add_u32 m0, s40, 16384
    s_add_u32 s64, s39, 0x14000
    buffer_load_dwordx4 v89, s[56:59], s64 offen lds
    s_add_u32 m0, s40, 17408
    s_add_u32 s64, s39, 0x19000
    buffer_load_dwordx4 v89, s[56:59], s64 offen lds
    s_add_u32 m0, s40, 18432
    s_add_u32 s64, s39, 0x1e000
    buffer_load_dwordx4 v89, s[56:59], s64 offen lds
    s_add_u32 m0, s40, 19456
    s_add_u32 s64, s39, 0x23000
    buffer_load_dwordx4 v89, s[56:59], s64 offen lds
    s_waitcnt vmcnt(32)
    ds_read_b64_tr_b16 a[48:49], v91 offset:20480
    ds_read_b64_tr_b16 a[50:51], v91 offset:20992
    ds_read_b64_tr_b16 a[52:53], v91 offset:22528
    ds_read_b64_tr_b16 a[54:55], v91 offset:23040
    ds_read_b64_tr_b16 a[56:57], v92 offset:20480
    ds_read_b64_tr_b16 a[58:59], v92 offset:20992
    ds_read_b64_tr_b16 a[60:61], v92 offset:22528
    ds_read_b64_tr_b16 a[62:63], v92 offset:23040
    s_waitcnt lgkmcnt(0)
    s_add_u32 m0, s40, 20480
    s_add_u32 s64, s39, 0x100
    buffer_load_dwordx4 v89, s[56:59], s64 offen lds
    s_add_u32 m0, s40, 21504
    s_add_u32 s64, s39, 0x5100
    buffer_load_dwordx4 v89, s[56:59], s64 offen lds
    s_add_u32 m0, s40, 22528
    s_add_u32 s64, s39, 0xa100
    buffer_load_dwordx4 v89, s[56:59], s64 offen lds
    s_add_u32 m0, s40, 23552
    s_add_u32 s64, s39, 0xf100
    buffer_load_dwordx4 v89, s[56:59], s64 offen lds
    s_waitcnt vmcnt(32)
    ds_read_b64_tr_b16 a[64:65], v91 offset:24576
    ds_read_b64_tr_b16 a[66:67], v91 offset:25088
    ds_read_b64_tr_b16 a[68:69], v91 offset:26624
    ds_read_b64_tr_b16 a[70:71], v91 offset:27136
    ds_read_b64_tr_b16 a[72:73], v92 offset:24576
    ds_read_b64_tr_b16 a[74:75], v92 offset:25088
    ds_read_b64_tr_b16 a[76:77], v92 offset:26624
    ds_read_b64_tr_b16 a[78:79], v92 offset:27136
    s_waitcnt lgkmcnt(0)
    s_add_u32 m0, s40, 24576
    s_add_u32 s64, s39, 0x14100
    buffer_load_dwordx4 v89, s[56:59], s64 offen lds
    s_add_u32 m0, s40, 25600
    s_add_u32 s64, s39, 0x19100
    buffer_load_dwordx4 v89, s[56:59], s64 offen lds
    s_add_u32 m0, s40, 26624
    s_add_u32 s64, s39, 0x1e100
    buffer_load_dwordx4 v89, s[56:59], s64 offen lds
    s_add_u32 m0, s40, 27648
    s_add_u32 s64, s39, 0x23100
    buffer_load_dwordx4 v89, s[56:59], s64 offen lds
    s_waitcnt vmcnt(32)
    ds_read_b64_tr_b16 a[80:81], v91 offset:28672
    ds_read_b64_tr_b16 a[82:83], v91 offset:29184
    ds_read_b64_tr_b16 a[84:85], v91 offset:30720
    ds_read_b64_tr_b16 a[86:87], v91 offset:31232
    ds_read_b64_tr_b16 a[88:89], v92 offset:28672
    ds_read_b64_tr_b16 a[90:91], v92 offset:29184
    ds_read_b64_tr_b16 a[92:93], v92 offset:30720
    ds_read_b64_tr_b16 a[94:95], v92 offset:31232
    s_waitcnt lgkmcnt(0)
    s_add_u32 m0, s40, 28672
    s_add_u32 s64, s41, 0x0
    buffer_load_dwordx4 v90, s[56:59], s64 offen lds
    s_add_u32 m0, s40, 29696
    s_add_u32 s64, s41, 0xa000
    buffer_load_dwordx4 v90, s[56:59], s64 offen lds
    s_add_u32 m0, s40, 30720
    s_add_u32 s64, s41, 0x14000
    buffer_load_dwordx4 v90, s[56:59], s64 offen lds
    s_add_u32 m0, s40, 31744
    s_add_u32 s64, s41, 0x1e000
    buffer_load_dwordx4 v90, s[56:59], s64 offen lds
    s_waitcnt vmcnt(32)
    ds_read_b64_tr_b16 a[96:97], v91 offset:32768
    ds_read_b64_tr_b16 a[98:99], v91 offset:33280
    ds_read_b64_tr_b16 a[100:101], v91 offset:34816
    ds_read_b64_tr_b16 a[102:103], v91 offset:35328
    ds_read_b64_tr_b16 a[104:105], v92 offset:32768
    ds_read_b64_tr_b16 a[106:107], v92 offset:33280
    ds_read_b64_tr_b16 a[108:109], v92 offset:34816
    ds_read_b64_tr_b16 a[110:111], v92 offset:35328
    s_waitcnt lgkmcnt(0)
    s_add_u32 m0, s40, 32768
    s_add_u32 s64, s72, 0x180000
    buffer_load_dwordx4 v88, s[48:51], s64 offen lds
    s_add_u32 m0, s40, 33792
    s_add_u32 s64, s72, 0x1a0000
    buffer_load_dwordx4 v88, s[48:51], s64 offen lds
    s_add_u32 m0, s40, 34816
    s_add_u32 s64, s72, 0x1c0000
    buffer_load_dwordx4 v88, s[48:51], s64 offen lds
    s_add_u32 m0, s40, 35840
    s_add_u32 s64, s72, 0x1e0000
    buffer_load_dwordx4 v88, s[48:51], s64 offen lds
    s_waitcnt vmcnt(32)
    ds_read_b64_tr_b16 a[112:113], v91 offset:0
    ds_read_b64_tr_b16 a[114:115], v91 offset:512
    ds_read_b64_tr_b16 a[116:117], v91 offset:2048
    ds_read_b64_tr_b16 a[118:119], v91 offset:2560
    ds_read_b64_tr_b16 a[120:121], v92 offset:0
    ds_read_b64_tr_b16 a[122:123], v92 offset:512
    ds_read_b64_tr_b16 a[124:125], v92 offset:2048
    ds_read_b64_tr_b16 a[126:127], v92 offset:2560
    s_waitcnt lgkmcnt(0)
    s_add_u32 m0, s40, 0
    s_add_u32 s64, s71, 0x0
    buffer_load_dwordx4 v88, s[48:51], s64 offen lds
    s_add_u32 m0, s40, 1024
    s_add_u32 s64, s71, 0x20000
    buffer_load_dwordx4 v88, s[48:51], s64 offen lds
    s_add_u32 m0, s40, 2048
    s_add_u32 s64, s71, 0x40000
    buffer_load_dwordx4 v88, s[48:51], s64 offen lds
    s_add_u32 m0, s40, 3072
    s_add_u32 s64, s71, 0x60000
    buffer_load_dwordx4 v88, s[48:51], s64 offen lds
    s_waitcnt vmcnt(32)
    ds_read_b64_tr_b16 a[128:129], v91 offset:4096
    ds_read_b64_tr_b16 a[130:131], v91 offset:4608
    ds_read_b64_tr_b16 a[132:133], v91 offset:6144
    ds_read_b64_tr_b16 a[134:135], v91 offset:6656
    ds_read_b64_tr_b16 a[136:137], v92 offset:4096
    ds_read_b64_tr_b16 a[138:139], v92 offset:4608
    ds_read_b64_tr_b16 a[140:141], v92 offset:6144
    ds_read_b64_tr_b16 a[142:143], v92 offset:6656
    s_waitcnt lgkmcnt(0)
    s_add_u32 m0, s40, 4096
    s_add_u32 s64, s71, 0x80000
    buffer_load_dwordx4 v88, s[48:51], s64 offen lds
    s_add_u32 m0, s40, 5120
    s_add_u32 s64, s71, 0xa0000
    buffer_load_dwordx4 v88, s[48:51], s64 offen lds
    s_add_u32 m0, s40, 6144
    s_add_u32 s64, s71, 0xc0000
    buffer_load_dwordx4 v88, s[48:51], s64 offen lds
    s_add_u32 m0, s40, 7168
    s_add_u32 s64, s71, 0xe0000
    buffer_load_dwordx4 v88, s[48:51], s64 offen lds
    s_waitcnt vmcnt(32)
    ds_read_b64_tr_b16 a[144:145], v91 offset:8192
    ds_read_b64_tr_b16 a[146:147], v91 offset:8704
    ds_read_b64_tr_b16 a[148:149], v91 offset:10240
    ds_read_b64_tr_b16 a[150:151], v91 offset:10752
    ds_read_b64_tr_b16 a[152:153], v92 offset:8192
    ds_read_b64_tr_b16 a[154:155], v92 offset:8704
    ds_read_b64_tr_b16 a[156:157], v92 offset:10240
    ds_read_b64_tr_b16 a[158:159], v92 offset:10752
    s_waitcnt lgkmcnt(0)
    s_add_u32 m0, s40, 8192
    s_add_u32 s64, s71, 0x100000
    buffer_load_dwordx4 v88, s[48:51], s64 offen lds
    s_add_u32 m0, s40, 9216
    s_add_u32 s64, s71, 0x120000
    buffer_load_dwordx4 v88, s[48:51], s64 offen lds
    s_add_u32 m0, s40, 10240
    s_add_u32 s64, s71, 0x140000
    buffer_load_dwordx4 v88, s[48:51], s64 offen lds
    s_add_u32 m0, s40, 11264
    s_add_u32 s64, s71, 0x160000
    buffer_load_dwordx4 v88, s[48:51], s64 offen lds
    s_waitcnt vmcnt(32)
    ds_read_b64_tr_b16 a[160:161], v93 offset:12288
    ds_read_b64_tr_b16 a[162:163], v93 offset:12544
    ds_read_b64_tr_b16 a[164:165], v93 offset:13312
    ds_read_b64_tr_b16 a[166:167], v93 offset:13568
    ds_read_b64_tr_b16 a[168:169], v93 offset:14336
    ds_read_b64_tr_b16 a[170:171], v93 offset:14592
    ds_read_b64_tr_b16 a[172:173], v93 offset:15360
    ds_read_b64_tr_b16 a[174:175], v93 offset:15616
    s_waitcnt lgkmcnt(0)
    s_add_u32 m0, s40, 12288
    s_add_u32 s64, s71, 0x180000
    buffer_load_dwordx4 v88, s[48:51], s64 offen lds
    s_add_u32 m0, s40, 13312
    s_add_u32 s64, s71, 0x1a0000
    buffer_load_dwordx4 v88, s[48:51], s64 offen lds
    s_add_u32 m0, s40, 14336
    s_add_u32 s64, s71, 0x1c0000
    buffer_load_dwordx4 v88, s[48:51], s64 offen lds
    s_add_u32 m0, s40, 15360
    s_add_u32 s64, s71, 0x1e0000
    buffer_load_dwordx4 v88, s[48:51], s64 offen lds
    s_waitcnt vmcnt(32)
    ds_read_b64_tr_b16 a[176:177], v93 offset:16384
    ds_read_b64_tr_b16 a[178:179], v93 offset:16640
    ds_read_b64_tr_b16 a[180:181], v93 offset:17408
    ds_read_b64_tr_b16 a[182:183], v93 offset:17664
    ds_read_b64_tr_b16 a[184:185], v93 offset:18432
    ds_read_b64_tr_b16 a[186:187], v93 offset:18688
    ds_read_b64_tr_b16 a[188:189], v93 offset:19456
    ds_read_b64_tr_b16 a[190:191], v93 offset:19712
    s_waitcnt lgkmcnt(0)
    s_add_u32 m0, s40, 16384
    s_add_u32 s64, s71, 0x200000
    buffer_load_dwordx4 v88, s[48:51], s64 offen lds
    s_add_u32 m0, s40, 17408
    s_add_u32 s64, s71, 0x220000
    buffer_load_dwordx4 v88, s[48:51], s64 offen lds
    s_add_u32 m0, s40, 18432
    s_add_u32 s64, s71, 0x240000
    buffer_load_dwordx4 v88, s[48:51], s64 offen lds
    s_add_u32 m0, s40, 19456
    s_add_u32 s64, s71, 0x260000
    buffer_load_dwordx4 v88, s[48:51], s64 offen lds
    s_waitcnt vmcnt(32)
    ds_read_b64_tr_b16 a[192:193], v93 offset:20480
    ds_read_b64_tr_b16 a[194:195], v93 offset:20736
    ds_read_b64_tr_b16 a[196:197], v93 offset:21504
    ds_read_b64_tr_b16 a[198:199], v93 offset:21760
    ds_read_b64_tr_b16 a[200:201], v93 offset:22528
    ds_read_b64_tr_b16 a[202:203], v93 offset:22784
    ds_read_b64_tr_b16 a[204:205], v93 offset:23552
    ds_read_b64_tr_b16 a[206:207], v93 offset:23808
    s_waitcnt lgkmcnt(0)
    s_add_u32 m0, s40, 20480
    s_add_u32 s64, s72, 0x0
    buffer_load_dwordx4 v88, s[48:51], s64 offen lds
    s_add_u32 m0, s40, 21504
    s_add_u32 s64, s72, 0x20000
    buffer_load_dwordx4 v88, s[48:51], s64 offen lds
    s_add_u32 m0, s40, 22528
    s_add_u32 s64, s72, 0x40000
    buffer_load_dwordx4 v88, s[48:51], s64 offen lds
    s_add_u32 m0, s40, 23552
    s_add_u32 s64, s72, 0x60000
    buffer_load_dwordx4 v88, s[48:51], s64 offen lds
    s_waitcnt vmcnt(32)
    ds_read_b64_tr_b16 a[208:209], v93 offset:24576
    ds_read_b64_tr_b16 a[210:211], v93 offset:24832
    ds_read_b64_tr_b16 a[212:213], v93 offset:25600
    ds_read_b64_tr_b16 a[214:215], v93 offset:25856
    ds_read_b64_tr_b16 a[216:217], v93 offset:26624
    ds_read_b64_tr_b16 a[218:219], v93 offset:26880
    ds_read_b64_tr_b16 a[220:221], v93 offset:27648
    ds_read_b64_tr_b16 a[222:223], v93 offset:27904
    s_waitcnt lgkmcnt(0)
    s_add_u32 m0, s40, 24576
    s_add_u32 s64, s72, 0x80000
    buffer_load_dwordx4 v88, s[48:51], s64 offen lds
    s_add_u32 m0, s40, 25600
    s_add_u32 s64, s72, 0xa0000
    buffer_load_dwordx4 v88, s[48:51], s64 offen lds
    s_add_u32 m0, s40, 26624
    s_add_u32 s64, s72, 0xc0000
    buffer_load_dwordx4 v88, s[48:51], s64 offen lds
    s_add_u32 m0, s40, 27648
    s_add_u32 s64, s72, 0xe0000
    buffer_load_dwordx4 v88, s[48:51], s64 offen lds
    s_waitcnt vmcnt(32)
    ds_read_b64_tr_b16 a[224:225], v94 offset:28672
    ds_read_b64_tr_b16 a[226:227], v94 offset:28800
    ds_read_b64_tr_b16 a[228:229], v94 offset:29696
    ds_read_b64_tr_b16 a[230:231], v94 offset:29824
    ds_read_b64_tr_b16 a[232:233], v94 offset:30720
    ds_read_b64_tr_b16 a[234:235], v94 offset:30848
    ds_read_b64_tr_b16 a[236:237], v94 offset:31744
    ds_read_b64_tr_b16 a[238:239], v94 offset:31872
    s_waitcnt lgkmcnt(0)
    s_add_u32 m0, s40, 28672
    s_add_u32 s64, s72, 0x100000
    buffer_load_dwordx4 v88, s[48:51], s64 offen lds
    s_add_u32 m0, s40, 29696
    s_add_u32 s64, s72, 0x120000
    buffer_load_dwordx4 v88, s[48:51], s64 offen lds
    s_add_u32 m0, s40, 30720
    s_add_u32 s64, s72, 0x140000
    buffer_load_dwordx4 v88, s[48:51], s64 offen lds
    s_add_u32 m0, s40, 31744
    s_add_u32 s64, s72, 0x160000
    buffer_load_dwordx4 v88, s[48:51], s64 offen lds
    s_waitcnt vmcnt(32)
    ds_read_b64_tr_b16 v[12:13], v91 offset:32768
    ds_read_b64_tr_b16 v[14:15], v91 offset:33280
    ds_read_b64_tr_b16 v[16:17], v91 offset:34816
    ds_read_b64_tr_b16 v[18:19], v91 offset:35328
    ds_read_b64_tr_b16 v[20:21], v92 offset:32768
    ds_read_b64_tr_b16 v[22:23], v92 offset:33280
    ds_read_b64_tr_b16 v[24:25], v92 offset:34816
    ds_read_b64_tr_b16 v[26:27], v92 offset:35328
    s_waitcnt lgkmcnt(0)
    ds_write_b128 v2, v[12:15] offset:32768
    ds_write_b128 v2, v[16:19] offset:33792
    ds_write_b128 v2, v[20:23] offset:34816
    ds_write_b128 v2, v[24:27] offset:35840
    s_waitcnt lgkmcnt(0)
    s_waitcnt vmcnt(28)
    ds_read_b64_tr_b16 v[12:13], v91 offset:0
    ds_read_b64_tr_b16 v[14:15], v91 offset:512
    ds_read_b64_tr_b16 v[16:17], v91 offset:2048
    ds_read_b64_tr_b16 v[18:19], v91 offset:2560
    ds_read_b64_tr_b16 v[20:21], v92 offset:0
    ds_read_b64_tr_b16 v[22:23], v92 offset:512
    ds_read_b64_tr_b16 v[24:25], v92 offset:2048
    ds_read_b64_tr_b16 v[26:27], v92 offset:2560
    s_waitcnt lgkmcnt(0)
    ds_write_b128 v2, v[12:15] offset:0
    ds_write_b128 v2, v[16:19] offset:1024
    ds_write_b128 v2, v[20:23] offset:2048
    ds_write_b128 v2, v[24:27] offset:3072
    s_waitcnt lgkmcnt(0)
    s_waitcnt vmcnt(24)
    ds_read_b64_tr_b16 v[12:13], v91 offset:4096
    ds_read_b64_tr_b16 v[14:15], v91 offset:4608
    ds_read_b64_tr_b16 v[16:17], v91 offset:6144
    ds_read_b64_tr_b16 v[18:19], v91 offset:6656
    ds_read_b64_tr_b16 v[20:21], v92 offset:4096
    ds_read_b64_tr_b16 v[22:23], v92 offset:4608
    ds_read_b64_tr_b16 v[24:25], v92 offset:6144
    ds_read_b64_tr_b16 v[26:27], v92 offset:6656
    s_waitcnt lgkmcnt(0)
    ds_write_b128 v2, v[12:15] offset:4096
    ds_write_b128 v2, v[16:19] offset:5120
    ds_write_b128 v2, v[20:23] offset:6144
    ds_write_b128 v2, v[24:27] offset:7168
    s_waitcnt lgkmcnt(0)
    s_waitcnt vmcnt(20)
    ds_read_b64_tr_b16 v[12:13], v91 offset:8192
    ds_read_b64_tr_b16 v[14:15], v91 offset:8704
    ds_read_b64_tr_b16 v[16:17], v91 offset:10240
    ds_read_b64_tr_b16 v[18:19], v91 offset:10752
    ds_read_b64_tr_b16 v[20:21], v92 offset:8192
    ds_read_b64_tr_b16 v[22:23], v92 offset:8704
    ds_read_b64_tr_b16 v[24:25], v92 offset:10240
    ds_read_b64_tr_b16 v[26:27], v92 offset:10752
    s_waitcnt lgkmcnt(0)
    ds_write_b128 v2, v[12:15] offset:8192
    ds_write_b128 v2, v[16:19] offset:9216
    ds_write_b128 v2, v[20:23] offset:10240
    ds_write_b128 v2, v[24:27] offset:11264
    s_waitcnt lgkmcnt(0)
    s_waitcnt vmcnt(16)
    ds_read_b64_tr_b16 v[12:13], v91 offset:12288
    ds_read_b64_tr_b16 v[14:15], v91 offset:12800
    ds_read_b64_tr_b16 v[16:17], v91 offset:14336
    ds_read_b64_tr_b16 v[18:19], v91 offset:14848
    ds_read_b64_tr_b16 v[20:21], v92 offset:12288
    ds_read_b64_tr_b16 v[22:23], v92 offset:12800
    ds_read_b64_tr_b16 v[24:25], v92 offset:14336
    ds_read_b64_tr_b16 v[26:27], v92 offset:14848
    s_waitcnt lgkmcnt(0)
    ds_write_b128 v2, v[12:15] offset:12288
    ds_write_b128 v2, v[16:19] offset:13312
    ds_write_b128 v2, v[20:23] offset:14336
    ds_write_b128 v2, v[24:27] offset:15360
    s_waitcnt lgkmcnt(0)
    s_waitcnt vmcnt(12)
    ds_read_b64_tr_b16 v[12:13], v91 offset:16384
    ds_read_b64_tr_b16 v[14:15], v91 offset:16896
    ds_read_b64_tr_b16 v[16:17], v91 offset:18432
    ds_read_b64_tr_b16 v[18:19], v91 offset:18944
    ds_read_b64_tr_b16 v[20:21], v92 offset:16384
    ds_read_b64_tr_b16 v[22:23], v92 offset:16896
    ds_read_b64_tr_b16 v[24:25], v92 offset:18432
    ds_read_b64_tr_b16 v[26:27], v92 offset:18944
    s_waitcnt lgkmcnt(0)
    ds_write_b128 v2, v[12:15] offset:16384
    ds_write_b128 v2, v[16:19] offset:17408
    ds_write_b128 v2, v[20:23] offset:18432
    ds_write_b128 v2, v[24:27] offset:19456
    s_waitcnt lgkmcnt(0)
    s_waitcnt vmcnt(8)
    ds_read_b64_tr_b16 v[12:13], v91 offset:20480
    ds_read_b64_tr_b16 v[14:15], v91 offset:20992
    ds_read_b64_tr_b16 v[16:17], v91 offset:22528
    ds_read_b64_tr_b16 v[18:19], v91 offset:23040
    ds_read_b64_tr_b16 v[20:21], v92 offset:20480
    ds_read_b64_tr_b16 v[22:23], v92 offset:20992
    ds_read_b64_tr_b16 v[24:25], v92 offset:22528
    ds_read_b64_tr_b16 v[26:27], v92 offset:23040
    s_waitcnt lgkmcnt(0)
    ds_write_b128 v2, v[12:15] offset:20480
    ds_write_b128 v2, v[16:19] offset:21504
    ds_write_b128 v2, v[20:23] offset:22528
    ds_write_b128 v2, v[24:27] offset:23552
    s_waitcnt lgkmcnt(0)
    s_waitcnt vmcnt(4)
    ds_read_b64_tr_b16 v[12:13], v91 offset:24576
    ds_read_b64_tr_b16 v[14:15], v91 offset:25088
    ds_read_b64_tr_b16 v[16:17], v91 offset:26624
    ds_read_b64_tr_b16 v[18:19], v91 offset:27136
    ds_read_b64_tr_b16 v[20:21], v92 offset:24576
    ds_read_b64_tr_b16 v[22:23], v92 offset:25088
    ds_read_b64_tr_b16 v[24:25], v92 offset:26624
    ds_read_b64_tr_b16 v[26:27], v92 offset:27136
    s_waitcnt lgkmcnt(0)
    ds_write_b128 v2, v[12:15] offset:24576
    ds_write_b128 v2, v[16:19] offset:25600
    ds_write_b128 v2, v[20:23] offset:26624
    ds_write_b128 v2, v[24:27] offset:27648
    s_waitcnt lgkmcnt(0)
    s_waitcnt vmcnt(0)
    ds_read_b64_tr_b16 v[12:13], v91 offset:28672
    ds_read_b64_tr_b16 v[14:15], v91 offset:29184
    ds_read_b64_tr_b16 v[16:17], v91 offset:30720
    ds_read_b64_tr_b16 v[18:19], v91 offset:31232
    ds_read_b64_tr_b16 v[20:21], v92 offset:28672
    ds_read_b64_tr_b16 v[22:23], v92 offset:29184
    ds_read_b64_tr_b16 v[24:25], v92 offset:30720
    ds_read_b64_tr_b16 v[26:27], v92 offset:31232
    s_waitcnt lgkmcnt(0)
    ds_write_b128 v2, v[12:15] offset:28672
    ds_write_b128 v2, v[16:19] offset:29696
    ds_write_b128 v2, v[20:23] offset:30720
    ds_write_b128 v2, v[24:27] offset:31744
    s_waitcnt lgkmcnt(0)
    s_cmp_lg_u32 s97, 0
    s_cbranch_scc1 CM_7
    v_mbcnt_lo_u32_b32 v0, -1, 0
    v_mbcnt_hi_u32_b32 v0, -1, v0
    v_mul_u32_u24 v8, 32, v0
    s_mov_b32 s64, 0x0
    s_mov_b32 s65, 0
    s_mov_b64 exec, 0xff
TK_8:
    buffer_load_dword v9, v8, s[60:63], s64 offen sc1
    s_add_u32 s65, s65, 1
    s_waitcnt vmcnt(0)
    s_mov_b32 s66, 0
    v_readlane_b32 s67, v9, 0
    s_add_u32 s66, s66, s67
    v_readlane_b32 s67, v9, 1
    s_add_u32 s66, s66, s67
    v_readlane_b32 s67, v9, 2
    s_add_u32 s66, s66, s67
    v_readlane_b32 s67, v9, 3
    s_add_u32 s66, s66, s67
    v_readlane_b32 s67, v9, 4
    s_add_u32 s66, s66, s67
    v_readlane_b32 s67, v9, 5
    s_add_u32 s66, s66, s67
    v_readlane_b32 s67, v9, 6
    s_add_u32 s66, s66, s67
    v_readlane_b32 s67, v9, 7
    s_add_u32 s66, s66, s67
    s_cmp_ge_u32 s66, 256
    s_cbranch_scc1 TKD_9
    s_cmp_gt_u32 s65, 262144
    s_cbranch_scc0 TK_8
TKD_9:
    v_cmp_ne_u32 vcc, 32, v9
    s_mov_b64 exec, -1
    s_cbranch_vccnz M_SLOW
CM_7:
    s_mov_b32 s65, 0
RI_10:
    buffer_load_dword v8, off, s[60:63], s95 sc1
    s_add_u32 s65, s65, 1
    s_waitcnt vmcnt(0)
    v_readfirstlane_b32 s64, v8
    s_cmp_ge_u32 s64, 192
    s_cbranch_scc1 RID_11
    s_cmp_gt_u32 s65, 65536
    s_cbranch_scc1 RID_11
    s_sleep 4
    s_branch RI_10
RID_11:
    s_mov_b32 s38, 0x3f80
    s_mov_b32 s53, 0
    s_cmp_eq_u32 s14, 2
    s_cselect_b32 s52, 1024, 0
    s_mov_b32 s44, 0x3030303
    s_mov_b32 s45, 0x3030303
    s_mov_b32 s46, 0xc0c0c0c
    s_mov_b32 s47, 0xc0c0c0c
    s_mov_b32 s48, 0x30303030
    s_mov_b32 s49, 0x30303030
    s_mov_b32 s50, 0xc0c0c0c0
    s_mov_b32 s51, 0xc0c0c0c0
    v_and_b32 v8, 7, v0
    v_mul_u32_u24 v8, 288, v8
    v_lshrrev_b32 v9, 4, v0
    v_lshl_add_u32 v8, v9, 4, v8
    v_add_u32 v0, 12800, v8
    s_mov_b32 s68, 0
    s_mov_b32 s40, 0
    s_mov_b32 s65, 0
CW_12:
    buffer_load_dwordx2 v[8:9], off, s[60:63], 0 offset:132 sc1
    s_add_u32 s65, s65, 1
    s_waitcnt vmcnt(0)
    v_readfirstlane_b32 s66, v8
    v_readfirstlane_b32 s67, v9
    s_min_u32 s64, s66, s67
    s_cmp_lg_u32 s64, 0
    s_cbranch_scc1 CWD_13
    s_cmp_gt_u32 s65, 65536
    s_cbranch_scc1 CWD_13
    s_sleep 4
    s_branch CW_12
CWD_13:
    s_sub_u32 s66, s66, 1
    s_and_b32 s66, s66, 3
    s_sub_u32 s67, s67, 1
    s_and_b32 s67, s67, 3
    s_mov_b32 s64, s66
    s_mov_b32 s65, s67
    s_cmp_eq_u32 s12, 0
    s_cselect_b32 s66, s65, s64
    s_cselect_b32 s64, s64, s65
    s_and_b32 s64, s64, 3
    s_lshl_b32 s64, s64, 13
    s_and_b32 s66, s66, 3
    s_lshl_b32 s66, s66, 13
    s_add_u32 s21, s21, s64
    s_add_u32 s20, s20, s66
    s_cmp_eq_u32 s42, 0
    s_cselect_b32 s18, 0x40000000, s18
    s_cselect_b32 s21, 0x40000000, s21
    s_lshl_b32 s65, s12, 7
    s_add_u32 s65, s65, 0x29a000
    s_cmp_eq_u32 s22, 0
    s_cselect_b32 s22, 0x40000000, s65
    s_lshl_b32 s64, s13, 2
    s_add_u32 s64, s64, s14
    s_cmp_ge_u32 s64, 40
    s_cselect_b32 s65, 40, 0
    s_sub_u32 s64, s64, s65
    s_cmp_ge_u32 s64, 40
    s_cselect_b32 s65, 40, 0
    s_sub_u32 s64, s64, s65
    s_cmp_ge_u32 s64, 40
    s_cselect_b32 s65, 40, 0
    s_sub_u32 s64, s64, s65
    s_lshl_b32 s27, s64, 7
    s_add_u32 s19, s27, 0x4000
    v_mov_b32 v29, 0
FSPIN_14:
    buffer_load_dwordx2 v[12:13], v29, s[4:7], s69 offen sc1
    s_add_u32 s68, s68, 1
    s_waitcnt vmcnt(0)
    v_and_b32 v12, v12, v13
    v_cmp_eq_u32 vcc, 0, v12
    s_cbranch_vccz FDONE_15
    s_cmp_gt_u32 s68, 262144
    s_cbranch_scc0 FSPIN_14
FDONE_15:
    s_barrier
    s_mov_b32 m0, s73
    s_nop 0
    buffer_load_dwordx4 v1, s[4:7], s28 offen lds
    buffer_load_dwordx4 v1, s[4:7], s28 offen offset:1024 lds
    s_mov_b32 m0, 15360
    v_lshlrev_b32 v12, 2, v1
    s_add_u32 s65, s3, 0xfff80000
    buffer_load_dword v12, s[4:7], s65 offen lds
    s_mov_b32 s15, 0
    s_mov_b32 s16, 0
    s_add_u32 s66, s17, s52
    buffer_load_dwordx4 v[12:15], v1, s[4:7], s66 offen sc1
    v_add_u32 v29, s52, v1
    s_waitcnt vmcnt(0)
    ds_write_b128 v29, v[12:15] offset:12800
    s_waitcnt lgkmcnt(0)
    v_mov_b64 v[32:33], 0
    v_mov_b64 v[34:35], 0
    v_mov_b64 v[36:37], 0
    v_mov_b64 v[38:39], 0
    v_mov_b64 v[40:41], 0
    v_mov_b64 v[42:43], 0
    v_mov_b64 v[44:45], 0
    v_mov_b64 v[46:47], 0
    v_mov_b64 v[48:49], 0
    v_mov_b64 v[50:51], 0
    v_mov_b64 v[52:53], 0
    v_mov_b64 v[54:55], 0
    v_mov_b32 v9, 0x40000000
    ds_read_b128 v[56:59], v2 offset:0
    ds_read_b128 v[60:63], v2 offset:1024
    ds_read_b128 v[64:67], v2 offset:2048
    ds_read_b128 v[68:71], v2 offset:3072
    s_cmp_eq_u32 s97, 0
    s_cbranch_scc1 REC_LOOP
    s_branch REC_LOOP_S
REC_POLL_S:
    s_cmp_lg_u32 s14, 3
    s_cbranch_scc1 NOFLG_16
    s_add_u32 s64, s15, 2
    s_and_b32 s65, s64, 0x43
    s_cmp_lg_u32 s65, 0
    s_cbranch_scc1 NOFLG_16
    s_lshl_b32 s64, s64, 7
    s_add_u32 s64, s64, s69
    v_mov_b32 v29, 0
FSPIN_17:
    buffer_load_dwordx2 v[12:13], v29, s[4:7], s64 offen sc1
    s_add_u32 s68, s68, 1
    s_waitcnt vmcnt(0)
    v_and_b32 v12, v12, v13
    v_cmp_eq_u32 vcc, 0, v12
    s_cbranch_vccz FDONE_18
    s_cmp_gt_u32 s68, 262144
    s_cbranch_scc0 FSPIN_17
FDONE_18:
NOFLG_16:
    s_add_u32 s66, s17, s52
    v_add_u32 v10, s52, v1
    s_xor_b32 s16, s16, 1
    v_mov_b64 v[32:33], 0
    v_mov_b64 v[34:35], 0
    v_mov_b64 v[36:37], 0
    v_mov_b64 v[38:39], 0
    v_mov_b64 v[40:41], 0
    v_mov_b64 v[42:43], 0
    v_mov_b64 v[44:45], 0
    v_mov_b64 v[46:47], 0
    v_mov_b64 v[48:49], 0
    v_mov_b64 v[50:51], 0
    v_mov_b64 v[52:53], 0
    v_mov_b64 v[54:55], 0
    ds_read_b128 v[56:59], v2 offset:0
    ds_read_b128 v[60:63], v2 offset:1024
    ds_read_b128 v[64:67], v2 offset:2048
    ds_read_b128 v[68:71], v2 offset:3072
    s_barrier
    s_cmp_lt_u32 s15, 63
    s_cbranch_scc0 REC_END
    s_nop 14
    buffer_load_dwordx4 v[20:23], v1, s[4:7], s66 offen sc1
    s_nop 7
    buffer_load_dwordx4 v[24:27], v1, s[4:7], s66 offen sc1
    s_nop 7
    buffer_load_dwordx4 v[28:31], v1, s[4:7], s66 offen sc1
IPOLL_19:
    s_waitcnt vmcnt(2)
    ds_write_b128 v10, v[20:23] offset:12800
    v_max3_u32 v11, v20, v21, v22
    v_max_u32 v11, v11, v23
    v_cmp_eq_u32 vcc, -1, v11
    s_cbranch_vccz IOK_20
    buffer_load_dwordx4 v[20:23], v1, s[4:7], s66 offen sc1
    s_waitcnt vmcnt(2)
    ds_write_b128 v10, v[24:27] offset:12800
    v_max3_u32 v11, v24, v25, v26
    v_max_u32 v11, v11, v27
    v_cmp_eq_u32 vcc, -1, v11
    s_cbranch_vccz IOK_20
    buffer_load_dwordx4 v[24:27], v1, s[4:7], s66 offen sc1
    s_waitcnt vmcnt(2)
    ds_write_b128 v10, v[28:31] offset:12800
    v_max3_u32 v11, v28, v29, v30
    v_max_u32 v11, v11, v31
    v_cmp_eq_u32 vcc, -1, v11
    s_add_u32 s68, s68, 1
    s_add_u32 s53, s53, 1
    s_cmp_gt_u32 s68, 262144
    s_cbranch_scc1 IOK_20
    s_cbranch_vccz IOK_20
    buffer_load_dwordx4 v[28:31], v1, s[4:7], s66 offen sc1
    s_branch IPOLL_19
IOK_20:
    s_waitcnt lgkmcnt(0)
REC_LOOP_S:
    s_barrier
    ds_read_b128 v[12:15], v1 offset:12800
    ds_read_b128 v[16:19], v1 offset:13824
    buffer_load_dwordx4 v[20:23], v1, s[4:7], s17 offen offset:2048
    ds_read_b128 v[72:75], v2 offset:4096
    ds_read_b128 v[76:79], v2 offset:5120
    ds_read_b128 v[80:83], v2 offset:6144
    ds_read_b128 v[84:87], v2 offset:7168
    s_add_u32 s74, s17, 0x1000
    s_add_u32 s20, s20, 0x8000
    s_add_u32 s75, s20, 0x1000
    s_mov_b32 m0, 15360
    s_add_u32 s65, s20, s27
    s_waitcnt lgkmcnt(5)
    v_smfmac_f32_16x16x64_bf16 v[32:35], v[12:15], v[96:103], v6
    buffer_load_dwordx4 v[24:27], v1, s[4:7], s17 offen offset:3072
    v_smfmac_f32_16x16x64_bf16 v[36:39], v[12:15], v[104:111], v6
    v_smfmac_f32_16x16x64_bf16 v[40:43], v[12:15], v[56:63], v6
    buffer_load_dwordx4 v[28:31], v1, s[4:7], s74 offen offset:0
    ds_read_b128 v[56:59], v2 offset:8192
    ds_read_b128 v[60:63], v2 offset:9216
    v_smfmac_f32_16x16x64_bf16 v[44:47], v[12:15], v[64:71], v6
    ds_read_b128 v[64:67], v2 offset:10240
    ds_read_b128 v[68:71], v2 offset:11264
    s_waitcnt lgkmcnt(8)
    v_smfmac_f32_16x16x64_bf16 v[48:51], v[12:15], a[0:7], v6
    v_smfmac_f32_16x16x64_bf16 v[52:55], v[12:15], a[8:15], v6
    buffer_load_dwordx4 v[12:15], v1, s[4:7], s20 offen offset:0
    buffer_load_dword off, s[4:7], s65 lds
    v_smfmac_f32_16x16x64_bf16 v[32:35], v[16:19], v[112:119], v6
    v_smfmac_f32_16x16x64_bf16 v[36:39], v[16:19], v[120:127], v6
    s_waitcnt lgkmcnt(4)
    v_smfmac_f32_16x16x64_bf16 v[40:43], v[16:19], v[72:79], v6
    ds_read_b128 v[72:75], v2 offset:12288
    ds_read_b128 v[76:79], v2 offset:13312
    v_smfmac_f32_16x16x64_bf16 v[44:47], v[16:19], v[80:87], v6
    ds_read_b128 v[80:83], v2 offset:14336
    ds_read_b128 v[84:87], v2 offset:15360
    s_waitcnt vmcnt(4)
    v_cmp_eq_u32 vcc, -1, v23
    v_smfmac_f32_16x16x64_bf16 v[48:51], v[16:19], a[16:23], v6
    v_smfmac_f32_16x16x64_bf16 v[52:55], v[16:19], a[24:31], v6
    s_cbranch_vccnz RETRY_21
BACK_22:
    buffer_load_dwordx4 v[16:19], v1, s[4:7], s20 offen offset:1024
    v_smfmac_f32_16x16x64_bf16 v[32:35], v[20:23], v[128:135], v6
    v_smfmac_f32_16x16x64_bf16 v[36:39], v[20:23], v[136:143], v6
    s_waitcnt lgkmcnt(4)
    v_smfmac_f32_16x16x64_bf16 v[40:43], v[20:23], v[56:63], v6
    ds_read_b128 v[56:59], v2 offset:16384
    ds_read_b128 v[60:63], v2 offset:17408
    v_smfmac_f32_16x16x64_bf16 v[44:47], v[20:23], v[64:71], v6
    ds_read_b128 v[64:67], v2 offset:18432
    ds_read_b128 v[68:71], v2 offset:19456
    s_waitcnt vmcnt(4)
    v_cmp_eq_u32 vcc, -1, v27
    v_smfmac_f32_16x16x64_bf16 v[48:51], v[20:23], a[32:39], v6
    v_smfmac_f32_16x16x64_bf16 v[52:55], v[20:23], a[40:47], v6
    s_cbranch_vccnz RETRY_23
BACK_24:
    buffer_load_dwordx4 v[20:23], v1, s[4:7], s20 offen offset:2048
    v_smfmac_f32_16x16x64_bf16 v[32:35], v[24:27], v[144:151], v6
    v_smfmac_f32_16x16x64_bf16 v[36:39], v[24:27], v[152:159], v6
    s_waitcnt lgkmcnt(4)
    v_smfmac_f32_16x16x64_bf16 v[40:43], v[24:27], v[72:79], v6
    ds_read_b128 v[72:75], v2 offset:20480
    ds_read_b128 v[76:79], v2 offset:21504
    v_smfmac_f32_16x16x64_bf16 v[44:47], v[24:27], v[80:87], v6
    ds_read_b128 v[80:83], v2 offset:22528
    ds_read_b128 v[84:87], v2 offset:23552
    s_waitcnt vmcnt(4)
    v_cmp_eq_u32 vcc, -1, v31
    v_smfmac_f32_16x16x64_bf16 v[48:51], v[24:27], a[48:55], v6
    v_smfmac_f32_16x16x64_bf16 v[52:55], v[24:27], a[56:63], v6
    s_cbranch_vccnz RETRY_25
BACK_26:
    buffer_load_dwordx4 v[24:27], v1, s[4:7], s20 offen offset:3072
    v_smfmac_f32_16x16x64_bf16 v[32:35], v[28:31], v[160:167], v6
    v_smfmac_f32_16x16x64_bf16 v[36:39], v[28:31], v[168:175], v6
    s_waitcnt lgkmcnt(4)
    v_smfmac_f32_16x16x64_bf16 v[40:43], v[28:31], v[56:63], v6
    ds_read_b128 v[56:59], v2 offset:24576
    ds_read_b128 v[60:63], v2 offset:25600
    v_smfmac_f32_16x16x64_bf16 v[44:47], v[28:31], v[64:71], v6
    ds_read_b128 v[64:67], v2 offset:26624
    ds_read_b128 v[68:71], v2 offset:27648
    s_waitcnt vmcnt(4)
    v_cmp_eq_u32 vcc, -1, v15
    v_smfmac_f32_16x16x64_bf16 v[48:51], v[28:31], a[64:71], v6
    v_smfmac_f32_16x16x64_bf16 v[52:55], v[28:31], a[72:79], v6
    s_cbranch_vccnz RETRY_27
BACK_28:
    buffer_load_dwordx4 v[28:31], v1, s[4:7], s75 offen offset:0
    v_smfmac_f32_16x16x64_bf16 v[32:35], v[12:15], v[176:183], v6
    s_waitcnt vmcnt(3)
    v_cmp_eq_u32 vcc, -1, v19
    v_smfmac_f32_16x16x64_bf16 v[36:39], v[12:15], v[184:191], v6
    s_waitcnt lgkmcnt(4)
    v_smfmac_f32_16x16x64_bf16 v[40:43], v[12:15], v[72:79], v6
    ds_read_b128 v[72:75], v2 offset:28672
    ds_read_b128 v[76:79], v2 offset:29696
    v_smfmac_f32_16x16x64_bf16 v[44:47], v[12:15], v[80:87], v6
    ds_read_b128 v[80:83], v2 offset:30720
    ds_read_b128 v[84:87], v2 offset:31744
    buffer_load_dwordx4 v[88:91], v1, s[4:7], s29 offen offset:0
    s_cbranch_vccnz RETRY_29
BACK_30:
    v_smfmac_f32_16x16x64_bf16 v[32:35], v[16:19], v[192:199], v6
    s_waitcnt vmcnt(3)
    v_cmp_eq_u32 vcc, -1, v23
    v_smfmac_f32_16x16x64_bf16 v[36:39], v[16:19], v[200:207], v6
    s_waitcnt lgkmcnt(4)
    v_smfmac_f32_16x16x64_bf16 v[40:43], v[16:19], v[56:63], v6
    ds_read_b128 v[56:59], v2 offset:32768
    ds_read_b128 v[60:63], v2 offset:33792
    v_smfmac_f32_16x16x64_bf16 v[44:47], v[16:19], v[64:71], v6
    ds_read_b128 v[64:67], v2 offset:34816
    ds_read_b128 v[68:71], v2 offset:35840
    s_cbranch_vccnz RETRY_31
BACK_32:
    v_smfmac_f32_16x16x64_bf16 v[32:35], v[20:23], v[208:215], v6
    s_waitcnt vmcnt(2)
    v_cmp_eq_u32 vcc, -1, v27
    v_smfmac_f32_16x16x64_bf16 v[36:39], v[20:23], v[216:223], v6
    s_waitcnt lgkmcnt(4)
    v_smfmac_f32_16x16x64_bf16 v[40:43], v[20:23], v[72:79], v6
    ds_read_b128 v[72:75], v1 offset:0
    ds_read_b128 v[76:79], v1 offset:4096
    v_smfmac_f32_16x16x64_bf16 v[44:47], v[20:23], v[80:87], v6
    ds_read_b128 v[80:83], v1 offset:1024
    ds_read_b128 v[84:87], v1 offset:5120
    buffer_load_dwordx4 v[92:95], v1, s[4:7], s29 offen offset:1024
    s_cbranch_vccnz RETRY_33
BACK_34:
    v_smfmac_f32_16x16x64_bf16 v[32:35], v[24:27], v[224:231], v6
    s_waitcnt vmcnt(2)
    v_cmp_eq_u32 vcc, -1, v31
    v_smfmac_f32_16x16x64_bf16 v[36:39], v[24:27], v[232:239], v6
    s_waitcnt lgkmcnt(4)
    v_smfmac_f32_16x16x64_bf16 v[40:43], v[24:27], v[56:63], v6
    ds_read_b128 v[56:59], v1 offset:2048
    ds_read_b128 v[60:63], v1 offset:6144
    v_smfmac_f32_16x16x64_bf16 v[44:47], v[24:27], v[64:71], v6
    ds_read_b128 v[64:67], v1 offset:3072
    ds_read_b128 v[68:71], v1 offset:7168
    s_cbranch_vccnz RETRY_35
BACK_36:
    v_smfmac_f32_16x16x64_bf16 v[32:35], v[28:31], v[240:247], v6
    v_smfmac_f32_16x16x64_bf16 v[36:39], v[28:31], v[248:255], v6
    v_smfmac_f32_16x16x64_bf16 v[40:43], v[28:31], a[240:247], v6
    v_smfmac_f32_16x16x64_bf16 v[44:47], v[28:31], a[248:255], v6
    v_lshlrev_b32 v8, 2, v1
    s_add_u32 s65, s17, s19
    buffer_load_dword v8, s[4:7], s3 offen lds
    buffer_load_dword off, s[4:7], s65 sc1 lds
    buffer_store_dword v6, off, s[4:7], s22 sc1
    s_add_u32 s22, s22, 256
    v_permlane32_swap_b32 v32, v36
    v_permlane32_swap_b32 v33, v37
    v_permlane32_swap_b32 v34, v38
    v_permlane32_swap_b32 v35, v39
    v_pk_add_f32 v[32:33], v[32:33], v[36:37]
    v_pk_add_f32 v[34:35], v[34:35], v[38:39]
    v_cvt_pk_bf16_f32 v36, v32, v33
    v_cvt_pk_bf16_f32 v37, v34, v35
    ds_write_b64 v3, v[36:37] offset:0
    v_permlane32_swap_b32 v40, v44
    v_permlane32_swap_b32 v41, v45
    v_permlane32_swap_b32 v42, v46
    v_permlane32_swap_b32 v43, v47
    v_pk_add_f32 v[40:41], v[40:41], v[44:45]
    v_pk_add_f32 v[42:43], v[42:43], v[46:47]
    v_cvt_pk_bf16_f32 v44, v40, v41
    v_cvt_pk_bf16_f32 v45, v42, v43
    ds_write_b64 v3, v[44:45] offset:2304
    v_smfmac_f32_16x16x64_bf16 v[48:51], v[12:15], a[80:87], v6
    v_smfmac_f32_16x16x64_bf16 v[52:55], v[12:15], a[88:95], v6
    v_smfmac_f32_16x16x64_bf16 v[48:51], v[16:19], a[96:103], v6
    v_smfmac_f32_16x16x64_bf16 v[52:55], v[16:19], a[104:111], v6
    s_waitcnt lgkmcnt(0)
    s_barrier
    ds_read_b64_tr_b16 v[32:33], v4 offset:0
    ds_read_b64_tr_b16 v[34:35], v4 offset:128
    ds_read_b64_tr_b16 v[36:37], v4 offset:256
    ds_read_b64_tr_b16 v[38:39], v4 offset:384
    v_smfmac_f32_16x16x64_bf16 v[48:51], v[20:23], a[112:119], v6
    v_smfmac_f32_16x16x64_bf16 v[52:55], v[20:23], a[120:127], v6
    ds_read_b64_tr_b16 v[40:41], v4 offset:512
    ds_read_b64_tr_b16 v[42:43], v4 offset:640
    ds_read_b64_tr_b16 v[44:45], v4 offset:768
    ds_read_b64_tr_b16 v[46:47], v4 offset:896
    v_smfmac_f32_16x16x64_bf16 v[48:51], v[24:27], a[128:135], v6
    v_smfmac_f32_16x16x64_bf16 v[52:55], v[24:27], a[136:143], v6
    s_waitcnt lgkmcnt(4)
    v_mfma_f32_16x16x32_bf16 v[8:11], v[72:75], v[32:35], 0
    ds_read_b64_tr_b16 v[12:13], v4 offset:2304
    ds_read_b64_tr_b16 v[14:15], v4 offset:2432
    v_mfma_f32_16x16x32_bf16 v[8:11], v[80:83], v[36:39], v[8:11]
    ds_read_b64_tr_b16 v[16:17], v4 offset:2560
    ds_read_b64_tr_b16 v[18:19], v4 offset:2688
    s_waitcnt lgkmcnt(4)
    v_mfma_f32_16x16x32_bf16 v[8:11], v[56:59], v[40:43], v[8:11]
    ds_read_b64_tr_b16 v[56:57], v4 offset:2816
    ds_read_b64_tr_b16 v[58:59], v4 offset:2944
    v_mfma_f32_16x16x32_bf16 v[8:11], v[64:67], v[44:47], v[8:11]
    ds_read_b64_tr_b16 v[64:65], v4 offset:3072
    ds_read_b64_tr_b16 v[66:67], v4 offset:3200
    v_mfma_f32_16x16x32_bf16 v[72:75], v[76:79], v[32:35], 0
    v_mfma_f32_16x16x32_bf16 v[72:75], v[84:87], v[36:39], v[72:75]
    v_mfma_f32_16x16x32_bf16 v[72:75], v[60:63], v[40:43], v[72:75]
    v_mfma_f32_16x16x32_bf16 v[72:75], v[68:71], v[44:47], v[72:75]
    s_waitcnt lgkmcnt(4)
    v_mfma_f32_16x16x32_bf16 v[80:83], v[12:15], v[32:35], 0
    v_mfma_f32_16x16x32_bf16 v[80:83], v[16:19], v[36:39], v[80:83]
    s_waitcnt lgkmcnt(0)
    v_mfma_f32_16x16x32_bf16 v[80:83], v[56:59], v[40:43], v[80:83]
    v_mfma_f32_16x16x32_bf16 v[80:83], v[64:67], v[44:47], v[80:83]
    v_smfmac_f32_16x16x64_bf16 v[48:51], v[28:31], a[144:151], v6
    v_smfmac_f32_16x16x64_bf16 v[52:55], v[28:31], a[152:159], v6
    v_mov_b32 v24, 0x3f803f80
    v_mov_b32 v25, 0x3f803f80
    v_mov_b32 v26, 0x3f803f80
    v_mov_b32 v27, 0x3f803f80
    v_max3_f32 v20, v8, v9, v10
    v_max3_f32 v21, v11, v72, v73
    v_max3_f32 v20, v20, v21, v74
    v_max3_f32 v21, v80, v81, v82
    v_max3_f32 v20, v20, v75, v83
    v_max_f32 v20, v20, v21
    v_mov_b32 v21, v20
    v_cvt_pk_bf16_f32 v48, v48, v49
    v_cvt_pk_bf16_f32 v49, v50, v51
    v_permlane16_swap_b32 v20, v21
    v_max_f32 v20, v20, v21
    v_mov_b32 v21, v20
    v_cvt_pk_bf16_f32 v50, v52, v53
    v_cvt_pk_bf16_f32 v51, v54, v55
    v_permlane32_swap_b32 v20, v21
    v_max_f32 v20, v20, v21
    v_mul_f32 v22, s10, v20
    v_mul_f32 v23, s10, v20
    v_pk_fma_f32 v[8:9], v[8:9], s[10:11], v[22:23] neg_lo:[0,0,1] neg_hi:[0,0,1]
    v_pk_fma_f32 v[10:11], v[10:11], s[10:11], v[22:23] neg_lo:[0,0,1] neg_hi:[0,0,1]
    v_pk_fma_f32 v[72:73], v[72:73], s[10:11], v[22:23] neg_lo:[0,0,1] neg_hi:[0,0,1]
    v_pk_fma_f32 v[74:75], v[74:75], s[10:11], v[22:23] neg_lo:[0,0,1] neg_hi:[0,0,1]
    v_pk_fma_f32 v[80:81], v[80:81], s[10:11], v[22:23] neg_lo:[0,0,1] neg_hi:[0,0,1]
    v_pk_fma_f32 v[82:83], v[82:83], s[10:11], v[22:23] neg_lo:[0,0,1] neg_hi:[0,0,1]
    v_exp_f32 v8, v8
    v_exp_f32 v9, v9
    v_exp_f32 v10, v10
    v_exp_f32 v11, v11
    v_exp_f32 v72, v72
    v_exp_f32 v73, v73
    v_exp_f32 v74, v74
    v_exp_f32 v75, v75
    v_cvt_pk_bf16_f32 v32, v8, v9
    v_cvt_pk_bf16_f32 v33, v10, v11
    v_exp_f32 v80, v80
    v_exp_f32 v81, v81
    v_exp_f32 v82, v82
    v_exp_f32 v83, v83
    v_cvt_pk_bf16_f32 v34, v72, v73
    v_cvt_pk_bf16_f32 v35, v74, v75
    v_cndmask_b32 v12, 0, v24, s[34:35]
    v_cndmask_b32 v13, 0, v24, s[34:35]
    s_waitcnt vmcnt(3)
    v_mfma_f32_16x16x32_bf16 v[8:11], v[24:27], v[32:35], 0
    v_cvt_pk_bf16_f32 v36, v80, v81
    v_mfma_f32_16x16x32_bf16 v[40:43], v[88:91], v[32:35], 0
    v_cvt_pk_bf16_f32 v37, v82, v83
    v_mfma_f32_16x16x32_bf16 v[44:47], v[92:95], v[32:35], 0
    v_mfma_f32_16x16x16_bf16 v[8:11], v[12:13], v[36:37], v[8:11]
    v_mov_b64 v[72:73], 0
    v_mfma_f32_16x16x16_bf16 v[40:43], v[48:49], v[36:37], v[40:43]
    v_mov_b64 v[74:75], 0
    v_mfma_f32_16x16x16_bf16 v[44:47], v[50:51], v[36:37], v[44:47]
    v_mov_b64 v[76:77], 0
    v_mov_b64 v[78:79], 0
    v_mov_b64 v[80:81], 0
    v_mov_b64 v[82:83], 0
    v_rcp_f32 v22, v8
    s_nop 2
    v_cndmask_b32 v40, v44, v40, s[32:33]
    v_cndmask_b32 v41, v45, v41, s[32:33]
    v_cndmask_b32 v42, v46, v42, s[32:33]
    v_cndmask_b32 v43, v47, v43, s[32:33]
    v_mov_b32 v23, v22
    v_pk_mul_f32 v[40:41], v[40:41], v[22:23]
    v_pk_mul_f32 v[42:43], v[42:43], v[22:23]
    v_cvt_pk_bf16_f32 v44, v40, v41
    v_cvt_pk_bf16_f32 v45, v42, v43
    ds_write_b64 v5, v[44:45]
    s_mov_b32 m0, s73
    s_add_u32 s28, s28, 0x80000
    buffer_load_dwordx4 v1, s[4:7], s28 offen lds
    buffer_load_dwordx4 v1, s[4:7], s28 offen offset:1024 lds
    v_and_b32 v9, 0x70, v1
    v_bfe_u32 v29, v1, 8, 1
    v_lshl_add_u32 v9, v29, 3, v9
    v_bfe_u32 v29, v1, 9, 1
    v_lshl_add_u32 v9, v29, 2, v9
    v_mov_b32 v29, 0x40000000
    s_waitcnt lgkmcnt(0)
    s_barrier
    ds_read_b128 v[12:15], v0 offset:0
    ds_read_b128 v[16:19], v0 offset:64
    ds_read_b128 v[20:23], v0 offset:128
    ds_read_b128 v[24:27], v0 offset:192
    v_cndmask_b32 v9, v29, v9, s[32:33]
    v_and_b32 v29, 16, v1
    v_lshlrev_b32 v29, v29, s38
    v_cndmask_b32 v88, 0, v29, s[44:45]
    v_cndmask_b32 v89, 0, v29, s[46:47]
    v_cndmask_b32 v90, 0, v29, s[48:49]
    v_cndmask_b32 v91, 0, v29, s[50:51]
    s_waitcnt lgkmcnt(3)
    v_smfmac_f32_16x16x64_bf16 v[72:75], v[12:15], a[160:167], v6
    s_waitcnt lgkmcnt(2)
    v_smfmac_f32_16x16x64_bf16 v[72:75], v[16:19], a[168:175], v6
    s_waitcnt lgkmcnt(1)
    v_smfmac_f32_16x16x64_bf16 v[72:75], v[20:23], a[176:183], v6
    s_waitcnt lgkmcnt(0)
    v_smfmac_f32_16x16x64_bf16 v[72:75], v[24:27], a[184:191], v6
    v_smfmac_f32_16x16x64_bf16 v[76:79], v[12:15], a[192:199], v6
    v_smfmac_f32_16x16x64_bf16 v[76:79], v[16:19], a[200:207], v6
    v_cvt_pk_bf16_f32 v72, v72, v73
    v_smfmac_f32_16x16x64_bf16 v[76:79], v[20:23], a[208:215], v6
    v_cvt_pk_bf16_f32 v73, v74, v75
    v_smfmac_f32_16x16x64_bf16 v[76:79], v[24:27], a[216:223], v6
    v_and_or_b32 v72, v72, -2, s16
    v_mfma_f32_16x16x32_bf16 v[80:83], v[12:15], a[224:227], 0
    buffer_store_dwordx2 v[72:73], v7, s[4:7], s23 offen sc1
    v_mfma_f32_16x16x32_bf16 v[80:83], v[16:19], a[228:231], v[80:83]
    v_mfma_f32_16x16x32_bf16 v[80:83], v[20:23], a[232:235], v[80:83]
    v_cvt_pk_bf16_f32 v76, v76, v77
    v_cvt_pk_bf16_f32 v77, v78, v79
    v_mfma_f32_16x16x32_bf16 v[80:83], v[24:27], a[236:239], v[80:83]
    v_and_or_b32 v76, v76, -2, s16
    buffer_store_dwordx2 v[76:77], v7, s[4:7], s25 offen sc1
    s_add_u32 s17, s17, 0x4000
    s_add_u32 s3, s3, 0x80000
    s_add_u32 s29, s29, 0x80000
    s_add_u32 s18, s18, 0x4000
    s_add_u32 s21, s21, 0x8000
    s_add_u32 s15, s15, 1
    s_nop 0
    v_cvt_pk_bf16_f32 v80, v80, v81
    v_cvt_pk_bf16_f32 v81, v82, v83
    v_and_or_b32 v80, v80, -2, s16
    s_mov_b64 exec, s[34:35]
    buffer_store_dwordx2 v[80:81], v7, s[4:7], s26 offen sc1
    s_mov_b64 exec, -1
    s_cmp_lg_u32 s42, 0
    s_cbranch_scc1 OWN_38
    s_cmp_lt_u32 s14, 2
    s_cbranch_scc1 IDLE_37
    s_branch REC_POLL_S
OWN_38:
    s_nop 15
    s_nop 13
    buffer_load_dwordx4 v[12:15], v1, s[4:7], s24 offen offset:0 sc1
    buffer_load_dwordx4 v[16:19], v1, s[4:7], s24 offen offset:1024 sc1
    buffer_load_dwordx4 v[20:23], v1, s[4:7], s24 offen offset:2048 sc1
    buffer_load_dwordx4 v[24:27], v1, s[4:7], s24 offen offset:3072 sc1
    ds_read_b128 v[56:59], v2 offset:0
    ds_read_b128 v[60:63], v2 offset:1024
    ds_read_b128 v[64:67], v2 offset:2048
    ds_read_b128 v[68:71], v2 offset:3072
    v_mov_b64 v[32:33], 0
    v_mov_b64 v[34:35], 0
    v_mov_b64 v[36:37], 0
    v_mov_b64 v[38:39], 0
    v_mov_b64 v[40:41], 0
    v_mov_b64 v[42:43], 0
    v_mov_b64 v[44:45], 0
    v_mov_b64 v[46:47], 0
    buffer_load_dwordx4 v[72:75], v1, s[4:7], s24 offen offset:0 sc1
    buffer_load_dwordx4 v[76:79], v1, s[4:7], s24 offen offset:1024 sc1
    buffer_load_dwordx4 v[80:83], v1, s[4:7], s24 offen offset:2048 sc1
    buffer_load_dwordx4 v[84:87], v1, s[4:7], s24 offen offset:3072 sc1
    v_mov_b64 v[48:49], 0
    v_mov_b64 v[50:51], 0
    v_mov_b64 v[52:53], 0
    v_mov_b64 v[54:55], 0
OPOLL_40:
    s_waitcnt vmcnt(7)
    v_mfma_f32_16x16x32_bf16 v[92:95], v[12:15], v[88:91], 0
    v_bitop3_b32 v10, v12, v14, s16 bitop3:0x7e
    s_waitcnt vmcnt(6)
    v_mfma_f32_16x16x32_bf16 v[92:95], v[16:19], v[88:91], v[92:95]
    v_bitop3_b32 v11, v16, v18, s16 bitop3:0x7e
    s_waitcnt vmcnt(5)
    v_mfma_f32_16x16x32_bf16 v[92:95], v[20:23], v[88:91], v[92:95]
    v_bitop3_b32 v30, v20, v22, s16 bitop3:0x7e
    s_waitcnt vmcnt(4)
    v_mfma_f32_16x16x32_bf16 v[92:95], v[24:27], v[88:91], v[92:95]
    v_bitop3_b32 v31, v24, v26, s16 bitop3:0x7e
    v_or3_b32 v10, v10, v11, v30
    v_bitop3_b32 v10, v10, v31, 1 bitop3:0xa8
    v_cmp_ne_u32 vcc, 0, v10
    s_nop 3
    s_cbranch_vccz ODONE_39
    s_add_u32 s40, s40, 1
    buffer_load_dwordx4 v[12:15], v1, s[4:7], s24 offen offset:0 sc1
    buffer_load_dwordx4 v[16:19], v1, s[4:7], s24 offen offset:1024 sc1
    buffer_load_dwordx4 v[20:23], v1, s[4:7], s24 offen offset:2048 sc1
    buffer_load_dwordx4 v[24:27], v1, s[4:7], s24 offen offset:3072 sc1
    s_waitcnt vmcnt(7)
    v_mfma_f32_16x16x32_bf16 v[92:95], v[72:75], v[88:91], 0
    v_bitop3_b32 v10, v72, v74, s16 bitop3:0x7e
    s_waitcnt vmcnt(6)
    v_mfma_f32_16x16x32_bf16 v[92:95], v[76:79], v[88:91], v[92:95]
    v_bitop3_b32 v11, v76, v78, s16 bitop3:0x7e
    s_waitcnt vmcnt(5)
    v_mfma_f32_16x16x32_bf16 v[92:95], v[80:83], v[88:91], v[92:95]
    v_bitop3_b32 v30, v80, v82, s16 bitop3:0x7e
    s_waitcnt vmcnt(4)
    v_mfma_f32_16x16x32_bf16 v[92:95], v[84:87], v[88:91], v[92:95]
    v_bitop3_b32 v31, v84, v86, s16 bitop3:0x7e
    v_or3_b32 v10, v10, v11, v30
    v_bitop3_b32 v10, v10, v31, 1 bitop3:0xa8
    v_cmp_ne_u32 vcc, 0, v10
    s_add_u32 s68, s68, 1
    s_cmp_gt_u32 s68, 262144
    s_cbranch_scc1 ODONE_39
    s_nop 0
    s_cbranch_vccz ODONE_39
    s_add_u32 s40, s40, 1
    buffer_load_dwordx4 v[72:75], v1, s[4:7], s24 offen offset:0 sc1
    buffer_load_dwordx4 v[76:79], v1, s[4:7], s24 offen offset:1024 sc1
    buffer_load_dwordx4 v[80:83], v1, s[4:7], s24 offen offset:2048 sc1
    buffer_load_dwordx4 v[84:87], v1, s[4:7], s24 offen offset:3072 sc1
    s_branch OPOLL_40
ODONE_39:
    v_permlane32_swap_b32 v92, v94
    v_permlane32_swap_b32 v93, v95
    v_add_f32 v92, v92, v94
    v_add_f32 v93, v93, v95
    v_cvt_pk_bf16_f32 v8, v92, v93
    buffer_store_dword v8, v9, s[4:7], s18 offen sc1
    s_barrier
    s_nop 15
    s_nop 15
    s_nop 12
    buffer_store_dword v8, v9, s[4:7], s21 offen sc1
    s_xor_b32 s16, s16, 1
    s_waitcnt vmcnt(2) lgkmcnt(0)
    s_cmp_lt_u32 s15, 63
    s_cbranch_scc1 REC_LOOP_S
    s_branch REC_END
IDLE_37:
    s_barrier
    v_mov_b64 v[32:33], 0
    v_mov_b64 v[34:35], 0
    v_mov_b64 v[36:37], 0
    v_mov_b64 v[38:39], 0
    v_mov_b64 v[40:41], 0
    v_mov_b64 v[42:43], 0
    v_mov_b64 v[44:45], 0
    v_mov_b64 v[46:47], 0
    v_mov_b64 v[48:49], 0
    v_mov_b64 v[50:51], 0
    v_mov_b64 v[52:53], 0
    v_mov_b64 v[54:55], 0
    ds_read_b128 v[56:59], v2 offset:0
    ds_read_b128 v[60:63], v2 offset:1024
    ds_read_b128 v[64:67], v2 offset:2048
    ds_read_b128 v[68:71], v2 offset:3072
    s_xor_b32 s16, s16, 1
    s_waitcnt vmcnt(0)
    s_cmp_lt_u32 s15, 63
    s_cbranch_scc1 REC_LOOP_S
    s_branch REC_END
REC_TAIL_S:
RETRY_21:
SPIN_41:
    buffer_load_dwordx4 v[20:23], v1, s[4:7], s17 offen offset:2048 sc1
    buffer_load_dwordx4 v[24:27], v1, s[4:7], s17 offen offset:3072 sc1
    buffer_load_dwordx4 v[28:31], v1, s[4:7], s74 offen offset:0 sc1
    s_add_u32 s68, s68, 1
    s_add_u32 s40, s40, 1024
    s_cmp_gt_u32 s68, 262144
    s_waitcnt vmcnt(0)
    s_cbranch_scc1 BACK_22
    v_cmp_eq_u32 vcc, -1, v23
    s_cbranch_vccnz SPIN_41
    s_branch BACK_22
RETRY_23:
SPIN_42:
    buffer_load_dwordx4 v[24:27], v1, s[4:7], s17 offen offset:3072 sc1
    buffer_load_dwordx4 v[28:31], v1, s[4:7], s74 offen offset:0 sc1
    s_add_u32 s68, s68, 1
    s_add_u32 s40, s40, 1024
    s_cmp_gt_u32 s68, 262144
    s_waitcnt vmcnt(0)
    s_cbranch_scc1 BACK_24
    v_cmp_eq_u32 vcc, -1, v27
    s_cbranch_vccnz SPIN_42
    s_branch BACK_24
RETRY_25:
SPIN_43:
    buffer_load_dwordx4 v[28:31], v1, s[4:7], s74 offen offset:0 sc1
    s_add_u32 s68, s68, 1
    s_add_u32 s40, s40, 1024
    s_cmp_gt_u32 s68, 262144
    s_waitcnt vmcnt(0)
    s_cbranch_scc1 BACK_26
    v_cmp_eq_u32 vcc, -1, v31
    s_cbranch_vccnz SPIN_43
    s_branch BACK_26
RETRY_27:
SPIN_44:
    buffer_load_dwordx4 v[12:15], v1, s[4:7], s20 offen offset:0 sc1
    buffer_load_dwordx4 v[16:19], v1, s[4:7], s20 offen offset:1024 sc1
    buffer_load_dwordx4 v[20:23], v1, s[4:7], s20 offen offset:2048 sc1
    buffer_load_dwordx4 v[24:27], v1, s[4:7], s20 offen offset:3072 sc1
    s_add_u32 s68, s68, 1
    s_add_u32 s40, s40, 1048576
    s_cmp_gt_u32 s68, 262144
    s_waitcnt vmcnt(0)
    s_cbranch_scc1 BACK_28
    v_cmp_eq_u32 vcc, -1, v15
    s_cbranch_vccnz SPIN_44
    s_branch BACK_28
RETRY_29:
SPIN_45:
    buffer_load_dwordx4 v[16:19], v1, s[4:7], s20 offen offset:1024 sc1
    buffer_load_dwordx4 v[20:23], v1, s[4:7], s20 offen offset:2048 sc1
    buffer_load_dwordx4 v[24:27], v1, s[4:7], s20 offen offset:3072 sc1
    buffer_load_dwordx4 v[28:31], v1, s[4:7], s75 offen offset:0 sc1
    s_add_u32 s68, s68, 1
    s_add_u32 s40, s40, 1048576
    s_cmp_gt_u32 s68, 262144
    s_waitcnt vmcnt(0)
    s_cbranch_scc1 BACK_30
    v_cmp_eq_u32 vcc, -1, v19
    s_cbranch_vccnz SPIN_45
    s_branch BACK_30
RETRY_31:
SPIN_46:
    buffer_load_dwordx4 v[20:23], v1, s[4:7], s20 offen offset:2048 sc1
    buffer_load_dwordx4 v[24:27], v1, s[4:7], s20 offen offset:3072 sc1
    buffer_load_dwordx4 v[28:31], v1, s[4:7], s75 offen offset:0 sc1
    s_add_u32 s68, s68, 1
    s_add_u32 s40, s40, 1048576
    s_cmp_gt_u32 s68, 262144
    s_waitcnt vmcnt(0)
    s_cbranch_scc1 BACK_32
    v_cmp_eq_u32 vcc, -1, v23
    s_cbranch_vccnz SPIN_46
    s_branch BACK_32
RETRY_33:
SPIN_47:
    buffer_load_dwordx4 v[24:27], v1, s[4:7], s20 offen offset:3072 sc1
    buffer_load_dwordx4 v[28:31], v1, s[4:7], s75 offen offset:0 sc1
    s_add_u32 s68, s68, 1
    s_add_u32 s40, s40, 1048576
    s_cmp_gt_u32 s68, 262144
    s_waitcnt vmcnt(0)
    s_cbranch_scc1 BACK_34
    v_cmp_eq_u32 vcc, -1, v27
    s_cbranch_vccnz SPIN_47
    s_branch BACK_34
RETRY_35:
SPIN_48:
    buffer_load_dwordx4 v[28:31], v1, s[4:7], s75 offen offset:0 sc1
    s_add_u32 s68, s68, 1
    s_add_u32 s40, s40, 1048576
    s_cmp_gt_u32 s68, 262144
    s_waitcnt vmcnt(0)
    s_cbranch_scc1 BACK_36
    v_cmp_eq_u32 vcc, -1, v31
    s_cbranch_vccnz SPIN_48
    s_branch BACK_36
REC_POLL:
    s_cmp_lg_u32 s14, 3
    s_cbranch_scc1 NOFLG_49
    s_add_u32 s64, s15, 2
    s_and_b32 s65, s64, 0x43
    s_cmp_lg_u32 s65, 0
    s_cbranch_scc1 NOFLG_49
    s_lshl_b32 s64, s64, 7
    s_add_u32 s64, s64, s69
    v_mov_b32 v29, 0
FSPIN_50:
    buffer_load_dwordx2 v[12:13], v29, s[4:7], s64 offen sc1
    s_add_u32 s68, s68, 1
    s_waitcnt vmcnt(0)
    v_and_b32 v12, v12, v13
    v_cmp_eq_u32 vcc, 0, v12
    s_cbranch_vccz FDONE_51
    s_cmp_gt_u32 s68, 262144
    s_cbranch_scc0 FSPIN_50
FDONE_51:
NOFLG_49:
    s_add_u32 s66, s17, s52
    v_add_u32 v10, s52, v1
    s_xor_b32 s16, s16, 1
    v_mov_b64 v[32:33], 0
    v_mov_b64 v[34:35], 0
    v_mov_b64 v[36:37], 0
    v_mov_b64 v[38:39], 0
    v_mov_b64 v[40:41], 0
    v_mov_b64 v[42:43], 0
    v_mov_b64 v[44:45], 0
    v_mov_b64 v[46:47], 0
    v_mov_b64 v[48:49], 0
    v_mov_b64 v[50:51], 0
    v_mov_b64 v[52:53], 0
    v_mov_b64 v[54:55], 0
    ds_read_b128 v[56:59], v2 offset:0
    ds_read_b128 v[60:63], v2 offset:1024
    ds_read_b128 v[64:67], v2 offset:2048
    ds_read_b128 v[68:71], v2 offset:3072
    s_barrier
    s_cmp_lt_u32 s15, 63
    s_cbranch_scc0 REC_END
    s_nop 14
    buffer_load_dwordx4 v[20:23], v1, s[4:7], s66 offen sc1
    s_nop 7
    buffer_load_dwordx4 v[24:27], v1, s[4:7], s66 offen sc1
    s_nop 7
    buffer_load_dwordx4 v[28:31], v1, s[4:7], s66 offen sc1
IPOLL_52:
    s_waitcnt vmcnt(2)
    ds_write_b128 v10, v[20:23] offset:12800
    v_max3_u32 v11, v20, v21, v22
    v_max_u32 v11, v11, v23
    v_cmp_eq_u32 vcc, -1, v11
    s_cbranch_vccz IOK_53
    buffer_load_dwordx4 v[20:23], v1, s[4:7], s66 offen sc1
    s_waitcnt vmcnt(2)
    ds_write_b128 v10, v[24:27] offset:12800
    v_max3_u32 v11, v24, v25, v26
    v_max_u32 v11, v11, v27
    v_cmp_eq_u32 vcc, -1, v11
    s_cbranch_vccz IOK_53
    buffer_load_dwordx4 v[24:27], v1, s[4:7], s66 offen sc1
    s_waitcnt vmcnt(2)
    ds_write_b128 v10, v[28:31] offset:12800
    v_max3_u32 v11, v28, v29, v30
    v_max_u32 v11, v11, v31
    v_cmp_eq_u32 vcc, -1, v11
    s_add_u32 s68, s68, 1
    s_add_u32 s53, s53, 1
    s_cmp_gt_u32 s68, 262144
    s_cbranch_scc1 IOK_53
    s_cbranch_vccz IOK_53
    buffer_load_dwordx4 v[28:31], v1, s[4:7], s66 offen sc1
    s_branch IPOLL_52
IOK_53:
    s_waitcnt lgkmcnt(0)
REC_LOOP:
    s_barrier
    ds_read_b128 v[12:15], v1 offset:12800
    ds_read_b128 v[16:19], v1 offset:13824
    buffer_load_dwordx4 v[20:23], v1, s[4:7], s17 offen offset:2048
    ds_read_b128 v[72:75], v2 offset:4096
    ds_read_b128 v[76:79], v2 offset:5120
    ds_read_b128 v[80:83], v2 offset:6144
    ds_read_b128 v[84:87], v2 offset:7168
    s_add_u32 s74, s17, 0x1000
    s_add_u32 s20, s20, 0x8000
    s_add_u32 s75, s20, 0x1000
    s_mov_b32 m0, 15360
    s_add_u32 s65, s20, s27
    s_waitcnt lgkmcnt(5)
    v_smfmac_f32_16x16x64_bf16 v[32:35], v[12:15], v[96:103], v6
    buffer_load_dwordx4 v[24:27], v1, s[4:7], s17 offen offset:3072
    v_smfmac_f32_16x16x64_bf16 v[36:39], v[12:15], v[104:111], v6
    v_smfmac_f32_16x16x64_bf16 v[40:43], v[12:15], v[56:63], v6
    buffer_load_dwordx4 v[28:31], v1, s[4:7], s74 offen offset:0
    ds_read_b128 v[56:59], v2 offset:8192
    ds_read_b128 v[60:63], v2 offset:9216
    v_smfmac_f32_16x16x64_bf16 v[44:47], v[12:15], v[64:71], v6
    ds_read_b128 v[64:67], v2 offset:10240
    ds_read_b128 v[68:71], v2 offset:11264
    s_waitcnt lgkmcnt(8)
    v_smfmac_f32_16x16x64_bf16 v[48:51], v[12:15], a[0:7], v6
    v_smfmac_f32_16x16x64_bf16 v[52:55], v[12:15], a[8:15], v6
    buffer_load_dwordx4 v[12:15], v1, s[4:7], s20 offen offset:0
    buffer_load_dword off, s[4:7], s65 lds
    v_smfmac_f32_16x16x64_bf16 v[32:35], v[16:19], v[112:119], v6
    v_smfmac_f32_16x16x64_bf16 v[36:39], v[16:19], v[120:127], v6
    s_waitcnt lgkmcnt(4)
    v_smfmac_f32_16x16x64_bf16 v[40:43], v[16:19], v[72:79], v6
    ds_read_b128 v[72:75], v2 offset:12288
    ds_read_b128 v[76:79], v2 offset:13312
    v_smfmac_f32_16x16x64_bf16 v[44:47], v[16:19], v[80:87], v6
    ds_read_b128 v[80:83], v2 offset:14336
    ds_read_b128 v[84:87], v2 offset:15360
    s_waitcnt vmcnt(4)
    v_cmp_eq_u32 vcc, -1, v23
    v_smfmac_f32_16x16x64_bf16 v[48:51], v[16:19], a[16:23], v6
    v_smfmac_f32_16x16x64_bf16 v[52:55], v[16:19], a[24:31], v6
    s_cbranch_vccnz RETRY_54
BACK_55:
    buffer_load_dwordx4 v[16:19], v1, s[4:7], s20 offen offset:1024
    v_smfmac_f32_16x16x64_bf16 v[32:35], v[20:23], v[128:135], v6
    v_smfmac_f32_16x16x64_bf16 v[36:39], v[20:23], v[136:143], v6
    s_waitcnt lgkmcnt(4)
    v_smfmac_f32_16x16x64_bf16 v[40:43], v[20:23], v[56:63], v6
    ds_read_b128 v[56:59], v2 offset:16384
    ds_read_b128 v[60:63], v2 offset:17408
    v_smfmac_f32_16x16x64_bf16 v[44:47], v[20:23], v[64:71], v6
    ds_read_b128 v[64:67], v2 offset:18432
    ds_read_b128 v[68:71], v2 offset:19456
    s_waitcnt vmcnt(4)
    v_cmp_eq_u32 vcc, -1, v27
    v_smfmac_f32_16x16x64_bf16 v[48:51], v[20:23], a[32:39], v6
    v_smfmac_f32_16x16x64_bf16 v[52:55], v[20:23], a[40:47], v6
    s_cbranch_vccnz RETRY_56
BACK_57:
    buffer_load_dwordx4 v[20:23], v1, s[4:7], s20 offen offset:2048
    v_smfmac_f32_16x16x64_bf16 v[32:35], v[24:27], v[144:151], v6
    v_smfmac_f32_16x16x64_bf16 v[36:39], v[24:27], v[152:159], v6
    s_waitcnt lgkmcnt(4)
    v_smfmac_f32_16x16x64_bf16 v[40:43], v[24:27], v[72:79], v6
    ds_read_b128 v[72:75], v2 offset:20480
    ds_read_b128 v[76:79], v2 offset:21504
    v_smfmac_f32_16x16x64_bf16 v[44:47], v[24:27], v[80:87], v6
    ds_read_b128 v[80:83], v2 offset:22528
    ds_read_b128 v[84:87], v2 offset:23552
    s_waitcnt vmcnt(4)
    v_cmp_eq_u32 vcc, -1, v31
    v_smfmac_f32_16x16x64_bf16 v[48:51], v[24:27], a[48:55], v6
    v_smfmac_f32_16x16x64_bf16 v[52:55], v[24:27], a[56:63], v6
    s_cbranch_vccnz RETRY_58
BACK_59:
    buffer_load_dwordx4 v[24:27], v1, s[4:7], s20 offen offset:3072
    v_smfmac_f32_16x16x64_bf16 v[32:35], v[28:31], v[160:167], v6
    v_smfmac_f32_16x16x64_bf16 v[36:39], v[28:31], v[168:175], v6
    s_waitcnt lgkmcnt(4)
    v_smfmac_f32_16x16x64_bf16 v[40:43], v[28:31], v[56:63], v6
    ds_read_b128 v[56:59], v2 offset:24576
    ds_read_b128 v[60:63], v2 offset:25600
    v_smfmac_f32_16x16x64_bf16 v[44:47], v[28:31], v[64:71], v6
    ds_read_b128 v[64:67], v2 offset:26624
    ds_read_b128 v[68:71], v2 offset:27648
    s_waitcnt vmcnt(4)
    v_cmp_eq_u32 vcc, -1, v15
    v_smfmac_f32_16x16x64_bf16 v[48:51], v[28:31], a[64:71], v6
    v_smfmac_f32_16x16x64_bf16 v[52:55], v[28:31], a[72:79], v6
    s_cbranch_vccnz RETRY_60
BACK_61:
    buffer_load_dwordx4 v[28:31], v1, s[4:7], s75 offen offset:0
    v_smfmac_f32_16x16x64_bf16 v[32:35], v[12:15], v[176:183], v6
    s_waitcnt vmcnt(3)
    v_cmp_eq_u32 vcc, -1, v19
    v_smfmac_f32_16x16x64_bf16 v[36:39], v[12:15], v[184:191], v6
    s_waitcnt lgkmcnt(4)
    v_smfmac_f32_16x16x64_bf16 v[40:43], v[12:15], v[72:79], v6
    ds_read_b128 v[72:75], v2 offset:28672
    ds_read_b128 v[76:79], v2 offset:29696
    v_smfmac_f32_16x16x64_bf16 v[44:47], v[12:15], v[80:87], v6
    ds_read_b128 v[80:83], v2 offset:30720
    ds_read_b128 v[84:87], v2 offset:31744
    buffer_load_dwordx4 v[88:91], v1, s[4:7], s29 offen offset:0
    s_cbranch_vccnz RETRY_62
BACK_63:
    v_smfmac_f32_16x16x64_bf16 v[32:35], v[16:19], v[192:199], v6
    s_waitcnt vmcnt(3)
    v_cmp_eq_u32 vcc, -1, v23
    v_smfmac_f32_16x16x64_bf16 v[36:39], v[16:19], v[200:207], v6
    s_waitcnt lgkmcnt(4)
    v_smfmac_f32_16x16x64_bf16 v[40:43], v[16:19], v[56:63], v6
    ds_read_b128 v[56:59], v2 offset:32768
    ds_read_b128 v[60:63], v2 offset:33792
    v_smfmac_f32_16x16x64_bf16 v[44:47], v[16:19], v[64:71], v6
    ds_read_b128 v[64:67], v2 offset:34816
    ds_read_b128 v[68:71], v2 offset:35840
    s_cbranch_vccnz RETRY_64
BACK_65:
    v_smfmac_f32_16x16x64_bf16 v[32:35], v[20:23], v[208:215], v6
    s_waitcnt vmcnt(2)
    v_cmp_eq_u32 vcc, -1, v27
    v_smfmac_f32_16x16x64_bf16 v[36:39], v[20:23], v[216:223], v6
    s_waitcnt lgkmcnt(4)
    v_smfmac_f32_16x16x64_bf16 v[40:43], v[20:23], v[72:79], v6
    ds_read_b128 v[72:75], v1 offset:0
    ds_read_b128 v[76:79], v1 offset:4096
    v_smfmac_f32_16x16x64_bf16 v[44:47], v[20:23], v[80:87], v6
    ds_read_b128 v[80:83], v1 offset:1024
    ds_read_b128 v[84:87], v1 offset:5120
    buffer_load_dwordx4 v[92:95], v1, s[4:7], s29 offen offset:1024
    s_cbranch_vccnz RETRY_66
BACK_67:
    v_smfmac_f32_16x16x64_bf16 v[32:35], v[24:27], v[224:231], v6
    s_waitcnt vmcnt(2)
    v_cmp_eq_u32 vcc, -1, v31
    v_smfmac_f32_16x16x64_bf16 v[36:39], v[24:27], v[232:239], v6
    s_waitcnt lgkmcnt(4)
    v_smfmac_f32_16x16x64_bf16 v[40:43], v[24:27], v[56:63], v6
    ds_read_b128 v[56:59], v1 offset:2048
    ds_read_b128 v[60:63], v1 offset:6144
    v_smfmac_f32_16x16x64_bf16 v[44:47], v[24:27], v[64:71], v6
    ds_read_b128 v[64:67], v1 offset:3072
    ds_read_b128 v[68:71], v1 offset:7168
    s_cbranch_vccnz RETRY_68
BACK_69:
    v_smfmac_f32_16x16x64_bf16 v[32:35], v[28:31], v[240:247], v6
    v_smfmac_f32_16x16x64_bf16 v[36:39], v[28:31], v[248:255], v6
    v_smfmac_f32_16x16x64_bf16 v[40:43], v[28:31], a[240:247], v6
    v_smfmac_f32_16x16x64_bf16 v[44:47], v[28:31], a[248:255], v6
    v_lshlrev_b32 v8, 2, v1
    s_add_u32 s65, s17, s19
    buffer_load_dword v8, s[4:7], s3 offen lds
    buffer_load_dword off, s[4:7], s65 sc1 lds
    buffer_store_dword v6, off, s[4:7], s22 sc1
    s_add_u32 s22, s22, 256
    v_permlane32_swap_b32 v32, v36
    v_permlane32_swap_b32 v33, v37
    v_permlane32_swap_b32 v34, v38
    v_permlane32_swap_b32 v35, v39
    v_pk_add_f32 v[32:33], v[32:33], v[36:37]
    v_pk_add_f32 v[34:35], v[34:35], v[38:39]
    v_cvt_pk_bf16_f32 v36, v32, v33
    v_cvt_pk_bf16_f32 v37, v34, v35
    ds_write_b64 v3, v[36:37] offset:0
    v_permlane32_swap_b32 v40, v44
    v_permlane32_swap_b32 v41, v45
    v_permlane32_swap_b32 v42, v46
    v_permlane32_swap_b32 v43, v47
    v_pk_add_f32 v[40:41], v[40:41], v[44:45]
    v_pk_add_f32 v[42:43], v[42:43], v[46:47]
    v_cvt_pk_bf16_f32 v44, v40, v41
    v_cvt_pk_bf16_f32 v45, v42, v43
    ds_write_b64 v3, v[44:45] offset:2304
    v_smfmac_f32_16x16x64_bf16 v[48:51], v[12:15], a[80:87], v6
    v_smfmac_f32_16x16x64_bf16 v[52:55], v[12:15], a[88:95], v6
    v_smfmac_f32_16x16x64_bf16 v[48:51], v[16:19], a[96:103], v6
    v_smfmac_f32_16x16x64_bf16 v[52:55], v[16:19], a[104:111], v6
    s_waitcnt lgkmcnt(0)
    s_barrier
    ds_read_b64_tr_b16 v[32:33], v4 offset:0
    ds_read_b64_tr_b16 v[34:35], v4 offset:128
    ds_read_b64_tr_b16 v[36:37], v4 offset:256
    ds_read_b64_tr_b16 v[38:39], v4 offset:384
    v_smfmac_f32_16x16x64_bf16 v[48:51], v[20:23], a[112:119], v6
    v_smfmac_f32_16x16x64_bf16 v[52:55], v[20:23], a[120:127], v6
    ds_read_b64_tr_b16 v[40:41], v4 offset:512
    ds_read_b64_tr_b16 v[42:43], v4 offset:640
    ds_read_b64_tr_b16 v[44:45], v4 offset:768
    ds_read_b64_tr_b16 v[46:47], v4 offset:896
    v_smfmac_f32_16x16x64_bf16 v[48:51], v[24:27], a[128:135], v6
    v_smfmac_f32_16x16x64_bf16 v[52:55], v[24:27], a[136:143], v6
    s_waitcnt lgkmcnt(4)
    v_mfma_f32_16x16x32_bf16 v[8:11], v[72:75], v[32:35], 0
    ds_read_b64_tr_b16 v[12:13], v4 offset:2304
    ds_read_b64_tr_b16 v[14:15], v4 offset:2432
    v_mfma_f32_16x16x32_bf16 v[8:11], v[80:83], v[36:39], v[8:11]
    ds_read_b64_tr_b16 v[16:17], v4 offset:2560
    ds_read_b64_tr_b16 v[18:19], v4 offset:2688
    s_waitcnt lgkmcnt(4)
    v_mfma_f32_16x16x32_bf16 v[8:11], v[56:59], v[40:43], v[8:11]
    ds_read_b64_tr_b16 v[56:57], v4 offset:2816
    ds_read_b64_tr_b16 v[58:59], v4 offset:2944
    v_mfma_f32_16x16x32_bf16 v[8:11], v[64:67], v[44:47], v[8:11]
    ds_read_b64_tr_b16 v[64:65], v4 offset:3072
    ds_read_b64_tr_b16 v[66:67], v4 offset:3200
    v_mfma_f32_16x16x32_bf16 v[72:75], v[76:79], v[32:35], 0
    v_mfma_f32_16x16x32_bf16 v[72:75], v[84:87], v[36:39], v[72:75]
    v_mfma_f32_16x16x32_bf16 v[72:75], v[60:63], v[40:43], v[72:75]
    v_mfma_f32_16x16x32_bf16 v[72:75], v[68:71], v[44:47], v[72:75]
    s_waitcnt lgkmcnt(4)
    v_mfma_f32_16x16x32_bf16 v[80:83], v[12:15], v[32:35], 0
    v_mfma_f32_16x16x32_bf16 v[80:83], v[16:19], v[36:39], v[80:83]
    s_waitcnt lgkmcnt(0)
    v_mfma_f32_16x16x32_bf16 v[80:83], v[56:59], v[40:43], v[80:83]
    v_mfma_f32_16x16x32_bf16 v[80:83], v[64:67], v[44:47], v[80:83]
    v_smfmac_f32_16x16x64_bf16 v[48:51], v[28:31], a[144:151], v6
    v_smfmac_f32_16x16x64_bf16 v[52:55], v[28:31], a[152:159], v6
    v_mov_b32 v24, 0x3f803f80
    v_mov_b32 v25, 0x3f803f80
    v_mov_b32 v26, 0x3f803f80
    v_mov_b32 v27, 0x3f803f80
    v_max3_f32 v20, v8, v9, v10
    v_max3_f32 v21, v11, v72, v73
    v_max3_f32 v20, v20, v21, v74
    v_max3_f32 v21, v80, v81, v82
    v_max3_f32 v20, v20, v75, v83
    v_max_f32 v20, v20, v21
    v_mov_b32 v21, v20
    v_cvt_pk_bf16_f32 v48, v48, v49
    v_cvt_pk_bf16_f32 v49, v50, v51
    v_permlane16_swap_b32 v20, v21
    v_max_f32 v20, v20, v21
    v_mov_b32 v21, v20
    v_cvt_pk_bf16_f32 v50, v52, v53
    v_cvt_pk_bf16_f32 v51, v54, v55
    v_permlane32_swap_b32 v20, v21
    v_max_f32 v20, v20, v21
    v_mul_f32 v22, s10, v20
    v_mul_f32 v23, s10, v20
    v_pk_fma_f32 v[8:9], v[8:9], s[10:11], v[22:23] neg_lo:[0,0,1] neg_hi:[0,0,1]
    v_pk_fma_f32 v[10:11], v[10:11], s[10:11], v[22:23] neg_lo:[0,0,1] neg_hi:[0,0,1]
    v_pk_fma_f32 v[72:73], v[72:73], s[10:11], v[22:23] neg_lo:[0,0,1] neg_hi:[0,0,1]
    v_pk_fma_f32 v[74:75], v[74:75], s[10:11], v[22:23] neg_lo:[0,0,1] neg_hi:[0,0,1]
    v_pk_fma_f32 v[80:81], v[80:81], s[10:11], v[22:23] neg_lo:[0,0,1] neg_hi:[0,0,1]
    v_pk_fma_f32 v[82:83], v[82:83], s[10:11], v[22:23] neg_lo:[0,0,1] neg_hi:[0,0,1]
    v_exp_f32 v8, v8
    v_exp_f32 v9, v9
    v_exp_f32 v10, v10
    v_exp_f32 v11, v11
    v_exp_f32 v72, v72
    v_exp_f32 v73, v73
    v_exp_f32 v74, v74
    v_exp_f32 v75, v75
    v_cvt_pk_bf16_f32 v32, v8, v9
    v_cvt_pk_bf16_f32 v33, v10, v11
    v_exp_f32 v80, v80
    v_exp_f32 v81, v81
    v_exp_f32 v82, v82
    v_exp_f32 v83, v83
    v_cvt_pk_bf16_f32 v34, v72, v73
    v_cvt_pk_bf16_f32 v35, v74, v75
    v_cndmask_b32 v12, 0, v24, s[34:35]
    v_cndmask_b32 v13, 0, v24, s[34:35]
    s_waitcnt vmcnt(3)
    v_mfma_f32_16x16x32_bf16 v[8:11], v[24:27], v[32:35], 0
    v_cvt_pk_bf16_f32 v36, v80, v81
    v_mfma_f32_16x16x32_bf16 v[40:43], v[88:91], v[32:35], 0
    v_cvt_pk_bf16_f32 v37, v82, v83
    v_mfma_f32_16x16x32_bf16 v[44:47], v[92:95], v[32:35], 0
    v_mfma_f32_16x16x16_bf16 v[8:11], v[12:13], v[36:37], v[8:11]
    v_mov_b64 v[72:73], 0
    v_mfma_f32_16x16x16_bf16 v[40:43], v[48:49], v[36:37], v[40:43]
    v_mov_b64 v[74:75], 0
    v_mfma_f32_16x16x16_bf16 v[44:47], v[50:51], v[36:37], v[44:47]
    v_mov_b64 v[76:77], 0
    v_mov_b64 v[78:79], 0
    v_mov_b64 v[80:81], 0
    v_mov_b64 v[82:83], 0
    v_rcp_f32 v22, v8
    s_nop 2
    v_cndmask_b32 v40, v44, v40, s[32:33]
    v_cndmask_b32 v41, v45, v41, s[32:33]
    v_cndmask_b32 v42, v46, v42, s[32:33]
    v_cndmask_b32 v43, v47, v43, s[32:33]
    v_mov_b32 v23, v22
    v_pk_mul_f32 v[40:41], v[40:41], v[22:23]
    v_pk_mul_f32 v[42:43], v[42:43], v[22:23]
    v_cvt_pk_bf16_f32 v44, v40, v41
    v_cvt_pk_bf16_f32 v45, v42, v43
    ds_write_b64 v5, v[44:45]
    s_mov_b32 m0, s73
    s_add_u32 s28, s28, 0x80000
    buffer_load_dwordx4 v1, s[4:7], s28 offen lds
    buffer_load_dwordx4 v1, s[4:7], s28 offen offset:1024 lds
    v_and_b32 v9, 0x70, v1
    v_bfe_u32 v29, v1, 8, 1
    v_lshl_add_u32 v9, v29, 3, v9
    v_bfe_u32 v29, v1, 9, 1
    v_lshl_add_u32 v9, v29, 2, v9
    v_mov_b32 v29, 0x40000000
    s_waitcnt lgkmcnt(0)
    s_barrier
    ds_read_b128 v[12:15], v0 offset:0
    ds_read_b128 v[16:19], v0 offset:64
    ds_read_b128 v[20:23], v0 offset:128
    ds_read_b128 v[24:27], v0 offset:192
    v_cndmask_b32 v9, v29, v9, s[32:33]
    v_and_b32 v29, 16, v1
    v_lshlrev_b32 v29, v29, s38
    v_cndmask_b32 v88, 0, v29, s[44:45]
    v_cndmask_b32 v89, 0, v29, s[46:47]
    v_cndmask_b32 v90, 0, v29, s[48:49]
    v_cndmask_b32 v91, 0, v29, s[50:51]
    s_waitcnt lgkmcnt(3)
    v_smfmac_f32_16x16x64_bf16 v[72:75], v[12:15], a[160:167], v6
    s_waitcnt lgkmcnt(2)
    v_smfmac_f32_16x16x64_bf16 v[72:75], v[16:19], a[168:175], v6
    s_waitcnt lgkmcnt(1)
    v_smfmac_f32_16x16x64_bf16 v[72:75], v[20:23], a[176:183], v6
    s_waitcnt lgkmcnt(0)
    v_smfmac_f32_16x16x64_bf16 v[72:75], v[24:27], a[184:191], v6
    v_smfmac_f32_16x16x64_bf16 v[76:79], v[12:15], a[192:199], v6
    v_smfmac_f32_16x16x64_bf16 v[76:79], v[16:19], a[200:207], v6
    v_cvt_pk_bf16_f32 v72, v72, v73
    v_smfmac_f32_16x16x64_bf16 v[76:79], v[20:23], a[208:215], v6
    v_cvt_pk_bf16_f32 v73, v74, v75
    v_smfmac_f32_16x16x64_bf16 v[76:79], v[24:27], a[216:223], v6
    v_and_or_b32 v72, v72, -2, s16
    v_mfma_f32_16x16x32_bf16 v[80:83], v[12:15], a[224:227], 0
    buffer_store_dwordx2 v[72:73], v7, s[4:7], s23 offen
    v_mfma_f32_16x16x32_bf16 v[80:83], v[16:19], a[228:231], v[80:83]
    v_mfma_f32_16x16x32_bf16 v[80:83], v[20:23], a[232:235], v[80:83]
    v_cvt_pk_bf16_f32 v76, v76, v77
    v_cvt_pk_bf16_f32 v77, v78, v79
    v_mfma_f32_16x16x32_bf16 v[80:83], v[24:27], a[236:239], v[80:83]
    v_and_or_b32 v76, v76, -2, s16
    buffer_store_dwordx2 v[76:77], v7, s[4:7], s25 offen
    s_add_u32 s17, s17, 0x4000
    s_add_u32 s3, s3, 0x80000
    s_add_u32 s29, s29, 0x80000
    s_add_u32 s18, s18, 0x4000
    s_add_u32 s21, s21, 0x8000
    s_add_u32 s15, s15, 1
    s_nop 0
    v_cvt_pk_bf16_f32 v80, v80, v81
    v_cvt_pk_bf16_f32 v81, v82, v83
    v_and_or_b32 v80, v80, -2, s16
    s_mov_b64 exec, s[34:35]
    buffer_store_dwordx2 v[80:81], v7, s[4:7], s26 offen
    s_mov_b64 exec, -1
    s_cmp_lg_u32 s42, 0
    s_cbranch_scc1 OWN_71
    s_cmp_lt_u32 s14, 2
    s_cbranch_scc1 IDLE_70
    s_branch REC_POLL
OWN_71:
    s_nop 15
    s_nop 13
    buffer_load_dwordx4 v[12:15], v1, s[4:7], s24 offen offset:0 sc1
    buffer_load_dwordx4 v[16:19], v1, s[4:7], s24 offen offset:1024 sc1
    buffer_load_dwordx4 v[20:23], v1, s[4:7], s24 offen offset:2048 sc1
    buffer_load_dwordx4 v[24:27], v1, s[4:7], s24 offen offset:3072 sc1
    ds_read_b128 v[56:59], v2 offset:0
    ds_read_b128 v[60:63], v2 offset:1024
    ds_read_b128 v[64:67], v2 offset:2048
    ds_read_b128 v[68:71], v2 offset:3072
    v_mov_b64 v[32:33], 0
    v_mov_b64 v[34:35], 0
    v_mov_b64 v[36:37], 0
    v_mov_b64 v[38:39], 0
    v_mov_b64 v[40:41], 0
    v_mov_b64 v[42:43], 0
    v_mov_b64 v[44:45], 0
    v_mov_b64 v[46:47], 0
    buffer_load_dwordx4 v[72:75], v1, s[4:7], s24 offen offset:0 sc1
    buffer_load_dwordx4 v[76:79], v1, s[4:7], s24 offen offset:1024 sc1
    buffer_load_dwordx4 v[80:83], v1, s[4:7], s24 offen offset:2048 sc1
    buffer_load_dwordx4 v[84:87], v1, s[4:7], s24 offen offset:3072 sc1
    v_mov_b64 v[48:49], 0
    v_mov_b64 v[50:51], 0
    v_mov_b64 v[52:53], 0
    v_mov_b64 v[54:55], 0
OPOLL_73:
    s_waitcnt vmcnt(7)
    v_mfma_f32_16x16x32_bf16 v[92:95], v[12:15], v[88:91], 0
    v_bitop3_b32 v10, v12, v14, s16 bitop3:0x7e
    s_waitcnt vmcnt(6)
    v_mfma_f32_16x16x32_bf16 v[92:95], v[16:19], v[88:91], v[92:95]
    v_bitop3_b32 v11, v16, v18, s16 bitop3:0x7e
    s_waitcnt vmcnt(5)
    v_mfma_f32_16x16x32_bf16 v[92:95], v[20:23], v[88:91], v[92:95]
    v_bitop3_b32 v30, v20, v22, s16 bitop3:0x7e
    s_waitcnt vmcnt(4)
    v_mfma_f32_16x16x32_bf16 v[92:95], v[24:27], v[88:91], v[92:95]
    v_bitop3_b32 v31, v24, v26, s16 bitop3:0x7e
    v_or3_b32 v10, v10, v11, v30
    v_bitop3_b32 v10, v10, v31, 1 bitop3:0xa8
    v_cmp_ne_u32 vcc, 0, v10
    s_nop 3
    s_cbranch_vccz ODONE_72
    s_add_u32 s40, s40, 1
    buffer_load_dwordx4 v[12:15], v1, s[4:7], s24 offen offset:0 sc1
    buffer_load_dwordx4 v[16:19], v1, s[4:7], s24 offen offset:1024 sc1
    buffer_load_dwordx4 v[20:23], v1, s[4:7], s24 offen offset:2048 sc1
    buffer_load_dwordx4 v[24:27], v1, s[4:7], s24 offen offset:3072 sc1
    s_waitcnt vmcnt(7)
    v_mfma_f32_16x16x32_bf16 v[92:95], v[72:75], v[88:91], 0
    v_bitop3_b32 v10, v72, v74, s16 bitop3:0x7e
    s_waitcnt vmcnt(6)
    v_mfma_f32_16x16x32_bf16 v[92:95], v[76:79], v[88:91], v[92:95]
    v_bitop3_b32 v11, v76, v78, s16 bitop3:0x7e
    s_waitcnt vmcnt(5)
    v_mfma_f32_16x16x32_bf16 v[92:95], v[80:83], v[88:91], v[92:95]
    v_bitop3_b32 v30, v80, v82, s16 bitop3:0x7e
    s_waitcnt vmcnt(4)
    v_mfma_f32_16x16x32_bf16 v[92:95], v[84:87], v[88:91], v[92:95]
    v_bitop3_b32 v31, v84, v86, s16 bitop3:0x7e
    v_or3_b32 v10, v10, v11, v30
    v_bitop3_b32 v10, v10, v31, 1 bitop3:0xa8
    v_cmp_ne_u32 vcc, 0, v10
    s_add_u32 s68, s68, 1
    s_cmp_gt_u32 s68, 262144
    s_cbranch_scc1 ODONE_72
    s_nop 0
    s_cbranch_vccz ODONE_72
    s_add_u32 s40, s40, 1
    buffer_load_dwordx4 v[72:75], v1, s[4:7], s24 offen offset:0 sc1
    buffer_load_dwordx4 v[76:79], v1, s[4:7], s24 offen offset:1024 sc1
    buffer_load_dwordx4 v[80:83], v1, s[4:7], s24 offen offset:2048 sc1
    buffer_load_dwordx4 v[84:87], v1, s[4:7], s24 offen offset:3072 sc1
    s_branch OPOLL_73
ODONE_72:
    v_permlane32_swap_b32 v92, v94
    v_permlane32_swap_b32 v93, v95
    v_add_f32 v92, v92, v94
    v_add_f32 v93, v93, v95
    v_cvt_pk_bf16_f32 v8, v92, v93
    buffer_store_dword v8, v9, s[4:7], s18 offen
    s_barrier
    s_nop 15
    s_nop 15
    s_nop 12
    buffer_store_dword v8, v9, s[4:7], s21 offen sc1
    s_xor_b32 s16, s16, 1
    s_waitcnt vmcnt(2) lgkmcnt(0)
    s_cmp_lt_u32 s15, 63
    s_cbranch_scc1 REC_LOOP
    s_branch REC_END
IDLE_70:
    s_barrier
    v_mov_b64 v[32:33], 0
    v_mov_b64 v[34:35], 0
    v_mov_b64 v[36:37], 0
    v_mov_b64 v[38:39], 0
    v_mov_b64 v[40:41], 0
    v_mov_b64 v[42:43], 0
    v_mov_b64 v[44:45], 0
    v_mov_b64 v[46:47], 0
    v_mov_b64 v[48:49], 0
    v_mov_b64 v[50:51], 0
    v_mov_b64 v[52:53], 0
    v_mov_b64 v[54:55], 0
    ds_read_b128 v[56:59], v2 offset:0
    ds_read_b128 v[60:63], v2 offset:1024
    ds_read_b128 v[64:67], v2 offset:2048
    ds_read_b128 v[68:71], v2 offset:3072
    s_xor_b32 s16, s16, 1
    s_waitcnt vmcnt(0)
    s_cmp_lt_u32 s15, 63
    s_cbranch_scc1 REC_LOOP
    s_branch REC_END
REC_TAIL:
RETRY_54:
SPIN_74:
    buffer_load_dwordx4 v[20:23], v1, s[4:7], s17 offen offset:2048 sc1
    buffer_load_dwordx4 v[24:27], v1, s[4:7], s17 offen offset:3072 sc1
    buffer_load_dwordx4 v[28:31], v1, s[4:7], s74 offen offset:0 sc1
    s_add_u32 s68, s68, 1
    s_add_u32 s40, s40, 1024
    s_cmp_gt_u32 s68, 262144
    s_waitcnt vmcnt(0)
    s_cbranch_scc1 BACK_55
    v_cmp_eq_u32 vcc, -1, v23
    s_cbranch_vccnz SPIN_74
    s_branch BACK_55
RETRY_56:
SPIN_75:
    buffer_load_dwordx4 v[24:27], v1, s[4:7], s17 offen offset:3072 sc1
    buffer_load_dwordx4 v[28:31], v1, s[4:7], s74 offen offset:0 sc1
    s_add_u32 s68, s68, 1
    s_add_u32 s40, s40, 1024
    s_cmp_gt_u32 s68, 262144
    s_waitcnt vmcnt(0)
    s_cbranch_scc1 BACK_57
    v_cmp_eq_u32 vcc, -1, v27
    s_cbranch_vccnz SPIN_75
    s_branch BACK_57
RETRY_58:
SPIN_76:
    buffer_load_dwordx4 v[28:31], v1, s[4:7], s74 offen offset:0 sc1
    s_add_u32 s68, s68, 1
    s_add_u32 s40, s40, 1024
    s_cmp_gt_u32 s68, 262144
    s_waitcnt vmcnt(0)
    s_cbranch_scc1 BACK_59
    v_cmp_eq_u32 vcc, -1, v31
    s_cbranch_vccnz SPIN_76
    s_branch BACK_59
RETRY_60:
SPIN_77:
    buffer_load_dwordx4 v[12:15], v1, s[4:7], s20 offen offset:0 sc1
    buffer_load_dwordx4 v[16:19], v1, s[4:7], s20 offen offset:1024 sc1
    buffer_load_dwordx4 v[20:23], v1, s[4:7], s20 offen offset:2048 sc1
    buffer_load_dwordx4 v[24:27], v1, s[4:7], s20 offen offset:3072 sc1
    s_add_u32 s68, s68, 1
    s_add_u32 s40, s40, 1048576
    s_cmp_gt_u32 s68, 262144
    s_waitcnt vmcnt(0)
    s_cbranch_scc1 BACK_61
    v_cmp_eq_u32 vcc, -1, v15
    s_cbranch_vccnz SPIN_77
    s_branch BACK_61
RETRY_62:
SPIN_78:
    buffer_load_dwordx4 v[16:19], v1, s[4:7], s20 offen offset:1024 sc1
    buffer_load_dwordx4 v[20:23], v1, s[4:7], s20 offen offset:2048 sc1
    buffer_load_dwordx4 v[24:27], v1, s[4:7], s20 offen offset:3072 sc1
    buffer_load_dwordx4 v[28:31], v1, s[4:7], s75 offen offset:0 sc1
    s_add_u32 s68, s68, 1
    s_add_u32 s40, s40, 1048576
    s_cmp_gt_u32 s68, 262144
    s_waitcnt vmcnt(0)
    s_cbranch_scc1 BACK_63
    v_cmp_eq_u32 vcc, -1, v19
    s_cbranch_vccnz SPIN_78
    s_branch BACK_63
RETRY_64:
SPIN_79:
    buffer_load_dwordx4 v[20:23], v1, s[4:7], s20 offen offset:2048 sc1
    buffer_load_dwordx4 v[24:27], v1, s[4:7], s20 offen offset:3072 sc1
    buffer_load_dwordx4 v[28:31], v1, s[4:7], s75 offen offset:0 sc1
    s_add_u32 s68, s68, 1
    s_add_u32 s40, s40, 1048576
    s_cmp_gt_u32 s68, 262144
    s_waitcnt vmcnt(0)
    s_cbranch_scc1 BACK_65
    v_cmp_eq_u32 vcc, -1, v23
    s_cbranch_vccnz SPIN_79
    s_branch BACK_65
RETRY_66:
SPIN_80:
    buffer_load_dwordx4 v[24:27], v1, s[4:7], s20 offen offset:3072 sc1
    buffer_load_dwordx4 v[28:31], v1, s[4:7], s75 offen offset:0 sc1
    s_add_u32 s68, s68, 1
    s_add_u32 s40, s40, 1048576
    s_cmp_gt_u32 s68, 262144
    s_waitcnt vmcnt(0)
    s_cbranch_scc1 BACK_67
    v_cmp_eq_u32 vcc, -1, v27
    s_cbranch_vccnz SPIN_80
    s_branch BACK_67
RETRY_68:
SPIN_81:
    buffer_load_dwordx4 v[28:31], v1, s[4:7], s75 offen offset:0 sc1
    s_add_u32 s68, s68, 1
    s_add_u32 s40, s40, 1048576
    s_cmp_gt_u32 s68, 262144
    s_waitcnt vmcnt(0)
    s_cbranch_scc1 BACK_69
    v_cmp_eq_u32 vcc, -1, v31
    s_cbranch_vccnz SPIN_81
    s_branch BACK_69
REC_END:
    buffer_store_dword v6, off, s[4:7], s22 sc1
    s_branch M_EXIT
M_HELP:
    v_mbcnt_lo_u32_b32 v0, -1, 0
    v_mbcnt_hi_u32_b32 v0, -1, v0
    s_load_dwordx2 s[16:17], s[0:1], 0
    s_mov_b32 s18, 2621440
    s_mov_b32 s19, 0x00020000
    s_load_dwordx2 s[20:21], s[0:1], 64
    s_mov_b32 s22, 1280
    s_mov_b32 s23, 0x00020000
    s_load_dwordx2 s[24:25], s[0:1], 8
    s_mov_b32 s26, 10240
    s_mov_b32 s27, 0x00020000
    s_lshl_b32 s28, s96, 2
    s_add_u32 s28, s28, s14
    s_mul_i32 s28, s28, 3
    v_lshlrev_b32 v3, 4, v0
    v_lshlrev_b32 v4, 2, v0
    s_waitcnt lgkmcnt(0)
    s_add_u32 s29, s28, 0
    s_mul_i32 s33, s29, 1280
    buffer_load_dwordx4 v[10:13], v3, s[16:19], s33 offen
    buffer_load_dword v14, v4, s[16:19], s33 offen offset:1024
    s_add_u32 s29, s28, 1
    s_mul_i32 s34, s29, 1280
    buffer_load_dwordx4 v[16:19], v3, s[16:19], s34 offen
    buffer_load_dword v20, v4, s[16:19], s34 offen offset:1024
    s_add_u32 s29, s28, 2
    s_mul_i32 s35, s29, 1280
    buffer_load_dwordx4 v[22:25], v3, s[16:19], s35 offen
    buffer_load_dword v26, v4, s[16:19], s35 offen offset:1024
    buffer_load_dwordx4 v[28:31], v3, s[20:23], 0 offen
    buffer_load_dword v32, v4, s[20:23], 0 offen offset:1024
    s_cmp_ge_u32 s96, 10
    s_cbranch_scc1 INM0_82
    v_and_b32 v5, 7, v0
    v_mul_u32_u24 v5, 1280, v5
    v_lshrrev_b32 v6, 4, v0
    v_lshl_add_u32 v5, v6, 5, v5
    v_bfe_u32 v6, v0, 3, 1
    v_lshl_add_u32 v5, v6, 4, v5
    s_lshl_b32 s29, s96, 7
    buffer_load_dwordx4 v[34:37], v5, s[24:27], s29 offen
INM0_82:
    s_waitcnt vmcnt(0)
    s_add_u32 s29, s28, 0
    s_cmp_ge_u32 s29, 2048
    s_cbranch_scc1 INR_83
    v_lshlrev_b32 v50, 16, v10
    v_and_b32 v60, 0xffff0000, v10
    v_lshlrev_b32 v51, 16, v11
    v_and_b32 v61, 0xffff0000, v11
    v_lshlrev_b32 v52, 16, v12
    v_and_b32 v62, 0xffff0000, v12
    v_lshlrev_b32 v53, 16, v13
    v_and_b32 v63, 0xffff0000, v13
    v_lshlrev_b32 v54, 16, v14
    v_and_b32 v64, 0xffff0000, v14
    v_add_f32 v70, v50, v60
    v_add_f32 v70, v70, v51
    v_add_f32 v70, v70, v61
    v_add_f32 v70, v70, v52
    v_add_f32 v70, v70, v62
    v_add_f32 v70, v70, v53
    v_add_f32 v70, v70, v63
    v_add_f32 v70, v70, v54
    v_add_f32 v70, v70, v64
    s_nop 1
    v_add_f32_dpp v70, v70, v70 quad_perm:[1,0,3,2] row_mask:0xf bank_mask:0xf
    s_nop 1
    v_add_f32_dpp v70, v70, v70 quad_perm:[2,3,0,1] row_mask:0xf bank_mask:0xf
    s_nop 1
    v_add_f32_dpp v70, v70, v70 row_half_mirror row_mask:0xf bank_mask:0xf
    s_nop 1
    v_add_f32_dpp v70, v70, v70 row_mirror row_mask:0xf bank_mask:0xf
    v_mov_b32 v71, v70
    s_nop 1
    v_permlane16_swap_b32 v70, v71
    v_add_f32 v70, v70, v71
    v_mov_b32 v71, v70
    s_nop 1
    v_permlane32_swap_b32 v70, v71
    v_add_f32 v70, v70, v71
    v_mul_f32 v72, 0x3acccccd, v70
    v_mov_b32 v73, 0
    v_sub_f32 v74, v50, v72
    v_fmac_f32 v73, v74, v74
    v_sub_f32 v74, v60, v72
    v_fmac_f32 v73, v74, v74
    v_sub_f32 v74, v51, v72
    v_fmac_f32 v73, v74, v74
    v_sub_f32 v74, v61, v72
    v_fmac_f32 v73, v74, v74
    v_sub_f32 v74, v52, v72
    v_fmac_f32 v73, v74, v74
    v_sub_f32 v74, v62, v72
    v_fmac_f32 v73, v74, v74
    v_sub_f32 v74, v53, v72
    v_fmac_f32 v73, v74, v74
    v_sub_f32 v74, v63, v72
    v_fmac_f32 v73, v74, v74
    v_sub_f32 v74, v54, v72
    v_fmac_f32 v73, v74, v74
    v_sub_f32 v74, v64, v72
    v_fmac_f32 v73, v74, v74
    s_nop 1
    v_add_f32_dpp v73, v73, v73 quad_perm:[1,0,3,2] row_mask:0xf bank_mask:0xf
    s_nop 1
    v_add_f32_dpp v73, v73, v73 quad_perm:[2,3,0,1] row_mask:0xf bank_mask:0xf
    s_nop 1
    v_add_f32_dpp v73, v73, v73 row_half_mirror row_mask:0xf bank_mask:0xf
    s_nop 1
    v_add_f32_dpp v73, v73, v73 row_mirror row_mask:0xf bank_mask:0xf
    v_mov_b32 v71, v73
    s_nop 1
    v_permlane16_swap_b32 v73, v71
    v_add_f32 v73, v73, v71
    v_mov_b32 v71, v73
    s_nop 1
    v_permlane32_swap_b32 v73, v71
    v_add_f32 v73, v73, v71
    v_mul_f32 v73, 0x3acccccd, v73
    v_cvt_pk_bf16_f32 v72, v72, v72
    v_lshlrev_b32 v72, 16, v72
    v_cvt_pk_bf16_f32 v73, v73, v73
    v_lshlrev_b32 v73, 16, v73
    v_add_f32 v73, 0x3727c5ac, v73
    v_cvt_pk_bf16_f32 v73, v73, v73
    v_lshlrev_b32 v73, 16, v73
    v_sqrt_f32 v73, v73
    s_nop 0
    v_cvt_pk_bf16_f32 v73, v73, v73
    v_lshlrev_b32 v73, 16, v73
    v_rcp_f32 v75, v73
    s_nop 0
    v_mov_b32 v76, 0
    v_sub_f32 v50, v50, v72
    v_cvt_pk_bf16_f32 v50, v50, v50
    v_lshlrev_b32 v50, 16, v50
    v_mul_f32 v74, v50, v75
    v_fma_f32 v77, -v74, v73, v50
    v_fma_f32 v50, v77, v75, v74
    v_sub_f32 v60, v60, v72
    v_cvt_pk_bf16_f32 v60, v60, v60
    v_lshlrev_b32 v60, 16, v60
    v_mul_f32 v74, v60, v75
    v_fma_f32 v77, -v74, v73, v60
    v_fma_f32 v60, v77, v75, v74
    v_cvt_pk_bf16_f32 v10, v50, v60
    v_lshlrev_b32 v74, 16, v10
    v_lshlrev_b32 v77, 16, v28
    v_fmac_f32 v76, v74, v77
    v_and_b32 v74, 0xffff0000, v10
    v_and_b32 v77, 0xffff0000, v28
    v_fmac_f32 v76, v74, v77
    v_sub_f32 v51, v51, v72
    v_cvt_pk_bf16_f32 v51, v51, v51
    v_lshlrev_b32 v51, 16, v51
    v_mul_f32 v74, v51, v75
    v_fma_f32 v77, -v74, v73, v51
    v_fma_f32 v51, v77, v75, v74
    v_sub_f32 v61, v61, v72
    v_cvt_pk_bf16_f32 v61, v61, v61
    v_lshlrev_b32 v61, 16, v61
    v_mul_f32 v74, v61, v75
    v_fma_f32 v77, -v74, v73, v61
    v_fma_f32 v61, v77, v75, v74
    v_cvt_pk_bf16_f32 v11, v51, v61
    v_lshlrev_b32 v74, 16, v11
    v_lshlrev_b32 v77, 16, v29
    v_fmac_f32 v76, v74, v77
    v_and_b32 v74, 0xffff0000, v11
    v_and_b32 v77, 0xffff0000, v29
    v_fmac_f32 v76, v74, v77
    v_sub_f32 v52, v52, v72
    v_cvt_pk_bf16_f32 v52, v52, v52
    v_lshlrev_b32 v52, 16, v52
    v_mul_f32 v74, v52, v75
    v_fma_f32 v77, -v74, v73, v52
    v_fma_f32 v52, v77, v75, v74
    v_sub_f32 v62, v62, v72
    v_cvt_pk_bf16_f32 v62, v62, v62
    v_lshlrev_b32 v62, 16, v62
    v_mul_f32 v74, v62, v75
    v_fma_f32 v77, -v74, v73, v62
    v_fma_f32 v62, v77, v75, v74
    v_cvt_pk_bf16_f32 v12, v52, v62
    v_lshlrev_b32 v74, 16, v12
    v_lshlrev_b32 v77, 16, v30
    v_fmac_f32 v76, v74, v77
    v_and_b32 v74, 0xffff0000, v12
    v_and_b32 v77, 0xffff0000, v30
    v_fmac_f32 v76, v74, v77
    v_sub_f32 v53, v53, v72
    v_cvt_pk_bf16_f32 v53, v53, v53
    v_lshlrev_b32 v53, 16, v53
    v_mul_f32 v74, v53, v75
    v_fma_f32 v77, -v74, v73, v53
    v_fma_f32 v53, v77, v75, v74
    v_sub_f32 v63, v63, v72
    v_cvt_pk_bf16_f32 v63, v63, v63
    v_lshlrev_b32 v63, 16, v63
    v_mul_f32 v74, v63, v75
    v_fma_f32 v77, -v74, v73, v63
    v_fma_f32 v63, v77, v75, v74
    v_cvt_pk_bf16_f32 v13, v53, v63
    v_lshlrev_b32 v74, 16, v13
    v_lshlrev_b32 v77, 16, v31
    v_fmac_f32 v76, v74, v77
    v_and_b32 v74, 0xffff0000, v13
    v_and_b32 v77, 0xffff0000, v31
    v_fmac_f32 v76, v74, v77
    v_sub_f32 v54, v54, v72
    v_cvt_pk_bf16_f32 v54, v54, v54
    v_lshlrev_b32 v54, 16, v54
    v_mul_f32 v74, v54, v75
    v_fma_f32 v77, -v74, v73, v54
    v_fma_f32 v54, v77, v75, v74
    v_sub_f32 v64, v64, v72
    v_cvt_pk_bf16_f32 v64, v64, v64
    v_lshlrev_b32 v64, 16, v64
    v_mul_f32 v74, v64, v75
    v_fma_f32 v77, -v74, v73, v64
    v_fma_f32 v64, v77, v75, v74
    v_cvt_pk_bf16_f32 v14, v54, v64
    v_lshlrev_b32 v74, 16, v14
    v_lshlrev_b32 v77, 16, v32
    v_fmac_f32 v76, v74, v77
    v_and_b32 v74, 0xffff0000, v14
    v_and_b32 v77, 0xffff0000, v32
    v_fmac_f32 v76, v74, v77
    s_add_u32 s30, s33, 0x0
    buffer_store_dwordx4 v[10:13], v3, s[4:7], s30 offen sc1
    buffer_store_dword v14, v4, s[4:7], s30 offen offset:1024 sc1
    s_nop 1
    v_add_f32_dpp v76, v76, v76 quad_perm:[1,0,3,2] row_mask:0xf bank_mask:0xf
    s_nop 1
    v_add_f32_dpp v76, v76, v76 quad_perm:[2,3,0,1] row_mask:0xf bank_mask:0xf
    s_nop 1
    v_add_f32_dpp v76, v76, v76 row_half_mirror row_mask:0xf bank_mask:0xf
    s_nop 1
    v_add_f32_dpp v76, v76, v76 row_mirror row_mask:0xf bank_mask:0xf
    v_mov_b32 v71, v76
    s_nop 1
    v_permlane16_swap_b32 v76, v71
    v_add_f32 v76, v76, v71
    v_mov_b32 v71, v76
    s_nop 1
    v_permlane32_swap_b32 v76, v71
    v_add_f32 v76, v76, v71
    v_cvt_pk_bf16_f32 v76, v76, v76
    v_lshlrev_b32 v76, 16, v76
    s_lshl_b32 s30, s29, 2
    s_add_u32 s30, s30, 0x280000
    s_mov_b64 exec, 1
    buffer_store_dword v76, off, s[4:7], s30 sc1
    s_mov_b64 exec, -1
INR_83:
    s_add_u32 s29, s28, 1
    s_cmp_ge_u32 s29, 2048
    s_cbranch_scc1 INR_84
    v_lshlrev_b32 v50, 16, v16
    v_and_b32 v60, 0xffff0000, v16
    v_lshlrev_b32 v51, 16, v17
    v_and_b32 v61, 0xffff0000, v17
    v_lshlrev_b32 v52, 16, v18
    v_and_b32 v62, 0xffff0000, v18
    v_lshlrev_b32 v53, 16, v19
    v_and_b32 v63, 0xffff0000, v19
    v_lshlrev_b32 v54, 16, v20
    v_and_b32 v64, 0xffff0000, v20
    v_add_f32 v70, v50, v60
    v_add_f32 v70, v70, v51
    v_add_f32 v70, v70, v61
    v_add_f32 v70, v70, v52
    v_add_f32 v70, v70, v62
    v_add_f32 v70, v70, v53
    v_add_f32 v70, v70, v63
    v_add_f32 v70, v70, v54
    v_add_f32 v70, v70, v64
    s_nop 1
    v_add_f32_dpp v70, v70, v70 quad_perm:[1,0,3,2] row_mask:0xf bank_mask:0xf
    s_nop 1
    v_add_f32_dpp v70, v70, v70 quad_perm:[2,3,0,1] row_mask:0xf bank_mask:0xf
    s_nop 1
    v_add_f32_dpp v70, v70, v70 row_half_mirror row_mask:0xf bank_mask:0xf
    s_nop 1
    v_add_f32_dpp v70, v70, v70 row_mirror row_mask:0xf bank_mask:0xf
    v_mov_b32 v71, v70
    s_nop 1
    v_permlane16_swap_b32 v70, v71
    v_add_f32 v70, v70, v71
    v_mov_b32 v71, v70
    s_nop 1
    v_permlane32_swap_b32 v70, v71
    v_add_f32 v70, v70, v71
    v_mul_f32 v72, 0x3acccccd, v70
    v_mov_b32 v73, 0
    v_sub_f32 v74, v50, v72
    v_fmac_f32 v73, v74, v74
    v_sub_f32 v74, v60, v72
    v_fmac_f32 v73, v74, v74
    v_sub_f32 v74, v51, v72
    v_fmac_f32 v73, v74, v74
    v_sub_f32 v74, v61, v72
    v_fmac_f32 v73, v74, v74
    v_sub_f32 v74, v52, v72
    v_fmac_f32 v73, v74, v74
    v_sub_f32 v74, v62, v72
    v_fmac_f32 v73, v74, v74
    v_sub_f32 v74, v53, v72
    v_fmac_f32 v73, v74, v74
    v_sub_f32 v74, v63, v72
    v_fmac_f32 v73, v74, v74
    v_sub_f32 v74, v54, v72
    v_fmac_f32 v73, v74, v74
    v_sub_f32 v74, v64, v72
    v_fmac_f32 v73, v74, v74
    s_nop 1
    v_add_f32_dpp v73, v73, v73 quad_perm:[1,0,3,2] row_mask:0xf bank_mask:0xf
    s_nop 1
    v_add_f32_dpp v73, v73, v73 quad_perm:[2,3,0,1] row_mask:0xf bank_mask:0xf
    s_nop 1
    v_add_f32_dpp v73, v73, v73 row_half_mirror row_mask:0xf bank_mask:0xf
    s_nop 1
    v_add_f32_dpp v73, v73, v73 row_mirror row_mask:0xf bank_mask:0xf
    v_mov_b32 v71, v73
    s_nop 1
    v_permlane16_swap_b32 v73, v71
    v_add_f32 v73, v73, v71
    v_mov_b32 v71, v73
    s_nop 1
    v_permlane32_swap_b32 v73, v71
    v_add_f32 v73, v73, v71
    v_mul_f32 v73, 0x3acccccd, v73
    v_cvt_pk_bf16_f32 v72, v72, v72
    v_lshlrev_b32 v72, 16, v72
    v_cvt_pk_bf16_f32 v73, v73, v73
    v_lshlrev_b32 v73, 16, v73
    v_add_f32 v73, 0x3727c5ac, v73
    v_cvt_pk_bf16_f32 v73, v73, v73
    v_lshlrev_b32 v73, 16, v73
    v_sqrt_f32 v73, v73
    s_nop 0
    v_cvt_pk_bf16_f32 v73, v73, v73
    v_lshlrev_b32 v73, 16, v73
    v_rcp_f32 v75, v73
    s_nop 0
    v_mov_b32 v76, 0
    v_sub_f32 v50, v50, v72
    v_cvt_pk_bf16_f32 v50, v50, v50
    v_lshlrev_b32 v50, 16, v50
    v_mul_f32 v74, v50, v75
    v_fma_f32 v77, -v74, v73, v50
    v_fma_f32 v50, v77, v75, v74
    v_sub_f32 v60, v60, v72
    v_cvt_pk_bf16_f32 v60, v60, v60
    v_lshlrev_b32 v60, 16, v60
    v_mul_f32 v74, v60, v75
    v_fma_f32 v77, -v74, v73, v60
    v_fma_f32 v60, v77, v75, v74
    v_cvt_pk_bf16_f32 v16, v50, v60
    v_lshlrev_b32 v74, 16, v16
    v_lshlrev_b32 v77, 16, v28
    v_fmac_f32 v76, v74, v77
    v_and_b32 v74, 0xffff0000, v16
    v_and_b32 v77, 0xffff0000, v28
    v_fmac_f32 v76, v74, v77
    v_sub_f32 v51, v51, v72
    v_cvt_pk_bf16_f32 v51, v51, v51
    v_lshlrev_b32 v51, 16, v51
    v_mul_f32 v74, v51, v75
    v_fma_f32 v77, -v74, v73, v51
    v_fma_f32 v51, v77, v75, v74
    v_sub_f32 v61, v61, v72
    v_cvt_pk_bf16_f32 v61, v61, v61
    v_lshlrev_b32 v61, 16, v61
    v_mul_f32 v74, v61, v75
    v_fma_f32 v77, -v74, v73, v61
    v_fma_f32 v61, v77, v75, v74
    v_cvt_pk_bf16_f32 v17, v51, v61
    v_lshlrev_b32 v74, 16, v17
    v_lshlrev_b32 v77, 16, v29
    v_fmac_f32 v76, v74, v77
    v_and_b32 v74, 0xffff0000, v17
    v_and_b32 v77, 0xffff0000, v29
    v_fmac_f32 v76, v74, v77
    v_sub_f32 v52, v52, v72
    v_cvt_pk_bf16_f32 v52, v52, v52
    v_lshlrev_b32 v52, 16, v52
    v_mul_f32 v74, v52, v75
    v_fma_f32 v77, -v74, v73, v52
    v_fma_f32 v52, v77, v75, v74
    v_sub_f32 v62, v62, v72
    v_cvt_pk_bf16_f32 v62, v62, v62
    v_lshlrev_b32 v62, 16, v62
    v_mul_f32 v74, v62, v75
    v_fma_f32 v77, -v74, v73, v62
    v_fma_f32 v62, v77, v75, v74
    v_cvt_pk_bf16_f32 v18, v52, v62
    v_lshlrev_b32 v74, 16, v18
    v_lshlrev_b32 v77, 16, v30
    v_fmac_f32 v76, v74, v77
    v_and_b32 v74, 0xffff0000, v18
    v_and_b32 v77, 0xffff0000, v30
    v_fmac_f32 v76, v74, v77
    v_sub_f32 v53, v53, v72
    v_cvt_pk_bf16_f32 v53, v53, v53
    v_lshlrev_b32 v53, 16, v53
    v_mul_f32 v74, v53, v75
    v_fma_f32 v77, -v74, v73, v53
    v_fma_f32 v53, v77, v75, v74
    v_sub_f32 v63, v63, v72
    v_cvt_pk_bf16_f32 v63, v63, v63
    v_lshlrev_b32 v63, 16, v63
    v_mul_f32 v74, v63, v75
    v_fma_f32 v77, -v74, v73, v63
    v_fma_f32 v63, v77, v75, v74
    v_cvt_pk_bf16_f32 v19, v53, v63
    v_lshlrev_b32 v74, 16, v19
    v_lshlrev_b32 v77, 16, v31
    v_fmac_f32 v76, v74, v77
    v_and_b32 v74, 0xffff0000, v19
    v_and_b32 v77, 0xffff0000, v31
    v_fmac_f32 v76, v74, v77
    v_sub_f32 v54, v54, v72
    v_cvt_pk_bf16_f32 v54, v54, v54
    v_lshlrev_b32 v54, 16, v54
    v_mul_f32 v74, v54, v75
    v_fma_f32 v77, -v74, v73, v54
    v_fma_f32 v54, v77, v75, v74
    v_sub_f32 v64, v64, v72
    v_cvt_pk_bf16_f32 v64, v64, v64
    v_lshlrev_b32 v64, 16, v64
    v_mul_f32 v74, v64, v75
    v_fma_f32 v77, -v74, v73, v64
    v_fma_f32 v64, v77, v75, v74
    v_cvt_pk_bf16_f32 v20, v54, v64
    v_lshlrev_b32 v74, 16, v20
    v_lshlrev_b32 v77, 16, v32
    v_fmac_f32 v76, v74, v77
    v_and_b32 v74, 0xffff0000, v20
    v_and_b32 v77, 0xffff0000, v32
    v_fmac_f32 v76, v74, v77
    s_add_u32 s30, s34, 0x0
    buffer_store_dwordx4 v[16:19], v3, s[4:7], s30 offen sc1
    buffer_store_dword v20, v4, s[4:7], s30 offen offset:1024 sc1
    s_nop 1
    v_add_f32_dpp v76, v76, v76 quad_perm:[1,0,3,2] row_mask:0xf bank_mask:0xf
    s_nop 1
    v_add_f32_dpp v76, v76, v76 quad_perm:[2,3,0,1] row_mask:0xf bank_mask:0xf
    s_nop 1
    v_add_f32_dpp v76, v76, v76 row_half_mirror row_mask:0xf bank_mask:0xf
    s_nop 1
    v_add_f32_dpp v76, v76, v76 row_mirror row_mask:0xf bank_mask:0xf
    v_mov_b32 v71, v76
    s_nop 1
    v_permlane16_swap_b32 v76, v71
    v_add_f32 v76, v76, v71
    v_mov_b32 v71, v76
    s_nop 1
    v_permlane32_swap_b32 v76, v71
    v_add_f32 v76, v76, v71
    v_cvt_pk_bf16_f32 v76, v76, v76
    v_lshlrev_b32 v76, 16, v76
    s_lshl_b32 s30, s29, 2
    s_add_u32 s30, s30, 0x280000
    s_mov_b64 exec, 1
    buffer_store_dword v76, off, s[4:7], s30 sc1
    s_mov_b64 exec, -1
INR_84:
    s_add_u32 s29, s28, 2
    s_cmp_ge_u32 s29, 2048
    s_cbranch_scc1 INR_85
    v_lshlrev_b32 v50, 16, v22
    v_and_b32 v60, 0xffff0000, v22
    v_lshlrev_b32 v51, 16, v23
    v_and_b32 v61, 0xffff0000, v23
    v_lshlrev_b32 v52, 16, v24
    v_and_b32 v62, 0xffff0000, v24
    v_lshlrev_b32 v53, 16, v25
    v_and_b32 v63, 0xffff0000, v25
    v_lshlrev_b32 v54, 16, v26
    v_and_b32 v64, 0xffff0000, v26
    v_add_f32 v70, v50, v60
    v_add_f32 v70, v70, v51
    v_add_f32 v70, v70, v61
    v_add_f32 v70, v70, v52
    v_add_f32 v70, v70, v62
    v_add_f32 v70, v70, v53
    v_add_f32 v70, v70, v63
    v_add_f32 v70, v70, v54
    v_add_f32 v70, v70, v64
    s_nop 1
    v_add_f32_dpp v70, v70, v70 quad_perm:[1,0,3,2] row_mask:0xf bank_mask:0xf
    s_nop 1
    v_add_f32_dpp v70, v70, v70 quad_perm:[2,3,0,1] row_mask:0xf bank_mask:0xf
    s_nop 1
    v_add_f32_dpp v70, v70, v70 row_half_mirror row_mask:0xf bank_mask:0xf
    s_nop 1
    v_add_f32_dpp v70, v70, v70 row_mirror row_mask:0xf bank_mask:0xf
    v_mov_b32 v71, v70
    s_nop 1
    v_permlane16_swap_b32 v70, v71
    v_add_f32 v70, v70, v71
    v_mov_b32 v71, v70
    s_nop 1
    v_permlane32_swap_b32 v70, v71
    v_add_f32 v70, v70, v71
    v_mul_f32 v72, 0x3acccccd, v70
    v_mov_b32 v73, 0
    v_sub_f32 v74, v50, v72
    v_fmac_f32 v73, v74, v74
    v_sub_f32 v74, v60, v72
    v_fmac_f32 v73, v74, v74
    v_sub_f32 v74, v51, v72
    v_fmac_f32 v73, v74, v74
    v_sub_f32 v74, v61, v72
    v_fmac_f32 v73, v74, v74
    v_sub_f32 v74, v52, v72
    v_fmac_f32 v73, v74, v74
    v_sub_f32 v74, v62, v72
    v_fmac_f32 v73, v74, v74
    v_sub_f32 v74, v53, v72
    v_fmac_f32 v73, v74, v74
    v_sub_f32 v74, v63, v72
    v_fmac_f32 v73, v74, v74
    v_sub_f32 v74, v54, v72
    v_fmac_f32 v73, v74, v74
    v_sub_f32 v74, v64, v72
    v_fmac_f32 v73, v74, v74
    s_nop 1
    v_add_f32_dpp v73, v73, v73 quad_perm:[1,0,3,2] row_mask:0xf bank_mask:0xf
    s_nop 1
    v_add_f32_dpp v73, v73, v73 quad_perm:[2,3,0,1] row_mask:0xf bank_mask:0xf
    s_nop 1
    v_add_f32_dpp v73, v73, v73 row_half_mirror row_mask:0xf bank_mask:0xf
    s_nop 1
    v_add_f32_dpp v73, v73, v73 row_mirror row_mask:0xf bank_mask:0xf
    v_mov_b32 v71, v73
    s_nop 1
    v_permlane16_swap_b32 v73, v71
    v_add_f32 v73, v73, v71
    v_mov_b32 v71, v73
    s_nop 1
    v_permlane32_swap_b32 v73, v71
    v_add_f32 v73, v73, v71
    v_mul_f32 v73, 0x3acccccd, v73
    v_cvt_pk_bf16_f32 v72, v72, v72
    v_lshlrev_b32 v72, 16, v72
    v_cvt_pk_bf16_f32 v73, v73, v73
    v_lshlrev_b32 v73, 16, v73
    v_add_f32 v73, 0x3727c5ac, v73
    v_cvt_pk_bf16_f32 v73, v73, v73
    v_lshlrev_b32 v73, 16, v73
    v_sqrt_f32 v73, v73
    s_nop 0
    v_cvt_pk_bf16_f32 v73, v73, v73
    v_lshlrev_b32 v73, 16, v73
    v_rcp_f32 v75, v73
    s_nop 0
    v_mov_b32 v76, 0
    v_sub_f32 v50, v50, v72
    v_cvt_pk_bf16_f32 v50, v50, v50
    v_lshlrev_b32 v50, 16, v50
    v_mul_f32 v74, v50, v75
    v_fma_f32 v77, -v74, v73, v50
    v_fma_f32 v50, v77, v75, v74
    v_sub_f32 v60, v60, v72
    v_cvt_pk_bf16_f32 v60, v60, v60
    v_lshlrev_b32 v60, 16, v60
    v_mul_f32 v74, v60, v75
    v_fma_f32 v77, -v74, v73, v60
    v_fma_f32 v60, v77, v75, v74
    v_cvt_pk_bf16_f32 v22, v50, v60
    v_lshlrev_b32 v74, 16, v22
    v_lshlrev_b32 v77, 16, v28
    v_fmac_f32 v76, v74, v77
    v_and_b32 v74, 0xffff0000, v22
    v_and_b32 v77, 0xffff0000, v28
    v_fmac_f32 v76, v74, v77
    v_sub_f32 v51, v51, v72
    v_cvt_pk_bf16_f32 v51, v51, v51
    v_lshlrev_b32 v51, 16, v51
    v_mul_f32 v74, v51, v75
    v_fma_f32 v77, -v74, v73, v51
    v_fma_f32 v51, v77, v75, v74
    v_sub_f32 v61, v61, v72
    v_cvt_pk_bf16_f32 v61, v61, v61
    v_lshlrev_b32 v61, 16, v61
    v_mul_f32 v74, v61, v75
    v_fma_f32 v77, -v74, v73, v61
    v_fma_f32 v61, v77, v75, v74
    v_cvt_pk_bf16_f32 v23, v51, v61
    v_lshlrev_b32 v74, 16, v23
    v_lshlrev_b32 v77, 16, v29
    v_fmac_f32 v76, v74, v77
    v_and_b32 v74, 0xffff0000, v23
    v_and_b32 v77, 0xffff0000, v29
    v_fmac_f32 v76, v74, v77
    v_sub_f32 v52, v52, v72
    v_cvt_pk_bf16_f32 v52, v52, v52
    v_lshlrev_b32 v52, 16, v52
    v_mul_f32 v74, v52, v75
    v_fma_f32 v77, -v74, v73, v52
    v_fma_f32 v52, v77, v75, v74
    v_sub_f32 v62, v62, v72
    v_cvt_pk_bf16_f32 v62, v62, v62
    v_lshlrev_b32 v62, 16, v62
    v_mul_f32 v74, v62, v75
    v_fma_f32 v77, -v74, v73, v62
    v_fma_f32 v62, v77, v75, v74
    v_cvt_pk_bf16_f32 v24, v52, v62
    v_lshlrev_b32 v74, 16, v24
    v_lshlrev_b32 v77, 16, v30
    v_fmac_f32 v76, v74, v77
    v_and_b32 v74, 0xffff0000, v24
    v_and_b32 v77, 0xffff0000, v30
    v_fmac_f32 v76, v74, v77
    v_sub_f32 v53, v53, v72
    v_cvt_pk_bf16_f32 v53, v53, v53
    v_lshlrev_b32 v53, 16, v53
    v_mul_f32 v74, v53, v75
    v_fma_f32 v77, -v74, v73, v53
    v_fma_f32 v53, v77, v75, v74
    v_sub_f32 v63, v63, v72
    v_cvt_pk_bf16_f32 v63, v63, v63
    v_lshlrev_b32 v63, 16, v63
    v_mul_f32 v74, v63, v75
    v_fma_f32 v77, -v74, v73, v63
    v_fma_f32 v63, v77, v75, v74
    v_cvt_pk_bf16_f32 v25, v53, v63
    v_lshlrev_b32 v74, 16, v25
    v_lshlrev_b32 v77, 16, v31
    v_fmac_f32 v76, v74, v77
    v_and_b32 v74, 0xffff0000, v25
    v_and_b32 v77, 0xffff0000, v31
    v_fmac_f32 v76, v74, v77
    v_sub_f32 v54, v54, v72
    v_cvt_pk_bf16_f32 v54, v54, v54
    v_lshlrev_b32 v54, 16, v54
    v_mul_f32 v74, v54, v75
    v_fma_f32 v77, -v74, v73, v54
    v_fma_f32 v54, v77, v75, v74
    v_sub_f32 v64, v64, v72
    v_cvt_pk_bf16_f32 v64, v64, v64
    v_lshlrev_b32 v64, 16, v64
    v_mul_f32 v74, v64, v75
    v_fma_f32 v77, -v74, v73, v64
    v_fma_f32 v64, v77, v75, v74
    v_cvt_pk_bf16_f32 v26, v54, v64
    v_lshlrev_b32 v74, 16, v26
    v_lshlrev_b32 v77, 16, v32
    v_fmac_f32 v76, v74, v77
    v_and_b32 v74, 0xffff0000, v26
    v_and_b32 v77, 0xffff0000, v32
    v_fmac_f32 v76, v74, v77
    s_add_u32 s30, s35, 0x0
    buffer_store_dwordx4 v[22:25], v3, s[4:7], s30 offen sc1
    buffer_store_dword v26, v4, s[4:7], s30 offen offset:1024 sc1
    s_nop 1
    v_add_f32_dpp v76, v76, v76 quad_perm:[1,0,3,2] row_mask:0xf bank_mask:0xf
    s_nop 1
    v_add_f32_dpp v76, v76, v76 quad_perm:[2,3,0,1] row_mask:0xf bank_mask:0xf
    s_nop 1
    v_add_f32_dpp v76, v76, v76 row_half_mirror row_mask:0xf bank_mask:0xf
    s_nop 1
    v_add_f32_dpp v76, v76, v76 row_mirror row_mask:0xf bank_mask:0xf
    v_mov_b32 v71, v76
    s_nop 1
    v_permlane16_swap_b32 v76, v71
    v_add_f32 v76, v76, v71
    v_mov_b32 v71, v76
    s_nop 1
    v_permlane32_swap_b32 v76, v71
    v_add_f32 v76, v76, v71
    v_cvt_pk_bf16_f32 v76, v76, v76
    v_lshlrev_b32 v76, 16, v76
    s_lshl_b32 s30, s29, 2
    s_add_u32 s30, s30, 0x280000
    s_mov_b64 exec, 1
    buffer_store_dword v76, off, s[4:7], s30 sc1
    s_mov_b64 exec, -1
INR_85:
    s_lshl_b32 s29, s96, 2
    s_add_u32 s29, s29, s14
    s_lshl_b32 s29, s29, 6
    v_add_u32 v5, s29, v0
    v_lshlrev_b32 v6, 4, v5
    v_mov_b32 v40, -1
    v_mov_b32 v44, 0
    v_mov_b32 v41, -1
    v_mov_b32 v45, 0
    v_mov_b32 v42, -1
    v_mov_b32 v46, 0
    v_mov_b32 v43, -1
    v_mov_b32 v47, 0
    v_cmp_gt_u32 vcc, 0x1000, v5
    s_nop 0
    s_and_saveexec_b64 s[38:39], vcc
    s_cbranch_execz INF_86
    s_mov_b32 s30, 0x290000
    buffer_store_dwordx4 v[44:47], v6, s[4:7], s30 offen sc1
INF_86:
    s_mov_b64 exec, s[38:39]
    v_cmp_gt_u32 vcc, 0x5000, v5
    s_nop 0
    s_and_saveexec_b64 s[38:39], vcc
    s_cbranch_execz INF_87
    s_mov_b32 s30, 0x300000
    buffer_store_dwordx4 v[40:43], v6, s[4:7], s30 offen sc1
INF_87:
    s_mov_b64 exec, s[38:39]
    v_lshrrev_b32 v7, 6, v5
    v_mul_u32_u24 v7, 52429, v7
    v_lshrrev_b32 v7, 18, v7
    v_mul_u32_u24 v8, 320, v7
    v_sub_u32 v8, v5, v8
    v_lshlrev_b32 v48, 4, v8
    v_lshl_add_u32 v49, v7, 13, v48
    v_cmp_gt_u32 vcc, 0xa000, v5
    s_nop 0
    s_and_saveexec_b64 s[38:39], vcc
    s_cbranch_execz INF_88
    s_mov_b32 s30, 0x5904000
    buffer_store_dwordx4 v[40:43], v49, s[4:7], s30 offen sc1
INF_88:
    s_mov_b64 exec, s[38:39]
    s_mov_b32 s65, 0
CW_89:
    buffer_load_dwordx2 v[8:9], off, s[60:63], 0 offset:132 sc1
    s_add_u32 s65, s65, 1
    s_waitcnt vmcnt(0)
    v_readfirstlane_b32 s31, v8
    v_readfirstlane_b32 s32, v9
    s_min_u32 s64, s31, s32
    s_cmp_lg_u32 s64, 0
    s_cbranch_scc1 CWD_90
    s_cmp_gt_u32 s65, 65536
    s_cbranch_scc1 CWD_90
    s_sleep 4
    s_branch CW_89
CWD_90:
    s_sub_u32 s31, s31, 1
    s_and_b32 s31, s31, 3
    s_sub_u32 s32, s32, 1
    s_and_b32 s32, s32, 3
    s_lshl_b32 s31, s31, 13
    s_lshl_b32 s32, s32, 13
    s_add_u32 s32, s32, 0x200000
    v_and_b32 v8, 1, v7
    v_cmp_eq_u32 vcc, 1, v8
    v_mov_b32 v8, s31
    v_mov_b32 v9, s32
    v_cndmask_b32 v8, v8, v9, vcc
    v_lshrrev_b32 v9, 1, v7
    v_lshl_add_u32 v8, v9, 15, v8
    v_add_u32 v49, v8, v48
    v_cmp_le_u32 vcc, 640, v5
    v_mov_b32 v9, 0x40000000
    s_nop 0
    v_cndmask_b32 v49, v9, v49, vcc
    v_cmp_gt_u32 vcc, 0xa000, v5
    s_nop 0
    s_and_saveexec_b64 s[38:39], vcc
    s_cbranch_execz INF_91
    s_mov_b32 s30, 0x6000000
    buffer_store_dwordx4 v[40:43], v49, s[4:7], s30 offen sc1
INF_91:
    s_mov_b64 exec, s[38:39]
    s_cmp_ge_u32 s96, 10
    s_cbranch_scc1 INM1_92
    s_cmp_ge_u32 s14, 2
    s_cbranch_scc1 INM1_92
    s_cmp_ge_u32 s96, 5
    s_cselect_b32 s36, 1, 0
    s_mul_i32 s29, s36, 5
    s_sub_u32 s29, s96, s29
    s_lshl_b32 s29, s29, 10
    s_lshl_b32 s30, s36, 13
    s_add_u32 s30, s30, 0x5900000
    s_cmp_eq_u32 s36, 0
    s_cselect_b32 s37, s31, s32
    s_add_u32 s37, s37, 0x6000000
    s_cmp_eq_u32 s14, 0
    s_cselect_b32 s30, s30, s37
    s_add_u32 s30, s30, s29
    buffer_store_dwordx4 v[34:37], v3, s[4:7], s30 offen sc1
INM1_92:
    s_waitcnt vmcnt(0)
    s_barrier
    s_cmp_lg_u32 s14, 0
    s_cbranch_scc1 INE_93
    s_cmp_lg_u32 s96, 10
    s_cbranch_scc1 ING_94
    v_mov_b32 v44, 1
    v_lshlrev_b32 v6, 7, v0
    s_mov_b32 s30, 0x29a000
    s_mov_b64 exec, 3
    buffer_store_dword v44, v6, s[4:7], s30 offen sc1
    s_mov_b64 exec, -1
    s_waitcnt vmcnt(0)
ING_94:
    v_mov_b32 v8, 1
    s_mov_b64 exec, 1
    buffer_atomic_add v8, off, s[60:63], s95 sc1
    s_mov_b64 exec, -1
INE_93:
    v_mbcnt_lo_u32_b32 v0, -1, 0
    v_mbcnt_hi_u32_b32 v0, -1, v0
    s_and_b32 s12, s96, 1
    s_lshr_b32 s3, s96, 1
    s_and_b32 s13, s3, 31
    s_lshr_b32 s3, s3, 5
    s_load_dwordx4 s[48:51], s[0:1], 16
    s_load_dwordx2 s[52:53], s[0:1], 32
    s_waitcnt lgkmcnt(0)
    s_mov_b32 s46, 5242880
    s_mov_b32 s47, 0x00020000
    s_cmp_eq_u32 s3, 0
    s_cbranch_scc1 H_E0
    s_cmp_eq_u32 s3, 1
    s_cbranch_scc1 H_E1
    s_cmp_eq_u32 s3, 2
    s_cbranch_scc1 H_E2
    s_branch M_EXIT
H_E0:
    s_mov_b32 s44, s50
    s_mov_b32 s45, s51
    s_lshl_b32 s16, s13, 14
    s_mov_b32 s17, 0x80000
    s_lshl_b32 s64, s14, 10
    s_add_u32 s16, s16, 0x1400000
    s_add_u32 s16, s16, s64
    s_mul_i32 s64, s12, s17
    s_lshl_b32 s64, s64, 2
    s_add_u32 s16, s16, s64
    s_lshl_b32 s18, s13, 4
    s_add_u32 s18, s18, 0x291000
    s_branch G_T
H_E1:
    s_mov_b32 s44, s52
    s_mov_b32 s45, s53
    s_lshl_b32 s16, s13, 14
    s_mov_b32 s17, 0x80000
    s_lshl_b32 s64, s14, 11
    s_add_u32 s16, s16, 0x1402000
    s_add_u32 s16, s16, s64
    s_mul_i32 s64, s12, s17
    s_lshl_b32 s64, s64, 2
    s_add_u32 s16, s16, s64
    s_lshl_b32 s18, s13, 4
    s_add_u32 s18, s18, 0x291004
    s_branch G_N
H_E2:
    s_mov_b32 s44, s48
    s_mov_b32 s45, s49
    s_lshl_b32 s16, s13, 13
    s_mov_b32 s17, 0x40000
    s_lshl_b32 s64, s14, 10
    s_add_u32 s16, s16, 0x3400000
    s_add_u32 s16, s16, s64
    s_mul_i32 s64, s12, s17
    s_lshl_b32 s64, s64, 2
    s_add_u32 s16, s16, s64
    s_lshl_b32 s18, s13, 4
    s_add_u32 s18, s18, 0x291008
    s_branch G_T
G_T:
    s_lshl_b32 s65, s13, 8
    s_lshl_b32 s66, s14, 6
    s_add_u32 s20, s65, s66
    s_mul_i32 s21, s14, 36864
    v_lshrrev_b32 v6, 2, v0
    v_mul_u32_u24 v5, 8192, v6
    v_lshrrev_b32 v6, 5, v0
    v_lshlrev_b32 v6, 1, v6
    v_and_b32 v7, 3, v0
    v_xor_b32 v6, v6, v7
    v_lshl_add_u32 v5, v6, 4, v5
    v_lshrrev_b32 v6, 5, v0
    v_lshlrev_b32 v3, 10, v6
    v_bfe_u32 v6, v0, 2, 2
    v_lshl_add_u32 v3, v6, 6, v3
    v_and_b32 v6, 3, v0
    v_lshl_add_u32 v3, v6, 3, v3
    v_bfe_u32 v6, v0, 4, 1
    v_lshl_add_u32 v3, v6, 9, v3
    v_add_u32 v3, s21, v3
    v_lshlrev_b32 v6, 5, v6
    v_sub_u32 v4, 32, v6
    v_add_u32 v4, v4, v3
    v_add_u32 v3, v3, v6
    s_add_u32 m0, s21, 0
    s_add_u32 s64, s20, 0x0
    buffer_load_dwordx4 v5, s[44:47], s64 offen lds
    s_add_u32 m0, s21, 1024
    s_add_u32 s64, s20, 0x20000
    buffer_load_dwordx4 v5, s[44:47], s64 offen lds
    s_add_u32 m0, s21, 2048
    s_add_u32 s64, s20, 0x40000
    buffer_load_dwordx4 v5, s[44:47], s64 offen lds
    s_add_u32 m0, s21, 3072
    s_add_u32 s64, s20, 0x60000
    buffer_load_dwordx4 v5, s[44:47], s64 offen lds
    s_add_u32 m0, s21, 4096
    s_add_u32 s64, s20, 0x80000
    buffer_load_dwordx4 v5, s[44:47], s64 offen lds
    s_add_u32 m0, s21, 5120
    s_add_u32 s64, s20, 0xa0000
    buffer_load_dwordx4 v5, s[44:47], s64 offen lds
    s_add_u32 m0, s21, 6144
    s_add_u32 s64, s20, 0xc0000
    buffer_load_dwordx4 v5, s[44:47], s64 offen lds
    s_add_u32 m0, s21, 7168
    s_add_u32 s64, s20, 0xe0000
    buffer_load_dwordx4 v5, s[44:47], s64 offen lds
    s_add_u32 m0, s21, 8192
    s_add_u32 s64, s20, 0x100000
    buffer_load_dwordx4 v5, s[44:47], s64 offen lds
    s_add_u32 m0, s21, 9216
    s_add_u32 s64, s20, 0x120000
    buffer_load_dwordx4 v5, s[44:47], s64 offen lds
    s_add_u32 m0, s21, 10240
    s_add_u32 s64, s20, 0x140000
    buffer_load_dwordx4 v5, s[44:47], s64 offen lds
    s_add_u32 m0, s21, 11264
    s_add_u32 s64, s20, 0x160000
    buffer_load_dwordx4 v5, s[44:47], s64 offen lds
    s_add_u32 m0, s21, 12288
    s_add_u32 s64, s20, 0x180000
    buffer_load_dwordx4 v5, s[44:47], s64 offen lds
    s_add_u32 m0, s21, 13312
    s_add_u32 s64, s20, 0x1a0000
    buffer_load_dwordx4 v5, s[44:47], s64 offen lds
    s_add_u32 m0, s21, 14336
    s_add_u32 s64, s20, 0x1c0000
    buffer_load_dwordx4 v5, s[44:47], s64 offen lds
    s_add_u32 m0, s21, 15360
    s_add_u32 s64, s20, 0x1e0000
    buffer_load_dwordx4 v5, s[44:47], s64 offen lds
    s_add_u32 m0, s21, 16384
    s_add_u32 s64, s20, 0x200000
    buffer_load_dwordx4 v5, s[44:47], s64 offen lds
    s_add_u32 m0, s21, 17408
    s_add_u32 s64, s20, 0x220000
    buffer_load_dwordx4 v5, s[44:47], s64 offen lds
    s_add_u32 m0, s21, 18432
    s_add_u32 s64, s20, 0x240000
    buffer_load_dwordx4 v5, s[44:47], s64 offen lds
    s_add_u32 m0, s21, 19456
    s_add_u32 s64, s20, 0x260000
    buffer_load_dwordx4 v5, s[44:47], s64 offen lds
    s_add_u32 m0, s21, 20480
    s_add_u32 s64, s20, 0x280000
    buffer_load_dwordx4 v5, s[44:47], s64 offen lds
    s_add_u32 m0, s21, 21504
    s_add_u32 s64, s20, 0x2a0000
    buffer_load_dwordx4 v5, s[44:47], s64 offen lds
    s_add_u32 m0, s21, 22528
    s_add_u32 s64, s20, 0x2c0000
    buffer_load_dwordx4 v5, s[44:47], s64 offen lds
    s_add_u32 m0, s21, 23552
    s_add_u32 s64, s20, 0x2e0000
    buffer_load_dwordx4 v5, s[44:47], s64 offen lds
    s_add_u32 m0, s21, 24576
    s_add_u32 s64, s20, 0x300000
    buffer_load_dwordx4 v5, s[44:47], s64 offen lds
    s_add_u32 m0, s21, 25600
    s_add_u32 s64, s20, 0x320000
    buffer_load_dwordx4 v5, s[44:47], s64 offen lds
    s_add_u32 m0, s21, 26624
    s_add_u32 s64, s20, 0x340000
    buffer_load_dwordx4 v5, s[44:47], s64 offen lds
    s_add_u32 m0, s21, 27648
    s_add_u32 s64, s20, 0x360000
    buffer_load_dwordx4 v5, s[44:47], s64 offen lds
    s_add_u32 m0, s21, 28672
    s_add_u32 s64, s20, 0x380000
    buffer_load_dwordx4 v5, s[44:47], s64 offen lds
    s_add_u32 m0, s21, 29696
    s_add_u32 s64, s20, 0x3a0000
    buffer_load_dwordx4 v5, s[44:47], s64 offen lds
    s_add_u32 m0, s21, 30720
    s_add_u32 s64, s20, 0x3c0000
    buffer_load_dwordx4 v5, s[44:47], s64 offen lds
    s_add_u32 m0, s21, 31744
    s_add_u32 s64, s20, 0x3e0000
    buffer_load_dwordx4 v5, s[44:47], s64 offen lds
    s_add_u32 m0, s21, 32768
    s_add_u32 s64, s20, 0x400000
    buffer_load_dwordx4 v5, s[44:47], s64 offen lds
    s_add_u32 m0, s21, 33792
    s_add_u32 s64, s20, 0x420000
    buffer_load_dwordx4 v5, s[44:47], s64 offen lds
    s_add_u32 m0, s21, 34816
    s_add_u32 s64, s20, 0x440000
    buffer_load_dwordx4 v5, s[44:47], s64 offen lds
    s_add_u32 m0, s21, 35840
    s_add_u32 s64, s20, 0x460000
    buffer_load_dwordx4 v5, s[44:47], s64 offen lds
    s_waitcnt vmcnt(32)
    ds_read_b64_tr_b16 v[96:97], v3 offset:0
    ds_read_b64_tr_b16 v[98:99], v3 offset:256
    ds_read_b64_tr_b16 v[100:101], v4 offset:0
    ds_read_b64_tr_b16 v[102:103], v4 offset:256
    ds_read_b64_tr_b16 v[104:105], v3 offset:2048
    ds_read_b64_tr_b16 v[106:107], v3 offset:2304
    ds_read_b64_tr_b16 v[108:109], v4 offset:2048
    ds_read_b64_tr_b16 v[110:111], v4 offset:2304
    s_waitcnt lgkmcnt(0)
    s_add_u32 m0, s21, 0
    s_add_u32 s64, s20, 0x480000
    buffer_load_dwordx4 v5, s[44:47], s64 offen lds
    s_add_u32 m0, s21, 1024
    s_add_u32 s64, s20, 0x4a0000
    buffer_load_dwordx4 v5, s[44:47], s64 offen lds
    s_add_u32 m0, s21, 2048
    s_add_u32 s64, s20, 0x4c0000
    buffer_load_dwordx4 v5, s[44:47], s64 offen lds
    s_add_u32 m0, s21, 3072
    s_add_u32 s64, s20, 0x4e0000
    buffer_load_dwordx4 v5, s[44:47], s64 offen lds
    s_waitcnt vmcnt(32)
    ds_read_b64_tr_b16 v[112:113], v3 offset:4096
    ds_read_b64_tr_b16 v[114:115], v3 offset:4352
    ds_read_b64_tr_b16 v[116:117], v4 offset:4096
    ds_read_b64_tr_b16 v[118:119], v4 offset:4352
    ds_read_b64_tr_b16 v[120:121], v3 offset:6144
    ds_read_b64_tr_b16 v[122:123], v3 offset:6400
    ds_read_b64_tr_b16 v[124:125], v4 offset:6144
    ds_read_b64_tr_b16 v[126:127], v4 offset:6400
    s_waitcnt lgkmcnt(0)
    s_waitcnt vmcnt(28)
    ds_read_b64_tr_b16 v[128:129], v3 offset:8192
    ds_read_b64_tr_b16 v[130:131], v3 offset:8448
    ds_read_b64_tr_b16 v[132:133], v4 offset:8192
    ds_read_b64_tr_b16 v[134:135], v4 offset:8448
    ds_read_b64_tr_b16 v[136:137], v3 offset:10240
    ds_read_b64_tr_b16 v[138:139], v3 offset:10496
    ds_read_b64_tr_b16 v[140:141], v4 offset:10240
    ds_read_b64_tr_b16 v[142:143], v4 offset:10496
    s_waitcnt lgkmcnt(0)
    s_waitcnt vmcnt(24)
    ds_read_b64_tr_b16 v[144:145], v3 offset:12288
    ds_read_b64_tr_b16 v[146:147], v3 offset:12544
    ds_read_b64_tr_b16 v[148:149], v4 offset:12288
    ds_read_b64_tr_b16 v[150:151], v4 offset:12544
    ds_read_b64_tr_b16 v[152:153], v3 offset:14336
    ds_read_b64_tr_b16 v[154:155], v3 offset:14592
    ds_read_b64_tr_b16 v[156:157], v4 offset:14336
    ds_read_b64_tr_b16 v[158:159], v4 offset:14592
    s_waitcnt lgkmcnt(0)
    s_waitcnt vmcnt(20)
    ds_read_b64_tr_b16 v[160:161], v3 offset:16384
    ds_read_b64_tr_b16 v[162:163], v3 offset:16640
    ds_read_b64_tr_b16 v[164:165], v4 offset:16384
    ds_read_b64_tr_b16 v[166:167], v4 offset:16640
    ds_read_b64_tr_b16 v[168:169], v3 offset:18432
    ds_read_b64_tr_b16 v[170:171], v3 offset:18688
    ds_read_b64_tr_b16 v[172:173], v4 offset:18432
    ds_read_b64_tr_b16 v[174:175], v4 offset:18688
    s_waitcnt lgkmcnt(0)
    s_waitcnt vmcnt(16)
    ds_read_b64_tr_b16 v[176:177], v3 offset:20480
    ds_read_b64_tr_b16 v[178:179], v3 offset:20736
    ds_read_b64_tr_b16 v[180:181], v4 offset:20480
    ds_read_b64_tr_b16 v[182:183], v4 offset:20736
    ds_read_b64_tr_b16 v[184:185], v3 offset:22528
    ds_read_b64_tr_b16 v[186:187], v3 offset:22784
    ds_read_b64_tr_b16 v[188:189], v4 offset:22528
    ds_read_b64_tr_b16 v[190:191], v4 offset:22784
    s_waitcnt lgkmcnt(0)
    s_waitcnt vmcnt(12)
    ds_read_b64_tr_b16 v[192:193], v3 offset:24576
    ds_read_b64_tr_b16 v[194:195], v3 offset:24832
    ds_read_b64_tr_b16 v[196:197], v4 offset:24576
    ds_read_b64_tr_b16 v[198:199], v4 offset:24832
    ds_read_b64_tr_b16 v[200:201], v3 offset:26624
    ds_read_b64_tr_b16 v[202:203], v3 offset:26880
    ds_read_b64_tr_b16 v[204:205], v4 offset:26624
    ds_read_b64_tr_b16 v[206:207], v4 offset:26880
    s_waitcnt lgkmcnt(0)
    s_waitcnt vmcnt(8)
    ds_read_b64_tr_b16 v[208:209], v3 offset:28672
    ds_read_b64_tr_b16 v[210:211], v3 offset:28928
    ds_read_b64_tr_b16 v[212:213], v4 offset:28672
    ds_read_b64_tr_b16 v[214:215], v4 offset:28928
    ds_read_b64_tr_b16 v[216:217], v3 offset:30720
    ds_read_b64_tr_b16 v[218:219], v3 offset:30976
    ds_read_b64_tr_b16 v[220:221], v4 offset:30720
    ds_read_b64_tr_b16 v[222:223], v4 offset:30976
    s_waitcnt lgkmcnt(0)
    s_waitcnt vmcnt(4)
    ds_read_b64_tr_b16 v[224:225], v3 offset:32768
    ds_read_b64_tr_b16 v[226:227], v3 offset:33024
    ds_read_b64_tr_b16 v[228:229], v4 offset:32768
    ds_read_b64_tr_b16 v[230:231], v4 offset:33024
    ds_read_b64_tr_b16 v[232:233], v3 offset:34816
    ds_read_b64_tr_b16 v[234:235], v3 offset:35072
    ds_read_b64_tr_b16 v[236:237], v4 offset:34816
    ds_read_b64_tr_b16 v[238:239], v4 offset:35072
    s_waitcnt lgkmcnt(0)
    s_waitcnt vmcnt(0)
    ds_read_b64_tr_b16 v[240:241], v3 offset:0
    ds_read_b64_tr_b16 v[242:243], v3 offset:256
    ds_read_b64_tr_b16 v[244:245], v4 offset:0
    ds_read_b64_tr_b16 v[246:247], v4 offset:256
    ds_read_b64_tr_b16 v[248:249], v3 offset:2048
    ds_read_b64_tr_b16 v[250:251], v3 offset:2304
    ds_read_b64_tr_b16 v[252:253], v4 offset:2048
    ds_read_b64_tr_b16 v[254:255], v4 offset:2304
    s_waitcnt lgkmcnt(0)
    s_cmp_lg_u32 s97, 0
    s_cbranch_scc1 CM_95
    v_mbcnt_lo_u32_b32 v0, -1, 0
    v_mbcnt_hi_u32_b32 v0, -1, v0
    v_mul_u32_u24 v8, 32, v0
    s_mov_b32 s64, 0x0
    s_mov_b32 s65, 0
    s_mov_b64 exec, 0xff
TK_96:
    buffer_load_dword v9, v8, s[60:63], s64 offen sc1
    s_add_u32 s65, s65, 1
    s_waitcnt vmcnt(0)
    s_mov_b32 s66, 0
    v_readlane_b32 s67, v9, 0
    s_add_u32 s66, s66, s67
    v_readlane_b32 s67, v9, 1
    s_add_u32 s66, s66, s67
    v_readlane_b32 s67, v9, 2
    s_add_u32 s66, s66, s67
    v_readlane_b32 s67, v9, 3
    s_add_u32 s66, s66, s67
    v_readlane_b32 s67, v9, 4
    s_add_u32 s66, s66, s67
    v_readlane_b32 s67, v9, 5
    s_add_u32 s66, s66, s67
    v_readlane_b32 s67, v9, 6
    s_add_u32 s66, s66, s67
    v_readlane_b32 s67, v9, 7
    s_add_u32 s66, s66, s67
    s_cmp_ge_u32 s66, 256
    s_cbranch_scc1 TKD_97
    s_cmp_gt_u32 s65, 262144
    s_cbranch_scc0 TK_96
TKD_97:
    v_cmp_ne_u32 vcc, 32, v9
    s_mov_b64 exec, -1
    s_cbranch_vccnz M_SLOW
CM_95:
    s_mov_b32 s65, 0
GI_98:
    buffer_load_dword v8, off, s[60:63], s95 sc1
    s_add_u32 s65, s65, 1
    s_waitcnt vmcnt(0)
    v_readfirstlane_b32 s64, v8
    s_cmp_ge_u32 s64, 192
    s_cbranch_scc1 GID_99
    s_cmp_gt_u32 s65, 65536
    s_cbranch_scc1 GID_99
    s_sleep 4
    s_branch GI_98
GID_99:
    v_mbcnt_lo_u32_b32 v0, -1, 0
    v_mbcnt_hi_u32_b32 v0, -1, v0
    s_cmp_lg_u32 s3, 2
    s_cbranch_scc1 NOSEL_100
    s_or_b32 s64, s13, s12
    s_or_b32 s64, s64, s14
    s_cmp_lg_u32 s64, 0
    s_cbranch_scc1 NOSEL_100
    s_mov_b32 s29, 0
    v_lshlrev_b32 v1, 4, v0
    s_mov_b32 s64, 0x280000
    buffer_load_dwordx4 v[16:19], v1, s[4:7], s64 offen offset:0 sc1
    buffer_load_dwordx4 v[20:23], v1, s[4:7], s64 offen offset:1024 sc1
    buffer_load_dwordx4 v[24:27], v1, s[4:7], s64 offen offset:2048 sc1
    buffer_load_dwordx4 v[28:31], v1, s[4:7], s64 offen offset:3072 sc1
    s_add_u32 s64, s64, 4096
    buffer_load_dwordx4 v[32:35], v1, s[4:7], s64 offen offset:0 sc1
    buffer_load_dwordx4 v[36:39], v1, s[4:7], s64 offen offset:1024 sc1
    buffer_load_dwordx4 v[40:43], v1, s[4:7], s64 offen offset:2048 sc1
    buffer_load_dwordx4 v[44:47], v1, s[4:7], s64 offen offset:3072 sc1
    s_waitcnt vmcnt(0)
    v_lshlrev_b32 v2, 2, v0
    v_ashrrev_i32 v3, 31, v16
    v_or_b32 v3, 0x80000000, v3
    v_xor_b32 v16, v16, v3
    v_and_b32 v16, 0xffff0000, v16
    v_sub_u32 v3, 65535, v2
    v_or_b32 v16, v16, v3
    v_ashrrev_i32 v3, 31, v17
    v_or_b32 v3, 0x80000000, v3
    v_xor_b32 v17, v17, v3
    v_and_b32 v17, 0xffff0000, v17
    v_sub_u32 v3, 65534, v2
    v_or_b32 v17, v17, v3
    v_ashrrev_i32 v3, 31, v18
    v_or_b32 v3, 0x80000000, v3
    v_xor_b32 v18, v18, v3
    v_and_b32 v18, 0xffff0000, v18
    v_sub_u32 v3, 65533, v2
    v_or_b32 v18, v18, v3
    v_ashrrev_i32 v3, 31, v19
    v_or_b32 v3, 0x80000000, v3
    v_xor_b32 v19, v19, v3
    v_and_b32 v19, 0xffff0000, v19
    v_sub_u32 v3, 65532, v2
    v_or_b32 v19, v19, v3
    v_ashrrev_i32 v3, 31, v20
    v_or_b32 v3, 0x80000000, v3
    v_xor_b32 v20, v20, v3
    v_and_b32 v20, 0xffff0000, v20
    v_sub_u32 v3, 65279, v2
    v_or_b32 v20, v20, v3
    v_ashrrev_i32 v3, 31, v21
    v_or_b32 v3, 0x80000000, v3
    v_xor_b32 v21, v21, v3
    v_and_b32 v21, 0xffff0000, v21
    v_sub_u32 v3, 65278, v2
    v_or_b32 v21, v21, v3
    v_ashrrev_i32 v3, 31, v22
    v_or_b32 v3, 0x80000000, v3
    v_xor_b32 v22, v22, v3
    v_and_b32 v22, 0xffff0000, v22
    v_sub_u32 v3, 65277, v2
    v_or_b32 v22, v22, v3
    v_ashrrev_i32 v3, 31, v23
    v_or_b32 v3, 0x80000000, v3
    v_xor_b32 v23, v23, v3
    v_and_b32 v23, 0xffff0000, v23
    v_sub_u32 v3, 65276, v2
    v_or_b32 v23, v23, v3
    v_ashrrev_i32 v3, 31, v24
    v_or_b32 v3, 0x80000000, v3
    v_xor_b32 v24, v24, v3
    v_and_b32 v24, 0xffff0000, v24
    v_sub_u32 v3, 65023, v2
    v_or_b32 v24, v24, v3
    v_ashrrev_i32 v3, 31, v25
    v_or_b32 v3, 0x80000000, v3
    v_xor_b32 v25, v25, v3
    v_and_b32 v25, 0xffff0000, v25
    v_sub_u32 v3, 65022, v2
    v_or_b32 v25, v25, v3
    v_ashrrev_i32 v3, 31, v26
    v_or_b32 v3, 0x80000000, v3
    v_xor_b32 v26, v26, v3
    v_and_b32 v26, 0xffff0000, v26
    v_sub_u32 v3, 65021, v2
    v_or_b32 v26, v26, v3
    v_ashrrev_i32 v3, 31, v27
    v_or_b32 v3, 0x80000000, v3
    v_xor_b32 v27, v27, v3
    v_and_b32 v27, 0xffff0000, v27
    v_sub_u32 v3, 65020, v2
    v_or_b32 v27, v27, v3
    v_ashrrev_i32 v3, 31, v28
    v_or_b32 v3, 0x80000000, v3
    v_xor_b32 v28, v28, v3
    v_and_b32 v28, 0xffff0000, v28
    v_sub_u32 v3, 64767, v2
    v_or_b32 v28, v28, v3
    v_ashrrev_i32 v3, 31, v29
    v_or_b32 v3, 0x80000000, v3
    v_xor_b32 v29, v29, v3
    v_and_b32 v29, 0xffff0000, v29
    v_sub_u32 v3, 64766, v2
    v_or_b32 v29, v29, v3
    v_ashrrev_i32 v3, 31, v30
    v_or_b32 v3, 0x80000000, v3
    v_xor_b32 v30, v30, v3
    v_and_b32 v30, 0xffff0000, v30
    v_sub_u32 v3, 64765, v2
    v_or_b32 v30, v30, v3
    v_ashrrev_i32 v3, 31, v31
    v_or_b32 v3, 0x80000000, v3
    v_xor_b32 v31, v31, v3
    v_and_b32 v31, 0xffff0000, v31
    v_sub_u32 v3, 64764, v2
    v_or_b32 v31, v31, v3
    v_ashrrev_i32 v3, 31, v32
    v_or_b32 v3, 0x80000000, v3
    v_xor_b32 v32, v32, v3
    v_and_b32 v32, 0xffff0000, v32
    v_sub_u32 v3, 64511, v2
    v_or_b32 v32, v32, v3
    v_ashrrev_i32 v3, 31, v33
    v_or_b32 v3, 0x80000000, v3
    v_xor_b32 v33, v33, v3
    v_and_b32 v33, 0xffff0000, v33
    v_sub_u32 v3, 64510, v2
    v_or_b32 v33, v33, v3
    v_ashrrev_i32 v3, 31, v34
    v_or_b32 v3, 0x80000000, v3
    v_xor_b32 v34, v34, v3
    v_and_b32 v34, 0xffff0000, v34
    v_sub_u32 v3, 64509, v2
    v_or_b32 v34, v34, v3
    v_ashrrev_i32 v3, 31, v35
    v_or_b32 v3, 0x80000000, v3
    v_xor_b32 v35, v35, v3
    v_and_b32 v35, 0xffff0000, v35
    v_sub_u32 v3, 64508, v2
    v_or_b32 v35, v35, v3
    v_ashrrev_i32 v3, 31, v36
    v_or_b32 v3, 0x80000000, v3
    v_xor_b32 v36, v36, v3
    v_and_b32 v36, 0xffff0000, v36
    v_sub_u32 v3, 64255, v2
    v_or_b32 v36, v36, v3
    v_ashrrev_i32 v3, 31, v37
    v_or_b32 v3, 0x80000000, v3
    v_xor_b32 v37, v37, v3
    v_and_b32 v37, 0xffff0000, v37
    v_sub_u32 v3, 64254, v2
    v_or_b32 v37, v37, v3
    v_ashrrev_i32 v3, 31, v38
    v_or_b32 v3, 0x80000000, v3
    v_xor_b32 v38, v38, v3
    v_and_b32 v38, 0xffff0000, v38
    v_sub_u32 v3, 64253, v2
    v_or_b32 v38, v38, v3
    v_ashrrev_i32 v3, 31, v39
    v_or_b32 v3, 0x80000000, v3
    v_xor_b32 v39, v39, v3
    v_and_b32 v39, 0xffff0000, v39
    v_sub_u32 v3, 64252, v2
    v_or_b32 v39, v39, v3
    v_ashrrev_i32 v3, 31, v40
    v_or_b32 v3, 0x80000000, v3
    v_xor_b32 v40, v40, v3
    v_and_b32 v40, 0xffff0000, v40
    v_sub_u32 v3, 63999, v2
    v_or_b32 v40, v40, v3
    v_ashrrev_i32 v3, 31, v41
    v_or_b32 v3, 0x80000000, v3
    v_xor_b32 v41, v41, v3
    v_and_b32 v41, 0xffff0000, v41
    v_sub_u32 v3, 63998, v2
    v_or_b32 v41, v41, v3
    v_ashrrev_i32 v3, 31, v42
    v_or_b32 v3, 0x80000000, v3
    v_xor_b32 v42, v42, v3
    v_and_b32 v42, 0xffff0000, v42
    v_sub_u32 v3, 63997, v2
    v_or_b32 v42, v42, v3
    v_ashrrev_i32 v3, 31, v43
    v_or_b32 v3, 0x80000000, v3
    v_xor_b32 v43, v43, v3
    v_and_b32 v43, 0xffff0000, v43
    v_sub_u32 v3, 63996, v2
    v_or_b32 v43, v43, v3
    v_ashrrev_i32 v3, 31, v44
    v_or_b32 v3, 0x80000000, v3
    v_xor_b32 v44, v44, v3
    v_and_b32 v44, 0xffff0000, v44
    v_sub_u32 v3, 63743, v2
    v_or_b32 v44, v44, v3
    v_ashrrev_i32 v3, 31, v45
    v_or_b32 v3, 0x80000000, v3
    v_xor_b32 v45, v45, v3
    v_and_b32 v45, 0xffff0000, v45
    v_sub_u32 v3, 63742, v2
    v_or_b32 v45, v45, v3
    v_ashrrev_i32 v3, 31, v46
    v_or_b32 v3, 0x80000000, v3
    v_xor_b32 v46, v46, v3
    v_and_b32 v46, 0xffff0000, v46
    v_sub_u32 v3, 63741, v2
    v_or_b32 v46, v46, v3
    v_ashrrev_i32 v3, 31, v47
    v_or_b32 v3, 0x80000000, v3
    v_xor_b32 v47, v47, v3
    v_and_b32 v47, 0xffff0000, v47
    v_sub_u32 v3, 63740, v2
    v_or_b32 v47, v47, v3
    v_max3_u32 v4, v16, v17, v18
    v_max3_u32 v4, v4, v19, v20
    v_max3_u32 v4, v4, v21, v22
    v_max3_u32 v4, v4, v23, v24
    v_max3_u32 v4, v4, v25, v26
    v_max3_u32 v4, v4, v27, v28
    v_max3_u32 v4, v4, v29, v30
    v_max3_u32 v4, v4, v31, v32
    v_max3_u32 v4, v4, v33, v34
    v_max3_u32 v4, v4, v35, v36
    v_max3_u32 v4, v4, v37, v38
    v_max3_u32 v4, v4, v39, v40
    v_max3_u32 v4, v4, v41, v42
    v_max3_u32 v4, v4, v43, v44
    v_max3_u32 v4, v4, v45, v46
    v_max_u32 v4, v4, v47
    s_nop 1
    v_max_u32_dpp v4, v4, v4 quad_perm:[1,0,3,2] row_mask:0xf bank_mask:0xf
    s_nop 1
    v_max_u32_dpp v4, v4, v4 quad_perm:[2,3,0,1] row_mask:0xf bank_mask:0xf
    s_nop 1
    v_max_u32_dpp v4, v4, v4 row_half_mirror row_mask:0xf bank_mask:0xf
    s_nop 1
    v_max_u32_dpp v4, v4, v4 row_mirror row_mask:0xf bank_mask:0xf
    v_mov_b32 v5, v4
    s_nop 1
    v_permlane16_swap_b32 v4, v5
    v_max_u32 v4, v4, v5
    v_mov_b32 v5, v4
    s_nop 1
    v_permlane32_swap_b32 v4, v5
    v_max_u32 v4, v4, v5
    v_mov_b32 v56, v4
    v_cmp_eq_u32 vcc, v4, v16
    s_nop 1
    v_cndmask_b32 v16, v16, 0, vcc
    v_cmp_eq_u32 vcc, v4, v17
    s_nop 1
    v_cndmask_b32 v17, v17, 0, vcc
    v_cmp_eq_u32 vcc, v4, v18
    s_nop 1
    v_cndmask_b32 v18, v18, 0, vcc
    v_cmp_eq_u32 vcc, v4, v19
    s_nop 1
    v_cndmask_b32 v19, v19, 0, vcc
    v_cmp_eq_u32 vcc, v4, v20
    s_nop 1
    v_cndmask_b32 v20, v20, 0, vcc
    v_cmp_eq_u32 vcc, v4, v21
    s_nop 1
    v_cndmask_b32 v21, v21, 0, vcc
    v_cmp_eq_u32 vcc, v4, v22
    s_nop 1
    v_cndmask_b32 v22, v22, 0, vcc
    v_cmp_eq_u32 vcc, v4, v23
    s_nop 1
    v_cndmask_b32 v23, v23, 0, vcc
    v_cmp_eq_u32 vcc, v4, v24
    s_nop 1
    v_cndmask_b32 v24, v24, 0, vcc
    v_cmp_eq_u32 vcc, v4, v25
    s_nop 1
    v_cndmask_b32 v25, v25, 0, vcc
    v_cmp_eq_u32 vcc, v4, v26
    s_nop 1
    v_cndmask_b32 v26, v26, 0, vcc
    v_cmp_eq_u32 vcc, v4, v27
    s_nop 1
    v_cndmask_b32 v27, v27, 0, vcc
    v_cmp_eq_u32 vcc, v4, v28
    s_nop 1
    v_cndmask_b32 v28, v28, 0, vcc
    v_cmp_eq_u32 vcc, v4, v29
    s_nop 1
    v_cndmask_b32 v29, v29, 0, vcc
    v_cmp_eq_u32 vcc, v4, v30
    s_nop 1
    v_cndmask_b32 v30, v30, 0, vcc
    v_cmp_eq_u32 vcc, v4, v31
    s_nop 1
    v_cndmask_b32 v31, v31, 0, vcc
    v_cmp_eq_u32 vcc, v4, v32
    s_nop 1
    v_cndmask_b32 v32, v32, 0, vcc
    v_cmp_eq_u32 vcc, v4, v33
    s_nop 1
    v_cndmask_b32 v33, v33, 0, vcc
    v_cmp_eq_u32 vcc, v4, v34
    s_nop 1
    v_cndmask_b32 v34, v34, 0, vcc
    v_cmp_eq_u32 vcc, v4, v35
    s_nop 1
    v_cndmask_b32 v35, v35, 0, vcc
    v_cmp_eq_u32 vcc, v4, v36
    s_nop 1
    v_cndmask_b32 v36, v36, 0, vcc
    v_cmp_eq_u32 vcc, v4, v37
    s_nop 1
    v_cndmask_b32 v37, v37, 0, vcc
    v_cmp_eq_u32 vcc, v4, v38
    s_nop 1
    v_cndmask_b32 v38, v38, 0, vcc
    v_cmp_eq_u32 vcc, v4, v39
    s_nop 1
    v_cndmask_b32 v39, v39, 0, vcc
    v_cmp_eq_u32 vcc, v4, v40
    s_nop 1
    v_cndmask_b32 v40, v40, 0, vcc
    v_cmp_eq_u32 vcc, v4, v41
    s_nop 1
    v_cndmask_b32 v41, v41, 0, vcc
    v_cmp_eq_u32 vcc, v4, v42
    s_nop 1
    v_cndmask_b32 v42, v42, 0, vcc
    v_cmp_eq_u32 vcc, v4, v43
    s_nop 1
    v_cndmask_b32 v43, v43, 0, vcc
    v_cmp_eq_u32 vcc, v4, v44
    s_nop 1
    v_cndmask_b32 v44, v44, 0, vcc
    v_cmp_eq_u32 vcc, v4, v45
    s_nop 1
    v_cndmask_b32 v45, v45, 0, vcc
    v_cmp_eq_u32 vcc, v4, v46
    s_nop 1
    v_cndmask_b32 v46, v46, 0, vcc
    v_cmp_eq_u32 vcc, v4, v47
    s_nop 1
    v_cndmask_b32 v47, v47, 0, vcc
    v_max3_u32 v4, v16, v17, v18
    v_max3_u32 v4, v4, v19, v20
    v_max3_u32 v4, v4, v21, v22
    v_max3_u32 v4, v4, v23, v24
    v_max3_u32 v4, v4, v25, v26
    v_max3_u32 v4, v4, v27, v28
    v_max3_u32 v4, v4, v29, v30
    v_max3_u32 v4, v4, v31, v32
    v_max3_u32 v4, v4, v33, v34
    v_max3_u32 v4, v4, v35, v36
    v_max3_u32 v4, v4, v37, v38
    v_max3_u32 v4, v4, v39, v40
    v_max3_u32 v4, v4, v41, v42
    v_max3_u32 v4, v4, v43, v44
    v_max3_u32 v4, v4, v45, v46
    v_max_u32 v4, v4, v47
    s_nop 1
    v_max_u32_dpp v4, v4, v4 quad_perm:[1,0,3,2] row_mask:0xf bank_mask:0xf
    s_nop 1
    v_max_u32_dpp v4, v4, v4 quad_perm:[2,3,0,1] row_mask:0xf bank_mask:0xf
    s_nop 1
    v_max_u32_dpp v4, v4, v4 row_half_mirror row_mask:0xf bank_mask:0xf
    s_nop 1
    v_max_u32_dpp v4, v4, v4 row_mirror row_mask:0xf bank_mask:0xf
    v_mov_b32 v5, v4
    s_nop 1
    v_permlane16_swap_b32 v4, v5
    v_max_u32 v4, v4, v5
    v_mov_b32 v5, v4
    s_nop 1
    v_permlane32_swap_b32 v4, v5
    v_max_u32 v4, v4, v5
    v_mov_b32 v57, v4
    v_cmp_eq_u32 vcc, v4, v16
    s_nop 1
    v_cndmask_b32 v16, v16, 0, vcc
    v_cmp_eq_u32 vcc, v4, v17
    s_nop 1
    v_cndmask_b32 v17, v17, 0, vcc
    v_cmp_eq_u32 vcc, v4, v18
    s_nop 1
    v_cndmask_b32 v18, v18, 0, vcc
    v_cmp_eq_u32 vcc, v4, v19
    s_nop 1
    v_cndmask_b32 v19, v19, 0, vcc
    v_cmp_eq_u32 vcc, v4, v20
    s_nop 1
    v_cndmask_b32 v20, v20, 0, vcc
    v_cmp_eq_u32 vcc, v4, v21
    s_nop 1
    v_cndmask_b32 v21, v21, 0, vcc
    v_cmp_eq_u32 vcc, v4, v22
    s_nop 1
    v_cndmask_b32 v22, v22, 0, vcc
    v_cmp_eq_u32 vcc, v4, v23
    s_nop 1
    v_cndmask_b32 v23, v23, 0, vcc
    v_cmp_eq_u32 vcc, v4, v24
    s_nop 1
    v_cndmask_b32 v24, v24, 0, vcc
    v_cmp_eq_u32 vcc, v4, v25
    s_nop 1
    v_cndmask_b32 v25, v25, 0, vcc
    v_cmp_eq_u32 vcc, v4, v26
    s_nop 1
    v_cndmask_b32 v26, v26, 0, vcc
    v_cmp_eq_u32 vcc, v4, v27
    s_nop 1
    v_cndmask_b32 v27, v27, 0, vcc
    v_cmp_eq_u32 vcc, v4, v28
    s_nop 1
    v_cndmask_b32 v28, v28, 0, vcc
    v_cmp_eq_u32 vcc, v4, v29
    s_nop 1
    v_cndmask_b32 v29, v29, 0, vcc
    v_cmp_eq_u32 vcc, v4, v30
    s_nop 1
    v_cndmask_b32 v30, v30, 0, vcc
    v_cmp_eq_u32 vcc, v4, v31
    s_nop 1
    v_cndmask_b32 v31, v31, 0, vcc
    v_cmp_eq_u32 vcc, v4, v32
    s_nop 1
    v_cndmask_b32 v32, v32, 0, vcc
    v_cmp_eq_u32 vcc, v4, v33
    s_nop 1
    v_cndmask_b32 v33, v33, 0, vcc
    v_cmp_eq_u32 vcc, v4, v34
    s_nop 1
    v_cndmask_b32 v34, v34, 0, vcc
    v_cmp_eq_u32 vcc, v4, v35
    s_nop 1
    v_cndmask_b32 v35, v35, 0, vcc
    v_cmp_eq_u32 vcc, v4, v36
    s_nop 1
    v_cndmask_b32 v36, v36, 0, vcc
    v_cmp_eq_u32 vcc, v4, v37
    s_nop 1
    v_cndmask_b32 v37, v37, 0, vcc
    v_cmp_eq_u32 vcc, v4, v38
    s_nop 1
    v_cndmask_b32 v38, v38, 0, vcc
    v_cmp_eq_u32 vcc, v4, v39
    s_nop 1
    v_cndmask_b32 v39, v39, 0, vcc
    v_cmp_eq_u32 vcc, v4, v40
    s_nop 1
    v_cndmask_b32 v40, v40, 0, vcc
    v_cmp_eq_u32 vcc, v4, v41
    s_nop 1
    v_cndmask_b32 v41, v41, 0, vcc
    v_cmp_eq_u32 vcc, v4, v42
    s_nop 1
    v_cndmask_b32 v42, v42, 0, vcc
    v_cmp_eq_u32 vcc, v4, v43
    s_nop 1
    v_cndmask_b32 v43, v43, 0, vcc
    v_cmp_eq_u32 vcc, v4, v44
    s_nop 1
    v_cndmask_b32 v44, v44, 0, vcc
    v_cmp_eq_u32 vcc, v4, v45
    s_nop 1
    v_cndmask_b32 v45, v45, 0, vcc
    v_cmp_eq_u32 vcc, v4, v46
    s_nop 1
    v_cndmask_b32 v46, v46, 0, vcc
    v_cmp_eq_u32 vcc, v4, v47
    s_nop 1
    v_cndmask_b32 v47, v47, 0, vcc
    v_max3_u32 v4, v16, v17, v18
    v_max3_u32 v4, v4, v19, v20
    v_max3_u32 v4, v4, v21, v22
    v_max3_u32 v4, v4, v23, v24
    v_max3_u32 v4, v4, v25, v26
    v_max3_u32 v4, v4, v27, v28
    v_max3_u32 v4, v4, v29, v30
    v_max3_u32 v4, v4, v31, v32
    v_max3_u32 v4, v4, v33, v34
    v_max3_u32 v4, v4, v35, v36
    v_max3_u32 v4, v4, v37, v38
    v_max3_u32 v4, v4, v39, v40
    v_max3_u32 v4, v4, v41, v42
    v_max3_u32 v4, v4, v43, v44
    v_max3_u32 v4, v4, v45, v46
    v_max_u32 v4, v4, v47
    s_nop 1
    v_max_u32_dpp v4, v4, v4 quad_perm:[1,0,3,2] row_mask:0xf bank_mask:0xf
    s_nop 1
    v_max_u32_dpp v4, v4, v4 quad_perm:[2,3,0,1] row_mask:0xf bank_mask:0xf
    s_nop 1
    v_max_u32_dpp v4, v4, v4 row_half_mirror row_mask:0xf bank_mask:0xf
    s_nop 1
    v_max_u32_dpp v4, v4, v4 row_mirror row_mask:0xf bank_mask:0xf
    v_mov_b32 v5, v4
    s_nop 1
    v_permlane16_swap_b32 v4, v5
    v_max_u32 v4, v4, v5
    v_mov_b32 v5, v4
    s_nop 1
    v_permlane32_swap_b32 v4, v5
    v_max_u32 v4, v4, v5
    v_mov_b32 v58, v4
    v_cmp_eq_u32 vcc, v4, v16
    s_nop 1
    v_cndmask_b32 v16, v16, 0, vcc
    v_cmp_eq_u32 vcc, v4, v17
    s_nop 1
    v_cndmask_b32 v17, v17, 0, vcc
    v_cmp_eq_u32 vcc, v4, v18
    s_nop 1
    v_cndmask_b32 v18, v18, 0, vcc
    v_cmp_eq_u32 vcc, v4, v19
    s_nop 1
    v_cndmask_b32 v19, v19, 0, vcc
    v_cmp_eq_u32 vcc, v4, v20
    s_nop 1
    v_cndmask_b32 v20, v20, 0, vcc
    v_cmp_eq_u32 vcc, v4, v21
    s_nop 1
    v_cndmask_b32 v21, v21, 0, vcc
    v_cmp_eq_u32 vcc, v4, v22
    s_nop 1
    v_cndmask_b32 v22, v22, 0, vcc
    v_cmp_eq_u32 vcc, v4, v23
    s_nop 1
    v_cndmask_b32 v23, v23, 0, vcc
    v_cmp_eq_u32 vcc, v4, v24
    s_nop 1
    v_cndmask_b32 v24, v24, 0, vcc
    v_cmp_eq_u32 vcc, v4, v25
    s_nop 1
    v_cndmask_b32 v25, v25, 0, vcc
    v_cmp_eq_u32 vcc, v4, v26
    s_nop 1
    v_cndmask_b32 v26, v26, 0, vcc
    v_cmp_eq_u32 vcc, v4, v27
    s_nop 1
    v_cndmask_b32 v27, v27, 0, vcc
    v_cmp_eq_u32 vcc, v4, v28
    s_nop 1
    v_cndmask_b32 v28, v28, 0, vcc
    v_cmp_eq_u32 vcc, v4, v29
    s_nop 1
    v_cndmask_b32 v29, v29, 0, vcc
    v_cmp_eq_u32 vcc, v4, v30
    s_nop 1
    v_cndmask_b32 v30, v30, 0, vcc
    v_cmp_eq_u32 vcc, v4, v31
    s_nop 1
    v_cndmask_b32 v31, v31, 0, vcc
    v_cmp_eq_u32 vcc, v4, v32
    s_nop 1
    v_cndmask_b32 v32, v32, 0, vcc
    v_cmp_eq_u32 vcc, v4, v33
    s_nop 1
    v_cndmask_b32 v33, v33, 0, vcc
    v_cmp_eq_u32 vcc, v4, v34
    s_nop 1
    v_cndmask_b32 v34, v34, 0, vcc
    v_cmp_eq_u32 vcc, v4, v35
    s_nop 1
    v_cndmask_b32 v35, v35, 0, vcc
    v_cmp_eq_u32 vcc, v4, v36
    s_nop 1
    v_cndmask_b32 v36, v36, 0, vcc
    v_cmp_eq_u32 vcc, v4, v37
    s_nop 1
    v_cndmask_b32 v37, v37, 0, vcc
    v_cmp_eq_u32 vcc, v4, v38
    s_nop 1
    v_cndmask_b32 v38, v38, 0, vcc
    v_cmp_eq_u32 vcc, v4, v39
    s_nop 1
    v_cndmask_b32 v39, v39, 0, vcc
    v_cmp_eq_u32 vcc, v4, v40
    s_nop 1
    v_cndmask_b32 v40, v40, 0, vcc
    v_cmp_eq_u32 vcc, v4, v41
    s_nop 1
    v_cndmask_b32 v41, v41, 0, vcc
    v_cmp_eq_u32 vcc, v4, v42
    s_nop 1
    v_cndmask_b32 v42, v42, 0, vcc
    v_cmp_eq_u32 vcc, v4, v43
    s_nop 1
    v_cndmask_b32 v43, v43, 0, vcc
    v_cmp_eq_u32 vcc, v4, v44
    s_nop 1
    v_cndmask_b32 v44, v44, 0, vcc
    v_cmp_eq_u32 vcc, v4, v45
    s_nop 1
    v_cndmask_b32 v45, v45, 0, vcc
    v_cmp_eq_u32 vcc, v4, v46
    s_nop 1
    v_cndmask_b32 v46, v46, 0, vcc
    v_cmp_eq_u32 vcc, v4, v47
    s_nop 1
    v_cndmask_b32 v47, v47, 0, vcc
    v_max3_u32 v4, v16, v17, v18
    v_max3_u32 v4, v4, v19, v20
    v_max3_u32 v4, v4, v21, v22
    v_max3_u32 v4, v4, v23, v24
    v_max3_u32 v4, v4, v25, v26
    v_max3_u32 v4, v4, v27, v28
    v_max3_u32 v4, v4, v29, v30
    v_max3_u32 v4, v4, v31, v32
    v_max3_u32 v4, v4, v33, v34
    v_max3_u32 v4, v4, v35, v36
    v_max3_u32 v4, v4, v37, v38
    v_max3_u32 v4, v4, v39, v40
    v_max3_u32 v4, v4, v41, v42
    v_max3_u32 v4, v4, v43, v44
    v_max3_u32 v4, v4, v45, v46
    v_max_u32 v4, v4, v47
    s_nop 1
    v_max_u32_dpp v4, v4, v4 quad_perm:[1,0,3,2] row_mask:0xf bank_mask:0xf
    s_nop 1
    v_max_u32_dpp v4, v4, v4 quad_perm:[2,3,0,1] row_mask:0xf bank_mask:0xf
    s_nop 1
    v_max_u32_dpp v4, v4, v4 row_half_mirror row_mask:0xf bank_mask:0xf
    s_nop 1
    v_max_u32_dpp v4, v4, v4 row_mirror row_mask:0xf bank_mask:0xf
    v_mov_b32 v5, v4
    s_nop 1
    v_permlane16_swap_b32 v4, v5
    v_max_u32 v4, v4, v5
    v_mov_b32 v5, v4
    s_nop 1
    v_permlane32_swap_b32 v4, v5
    v_max_u32 v4, v4, v5
    v_mov_b32 v59, v4
    v_cmp_eq_u32 vcc, v4, v16
    s_nop 1
    v_cndmask_b32 v16, v16, 0, vcc
    v_cmp_eq_u32 vcc, v4, v17
    s_nop 1
    v_cndmask_b32 v17, v17, 0, vcc
    v_cmp_eq_u32 vcc, v4, v18
    s_nop 1
    v_cndmask_b32 v18, v18, 0, vcc
    v_cmp_eq_u32 vcc, v4, v19
    s_nop 1
    v_cndmask_b32 v19, v19, 0, vcc
    v_cmp_eq_u32 vcc, v4, v20
    s_nop 1
    v_cndmask_b32 v20, v20, 0, vcc
    v_cmp_eq_u32 vcc, v4, v21
    s_nop 1
    v_cndmask_b32 v21, v21, 0, vcc
    v_cmp_eq_u32 vcc, v4, v22
    s_nop 1
    v_cndmask_b32 v22, v22, 0, vcc
    v_cmp_eq_u32 vcc, v4, v23
    s_nop 1
    v_cndmask_b32 v23, v23, 0, vcc
    v_cmp_eq_u32 vcc, v4, v24
    s_nop 1
    v_cndmask_b32 v24, v24, 0, vcc
    v_cmp_eq_u32 vcc, v4, v25
    s_nop 1
    v_cndmask_b32 v25, v25, 0, vcc
    v_cmp_eq_u32 vcc, v4, v26
    s_nop 1
    v_cndmask_b32 v26, v26, 0, vcc
    v_cmp_eq_u32 vcc, v4, v27
    s_nop 1
    v_cndmask_b32 v27, v27, 0, vcc
    v_cmp_eq_u32 vcc, v4, v28
    s_nop 1
    v_cndmask_b32 v28, v28, 0, vcc
    v_cmp_eq_u32 vcc, v4, v29
    s_nop 1
    v_cndmask_b32 v29, v29, 0, vcc
    v_cmp_eq_u32 vcc, v4, v30
    s_nop 1
    v_cndmask_b32 v30, v30, 0, vcc
    v_cmp_eq_u32 vcc, v4, v31
    s_nop 1
    v_cndmask_b32 v31, v31, 0, vcc
    v_cmp_eq_u32 vcc, v4, v32
    s_nop 1
    v_cndmask_b32 v32, v32, 0, vcc
    v_cmp_eq_u32 vcc, v4, v33
    s_nop 1
    v_cndmask_b32 v33, v33, 0, vcc
    v_cmp_eq_u32 vcc, v4, v34
    s_nop 1
    v_cndmask_b32 v34, v34, 0, vcc
    v_cmp_eq_u32 vcc, v4, v35
    s_nop 1
    v_cndmask_b32 v35, v35, 0, vcc
    v_cmp_eq_u32 vcc, v4, v36
    s_nop 1
    v_cndmask_b32 v36, v36, 0, vcc
    v_cmp_eq_u32 vcc, v4, v37
    s_nop 1
    v_cndmask_b32 v37, v37, 0, vcc
    v_cmp_eq_u32 vcc, v4, v38
    s_nop 1
    v_cndmask_b32 v38, v38, 0, vcc
    v_cmp_eq_u32 vcc, v4, v39
    s_nop 1
    v_cndmask_b32 v39, v39, 0, vcc
    v_cmp_eq_u32 vcc, v4, v40
    s_nop 1
    v_cndmask_b32 v40, v40, 0, vcc
    v_cmp_eq_u32 vcc, v4, v41
    s_nop 1
    v_cndmask_b32 v41, v41, 0, vcc
    v_cmp_eq_u32 vcc, v4, v42
    s_nop 1
    v_cndmask_b32 v42, v42, 0, vcc
    v_cmp_eq_u32 vcc, v4, v43
    s_nop 1
    v_cndmask_b32 v43, v43, 0, vcc
    v_cmp_eq_u32 vcc, v4, v44
    s_nop 1
    v_cndmask_b32 v44, v44, 0, vcc
    v_cmp_eq_u32 vcc, v4, v45
    s_nop 1
    v_cndmask_b32 v45, v45, 0, vcc
    v_cmp_eq_u32 vcc, v4, v46
    s_nop 1
    v_cndmask_b32 v46, v46, 0, vcc
    v_cmp_eq_u32 vcc, v4, v47
    s_nop 1
    v_cndmask_b32 v47, v47, 0, vcc
    v_max3_u32 v4, v16, v17, v18
    v_max3_u32 v4, v4, v19, v20
    v_max3_u32 v4, v4, v21, v22
    v_max3_u32 v4, v4, v23, v24
    v_max3_u32 v4, v4, v25, v26
    v_max3_u32 v4, v4, v27, v28
    v_max3_u32 v4, v4, v29, v30
    v_max3_u32 v4, v4, v31, v32
    v_max3_u32 v4, v4, v33, v34
    v_max3_u32 v4, v4, v35, v36
    v_max3_u32 v4, v4, v37, v38
    v_max3_u32 v4, v4, v39, v40
    v_max3_u32 v4, v4, v41, v42
    v_max3_u32 v4, v4, v43, v44
    v_max3_u32 v4, v4, v45, v46
    v_max_u32 v4, v4, v47
    s_nop 1
    v_max_u32_dpp v4, v4, v4 quad_perm:[1,0,3,2] row_mask:0xf bank_mask:0xf
    s_nop 1
    v_max_u32_dpp v4, v4, v4 quad_perm:[2,3,0,1] row_mask:0xf bank_mask:0xf
    s_nop 1
    v_max_u32_dpp v4, v4, v4 row_half_mirror row_mask:0xf bank_mask:0xf
    s_nop 1
    v_max_u32_dpp v4, v4, v4 row_mirror row_mask:0xf bank_mask:0xf
    v_mov_b32 v5, v4
    s_nop 1
    v_permlane16_swap_b32 v4, v5
    v_max_u32 v4, v4, v5
    v_mov_b32 v5, v4
    s_nop 1
    v_permlane32_swap_b32 v4, v5
    v_max_u32 v4, v4, v5
    v_mov_b32 v60, v4
    v_cmp_eq_u32 vcc, v4, v16
    s_nop 1
    v_cndmask_b32 v16, v16, 0, vcc
    v_cmp_eq_u32 vcc, v4, v17
    s_nop 1
    v_cndmask_b32 v17, v17, 0, vcc
    v_cmp_eq_u32 vcc, v4, v18
    s_nop 1
    v_cndmask_b32 v18, v18, 0, vcc
    v_cmp_eq_u32 vcc, v4, v19
    s_nop 1
    v_cndmask_b32 v19, v19, 0, vcc
    v_cmp_eq_u32 vcc, v4, v20
    s_nop 1
    v_cndmask_b32 v20, v20, 0, vcc
    v_cmp_eq_u32 vcc, v4, v21
    s_nop 1
    v_cndmask_b32 v21, v21, 0, vcc
    v_cmp_eq_u32 vcc, v4, v22
    s_nop 1
    v_cndmask_b32 v22, v22, 0, vcc
    v_cmp_eq_u32 vcc, v4, v23
    s_nop 1
    v_cndmask_b32 v23, v23, 0, vcc
    v_cmp_eq_u32 vcc, v4, v24
    s_nop 1
    v_cndmask_b32 v24, v24, 0, vcc
    v_cmp_eq_u32 vcc, v4, v25
    s_nop 1
    v_cndmask_b32 v25, v25, 0, vcc
    v_cmp_eq_u32 vcc, v4, v26
    s_nop 1
    v_cndmask_b32 v26, v26, 0, vcc
    v_cmp_eq_u32 vcc, v4, v27
    s_nop 1
    v_cndmask_b32 v27, v27, 0, vcc
    v_cmp_eq_u32 vcc, v4, v28
    s_nop 1
    v_cndmask_b32 v28, v28, 0, vcc
    v_cmp_eq_u32 vcc, v4, v29
    s_nop 1
    v_cndmask_b32 v29, v29, 0, vcc
    v_cmp_eq_u32 vcc, v4, v30
    s_nop 1
    v_cndmask_b32 v30, v30, 0, vcc
    v_cmp_eq_u32 vcc, v4, v31
    s_nop 1
    v_cndmask_b32 v31, v31, 0, vcc
    v_cmp_eq_u32 vcc, v4, v32
    s_nop 1
    v_cndmask_b32 v32, v32, 0, vcc
    v_cmp_eq_u32 vcc, v4, v33
    s_nop 1
    v_cndmask_b32 v33, v33, 0, vcc
    v_cmp_eq_u32 vcc, v4, v34
    s_nop 1
    v_cndmask_b32 v34, v34, 0, vcc
    v_cmp_eq_u32 vcc, v4, v35
    s_nop 1
    v_cndmask_b32 v35, v35, 0, vcc
    v_cmp_eq_u32 vcc, v4, v36
    s_nop 1
    v_cndmask_b32 v36, v36, 0, vcc
    v_cmp_eq_u32 vcc, v4, v37
    s_nop 1
    v_cndmask_b32 v37, v37, 0, vcc
    v_cmp_eq_u32 vcc, v4, v38
    s_nop 1
    v_cndmask_b32 v38, v38, 0, vcc
    v_cmp_eq_u32 vcc, v4, v39
    s_nop 1
    v_cndmask_b32 v39, v39, 0, vcc
    v_cmp_eq_u32 vcc, v4, v40
    s_nop 1
    v_cndmask_b32 v40, v40, 0, vcc
    v_cmp_eq_u32 vcc, v4, v41
    s_nop 1
    v_cndmask_b32 v41, v41, 0, vcc
    v_cmp_eq_u32 vcc, v4, v42
    s_nop 1
    v_cndmask_b32 v42, v42, 0, vcc
    v_cmp_eq_u32 vcc, v4, v43
    s_nop 1
    v_cndmask_b32 v43, v43, 0, vcc
    v_cmp_eq_u32 vcc, v4, v44
    s_nop 1
    v_cndmask_b32 v44, v44, 0, vcc
    v_cmp_eq_u32 vcc, v4, v45
    s_nop 1
    v_cndmask_b32 v45, v45, 0, vcc
    v_cmp_eq_u32 vcc, v4, v46
    s_nop 1
    v_cndmask_b32 v46, v46, 0, vcc
    v_cmp_eq_u32 vcc, v4, v47
    s_nop 1
    v_cndmask_b32 v47, v47, 0, vcc
    v_max3_u32 v4, v16, v17, v18
    v_max3_u32 v4, v4, v19, v20
    v_max3_u32 v4, v4, v21, v22
    v_max3_u32 v4, v4, v23, v24
    v_max3_u32 v4, v4, v25, v26
    v_max3_u32 v4, v4, v27, v28
    v_max3_u32 v4, v4, v29, v30
    v_max3_u32 v4, v4, v31, v32
    v_max3_u32 v4, v4, v33, v34
    v_max3_u32 v4, v4, v35, v36
    v_max3_u32 v4, v4, v37, v38
    v_max3_u32 v4, v4, v39, v40
    v_max3_u32 v4, v4, v41, v42
    v_max3_u32 v4, v4, v43, v44
    v_max3_u32 v4, v4, v45, v46
    v_max_u32 v4, v4, v47
    s_nop 1
    v_max_u32_dpp v4, v4, v4 quad_perm:[1,0,3,2] row_mask:0xf bank_mask:0xf
    s_nop 1
    v_max_u32_dpp v4, v4, v4 quad_perm:[2,3,0,1] row_mask:0xf bank_mask:0xf
    s_nop 1
    v_max_u32_dpp v4, v4, v4 row_half_mirror row_mask:0xf bank_mask:0xf
    s_nop 1
    v_max_u32_dpp v4, v4, v4 row_mirror row_mask:0xf bank_mask:0xf
    v_mov_b32 v5, v4
    s_nop 1
    v_permlane16_swap_b32 v4, v5
    v_max_u32 v4, v4, v5
    v_mov_b32 v5, v4
    s_nop 1
    v_permlane32_swap_b32 v4, v5
    v_max_u32 v4, v4, v5
    v_mov_b32 v61, v4
    v_cmp_eq_u32 vcc, v4, v16
    s_nop 1
    v_cndmask_b32 v16, v16, 0, vcc
    v_cmp_eq_u32 vcc, v4, v17
    s_nop 1
    v_cndmask_b32 v17, v17, 0, vcc
    v_cmp_eq_u32 vcc, v4, v18
    s_nop 1
    v_cndmask_b32 v18, v18, 0, vcc
    v_cmp_eq_u32 vcc, v4, v19
    s_nop 1
    v_cndmask_b32 v19, v19, 0, vcc
    v_cmp_eq_u32 vcc, v4, v20
    s_nop 1
    v_cndmask_b32 v20, v20, 0, vcc
    v_cmp_eq_u32 vcc, v4, v21
    s_nop 1
    v_cndmask_b32 v21, v21, 0, vcc
    v_cmp_eq_u32 vcc, v4, v22
    s_nop 1
    v_cndmask_b32 v22, v22, 0, vcc
    v_cmp_eq_u32 vcc, v4, v23
    s_nop 1
    v_cndmask_b32 v23, v23, 0, vcc
    v_cmp_eq_u32 vcc, v4, v24
    s_nop 1
    v_cndmask_b32 v24, v24, 0, vcc
    v_cmp_eq_u32 vcc, v4, v25
    s_nop 1
    v_cndmask_b32 v25, v25, 0, vcc
    v_cmp_eq_u32 vcc, v4, v26
    s_nop 1
    v_cndmask_b32 v26, v26, 0, vcc
    v_cmp_eq_u32 vcc, v4, v27
    s_nop 1
    v_cndmask_b32 v27, v27, 0, vcc
    v_cmp_eq_u32 vcc, v4, v28
    s_nop 1
    v_cndmask_b32 v28, v28, 0, vcc
    v_cmp_eq_u32 vcc, v4, v29
    s_nop 1
    v_cndmask_b32 v29, v29, 0, vcc
    v_cmp_eq_u32 vcc, v4, v30
    s_nop 1
    v_cndmask_b32 v30, v30, 0, vcc
    v_cmp_eq_u32 vcc, v4, v31
    s_nop 1
    v_cndmask_b32 v31, v31, 0, vcc
    v_cmp_eq_u32 vcc, v4, v32
    s_nop 1
    v_cndmask_b32 v32, v32, 0, vcc
    v_cmp_eq_u32 vcc, v4, v33
    s_nop 1
    v_cndmask_b32 v33, v33, 0, vcc
    v_cmp_eq_u32 vcc, v4, v34
    s_nop 1
    v_cndmask_b32 v34, v34, 0, vcc
    v_cmp_eq_u32 vcc, v4, v35
    s_nop 1
    v_cndmask_b32 v35, v35, 0, vcc
    v_cmp_eq_u32 vcc, v4, v36
    s_nop 1
    v_cndmask_b32 v36, v36, 0, vcc
    v_cmp_eq_u32 vcc, v4, v37
    s_nop 1
    v_cndmask_b32 v37, v37, 0, vcc
    v_cmp_eq_u32 vcc, v4, v38
    s_nop 1
    v_cndmask_b32 v38, v38, 0, vcc
    v_cmp_eq_u32 vcc, v4, v39
    s_nop 1
    v_cndmask_b32 v39, v39, 0, vcc
    v_cmp_eq_u32 vcc, v4, v40
    s_nop 1
    v_cndmask_b32 v40, v40, 0, vcc
    v_cmp_eq_u32 vcc, v4, v41
    s_nop 1
    v_cndmask_b32 v41, v41, 0, vcc
    v_cmp_eq_u32 vcc, v4, v42
    s_nop 1
    v_cndmask_b32 v42, v42, 0, vcc
    v_cmp_eq_u32 vcc, v4, v43
    s_nop 1
    v_cndmask_b32 v43, v43, 0, vcc
    v_cmp_eq_u32 vcc, v4, v44
    s_nop 1
    v_cndmask_b32 v44, v44, 0, vcc
    v_cmp_eq_u32 vcc, v4, v45
    s_nop 1
    v_cndmask_b32 v45, v45, 0, vcc
    v_cmp_eq_u32 vcc, v4, v46
    s_nop 1
    v_cndmask_b32 v46, v46, 0, vcc
    v_cmp_eq_u32 vcc, v4, v47
    s_nop 1
    v_cndmask_b32 v47, v47, 0, vcc
    v_max3_u32 v4, v16, v17, v18
    v_max3_u32 v4, v4, v19, v20
    v_max3_u32 v4, v4, v21, v22
    v_max3_u32 v4, v4, v23, v24
    v_max3_u32 v4, v4, v25, v26
    v_max3_u32 v4, v4, v27, v28
    v_max3_u32 v4, v4, v29, v30
    v_max3_u32 v4, v4, v31, v32
    v_max3_u32 v4, v4, v33, v34
    v_max3_u32 v4, v4, v35, v36
    v_max3_u32 v4, v4, v37, v38
    v_max3_u32 v4, v4, v39, v40
    v_max3_u32 v4, v4, v41, v42
    v_max3_u32 v4, v4, v43, v44
    v_max3_u32 v4, v4, v45, v46
    v_max_u32 v4, v4, v47
    s_nop 1
    v_max_u32_dpp v4, v4, v4 quad_perm:[1,0,3,2] row_mask:0xf bank_mask:0xf
    s_nop 1
    v_max_u32_dpp v4, v4, v4 quad_perm:[2,3,0,1] row_mask:0xf bank_mask:0xf
    s_nop 1
    v_max_u32_dpp v4, v4, v4 row_half_mirror row_mask:0xf bank_mask:0xf
    s_nop 1
    v_max_u32_dpp v4, v4, v4 row_mirror row_mask:0xf bank_mask:0xf
    v_mov_b32 v5, v4
    s_nop 1
    v_permlane16_swap_b32 v4, v5
    v_max_u32 v4, v4, v5
    v_mov_b32 v5, v4
    s_nop 1
    v_permlane32_swap_b32 v4, v5
    v_max_u32 v4, v4, v5
    v_mov_b32 v62, v4
    v_cmp_eq_u32 vcc, v4, v16
    s_nop 1
    v_cndmask_b32 v16, v16, 0, vcc
    v_cmp_eq_u32 vcc, v4, v17
    s_nop 1
    v_cndmask_b32 v17, v17, 0, vcc
    v_cmp_eq_u32 vcc, v4, v18
    s_nop 1
    v_cndmask_b32 v18, v18, 0, vcc
    v_cmp_eq_u32 vcc, v4, v19
    s_nop 1
    v_cndmask_b32 v19, v19, 0, vcc
    v_cmp_eq_u32 vcc, v4, v20
    s_nop 1
    v_cndmask_b32 v20, v20, 0, vcc
    v_cmp_eq_u32 vcc, v4, v21
    s_nop 1
    v_cndmask_b32 v21, v21, 0, vcc
    v_cmp_eq_u32 vcc, v4, v22
    s_nop 1
    v_cndmask_b32 v22, v22, 0, vcc
    v_cmp_eq_u32 vcc, v4, v23
    s_nop 1
    v_cndmask_b32 v23, v23, 0, vcc
    v_cmp_eq_u32 vcc, v4, v24
    s_nop 1
    v_cndmask_b32 v24, v24, 0, vcc
    v_cmp_eq_u32 vcc, v4, v25
    s_nop 1
    v_cndmask_b32 v25, v25, 0, vcc
    v_cmp_eq_u32 vcc, v4, v26
    s_nop 1
    v_cndmask_b32 v26, v26, 0, vcc
    v_cmp_eq_u32 vcc, v4, v27
    s_nop 1
    v_cndmask_b32 v27, v27, 0, vcc
    v_cmp_eq_u32 vcc, v4, v28
    s_nop 1
    v_cndmask_b32 v28, v28, 0, vcc
    v_cmp_eq_u32 vcc, v4, v29
    s_nop 1
    v_cndmask_b32 v29, v29, 0, vcc
    v_cmp_eq_u32 vcc, v4, v30
    s_nop 1
    v_cndmask_b32 v30, v30, 0, vcc
    v_cmp_eq_u32 vcc, v4, v31
    s_nop 1
    v_cndmask_b32 v31, v31, 0, vcc
    v_cmp_eq_u32 vcc, v4, v32
    s_nop 1
    v_cndmask_b32 v32, v32, 0, vcc
    v_cmp_eq_u32 vcc, v4, v33
    s_nop 1
    v_cndmask_b32 v33, v33, 0, vcc
    v_cmp_eq_u32 vcc, v4, v34
    s_nop 1
    v_cndmask_b32 v34, v34, 0, vcc
    v_cmp_eq_u32 vcc, v4, v35
    s_nop 1
    v_cndmask_b32 v35, v35, 0, vcc
    v_cmp_eq_u32 vcc, v4, v36
    s_nop 1
    v_cndmask_b32 v36, v36, 0, vcc
    v_cmp_eq_u32 vcc, v4, v37
    s_nop 1
    v_cndmask_b32 v37, v37, 0, vcc
    v_cmp_eq_u32 vcc, v4, v38
    s_nop 1
    v_cndmask_b32 v38, v38, 0, vcc
    v_cmp_eq_u32 vcc, v4, v39
    s_nop 1
    v_cndmask_b32 v39, v39, 0, vcc
    v_cmp_eq_u32 vcc, v4, v40
    s_nop 1
    v_cndmask_b32 v40, v40, 0, vcc
    v_cmp_eq_u32 vcc, v4, v41
    s_nop 1
    v_cndmask_b32 v41, v41, 0, vcc
    v_cmp_eq_u32 vcc, v4, v42
    s_nop 1
    v_cndmask_b32 v42, v42, 0, vcc
    v_cmp_eq_u32 vcc, v4, v43
    s_nop 1
    v_cndmask_b32 v43, v43, 0, vcc
    v_cmp_eq_u32 vcc, v4, v44
    s_nop 1
    v_cndmask_b32 v44, v44, 0, vcc
    v_cmp_eq_u32 vcc, v4, v45
    s_nop 1
    v_cndmask_b32 v45, v45, 0, vcc
    v_cmp_eq_u32 vcc, v4, v46
    s_nop 1
    v_cndmask_b32 v46, v46, 0, vcc
    v_cmp_eq_u32 vcc, v4, v47
    s_nop 1
    v_cndmask_b32 v47, v47, 0, vcc
    v_max3_u32 v4, v16, v17, v18
    v_max3_u32 v4, v4, v19, v20
    v_max3_u32 v4, v4, v21, v22
    v_max3_u32 v4, v4, v23, v24
    v_max3_u32 v4, v4, v25, v26
    v_max3_u32 v4, v4, v27, v28
    v_max3_u32 v4, v4, v29, v30
    v_max3_u32 v4, v4, v31, v32
    v_max3_u32 v4, v4, v33, v34
    v_max3_u32 v4, v4, v35, v36
    v_max3_u32 v4, v4, v37, v38
    v_max3_u32 v4, v4, v39, v40
    v_max3_u32 v4, v4, v41, v42
    v_max3_u32 v4, v4, v43, v44
    v_max3_u32 v4, v4, v45, v46
    v_max_u32 v4, v4, v47
    s_nop 1
    v_max_u32_dpp v4, v4, v4 quad_perm:[1,0,3,2] row_mask:0xf bank_mask:0xf
    s_nop 1
    v_max_u32_dpp v4, v4, v4 quad_perm:[2,3,0,1] row_mask:0xf bank_mask:0xf
    s_nop 1
    v_max_u32_dpp v4, v4, v4 row_half_mirror row_mask:0xf bank_mask:0xf
    s_nop 1
    v_max_u32_dpp v4, v4, v4 row_mirror row_mask:0xf bank_mask:0xf
    v_mov_b32 v5, v4
    s_nop 1
    v_permlane16_swap_b32 v4, v5
    v_max_u32 v4, v4, v5
    v_mov_b32 v5, v4
    s_nop 1
    v_permlane32_swap_b32 v4, v5
    v_max_u32 v4, v4, v5
    v_mov_b32 v63, v4
    v_mov_b32 v4, v56
    v_cmp_eq_u32 vcc, 1, v0
    s_nop 1
    v_cndmask_b32 v4, v4, v57, vcc
    v_cmp_eq_u32 vcc, 2, v0
    s_nop 1
    v_cndmask_b32 v4, v4, v58, vcc
    v_cmp_eq_u32 vcc, 3, v0
    s_nop 1
    v_cndmask_b32 v4, v4, v59, vcc
    v_cmp_eq_u32 vcc, 4, v0
    s_nop 1
    v_cndmask_b32 v4, v4, v60, vcc
    v_cmp_eq_u32 vcc, 5, v0
    s_nop 1
    v_cndmask_b32 v4, v4, v61, vcc
    v_cmp_eq_u32 vcc, 6, v0
    s_nop 1
    v_cndmask_b32 v4, v4, v62, vcc
    v_cmp_eq_u32 vcc, 7, v0
    s_nop 1
    v_cndmask_b32 v4, v4, v63, vcc
    v_and_b32 v5, 0xffff, v4
    v_sub_u32 v5, 0xffff, v5
    v_and_b32 v4, 0xffff0000, v4
    v_ashrrev_i32 v3, 31, v4
    v_not_b32 v3, v3
    v_or_b32 v3, 0x80000000, v3
    v_xor_b32 v4, v4, v3
    v_and_b32 v4, 0xffff0000, v4
    v_mul_f32 v4, 0xbfb8aa3b, v4
    v_exp_f32 v4, v4
    s_nop 0
    v_add_f32 v4, 1.0, v4
    v_rcp_f32 v4, v4
    s_nop 0
    v_cvt_pk_bf16_f32 v4, v4, v4
    v_lshlrev_b32 v4, 16, v4
    v_lshlrev_b32 v6, 2, v0
    s_mov_b32 s64, 0x5400000
    s_mov_b64 exec, 0xff
    buffer_store_dword v5, v6, s[4:7], s64 offen sc1
    buffer_store_dword v4, v6, s[4:7], s64 offen offset:32 sc1
    s_mov_b64 exec, -1
    s_waitcnt vmcnt(0)
    v_mov_b32 v7, 1
    v_mov_b32 v8, 0
    s_mov_b32 s64, 0x298000
    s_mov_b64 exec, 1
    buffer_atomic_add v7, v8, s[4:7], s64 offen sc1
    s_mov_b64 exec, -1
    v_mbcnt_lo_u32_b32 v0, -1, 0
    v_mbcnt_hi_u32_b32 v0, -1, v0
NOSEL_100:
    v_lshlrev_b32 v1, 4, v0
    v_lshrrev_b32 v6, 3, v0
    v_mul_u32_u24 v2, 1280, v6
    v_and_b32 v7, 7, v0
    v_xor_b32 v7, v7, v6
    v_lshl_add_u32 v2, v7, 4, v2
    v_bfe_u32 v6, v0, 3, 1
    v_lshlrev_b32 v9, 10, v6
    v_and_b32 v6, 7, v0
    v_lshl_add_u32 v9, v6, 7, v9
    v_lshrrev_b32 v7, 4, v0
    v_xor_b32 v7, v7, v6
    v_lshl_add_u32 v3, v7, 4, v9
    v_xor_b32 v7, 4, v7
    v_lshl_add_u32 v4, v7, 4, v9
    v_add_u32 v6, 0x10000, v3
    v_add_u32 v9, 0x10000, v4
    s_barrier
    s_mul_i32 s20, s12, 163840
    s_mul_i32 s64, s14, 40960
    s_add_u32 s20, s20, s64
    s_add_u32 s20, s20, 0x0
    s_lshl_b32 s21, s14, 12
    s_add_u32 m0, s21, 0
    s_add_u32 s64, s20, 0x0
    buffer_load_dwordx4 v2, s[4:7], s64 offen lds
    s_add_u32 m0, s21, 1024
    s_add_u32 s64, s20, 0x2800
    buffer_load_dwordx4 v2, s[4:7], s64 offen lds
    s_add_u32 m0, s21, 2048
    s_add_u32 s64, s20, 0x5000
    buffer_load_dwordx4 v2, s[4:7], s64 offen lds
    s_add_u32 m0, s21, 3072
    s_add_u32 s64, s20, 0x7800
    buffer_load_dwordx4 v2, s[4:7], s64 offen lds
    s_add_u32 m0, s21, 16384
    s_add_u32 s64, s20, 0x80
    buffer_load_dwordx4 v2, s[4:7], s64 offen lds
    s_add_u32 m0, s21, 17408
    s_add_u32 s64, s20, 0x2880
    buffer_load_dwordx4 v2, s[4:7], s64 offen lds
    s_add_u32 m0, s21, 18432
    s_add_u32 s64, s20, 0x5080
    buffer_load_dwordx4 v2, s[4:7], s64 offen lds
    s_add_u32 m0, s21, 19456
    s_add_u32 s64, s20, 0x7880
    buffer_load_dwordx4 v2, s[4:7], s64 offen lds
    s_add_u32 m0, s21, 32768
    s_add_u32 s64, s20, 0x100
    buffer_load_dwordx4 v2, s[4:7], s64 offen lds
    s_add_u32 m0, s21, 33792
    s_add_u32 s64, s20, 0x2900
    buffer_load_dwordx4 v2, s[4:7], s64 offen lds
    s_add_u32 m0, s21, 34816
    s_add_u32 s64, s20, 0x5100
    buffer_load_dwordx4 v2, s[4:7], s64 offen lds
    s_add_u32 m0, s21, 35840
    s_add_u32 s64, s20, 0x7900
    buffer_load_dwordx4 v2, s[4:7], s64 offen lds
    s_add_u32 m0, s21, 49152
    s_add_u32 s64, s20, 0x180
    buffer_load_dwordx4 v2, s[4:7], s64 offen lds
    s_add_u32 m0, s21, 50176
    s_add_u32 s64, s20, 0x2980
    buffer_load_dwordx4 v2, s[4:7], s64 offen lds
    s_add_u32 m0, s21, 51200
    s_add_u32 s64, s20, 0x5180
    buffer_load_dwordx4 v2, s[4:7], s64 offen lds
    s_add_u32 m0, s21, 52224
    s_add_u32 s64, s20, 0x7980
    buffer_load_dwordx4 v2, s[4:7], s64 offen lds
    s_mov_b32 s64, 0x40000000
    buffer_store_dword v7, v1, s[4:7], s64 offen
    buffer_store_dword v7, v1, s[4:7], s64 offen
    buffer_store_dword v7, v1, s[4:7], s64 offen
    buffer_store_dword v7, v1, s[4:7], s64 offen
    buffer_store_dword v7, v1, s[4:7], s64 offen
    buffer_store_dword v7, v1, s[4:7], s64 offen
    buffer_store_dword v7, v1, s[4:7], s64 offen
    buffer_store_dword v7, v1, s[4:7], s64 offen
    s_waitcnt vmcnt(20)
    s_barrier
    ds_read_b128 a[0:3], v3 offset:0
    ds_read_b128 a[4:7], v3 offset:2048
    ds_read_b128 a[8:11], v3 offset:4096
    ds_read_b128 a[12:15], v3 offset:6144
    ds_read_b128 a[16:19], v3 offset:8192
    ds_read_b128 a[20:23], v3 offset:10240
    ds_read_b128 a[24:27], v3 offset:12288
    ds_read_b128 a[28:31], v3 offset:14336
    s_mov_b32 s19, 0
    s_mov_b32 s22, s16
    s_mov_b32 s23, 0x40000000
G_T_LOOP:
    s_waitcnt lgkmcnt(4)
    v_mfma_f32_16x16x32_bf16 v[16:19], v[96:99], a[0:3], 0
    v_mfma_f32_16x16x32_bf16 v[20:23], v[100:103], a[0:3], 0
    ds_read_b128 a[32:35], v4 offset:0
    v_mfma_f32_16x16x32_bf16 v[24:27], v[96:99], a[4:7], 0
    v_mfma_f32_16x16x32_bf16 v[28:31], v[100:103], a[4:7], 0
    ds_read_b128 a[36:39], v4 offset:2048
    v_mfma_f32_16x16x32_bf16 v[32:35], v[96:99], a[8:11], 0
    v_mfma_f32_16x16x32_bf16 v[36:39], v[100:103], a[8:11], 0
    ds_read_b128 a[40:43], v4 offset:4096
    v_mfma_f32_16x16x32_bf16 v[40:43], v[96:99], a[12:15], 0
    v_mfma_f32_16x16x32_bf16 v[44:47], v[100:103], a[12:15], 0
    ds_read_b128 a[44:47], v4 offset:6144
    s_waitcnt lgkmcnt(4)
    v_mfma_f32_16x16x32_bf16 v[48:51], v[96:99], a[16:19], 0
    v_mfma_f32_16x16x32_bf16 v[52:55], v[100:103], a[16:19], 0
    ds_read_b128 a[48:51], v4 offset:8192
    v_mfma_f32_16x16x32_bf16 v[56:59], v[96:99], a[20:23], 0
    v_mfma_f32_16x16x32_bf16 v[60:63], v[100:103], a[20:23], 0
    ds_read_b128 a[52:55], v4 offset:10240
    v_mfma_f32_16x16x32_bf16 v[64:67], v[96:99], a[24:27], 0
    v_mfma_f32_16x16x32_bf16 v[68:71], v[100:103], a[24:27], 0
    ds_read_b128 a[56:59], v4 offset:12288
    v_mfma_f32_16x16x32_bf16 v[72:75], v[96:99], a[28:31], 0
    v_mfma_f32_16x16x32_bf16 v[76:79], v[100:103], a[28:31], 0
    ds_read_b128 a[60:63], v4 offset:14336
    s_waitcnt vmcnt(16)
    s_barrier
    s_waitcnt lgkmcnt(4)
    v_mfma_f32_16x16x32_bf16 v[16:19], v[104:107], a[32:35], v[16:19]
    v_mfma_f32_16x16x32_bf16 v[20:23], v[108:111], a[32:35], v[20:23]
    ds_read_b128 a[0:3], v3 offset:16384
    s_add_u32 m0, s21, 65536
    v_mfma_f32_16x16x32_bf16 v[24:27], v[104:107], a[36:39], v[24:27]
    v_mfma_f32_16x16x32_bf16 v[28:31], v[108:111], a[36:39], v[28:31]
    ds_read_b128 a[4:7], v3 offset:18432
    s_add_u32 s64, s20, 0x200
    buffer_load_dwordx4 v2, s[4:7], s64 offen lds
    v_mfma_f32_16x16x32_bf16 v[32:35], v[104:107], a[40:43], v[32:35]
    v_mfma_f32_16x16x32_bf16 v[36:39], v[108:111], a[40:43], v[36:39]
    ds_read_b128 a[8:11], v3 offset:20480
    s_add_u32 m0, s21, 66560
    v_mfma_f32_16x16x32_bf16 v[40:43], v[104:107], a[44:47], v[40:43]
    v_mfma_f32_16x16x32_bf16 v[44:47], v[108:111], a[44:47], v[44:47]
    ds_read_b128 a[12:15], v3 offset:22528
    s_add_u32 s64, s20, 0x2a00
    buffer_load_dwordx4 v2, s[4:7], s64 offen lds
    s_waitcnt lgkmcnt(4)
    v_mfma_f32_16x16x32_bf16 v[48:51], v[104:107], a[48:51], v[48:51]
    v_mfma_f32_16x16x32_bf16 v[52:55], v[108:111], a[48:51], v[52:55]
    ds_read_b128 a[16:19], v3 offset:24576
    s_add_u32 m0, s21, 67584
    v_mfma_f32_16x16x32_bf16 v[56:59], v[104:107], a[52:55], v[56:59]
    v_mfma_f32_16x16x32_bf16 v[60:63], v[108:111], a[52:55], v[60:63]
    ds_read_b128 a[20:23], v3 offset:26624
    s_add_u32 s64, s20, 0x5200
    buffer_load_dwordx4 v2, s[4:7], s64 offen lds
    v_mfma_f32_16x16x32_bf16 v[64:67], v[104:107], a[56:59], v[64:67]
    v_mfma_f32_16x16x32_bf16 v[68:71], v[108:111], a[56:59], v[68:71]
    ds_read_b128 a[24:27], v3 offset:28672
    s_add_u32 m0, s21, 68608
    v_mfma_f32_16x16x32_bf16 v[72:75], v[104:107], a[60:63], v[72:75]
    v_mfma_f32_16x16x32_bf16 v[76:79], v[108:111], a[60:63], v[76:79]
    ds_read_b128 a[28:31], v3 offset:30720
    s_add_u32 s64, s20, 0x7a00
    buffer_load_dwordx4 v2, s[4:7], s64 offen lds
    s_waitcnt lgkmcnt(4)
    v_mfma_f32_16x16x32_bf16 v[16:19], v[112:115], a[0:3], v[16:19]
    v_mfma_f32_16x16x32_bf16 v[20:23], v[116:119], a[0:3], v[20:23]
    ds_read_b128 a[32:35], v4 offset:16384
    v_mfma_f32_16x16x32_bf16 v[24:27], v[112:115], a[4:7], v[24:27]
    v_mfma_f32_16x16x32_bf16 v[28:31], v[116:119], a[4:7], v[28:31]
    ds_read_b128 a[36:39], v4 offset:18432
    v_mfma_f32_16x16x32_bf16 v[32:35], v[112:115], a[8:11], v[32:35]
    v_mfma_f32_16x16x32_bf16 v[36:39], v[116:119], a[8:11], v[36:39]
    ds_read_b128 a[40:43], v4 offset:20480
    v_mfma_f32_16x16x32_bf16 v[40:43], v[112:115], a[12:15], v[40:43]
    v_mfma_f32_16x16x32_bf16 v[44:47], v[116:119], a[12:15], v[44:47]
    ds_read_b128 a[44:47], v4 offset:22528
    s_waitcnt lgkmcnt(4)
    v_mfma_f32_16x16x32_bf16 v[48:51], v[112:115], a[16:19], v[48:51]
    v_mfma_f32_16x16x32_bf16 v[52:55], v[116:119], a[16:19], v[52:55]
    ds_read_b128 a[48:51], v4 offset:24576
    v_mfma_f32_16x16x32_bf16 v[56:59], v[112:115], a[20:23], v[56:59]
    v_mfma_f32_16x16x32_bf16 v[60:63], v[116:119], a[20:23], v[60:63]
    ds_read_b128 a[52:55], v4 offset:26624
    v_mfma_f32_16x16x32_bf16 v[64:67], v[112:115], a[24:27], v[64:67]
    v_mfma_f32_16x16x32_bf16 v[68:71], v[116:119], a[24:27], v[68:71]
    ds_read_b128 a[56:59], v4 offset:28672
    v_mfma_f32_16x16x32_bf16 v[72:75], v[112:115], a[28:31], v[72:75]
    v_mfma_f32_16x16x32_bf16 v[76:79], v[116:119], a[28:31], v[76:79]
    ds_read_b128 a[60:63], v4 offset:30720
    s_waitcnt vmcnt(16)
    s_barrier
    s_waitcnt lgkmcnt(4)
    v_mfma_f32_16x16x32_bf16 v[16:19], v[120:123], a[32:35], v[16:19]
    v_mfma_f32_16x16x32_bf16 v[20:23], v[124:127], a[32:35], v[20:23]
    ds_read_b128 a[0:3], v3 offset:32768
    s_add_u32 m0, s21, 0
    v_mfma_f32_16x16x32_bf16 v[24:27], v[120:123], a[36:39], v[24:27]
    v_mfma_f32_16x16x32_bf16 v[28:31], v[124:127], a[36:39], v[28:31]
    ds_read_b128 a[4:7], v3 offset:34816
    s_add_u32 s64, s20, 0x280
    buffer_load_dwordx4 v2, s[4:7], s64 offen lds
    v_mfma_f32_16x16x32_bf16 v[32:35], v[120:123], a[40:43], v[32:35]
    v_mfma_f32_16x16x32_bf16 v[36:39], v[124:127], a[40:43], v[36:39]
    ds_read_b128 a[8:11], v3 offset:36864
    s_add_u32 m0, s21, 1024
    v_mfma_f32_16x16x32_bf16 v[40:43], v[120:123], a[44:47], v[40:43]
    v_mfma_f32_16x16x32_bf16 v[44:47], v[124:127], a[44:47], v[44:47]
    ds_read_b128 a[12:15], v3 offset:38912
    s_add_u32 s64, s20, 0x2a80
    buffer_load_dwordx4 v2, s[4:7], s64 offen lds
    s_waitcnt lgkmcnt(4)
    v_mfma_f32_16x16x32_bf16 v[48:51], v[120:123], a[48:51], v[48:51]
    v_mfma_f32_16x16x32_bf16 v[52:55], v[124:127], a[48:51], v[52:55]
    ds_read_b128 a[16:19], v3 offset:40960
    s_add_u32 m0, s21, 2048
    v_mfma_f32_16x16x32_bf16 v[56:59], v[120:123], a[52:55], v[56:59]
    v_mfma_f32_16x16x32_bf16 v[60:63], v[124:127], a[52:55], v[60:63]
    ds_read_b128 a[20:23], v3 offset:43008
    s_add_u32 s64, s20, 0x5280
    buffer_load_dwordx4 v2, s[4:7], s64 offen lds
    v_mfma_f32_16x16x32_bf16 v[64:67], v[120:123], a[56:59], v[64:67]
    v_mfma_f32_16x16x32_bf16 v[68:71], v[124:127], a[56:59], v[68:71]
    ds_read_b128 a[24:27], v3 offset:45056
    s_add_u32 m0, s21, 3072
    v_mfma_f32_16x16x32_bf16 v[72:75], v[120:123], a[60:63], v[72:75]
    v_mfma_f32_16x16x32_bf16 v[76:79], v[124:127], a[60:63], v[76:79]
    ds_read_b128 a[28:31], v3 offset:47104
    s_add_u32 s64, s20, 0x7a80
    buffer_load_dwordx4 v2, s[4:7], s64 offen lds
    s_waitcnt lgkmcnt(4)
    v_mfma_f32_16x16x32_bf16 v[16:19], v[128:131], a[0:3], v[16:19]
    v_mfma_f32_16x16x32_bf16 v[20:23], v[132:135], a[0:3], v[20:23]
    ds_read_b128 a[32:35], v4 offset:32768
    v_mfma_f32_16x16x32_bf16 v[24:27], v[128:131], a[4:7], v[24:27]
    v_mfma_f32_16x16x32_bf16 v[28:31], v[132:135], a[4:7], v[28:31]
    ds_read_b128 a[36:39], v4 offset:34816
    v_mfma_f32_16x16x32_bf16 v[32:35], v[128:131], a[8:11], v[32:35]
    v_mfma_f32_16x16x32_bf16 v[36:39], v[132:135], a[8:11], v[36:39]
    ds_read_b128 a[40:43], v4 offset:36864
    v_mfma_f32_16x16x32_bf16 v[40:43], v[128:131], a[12:15], v[40:43]
    v_mfma_f32_16x16x32_bf16 v[44:47], v[132:135], a[12:15], v[44:47]
    ds_read_b128 a[44:47], v4 offset:38912
    s_waitcnt lgkmcnt(4)
    v_mfma_f32_16x16x32_bf16 v[48:51], v[128:131], a[16:19], v[48:51]
    v_mfma_f32_16x16x32_bf16 v[52:55], v[132:135], a[16:19], v[52:55]
    ds_read_b128 a[48:51], v4 offset:40960
    v_mfma_f32_16x16x32_bf16 v[56:59], v[128:131], a[20:23], v[56:59]
    v_mfma_f32_16x16x32_bf16 v[60:63], v[132:135], a[20:23], v[60:63]
    ds_read_b128 a[52:55], v4 offset:43008
    v_mfma_f32_16x16x32_bf16 v[64:67], v[128:131], a[24:27], v[64:67]
    v_mfma_f32_16x16x32_bf16 v[68:71], v[132:135], a[24:27], v[68:71]
    ds_read_b128 a[56:59], v4 offset:45056
    v_mfma_f32_16x16x32_bf16 v[72:75], v[128:131], a[28:31], v[72:75]
    v_mfma_f32_16x16x32_bf16 v[76:79], v[132:135], a[28:31], v[76:79]
    ds_read_b128 a[60:63], v4 offset:47104
    s_waitcnt vmcnt(16)
    s_barrier
    s_waitcnt lgkmcnt(4)
    v_mfma_f32_16x16x32_bf16 v[16:19], v[136:139], a[32:35], v[16:19]
    v_mfma_f32_16x16x32_bf16 v[20:23], v[140:143], a[32:35], v[20:23]
    ds_read_b128 a[0:3], v3 offset:49152
    s_add_u32 m0, s21, 16384
    v_mfma_f32_16x16x32_bf16 v[24:27], v[136:139], a[36:39], v[24:27]
    v_mfma_f32_16x16x32_bf16 v[28:31], v[140:143], a[36:39], v[28:31]
    ds_read_b128 a[4:7], v3 offset:51200
    s_add_u32 s64, s20, 0x300
    buffer_load_dwordx4 v2, s[4:7], s64 offen lds
    v_mfma_f32_16x16x32_bf16 v[32:35], v[136:139], a[40:43], v[32:35]
    v_mfma_f32_16x16x32_bf16 v[36:39], v[140:143], a[40:43], v[36:39]
    ds_read_b128 a[8:11], v3 offset:53248
    s_add_u32 m0, s21, 17408
    v_mfma_f32_16x16x32_bf16 v[40:43], v[136:139], a[44:47], v[40:43]
    v_mfma_f32_16x16x32_bf16 v[44:47], v[140:143], a[44:47], v[44:47]
    ds_read_b128 a[12:15], v3 offset:55296
    s_add_u32 s64, s20, 0x2b00
    buffer_load_dwordx4 v2, s[4:7], s64 offen lds
    s_waitcnt lgkmcnt(4)
    v_mfma_f32_16x16x32_bf16 v[48:51], v[136:139], a[48:51], v[48:51]
    v_mfma_f32_16x16x32_bf16 v[52:55], v[140:143], a[48:51], v[52:55]
    ds_read_b128 a[16:19], v3 offset:57344
    s_add_u32 m0, s21, 18432
    v_mfma_f32_16x16x32_bf16 v[56:59], v[136:139], a[52:55], v[56:59]
    v_mfma_f32_16x16x32_bf16 v[60:63], v[140:143], a[52:55], v[60:63]
    ds_read_b128 a[20:23], v3 offset:59392
    s_add_u32 s64, s20, 0x5300
    buffer_load_dwordx4 v2, s[4:7], s64 offen lds
    v_mfma_f32_16x16x32_bf16 v[64:67], v[136:139], a[56:59], v[64:67]
    v_mfma_f32_16x16x32_bf16 v[68:71], v[140:143], a[56:59], v[68:71]
    ds_read_b128 a[24:27], v3 offset:61440
    s_add_u32 m0, s21, 19456
    v_mfma_f32_16x16x32_bf16 v[72:75], v[136:139], a[60:63], v[72:75]
    v_mfma_f32_16x16x32_bf16 v[76:79], v[140:143], a[60:63], v[76:79]
    ds_read_b128 a[28:31], v3 offset:63488
    s_add_u32 s64, s20, 0x7b00
    buffer_load_dwordx4 v2, s[4:7], s64 offen lds
    s_waitcnt lgkmcnt(4)
    v_mfma_f32_16x16x32_bf16 v[16:19], v[144:147], a[0:3], v[16:19]
    v_mfma_f32_16x16x32_bf16 v[20:23], v[148:151], a[0:3], v[20:23]
    ds_read_b128 a[32:35], v4 offset:49152
    v_mfma_f32_16x16x32_bf16 v[24:27], v[144:147], a[4:7], v[24:27]
    v_mfma_f32_16x16x32_bf16 v[28:31], v[148:151], a[4:7], v[28:31]
    ds_read_b128 a[36:39], v4 offset:51200
    v_mfma_f32_16x16x32_bf16 v[32:35], v[144:147], a[8:11], v[32:35]
    v_mfma_f32_16x16x32_bf16 v[36:39], v[148:151], a[8:11], v[36:39]
    ds_read_b128 a[40:43], v4 offset:53248
    v_mfma_f32_16x16x32_bf16 v[40:43], v[144:147], a[12:15], v[40:43]
    v_mfma_f32_16x16x32_bf16 v[44:47], v[148:151], a[12:15], v[44:47]
    ds_read_b128 a[44:47], v4 offset:55296
    s_waitcnt lgkmcnt(4)
    v_mfma_f32_16x16x32_bf16 v[48:51], v[144:147], a[16:19], v[48:51]
    v_mfma_f32_16x16x32_bf16 v[52:55], v[148:151], a[16:19], v[52:55]
    ds_read_b128 a[48:51], v4 offset:57344
    v_mfma_f32_16x16x32_bf16 v[56:59], v[144:147], a[20:23], v[56:59]
    v_mfma_f32_16x16x32_bf16 v[60:63], v[148:151], a[20:23], v[60:63]
    ds_read_b128 a[52:55], v4 offset:59392
    v_mfma_f32_16x16x32_bf16 v[64:67], v[144:147], a[24:27], v[64:67]
    v_mfma_f32_16x16x32_bf16 v[68:71], v[148:151], a[24:27], v[68:71]
    ds_read_b128 a[56:59], v4 offset:61440
    v_mfma_f32_16x16x32_bf16 v[72:75], v[144:147], a[28:31], v[72:75]
    v_mfma_f32_16x16x32_bf16 v[76:79], v[148:151], a[28:31], v[76:79]
    ds_read_b128 a[60:63], v4 offset:63488
    s_waitcnt vmcnt(8)
    s_barrier
    s_cmp_lg_u32 s14, 0
    s_cbranch_scc1 GF_101
    v_mov_b32 v7, 1
    v_mov_b32 v8, 0
    s_mov_b64 exec, 1
    buffer_store_dword v7, v8, s[4:7], s23 offen sc1
    s_mov_b64 exec, -1
GF_101:
    s_waitcnt lgkmcnt(4)
    v_mfma_f32_16x16x32_bf16 v[16:19], v[152:155], a[32:35], v[16:19]
    v_mfma_f32_16x16x32_bf16 v[20:23], v[156:159], a[32:35], v[20:23]
    ds_read_b128 a[0:3], v6 offset:0
    s_add_u32 m0, s21, 32768
    v_mfma_f32_16x16x32_bf16 v[24:27], v[152:155], a[36:39], v[24:27]
    v_mfma_f32_16x16x32_bf16 v[28:31], v[156:159], a[36:39], v[28:31]
    ds_read_b128 a[4:7], v6 offset:2048
    s_add_u32 s64, s20, 0x380
    buffer_load_dwordx4 v2, s[4:7], s64 offen lds
    v_mfma_f32_16x16x32_bf16 v[32:35], v[152:155], a[40:43], v[32:35]
    v_mfma_f32_16x16x32_bf16 v[36:39], v[156:159], a[40:43], v[36:39]
    ds_read_b128 a[8:11], v6 offset:4096
    s_add_u32 m0, s21, 33792
    v_mfma_f32_16x16x32_bf16 v[40:43], v[152:155], a[44:47], v[40:43]
    v_mfma_f32_16x16x32_bf16 v[44:47], v[156:159], a[44:47], v[44:47]
    ds_read_b128 a[12:15], v6 offset:6144
    s_add_u32 s64, s20, 0x2b80
    buffer_load_dwordx4 v2, s[4:7], s64 offen lds
    s_waitcnt lgkmcnt(4)
    v_mfma_f32_16x16x32_bf16 v[48:51], v[152:155], a[48:51], v[48:51]
    v_mfma_f32_16x16x32_bf16 v[52:55], v[156:159], a[48:51], v[52:55]
    ds_read_b128 a[16:19], v6 offset:8192
    s_add_u32 m0, s21, 34816
    v_mfma_f32_16x16x32_bf16 v[56:59], v[152:155], a[52:55], v[56:59]
    v_mfma_f32_16x16x32_bf16 v[60:63], v[156:159], a[52:55], v[60:63]
    ds_read_b128 a[20:23], v6 offset:10240
    s_add_u32 s64, s20, 0x5380
    buffer_load_dwordx4 v2, s[4:7], s64 offen lds
    v_mfma_f32_16x16x32_bf16 v[64:67], v[152:155], a[56:59], v[64:67]
    v_mfma_f32_16x16x32_bf16 v[68:71], v[156:159], a[56:59], v[68:71]
    ds_read_b128 a[24:27], v6 offset:12288
    s_add_u32 m0, s21, 35840
    v_mfma_f32_16x16x32_bf16 v[72:75], v[152:155], a[60:63], v[72:75]
    v_mfma_f32_16x16x32_bf16 v[76:79], v[156:159], a[60:63], v[76:79]
    ds_read_b128 a[28:31], v6 offset:14336
    s_add_u32 s64, s20, 0x7b80
    buffer_load_dwordx4 v2, s[4:7], s64 offen lds
    s_waitcnt lgkmcnt(4)
    v_mfma_f32_16x16x32_bf16 v[16:19], v[160:163], a[0:3], v[16:19]
    v_mfma_f32_16x16x32_bf16 v[20:23], v[164:167], a[0:3], v[20:23]
    ds_read_b128 a[32:35], v9 offset:0
    v_mfma_f32_16x16x32_bf16 v[24:27], v[160:163], a[4:7], v[24:27]
    v_mfma_f32_16x16x32_bf16 v[28:31], v[164:167], a[4:7], v[28:31]
    ds_read_b128 a[36:39], v9 offset:2048
    v_mfma_f32_16x16x32_bf16 v[32:35], v[160:163], a[8:11], v[32:35]
    v_mfma_f32_16x16x32_bf16 v[36:39], v[164:167], a[8:11], v[36:39]
    ds_read_b128 a[40:43], v9 offset:4096
    v_mfma_f32_16x16x32_bf16 v[40:43], v[160:163], a[12:15], v[40:43]
    v_mfma_f32_16x16x32_bf16 v[44:47], v[164:167], a[12:15], v[44:47]
    ds_read_b128 a[44:47], v9 offset:6144
    s_waitcnt lgkmcnt(4)
    v_mfma_f32_16x16x32_bf16 v[48:51], v[160:163], a[16:19], v[48:51]
    v_mfma_f32_16x16x32_bf16 v[52:55], v[164:167], a[16:19], v[52:55]
    ds_read_b128 a[48:51], v9 offset:8192
    v_mfma_f32_16x16x32_bf16 v[56:59], v[160:163], a[20:23], v[56:59]
    v_mfma_f32_16x16x32_bf16 v[60:63], v[164:167], a[20:23], v[60:63]
    ds_read_b128 a[52:55], v9 offset:10240
    v_mfma_f32_16x16x32_bf16 v[64:67], v[160:163], a[24:27], v[64:67]
    v_mfma_f32_16x16x32_bf16 v[68:71], v[164:167], a[24:27], v[68:71]
    ds_read_b128 a[56:59], v9 offset:12288
    v_mfma_f32_16x16x32_bf16 v[72:75], v[160:163], a[28:31], v[72:75]
    v_mfma_f32_16x16x32_bf16 v[76:79], v[164:167], a[28:31], v[76:79]
    ds_read_b128 a[60:63], v9 offset:14336
    s_waitcnt vmcnt(8)
    s_barrier
    s_waitcnt lgkmcnt(4)
    v_mfma_f32_16x16x32_bf16 v[16:19], v[168:171], a[32:35], v[16:19]
    v_mfma_f32_16x16x32_bf16 v[20:23], v[172:175], a[32:35], v[20:23]
    ds_read_b128 a[0:3], v3 offset:0
    s_add_u32 m0, s21, 49152
    v_mfma_f32_16x16x32_bf16 v[24:27], v[168:171], a[36:39], v[24:27]
    v_mfma_f32_16x16x32_bf16 v[28:31], v[172:175], a[36:39], v[28:31]
    ds_read_b128 a[4:7], v3 offset:2048
    s_add_u32 s64, s20, 0x400
    buffer_load_dwordx4 v2, s[4:7], s64 offen lds
    v_mfma_f32_16x16x32_bf16 v[32:35], v[168:171], a[40:43], v[32:35]
    v_mfma_f32_16x16x32_bf16 v[36:39], v[172:175], a[40:43], v[36:39]
    ds_read_b128 a[8:11], v3 offset:4096
    s_add_u32 m0, s21, 50176
    v_mfma_f32_16x16x32_bf16 v[40:43], v[168:171], a[44:47], v[40:43]
    v_mfma_f32_16x16x32_bf16 v[44:47], v[172:175], a[44:47], v[44:47]
    ds_read_b128 a[12:15], v3 offset:6144
    s_add_u32 s64, s20, 0x2c00
    buffer_load_dwordx4 v2, s[4:7], s64 offen lds
    s_waitcnt lgkmcnt(4)
    v_mfma_f32_16x16x32_bf16 v[48:51], v[168:171], a[48:51], v[48:51]
    v_mfma_f32_16x16x32_bf16 v[52:55], v[172:175], a[48:51], v[52:55]
    ds_read_b128 a[16:19], v3 offset:8192
    s_add_u32 m0, s21, 51200
    v_mfma_f32_16x16x32_bf16 v[56:59], v[168:171], a[52:55], v[56:59]
    v_mfma_f32_16x16x32_bf16 v[60:63], v[172:175], a[52:55], v[60:63]
    ds_read_b128 a[20:23], v3 offset:10240
    s_add_u32 s64, s20, 0x5400
    buffer_load_dwordx4 v2, s[4:7], s64 offen lds
    v_mfma_f32_16x16x32_bf16 v[64:67], v[168:171], a[56:59], v[64:67]
    v_mfma_f32_16x16x32_bf16 v[68:71], v[172:175], a[56:59], v[68:71]
    ds_read_b128 a[24:27], v3 offset:12288
    s_add_u32 m0, s21, 52224
    v_mfma_f32_16x16x32_bf16 v[72:75], v[168:171], a[60:63], v[72:75]
    v_mfma_f32_16x16x32_bf16 v[76:79], v[172:175], a[60:63], v[76:79]
    ds_read_b128 a[28:31], v3 offset:14336
    s_add_u32 s64, s20, 0x7c00
    buffer_load_dwordx4 v2, s[4:7], s64 offen lds
    s_waitcnt lgkmcnt(4)
    v_mfma_f32_16x16x32_bf16 v[16:19], v[176:179], a[0:3], v[16:19]
    v_mfma_f32_16x16x32_bf16 v[20:23], v[180:183], a[0:3], v[20:23]
    ds_read_b128 a[32:35], v4 offset:0
    v_mfma_f32_16x16x32_bf16 v[24:27], v[176:179], a[4:7], v[24:27]
    v_mfma_f32_16x16x32_bf16 v[28:31], v[180:183], a[4:7], v[28:31]
    ds_read_b128 a[36:39], v4 offset:2048
    v_mfma_f32_16x16x32_bf16 v[32:35], v[176:179], a[8:11], v[32:35]
    v_mfma_f32_16x16x32_bf16 v[36:39], v[180:183], a[8:11], v[36:39]
    ds_read_b128 a[40:43], v4 offset:4096
    v_mfma_f32_16x16x32_bf16 v[40:43], v[176:179], a[12:15], v[40:43]
    v_mfma_f32_16x16x32_bf16 v[44:47], v[180:183], a[12:15], v[44:47]
    ds_read_b128 a[44:47], v4 offset:6144
    s_waitcnt lgkmcnt(4)
    v_mfma_f32_16x16x32_bf16 v[48:51], v[176:179], a[16:19], v[48:51]
    v_mfma_f32_16x16x32_bf16 v[52:55], v[180:183], a[16:19], v[52:55]
    ds_read_b128 a[48:51], v4 offset:8192
    v_mfma_f32_16x16x32_bf16 v[56:59], v[176:179], a[20:23], v[56:59]
    v_mfma_f32_16x16x32_bf16 v[60:63], v[180:183], a[20:23], v[60:63]
    ds_read_b128 a[52:55], v4 offset:10240
    v_mfma_f32_16x16x32_bf16 v[64:67], v[176:179], a[24:27], v[64:67]
    v_mfma_f32_16x16x32_bf16 v[68:71], v[180:183], a[24:27], v[68:71]
    ds_read_b128 a[56:59], v4 offset:12288
    v_mfma_f32_16x16x32_bf16 v[72:75], v[176:179], a[28:31], v[72:75]
    v_mfma_f32_16x16x32_bf16 v[76:79], v[180:183], a[28:31], v[76:79]
    ds_read_b128 a[60:63], v4 offset:14336
    s_waitcnt vmcnt(8)
    s_barrier
    s_waitcnt lgkmcnt(4)
    v_mfma_f32_16x16x32_bf16 v[16:19], v[184:187], a[32:35], v[16:19]
    v_mfma_f32_16x16x32_bf16 v[20:23], v[188:191], a[32:35], v[20:23]
    ds_read_b128 a[0:3], v3 offset:16384
    s_add_u32 m0, s21, 65536
    v_mfma_f32_16x16x32_bf16 v[24:27], v[184:187], a[36:39], v[24:27]
    v_mfma_f32_16x16x32_bf16 v[28:31], v[188:191], a[36:39], v[28:31]
    ds_read_b128 a[4:7], v3 offset:18432
    s_add_u32 s64, s20, 0x480
    buffer_load_dwordx4 v2, s[4:7], s64 offen lds
    v_mfma_f32_16x16x32_bf16 v[32:35], v[184:187], a[40:43], v[32:35]
    v_mfma_f32_16x16x32_bf16 v[36:39], v[188:191], a[40:43], v[36:39]
    ds_read_b128 a[8:11], v3 offset:20480
    s_add_u32 m0, s21, 66560
    v_mfma_f32_16x16x32_bf16 v[40:43], v[184:187], a[44:47], v[40:43]
    v_mfma_f32_16x16x32_bf16 v[44:47], v[188:191], a[44:47], v[44:47]
    ds_read_b128 a[12:15], v3 offset:22528
    s_add_u32 s64, s20, 0x2c80
    buffer_load_dwordx4 v2, s[4:7], s64 offen lds
    s_waitcnt lgkmcnt(4)
    v_mfma_f32_16x16x32_bf16 v[48:51], v[184:187], a[48:51], v[48:51]
    v_mfma_f32_16x16x32_bf16 v[52:55], v[188:191], a[48:51], v[52:55]
    ds_read_b128 a[16:19], v3 offset:24576
    s_add_u32 m0, s21, 67584
    v_mfma_f32_16x16x32_bf16 v[56:59], v[184:187], a[52:55], v[56:59]
    v_mfma_f32_16x16x32_bf16 v[60:63], v[188:191], a[52:55], v[60:63]
    ds_read_b128 a[20:23], v3 offset:26624
    s_add_u32 s64, s20, 0x5480
    buffer_load_dwordx4 v2, s[4:7], s64 offen lds
    v_mfma_f32_16x16x32_bf16 v[64:67], v[184:187], a[56:59], v[64:67]
    v_mfma_f32_16x16x32_bf16 v[68:71], v[188:191], a[56:59], v[68:71]
    ds_read_b128 a[24:27], v3 offset:28672
    s_add_u32 m0, s21, 68608
    v_mfma_f32_16x16x32_bf16 v[72:75], v[184:187], a[60:63], v[72:75]
    v_mfma_f32_16x16x32_bf16 v[76:79], v[188:191], a[60:63], v[76:79]
    ds_read_b128 a[28:31], v3 offset:30720
    s_add_u32 s64, s20, 0x7c80
    buffer_load_dwordx4 v2, s[4:7], s64 offen lds
    s_waitcnt lgkmcnt(4)
    v_mfma_f32_16x16x32_bf16 v[16:19], v[192:195], a[0:3], v[16:19]
    v_mfma_f32_16x16x32_bf16 v[20:23], v[196:199], a[0:3], v[20:23]
    ds_read_b128 a[32:35], v4 offset:16384
    v_mfma_f32_16x16x32_bf16 v[24:27], v[192:195], a[4:7], v[24:27]
    v_mfma_f32_16x16x32_bf16 v[28:31], v[196:199], a[4:7], v[28:31]
    ds_read_b128 a[36:39], v4 offset:18432
    v_mfma_f32_16x16x32_bf16 v[32:35], v[192:195], a[8:11], v[32:35]
    v_mfma_f32_16x16x32_bf16 v[36:39], v[196:199], a[8:11], v[36:39]
    ds_read_b128 a[40:43], v4 offset:20480
    v_mfma_f32_16x16x32_bf16 v[40:43], v[192:195], a[12:15], v[40:43]
    v_mfma_f32_16x16x32_bf16 v[44:47], v[196:199], a[12:15], v[44:47]
    ds_read_b128 a[44:47], v4 offset:22528
    s_waitcnt lgkmcnt(4)
    v_mfma_f32_16x16x32_bf16 v[48:51], v[192:195], a[16:19], v[48:51]
    v_mfma_f32_16x16x32_bf16 v[52:55], v[196:199], a[16:19], v[52:55]
    ds_read_b128 a[48:51], v4 offset:24576
    v_mfma_f32_16x16x32_bf16 v[56:59], v[192:195], a[20:23], v[56:59]
    v_mfma_f32_16x16x32_bf16 v[60:63], v[196:199], a[20:23], v[60:63]
    ds_read_b128 a[52:55], v4 offset:26624
    v_mfma_f32_16x16x32_bf16 v[64:67], v[192:195], a[24:27], v[64:67]
    v_mfma_f32_16x16x32_bf16 v[68:71], v[196:199], a[24:27], v[68:71]
    ds_read_b128 a[56:59], v4 offset:28672
    v_mfma_f32_16x16x32_bf16 v[72:75], v[192:195], a[28:31], v[72:75]
    v_mfma_f32_16x16x32_bf16 v[76:79], v[196:199], a[28:31], v[76:79]
    ds_read_b128 a[60:63], v4 offset:30720
    s_waitcnt vmcnt(8)
    s_barrier
    s_waitcnt lgkmcnt(4)
    v_mfma_f32_16x16x32_bf16 v[16:19], v[200:203], a[32:35], v[16:19]
    v_mfma_f32_16x16x32_bf16 v[20:23], v[204:207], a[32:35], v[20:23]
    ds_read_b128 a[0:3], v3 offset:32768
    s_add_u32 m0, s21, 0
    v_mfma_f32_16x16x32_bf16 v[24:27], v[200:203], a[36:39], v[24:27]
    v_mfma_f32_16x16x32_bf16 v[28:31], v[204:207], a[36:39], v[28:31]
    ds_read_b128 a[4:7], v3 offset:34816
    s_add_u32 s64, s20, 0x50000
    buffer_load_dwordx4 v2, s[4:7], s64 offen lds
    v_mfma_f32_16x16x32_bf16 v[32:35], v[200:203], a[40:43], v[32:35]
    v_mfma_f32_16x16x32_bf16 v[36:39], v[204:207], a[40:43], v[36:39]
    ds_read_b128 a[8:11], v3 offset:36864
    s_add_u32 m0, s21, 1024
    v_mfma_f32_16x16x32_bf16 v[40:43], v[200:203], a[44:47], v[40:43]
    v_mfma_f32_16x16x32_bf16 v[44:47], v[204:207], a[44:47], v[44:47]
    ds_read_b128 a[12:15], v3 offset:38912
    s_add_u32 s64, s20, 0x52800
    buffer_load_dwordx4 v2, s[4:7], s64 offen lds
    s_waitcnt lgkmcnt(4)
    v_mfma_f32_16x16x32_bf16 v[48:51], v[200:203], a[48:51], v[48:51]
    v_mfma_f32_16x16x32_bf16 v[52:55], v[204:207], a[48:51], v[52:55]
    ds_read_b128 a[16:19], v3 offset:40960
    s_add_u32 m0, s21, 2048
    v_mfma_f32_16x16x32_bf16 v[56:59], v[200:203], a[52:55], v[56:59]
    v_mfma_f32_16x16x32_bf16 v[60:63], v[204:207], a[52:55], v[60:63]
    ds_read_b128 a[20:23], v3 offset:43008
    s_add_u32 s64, s20, 0x55000
    buffer_load_dwordx4 v2, s[4:7], s64 offen lds
    v_mfma_f32_16x16x32_bf16 v[64:67], v[200:203], a[56:59], v[64:67]
    v_mfma_f32_16x16x32_bf16 v[68:71], v[204:207], a[56:59], v[68:71]
    ds_read_b128 a[24:27], v3 offset:45056
    s_add_u32 m0, s21, 3072
    v_mfma_f32_16x16x32_bf16 v[72:75], v[200:203], a[60:63], v[72:75]
    v_mfma_f32_16x16x32_bf16 v[76:79], v[204:207], a[60:63], v[76:79]
    ds_read_b128 a[28:31], v3 offset:47104
    s_add_u32 s64, s20, 0x57800
    buffer_load_dwordx4 v2, s[4:7], s64 offen lds
    s_waitcnt lgkmcnt(4)
    v_mfma_f32_16x16x32_bf16 v[16:19], v[208:211], a[0:3], v[16:19]
    v_mfma_f32_16x16x32_bf16 v[20:23], v[212:215], a[0:3], v[20:23]
    ds_read_b128 a[32:35], v4 offset:32768
    v_mfma_f32_16x16x32_bf16 v[24:27], v[208:211], a[4:7], v[24:27]
    v_mfma_f32_16x16x32_bf16 v[28:31], v[212:215], a[4:7], v[28:31]
    ds_read_b128 a[36:39], v4 offset:34816
    v_mfma_f32_16x16x32_bf16 v[32:35], v[208:211], a[8:11], v[32:35]
    v_mfma_f32_16x16x32_bf16 v[36:39], v[212:215], a[8:11], v[36:39]
    ds_read_b128 a[40:43], v4 offset:36864
    v_mfma_f32_16x16x32_bf16 v[40:43], v[208:211], a[12:15], v[40:43]
    v_mfma_f32_16x16x32_bf16 v[44:47], v[212:215], a[12:15], v[44:47]
    ds_read_b128 a[44:47], v4 offset:38912
    s_waitcnt lgkmcnt(4)
    v_mfma_f32_16x16x32_bf16 v[48:51], v[208:211], a[16:19], v[48:51]
    v_mfma_f32_16x16x32_bf16 v[52:55], v[212:215], a[16:19], v[52:55]
    ds_read_b128 a[48:51], v4 offset:40960
    v_mfma_f32_16x16x32_bf16 v[56:59], v[208:211], a[20:23], v[56:59]
    v_mfma_f32_16x16x32_bf16 v[60:63], v[212:215], a[20:23], v[60:63]
    ds_read_b128 a[52:55], v4 offset:43008
    v_mfma_f32_16x16x32_bf16 v[64:67], v[208:211], a[24:27], v[64:67]
    v_mfma_f32_16x16x32_bf16 v[68:71], v[212:215], a[24:27], v[68:71]
    ds_read_b128 a[56:59], v4 offset:45056
    v_mfma_f32_16x16x32_bf16 v[72:75], v[208:211], a[28:31], v[72:75]
    v_mfma_f32_16x16x32_bf16 v[76:79], v[212:215], a[28:31], v[76:79]
    ds_read_b128 a[60:63], v4 offset:47104
    s_waitcnt vmcnt(8)
    s_barrier
    s_waitcnt lgkmcnt(4)
    v_mfma_f32_16x16x32_bf16 v[16:19], v[216:219], a[32:35], v[16:19]
    v_mfma_f32_16x16x32_bf16 v[20:23], v[220:223], a[32:35], v[20:23]
    ds_read_b128 a[0:3], v3 offset:49152
    s_add_u32 m0, s21, 16384
    v_mfma_f32_16x16x32_bf16 v[24:27], v[216:219], a[36:39], v[24:27]
    v_mfma_f32_16x16x32_bf16 v[28:31], v[220:223], a[36:39], v[28:31]
    ds_read_b128 a[4:7], v3 offset:51200
    s_add_u32 s64, s20, 0x50080
    buffer_load_dwordx4 v2, s[4:7], s64 offen lds
    v_mfma_f32_16x16x32_bf16 v[32:35], v[216:219], a[40:43], v[32:35]
    v_mfma_f32_16x16x32_bf16 v[36:39], v[220:223], a[40:43], v[36:39]
    ds_read_b128 a[8:11], v3 offset:53248
    s_add_u32 m0, s21, 17408
    v_mfma_f32_16x16x32_bf16 v[40:43], v[216:219], a[44:47], v[40:43]
    v_mfma_f32_16x16x32_bf16 v[44:47], v[220:223], a[44:47], v[44:47]
    ds_read_b128 a[12:15], v3 offset:55296
    s_add_u32 s64, s20, 0x52880
    buffer_load_dwordx4 v2, s[4:7], s64 offen lds
    s_waitcnt lgkmcnt(4)
    v_mfma_f32_16x16x32_bf16 v[48:51], v[216:219], a[48:51], v[48:51]
    v_mfma_f32_16x16x32_bf16 v[52:55], v[220:223], a[48:51], v[52:55]
    ds_read_b128 a[16:19], v3 offset:57344
    s_add_u32 m0, s21, 18432
    v_mfma_f32_16x16x32_bf16 v[56:59], v[216:219], a[52:55], v[56:59]
    v_mfma_f32_16x16x32_bf16 v[60:63], v[220:223], a[52:55], v[60:63]
    ds_read_b128 a[20:23], v3 offset:59392
    s_add_u32 s64, s20, 0x55080
    buffer_load_dwordx4 v2, s[4:7], s64 offen lds
    v_mfma_f32_16x16x32_bf16 v[64:67], v[216:219], a[56:59], v[64:67]
    v_mfma_f32_16x16x32_bf16 v[68:71], v[220:223], a[56:59], v[68:71]
    ds_read_b128 a[24:27], v3 offset:61440
    s_add_u32 m0, s21, 19456
    v_mfma_f32_16x16x32_bf16 v[72:75], v[216:219], a[60:63], v[72:75]
    v_mfma_f32_16x16x32_bf16 v[76:79], v[220:223], a[60:63], v[76:79]
    ds_read_b128 a[28:31], v3 offset:63488
    s_add_u32 s64, s20, 0x57880
    buffer_load_dwordx4 v2, s[4:7], s64 offen lds
    s_waitcnt lgkmcnt(4)
    v_mfma_f32_16x16x32_bf16 v[16:19], v[224:227], a[0:3], v[16:19]
    v_mfma_f32_16x16x32_bf16 v[20:23], v[228:231], a[0:3], v[20:23]
    ds_read_b128 a[32:35], v4 offset:49152
    v_mfma_f32_16x16x32_bf16 v[24:27], v[224:227], a[4:7], v[24:27]
    v_mfma_f32_16x16x32_bf16 v[28:31], v[228:231], a[4:7], v[28:31]
    ds_read_b128 a[36:39], v4 offset:51200
    v_mfma_f32_16x16x32_bf16 v[32:35], v[224:227], a[8:11], v[32:35]
    v_mfma_f32_16x16x32_bf16 v[36:39], v[228:231], a[8:11], v[36:39]
    ds_read_b128 a[40:43], v4 offset:53248
    v_mfma_f32_16x16x32_bf16 v[40:43], v[224:227], a[12:15], v[40:43]
    v_mfma_f32_16x16x32_bf16 v[44:47], v[228:231], a[12:15], v[44:47]
    ds_read_b128 a[44:47], v4 offset:55296
    s_waitcnt lgkmcnt(4)
    v_mfma_f32_16x16x32_bf16 v[48:51], v[224:227], a[16:19], v[48:51]
    v_mfma_f32_16x16x32_bf16 v[52:55], v[228:231], a[16:19], v[52:55]
    ds_read_b128 a[48:51], v4 offset:57344
    v_mfma_f32_16x16x32_bf16 v[56:59], v[224:227], a[20:23], v[56:59]
    v_mfma_f32_16x16x32_bf16 v[60:63], v[228:231], a[20:23], v[60:63]
    ds_read_b128 a[52:55], v4 offset:59392
    v_mfma_f32_16x16x32_bf16 v[64:67], v[224:227], a[24:27], v[64:67]
    v_mfma_f32_16x16x32_bf16 v[68:71], v[228:231], a[24:27], v[68:71]
    ds_read_b128 a[56:59], v4 offset:61440
    v_mfma_f32_16x16x32_bf16 v[72:75], v[224:227], a[28:31], v[72:75]
    v_mfma_f32_16x16x32_bf16 v[76:79], v[228:231], a[28:31], v[76:79]
    ds_read_b128 a[60:63], v4 offset:63488
    s_waitcnt vmcnt(8)
    s_barrier
    s_waitcnt lgkmcnt(4)
    v_mfma_f32_16x16x32_bf16 v[16:19], v[232:235], a[32:35], v[16:19]
    v_mfma_f32_16x16x32_bf16 v[20:23], v[236:239], a[32:35], v[20:23]
    ds_read_b128 a[0:3], v6 offset:0
    s_add_u32 m0, s21, 32768
    v_mfma_f32_16x16x32_bf16 v[24:27], v[232:235], a[36:39], v[24:27]
    v_mfma_f32_16x16x32_bf16 v[28:31], v[236:239], a[36:39], v[28:31]
    ds_read_b128 a[4:7], v6 offset:2048
    s_add_u32 s64, s20, 0x50100
    buffer_load_dwordx4 v2, s[4:7], s64 offen lds
    v_mfma_f32_16x16x32_bf16 v[32:35], v[232:235], a[40:43], v[32:35]
    v_mfma_f32_16x16x32_bf16 v[36:39], v[236:239], a[40:43], v[36:39]
    ds_read_b128 a[8:11], v6 offset:4096
    s_add_u32 m0, s21, 33792
    v_mfma_f32_16x16x32_bf16 v[40:43], v[232:235], a[44:47], v[40:43]
    v_mfma_f32_16x16x32_bf16 v[44:47], v[236:239], a[44:47], v[44:47]
    ds_read_b128 a[12:15], v6 offset:6144
    s_add_u32 s64, s20, 0x52900
    buffer_load_dwordx4 v2, s[4:7], s64 offen lds
    s_waitcnt lgkmcnt(4)
    v_mfma_f32_16x16x32_bf16 v[48:51], v[232:235], a[48:51], v[48:51]
    v_mfma_f32_16x16x32_bf16 v[52:55], v[236:239], a[48:51], v[52:55]
    ds_read_b128 a[16:19], v6 offset:8192
    s_add_u32 m0, s21, 34816
    v_mfma_f32_16x16x32_bf16 v[56:59], v[232:235], a[52:55], v[56:59]
    v_mfma_f32_16x16x32_bf16 v[60:63], v[236:239], a[52:55], v[60:63]
    ds_read_b128 a[20:23], v6 offset:10240
    s_add_u32 s64, s20, 0x55100
    buffer_load_dwordx4 v2, s[4:7], s64 offen lds
    v_mfma_f32_16x16x32_bf16 v[64:67], v[232:235], a[56:59], v[64:67]
    v_mfma_f32_16x16x32_bf16 v[68:71], v[236:239], a[56:59], v[68:71]
    ds_read_b128 a[24:27], v6 offset:12288
    s_add_u32 m0, s21, 35840
    v_mfma_f32_16x16x32_bf16 v[72:75], v[232:235], a[60:63], v[72:75]
    v_mfma_f32_16x16x32_bf16 v[76:79], v[236:239], a[60:63], v[76:79]
    ds_read_b128 a[28:31], v6 offset:14336
    s_add_u32 s64, s20, 0x57900
    buffer_load_dwordx4 v2, s[4:7], s64 offen lds
    s_waitcnt lgkmcnt(4)
    v_mfma_f32_16x16x32_bf16 v[16:19], v[240:243], a[0:3], v[16:19]
    v_mfma_f32_16x16x32_bf16 v[20:23], v[244:247], a[0:3], v[20:23]
    ds_read_b128 a[32:35], v9 offset:0
    v_mfma_f32_16x16x32_bf16 v[24:27], v[240:243], a[4:7], v[24:27]
    v_mfma_f32_16x16x32_bf16 v[28:31], v[244:247], a[4:7], v[28:31]
    ds_read_b128 a[36:39], v9 offset:2048
    v_mfma_f32_16x16x32_bf16 v[32:35], v[240:243], a[8:11], v[32:35]
    v_mfma_f32_16x16x32_bf16 v[36:39], v[244:247], a[8:11], v[36:39]
    ds_read_b128 a[40:43], v9 offset:4096
    v_mfma_f32_16x16x32_bf16 v[40:43], v[240:243], a[12:15], v[40:43]
    v_mfma_f32_16x16x32_bf16 v[44:47], v[244:247], a[12:15], v[44:47]
    ds_read_b128 a[44:47], v9 offset:6144
    s_waitcnt lgkmcnt(4)
    v_mfma_f32_16x16x32_bf16 v[48:51], v[240:243], a[16:19], v[48:51]
    v_mfma_f32_16x16x32_bf16 v[52:55], v[244:247], a[16:19], v[52:55]
    ds_read_b128 a[48:51], v9 offset:8192
    v_mfma_f32_16x16x32_bf16 v[56:59], v[240:243], a[20:23], v[56:59]
    v_mfma_f32_16x16x32_bf16 v[60:63], v[244:247], a[20:23], v[60:63]
    ds_read_b128 a[52:55], v9 offset:10240
    v_mfma_f32_16x16x32_bf16 v[64:67], v[240:243], a[24:27], v[64:67]
    v_mfma_f32_16x16x32_bf16 v[68:71], v[244:247], a[24:27], v[68:71]
    ds_read_b128 a[56:59], v9 offset:12288
    v_mfma_f32_16x16x32_bf16 v[72:75], v[240:243], a[28:31], v[72:75]
    v_mfma_f32_16x16x32_bf16 v[76:79], v[244:247], a[28:31], v[76:79]
    ds_read_b128 a[60:63], v9 offset:14336
    s_waitcnt vmcnt(8)
    s_barrier
    s_waitcnt lgkmcnt(4)
    v_mfma_f32_16x16x32_bf16 v[16:19], v[248:251], a[32:35], v[16:19]
    v_mfma_f32_16x16x32_bf16 v[20:23], v[252:255], a[32:35], v[20:23]
    ds_read_b128 a[0:3], v3 offset:0
    s_add_u32 m0, s21, 49152
    v_mfma_f32_16x16x32_bf16 v[24:27], v[248:251], a[36:39], v[24:27]
    v_mfma_f32_16x16x32_bf16 v[28:31], v[252:255], a[36:39], v[28:31]
    ds_read_b128 a[4:7], v3 offset:2048
    s_add_u32 s64, s20, 0x50180
    buffer_load_dwordx4 v2, s[4:7], s64 offen lds
    v_mfma_f32_16x16x32_bf16 v[32:35], v[248:251], a[40:43], v[32:35]
    v_mfma_f32_16x16x32_bf16 v[36:39], v[252:255], a[40:43], v[36:39]
    ds_read_b128 a[8:11], v3 offset:4096
    s_add_u32 m0, s21, 50176
    v_mfma_f32_16x16x32_bf16 v[40:43], v[248:251], a[44:47], v[40:43]
    v_mfma_f32_16x16x32_bf16 v[44:47], v[252:255], a[44:47], v[44:47]
    ds_read_b128 a[12:15], v3 offset:6144
    s_add_u32 s64, s20, 0x52980
    buffer_load_dwordx4 v2, s[4:7], s64 offen lds
    s_waitcnt lgkmcnt(4)
    v_mfma_f32_16x16x32_bf16 v[48:51], v[248:251], a[48:51], v[48:51]
    v_mfma_f32_16x16x32_bf16 v[52:55], v[252:255], a[48:51], v[52:55]
    ds_read_b128 a[16:19], v3 offset:8192
    s_add_u32 m0, s21, 51200
    v_mfma_f32_16x16x32_bf16 v[56:59], v[248:251], a[52:55], v[56:59]
    v_mfma_f32_16x16x32_bf16 v[60:63], v[252:255], a[52:55], v[60:63]
    ds_read_b128 a[20:23], v3 offset:10240
    s_add_u32 s64, s20, 0x55180
    buffer_load_dwordx4 v2, s[4:7], s64 offen lds
    v_mfma_f32_16x16x32_bf16 v[64:67], v[248:251], a[56:59], v[64:67]
    v_mfma_f32_16x16x32_bf16 v[68:71], v[252:255], a[56:59], v[68:71]
    ds_read_b128 a[24:27], v3 offset:12288
    s_add_u32 m0, s21, 52224
    v_mfma_f32_16x16x32_bf16 v[72:75], v[248:251], a[60:63], v[72:75]
    v_mfma_f32_16x16x32_bf16 v[76:79], v[252:255], a[60:63], v[76:79]
    ds_read_b128 a[28:31], v3 offset:14336
    s_add_u32 s64, s20, 0x57980
    buffer_load_dwordx4 v2, s[4:7], s64 offen lds
    s_nop 5
    s_mul_i32 s65, s17, 0
    s_add_u32 s65, s65, s22
    s_add_u32 s64, s65, 0
    v_cvt_pk_bf16_f32 v80, v16, v17
    v_cvt_pk_bf16_f32 v81, v18, v19
    v_cvt_pk_bf16_f32 v82, v20, v21
    v_cvt_pk_bf16_f32 v83, v22, v23
    buffer_store_dwordx4 v[80:83], v1, s[4:7], s64 offen sc1
    s_add_u32 s64, s65, 4096
    v_cvt_pk_bf16_f32 v84, v24, v25
    v_cvt_pk_bf16_f32 v85, v26, v27
    v_cvt_pk_bf16_f32 v86, v28, v29
    v_cvt_pk_bf16_f32 v87, v30, v31
    buffer_store_dwordx4 v[84:87], v1, s[4:7], s64 offen sc1
    s_mul_i32 s65, s17, 1
    s_add_u32 s65, s65, s22
    s_add_u32 s64, s65, 0
    v_cvt_pk_bf16_f32 v88, v32, v33
    v_cvt_pk_bf16_f32 v89, v34, v35
    v_cvt_pk_bf16_f32 v90, v36, v37
    v_cvt_pk_bf16_f32 v91, v38, v39
    buffer_store_dwordx4 v[88:91], v1, s[4:7], s64 offen sc1
    s_add_u32 s64, s65, 4096
    v_cvt_pk_bf16_f32 v92, v40, v41
    v_cvt_pk_bf16_f32 v93, v42, v43
    v_cvt_pk_bf16_f32 v94, v44, v45
    v_cvt_pk_bf16_f32 v95, v46, v47
    buffer_store_dwordx4 v[92:95], v1, s[4:7], s64 offen sc1
    s_mul_i32 s65, s17, 2
    s_add_u32 s65, s65, s22
    s_add_u32 s64, s65, 0
    v_cvt_pk_bf16_f32 v80, v48, v49
    v_cvt_pk_bf16_f32 v81, v50, v51
    v_cvt_pk_bf16_f32 v82, v52, v53
    v_cvt_pk_bf16_f32 v83, v54, v55
    buffer_store_dwordx4 v[80:83], v1, s[4:7], s64 offen sc1
    s_add_u32 s64, s65, 4096
    v_cvt_pk_bf16_f32 v84, v56, v57
    v_cvt_pk_bf16_f32 v85, v58, v59
    v_cvt_pk_bf16_f32 v86, v60, v61
    v_cvt_pk_bf16_f32 v87, v62, v63
    buffer_store_dwordx4 v[84:87], v1, s[4:7], s64 offen sc1
    s_mul_i32 s65, s17, 3
    s_add_u32 s65, s65, s22
    s_add_u32 s64, s65, 0
    v_cvt_pk_bf16_f32 v88, v64, v65
    v_cvt_pk_bf16_f32 v89, v66, v67
    v_cvt_pk_bf16_f32 v90, v68, v69
    v_cvt_pk_bf16_f32 v91, v70, v71
    buffer_store_dwordx4 v[88:91], v1, s[4:7], s64 offen sc1
    s_add_u32 s64, s65, 4096
    v_cvt_pk_bf16_f32 v92, v72, v73
    v_cvt_pk_bf16_f32 v93, v74, v75
    v_cvt_pk_bf16_f32 v94, v76, v77
    v_cvt_pk_bf16_f32 v95, v78, v79
    buffer_store_dwordx4 v[92:95], v1, s[4:7], s64 offen sc1
    s_lshl_b32 s64, s19, 1
    s_add_u32 s64, s64, s12
    s_lshl_b32 s64, s64, 9
    s_add_u32 s23, s18, s64
    s_lshl_b32 s64, s17, 3
    s_add_u32 s22, s22, s64
    s_add_u32 s19, s19, 1
    s_add_u32 s20, s20, 0x50000
    s_cmp_lt_u32 s19, 8
    s_cbranch_scc1 G_T_LOOP
    s_waitcnt vmcnt(0) lgkmcnt(0)
    s_barrier
    s_cmp_lg_u32 s14, 0
    s_cbranch_scc1 GF_102
    v_mov_b32 v7, 1
    v_mov_b32 v8, 0
    s_mov_b64 exec, 1
    buffer_store_dword v7, v8, s[4:7], s23 offen sc1
    s_mov_b64 exec, -1
GF_102:
    s_cmp_eq_u32 s3, 2
    s_cbranch_scc1 H_Q
    s_cmp_eq_u32 s12, 1
    s_cbranch_scc1 H_OUT
    s_mov_b32 s29, 0
    v_lshlrev_b32 v1, 4, v0
    s_mov_b32 s65, 0
CW_103:
    buffer_load_dwordx2 v[8:9], off, s[60:63], 0 offset:132 sc1
    s_add_u32 s65, s65, 1
    s_waitcnt vmcnt(0)
    v_readfirstlane_b32 s66, v8
    v_readfirstlane_b32 s67, v9
    s_min_u32 s64, s66, s67
    s_cmp_lg_u32 s64, 0
    s_cbranch_scc1 CWD_104
    s_cmp_gt_u32 s65, 65536
    s_cbranch_scc1 CWD_104
    s_sleep 4
    s_branch CW_103
CWD_104:
    s_sub_u32 s66, s66, 1
    s_and_b32 s66, s66, 3
    s_sub_u32 s67, s67, 1
    s_and_b32 s67, s67, 3
    s_mov_b32 s64, s66
    s_mov_b32 s65, s67
    s_and_b32 s64, s64, 3
    s_lshl_b32 s64, s64, 13
    s_and_b32 s65, s65, 3
    s_lshl_b32 s65, s65, 13
    s_add_u32 s25, s64, 0x6000000
    s_add_u32 s30, s65, 0x6200000
    v_bfe_u32 v4, v0, 3, 1
    v_mul_u32_u24 v2, 0x8000, v4
    v_lshrrev_b32 v4, 5, v0
    v_lshl_add_u32 v2, v4, 8, v2
    v_bfe_u32 v4, v0, 4, 1
    v_lshl_add_u32 v2, v4, 7, v2
    v_and_b32 v4, 7, v0
    v_lshl_add_u32 v2, v4, 4, v2
    v_bfe_u32 v4, v0, 3, 1
    v_lshlrev_b32 v3, 16, v4
    v_lshrrev_b32 v4, 4, v0
    v_lshl_add_u32 v3, v4, 7, v3
    v_and_b32 v4, 7, v0
    v_lshl_add_u32 v3, v4, 4, v3
    s_lshl_b32 s26, s13, 11
    s_lshl_b32 s64, s14, 9
    s_add_u32 s26, s26, s64
    s_add_u32 s26, s26, 0x640000
    s_lshl_b32 s27, s13, 3
    s_add_u32 s27, s27, 0x294000
    s_mov_b32 s28, 0x29a000
    s_mov_b32 s24, 0
    v_lshlrev_b32 v6, 7, v0
MKT_LOOP:
    s_mov_b64 exec, 0xf
MKT_M_105:
    buffer_load_dword v5, v6, s[4:7], s28 offen sc1
    s_add_u32 s29, s29, 1
    s_waitcnt vmcnt(0)
    v_cmp_eq_u32 vcc, 0, v5
    s_cbranch_vccz MKT_MD_106
    s_cmp_gt_u32 s29, 262144
    s_cbranch_scc1 MKT_MD_106
    s_sleep 4
    s_branch MKT_M_105
MKT_MD_106:
    s_mov_b64 exec, -1
MKR_107:
    s_add_u32 s64, s25, 0x0
    buffer_load_dwordx4 v[16:19], v2, s[4:7], s64 offen sc1
    s_add_u32 s64, s25, 0x200
    buffer_load_dwordx4 v[20:23], v2, s[4:7], s64 offen sc1
    s_add_u32 s64, s25, 0x400
    buffer_load_dwordx4 v[24:27], v2, s[4:7], s64 offen sc1
    s_add_u32 s64, s25, 0x600
    buffer_load_dwordx4 v[28:31], v2, s[4:7], s64 offen sc1
    s_add_u32 s64, s25, 0x800
    buffer_load_dwordx4 v[32:35], v2, s[4:7], s64 offen sc1
    s_add_u32 s64, s25, 0xa00
    buffer_load_dwordx4 v[36:39], v2, s[4:7], s64 offen sc1
    s_add_u32 s64, s25, 0xc00
    buffer_load_dwordx4 v[40:43], v2, s[4:7], s64 offen sc1
    s_add_u32 s64, s25, 0xe00
    buffer_load_dwordx4 v[44:47], v2, s[4:7], s64 offen sc1
    s_add_u32 s64, s25, 0x1000
    buffer_load_dwordx4 v[48:51], v2, s[4:7], s64 offen sc1
    s_add_u32 s64, s25, 0x1200
    buffer_load_dwordx4 v[52:55], v2, s[4:7], s64 offen sc1
    s_add_u32 s64, s30, 0x0
    buffer_load_dwordx4 v[56:59], v2, s[4:7], s64 offen sc1
    s_add_u32 s64, s30, 0x200
    buffer_load_dwordx4 v[60:63], v2, s[4:7], s64 offen sc1
    s_add_u32 s64, s30, 0x400
    buffer_load_dwordx4 v[64:67], v2, s[4:7], s64 offen sc1
    s_add_u32 s64, s30, 0x600
    buffer_load_dwordx4 v[68:71], v2, s[4:7], s64 offen sc1
    s_add_u32 s64, s30, 0x800
    buffer_load_dwordx4 v[72:75], v2, s[4:7], s64 offen sc1
    s_add_u32 s64, s30, 0xa00
    buffer_load_dwordx4 v[76:79], v2, s[4:7], s64 offen sc1
    s_add_u32 s64, s30, 0xc00
    buffer_load_dwordx4 v[80:83], v2, s[4:7], s64 offen sc1
    s_add_u32 s64, s30, 0xe00
    buffer_load_dwordx4 v[84:87], v2, s[4:7], s64 offen sc1
    s_add_u32 s64, s30, 0x1000
    buffer_load_dwordx4 v[88:91], v2, s[4:7], s64 offen sc1
    s_add_u32 s64, s30, 0x1200
    buffer_load_dwordx4 v[92:95], v2, s[4:7], s64 offen sc1
    s_add_u32 s29, s29, 1
    s_waitcnt vmcnt(0)
    v_max3_u32 v4, v19, v23, v27
    v_max3_u32 v4, v4, v31, v35
    v_max3_u32 v4, v4, v39, v43
    v_max3_u32 v4, v4, v47, v51
    v_max3_u32 v4, v4, v55, v59
    v_max3_u32 v4, v4, v63, v67
    v_max3_u32 v4, v4, v71, v75
    v_max3_u32 v4, v4, v79, v83
    v_max3_u32 v4, v4, v87, v91
    v_max_u32 v4, v4, v95
    v_cmp_eq_u32 vcc, -1, v4
    s_cbranch_vccz MKO_108
    s_cmp_gt_u32 s29, 262144
    s_cbranch_scc0 MKR_107
MKO_108:
    v_mfma_f32_16x16x32_bf16 v[8:11], v[96:99], v[16:19], 0
    v_mfma_f32_16x16x32_bf16 v[12:15], v[100:103], v[16:19], 0
    v_mfma_f32_16x16x32_bf16 v[8:11], v[104:107], v[20:23], v[8:11]
    v_mfma_f32_16x16x32_bf16 v[12:15], v[108:111], v[20:23], v[12:15]
    v_mfma_f32_16x16x32_bf16 v[8:11], v[112:115], v[24:27], v[8:11]
    v_mfma_f32_16x16x32_bf16 v[12:15], v[116:119], v[24:27], v[12:15]
    v_mfma_f32_16x16x32_bf16 v[8:11], v[120:123], v[28:31], v[8:11]
    v_mfma_f32_16x16x32_bf16 v[12:15], v[124:127], v[28:31], v[12:15]
    v_mfma_f32_16x16x32_bf16 v[8:11], v[128:131], v[32:35], v[8:11]
    v_mfma_f32_16x16x32_bf16 v[12:15], v[132:135], v[32:35], v[12:15]
    v_mfma_f32_16x16x32_bf16 v[8:11], v[136:139], v[36:39], v[8:11]
    v_mfma_f32_16x16x32_bf16 v[12:15], v[140:143], v[36:39], v[12:15]
    v_mfma_f32_16x16x32_bf16 v[8:11], v[144:147], v[40:43], v[8:11]
    v_mfma_f32_16x16x32_bf16 v[12:15], v[148:151], v[40:43], v[12:15]
    v_mfma_f32_16x16x32_bf16 v[8:11], v[152:155], v[44:47], v[8:11]
    v_mfma_f32_16x16x32_bf16 v[12:15], v[156:159], v[44:47], v[12:15]
    v_mfma_f32_16x16x32_bf16 v[8:11], v[160:163], v[48:51], v[8:11]
    v_mfma_f32_16x16x32_bf16 v[12:15], v[164:167], v[48:51], v[12:15]
    v_mfma_f32_16x16x32_bf16 v[8:11], v[168:171], v[52:55], v[8:11]
    v_mfma_f32_16x16x32_bf16 v[12:15], v[172:175], v[52:55], v[12:15]
    v_mfma_f32_16x16x32_bf16 v[8:11], v[176:179], v[56:59], v[8:11]
    v_mfma_f32_16x16x32_bf16 v[12:15], v[180:183], v[56:59], v[12:15]
    v_mfma_f32_16x16x32_bf16 v[8:11], v[184:187], v[60:63], v[8:11]
    v_mfma_f32_16x16x32_bf16 v[12:15], v[188:191], v[60:63], v[12:15]
    v_mfma_f32_16x16x32_bf16 v[8:11], v[192:195], v[64:67], v[8:11]
    v_mfma_f32_16x16x32_bf16 v[12:15], v[196:199], v[64:67], v[12:15]
    v_mfma_f32_16x16x32_bf16 v[8:11], v[200:203], v[68:71], v[8:11]
    v_mfma_f32_16x16x32_bf16 v[12:15], v[204:207], v[68:71], v[12:15]
    v_mfma_f32_16x16x32_bf16 v[8:11], v[208:211], v[72:75], v[8:11]
    v_mfma_f32_16x16x32_bf16 v[12:15], v[212:215], v[72:75], v[12:15]
    v_mfma_f32_16x16x32_bf16 v[8:11], v[216:219], v[76:79], v[8:11]
    v_mfma_f32_16x16x32_bf16 v[12:15], v[220:223], v[76:79], v[12:15]
    v_mfma_f32_16x16x32_bf16 v[8:11], v[224:227], v[80:83], v[8:11]
    v_mfma_f32_16x16x32_bf16 v[12:15], v[228:231], v[80:83], v[12:15]
    v_mfma_f32_16x16x32_bf16 v[8:11], v[232:235], v[84:87], v[8:11]
    v_mfma_f32_16x16x32_bf16 v[12:15], v[236:239], v[84:87], v[12:15]
    v_mfma_f32_16x16x32_bf16 v[8:11], v[240:243], v[88:91], v[8:11]
    v_mfma_f32_16x16x32_bf16 v[12:15], v[244:247], v[88:91], v[12:15]
    v_mfma_f32_16x16x32_bf16 v[8:11], v[248:251], v[92:95], v[8:11]
    v_mfma_f32_16x16x32_bf16 v[12:15], v[252:255], v[92:95], v[12:15]
    s_nop 7
    v_cvt_pk_bf16_f32 v16, v8, v9
    v_cvt_pk_bf16_f32 v17, v10, v11
    v_cvt_pk_bf16_f32 v18, v12, v13
    v_cvt_pk_bf16_f32 v19, v14, v15
    buffer_store_dwordx4 v[16:19], v3, s[4:7], s26 offen sc1
    s_waitcnt vmcnt(0)
    s_barrier
    s_cmp_lg_u32 s14, 0
    s_cbranch_scc1 GF_109
    v_mov_b32 v7, 1
    v_mov_b32 v8, 0
    s_mov_b64 exec, 1
    buffer_store_dword v7, v8, s[4:7], s27 offen sc1
    s_mov_b64 exec, -1
GF_109:
    s_add_u32 s25, s25, 0x10000
    s_add_u32 s30, s30, 0x10000
    s_add_u32 s26, s26, 0x20000
    s_add_u32 s27, s27, 256
    s_add_u32 s28, s28, 512
    s_add_u32 s24, s24, 1
    s_cmp_lt_u32 s24, 32
    s_cbranch_scc1 MKT_LOOP
    s_branch M_EXIT
G_N:
    s_lshl_b32 s65, s13, 8
    s_lshl_b32 s66, s14, 6
    s_add_u32 s20, s65, s66
    s_mul_i32 s21, s14, 36864
    v_lshrrev_b32 v6, 2, v0
    v_mul_u32_u24 v5, 8192, v6
    v_lshrrev_b32 v6, 5, v0
    v_lshlrev_b32 v6, 1, v6
    v_and_b32 v7, 3, v0
    v_xor_b32 v6, v6, v7
    v_lshl_add_u32 v5, v6, 4, v5
    v_lshrrev_b32 v6, 5, v0
    v_lshlrev_b32 v3, 10, v6
    v_bfe_u32 v6, v0, 2, 2
    v_lshl_add_u32 v3, v6, 6, v3
    v_and_b32 v6, 3, v0
    v_lshl_add_u32 v3, v6, 3, v3
    v_bfe_u32 v6, v0, 4, 1
    v_lshl_add_u32 v3, v6, 9, v3
    v_add_u32 v3, s21, v3
    v_lshlrev_b32 v6, 5, v6
    v_sub_u32 v4, 32, v6
    v_add_u32 v4, v4, v3
    v_add_u32 v3, v3, v6
    s_add_u32 m0, s21, 0
    s_add_u32 s64, s20, 0x0
    buffer_load_dwordx4 v5, s[44:47], s64 offen lds
    s_add_u32 m0, s21, 1024
    s_add_u32 s64, s20, 0x20000
    buffer_load_dwordx4 v5, s[44:47], s64 offen lds
    s_add_u32 m0, s21, 2048
    s_add_u32 s64, s20, 0x40000
    buffer_load_dwordx4 v5, s[44:47], s64 offen lds
    s_add_u32 m0, s21, 3072
    s_add_u32 s64, s20, 0x60000
    buffer_load_dwordx4 v5, s[44:47], s64 offen lds
    s_add_u32 m0, s21, 4096
    s_add_u32 s64, s20, 0x80000
    buffer_load_dwordx4 v5, s[44:47], s64 offen lds
    s_add_u32 m0, s21, 5120
    s_add_u32 s64, s20, 0xa0000
    buffer_load_dwordx4 v5, s[44:47], s64 offen lds
    s_add_u32 m0, s21, 6144
    s_add_u32 s64, s20, 0xc0000
    buffer_load_dwordx4 v5, s[44:47], s64 offen lds
    s_add_u32 m0, s21, 7168
    s_add_u32 s64, s20, 0xe0000
    buffer_load_dwordx4 v5, s[44:47], s64 offen lds
    s_add_u32 m0, s21, 8192
    s_add_u32 s64, s20, 0x100000
    buffer_load_dwordx4 v5, s[44:47], s64 offen lds
    s_add_u32 m0, s21, 9216
    s_add_u32 s64, s20, 0x120000
    buffer_load_dwordx4 v5, s[44:47], s64 offen lds
    s_add_u32 m0, s21, 10240
    s_add_u32 s64, s20, 0x140000
    buffer_load_dwordx4 v5, s[44:47], s64 offen lds
    s_add_u32 m0, s21, 11264
    s_add_u32 s64, s20, 0x160000
    buffer_load_dwordx4 v5, s[44:47], s64 offen lds
    s_add_u32 m0, s21, 12288
    s_add_u32 s64, s20, 0x180000
    buffer_load_dwordx4 v5, s[44:47], s64 offen lds
    s_add_u32 m0, s21, 13312
    s_add_u32 s64, s20, 0x1a0000
    buffer_load_dwordx4 v5, s[44:47], s64 offen lds
    s_add_u32 m0, s21, 14336
    s_add_u32 s64, s20, 0x1c0000
    buffer_load_dwordx4 v5, s[44:47], s64 offen lds
    s_add_u32 m0, s21, 15360
    s_add_u32 s64, s20, 0x1e0000
    buffer_load_dwordx4 v5, s[44:47], s64 offen lds
    s_add_u32 m0, s21, 16384
    s_add_u32 s64, s20, 0x200000
    buffer_load_dwordx4 v5, s[44:47], s64 offen lds
    s_add_u32 m0, s21, 17408
    s_add_u32 s64, s20, 0x220000
    buffer_load_dwordx4 v5, s[44:47], s64 offen lds
    s_add_u32 m0, s21, 18432
    s_add_u32 s64, s20, 0x240000
    buffer_load_dwordx4 v5, s[44:47], s64 offen lds
    s_add_u32 m0, s21, 19456
    s_add_u32 s64, s20, 0x260000
    buffer_load_dwordx4 v5, s[44:47], s64 offen lds
    s_add_u32 m0, s21, 20480
    s_add_u32 s64, s20, 0x280000
    buffer_load_dwordx4 v5, s[44:47], s64 offen lds
    s_add_u32 m0, s21, 21504
    s_add_u32 s64, s20, 0x2a0000
    buffer_load_dwordx4 v5, s[44:47], s64 offen lds
    s_add_u32 m0, s21, 22528
    s_add_u32 s64, s20, 0x2c0000
    buffer_load_dwordx4 v5, s[44:47], s64 offen lds
    s_add_u32 m0, s21, 23552
    s_add_u32 s64, s20, 0x2e0000
    buffer_load_dwordx4 v5, s[44:47], s64 offen lds
    s_add_u32 m0, s21, 24576
    s_add_u32 s64, s20, 0x300000
    buffer_load_dwordx4 v5, s[44:47], s64 offen lds
    s_add_u32 m0, s21, 25600
    s_add_u32 s64, s20, 0x320000
    buffer_load_dwordx4 v5, s[44:47], s64 offen lds
    s_add_u32 m0, s21, 26624
    s_add_u32 s64, s20, 0x340000
    buffer_load_dwordx4 v5, s[44:47], s64 offen lds
    s_add_u32 m0, s21, 27648
    s_add_u32 s64, s20, 0x360000
    buffer_load_dwordx4 v5, s[44:47], s64 offen lds
    s_add_u32 m0, s21, 28672
    s_add_u32 s64, s20, 0x380000
    buffer_load_dwordx4 v5, s[44:47], s64 offen lds
    s_add_u32 m0, s21, 29696
    s_add_u32 s64, s20, 0x3a0000
    buffer_load_dwordx4 v5, s[44:47], s64 offen lds
    s_add_u32 m0, s21, 30720
    s_add_u32 s64, s20, 0x3c0000
    buffer_load_dwordx4 v5, s[44:47], s64 offen lds
    s_add_u32 m0, s21, 31744
    s_add_u32 s64, s20, 0x3e0000
    buffer_load_dwordx4 v5, s[44:47], s64 offen lds
    s_add_u32 m0, s21, 32768
    s_add_u32 s64, s20, 0x400000
    buffer_load_dwordx4 v5, s[44:47], s64 offen lds
    s_add_u32 m0, s21, 33792
    s_add_u32 s64, s20, 0x420000
    buffer_load_dwordx4 v5, s[44:47], s64 offen lds
    s_add_u32 m0, s21, 34816
    s_add_u32 s64, s20, 0x440000
    buffer_load_dwordx4 v5, s[44:47], s64 offen lds
    s_add_u32 m0, s21, 35840
    s_add_u32 s64, s20, 0x460000
    buffer_load_dwordx4 v5, s[44:47], s64 offen lds
    s_waitcnt vmcnt(32)
    ds_read_b64_tr_b16 v[96:97], v3 offset:0
    ds_read_b64_tr_b16 v[98:99], v3 offset:256
    ds_read_b64_tr_b16 v[100:101], v4 offset:0
    ds_read_b64_tr_b16 v[102:103], v4 offset:256
    ds_read_b64_tr_b16 v[104:105], v3 offset:2048
    ds_read_b64_tr_b16 v[106:107], v3 offset:2304
    ds_read_b64_tr_b16 v[108:109], v4 offset:2048
    ds_read_b64_tr_b16 v[110:111], v4 offset:2304
    s_waitcnt lgkmcnt(0)
    s_add_u32 m0, s21, 0
    s_add_u32 s64, s20, 0x480000
    buffer_load_dwordx4 v5, s[44:47], s64 offen lds
    s_add_u32 m0, s21, 1024
    s_add_u32 s64, s20, 0x4a0000
    buffer_load_dwordx4 v5, s[44:47], s64 offen lds
    s_add_u32 m0, s21, 2048
    s_add_u32 s64, s20, 0x4c0000
    buffer_load_dwordx4 v5, s[44:47], s64 offen lds
    s_add_u32 m0, s21, 3072
    s_add_u32 s64, s20, 0x4e0000
    buffer_load_dwordx4 v5, s[44:47], s64 offen lds
    s_waitcnt vmcnt(32)
    ds_read_b64_tr_b16 v[112:113], v3 offset:4096
    ds_read_b64_tr_b16 v[114:115], v3 offset:4352
    ds_read_b64_tr_b16 v[116:117], v4 offset:4096
    ds_read_b64_tr_b16 v[118:119], v4 offset:4352
    ds_read_b64_tr_b16 v[120:121], v3 offset:6144
    ds_read_b64_tr_b16 v[122:123], v3 offset:6400
    ds_read_b64_tr_b16 v[124:125], v4 offset:6144
    ds_read_b64_tr_b16 v[126:127], v4 offset:6400
    s_waitcnt lgkmcnt(0)
    s_waitcnt vmcnt(28)
    ds_read_b64_tr_b16 v[128:129], v3 offset:8192
    ds_read_b64_tr_b16 v[130:131], v3 offset:8448
    ds_read_b64_tr_b16 v[132:133], v4 offset:8192
    ds_read_b64_tr_b16 v[134:135], v4 offset:8448
    ds_read_b64_tr_b16 v[136:137], v3 offset:10240
    ds_read_b64_tr_b16 v[138:139], v3 offset:10496
    ds_read_b64_tr_b16 v[140:141], v4 offset:10240
    ds_read_b64_tr_b16 v[142:143], v4 offset:10496
    s_waitcnt lgkmcnt(0)
    s_waitcnt vmcnt(24)
    ds_read_b64_tr_b16 v[144:145], v3 offset:12288
    ds_read_b64_tr_b16 v[146:147], v3 offset:12544
    ds_read_b64_tr_b16 v[148:149], v4 offset:12288
    ds_read_b64_tr_b16 v[150:151], v4 offset:12544
    ds_read_b64_tr_b16 v[152:153], v3 offset:14336
    ds_read_b64_tr_b16 v[154:155], v3 offset:14592
    ds_read_b64_tr_b16 v[156:157], v4 offset:14336
    ds_read_b64_tr_b16 v[158:159], v4 offset:14592
    s_waitcnt lgkmcnt(0)
    s_waitcnt vmcnt(20)
    ds_read_b64_tr_b16 v[160:161], v3 offset:16384
    ds_read_b64_tr_b16 v[162:163], v3 offset:16640
    ds_read_b64_tr_b16 v[164:165], v4 offset:16384
    ds_read_b64_tr_b16 v[166:167], v4 offset:16640
    ds_read_b64_tr_b16 v[168:169], v3 offset:18432
    ds_read_b64_tr_b16 v[170:171], v3 offset:18688
    ds_read_b64_tr_b16 v[172:173], v4 offset:18432
    ds_read_b64_tr_b16 v[174:175], v4 offset:18688
    s_waitcnt lgkmcnt(0)
    s_waitcnt vmcnt(16)
    ds_read_b64_tr_b16 v[176:177], v3 offset:20480
    ds_read_b64_tr_b16 v[178:179], v3 offset:20736
    ds_read_b64_tr_b16 v[180:181], v4 offset:20480
    ds_read_b64_tr_b16 v[182:183], v4 offset:20736
    ds_read_b64_tr_b16 v[184:185], v3 offset:22528
    ds_read_b64_tr_b16 v[186:187], v3 offset:22784
    ds_read_b64_tr_b16 v[188:189], v4 offset:22528
    ds_read_b64_tr_b16 v[190:191], v4 offset:22784
    s_waitcnt lgkmcnt(0)
    s_waitcnt vmcnt(12)
    ds_read_b64_tr_b16 v[192:193], v3 offset:24576
    ds_read_b64_tr_b16 v[194:195], v3 offset:24832
    ds_read_b64_tr_b16 v[196:197], v4 offset:24576
    ds_read_b64_tr_b16 v[198:199], v4 offset:24832
    ds_read_b64_tr_b16 v[200:201], v3 offset:26624
    ds_read_b64_tr_b16 v[202:203], v3 offset:26880
    ds_read_b64_tr_b16 v[204:205], v4 offset:26624
    ds_read_b64_tr_b16 v[206:207], v4 offset:26880
    s_waitcnt lgkmcnt(0)
    s_waitcnt vmcnt(8)
    ds_read_b64_tr_b16 v[208:209], v3 offset:28672
    ds_read_b64_tr_b16 v[210:211], v3 offset:28928
    ds_read_b64_tr_b16 v[212:213], v4 offset:28672
    ds_read_b64_tr_b16 v[214:215], v4 offset:28928
    ds_read_b64_tr_b16 v[216:217], v3 offset:30720
    ds_read_b64_tr_b16 v[218:219], v3 offset:30976
    ds_read_b64_tr_b16 v[220:221], v4 offset:30720
    ds_read_b64_tr_b16 v[222:223], v4 offset:30976
    s_waitcnt lgkmcnt(0)
    s_waitcnt vmcnt(4)
    ds_read_b64_tr_b16 v[224:225], v3 offset:32768
    ds_read_b64_tr_b16 v[226:227], v3 offset:33024
    ds_read_b64_tr_b16 v[228:229], v4 offset:32768
    ds_read_b64_tr_b16 v[230:231], v4 offset:33024
    ds_read_b64_tr_b16 v[232:233], v3 offset:34816
    ds_read_b64_tr_b16 v[234:235], v3 offset:35072
    ds_read_b64_tr_b16 v[236:237], v4 offset:34816
    ds_read_b64_tr_b16 v[238:239], v4 offset:35072
    s_waitcnt lgkmcnt(0)
    s_waitcnt vmcnt(0)
    ds_read_b64_tr_b16 v[240:241], v3 offset:0
    ds_read_b64_tr_b16 v[242:243], v3 offset:256
    ds_read_b64_tr_b16 v[244:245], v4 offset:0
    ds_read_b64_tr_b16 v[246:247], v4 offset:256
    ds_read_b64_tr_b16 v[248:249], v3 offset:2048
    ds_read_b64_tr_b16 v[250:251], v3 offset:2304
    ds_read_b64_tr_b16 v[252:253], v4 offset:2048
    ds_read_b64_tr_b16 v[254:255], v4 offset:2304
    s_waitcnt lgkmcnt(0)
    s_cmp_lg_u32 s97, 0
    s_cbranch_scc1 CM_110
    v_mbcnt_lo_u32_b32 v0, -1, 0
    v_mbcnt_hi_u32_b32 v0, -1, v0
    v_mul_u32_u24 v8, 32, v0
    s_mov_b32 s64, 0x0
    s_mov_b32 s65, 0
    s_mov_b64 exec, 0xff
TK_111:
    buffer_load_dword v9, v8, s[60:63], s64 offen sc1
    s_add_u32 s65, s65, 1
    s_waitcnt vmcnt(0)
    s_mov_b32 s66, 0
    v_readlane_b32 s67, v9, 0
    s_add_u32 s66, s66, s67
    v_readlane_b32 s67, v9, 1
    s_add_u32 s66, s66, s67
    v_readlane_b32 s67, v9, 2
    s_add_u32 s66, s66, s67
    v_readlane_b32 s67, v9, 3
    s_add_u32 s66, s66, s67
    v_readlane_b32 s67, v9, 4
    s_add_u32 s66, s66, s67
    v_readlane_b32 s67, v9, 5
    s_add_u32 s66, s66, s67
    v_readlane_b32 s67, v9, 6
    s_add_u32 s66, s66, s67
    v_readlane_b32 s67, v9, 7
    s_add_u32 s66, s66, s67
    s_cmp_ge_u32 s66, 256
    s_cbranch_scc1 TKD_112
    s_cmp_gt_u32 s65, 262144
    s_cbranch_scc0 TK_111
TKD_112:
    v_cmp_ne_u32 vcc, 32, v9
    s_mov_b64 exec, -1
    s_cbranch_vccnz M_SLOW
CM_110:
    s_mov_b32 s65, 0
GI_113:
    buffer_load_dword v8, off, s[60:63], s95 sc1
    s_add_u32 s65, s65, 1
    s_waitcnt vmcnt(0)
    v_readfirstlane_b32 s64, v8
    s_cmp_ge_u32 s64, 192
    s_cbranch_scc1 GID_114
    s_cmp_gt_u32 s65, 65536
    s_cbranch_scc1 GID_114
    s_sleep 4
    s_branch GI_113
GID_114:
    v_mbcnt_lo_u32_b32 v0, -1, 0
    v_mbcnt_hi_u32_b32 v0, -1, v0
    v_lshlrev_b32 v1, 4, v0
    v_lshrrev_b32 v6, 3, v0
    v_mul_u32_u24 v2, 1280, v6
    v_and_b32 v7, 7, v0
    v_xor_b32 v7, v7, v6
    v_lshl_add_u32 v2, v7, 4, v2
    v_bfe_u32 v6, v0, 3, 1
    v_lshlrev_b32 v9, 10, v6
    v_and_b32 v6, 7, v0
    v_lshl_add_u32 v9, v6, 7, v9
    v_lshrrev_b32 v7, 4, v0
    v_xor_b32 v7, v7, v6
    v_lshl_add_u32 v3, v7, 4, v9
    v_xor_b32 v7, 4, v7
    v_lshl_add_u32 v4, v7, 4, v9
    v_add_u32 v6, 0x10000, v3
    v_add_u32 v9, 0x10000, v4
    s_barrier
    s_mul_i32 s20, s12, 163840
    s_mul_i32 s64, s14, 40960
    s_add_u32 s20, s20, s64
    s_add_u32 s20, s20, 0x0
    s_lshl_b32 s21, s14, 12
    s_add_u32 m0, s21, 0
    s_add_u32 s64, s20, 0x0
    buffer_load_dwordx4 v2, s[4:7], s64 offen lds
    s_add_u32 m0, s21, 1024
    s_add_u32 s64, s20, 0x2800
    buffer_load_dwordx4 v2, s[4:7], s64 offen lds
    s_add_u32 m0, s21, 2048
    s_add_u32 s64, s20, 0x5000
    buffer_load_dwordx4 v2, s[4:7], s64 offen lds
    s_add_u32 m0, s21, 3072
    s_add_u32 s64, s20, 0x7800
    buffer_load_dwordx4 v2, s[4:7], s64 offen lds
    s_add_u32 m0, s21, 16384
    s_add_u32 s64, s20, 0x80
    buffer_load_dwordx4 v2, s[4:7], s64 offen lds
    s_add_u32 m0, s21, 17408
    s_add_u32 s64, s20, 0x2880
    buffer_load_dwordx4 v2, s[4:7], s64 offen lds
    s_add_u32 m0, s21, 18432
    s_add_u32 s64, s20, 0x5080
    buffer_load_dwordx4 v2, s[4:7], s64 offen lds
    s_add_u32 m0, s21, 19456
    s_add_u32 s64, s20, 0x7880
    buffer_load_dwordx4 v2, s[4:7], s64 offen lds
    s_add_u32 m0, s21, 32768
    s_add_u32 s64, s20, 0x100
    buffer_load_dwordx4 v2, s[4:7], s64 offen lds
    s_add_u32 m0, s21, 33792
    s_add_u32 s64, s20, 0x2900
    buffer_load_dwordx4 v2, s[4:7], s64 offen lds
    s_add_u32 m0, s21, 34816
    s_add_u32 s64, s20, 0x5100
    buffer_load_dwordx4 v2, s[4:7], s64 offen lds
    s_add_u32 m0, s21, 35840
    s_add_u32 s64, s20, 0x7900
    buffer_load_dwordx4 v2, s[4:7], s64 offen lds
    s_add_u32 m0, s21, 49152
    s_add_u32 s64, s20, 0x180
    buffer_load_dwordx4 v2, s[4:7], s64 offen lds
    s_add_u32 m0, s21, 50176
    s_add_u32 s64, s20, 0x2980
    buffer_load_dwordx4 v2, s[4:7], s64 offen lds
    s_add_u32 m0, s21, 51200
    s_add_u32 s64, s20, 0x5180
    buffer_load_dwordx4 v2, s[4:7], s64 offen lds
    s_add_u32 m0, s21, 52224
    s_add_u32 s64, s20, 0x7980
    buffer_load_dwordx4 v2, s[4:7], s64 offen lds
    s_mov_b32 s64, 0x40000000
    buffer_store_dword v7, v1, s[4:7], s64 offen
    buffer_store_dword v7, v1, s[4:7], s64 offen
    buffer_store_dword v7, v1, s[4:7], s64 offen
    buffer_store_dword v7, v1, s[4:7], s64 offen
    buffer_store_dword v7, v1, s[4:7], s64 offen
    buffer_store_dword v7, v1, s[4:7], s64 offen
    buffer_store_dword v7, v1, s[4:7], s64 offen
    buffer_store_dword v7, v1, s[4:7], s64 offen
    s_waitcnt vmcnt(20)
    s_barrier
    ds_read_b128 a[0:3], v3 offset:0
    ds_read_b128 a[4:7], v3 offset:2048
    ds_read_b128 a[8:11], v3 offset:4096
    ds_read_b128 a[12:15], v3 offset:6144
    ds_read_b128 a[16:19], v3 offset:8192
    ds_read_b128 a[20:23], v3 offset:10240
    ds_read_b128 a[24:27], v3 offset:12288
    ds_read_b128 a[28:31], v3 offset:14336
    s_mov_b32 s19, 0
    s_mov_b32 s22, s16
    s_mov_b32 s23, 0x40000000
G_N_LOOP:
    s_waitcnt lgkmcnt(4)
    v_mfma_f32_16x16x32_bf16 v[16:19], a[0:3], v[96:99], 0
    v_mfma_f32_16x16x32_bf16 v[20:23], a[0:3], v[100:103], 0
    ds_read_b128 a[32:35], v4 offset:0
    v_mfma_f32_16x16x32_bf16 v[24:27], a[4:7], v[96:99], 0
    v_mfma_f32_16x16x32_bf16 v[28:31], a[4:7], v[100:103], 0
    ds_read_b128 a[36:39], v4 offset:2048
    v_mfma_f32_16x16x32_bf16 v[32:35], a[8:11], v[96:99], 0
    v_mfma_f32_16x16x32_bf16 v[36:39], a[8:11], v[100:103], 0
    ds_read_b128 a[40:43], v4 offset:4096
    v_mfma_f32_16x16x32_bf16 v[40:43], a[12:15], v[96:99], 0
    v_mfma_f32_16x16x32_bf16 v[44:47], a[12:15], v[100:103], 0
    ds_read_b128 a[44:47], v4 offset:6144
    s_waitcnt lgkmcnt(4)
    v_mfma_f32_16x16x32_bf16 v[48:51], a[16:19], v[96:99], 0
    v_mfma_f32_16x16x32_bf16 v[52:55], a[16:19], v[100:103], 0
    ds_read_b128 a[48:51], v4 offset:8192
    v_mfma_f32_16x16x32_bf16 v[56:59], a[20:23], v[96:99], 0
    v_mfma_f32_16x16x32_bf16 v[60:63], a[20:23], v[100:103], 0
    ds_read_b128 a[52:55], v4 offset:10240
    v_mfma_f32_16x16x32_bf16 v[64:67], a[24:27], v[96:99], 0
    v_mfma_f32_16x16x32_bf16 v[68:71], a[24:27], v[100:103], 0
    ds_read_b128 a[56:59], v4 offset:12288
    v_mfma_f32_16x16x32_bf16 v[72:75], a[28:31], v[96:99], 0
    v_mfma_f32_16x16x32_bf16 v[76:79], a[28:31], v[100:103], 0
    ds_read_b128 a[60:63], v4 offset:14336
    s_waitcnt vmcnt(16)
    s_barrier
    s_waitcnt lgkmcnt(4)
    v_mfma_f32_16x16x32_bf16 v[16:19], a[32:35], v[104:107], v[16:19]
    v_mfma_f32_16x16x32_bf16 v[20:23], a[32:35], v[108:111], v[20:23]
    ds_read_b128 a[0:3], v3 offset:16384
    s_add_u32 m0, s21, 65536
    v_mfma_f32_16x16x32_bf16 v[24:27], a[36:39], v[104:107], v[24:27]
    v_mfma_f32_16x16x32_bf16 v[28:31], a[36:39], v[108:111], v[28:31]
    ds_read_b128 a[4:7], v3 offset:18432
    s_add_u32 s64, s20, 0x200
    buffer_load_dwordx4 v2, s[4:7], s64 offen lds
    v_mfma_f32_16x16x32_bf16 v[32:35], a[40:43], v[104:107], v[32:35]
    v_mfma_f32_16x16x32_bf16 v[36:39], a[40:43], v[108:111], v[36:39]
    ds_read_b128 a[8:11], v3 offset:20480
    s_add_u32 m0, s21, 66560
    v_mfma_f32_16x16x32_bf16 v[40:43], a[44:47], v[104:107], v[40:43]
    v_mfma_f32_16x16x32_bf16 v[44:47], a[44:47], v[108:111], v[44:47]
    ds_read_b128 a[12:15], v3 offset:22528
    s_add_u32 s64, s20, 0x2a00
    buffer_load_dwordx4 v2, s[4:7], s64 offen lds
    s_waitcnt lgkmcnt(4)
    v_mfma_f32_16x16x32_bf16 v[48:51], a[48:51], v[104:107], v[48:51]
    v_mfma_f32_16x16x32_bf16 v[52:55], a[48:51], v[108:111], v[52:55]
    ds_read_b128 a[16:19], v3 offset:24576
    s_add_u32 m0, s21, 67584
    v_mfma_f32_16x16x32_bf16 v[56:59], a[52:55], v[104:107], v[56:59]
    v_mfma_f32_16x16x32_bf16 v[60:63], a[52:55], v[108:111], v[60:63]
    ds_read_b128 a[20:23], v3 offset:26624
    s_add_u32 s64, s20, 0x5200
    buffer_load_dwordx4 v2, s[4:7], s64 offen lds
    v_mfma_f32_16x16x32_bf16 v[64:67], a[56:59], v[104:107], v[64:67]
    v_mfma_f32_16x16x32_bf16 v[68:71], a[56:59], v[108:111], v[68:71]
    ds_read_b128 a[24:27], v3 offset:28672
    s_add_u32 m0, s21, 68608
    v_mfma_f32_16x16x32_bf16 v[72:75], a[60:63], v[104:107], v[72:75]
    v_mfma_f32_16x16x32_bf16 v[76:79], a[60:63], v[108:111], v[76:79]
    ds_read_b128 a[28:31], v3 offset:30720
    s_add_u32 s64, s20, 0x7a00
    buffer_load_dwordx4 v2, s[4:7], s64 offen lds
    s_waitcnt lgkmcnt(4)
    v_mfma_f32_16x16x32_bf16 v[16:19], a[0:3], v[112:115], v[16:19]
    v_mfma_f32_16x16x32_bf16 v[20:23], a[0:3], v[116:119], v[20:23]
    ds_read_b128 a[32:35], v4 offset:16384
    v_mfma_f32_16x16x32_bf16 v[24:27], a[4:7], v[112:115], v[24:27]
    v_mfma_f32_16x16x32_bf16 v[28:31], a[4:7], v[116:119], v[28:31]
    ds_read_b128 a[36:39], v4 offset:18432
    v_mfma_f32_16x16x32_bf16 v[32:35], a[8:11], v[112:115], v[32:35]
    v_mfma_f32_16x16x32_bf16 v[36:39], a[8:11], v[116:119], v[36:39]
    ds_read_b128 a[40:43], v4 offset:20480
    v_mfma_f32_16x16x32_bf16 v[40:43], a[12:15], v[112:115], v[40:43]
    v_mfma_f32_16x16x32_bf16 v[44:47], a[12:15], v[116:119], v[44:47]
    ds_read_b128 a[44:47], v4 offset:22528
    s_waitcnt lgkmcnt(4)
    v_mfma_f32_16x16x32_bf16 v[48:51], a[16:19], v[112:115], v[48:51]
    v_mfma_f32_16x16x32_bf16 v[52:55], a[16:19], v[116:119], v[52:55]
    ds_read_b128 a[48:51], v4 offset:24576
    v_mfma_f32_16x16x32_bf16 v[56:59], a[20:23], v[112:115], v[56:59]
    v_mfma_f32_16x16x32_bf16 v[60:63], a[20:23], v[116:119], v[60:63]
    ds_read_b128 a[52:55], v4 offset:26624
    v_mfma_f32_16x16x32_bf16 v[64:67], a[24:27], v[112:115], v[64:67]
    v_mfma_f32_16x16x32_bf16 v[68:71], a[24:27], v[116:119], v[68:71]
    ds_read_b128 a[56:59], v4 offset:28672
    v_mfma_f32_16x16x32_bf16 v[72:75], a[28:31], v[112:115], v[72:75]
    v_mfma_f32_16x16x32_bf16 v[76:79], a[28:31], v[116:119], v[76:79]
    ds_read_b128 a[60:63], v4 offset:30720
    s_waitcnt vmcnt(16)
    s_barrier
    s_waitcnt lgkmcnt(4)
    v_mfma_f32_16x16x32_bf16 v[16:19], a[32:35], v[120:123], v[16:19]
    v_mfma_f32_16x16x32_bf16 v[20:23], a[32:35], v[124:127], v[20:23]
    ds_read_b128 a[0:3], v3 offset:32768
    s_add_u32 m0, s21, 0
    v_mfma_f32_16x16x32_bf16 v[24:27], a[36:39], v[120:123], v[24:27]
    v_mfma_f32_16x16x32_bf16 v[28:31], a[36:39], v[124:127], v[28:31]
    ds_read_b128 a[4:7], v3 offset:34816
    s_add_u32 s64, s20, 0x280
    buffer_load_dwordx4 v2, s[4:7], s64 offen lds
    v_mfma_f32_16x16x32_bf16 v[32:35], a[40:43], v[120:123], v[32:35]
    v_mfma_f32_16x16x32_bf16 v[36:39], a[40:43], v[124:127], v[36:39]
    ds_read_b128 a[8:11], v3 offset:36864
    s_add_u32 m0, s21, 1024
    v_mfma_f32_16x16x32_bf16 v[40:43], a[44:47], v[120:123], v[40:43]
    v_mfma_f32_16x16x32_bf16 v[44:47], a[44:47], v[124:127], v[44:47]
    ds_read_b128 a[12:15], v3 offset:38912
    s_add_u32 s64, s20, 0x2a80
    buffer_load_dwordx4 v2, s[4:7], s64 offen lds
    s_waitcnt lgkmcnt(4)
    v_mfma_f32_16x16x32_bf16 v[48:51], a[48:51], v[120:123], v[48:51]
    v_mfma_f32_16x16x32_bf16 v[52:55], a[48:51], v[124:127], v[52:55]
    ds_read_b128 a[16:19], v3 offset:40960
    s_add_u32 m0, s21, 2048
    v_mfma_f32_16x16x32_bf16 v[56:59], a[52:55], v[120:123], v[56:59]
    v_mfma_f32_16x16x32_bf16 v[60:63], a[52:55], v[124:127], v[60:63]
    ds_read_b128 a[20:23], v3 offset:43008
    s_add_u32 s64, s20, 0x5280
    buffer_load_dwordx4 v2, s[4:7], s64 offen lds
    v_mfma_f32_16x16x32_bf16 v[64:67], a[56:59], v[120:123], v[64:67]
    v_mfma_f32_16x16x32_bf16 v[68:71], a[56:59], v[124:127], v[68:71]
    ds_read_b128 a[24:27], v3 offset:45056
    s_add_u32 m0, s21, 3072
    v_mfma_f32_16x16x32_bf16 v[72:75], a[60:63], v[120:123], v[72:75]
    v_mfma_f32_16x16x32_bf16 v[76:79], a[60:63], v[124:127], v[76:79]
    ds_read_b128 a[28:31], v3 offset:47104
    s_add_u32 s64, s20, 0x7a80
    buffer_load_dwordx4 v2, s[4:7], s64 offen lds
    s_waitcnt lgkmcnt(4)
    v_mfma_f32_16x16x32_bf16 v[16:19], a[0:3], v[128:131], v[16:19]
    v_mfma_f32_16x16x32_bf16 v[20:23], a[0:3], v[132:135], v[20:23]
    ds_read_b128 a[32:35], v4 offset:32768
    v_mfma_f32_16x16x32_bf16 v[24:27], a[4:7], v[128:131], v[24:27]
    v_mfma_f32_16x16x32_bf16 v[28:31], a[4:7], v[132:135], v[28:31]
    ds_read_b128 a[36:39], v4 offset:34816
    v_mfma_f32_16x16x32_bf16 v[32:35], a[8:11], v[128:131], v[32:35]
    v_mfma_f32_16x16x32_bf16 v[36:39], a[8:11], v[132:135], v[36:39]
    ds_read_b128 a[40:43], v4 offset:36864
    v_mfma_f32_16x16x32_bf16 v[40:43], a[12:15], v[128:131], v[40:43]
    v_mfma_f32_16x16x32_bf16 v[44:47], a[12:15], v[132:135], v[44:47]
    ds_read_b128 a[44:47], v4 offset:38912
    s_waitcnt lgkmcnt(4)
    v_mfma_f32_16x16x32_bf16 v[48:51], a[16:19], v[128:131], v[48:51]
    v_mfma_f32_16x16x32_bf16 v[52:55], a[16:19], v[132:135], v[52:55]
    ds_read_b128 a[48:51], v4 offset:40960
    v_mfma_f32_16x16x32_bf16 v[56:59], a[20:23], v[128:131], v[56:59]
    v_mfma_f32_16x16x32_bf16 v[60:63], a[20:23], v[132:135], v[60:63]
    ds_read_b128 a[52:55], v4 offset:43008
    v_mfma_f32_16x16x32_bf16 v[64:67], a[24:27], v[128:131], v[64:67]
    v_mfma_f32_16x16x32_bf16 v[68:71], a[24:27], v[132:135], v[68:71]
    ds_read_b128 a[56:59], v4 offset:45056
    v_mfma_f32_16x16x32_bf16 v[72:75], a[28:31], v[128:131], v[72:75]
    v_mfma_f32_16x16x32_bf16 v[76:79], a[28:31], v[132:135], v[76:79]
    ds_read_b128 a[60:63], v4 offset:47104
    s_waitcnt vmcnt(16)
    s_barrier
    s_waitcnt lgkmcnt(4)
    v_mfma_f32_16x16x32_bf16 v[16:19], a[32:35], v[136:139], v[16:19]
    v_mfma_f32_16x16x32_bf16 v[20:23], a[32:35], v[140:143], v[20:23]
    ds_read_b128 a[0:3], v3 offset:49152
    s_add_u32 m0, s21, 16384
    v_mfma_f32_16x16x32_bf16 v[24:27], a[36:39], v[136:139], v[24:27]
    v_mfma_f32_16x16x32_bf16 v[28:31], a[36:39], v[140:143], v[28:31]
    ds_read_b128 a[4:7], v3 offset:51200
    s_add_u32 s64, s20, 0x300
    buffer_load_dwordx4 v2, s[4:7], s64 offen lds
    v_mfma_f32_16x16x32_bf16 v[32:35], a[40:43], v[136:139], v[32:35]
    v_mfma_f32_16x16x32_bf16 v[36:39], a[40:43], v[140:143], v[36:39]
    ds_read_b128 a[8:11], v3 offset:53248
    s_add_u32 m0, s21, 17408
    v_mfma_f32_16x16x32_bf16 v[40:43], a[44:47], v[136:139], v[40:43]
    v_mfma_f32_16x16x32_bf16 v[44:47], a[44:47], v[140:143], v[44:47]
    ds_read_b128 a[12:15], v3 offset:55296
    s_add_u32 s64, s20, 0x2b00
    buffer_load_dwordx4 v2, s[4:7], s64 offen lds
    s_waitcnt lgkmcnt(4)
    v_mfma_f32_16x16x32_bf16 v[48:51], a[48:51], v[136:139], v[48:51]
    v_mfma_f32_16x16x32_bf16 v[52:55], a[48:51], v[140:143], v[52:55]
    ds_read_b128 a[16:19], v3 offset:57344
    s_add_u32 m0, s21, 18432
    v_mfma_f32_16x16x32_bf16 v[56:59], a[52:55], v[136:139], v[56:59]
    v_mfma_f32_16x16x32_bf16 v[60:63], a[52:55], v[140:143], v[60:63]
    ds_read_b128 a[20:23], v3 offset:59392
    s_add_u32 s64, s20, 0x5300
    buffer_load_dwordx4 v2, s[4:7], s64 offen lds
    v_mfma_f32_16x16x32_bf16 v[64:67], a[56:59], v[136:139], v[64:67]
    v_mfma_f32_16x16x32_bf16 v[68:71], a[56:59], v[140:143], v[68:71]
    ds_read_b128 a[24:27], v3 offset:61440
    s_add_u32 m0, s21, 19456
    v_mfma_f32_16x16x32_bf16 v[72:75], a[60:63], v[136:139], v[72:75]
    v_mfma_f32_16x16x32_bf16 v[76:79], a[60:63], v[140:143], v[76:79]
    ds_read_b128 a[28:31], v3 offset:63488
    s_add_u32 s64, s20, 0x7b00
    buffer_load_dwordx4 v2, s[4:7], s64 offen lds
    s_waitcnt lgkmcnt(4)
    v_mfma_f32_16x16x32_bf16 v[16:19], a[0:3], v[144:147], v[16:19]
    v_mfma_f32_16x16x32_bf16 v[20:23], a[0:3], v[148:151], v[20:23]
    ds_read_b128 a[32:35], v4 offset:49152
    v_mfma_f32_16x16x32_bf16 v[24:27], a[4:7], v[144:147], v[24:27]
    v_mfma_f32_16x16x32_bf16 v[28:31], a[4:7], v[148:151], v[28:31]
    ds_read_b128 a[36:39], v4 offset:51200
    v_mfma_f32_16x16x32_bf16 v[32:35], a[8:11], v[144:147], v[32:35]
    v_mfma_f32_16x16x32_bf16 v[36:39], a[8:11], v[148:151], v[36:39]
    ds_read_b128 a[40:43], v4 offset:53248
    v_mfma_f32_16x16x32_bf16 v[40:43], a[12:15], v[144:147], v[40:43]
    v_mfma_f32_16x16x32_bf16 v[44:47], a[12:15], v[148:151], v[44:47]
    ds_read_b128 a[44:47], v4 offset:55296
    s_waitcnt lgkmcnt(4)
    v_mfma_f32_16x16x32_bf16 v[48:51], a[16:19], v[144:147], v[48:51]
    v_mfma_f32_16x16x32_bf16 v[52:55], a[16:19], v[148:151], v[52:55]
    ds_read_b128 a[48:51], v4 offset:57344
    v_mfma_f32_16x16x32_bf16 v[56:59], a[20:23], v[144:147], v[56:59]
    v_mfma_f32_16x16x32_bf16 v[60:63], a[20:23], v[148:151], v[60:63]
    ds_read_b128 a[52:55], v4 offset:59392
    v_mfma_f32_16x16x32_bf16 v[64:67], a[24:27], v[144:147], v[64:67]
    v_mfma_f32_16x16x32_bf16 v[68:71], a[24:27], v[148:151], v[68:71]
    ds_read_b128 a[56:59], v4 offset:61440
    v_mfma_f32_16x16x32_bf16 v[72:75], a[28:31], v[144:147], v[72:75]
    v_mfma_f32_16x16x32_bf16 v[76:79], a[28:31], v[148:151], v[76:79]
    ds_read_b128 a[60:63], v4 offset:63488
    s_waitcnt vmcnt(8)
    s_barrier
    s_cmp_lg_u32 s14, 0
    s_cbranch_scc1 GF_115
    v_mov_b32 v7, 1
    v_mov_b32 v8, 0
    s_mov_b64 exec, 1
    buffer_store_dword v7, v8, s[4:7], s23 offen sc1
    s_mov_b64 exec, -1
GF_115:
    s_waitcnt lgkmcnt(4)
    v_mfma_f32_16x16x32_bf16 v[16:19], a[32:35], v[152:155], v[16:19]
    v_mfma_f32_16x16x32_bf16 v[20:23], a[32:35], v[156:159], v[20:23]
    ds_read_b128 a[0:3], v6 offset:0
    s_add_u32 m0, s21, 32768
    v_mfma_f32_16x16x32_bf16 v[24:27], a[36:39], v[152:155], v[24:27]
    v_mfma_f32_16x16x32_bf16 v[28:31], a[36:39], v[156:159], v[28:31]
    ds_read_b128 a[4:7], v6 offset:2048
    s_add_u32 s64, s20, 0x380
    buffer_load_dwordx4 v2, s[4:7], s64 offen lds
    v_mfma_f32_16x16x32_bf16 v[32:35], a[40:43], v[152:155], v[32:35]
    v_mfma_f32_16x16x32_bf16 v[36:39], a[40:43], v[156:159], v[36:39]
    ds_read_b128 a[8:11], v6 offset:4096
    s_add_u32 m0, s21, 33792
    v_mfma_f32_16x16x32_bf16 v[40:43], a[44:47], v[152:155], v[40:43]
    v_mfma_f32_16x16x32_bf16 v[44:47], a[44:47], v[156:159], v[44:47]
    ds_read_b128 a[12:15], v6 offset:6144
    s_add_u32 s64, s20, 0x2b80
    buffer_load_dwordx4 v2, s[4:7], s64 offen lds
    s_waitcnt lgkmcnt(4)
    v_mfma_f32_16x16x32_bf16 v[48:51], a[48:51], v[152:155], v[48:51]
    v_mfma_f32_16x16x32_bf16 v[52:55], a[48:51], v[156:159], v[52:55]
    ds_read_b128 a[16:19], v6 offset:8192
    s_add_u32 m0, s21, 34816
    v_mfma_f32_16x16x32_bf16 v[56:59], a[52:55], v[152:155], v[56:59]
    v_mfma_f32_16x16x32_bf16 v[60:63], a[52:55], v[156:159], v[60:63]
    ds_read_b128 a[20:23], v6 offset:10240
    s_add_u32 s64, s20, 0x5380
    buffer_load_dwordx4 v2, s[4:7], s64 offen lds
    v_mfma_f32_16x16x32_bf16 v[64:67], a[56:59], v[152:155], v[64:67]
    v_mfma_f32_16x16x32_bf16 v[68:71], a[56:59], v[156:159], v[68:71]
    ds_read_b128 a[24:27], v6 offset:12288
    s_add_u32 m0, s21, 35840
    v_mfma_f32_16x16x32_bf16 v[72:75], a[60:63], v[152:155], v[72:75]
    v_mfma_f32_16x16x32_bf16 v[76:79], a[60:63], v[156:159], v[76:79]
    ds_read_b128 a[28:31], v6 offset:14336
    s_add_u32 s64, s20, 0x7b80
    buffer_load_dwordx4 v2, s[4:7], s64 offen lds
    s_waitcnt lgkmcnt(4)
    v_mfma_f32_16x16x32_bf16 v[16:19], a[0:3], v[160:163], v[16:19]
    v_mfma_f32_16x16x32_bf16 v[20:23], a[0:3], v[164:167], v[20:23]
    ds_read_b128 a[32:35], v9 offset:0
    v_mfma_f32_16x16x32_bf16 v[24:27], a[4:7], v[160:163], v[24:27]
    v_mfma_f32_16x16x32_bf16 v[28:31], a[4:7], v[164:167], v[28:31]
    ds_read_b128 a[36:39], v9 offset:2048
    v_mfma_f32_16x16x32_bf16 v[32:35], a[8:11], v[160:163], v[32:35]
    v_mfma_f32_16x16x32_bf16 v[36:39], a[8:11], v[164:167], v[36:39]
    ds_read_b128 a[40:43], v9 offset:4096
    v_mfma_f32_16x16x32_bf16 v[40:43], a[12:15], v[160:163], v[40:43]
    v_mfma_f32_16x16x32_bf16 v[44:47], a[12:15], v[164:167], v[44:47]
    ds_read_b128 a[44:47], v9 offset:6144
    s_waitcnt lgkmcnt(4)
    v_mfma_f32_16x16x32_bf16 v[48:51], a[16:19], v[160:163], v[48:51]
    v_mfma_f32_16x16x32_bf16 v[52:55], a[16:19], v[164:167], v[52:55]
    ds_read_b128 a[48:51], v9 offset:8192
    v_mfma_f32_16x16x32_bf16 v[56:59], a[20:23], v[160:163], v[56:59]
    v_mfma_f32_16x16x32_bf16 v[60:63], a[20:23], v[164:167], v[60:63]
    ds_read_b128 a[52:55], v9 offset:10240
    v_mfma_f32_16x16x32_bf16 v[64:67], a[24:27], v[160:163], v[64:67]
    v_mfma_f32_16x16x32_bf16 v[68:71], a[24:27], v[164:167], v[68:71]
    ds_read_b128 a[56:59], v9 offset:12288
    v_mfma_f32_16x16x32_bf16 v[72:75], a[28:31], v[160:163], v[72:75]
    v_mfma_f32_16x16x32_bf16 v[76:79], a[28:31], v[164:167], v[76:79]
    ds_read_b128 a[60:63], v9 offset:14336
    s_waitcnt vmcnt(8)
    s_barrier
    s_waitcnt lgkmcnt(4)
    v_mfma_f32_16x16x32_bf16 v[16:19], a[32:35], v[168:171], v[16:19]
    v_mfma_f32_16x16x32_bf16 v[20:23], a[32:35], v[172:175], v[20:23]
    ds_read_b128 a[0:3], v3 offset:0
    s_add_u32 m0, s21, 49152
    v_mfma_f32_16x16x32_bf16 v[24:27], a[36:39], v[168:171], v[24:27]
    v_mfma_f32_16x16x32_bf16 v[28:31], a[36:39], v[172:175], v[28:31]
    ds_read_b128 a[4:7], v3 offset:2048
    s_add_u32 s64, s20, 0x400
    buffer_load_dwordx4 v2, s[4:7], s64 offen lds
    v_mfma_f32_16x16x32_bf16 v[32:35], a[40:43], v[168:171], v[32:35]
    v_mfma_f32_16x16x32_bf16 v[36:39], a[40:43], v[172:175], v[36:39]
    ds_read_b128 a[8:11], v3 offset:4096
    s_add_u32 m0, s21, 50176
    v_mfma_f32_16x16x32_bf16 v[40:43], a[44:47], v[168:171], v[40:43]
    v_mfma_f32_16x16x32_bf16 v[44:47], a[44:47], v[172:175], v[44:47]
    ds_read_b128 a[12:15], v3 offset:6144
    s_add_u32 s64, s20, 0x2c00
    buffer_load_dwordx4 v2, s[4:7], s64 offen lds
    s_waitcnt lgkmcnt(4)
    v_mfma_f32_16x16x32_bf16 v[48:51], a[48:51], v[168:171], v[48:51]
    v_mfma_f32_16x16x32_bf16 v[52:55], a[48:51], v[172:175], v[52:55]
    ds_read_b128 a[16:19], v3 offset:8192
    s_add_u32 m0, s21, 51200
    v_mfma_f32_16x16x32_bf16 v[56:59], a[52:55], v[168:171], v[56:59]
    v_mfma_f32_16x16x32_bf16 v[60:63], a[52:55], v[172:175], v[60:63]
    ds_read_b128 a[20:23], v3 offset:10240
    s_add_u32 s64, s20, 0x5400
    buffer_load_dwordx4 v2, s[4:7], s64 offen lds
    v_mfma_f32_16x16x32_bf16 v[64:67], a[56:59], v[168:171], v[64:67]
    v_mfma_f32_16x16x32_bf16 v[68:71], a[56:59], v[172:175], v[68:71]
    ds_read_b128 a[24:27], v3 offset:12288
    s_add_u32 m0, s21, 52224
    v_mfma_f32_16x16x32_bf16 v[72:75], a[60:63], v[168:171], v[72:75]
    v_mfma_f32_16x16x32_bf16 v[76:79], a[60:63], v[172:175], v[76:79]
    ds_read_b128 a[28:31], v3 offset:14336
    s_add_u32 s64, s20, 0x7c00
    buffer_load_dwordx4 v2, s[4:7], s64 offen lds
    s_waitcnt lgkmcnt(4)
    v_mfma_f32_16x16x32_bf16 v[16:19], a[0:3], v[176:179], v[16:19]
    v_mfma_f32_16x16x32_bf16 v[20:23], a[0:3], v[180:183], v[20:23]
    ds_read_b128 a[32:35], v4 offset:0
    v_mfma_f32_16x16x32_bf16 v[24:27], a[4:7], v[176:179], v[24:27]
    v_mfma_f32_16x16x32_bf16 v[28:31], a[4:7], v[180:183], v[28:31]
    ds_read_b128 a[36:39], v4 offset:2048
    v_mfma_f32_16x16x32_bf16 v[32:35], a[8:11], v[176:179], v[32:35]
    v_mfma_f32_16x16x32_bf16 v[36:39], a[8:11], v[180:183], v[36:39]
    ds_read_b128 a[40:43], v4 offset:4096
    v_mfma_f32_16x16x32_bf16 v[40:43], a[12:15], v[176:179], v[40:43]
    v_mfma_f32_16x16x32_bf16 v[44:47], a[12:15], v[180:183], v[44:47]
    ds_read_b128 a[44:47], v4 offset:6144
    s_waitcnt lgkmcnt(4)
    v_mfma_f32_16x16x32_bf16 v[48:51], a[16:19], v[176:179], v[48:51]
    v_mfma_f32_16x16x32_bf16 v[52:55], a[16:19], v[180:183], v[52:55]
    ds_read_b128 a[48:51], v4 offset:8192
    v_mfma_f32_16x16x32_bf16 v[56:59], a[20:23], v[176:179], v[56:59]
    v_mfma_f32_16x16x32_bf16 v[60:63], a[20:23], v[180:183], v[60:63]
    ds_read_b128 a[52:55], v4 offset:10240
    v_mfma_f32_16x16x32_bf16 v[64:67], a[24:27], v[176:179], v[64:67]
    v_mfma_f32_16x16x32_bf16 v[68:71], a[24:27], v[180:183], v[68:71]
    ds_read_b128 a[56:59], v4 offset:12288
    v_mfma_f32_16x16x32_bf16 v[72:75], a[28:31], v[176:179], v[72:75]
    v_mfma_f32_16x16x32_bf16 v[76:79], a[28:31], v[180:183], v[76:79]
    ds_read_b128 a[60:63], v4 offset:14336
    s_waitcnt vmcnt(8)
    s_barrier
    s_waitcnt lgkmcnt(4)
    v_mfma_f32_16x16x32_bf16 v[16:19], a[32:35], v[184:187], v[16:19]
    v_mfma_f32_16x16x32_bf16 v[20:23], a[32:35], v[188:191], v[20:23]
    ds_read_b128 a[0:3], v3 offset:16384
    s_add_u32 m0, s21, 65536
    v_mfma_f32_16x16x32_bf16 v[24:27], a[36:39], v[184:187], v[24:27]
    v_mfma_f32_16x16x32_bf16 v[28:31], a[36:39], v[188:191], v[28:31]
    ds_read_b128 a[4:7], v3 offset:18432
    s_add_u32 s64, s20, 0x480
    buffer_load_dwordx4 v2, s[4:7], s64 offen lds
    v_mfma_f32_16x16x32_bf16 v[32:35], a[40:43], v[184:187], v[32:35]
    v_mfma_f32_16x16x32_bf16 v[36:39], a[40:43], v[188:191], v[36:39]
    ds_read_b128 a[8:11], v3 offset:20480
    s_add_u32 m0, s21, 66560
    v_mfma_f32_16x16x32_bf16 v[40:43], a[44:47], v[184:187], v[40:43]
    v_mfma_f32_16x16x32_bf16 v[44:47], a[44:47], v[188:191], v[44:47]
    ds_read_b128 a[12:15], v3 offset:22528
    s_add_u32 s64, s20, 0x2c80
    buffer_load_dwordx4 v2, s[4:7], s64 offen lds
    s_waitcnt lgkmcnt(4)
    v_mfma_f32_16x16x32_bf16 v[48:51], a[48:51], v[184:187], v[48:51]
    v_mfma_f32_16x16x32_bf16 v[52:55], a[48:51], v[188:191], v[52:55]
    ds_read_b128 a[16:19], v3 offset:24576
    s_add_u32 m0, s21, 67584
    v_mfma_f32_16x16x32_bf16 v[56:59], a[52:55], v[184:187], v[56:59]
    v_mfma_f32_16x16x32_bf16 v[60:63], a[52:55], v[188:191], v[60:63]
    ds_read_b128 a[20:23], v3 offset:26624
    s_add_u32 s64, s20, 0x5480
    buffer_load_dwordx4 v2, s[4:7], s64 offen lds
    v_mfma_f32_16x16x32_bf16 v[64:67], a[56:59], v[184:187], v[64:67]
    v_mfma_f32_16x16x32_bf16 v[68:71], a[56:59], v[188:191], v[68:71]
    ds_read_b128 a[24:27], v3 offset:28672
    s_add_u32 m0, s21, 68608
    v_mfma_f32_16x16x32_bf16 v[72:75], a[60:63], v[184:187], v[72:75]
    v_mfma_f32_16x16x32_bf16 v[76:79], a[60:63], v[188:191], v[76:79]
    ds_read_b128 a[28:31], v3 offset:30720
    s_add_u32 s64, s20, 0x7c80
    buffer_load_dwordx4 v2, s[4:7], s64 offen lds
    s_waitcnt lgkmcnt(4)
    v_mfma_f32_16x16x32_bf16 v[16:19], a[0:3], v[192:195], v[16:19]
    v_mfma_f32_16x16x32_bf16 v[20:23], a[0:3], v[196:199], v[20:23]
    ds_read_b128 a[32:35], v4 offset:16384
    v_mfma_f32_16x16x32_bf16 v[24:27], a[4:7], v[192:195], v[24:27]
    v_mfma_f32_16x16x32_bf16 v[28:31], a[4:7], v[196:199], v[28:31]
    ds_read_b128 a[36:39], v4 offset:18432
    v_mfma_f32_16x16x32_bf16 v[32:35], a[8:11], v[192:195], v[32:35]
    v_mfma_f32_16x16x32_bf16 v[36:39], a[8:11], v[196:199], v[36:39]
    ds_read_b128 a[40:43], v4 offset:20480
    v_mfma_f32_16x16x32_bf16 v[40:43], a[12:15], v[192:195], v[40:43]
    v_mfma_f32_16x16x32_bf16 v[44:47], a[12:15], v[196:199], v[44:47]
    ds_read_b128 a[44:47], v4 offset:22528
    s_waitcnt lgkmcnt(4)
    v_mfma_f32_16x16x32_bf16 v[48:51], a[16:19], v[192:195], v[48:51]
    v_mfma_f32_16x16x32_bf16 v[52:55], a[16:19], v[196:199], v[52:55]
    ds_read_b128 a[48:51], v4 offset:24576
    v_mfma_f32_16x16x32_bf16 v[56:59], a[20:23], v[192:195], v[56:59]
    v_mfma_f32_16x16x32_bf16 v[60:63], a[20:23], v[196:199], v[60:63]
    ds_read_b128 a[52:55], v4 offset:26624
    v_mfma_f32_16x16x32_bf16 v[64:67], a[24:27], v[192:195], v[64:67]
    v_mfma_f32_16x16x32_bf16 v[68:71], a[24:27], v[196:199], v[68:71]
    ds_read_b128 a[56:59], v4 offset:28672
    v_mfma_f32_16x16x32_bf16 v[72:75], a[28:31], v[192:195], v[72:75]
    v_mfma_f32_16x16x32_bf16 v[76:79], a[28:31], v[196:199], v[76:79]
    ds_read_b128 a[60:63], v4 offset:30720
    s_waitcnt vmcnt(8)
    s_barrier
    s_waitcnt lgkmcnt(4)
    v_mfma_f32_16x16x32_bf16 v[16:19], a[32:35], v[200:203], v[16:19]
    v_mfma_f32_16x16x32_bf16 v[20:23], a[32:35], v[204:207], v[20:23]
    ds_read_b128 a[0:3], v3 offset:32768
    s_add_u32 m0, s21, 0
    v_mfma_f32_16x16x32_bf16 v[24:27], a[36:39], v[200:203], v[24:27]
    v_mfma_f32_16x16x32_bf16 v[28:31], a[36:39], v[204:207], v[28:31]
    ds_read_b128 a[4:7], v3 offset:34816
    s_add_u32 s64, s20, 0x50000
    buffer_load_dwordx4 v2, s[4:7], s64 offen lds
    v_mfma_f32_16x16x32_bf16 v[32:35], a[40:43], v[200:203], v[32:35]
    v_mfma_f32_16x16x32_bf16 v[36:39], a[40:43], v[204:207], v[36:39]
    ds_read_b128 a[8:11], v3 offset:36864
    s_add_u32 m0, s21, 1024
    v_mfma_f32_16x16x32_bf16 v[40:43], a[44:47], v[200:203], v[40:43]
    v_mfma_f32_16x16x32_bf16 v[44:47], a[44:47], v[204:207], v[44:47]
    ds_read_b128 a[12:15], v3 offset:38912
    s_add_u32 s64, s20, 0x52800
    buffer_load_dwordx4 v2, s[4:7], s64 offen lds
    s_waitcnt lgkmcnt(4)
    v_mfma_f32_16x16x32_bf16 v[48:51], a[48:51], v[200:203], v[48:51]
    v_mfma_f32_16x16x32_bf16 v[52:55], a[48:51], v[204:207], v[52:55]
    ds_read_b128 a[16:19], v3 offset:40960
    s_add_u32 m0, s21, 2048
    v_mfma_f32_16x16x32_bf16 v[56:59], a[52:55], v[200:203], v[56:59]
    v_mfma_f32_16x16x32_bf16 v[60:63], a[52:55], v[204:207], v[60:63]
    ds_read_b128 a[20:23], v3 offset:43008
    s_add_u32 s64, s20, 0x55000
    buffer_load_dwordx4 v2, s[4:7], s64 offen lds
    v_mfma_f32_16x16x32_bf16 v[64:67], a[56:59], v[200:203], v[64:67]
    v_mfma_f32_16x16x32_bf16 v[68:71], a[56:59], v[204:207], v[68:71]
    ds_read_b128 a[24:27], v3 offset:45056
    s_add_u32 m0, s21, 3072
    v_mfma_f32_16x16x32_bf16 v[72:75], a[60:63], v[200:203], v[72:75]
    v_mfma_f32_16x16x32_bf16 v[76:79], a[60:63], v[204:207], v[76:79]
    ds_read_b128 a[28:31], v3 offset:47104
    s_add_u32 s64, s20, 0x57800
    buffer_load_dwordx4 v2, s[4:7], s64 offen lds
    s_waitcnt lgkmcnt(4)
    v_mfma_f32_16x16x32_bf16 v[16:19], a[0:3], v[208:211], v[16:19]
    v_mfma_f32_16x16x32_bf16 v[20:23], a[0:3], v[212:215], v[20:23]
    ds_read_b128 a[32:35], v4 offset:32768
    v_mfma_f32_16x16x32_bf16 v[24:27], a[4:7], v[208:211], v[24:27]
    v_mfma_f32_16x16x32_bf16 v[28:31], a[4:7], v[212:215], v[28:31]
    ds_read_b128 a[36:39], v4 offset:34816
    v_mfma_f32_16x16x32_bf16 v[32:35], a[8:11], v[208:211], v[32:35]
    v_mfma_f32_16x16x32_bf16 v[36:39], a[8:11], v[212:215], v[36:39]
    ds_read_b128 a[40:43], v4 offset:36864
    v_mfma_f32_16x16x32_bf16 v[40:43], a[12:15], v[208:211], v[40:43]
    v_mfma_f32_16x16x32_bf16 v[44:47], a[12:15], v[212:215], v[44:47]
    ds_read_b128 a[44:47], v4 offset:38912
    s_waitcnt lgkmcnt(4)
    v_mfma_f32_16x16x32_bf16 v[48:51], a[16:19], v[208:211], v[48:51]
    v_mfma_f32_16x16x32_bf16 v[52:55], a[16:19], v[212:215], v[52:55]
    ds_read_b128 a[48:51], v4 offset:40960
    v_mfma_f32_16x16x32_bf16 v[56:59], a[20:23], v[208:211], v[56:59]
    v_mfma_f32_16x16x32_bf16 v[60:63], a[20:23], v[212:215], v[60:63]
    ds_read_b128 a[52:55], v4 offset:43008
    v_mfma_f32_16x16x32_bf16 v[64:67], a[24:27], v[208:211], v[64:67]
    v_mfma_f32_16x16x32_bf16 v[68:71], a[24:27], v[212:215], v[68:71]
    ds_read_b128 a[56:59], v4 offset:45056
    v_mfma_f32_16x16x32_bf16 v[72:75], a[28:31], v[208:211], v[72:75]
    v_mfma_f32_16x16x32_bf16 v[76:79], a[28:31], v[212:215], v[76:79]
    ds_read_b128 a[60:63], v4 offset:47104
    s_waitcnt vmcnt(8)
    s_barrier
    s_waitcnt lgkmcnt(4)
    v_mfma_f32_16x16x32_bf16 v[16:19], a[32:35], v[216:219], v[16:19]
    v_mfma_f32_16x16x32_bf16 v[20:23], a[32:35], v[220:223], v[20:23]
    ds_read_b128 a[0:3], v3 offset:49152
    s_add_u32 m0, s21, 16384
    v_mfma_f32_16x16x32_bf16 v[24:27], a[36:39], v[216:219], v[24:27]
    v_mfma_f32_16x16x32_bf16 v[28:31], a[36:39], v[220:223], v[28:31]
    ds_read_b128 a[4:7], v3 offset:51200
    s_add_u32 s64, s20, 0x50080
    buffer_load_dwordx4 v2, s[4:7], s64 offen lds
    v_mfma_f32_16x16x32_bf16 v[32:35], a[40:43], v[216:219], v[32:35]
    v_mfma_f32_16x16x32_bf16 v[36:39], a[40:43], v[220:223], v[36:39]
    ds_read_b128 a[8:11], v3 offset:53248
    s_add_u32 m0, s21, 17408
    v_mfma_f32_16x16x32_bf16 v[40:43], a[44:47], v[216:219], v[40:43]
    v_mfma_f32_16x16x32_bf16 v[44:47], a[44:47], v[220:223], v[44:47]
    ds_read_b128 a[12:15], v3 offset:55296
    s_add_u32 s64, s20, 0x52880
    buffer_load_dwordx4 v2, s[4:7], s64 offen lds
    s_waitcnt lgkmcnt(4)
    v_mfma_f32_16x16x32_bf16 v[48:51], a[48:51], v[216:219], v[48:51]
    v_mfma_f32_16x16x32_bf16 v[52:55], a[48:51], v[220:223], v[52:55]
    ds_read_b128 a[16:19], v3 offset:57344
    s_add_u32 m0, s21, 18432
    v_mfma_f32_16x16x32_bf16 v[56:59], a[52:55], v[216:219], v[56:59]
    v_mfma_f32_16x16x32_bf16 v[60:63], a[52:55], v[220:223], v[60:63]
    ds_read_b128 a[20:23], v3 offset:59392
    s_add_u32 s64, s20, 0x55080
    buffer_load_dwordx4 v2, s[4:7], s64 offen lds
    v_mfma_f32_16x16x32_bf16 v[64:67], a[56:59], v[216:219], v[64:67]
    v_mfma_f32_16x16x32_bf16 v[68:71], a[56:59], v[220:223], v[68:71]
    ds_read_b128 a[24:27], v3 offset:61440
    s_add_u32 m0, s21, 19456
    v_mfma_f32_16x16x32_bf16 v[72:75], a[60:63], v[216:219], v[72:75]
    v_mfma_f32_16x16x32_bf16 v[76:79], a[60:63], v[220:223], v[76:79]
    ds_read_b128 a[28:31], v3 offset:63488
    s_add_u32 s64, s20, 0x57880
    buffer_load_dwordx4 v2, s[4:7], s64 offen lds
    s_waitcnt lgkmcnt(4)
    v_mfma_f32_16x16x32_bf16 v[16:19], a[0:3], v[224:227], v[16:19]
    v_mfma_f32_16x16x32_bf16 v[20:23], a[0:3], v[228:231], v[20:23]
    ds_read_b128 a[32:35], v4 offset:49152
    v_mfma_f32_16x16x32_bf16 v[24:27], a[4:7], v[224:227], v[24:27]
    v_mfma_f32_16x16x32_bf16 v[28:31], a[4:7], v[228:231], v[28:31]
    ds_read_b128 a[36:39], v4 offset:51200
    v_mfma_f32_16x16x32_bf16 v[32:35], a[8:11], v[224:227], v[32:35]
    v_mfma_f32_16x16x32_bf16 v[36:39], a[8:11], v[228:231], v[36:39]
    ds_read_b128 a[40:43], v4 offset:53248
    v_mfma_f32_16x16x32_bf16 v[40:43], a[12:15], v[224:227], v[40:43]
    v_mfma_f32_16x16x32_bf16 v[44:47], a[12:15], v[228:231], v[44:47]
    ds_read_b128 a[44:47], v4 offset:55296
    s_waitcnt lgkmcnt(4)
    v_mfma_f32_16x16x32_bf16 v[48:51], a[16:19], v[224:227], v[48:51]
    v_mfma_f32_16x16x32_bf16 v[52:55], a[16:19], v[228:231], v[52:55]
    ds_read_b128 a[48:51], v4 offset:57344
    v_mfma_f32_16x16x32_bf16 v[56:59], a[20:23], v[224:227], v[56:59]
    v_mfma_f32_16x16x32_bf16 v[60:63], a[20:23], v[228:231], v[60:63]
    ds_read_b128 a[52:55], v4 offset:59392
    v_mfma_f32_16x16x32_bf16 v[64:67], a[24:27], v[224:227], v[64:67]
    v_mfma_f32_16x16x32_bf16 v[68:71], a[24:27], v[228:231], v[68:71]
    ds_read_b128 a[56:59], v4 offset:61440
    v_mfma_f32_16x16x32_bf16 v[72:75], a[28:31], v[224:227], v[72:75]
    v_mfma_f32_16x16x32_bf16 v[76:79], a[28:31], v[228:231], v[76:79]
    ds_read_b128 a[60:63], v4 offset:63488
    s_waitcnt vmcnt(8)
    s_barrier
    s_waitcnt lgkmcnt(4)
    v_mfma_f32_16x16x32_bf16 v[16:19], a[32:35], v[232:235], v[16:19]
    v_mfma_f32_16x16x32_bf16 v[20:23], a[32:35], v[236:239], v[20:23]
    ds_read_b128 a[0:3], v6 offset:0
    s_add_u32 m0, s21, 32768
    v_mfma_f32_16x16x32_bf16 v[24:27], a[36:39], v[232:235], v[24:27]
    v_mfma_f32_16x16x32_bf16 v[28:31], a[36:39], v[236:239], v[28:31]
    ds_read_b128 a[4:7], v6 offset:2048
    s_add_u32 s64, s20, 0x50100
    buffer_load_dwordx4 v2, s[4:7], s64 offen lds
    v_mfma_f32_16x16x32_bf16 v[32:35], a[40:43], v[232:235], v[32:35]
    v_mfma_f32_16x16x32_bf16 v[36:39], a[40:43], v[236:239], v[36:39]
    ds_read_b128 a[8:11], v6 offset:4096
    s_add_u32 m0, s21, 33792
    v_mfma_f32_16x16x32_bf16 v[40:43], a[44:47], v[232:235], v[40:43]
    v_mfma_f32_16x16x32_bf16 v[44:47], a[44:47], v[236:239], v[44:47]
    ds_read_b128 a[12:15], v6 offset:6144
    s_add_u32 s64, s20, 0x52900
    buffer_load_dwordx4 v2, s[4:7], s64 offen lds
    s_waitcnt lgkmcnt(4)
    v_mfma_f32_16x16x32_bf16 v[48:51], a[48:51], v[232:235], v[48:51]
    v_mfma_f32_16x16x32_bf16 v[52:55], a[48:51], v[236:239], v[52:55]
    ds_read_b128 a[16:19], v6 offset:8192
    s_add_u32 m0, s21, 34816
    v_mfma_f32_16x16x32_bf16 v[56:59], a[52:55], v[232:235], v[56:59]
    v_mfma_f32_16x16x32_bf16 v[60:63], a[52:55], v[236:239], v[60:63]
    ds_read_b128 a[20:23], v6 offset:10240
    s_add_u32 s64, s20, 0x55100
    buffer_load_dwordx4 v2, s[4:7], s64 offen lds
    v_mfma_f32_16x16x32_bf16 v[64:67], a[56:59], v[232:235], v[64:67]
    v_mfma_f32_16x16x32_bf16 v[68:71], a[56:59], v[236:239], v[68:71]
    ds_read_b128 a[24:27], v6 offset:12288
    s_add_u32 m0, s21, 35840
    v_mfma_f32_16x16x32_bf16 v[72:75], a[60:63], v[232:235], v[72:75]
    v_mfma_f32_16x16x32_bf16 v[76:79], a[60:63], v[236:239], v[76:79]
    ds_read_b128 a[28:31], v6 offset:14336
    s_add_u32 s64, s20, 0x57900
    buffer_load_dwordx4 v2, s[4:7], s64 offen lds
    s_waitcnt lgkmcnt(4)
    v_mfma_f32_16x16x32_bf16 v[16:19], a[0:3], v[240:243], v[16:19]
    v_mfma_f32_16x16x32_bf16 v[20:23], a[0:3], v[244:247], v[20:23]
    ds_read_b128 a[32:35], v9 offset:0
    v_mfma_f32_16x16x32_bf16 v[24:27], a[4:7], v[240:243], v[24:27]
    v_mfma_f32_16x16x32_bf16 v[28:31], a[4:7], v[244:247], v[28:31]
    ds_read_b128 a[36:39], v9 offset:2048
    v_mfma_f32_16x16x32_bf16 v[32:35], a[8:11], v[240:243], v[32:35]
    v_mfma_f32_16x16x32_bf16 v[36:39], a[8:11], v[244:247], v[36:39]
    ds_read_b128 a[40:43], v9 offset:4096
    v_mfma_f32_16x16x32_bf16 v[40:43], a[12:15], v[240:243], v[40:43]
    v_mfma_f32_16x16x32_bf16 v[44:47], a[12:15], v[244:247], v[44:47]
    ds_read_b128 a[44:47], v9 offset:6144
    s_waitcnt lgkmcnt(4)
    v_mfma_f32_16x16x32_bf16 v[48:51], a[16:19], v[240:243], v[48:51]
    v_mfma_f32_16x16x32_bf16 v[52:55], a[16:19], v[244:247], v[52:55]
    ds_read_b128 a[48:51], v9 offset:8192
    v_mfma_f32_16x16x32_bf16 v[56:59], a[20:23], v[240:243], v[56:59]
    v_mfma_f32_16x16x32_bf16 v[60:63], a[20:23], v[244:247], v[60:63]
    ds_read_b128 a[52:55], v9 offset:10240
    v_mfma_f32_16x16x32_bf16 v[64:67], a[24:27], v[240:243], v[64:67]
    v_mfma_f32_16x16x32_bf16 v[68:71], a[24:27], v[244:247], v[68:71]
    ds_read_b128 a[56:59], v9 offset:12288
    v_mfma_f32_16x16x32_bf16 v[72:75], a[28:31], v[240:243], v[72:75]
    v_mfma_f32_16x16x32_bf16 v[76:79], a[28:31], v[244:247], v[76:79]
    ds_read_b128 a[60:63], v9 offset:14336
    s_waitcnt vmcnt(8)
    s_barrier
    s_waitcnt lgkmcnt(4)
    v_mfma_f32_16x16x32_bf16 v[16:19], a[32:35], v[248:251], v[16:19]
    v_mfma_f32_16x16x32_bf16 v[20:23], a[32:35], v[252:255], v[20:23]
    ds_read_b128 a[0:3], v3 offset:0
    s_add_u32 m0, s21, 49152
    v_mfma_f32_16x16x32_bf16 v[24:27], a[36:39], v[248:251], v[24:27]
    v_mfma_f32_16x16x32_bf16 v[28:31], a[36:39], v[252:255], v[28:31]
    ds_read_b128 a[4:7], v3 offset:2048
    s_add_u32 s64, s20, 0x50180
    buffer_load_dwordx4 v2, s[4:7], s64 offen lds
    v_mfma_f32_16x16x32_bf16 v[32:35], a[40:43], v[248:251], v[32:35]
    v_mfma_f32_16x16x32_bf16 v[36:39], a[40:43], v[252:255], v[36:39]
    ds_read_b128 a[8:11], v3 offset:4096
    s_add_u32 m0, s21, 50176
    v_mfma_f32_16x16x32_bf16 v[40:43], a[44:47], v[248:251], v[40:43]
    v_mfma_f32_16x16x32_bf16 v[44:47], a[44:47], v[252:255], v[44:47]
    ds_read_b128 a[12:15], v3 offset:6144
    s_add_u32 s64, s20, 0x52980
    buffer_load_dwordx4 v2, s[4:7], s64 offen lds
    s_waitcnt lgkmcnt(4)
    v_mfma_f32_16x16x32_bf16 v[48:51], a[48:51], v[248:251], v[48:51]
    v_mfma_f32_16x16x32_bf16 v[52:55], a[48:51], v[252:255], v[52:55]
    ds_read_b128 a[16:19], v3 offset:8192
    s_add_u32 m0, s21, 51200
    v_mfma_f32_16x16x32_bf16 v[56:59], a[52:55], v[248:251], v[56:59]
    v_mfma_f32_16x16x32_bf16 v[60:63], a[52:55], v[252:255], v[60:63]
    ds_read_b128 a[20:23], v3 offset:10240
    s_add_u32 s64, s20, 0x55180
    buffer_load_dwordx4 v2, s[4:7], s64 offen lds
    v_mfma_f32_16x16x32_bf16 v[64:67], a[56:59], v[248:251], v[64:67]
    v_mfma_f32_16x16x32_bf16 v[68:71], a[56:59], v[252:255], v[68:71]
    ds_read_b128 a[24:27], v3 offset:12288
    s_add_u32 m0, s21, 52224
    v_mfma_f32_16x16x32_bf16 v[72:75], a[60:63], v[248:251], v[72:75]
    v_mfma_f32_16x16x32_bf16 v[76:79], a[60:63], v[252:255], v[76:79]
    ds_read_b128 a[28:31], v3 offset:14336
    s_add_u32 s64, s20, 0x57980
    buffer_load_dwordx4 v2, s[4:7], s64 offen lds
    s_nop 5
    s_mul_i32 s65, s17, 0
    s_add_u32 s65, s65, s22
    s_add_u32 s64, s65, 0
    v_cvt_pk_bf16_f32 v80, v16, v17
    v_cvt_pk_bf16_f32 v81, v18, v19
    v_cvt_pk_bf16_f32 v82, v24, v25
    v_cvt_pk_bf16_f32 v83, v26, v27
    buffer_store_dwordx4 v[80:83], v1, s[4:7], s64 offen sc1
    s_add_u32 s64, s65, 1024
    v_cvt_pk_bf16_f32 v84, v20, v21
    v_cvt_pk_bf16_f32 v85, v22, v23
    v_cvt_pk_bf16_f32 v86, v28, v29
    v_cvt_pk_bf16_f32 v87, v30, v31
    buffer_store_dwordx4 v[84:87], v1, s[4:7], s64 offen sc1
    s_mul_i32 s65, s17, 1
    s_add_u32 s65, s65, s22
    s_add_u32 s64, s65, 0
    v_cvt_pk_bf16_f32 v88, v32, v33
    v_cvt_pk_bf16_f32 v89, v34, v35
    v_cvt_pk_bf16_f32 v90, v40, v41
    v_cvt_pk_bf16_f32 v91, v42, v43
    buffer_store_dwordx4 v[88:91], v1, s[4:7], s64 offen sc1
    s_add_u32 s64, s65, 1024
    v_cvt_pk_bf16_f32 v92, v36, v37
    v_cvt_pk_bf16_f32 v93, v38, v39
    v_cvt_pk_bf16_f32 v94, v44, v45
    v_cvt_pk_bf16_f32 v95, v46, v47
    buffer_store_dwordx4 v[92:95], v1, s[4:7], s64 offen sc1
    s_mul_i32 s65, s17, 2
    s_add_u32 s65, s65, s22
    s_add_u32 s64, s65, 0
    v_cvt_pk_bf16_f32 v80, v48, v49
    v_cvt_pk_bf16_f32 v81, v50, v51
    v_cvt_pk_bf16_f32 v82, v56, v57
    v_cvt_pk_bf16_f32 v83, v58, v59
    buffer_store_dwordx4 v[80:83], v1, s[4:7], s64 offen sc1
    s_add_u32 s64, s65, 1024
    v_cvt_pk_bf16_f32 v84, v52, v53
    v_cvt_pk_bf16_f32 v85, v54, v55
    v_cvt_pk_bf16_f32 v86, v60, v61
    v_cvt_pk_bf16_f32 v87, v62, v63
    buffer_store_dwordx4 v[84:87], v1, s[4:7], s64 offen sc1
    s_mul_i32 s65, s17, 3
    s_add_u32 s65, s65, s22
    s_add_u32 s64, s65, 0
    v_cvt_pk_bf16_f32 v88, v64, v65
    v_cvt_pk_bf16_f32 v89, v66, v67
    v_cvt_pk_bf16_f32 v90, v72, v73
    v_cvt_pk_bf16_f32 v91, v74, v75
    buffer_store_dwordx4 v[88:91], v1, s[4:7], s64 offen sc1
    s_add_u32 s64, s65, 1024
    v_cvt_pk_bf16_f32 v92, v68, v69
    v_cvt_pk_bf16_f32 v93, v70, v71
    v_cvt_pk_bf16_f32 v94, v76, v77
    v_cvt_pk_bf16_f32 v95, v78, v79
    buffer_store_dwordx4 v[92:95], v1, s[4:7], s64 offen sc1
    s_lshl_b32 s64, s19, 1
    s_add_u32 s64, s64, s12
    s_lshl_b32 s64, s64, 9
    s_add_u32 s23, s18, s64
    s_lshl_b32 s64, s17, 3
    s_add_u32 s22, s22, s64
    s_add_u32 s19, s19, 1
    s_add_u32 s20, s20, 0x50000
    s_cmp_lt_u32 s19, 8
    s_cbranch_scc1 G_N_LOOP
    s_waitcnt vmcnt(0) lgkmcnt(0)
    s_barrier
    s_cmp_lg_u32 s14, 0
    s_cbranch_scc1 GF_116
    v_mov_b32 v7, 1
    v_mov_b32 v8, 0
    s_mov_b64 exec, 1
    buffer_store_dword v7, v8, s[4:7], s23 offen sc1
    s_mov_b64 exec, -1
GF_116:
    s_cmp_eq_u32 s12, 1
    s_cbranch_scc1 H_OUT
    s_mov_b32 s29, 0
    v_lshlrev_b32 v1, 4, v0
    s_mov_b32 s65, 0
CW_117:
    buffer_load_dwordx2 v[8:9], off, s[60:63], 0 offset:132 sc1
    s_add_u32 s65, s65, 1
    s_waitcnt vmcnt(0)
    v_readfirstlane_b32 s66, v8
    v_readfirstlane_b32 s67, v9
    s_min_u32 s64, s66, s67
    s_cmp_lg_u32 s64, 0
    s_cbranch_scc1 CWD_118
    s_cmp_gt_u32 s65, 65536
    s_cbranch_scc1 CWD_118
    s_sleep 4
    s_branch CW_117
CWD_118:
    s_sub_u32 s66, s66, 1
    s_and_b32 s66, s66, 3
    s_sub_u32 s67, s67, 1
    s_and_b32 s67, s67, 3
    s_mov_b32 s64, s66
    s_mov_b32 s65, s67
    s_and_b32 s64, s64, 3
    s_lshl_b32 s64, s64, 13
    s_and_b32 s65, s65, 3
    s_lshl_b32 s65, s65, 13
    s_add_u32 s25, s64, 0x6000000
    s_add_u32 s30, s65, 0x6200000
    v_bfe_u32 v4, v0, 3, 1
    v_mul_u32_u24 v2, 0x8000, v4
    v_lshrrev_b32 v4, 5, v0
    v_lshl_add_u32 v2, v4, 8, v2
    v_bfe_u32 v4, v0, 4, 1
    v_lshl_add_u32 v2, v4, 7, v2
    v_and_b32 v4, 7, v0
    v_lshl_add_u32 v2, v4, 4, v2
    v_lshrrev_b32 v4, 5, v0
    v_lshlrev_b32 v3, 16, v4
    v_bfe_u32 v4, v0, 4, 1
    v_lshl_add_u32 v3, v4, 7, v3
    v_and_b32 v4, 15, v0
    v_lshl_add_u32 v3, v4, 3, v3
    s_lshl_b32 s26, s13, 11
    s_lshl_b32 s64, s14, 9
    s_add_u32 s26, s26, s64
    s_add_u32 s26, s26, 0xa40000
    s_lshl_b32 s27, s13, 3
    s_add_u32 s27, s27, 0x294004
    s_mov_b32 s28, 0x29a000
    s_mov_b32 s24, 0
    v_lshlrev_b32 v6, 7, v0
MKN_LOOP:
    s_mov_b64 exec, 0xf
MKN_M_119:
    buffer_load_dword v5, v6, s[4:7], s28 offen sc1
    s_add_u32 s29, s29, 1
    s_waitcnt vmcnt(0)
    v_cmp_eq_u32 vcc, 0, v5
    s_cbranch_vccz MKN_MD_120
    s_cmp_gt_u32 s29, 262144
    s_cbranch_scc1 MKN_MD_120
    s_sleep 4
    s_branch MKN_M_119
MKN_MD_120:
    s_mov_b64 exec, -1
MKR_121:
    s_add_u32 s64, s25, 0x0
    buffer_load_dwordx4 v[16:19], v2, s[4:7], s64 offen sc1
    s_add_u32 s64, s25, 0x200
    buffer_load_dwordx4 v[20:23], v2, s[4:7], s64 offen sc1
    s_add_u32 s64, s25, 0x400
    buffer_load_dwordx4 v[24:27], v2, s[4:7], s64 offen sc1
    s_add_u32 s64, s25, 0x600
    buffer_load_dwordx4 v[28:31], v2, s[4:7], s64 offen sc1
    s_add_u32 s64, s25, 0x800
    buffer_load_dwordx4 v[32:35], v2, s[4:7], s64 offen sc1
    s_add_u32 s64, s25, 0xa00
    buffer_load_dwordx4 v[36:39], v2, s[4:7], s64 offen sc1
    s_add_u32 s64, s25, 0xc00
    buffer_load_dwordx4 v[40:43], v2, s[4:7], s64 offen sc1
    s_add_u32 s64, s25, 0xe00
    buffer_load_dwordx4 v[44:47], v2, s[4:7], s64 offen sc1
    s_add_u32 s64, s25, 0x1000
    buffer_load_dwordx4 v[48:51], v2, s[4:7], s64 offen sc1
    s_add_u32 s64, s25, 0x1200
    buffer_load_dwordx4 v[52:55], v2, s[4:7], s64 offen sc1
    s_add_u32 s64, s30, 0x0
    buffer_load_dwordx4 v[56:59], v2, s[4:7], s64 offen sc1
    s_add_u32 s64, s30, 0x200
    buffer_load_dwordx4 v[60:63], v2, s[4:7], s64 offen sc1
    s_add_u32 s64, s30, 0x400
    buffer_load_dwordx4 v[64:67], v2, s[4:7], s64 offen sc1
    s_add_u32 s64, s30, 0x600
    buffer_load_dwordx4 v[68:71], v2, s[4:7], s64 offen sc1
    s_add_u32 s64, s30, 0x800
    buffer_load_dwordx4 v[72:75], v2, s[4:7], s64 offen sc1
    s_add_u32 s64, s30, 0xa00
    buffer_load_dwordx4 v[76:79], v2, s[4:7], s64 offen sc1
    s_add_u32 s64, s30, 0xc00
    buffer_load_dwordx4 v[80:83], v2, s[4:7], s64 offen sc1
    s_add_u32 s64, s30, 0xe00
    buffer_load_dwordx4 v[84:87], v2, s[4:7], s64 offen sc1
    s_add_u32 s64, s30, 0x1000
    buffer_load_dwordx4 v[88:91], v2, s[4:7], s64 offen sc1
    s_add_u32 s64, s30, 0x1200
    buffer_load_dwordx4 v[92:95], v2, s[4:7], s64 offen sc1
    s_add_u32 s29, s29, 1
    s_waitcnt vmcnt(0)
    v_max3_u32 v4, v19, v23, v27
    v_max3_u32 v4, v4, v31, v35
    v_max3_u32 v4, v4, v39, v43
    v_max3_u32 v4, v4, v47, v51
    v_max3_u32 v4, v4, v55, v59
    v_max3_u32 v4, v4, v63, v67
    v_max3_u32 v4, v4, v71, v75
    v_max3_u32 v4, v4, v79, v83
    v_max3_u32 v4, v4, v87, v91
    v_max_u32 v4, v4, v95
    v_cmp_eq_u32 vcc, -1, v4
    s_cbranch_vccz MKO_122
    s_cmp_gt_u32 s29, 262144
    s_cbranch_scc0 MKR_121
MKO_122:
    v_mfma_f32_16x16x32_bf16 v[8:11], v[16:19], v[96:99], 0
    v_mfma_f32_16x16x32_bf16 v[12:15], v[16:19], v[100:103], 0
    v_mfma_f32_16x16x32_bf16 v[8:11], v[20:23], v[104:107], v[8:11]
    v_mfma_f32_16x16x32_bf16 v[12:15], v[20:23], v[108:111], v[12:15]
    v_mfma_f32_16x16x32_bf16 v[8:11], v[24:27], v[112:115], v[8:11]
    v_mfma_f32_16x16x32_bf16 v[12:15], v[24:27], v[116:119], v[12:15]
    v_mfma_f32_16x16x32_bf16 v[8:11], v[28:31], v[120:123], v[8:11]
    v_mfma_f32_16x16x32_bf16 v[12:15], v[28:31], v[124:127], v[12:15]
    v_mfma_f32_16x16x32_bf16 v[8:11], v[32:35], v[128:131], v[8:11]
    v_mfma_f32_16x16x32_bf16 v[12:15], v[32:35], v[132:135], v[12:15]
    v_mfma_f32_16x16x32_bf16 v[8:11], v[36:39], v[136:139], v[8:11]
    v_mfma_f32_16x16x32_bf16 v[12:15], v[36:39], v[140:143], v[12:15]
    v_mfma_f32_16x16x32_bf16 v[8:11], v[40:43], v[144:147], v[8:11]
    v_mfma_f32_16x16x32_bf16 v[12:15], v[40:43], v[148:151], v[12:15]
    v_mfma_f32_16x16x32_bf16 v[8:11], v[44:47], v[152:155], v[8:11]
    v_mfma_f32_16x16x32_bf16 v[12:15], v[44:47], v[156:159], v[12:15]
    v_mfma_f32_16x16x32_bf16 v[8:11], v[48:51], v[160:163], v[8:11]
    v_mfma_f32_16x16x32_bf16 v[12:15], v[48:51], v[164:167], v[12:15]
    v_mfma_f32_16x16x32_bf16 v[8:11], v[52:55], v[168:171], v[8:11]
    v_mfma_f32_16x16x32_bf16 v[12:15], v[52:55], v[172:175], v[12:15]
    v_mfma_f32_16x16x32_bf16 v[8:11], v[56:59], v[176:179], v[8:11]
    v_mfma_f32_16x16x32_bf16 v[12:15], v[56:59], v[180:183], v[12:15]
    v_mfma_f32_16x16x32_bf16 v[8:11], v[60:63], v[184:187], v[8:11]
    v_mfma_f32_16x16x32_bf16 v[12:15], v[60:63], v[188:191], v[12:15]
    v_mfma_f32_16x16x32_bf16 v[8:11], v[64:67], v[192:195], v[8:11]
    v_mfma_f32_16x16x32_bf16 v[12:15], v[64:67], v[196:199], v[12:15]
    v_mfma_f32_16x16x32_bf16 v[8:11], v[68:71], v[200:203], v[8:11]
    v_mfma_f32_16x16x32_bf16 v[12:15], v[68:71], v[204:207], v[12:15]
    v_mfma_f32_16x16x32_bf16 v[8:11], v[72:75], v[208:211], v[8:11]
    v_mfma_f32_16x16x32_bf16 v[12:15], v[72:75], v[212:215], v[12:15]
    v_mfma_f32_16x16x32_bf16 v[8:11], v[76:79], v[216:219], v[8:11]
    v_mfma_f32_16x16x32_bf16 v[12:15], v[76:79], v[220:223], v[12:15]
    v_mfma_f32_16x16x32_bf16 v[8:11], v[80:83], v[224:227], v[8:11]
    v_mfma_f32_16x16x32_bf16 v[12:15], v[80:83], v[228:231], v[12:15]
    v_mfma_f32_16x16x32_bf16 v[8:11], v[84:87], v[232:235], v[8:11]
    v_mfma_f32_16x16x32_bf16 v[12:15], v[84:87], v[236:239], v[12:15]
    v_mfma_f32_16x16x32_bf16 v[8:11], v[88:91], v[240:243], v[8:11]
    v_mfma_f32_16x16x32_bf16 v[12:15], v[88:91], v[244:247], v[12:15]
    v_mfma_f32_16x16x32_bf16 v[8:11], v[92:95], v[248:251], v[8:11]
    v_mfma_f32_16x16x32_bf16 v[12:15], v[92:95], v[252:255], v[12:15]
    s_nop 7
    v_cvt_pk_bf16_f32 v16, v8, v9
    v_cvt_pk_bf16_f32 v17, v10, v11
    v_cvt_pk_bf16_f32 v18, v12, v13
    v_cvt_pk_bf16_f32 v19, v14, v15
    buffer_store_dwordx2 v[16:17], v3, s[4:7], s26 offen sc1
    buffer_store_dwordx2 v[18:19], v3, s[4:7], s26 offen offset:256 sc1
    s_waitcnt vmcnt(0)
    s_barrier
    s_cmp_lg_u32 s14, 0
    s_cbranch_scc1 GF_123
    v_mov_b32 v7, 1
    v_mov_b32 v8, 0
    s_mov_b64 exec, 1
    buffer_store_dword v7, v8, s[4:7], s27 offen sc1
    s_mov_b64 exec, -1
GF_123:
    s_add_u32 s25, s25, 0x10000
    s_add_u32 s30, s30, 0x10000
    s_add_u32 s26, s26, 0x20000
    s_add_u32 s27, s27, 256
    s_add_u32 s28, s28, 512
    s_add_u32 s24, s24, 1
    s_cmp_lt_u32 s24, 32
    s_cbranch_scc1 MKN_LOOP
    s_branch M_EXIT
H_OUT:
    s_lshl_b32 s64, s3, 5
    s_add_u32 s64, s64, s13
    s_cmp_ge_u32 s64, 60
    s_cbranch_scc1 M_EXIT
    s_mul_hi_u32 s12, s64, 0xccccccd
    s_mul_i32 s65, s12, 20
    s_sub_u32 s13, s64, s65
    s_load_dwordx2 s[44:45], s[0:1], 40
    s_mov_b32 s46, 0x500000
    s_mov_b32 s47, 0x00020000
    s_load_dwordx2 s[48:49], s[0:1], 0
    s_mov_b32 s50, 0x280000
    s_mov_b32 s51, 0x00020000
    s_load_dwordx2 s[52:53], s[0:1], 96
    s_mov_b32 s54, 0x280000
    s_mov_b32 s55, 0x00020000
    s_mov_b32 s36, -1
    s_mov_b32 s37, 0
    s_waitcnt lgkmcnt(0)
    s_mul_i32 s21, s14, 36864
    v_lshrrev_b32 v7, 2, v0
    v_mul_u32_u24 v4, 1280, v7
    v_bfe_u32 v7, v0, 4, 1
    v_lshlrev_b32 v7, 1, v7
    v_and_b32 v8, 3, v0
    v_xor_b32 v7, v7, v8
    v_lshl_add_u32 v4, v7, 4, v4
    v_lshrrev_b32 v7, 4, v0
    v_lshlrev_b32 v2, 8, v7
    v_bfe_u32 v7, v0, 2, 2
    v_lshl_add_u32 v2, v7, 6, v2
    v_and_b32 v7, 3, v0
    v_lshl_add_u32 v2, v7, 3, v2
    v_add_u32 v2, s21, v2
    v_bfe_u32 v7, v0, 4, 1
    v_lshlrev_b32 v7, 5, v7
    v_sub_u32 v3, 32, v7
    v_add_u32 v3, v3, v2
    v_add_u32 v2, v2, v7
    s_mul_i32 s65, s14, 1310720
    s_lshl_b32 s66, s13, 6
    s_add_u32 s65, s65, s66
    s_add_u32 m0, s21, 0
    s_add_u32 s64, s65, 0x0
    buffer_load_dwordx4 v4, s[44:47], s64 offen lds
    s_add_u32 m0, s21, 1024
    s_add_u32 s64, s65, 0x5000
    buffer_load_dwordx4 v4, s[44:47], s64 offen lds
    s_add_u32 m0, s21, 2048
    s_add_u32 s64, s65, 0xa000
    buffer_load_dwordx4 v4, s[44:47], s64 offen lds
    s_add_u32 m0, s21, 3072
    s_add_u32 s64, s65, 0xf000
    buffer_load_dwordx4 v4, s[44:47], s64 offen lds
    s_add_u32 m0, s21, 4096
    s_add_u32 s64, s65, 0x14000
    buffer_load_dwordx4 v4, s[44:47], s64 offen lds
    s_add_u32 m0, s21, 5120
    s_add_u32 s64, s65, 0x19000
    buffer_load_dwordx4 v4, s[44:47], s64 offen lds
    s_add_u32 m0, s21, 6144
    s_add_u32 s64, s65, 0x1e000
    buffer_load_dwordx4 v4, s[44:47], s64 offen lds
    s_add_u32 m0, s21, 7168
    s_add_u32 s64, s65, 0x23000
    buffer_load_dwordx4 v4, s[44:47], s64 offen lds
    s_add_u32 m0, s21, 8192
    s_add_u32 s64, s65, 0x28000
    buffer_load_dwordx4 v4, s[44:47], s64 offen lds
    s_add_u32 m0, s21, 9216
    s_add_u32 s64, s65, 0x2d000
    buffer_load_dwordx4 v4, s[44:47], s64 offen lds
    s_add_u32 m0, s21, 10240
    s_add_u32 s64, s65, 0x32000
    buffer_load_dwordx4 v4, s[44:47], s64 offen lds
    s_add_u32 m0, s21, 11264
    s_add_u32 s64, s65, 0x37000
    buffer_load_dwordx4 v4, s[44:47], s64 offen lds
    s_add_u32 m0, s21, 12288
    s_add_u32 s64, s65, 0x3c000
    buffer_load_dwordx4 v4, s[44:47], s64 offen lds
    s_add_u32 m0, s21, 13312
    s_add_u32 s64, s65, 0x41000
    buffer_load_dwordx4 v4, s[44:47], s64 offen lds
    s_add_u32 m0, s21, 14336
    s_add_u32 s64, s65, 0x46000
    buffer_load_dwordx4 v4, s[44:47], s64 offen lds
    s_add_u32 m0, s21, 15360
    s_add_u32 s64, s65, 0x4b000
    buffer_load_dwordx4 v4, s[44:47], s64 offen lds
    s_add_u32 m0, s21, 16384
    s_add_u32 s64, s65, 0x50000
    buffer_load_dwordx4 v4, s[44:47], s64 offen lds
    s_add_u32 m0, s21, 17408
    s_add_u32 s64, s65, 0x55000
    buffer_load_dwordx4 v4, s[44:47], s64 offen lds
    s_add_u32 m0, s21, 18432
    s_add_u32 s64, s65, 0x5a000
    buffer_load_dwordx4 v4, s[44:47], s64 offen lds
    s_add_u32 m0, s21, 19456
    s_add_u32 s64, s65, 0x5f000
    buffer_load_dwordx4 v4, s[44:47], s64 offen lds
    s_add_u32 m0, s21, 20480
    s_add_u32 s64, s65, 0x64000
    buffer_load_dwordx4 v4, s[44:47], s64 offen lds
    s_add_u32 m0, s21, 21504
    s_add_u32 s64, s65, 0x69000
    buffer_load_dwordx4 v4, s[44:47], s64 offen lds
    s_add_u32 m0, s21, 22528
    s_add_u32 s64, s65, 0x6e000
    buffer_load_dwordx4 v4, s[44:47], s64 offen lds
    s_add_u32 m0, s21, 23552
    s_add_u32 s64, s65, 0x73000
    buffer_load_dwordx4 v4, s[44:47], s64 offen lds
    s_add_u32 m0, s21, 24576
    s_add_u32 s64, s65, 0x78000
    buffer_load_dwordx4 v4, s[44:47], s64 offen lds
    s_add_u32 m0, s21, 25600
    s_add_u32 s64, s65, 0x7d000
    buffer_load_dwordx4 v4, s[44:47], s64 offen lds
    s_add_u32 m0, s21, 26624
    s_add_u32 s64, s65, 0x82000
    buffer_load_dwordx4 v4, s[44:47], s64 offen lds
    s_add_u32 m0, s21, 27648
    s_add_u32 s64, s65, 0x87000
    buffer_load_dwordx4 v4, s[44:47], s64 offen lds
    s_add_u32 m0, s21, 28672
    s_add_u32 s64, s65, 0x8c000
    buffer_load_dwordx4 v4, s[44:47], s64 offen lds
    s_add_u32 m0, s21, 29696
    s_add_u32 s64, s65, 0x91000
    buffer_load_dwordx4 v4, s[44:47], s64 offen lds
    s_add_u32 m0, s21, 30720
    s_add_u32 s64, s65, 0x96000
    buffer_load_dwordx4 v4, s[44:47], s64 offen lds
    s_add_u32 m0, s21, 31744
    s_add_u32 s64, s65, 0x9b000
    buffer_load_dwordx4 v4, s[44:47], s64 offen lds
    s_add_u32 m0, s21, 32768
    s_add_u32 s64, s65, 0xa0000
    buffer_load_dwordx4 v4, s[44:47], s64 offen lds
    s_add_u32 m0, s21, 33792
    s_add_u32 s64, s65, 0xa5000
    buffer_load_dwordx4 v4, s[44:47], s64 offen lds
    s_add_u32 m0, s21, 34816
    s_add_u32 s64, s65, 0xaa000
    buffer_load_dwordx4 v4, s[44:47], s64 offen lds
    s_add_u32 m0, s21, 35840
    s_add_u32 s64, s65, 0xaf000
    buffer_load_dwordx4 v4, s[44:47], s64 offen lds
    s_waitcnt vmcnt(32)
    ds_read_b64_tr_b16 a[0:1], v2 offset:0
    ds_read_b64_tr_b16 a[2:3], v2 offset:1024
    ds_read_b64_tr_b16 a[4:5], v3 offset:0
    ds_read_b64_tr_b16 a[6:7], v3 offset:1024
    ds_read_b64_tr_b16 a[8:9], v2 offset:2048
    ds_read_b64_tr_b16 a[10:11], v2 offset:3072
    ds_read_b64_tr_b16 a[12:13], v3 offset:2048
    ds_read_b64_tr_b16 a[14:15], v3 offset:3072
    s_waitcnt lgkmcnt(0)
    s_add_u32 m0, s21, 0
    s_add_u32 s64, s65, 0xb4000
    buffer_load_dwordx4 v4, s[44:47], s64 offen lds
    s_add_u32 m0, s21, 1024
    s_add_u32 s64, s65, 0xb9000
    buffer_load_dwordx4 v4, s[44:47], s64 offen lds
    s_add_u32 m0, s21, 2048
    s_add_u32 s64, s65, 0xbe000
    buffer_load_dwordx4 v4, s[44:47], s64 offen lds
    s_add_u32 m0, s21, 3072
    s_add_u32 s64, s65, 0xc3000
    buffer_load_dwordx4 v4, s[44:47], s64 offen lds
    s_waitcnt vmcnt(32)
    ds_read_b64_tr_b16 a[16:17], v2 offset:4096
    ds_read_b64_tr_b16 a[18:19], v2 offset:5120
    ds_read_b64_tr_b16 a[20:21], v3 offset:4096
    ds_read_b64_tr_b16 a[22:23], v3 offset:5120
    ds_read_b64_tr_b16 a[24:25], v2 offset:6144
    ds_read_b64_tr_b16 a[26:27], v2 offset:7168
    ds_read_b64_tr_b16 a[28:29], v3 offset:6144
    ds_read_b64_tr_b16 a[30:31], v3 offset:7168
    s_waitcnt lgkmcnt(0)
    s_add_u32 m0, s21, 4096
    s_add_u32 s64, s65, 0xc8000
    buffer_load_dwordx4 v4, s[44:47], s64 offen lds
    s_add_u32 m0, s21, 5120
    s_add_u32 s64, s65, 0xcd000
    buffer_load_dwordx4 v4, s[44:47], s64 offen lds
    s_add_u32 m0, s21, 6144
    s_add_u32 s64, s65, 0xd2000
    buffer_load_dwordx4 v4, s[44:47], s64 offen lds
    s_add_u32 m0, s21, 7168
    s_add_u32 s64, s65, 0xd7000
    buffer_load_dwordx4 v4, s[44:47], s64 offen lds
    s_waitcnt vmcnt(32)
    ds_read_b64_tr_b16 a[32:33], v2 offset:8192
    ds_read_b64_tr_b16 a[34:35], v2 offset:9216
    ds_read_b64_tr_b16 a[36:37], v3 offset:8192
    ds_read_b64_tr_b16 a[38:39], v3 offset:9216
    ds_read_b64_tr_b16 a[40:41], v2 offset:10240
    ds_read_b64_tr_b16 a[42:43], v2 offset:11264
    ds_read_b64_tr_b16 a[44:45], v3 offset:10240
    ds_read_b64_tr_b16 a[46:47], v3 offset:11264
    s_waitcnt lgkmcnt(0)
    s_add_u32 m0, s21, 8192
    s_add_u32 s64, s65, 0xdc000
    buffer_load_dwordx4 v4, s[44:47], s64 offen lds
    s_add_u32 m0, s21, 9216
    s_add_u32 s64, s65, 0xe1000
    buffer_load_dwordx4 v4, s[44:47], s64 offen lds
    s_add_u32 m0, s21, 10240
    s_add_u32 s64, s65, 0xe6000
    buffer_load_dwordx4 v4, s[44:47], s64 offen lds
    s_add_u32 m0, s21, 11264
    s_add_u32 s64, s65, 0xeb000
    buffer_load_dwordx4 v4, s[44:47], s64 offen lds
    s_waitcnt vmcnt(32)
    ds_read_b64_tr_b16 a[48:49], v2 offset:12288
    ds_read_b64_tr_b16 a[50:51], v2 offset:13312
    ds_read_b64_tr_b16 a[52:53], v3 offset:12288
    ds_read_b64_tr_b16 a[54:55], v3 offset:13312
    ds_read_b64_tr_b16 a[56:57], v2 offset:14336
    ds_read_b64_tr_b16 a[58:59], v2 offset:15360
    ds_read_b64_tr_b16 a[60:61], v3 offset:14336
    ds_read_b64_tr_b16 a[62:63], v3 offset:15360
    s_waitcnt lgkmcnt(0)
    s_add_u32 m0, s21, 12288
    s_add_u32 s64, s65, 0xf0000
    buffer_load_dwordx4 v4, s[44:47], s64 offen lds
    s_add_u32 m0, s21, 13312
    s_add_u32 s64, s65, 0xf5000
    buffer_load_dwordx4 v4, s[44:47], s64 offen lds
    s_add_u32 m0, s21, 14336
    s_add_u32 s64, s65, 0xfa000
    buffer_load_dwordx4 v4, s[44:47], s64 offen lds
    s_add_u32 m0, s21, 15360
    s_add_u32 s64, s65, 0xff000
    buffer_load_dwordx4 v4, s[44:47], s64 offen lds
    s_waitcnt vmcnt(32)
    ds_read_b64_tr_b16 a[64:65], v2 offset:16384
    ds_read_b64_tr_b16 a[66:67], v2 offset:17408
    ds_read_b64_tr_b16 a[68:69], v3 offset:16384
    ds_read_b64_tr_b16 a[70:71], v3 offset:17408
    ds_read_b64_tr_b16 a[72:73], v2 offset:18432
    ds_read_b64_tr_b16 a[74:75], v2 offset:19456
    ds_read_b64_tr_b16 a[76:77], v3 offset:18432
    ds_read_b64_tr_b16 a[78:79], v3 offset:19456
    s_waitcnt lgkmcnt(0)
    s_add_u32 m0, s21, 16384
    s_add_u32 s64, s65, 0x104000
    buffer_load_dwordx4 v4, s[44:47], s64 offen lds
    s_add_u32 m0, s21, 17408
    s_add_u32 s64, s65, 0x109000
    buffer_load_dwordx4 v4, s[44:47], s64 offen lds
    s_add_u32 m0, s21, 18432
    s_add_u32 s64, s65, 0x10e000
    buffer_load_dwordx4 v4, s[44:47], s64 offen lds
    s_add_u32 m0, s21, 19456
    s_add_u32 s64, s65, 0x113000
    buffer_load_dwordx4 v4, s[44:47], s64 offen lds
    s_waitcnt vmcnt(32)
    ds_read_b64_tr_b16 a[80:81], v2 offset:20480
    ds_read_b64_tr_b16 a[82:83], v2 offset:21504
    ds_read_b64_tr_b16 a[84:85], v3 offset:20480
    ds_read_b64_tr_b16 a[86:87], v3 offset:21504
    ds_read_b64_tr_b16 a[88:89], v2 offset:22528
    ds_read_b64_tr_b16 a[90:91], v2 offset:23552
    ds_read_b64_tr_b16 a[92:93], v3 offset:22528
    ds_read_b64_tr_b16 a[94:95], v3 offset:23552
    s_waitcnt lgkmcnt(0)
    s_add_u32 m0, s21, 20480
    s_add_u32 s64, s65, 0x118000
    buffer_load_dwordx4 v4, s[44:47], s64 offen lds
    s_add_u32 m0, s21, 21504
    s_add_u32 s64, s65, 0x11d000
    buffer_load_dwordx4 v4, s[44:47], s64 offen lds
    s_add_u32 m0, s21, 22528
    s_add_u32 s64, s65, 0x122000
    buffer_load_dwordx4 v4, s[44:47], s64 offen lds
    s_add_u32 m0, s21, 23552
    s_add_u32 s64, s65, 0x127000
    buffer_load_dwordx4 v4, s[44:47], s64 offen lds
    s_waitcnt vmcnt(32)
    ds_read_b64_tr_b16 a[96:97], v2 offset:24576
    ds_read_b64_tr_b16 a[98:99], v2 offset:25600
    ds_read_b64_tr_b16 a[100:101], v3 offset:24576
    ds_read_b64_tr_b16 a[102:103], v3 offset:25600
    ds_read_b64_tr_b16 a[104:105], v2 offset:26624
    ds_read_b64_tr_b16 a[106:107], v2 offset:27648
    ds_read_b64_tr_b16 a[108:109], v3 offset:26624
    ds_read_b64_tr_b16 a[110:111], v3 offset:27648
    s_waitcnt lgkmcnt(0)
    s_add_u32 m0, s21, 24576
    s_add_u32 s64, s65, 0x12c000
    buffer_load_dwordx4 v4, s[44:47], s64 offen lds
    s_add_u32 m0, s21, 25600
    s_add_u32 s64, s65, 0x131000
    buffer_load_dwordx4 v4, s[44:47], s64 offen lds
    s_add_u32 m0, s21, 26624
    s_add_u32 s64, s65, 0x136000
    buffer_load_dwordx4 v4, s[44:47], s64 offen lds
    s_add_u32 m0, s21, 27648
    s_add_u32 s64, s65, 0x13b000
    buffer_load_dwordx4 v4, s[44:47], s64 offen lds
    s_waitcnt vmcnt(32)
    ds_read_b64_tr_b16 a[112:113], v2 offset:28672
    ds_read_b64_tr_b16 a[114:115], v2 offset:29696
    ds_read_b64_tr_b16 a[116:117], v3 offset:28672
    ds_read_b64_tr_b16 a[118:119], v3 offset:29696
    ds_read_b64_tr_b16 a[120:121], v2 offset:30720
    ds_read_b64_tr_b16 a[122:123], v2 offset:31744
    ds_read_b64_tr_b16 a[124:125], v3 offset:30720
    ds_read_b64_tr_b16 a[126:127], v3 offset:31744
    s_waitcnt lgkmcnt(0)
    s_waitcnt vmcnt(28)
    ds_read_b64_tr_b16 a[128:129], v2 offset:32768
    ds_read_b64_tr_b16 a[130:131], v2 offset:33792
    ds_read_b64_tr_b16 a[132:133], v3 offset:32768
    ds_read_b64_tr_b16 a[134:135], v3 offset:33792
    ds_read_b64_tr_b16 a[136:137], v2 offset:34816
    ds_read_b64_tr_b16 a[138:139], v2 offset:35840
    ds_read_b64_tr_b16 a[140:141], v3 offset:34816
    ds_read_b64_tr_b16 a[142:143], v3 offset:35840
    s_waitcnt lgkmcnt(0)
    s_waitcnt vmcnt(24)
    ds_read_b64_tr_b16 a[144:145], v2 offset:0
    ds_read_b64_tr_b16 a[146:147], v2 offset:1024
    ds_read_b64_tr_b16 a[148:149], v3 offset:0
    ds_read_b64_tr_b16 a[150:151], v3 offset:1024
    ds_read_b64_tr_b16 a[152:153], v2 offset:2048
    ds_read_b64_tr_b16 a[154:155], v2 offset:3072
    ds_read_b64_tr_b16 a[156:157], v3 offset:2048
    ds_read_b64_tr_b16 a[158:159], v3 offset:3072
    s_waitcnt lgkmcnt(0)
    s_waitcnt vmcnt(20)
    ds_read_b64_tr_b16 a[160:161], v2 offset:4096
    ds_read_b64_tr_b16 a[162:163], v2 offset:5120
    ds_read_b64_tr_b16 a[164:165], v3 offset:4096
    ds_read_b64_tr_b16 a[166:167], v3 offset:5120
    ds_read_b64_tr_b16 a[168:169], v2 offset:6144
    ds_read_b64_tr_b16 a[170:171], v2 offset:7168
    ds_read_b64_tr_b16 a[172:173], v3 offset:6144
    ds_read_b64_tr_b16 a[174:175], v3 offset:7168
    s_waitcnt lgkmcnt(0)
    s_waitcnt vmcnt(16)
    ds_read_b64_tr_b16 a[176:177], v2 offset:8192
    ds_read_b64_tr_b16 a[178:179], v2 offset:9216
    ds_read_b64_tr_b16 a[180:181], v3 offset:8192
    ds_read_b64_tr_b16 a[182:183], v3 offset:9216
    ds_read_b64_tr_b16 a[184:185], v2 offset:10240
    ds_read_b64_tr_b16 a[186:187], v2 offset:11264
    ds_read_b64_tr_b16 a[188:189], v3 offset:10240
    ds_read_b64_tr_b16 a[190:191], v3 offset:11264
    s_waitcnt lgkmcnt(0)
    s_waitcnt vmcnt(12)
    ds_read_b64_tr_b16 a[192:193], v2 offset:12288
    ds_read_b64_tr_b16 a[194:195], v2 offset:13312
    ds_read_b64_tr_b16 a[196:197], v3 offset:12288
    ds_read_b64_tr_b16 a[198:199], v3 offset:13312
    ds_read_b64_tr_b16 a[200:201], v2 offset:14336
    ds_read_b64_tr_b16 a[202:203], v2 offset:15360
    ds_read_b64_tr_b16 a[204:205], v3 offset:14336
    ds_read_b64_tr_b16 a[206:207], v3 offset:15360
    s_waitcnt lgkmcnt(0)
    s_waitcnt vmcnt(8)
    ds_read_b64_tr_b16 a[208:209], v2 offset:16384
    ds_read_b64_tr_b16 a[210:211], v2 offset:17408
    ds_read_b64_tr_b16 a[212:213], v3 offset:16384
    ds_read_b64_tr_b16 a[214:215], v3 offset:17408
    ds_read_b64_tr_b16 a[216:217], v2 offset:18432
    ds_read_b64_tr_b16 a[218:219], v2 offset:19456
    ds_read_b64_tr_b16 a[220:221], v3 offset:18432
    ds_read_b64_tr_b16 a[222:223], v3 offset:19456
    s_waitcnt lgkmcnt(0)
    s_waitcnt vmcnt(4)
    ds_read_b64_tr_b16 a[224:225], v2 offset:20480
    ds_read_b64_tr_b16 a[226:227], v2 offset:21504
    ds_read_b64_tr_b16 a[228:229], v3 offset:20480
    ds_read_b64_tr_b16 a[230:231], v3 offset:21504
    ds_read_b64_tr_b16 a[232:233], v2 offset:22528
    ds_read_b64_tr_b16 a[234:235], v2 offset:23552
    ds_read_b64_tr_b16 a[236:237], v3 offset:22528
    ds_read_b64_tr_b16 a[238:239], v3 offset:23552
    s_waitcnt lgkmcnt(0)
    s_waitcnt vmcnt(0)
    ds_read_b64_tr_b16 a[240:241], v2 offset:24576
    ds_read_b64_tr_b16 a[242:243], v2 offset:25600
    ds_read_b64_tr_b16 a[244:245], v3 offset:24576
    ds_read_b64_tr_b16 a[246:247], v3 offset:25600
    ds_read_b64_tr_b16 a[248:249], v2 offset:26624
    ds_read_b64_tr_b16 a[250:251], v2 offset:27648
    ds_read_b64_tr_b16 a[252:253], v3 offset:26624
    ds_read_b64_tr_b16 a[254:255], v3 offset:27648
    s_waitcnt lgkmcnt(0)
    s_barrier
    s_mov_b32 s29, 0
    v_lshlrev_b32 v1, 4, v0
    v_mov_b32 v8, 0
    s_mov_b32 s64, 0x298000
OUS_124:
    buffer_load_dword v7, v8, s[4:7], s64 offen sc1
    s_add_u32 s29, s29, 1
    s_waitcnt vmcnt(0)
    v_cmp_gt_u32 vcc, 1, v7
    s_cbranch_vccz OUSD_125
    s_cmp_gt_u32 s29, 262144
    s_cbranch_scc1 OUSD_125
    s_sleep 8
    s_branch OUS_124
OUSD_125:
    v_lshlrev_b32 v6, 2, v0
    s_mov_b32 s64, 0x5400000
    buffer_load_dword v7, v6, s[4:7], s64 offen sc1
    s_waitcnt vmcnt(0)
    v_readlane_b32 s72, v7, 0
    v_readlane_b32 s73, v7, 1
    v_readlane_b32 s74, v7, 2
    v_readlane_b32 s75, v7, 3
    v_readlane_b32 s76, v7, 4
    v_readlane_b32 s77, v7, 5
    v_readlane_b32 s78, v7, 6
    v_readlane_b32 s79, v7, 7
    s_and_b32 s64, s14, 1
    s_lshl_b32 s64, s64, 4
    v_and_b32 v6, 15, v0
    v_add_u32 v6, s64, v6
    v_mov_b32 v9, v6
    v_mul_u32_u24 v5, 1280, v6
    v_lshrrev_b32 v6, 4, v0
    v_lshl_add_u32 v5, v6, 3, v5
    s_lshr_b32 s64, s14, 1
    s_lshl_b32 s64, s64, 5
    s_lshl_b32 s65, s13, 6
    s_add_u32 s64, s64, s65
    v_add_u32 v5, s64, v5
    v_lshlrev_b32 v6, 2, v0
    s_mov_b32 s80, 0x49249249
    s_mov_b32 s81, 0x92492492
    s_lshl_b64 s[80:81], s[80:81], s12
    s_mov_b64 s[82:83], 0
    s_lshr_b32 s64, s72, 5
    s_bitset1_b64 s[82:83], s64
    s_lshr_b32 s64, s73, 5
    s_bitset1_b64 s[82:83], s64
    s_lshr_b32 s64, s74, 5
    s_bitset1_b64 s[82:83], s64
    s_lshr_b32 s64, s75, 5
    s_bitset1_b64 s[82:83], s64
    s_lshr_b32 s64, s76, 5
    s_bitset1_b64 s[82:83], s64
    s_lshr_b32 s64, s77, 5
    s_bitset1_b64 s[82:83], s64
    s_lshr_b32 s64, s78, 5
    s_bitset1_b64 s[82:83], s64
    s_lshr_b32 s64, s79, 5
    s_bitset1_b64 s[82:83], s64
OU_LOOP:
    s_cmp_eq_u64 s[80:81], 0
    s_cbranch_scc1 OU_END
    s_andn2_b64 s[84:85], s[80:81], s[82:83]
    s_cbranch_scc0 OU_WM
    s_ff1_i32_b64 s24, s[84:85]
    s_cmp_lt_u32 s24, 40
    s_cbranch_scc1 OU_GO
    s_cmp_eq_u64 s[82:83], 0
    s_cbranch_scc1 OU_GO
OU_WM:
    v_mov_b32 v8, 0
    s_mov_b32 s64, 0x298100
OUW_126:
    buffer_load_dword v7, v8, s[4:7], s64 offen sc1
    s_add_u32 s29, s29, 1
    s_waitcnt vmcnt(0)
    v_cmp_gt_u32 vcc, 40, v7
    s_cbranch_vccz OUWD_127
    s_cmp_gt_u32 s29, 262144
    s_cbranch_scc1 OUWD_127
    s_sleep 8
    s_branch OUW_126
OUWD_127:
    s_mov_b64 s[82:83], 0
    s_branch OU_LOOP
OU_GO:
    s_bitset0_b64 s[80:81], s24
    s_mul_i32 s67, s24, 40960
    buffer_load_dwordx2 v[160:161], v5, s[48:51], s67 offen
    s_add_u32 s64, s67, 0x0
    buffer_load_dwordx2 v[162:163], v5, s[4:7], s64 offen
    s_lshl_b32 s64, s24, 7
    s_add_u32 s64, s64, 0x296000
    s_mov_b64 exec, s[36:37]
OU_F_128:
    buffer_load_dword v7, v6, s[4:7], s64 offen sc1
    s_add_u32 s29, s29, 1
    s_waitcnt vmcnt(0)
    v_cmp_eq_u32 vcc, 0, v7
    s_cbranch_vccz OU_FD_129
    s_cmp_gt_u32 s29, 262144
    s_cbranch_scc1 OU_FD_129
    s_sleep 4
    s_branch OU_F_128
OU_FD_129:
    s_mov_b64 exec, -1
    s_lshl_b32 s25, s24, 18
    s_lshl_b32 s64, s14, 15
    s_add_u32 s25, s25, s64
    s_add_u32 s25, s25, 0x4400000
    s_add_u32 s64, s25, 0x0
    buffer_load_dwordx4 v[16:19], v1, s[4:7], s64 offen
    s_add_u32 s64, s25, 0x20000
    buffer_load_dwordx4 v[20:23], v1, s[4:7], s64 offen
    s_add_u32 s64, s25, 0x400
    buffer_load_dwordx4 v[24:27], v1, s[4:7], s64 offen
    s_add_u32 s64, s25, 0x20400
    buffer_load_dwordx4 v[28:31], v1, s[4:7], s64 offen
    s_add_u32 s64, s25, 0x800
    buffer_load_dwordx4 v[32:35], v1, s[4:7], s64 offen
    s_add_u32 s64, s25, 0x20800
    buffer_load_dwordx4 v[36:39], v1, s[4:7], s64 offen
    s_add_u32 s64, s25, 0xc00
    buffer_load_dwordx4 v[40:43], v1, s[4:7], s64 offen
    s_add_u32 s64, s25, 0x20c00
    buffer_load_dwordx4 v[44:47], v1, s[4:7], s64 offen
    s_add_u32 s64, s25, 0x1000
    buffer_load_dwordx4 v[48:51], v1, s[4:7], s64 offen
    s_add_u32 s64, s25, 0x21000
    buffer_load_dwordx4 v[52:55], v1, s[4:7], s64 offen
    s_add_u32 s64, s25, 0x1400
    buffer_load_dwordx4 v[56:59], v1, s[4:7], s64 offen
    s_add_u32 s64, s25, 0x21400
    buffer_load_dwordx4 v[60:63], v1, s[4:7], s64 offen
    s_add_u32 s64, s25, 0x1800
    buffer_load_dwordx4 v[64:67], v1, s[4:7], s64 offen
    s_add_u32 s64, s25, 0x21800
    buffer_load_dwordx4 v[68:71], v1, s[4:7], s64 offen
    s_add_u32 s64, s25, 0x1c00
    buffer_load_dwordx4 v[72:75], v1, s[4:7], s64 offen
    s_add_u32 s64, s25, 0x21c00
    buffer_load_dwordx4 v[76:79], v1, s[4:7], s64 offen
    s_add_u32 s64, s25, 0x2000
    buffer_load_dwordx4 v[80:83], v1, s[4:7], s64 offen
    s_add_u32 s64, s25, 0x22000
    buffer_load_dwordx4 v[84:87], v1, s[4:7], s64 offen
    s_add_u32 s64, s25, 0x2400
    buffer_load_dwordx4 v[88:91], v1, s[4:7], s64 offen
    s_add_u32 s64, s25, 0x22400
    buffer_load_dwordx4 v[92:95], v1, s[4:7], s64 offen
    s_add_u32 s64, s25, 0x2800
    buffer_load_dwordx4 v[96:99], v1, s[4:7], s64 offen
    s_add_u32 s64, s25, 0x22800
    buffer_load_dwordx4 v[100:103], v1, s[4:7], s64 offen
    s_add_u32 s64, s25, 0x2c00
    buffer_load_dwordx4 v[104:107], v1, s[4:7], s64 offen
    s_add_u32 s64, s25, 0x22c00
    buffer_load_dwordx4 v[108:111], v1, s[4:7], s64 offen
    s_add_u32 s64, s25, 0x3000
    buffer_load_dwordx4 v[112:115], v1, s[4:7], s64 offen
    s_add_u32 s64, s25, 0x23000
    buffer_load_dwordx4 v[116:119], v1, s[4:7], s64 offen
    s_add_u32 s64, s25, 0x3400
    buffer_load_dwordx4 v[120:123], v1, s[4:7], s64 offen
    s_add_u32 s64, s25, 0x23400
    buffer_load_dwordx4 v[124:127], v1, s[4:7], s64 offen
    s_add_u32 s64, s25, 0x3800
    buffer_load_dwordx4 v[128:131], v1, s[4:7], s64 offen
    s_add_u32 s64, s25, 0x23800
    buffer_load_dwordx4 v[132:135], v1, s[4:7], s64 offen
    s_add_u32 s64, s25, 0x3c00
    buffer_load_dwordx4 v[136:139], v1, s[4:7], s64 offen
    s_add_u32 s64, s25, 0x23c00
    buffer_load_dwordx4 v[140:143], v1, s[4:7], s64 offen
    s_waitcnt vmcnt(30)
    v_mfma_f32_16x16x32_bf16 v[144:147], a[0:3], v[16:19], 0
    v_mfma_f32_16x16x32_bf16 v[148:151], a[0:3], v[20:23], 0
    v_mfma_f32_16x16x32_bf16 v[152:155], a[4:7], v[16:19], 0
    v_mfma_f32_16x16x32_bf16 v[156:159], a[4:7], v[20:23], 0
    s_add_u32 s64, s25, 0x4000
    buffer_load_dwordx4 v[16:19], v1, s[4:7], s64 offen
    s_add_u32 s64, s25, 0x24000
    buffer_load_dwordx4 v[20:23], v1, s[4:7], s64 offen
    s_waitcnt vmcnt(30)
    v_mfma_f32_16x16x32_bf16 v[144:147], a[8:11], v[24:27], v[144:147]
    v_mfma_f32_16x16x32_bf16 v[148:151], a[8:11], v[28:31], v[148:151]
    v_mfma_f32_16x16x32_bf16 v[152:155], a[12:15], v[24:27], v[152:155]
    v_mfma_f32_16x16x32_bf16 v[156:159], a[12:15], v[28:31], v[156:159]
    s_add_u32 s64, s25, 0x4400
    buffer_load_dwordx4 v[24:27], v1, s[4:7], s64 offen
    s_add_u32 s64, s25, 0x24400
    buffer_load_dwordx4 v[28:31], v1, s[4:7], s64 offen
    s_waitcnt vmcnt(30)
    v_mfma_f32_16x16x32_bf16 v[144:147], a[16:19], v[32:35], v[144:147]
    v_mfma_f32_16x16x32_bf16 v[148:151], a[16:19], v[36:39], v[148:151]
    v_mfma_f32_16x16x32_bf16 v[152:155], a[20:23], v[32:35], v[152:155]
    v_mfma_f32_16x16x32_bf16 v[156:159], a[20:23], v[36:39], v[156:159]
    s_add_u32 s64, s25, 0x4800
    buffer_load_dwordx4 v[32:35], v1, s[4:7], s64 offen
    s_add_u32 s64, s25, 0x24800
    buffer_load_dwordx4 v[36:39], v1, s[4:7], s64 offen
    s_waitcnt vmcnt(30)
    v_mfma_f32_16x16x32_bf16 v[144:147], a[24:27], v[40:43], v[144:147]
    v_mfma_f32_16x16x32_bf16 v[148:151], a[24:27], v[44:47], v[148:151]
    v_mfma_f32_16x16x32_bf16 v[152:155], a[28:31], v[40:43], v[152:155]
    v_mfma_f32_16x16x32_bf16 v[156:159], a[28:31], v[44:47], v[156:159]
    s_add_u32 s64, s25, 0x4c00
    buffer_load_dwordx4 v[40:43], v1, s[4:7], s64 offen
    s_add_u32 s64, s25, 0x24c00
    buffer_load_dwordx4 v[44:47], v1, s[4:7], s64 offen
    s_waitcnt vmcnt(30)
    v_mfma_f32_16x16x32_bf16 v[144:147], a[32:35], v[48:51], v[144:147]
    v_mfma_f32_16x16x32_bf16 v[148:151], a[32:35], v[52:55], v[148:151]
    v_mfma_f32_16x16x32_bf16 v[152:155], a[36:39], v[48:51], v[152:155]
    v_mfma_f32_16x16x32_bf16 v[156:159], a[36:39], v[52:55], v[156:159]
    s_add_u32 s64, s25, 0x5000
    buffer_load_dwordx4 v[48:51], v1, s[4:7], s64 offen
    s_add_u32 s64, s25, 0x25000
    buffer_load_dwordx4 v[52:55], v1, s[4:7], s64 offen
    s_waitcnt vmcnt(30)
    v_mfma_f32_16x16x32_bf16 v[144:147], a[40:43], v[56:59], v[144:147]
    v_mfma_f32_16x16x32_bf16 v[148:151], a[40:43], v[60:63], v[148:151]
    v_mfma_f32_16x16x32_bf16 v[152:155], a[44:47], v[56:59], v[152:155]
    v_mfma_f32_16x16x32_bf16 v[156:159], a[44:47], v[60:63], v[156:159]
    s_add_u32 s64, s25, 0x5400
    buffer_load_dwordx4 v[56:59], v1, s[4:7], s64 offen
    s_add_u32 s64, s25, 0x25400
    buffer_load_dwordx4 v[60:63], v1, s[4:7], s64 offen
    s_waitcnt vmcnt(30)
    v_mfma_f32_16x16x32_bf16 v[144:147], a[48:51], v[64:67], v[144:147]
    v_mfma_f32_16x16x32_bf16 v[148:151], a[48:51], v[68:71], v[148:151]
    v_mfma_f32_16x16x32_bf16 v[152:155], a[52:55], v[64:67], v[152:155]
    v_mfma_f32_16x16x32_bf16 v[156:159], a[52:55], v[68:71], v[156:159]
    s_add_u32 s64, s25, 0x5800
    buffer_load_dwordx4 v[64:67], v1, s[4:7], s64 offen
    s_add_u32 s64, s25, 0x25800
    buffer_load_dwordx4 v[68:71], v1, s[4:7], s64 offen
    s_waitcnt vmcnt(30)
    v_mfma_f32_16x16x32_bf16 v[144:147], a[56:59], v[72:75], v[144:147]
    v_mfma_f32_16x16x32_bf16 v[148:151], a[56:59], v[76:79], v[148:151]
    v_mfma_f32_16x16x32_bf16 v[152:155], a[60:63], v[72:75], v[152:155]
    v_mfma_f32_16x16x32_bf16 v[156:159], a[60:63], v[76:79], v[156:159]
    s_add_u32 s64, s25, 0x5c00
    buffer_load_dwordx4 v[72:75], v1, s[4:7], s64 offen
    s_add_u32 s64, s25, 0x25c00
    buffer_load_dwordx4 v[76:79], v1, s[4:7], s64 offen
    s_waitcnt vmcnt(30)
    v_mfma_f32_16x16x32_bf16 v[144:147], a[64:67], v[80:83], v[144:147]
    v_mfma_f32_16x16x32_bf16 v[148:151], a[64:67], v[84:87], v[148:151]
    v_mfma_f32_16x16x32_bf16 v[152:155], a[68:71], v[80:83], v[152:155]
    v_mfma_f32_16x16x32_bf16 v[156:159], a[68:71], v[84:87], v[156:159]
    s_add_u32 s64, s25, 0x6000
    buffer_load_dwordx4 v[80:83], v1, s[4:7], s64 offen
    s_add_u32 s64, s25, 0x26000
    buffer_load_dwordx4 v[84:87], v1, s[4:7], s64 offen
    s_waitcnt vmcnt(30)
    v_mfma_f32_16x16x32_bf16 v[144:147], a[72:75], v[88:91], v[144:147]
    v_mfma_f32_16x16x32_bf16 v[148:151], a[72:75], v[92:95], v[148:151]
    v_mfma_f32_16x16x32_bf16 v[152:155], a[76:79], v[88:91], v[152:155]
    v_mfma_f32_16x16x32_bf16 v[156:159], a[76:79], v[92:95], v[156:159]
    s_add_u32 s64, s25, 0x6400
    buffer_load_dwordx4 v[88:91], v1, s[4:7], s64 offen
    s_add_u32 s64, s25, 0x26400
    buffer_load_dwordx4 v[92:95], v1, s[4:7], s64 offen
    s_waitcnt vmcnt(30)
    v_mfma_f32_16x16x32_bf16 v[144:147], a[80:83], v[96:99], v[144:147]
    v_mfma_f32_16x16x32_bf16 v[148:151], a[80:83], v[100:103], v[148:151]
    v_mfma_f32_16x16x32_bf16 v[152:155], a[84:87], v[96:99], v[152:155]
    v_mfma_f32_16x16x32_bf16 v[156:159], a[84:87], v[100:103], v[156:159]
    s_add_u32 s64, s25, 0x6800
    buffer_load_dwordx4 v[96:99], v1, s[4:7], s64 offen
    s_add_u32 s64, s25, 0x26800
    buffer_load_dwordx4 v[100:103], v1, s[4:7], s64 offen
    s_waitcnt vmcnt(30)
    v_mfma_f32_16x16x32_bf16 v[144:147], a[88:91], v[104:107], v[144:147]
    v_mfma_f32_16x16x32_bf16 v[148:151], a[88:91], v[108:111], v[148:151]
    v_mfma_f32_16x16x32_bf16 v[152:155], a[92:95], v[104:107], v[152:155]
    v_mfma_f32_16x16x32_bf16 v[156:159], a[92:95], v[108:111], v[156:159]
    s_add_u32 s64, s25, 0x6c00
    buffer_load_dwordx4 v[104:107], v1, s[4:7], s64 offen
    s_add_u32 s64, s25, 0x26c00
    buffer_load_dwordx4 v[108:111], v1, s[4:7], s64 offen
    s_waitcnt vmcnt(30)
    v_mfma_f32_16x16x32_bf16 v[144:147], a[96:99], v[112:115], v[144:147]
    v_mfma_f32_16x16x32_bf16 v[148:151], a[96:99], v[116:119], v[148:151]
    v_mfma_f32_16x16x32_bf16 v[152:155], a[100:103], v[112:115], v[152:155]
    v_mfma_f32_16x16x32_bf16 v[156:159], a[100:103], v[116:119], v[156:159]
    s_add_u32 s64, s25, 0x7000
    buffer_load_dwordx4 v[112:115], v1, s[4:7], s64 offen
    s_add_u32 s64, s25, 0x27000
    buffer_load_dwordx4 v[116:119], v1, s[4:7], s64 offen
    s_waitcnt vmcnt(30)
    v_mfma_f32_16x16x32_bf16 v[144:147], a[104:107], v[120:123], v[144:147]
    v_mfma_f32_16x16x32_bf16 v[148:151], a[104:107], v[124:127], v[148:151]
    v_mfma_f32_16x16x32_bf16 v[152:155], a[108:111], v[120:123], v[152:155]
    v_mfma_f32_16x16x32_bf16 v[156:159], a[108:111], v[124:127], v[156:159]
    s_add_u32 s64, s25, 0x7400
    buffer_load_dwordx4 v[120:123], v1, s[4:7], s64 offen
    s_add_u32 s64, s25, 0x27400
    buffer_load_dwordx4 v[124:127], v1, s[4:7], s64 offen
    s_waitcnt vmcnt(30)
    v_mfma_f32_16x16x32_bf16 v[144:147], a[112:115], v[128:131], v[144:147]
    v_mfma_f32_16x16x32_bf16 v[148:151], a[112:115], v[132:135], v[148:151]
    v_mfma_f32_16x16x32_bf16 v[152:155], a[116:119], v[128:131], v[152:155]
    v_mfma_f32_16x16x32_bf16 v[156:159], a[116:119], v[132:135], v[156:159]
    s_add_u32 s64, s25, 0x7800
    buffer_load_dwordx4 v[128:131], v1, s[4:7], s64 offen
    s_add_u32 s64, s25, 0x27800
    buffer_load_dwordx4 v[132:135], v1, s[4:7], s64 offen
    s_waitcnt vmcnt(30)
    v_mfma_f32_16x16x32_bf16 v[144:147], a[120:123], v[136:139], v[144:147]
    v_mfma_f32_16x16x32_bf16 v[148:151], a[120:123], v[140:143], v[148:151]
    v_mfma_f32_16x16x32_bf16 v[152:155], a[124:127], v[136:139], v[152:155]
    v_mfma_f32_16x16x32_bf16 v[156:159], a[124:127], v[140:143], v[156:159]
    s_add_u32 s64, s25, 0x7c00
    buffer_load_dwordx4 v[136:139], v1, s[4:7], s64 offen
    s_add_u32 s64, s25, 0x27c00
    buffer_load_dwordx4 v[140:143], v1, s[4:7], s64 offen
    s_waitcnt vmcnt(30)
    v_mfma_f32_16x16x32_bf16 v[144:147], a[128:131], v[16:19], v[144:147]
    v_mfma_f32_16x16x32_bf16 v[148:151], a[128:131], v[20:23], v[148:151]
    v_mfma_f32_16x16x32_bf16 v[152:155], a[132:135], v[16:19], v[152:155]
    v_mfma_f32_16x16x32_bf16 v[156:159], a[132:135], v[20:23], v[156:159]
    s_waitcnt vmcnt(28)
    v_mfma_f32_16x16x32_bf16 v[144:147], a[136:139], v[24:27], v[144:147]
    v_mfma_f32_16x16x32_bf16 v[148:151], a[136:139], v[28:31], v[148:151]
    v_mfma_f32_16x16x32_bf16 v[152:155], a[140:143], v[24:27], v[152:155]
    v_mfma_f32_16x16x32_bf16 v[156:159], a[140:143], v[28:31], v[156:159]
    s_waitcnt vmcnt(26)
    v_mfma_f32_16x16x32_bf16 v[144:147], a[144:147], v[32:35], v[144:147]
    v_mfma_f32_16x16x32_bf16 v[148:151], a[144:147], v[36:39], v[148:151]
    v_mfma_f32_16x16x32_bf16 v[152:155], a[148:151], v[32:35], v[152:155]
    v_mfma_f32_16x16x32_bf16 v[156:159], a[148:151], v[36:39], v[156:159]
    s_waitcnt vmcnt(24)
    v_mfma_f32_16x16x32_bf16 v[144:147], a[152:155], v[40:43], v[144:147]
    v_mfma_f32_16x16x32_bf16 v[148:151], a[152:155], v[44:47], v[148:151]
    v_mfma_f32_16x16x32_bf16 v[152:155], a[156:159], v[40:43], v[152:155]
    v_mfma_f32_16x16x32_bf16 v[156:159], a[156:159], v[44:47], v[156:159]
    s_waitcnt vmcnt(22)
    v_mfma_f32_16x16x32_bf16 v[144:147], a[160:163], v[48:51], v[144:147]
    v_mfma_f32_16x16x32_bf16 v[148:151], a[160:163], v[52:55], v[148:151]
    v_mfma_f32_16x16x32_bf16 v[152:155], a[164:167], v[48:51], v[152:155]
    v_mfma_f32_16x16x32_bf16 v[156:159], a[164:167], v[52:55], v[156:159]
    s_waitcnt vmcnt(20)
    v_mfma_f32_16x16x32_bf16 v[144:147], a[168:171], v[56:59], v[144:147]
    v_mfma_f32_16x16x32_bf16 v[148:151], a[168:171], v[60:63], v[148:151]
    v_mfma_f32_16x16x32_bf16 v[152:155], a[172:175], v[56:59], v[152:155]
    v_mfma_f32_16x16x32_bf16 v[156:159], a[172:175], v[60:63], v[156:159]
    s_waitcnt vmcnt(18)
    v_mfma_f32_16x16x32_bf16 v[144:147], a[176:179], v[64:67], v[144:147]
    v_mfma_f32_16x16x32_bf16 v[148:151], a[176:179], v[68:71], v[148:151]
    v_mfma_f32_16x16x32_bf16 v[152:155], a[180:183], v[64:67], v[152:155]
    v_mfma_f32_16x16x32_bf16 v[156:159], a[180:183], v[68:71], v[156:159]
    s_waitcnt vmcnt(16)
    v_mfma_f32_16x16x32_bf16 v[144:147], a[184:187], v[72:75], v[144:147]
    v_mfma_f32_16x16x32_bf16 v[148:151], a[184:187], v[76:79], v[148:151]
    v_mfma_f32_16x16x32_bf16 v[152:155], a[188:191], v[72:75], v[152:155]
    v_mfma_f32_16x16x32_bf16 v[156:159], a[188:191], v[76:79], v[156:159]
    s_waitcnt vmcnt(14)
    v_mfma_f32_16x16x32_bf16 v[144:147], a[192:195], v[80:83], v[144:147]
    v_mfma_f32_16x16x32_bf16 v[148:151], a[192:195], v[84:87], v[148:151]
    v_mfma_f32_16x16x32_bf16 v[152:155], a[196:199], v[80:83], v[152:155]
    v_mfma_f32_16x16x32_bf16 v[156:159], a[196:199], v[84:87], v[156:159]
    s_waitcnt vmcnt(12)
    v_mfma_f32_16x16x32_bf16 v[144:147], a[200:203], v[88:91], v[144:147]
    v_mfma_f32_16x16x32_bf16 v[148:151], a[200:203], v[92:95], v[148:151]
    v_mfma_f32_16x16x32_bf16 v[152:155], a[204:207], v[88:91], v[152:155]
    v_mfma_f32_16x16x32_bf16 v[156:159], a[204:207], v[92:95], v[156:159]
    s_waitcnt vmcnt(10)
    v_mfma_f32_16x16x32_bf16 v[144:147], a[208:211], v[96:99], v[144:147]
    v_mfma_f32_16x16x32_bf16 v[148:151], a[208:211], v[100:103], v[148:151]
    v_mfma_f32_16x16x32_bf16 v[152:155], a[212:215], v[96:99], v[152:155]
    v_mfma_f32_16x16x32_bf16 v[156:159], a[212:215], v[100:103], v[156:159]
    s_waitcnt vmcnt(8)
    v_mfma_f32_16x16x32_bf16 v[144:147], a[216:219], v[104:107], v[144:147]
    v_mfma_f32_16x16x32_bf16 v[148:151], a[216:219], v[108:111], v[148:151]
    v_mfma_f32_16x16x32_bf16 v[152:155], a[220:223], v[104:107], v[152:155]
    v_mfma_f32_16x16x32_bf16 v[156:159], a[220:223], v[108:111], v[156:159]
    s_waitcnt vmcnt(6)
    v_mfma_f32_16x16x32_bf16 v[144:147], a[224:227], v[112:115], v[144:147]
    v_mfma_f32_16x16x32_bf16 v[148:151], a[224:227], v[116:119], v[148:151]
    v_mfma_f32_16x16x32_bf16 v[152:155], a[228:231], v[112:115], v[152:155]
    v_mfma_f32_16x16x32_bf16 v[156:159], a[228:231], v[116:119], v[156:159]
    s_waitcnt vmcnt(4)
    v_mfma_f32_16x16x32_bf16 v[144:147], a[232:235], v[120:123], v[144:147]
    v_mfma_f32_16x16x32_bf16 v[148:151], a[232:235], v[124:127], v[148:151]
    v_mfma_f32_16x16x32_bf16 v[152:155], a[236:239], v[120:123], v[152:155]
    v_mfma_f32_16x16x32_bf16 v[156:159], a[236:239], v[124:127], v[156:159]
    s_waitcnt vmcnt(2)
    v_mfma_f32_16x16x32_bf16 v[144:147], a[240:243], v[128:131], v[144:147]
    v_mfma_f32_16x16x32_bf16 v[148:151], a[240:243], v[132:135], v[148:151]
    v_mfma_f32_16x16x32_bf16 v[152:155], a[244:247], v[128:131], v[152:155]
    v_mfma_f32_16x16x32_bf16 v[156:159], a[244:247], v[132:135], v[156:159]
    s_waitcnt vmcnt(0)
    v_mfma_f32_16x16x32_bf16 v[144:147], a[248:251], v[136:139], v[144:147]
    v_mfma_f32_16x16x32_bf16 v[148:151], a[248:251], v[140:143], v[148:151]
    v_mfma_f32_16x16x32_bf16 v[152:155], a[252:255], v[136:139], v[152:155]
    v_mfma_f32_16x16x32_bf16 v[156:159], a[252:255], v[140:143], v[156:159]
    s_lshl_b32 s64, s14, 12
    v_add_u32 v7, s64, v1
    s_barrier
    s_nop 3
    ds_write_b128 v7, v[144:147] offset:0
    ds_write_b128 v7, v[148:151] offset:1024
    ds_write_b128 v7, v[152:155] offset:2048
    ds_write_b128 v7, v[156:159] offset:3072
    s_waitcnt lgkmcnt(0)
    s_barrier
    s_lshl_b32 s64, s14, 10
    v_add_u32 v7, s64, v1
    ds_read_b128 v[16:19], v7 offset:0
    ds_read_b128 v[20:23], v7 offset:4096
    ds_read_b128 v[24:27], v7 offset:8192
    ds_read_b128 v[28:31], v7 offset:12288
    s_waitcnt lgkmcnt(0)
    v_add_f32 v16, v16, v20
    v_add_f32 v24, v24, v28
    v_add_f32 v16, v16, v24
    v_add_f32 v17, v17, v21
    v_add_f32 v25, v25, v29
    v_add_f32 v17, v17, v25
    v_add_f32 v18, v18, v22
    v_add_f32 v26, v26, v30
    v_add_f32 v18, v18, v26
    v_add_f32 v19, v19, v23
    v_add_f32 v27, v27, v31
    v_add_f32 v19, v19, v27
    v_cvt_pk_bf16_f32 v16, v16, v16
    v_lshlrev_b32 v16, 16, v16
    v_cvt_pk_bf16_f32 v17, v17, v17
    v_lshlrev_b32 v17, 16, v17
    v_cvt_pk_bf16_f32 v18, v18, v18
    v_lshlrev_b32 v18, 16, v18
    v_cvt_pk_bf16_f32 v19, v19, v19
    v_lshlrev_b32 v19, 16, v19
    v_lshlrev_b32 v20, 16, v162
    v_and_b32 v21, 0xffff0000, v162
    v_lshlrev_b32 v24, 16, v160
    v_and_b32 v25, 0xffff0000, v160
    v_lshlrev_b32 v22, 16, v163
    v_and_b32 v23, 0xffff0000, v163
    v_lshlrev_b32 v26, 16, v161
    v_and_b32 v27, 0xffff0000, v161
    s_lshl_b32 s64, s24, 5
    v_add_u32 v8, s64, v9
    v_mov_b32 v10, -1
    v_cmp_eq_u32 vcc, s72, v8
    s_nop 1
    v_cndmask_b32 v10, v10, 0, vcc
    v_cmp_eq_u32 vcc, s73, v8
    s_nop 1
    v_cndmask_b32 v10, v10, 1, vcc
    v_cmp_eq_u32 vcc, s74, v8
    s_nop 1
    v_cndmask_b32 v10, v10, 2, vcc
    v_cmp_eq_u32 vcc, s75, v8
    s_nop 1
    v_cndmask_b32 v10, v10, 3, vcc
    v_cmp_eq_u32 vcc, s76, v8
    s_nop 1
    v_cndmask_b32 v10, v10, 4, vcc
    v_cmp_eq_u32 vcc, s77, v8
    s_nop 1
    v_cndmask_b32 v10, v10, 5, vcc
    v_cmp_eq_u32 vcc, s78, v8
    s_nop 1
    v_cndmask_b32 v10, v10, 6, vcc
    v_cmp_eq_u32 vcc, s79, v8
    s_nop 1
    v_cndmask_b32 v10, v10, 7, vcc
    v_cmp_le_i32 vcc, 0, v10
    s_and_saveexec_b64 s[68:69], vcc
    s_cbranch_execz NOUPD_130
    v_mul_u32_u24 v10, 2560, v10
    v_lshrrev_b32 v11, 4, v0
    v_lshl_add_u32 v10, v11, 4, v10
    s_lshr_b32 s64, s14, 1
    s_lshl_b32 s64, s64, 6
    s_lshl_b32 s65, s13, 7
    s_add_u32 s64, s64, s65
    s_add_u32 s64, s64, 0x5410000
    buffer_load_dwordx4 v[164:167], v10, s[4:7], s64 offen sc1
    s_waitcnt vmcnt(0)
    v_add_f32 v20, v20, v164
    v_cvt_pk_bf16_f32 v20, v20, v20
    v_lshlrev_b32 v20, 16, v20
    v_add_f32 v21, v21, v165
    v_cvt_pk_bf16_f32 v21, v21, v21
    v_lshlrev_b32 v21, 16, v21
    v_add_f32 v22, v22, v166
    v_cvt_pk_bf16_f32 v22, v22, v22
    v_lshlrev_b32 v22, 16, v22
    v_add_f32 v23, v23, v167
    v_cvt_pk_bf16_f32 v23, v23, v23
    v_lshlrev_b32 v23, 16, v23
NOUPD_130:
    s_mov_b64 exec, -1
    v_mul_f32 v28, 0xbfb8aa3b, v20
    v_exp_f32 v28, v28
    s_nop 0
    v_add_f32 v28, 1.0, v28
    v_rcp_f32 v28, v28
    s_nop 0
    v_mul_f32 v28, v28, v20
    v_cvt_pk_bf16_f32 v28, v28, v28
    v_lshlrev_b32 v28, 16, v28
    v_mul_f32 v28, v28, v16
    v_cvt_pk_bf16_f32 v28, v28, v28
    v_lshlrev_b32 v28, 16, v28
    v_add_f32 v28, v28, v24
    v_mul_f32 v29, 0xbfb8aa3b, v21
    v_exp_f32 v29, v29
    s_nop 0
    v_add_f32 v29, 1.0, v29
    v_rcp_f32 v29, v29
    s_nop 0
    v_mul_f32 v29, v29, v21
    v_cvt_pk_bf16_f32 v29, v29, v29
    v_lshlrev_b32 v29, 16, v29
    v_mul_f32 v29, v29, v17
    v_cvt_pk_bf16_f32 v29, v29, v29
    v_lshlrev_b32 v29, 16, v29
    v_add_f32 v29, v29, v25
    v_mul_f32 v30, 0xbfb8aa3b, v22
    v_exp_f32 v30, v30
    s_nop 0
    v_add_f32 v30, 1.0, v30
    v_rcp_f32 v30, v30
    s_nop 0
    v_mul_f32 v30, v30, v22
    v_cvt_pk_bf16_f32 v30, v30, v30
    v_lshlrev_b32 v30, 16, v30
    v_mul_f32 v30, v30, v18
    v_cvt_pk_bf16_f32 v30, v30, v30
    v_lshlrev_b32 v30, 16, v30
    v_add_f32 v30, v30, v26
    v_mul_f32 v31, 0xbfb8aa3b, v23
    v_exp_f32 v31, v31
    s_nop 0
    v_add_f32 v31, 1.0, v31
    v_rcp_f32 v31, v31
    s_nop 0
    v_mul_f32 v31, v31, v23
    v_cvt_pk_bf16_f32 v31, v31, v31
    v_lshlrev_b32 v31, 16, v31
    v_mul_f32 v31, v31, v19
    v_cvt_pk_bf16_f32 v31, v31, v31
    v_lshlrev_b32 v31, 16, v31
    v_add_f32 v31, v31, v27
    v_cvt_pk_bf16_f32 v164, v28, v29
    v_cvt_pk_bf16_f32 v165, v30, v31
    buffer_store_dwordx2 v[164:165], v5, s[52:55], s67 offen
    s_branch OU_LOOP
OU_END:
    s_branch M_EXIT
H_Q:
    s_mov_b32 s29, 0
    v_lshlrev_b32 v1, 4, v0
    v_lshrrev_b32 v5, 4, v0
    v_lshlrev_b32 v2, 7, v5
    v_and_b32 v5, 7, v0
    v_lshl_add_u32 v2, v5, 4, v2
    v_bfe_u32 v5, v0, 4, 1
    v_lshlrev_b32 v3, 7, v5
    v_and_b32 v5, 15, v0
    v_lshl_add_u32 v3, v5, 3, v3
    s_mov_b32 s34, 0x3e0293ee
    s_mov_b32 s35, 0x3e0293ee
    s_mov_b32 s36, -1
    s_mov_b32 s37, 0
    v_lshrrev_b32 v5, 4, v0
    v_lshlrev_b32 v5, 2, v5
    v_and_b32 v6, 15, v0
    v_add_u32 v7, 0, v5
    v_cmp_le_u32 s[38:39], v7, v6
    v_add_u32 v7, 1, v5
    v_cmp_le_u32 s[40:41], v7, v6
    v_add_u32 v7, 2, v5
    v_cmp_le_u32 s[42:43], v7, v6
    v_add_u32 v7, 3, v5
    v_cmp_le_u32 s[44:45], v7, v6
    v_mov_b32 v248, 0x3f803f80
    v_mov_b32 v249, 0x3f803f80
    v_mov_b32 v250, 0x3f803f80
    v_mov_b32 v251, 0x3f803f80
    s_lshl_b32 s24, s12, 2
    s_add_u32 s24, s24, s14
    s_mov_b32 s25, 0
AT0_LOOP:
    s_lshl_b32 s64, s24, 5
    s_add_u32 s64, s64, s13
    s_lshl_b32 s26, s64, 13
    s_add_u32 s26, s26, 0x3400000
    s_lshl_b32 s27, s64, 14
    s_add_u32 s27, s27, 0x1400000
    s_lshl_b32 s65, s64, 11
    s_add_u32 s30, s65, 0x640000
    s_add_u32 s31, s65, 0xa40000
    s_lshl_b32 s33, s64, 2
    s_add_u32 s33, s33, 0x296000
    s_lshl_b32 s32, s24, 18
    s_lshl_b32 s65, s13, 12
    s_add_u32 s32, s32, s65
    s_add_u32 s32, s32, 0x4400000
    s_lshr_b32 s65, s24, 2
    s_lshl_b32 s65, s65, 9
    s_lshl_b32 s66, s13, 4
    s_add_u32 s65, s65, s66
    s_add_u32 s65, s65, 0x291000
    s_lshr_b32 s66, s24, 1
    s_lshl_b32 s66, s66, 8
    s_lshl_b32 s64, s13, 3
    s_add_u32 s66, s66, s64
    s_add_u32 s66, s66, 0x293ff4
    v_lshlrev_b32 v5, 2, v0
    v_mov_b32 v6, s65
    v_mov_b32 v7, s66
    v_cmp_gt_u32 vcc, 3, v0
    s_nop 1
    v_cndmask_b32 v6, v7, v6, vcc
    v_add_u32 v4, v5, v6
    s_mov_b32 s64, 0
    s_mov_b64 exec, 7
AT0_F_131:
    buffer_load_dword v5, v4, s[4:7], s64 offen sc1
    s_add_u32 s29, s29, 1
    s_waitcnt vmcnt(0)
    v_cmp_eq_u32 vcc, 0, v5
    s_cbranch_vccz AT0_FD_132
    s_cmp_gt_u32 s29, 262144
    s_cbranch_scc1 AT0_FD_132
    s_sleep 4
    s_branch AT0_F_131
AT0_FD_132:
    s_mov_b64 exec, -1
    buffer_load_dwordx4 v[16:19], v1, s[4:7], s26 offen offset:0
    buffer_load_dwordx4 v[20:23], v1, s[4:7], s26 offen offset:1024
    buffer_load_dwordx4 v[24:27], v1, s[4:7], s26 offen offset:2048
    buffer_load_dwordx4 v[28:31], v1, s[4:7], s26 offen offset:3072
    s_add_u32 s26, s26, 4096
    buffer_load_dwordx4 v[32:35], v1, s[4:7], s26 offen offset:0
    buffer_load_dwordx4 v[36:39], v1, s[4:7], s26 offen offset:1024
    buffer_load_dwordx4 v[40:43], v1, s[4:7], s26 offen offset:2048
    buffer_load_dwordx4 v[44:47], v1, s[4:7], s26 offen offset:3072
    buffer_load_dwordx4 v[48:51], v1, s[4:7], s27 offen offset:0
    buffer_load_dwordx4 v[52:55], v1, s[4:7], s27 offen offset:1024
    buffer_load_dwordx4 v[56:59], v1, s[4:7], s27 offen offset:2048
    buffer_load_dwordx4 v[60:63], v1, s[4:7], s27 offen offset:3072
    s_add_u32 s27, s27, 4096
    buffer_load_dwordx4 v[64:67], v1, s[4:7], s27 offen offset:0
    buffer_load_dwordx4 v[68:71], v1, s[4:7], s27 offen offset:1024
    buffer_load_dwordx4 v[72:75], v1, s[4:7], s27 offen offset:2048
    buffer_load_dwordx4 v[76:79], v1, s[4:7], s27 offen offset:3072
    s_add_u32 s27, s27, 4096
    buffer_load_dwordx4 v[80:83], v1, s[4:7], s27 offen offset:0
    buffer_load_dwordx4 v[84:87], v1, s[4:7], s27 offen offset:1024
    buffer_load_dwordx4 v[88:91], v1, s[4:7], s27 offen offset:2048
    buffer_load_dwordx4 v[92:95], v1, s[4:7], s27 offen offset:3072
    s_add_u32 s27, s27, 4096
    buffer_load_dwordx4 v[96:99], v1, s[4:7], s27 offen offset:0
    buffer_load_dwordx4 v[100:103], v1, s[4:7], s27 offen offset:1024
    buffer_load_dwordx4 v[104:107], v1, s[4:7], s27 offen offset:2048
    buffer_load_dwordx4 v[108:111], v1, s[4:7], s27 offen offset:3072
    s_mov_b64 exec, 0x18
AT0_G_133:
    buffer_load_dword v5, v4, s[4:7], s64 offen sc1
    s_add_u32 s29, s29, 1
    s_waitcnt vmcnt(0)
    v_cmp_eq_u32 vcc, 0, v5
    s_cbranch_vccz AT0_GD_134
    s_cmp_gt_u32 s29, 262144
    s_cbranch_scc1 AT0_GD_134
    s_sleep 4
    s_branch AT0_G_133
AT0_GD_134:
    s_mov_b64 exec, -1
    buffer_load_dwordx4 v[112:115], v2, s[4:7], s30 offen offset:0
    buffer_load_dwordx4 v[116:119], v2, s[4:7], s30 offen offset:512
    buffer_load_dwordx4 v[120:123], v2, s[4:7], s30 offen offset:1024
    buffer_load_dwordx4 v[124:127], v2, s[4:7], s30 offen offset:1536
    buffer_load_dwordx2 v[128:129], v3, s[4:7], s31 offen offset:0
    buffer_load_dwordx2 v[130:131], v3, s[4:7], s31 offen offset:256
    buffer_load_dwordx2 v[132:133], v3, s[4:7], s31 offen offset:512
    buffer_load_dwordx2 v[134:135], v3, s[4:7], s31 offen offset:768
    buffer_load_dwordx2 v[136:137], v3, s[4:7], s31 offen offset:1024
    buffer_load_dwordx2 v[138:139], v3, s[4:7], s31 offen offset:1280
    buffer_load_dwordx2 v[140:141], v3, s[4:7], s31 offen offset:1536
    buffer_load_dwordx2 v[142:143], v3, s[4:7], s31 offen offset:1792
    v_mfma_f32_16x16x32_bf16 v[148:151], v[48:51], v[16:19], 0
    v_mfma_f32_16x16x32_bf16 v[156:159], v[48:51], v[32:35], 0
    v_mfma_f32_16x16x32_bf16 v[160:163], v[64:67], v[32:35], 0
    v_mfma_f32_16x16x32_bf16 v[148:151], v[52:55], v[20:23], v[148:151]
    v_mfma_f32_16x16x32_bf16 v[156:159], v[52:55], v[36:39], v[156:159]
    v_mfma_f32_16x16x32_bf16 v[160:163], v[68:71], v[36:39], v[160:163]
    v_mfma_f32_16x16x32_bf16 v[148:151], v[56:59], v[24:27], v[148:151]
    v_mfma_f32_16x16x32_bf16 v[156:159], v[56:59], v[40:43], v[156:159]
    v_mfma_f32_16x16x32_bf16 v[160:163], v[72:75], v[40:43], v[160:163]
    v_mfma_f32_16x16x32_bf16 v[148:151], v[60:63], v[28:31], v[148:151]
    v_mfma_f32_16x16x32_bf16 v[156:159], v[60:63], v[44:47], v[156:159]
    v_mfma_f32_16x16x32_bf16 v[160:163], v[76:79], v[44:47], v[160:163]
    s_waitcnt vmcnt(8)
    v_mfma_f32_16x16x32_bf16 v[144:147], v[112:115], v[16:19], 0
    v_mfma_f32_16x16x32_bf16 v[152:155], v[112:115], v[32:35], 0
    v_mfma_f32_16x16x32_bf16 v[144:147], v[116:119], v[20:23], v[144:147]
    v_mfma_f32_16x16x32_bf16 v[152:155], v[116:119], v[36:39], v[152:155]
    v_mfma_f32_16x16x32_bf16 v[144:147], v[120:123], v[24:27], v[144:147]
    v_mfma_f32_16x16x32_bf16 v[152:155], v[120:123], v[40:43], v[152:155]
    v_mfma_f32_16x16x32_bf16 v[144:147], v[124:127], v[28:31], v[144:147]
    v_mfma_f32_16x16x32_bf16 v[152:155], v[124:127], v[44:47], v[152:155]
    v_mov_b32 v11, 0xff800000
    s_nop 7
    v_cndmask_b32 v148, v11, v148, s[38:39]
    v_cndmask_b32 v160, v11, v160, s[38:39]
    v_cndmask_b32 v144, v11, v144, s[36:37]
    v_cndmask_b32 v152, v11, v152, s[36:37]
    v_cndmask_b32 v149, v11, v149, s[40:41]
    v_cndmask_b32 v161, v11, v161, s[40:41]
    v_cndmask_b32 v145, v11, v145, s[36:37]
    v_cndmask_b32 v153, v11, v153, s[36:37]
    v_cndmask_b32 v150, v11, v150, s[42:43]
    v_cndmask_b32 v162, v11, v162, s[42:43]
    v_cndmask_b32 v146, v11, v146, s[36:37]
    v_cndmask_b32 v154, v11, v154, s[36:37]
    v_cndmask_b32 v151, v11, v151, s[44:45]
    v_cndmask_b32 v163, v11, v163, s[44:45]
    v_cndmask_b32 v147, v11, v147, s[36:37]
    v_cndmask_b32 v155, v11, v155, s[36:37]
    v_max3_f32 v8, v144, v145, v146
    v_max3_f32 v8, v8, v147, v148
    v_max3_f32 v8, v8, v149, v150
    v_max_f32 v8, v8, v151
    v_mov_b32 v9, v8
    s_nop 1
    v_permlane16_swap_b32 v8, v9
    v_max_f32 v8, v8, v9
    v_mov_b32 v9, v8
    s_nop 1
    v_permlane32_swap_b32 v8, v9
    v_max_f32 v8, v8, v9
    v_mul_f32 v8, s34, v8
    v_fma_f32 v144, v144, s34, -v8
    v_fma_f32 v145, v145, s34, -v8
    v_fma_f32 v146, v146, s34, -v8
    v_fma_f32 v147, v147, s34, -v8
    v_fma_f32 v148, v148, s34, -v8
    v_fma_f32 v149, v149, s34, -v8
    v_fma_f32 v150, v150, s34, -v8
    v_fma_f32 v151, v151, s34, -v8
    v_exp_f32 v144, v144
    v_exp_f32 v145, v145
    v_exp_f32 v146, v146
    v_exp_f32 v147, v147
    v_exp_f32 v148, v148
    v_exp_f32 v149, v149
    v_exp_f32 v150, v150
    v_exp_f32 v151, v151
    s_nop 0
    v_cvt_pk_bf16_f32 v164, v148, v149
    v_cvt_pk_bf16_f32 v165, v150, v151
    v_mov_b32 v166, 0
    v_mov_b32 v167, 0
    v_cvt_pk_bf16_f32 v168, v144, v145
    v_cvt_pk_bf16_f32 v169, v146, v147
    v_max3_f32 v8, v152, v153, v154
    v_max3_f32 v8, v8, v155, v156
    v_max3_f32 v8, v8, v157, v158
    v_max3_f32 v8, v8, v159, v160
    v_max3_f32 v8, v8, v161, v162
    v_max_f32 v8, v8, v163
    v_mov_b32 v9, v8
    s_nop 1
    v_permlane16_swap_b32 v8, v9
    v_max_f32 v8, v8, v9
    v_mov_b32 v9, v8
    s_nop 1
    v_permlane32_swap_b32 v8, v9
    v_max_f32 v8, v8, v9
    v_mul_f32 v8, s34, v8
    v_fma_f32 v152, v152, s34, -v8
    v_fma_f32 v153, v153, s34, -v8
    v_fma_f32 v154, v154, s34, -v8
    v_fma_f32 v155, v155, s34, -v8
    v_fma_f32 v156, v156, s34, -v8
    v_fma_f32 v157, v157, s34, -v8
    v_fma_f32 v158, v158, s34, -v8
    v_fma_f32 v159, v159, s34, -v8
    v_fma_f32 v160, v160, s34, -v8
    v_fma_f32 v161, v161, s34, -v8
    v_fma_f32 v162, v162, s34, -v8
    v_fma_f32 v163, v163, s34, -v8
    v_exp_f32 v152, v152
    v_exp_f32 v153, v153
    v_exp_f32 v154, v154
    v_exp_f32 v155, v155
    v_exp_f32 v156, v156
    v_exp_f32 v157, v157
    v_exp_f32 v158, v158
    v_exp_f32 v159, v159
    v_exp_f32 v160, v160
    v_exp_f32 v161, v161
    v_exp_f32 v162, v162
    v_exp_f32 v163, v163
    s_nop 0
    v_cvt_pk_bf16_f32 v170, v156, v157
    v_cvt_pk_bf16_f32 v171, v158, v159
    v_cvt_pk_bf16_f32 v172, v160, v161
    v_cvt_pk_bf16_f32 v173, v162, v163
    v_cvt_pk_bf16_f32 v174, v152, v153
    v_cvt_pk_bf16_f32 v175, v154, v155
    s_waitcnt vmcnt(0)
    v_mfma_f32_16x16x32_bf16 v[240:243], v[248:251], v[164:167], 0
    v_mfma_f32_16x16x32_bf16 v[244:247], v[248:251], v[170:173], 0
    v_mfma_f32_16x16x32_bf16 v[176:179], v[80:83], v[164:167], 0
    v_mfma_f32_16x16x32_bf16 v[180:183], v[80:83], v[170:173], 0
    v_mfma_f32_16x16x32_bf16 v[184:187], v[84:87], v[164:167], 0
    v_mfma_f32_16x16x32_bf16 v[188:191], v[84:87], v[170:173], 0
    v_mfma_f32_16x16x32_bf16 v[192:195], v[88:91], v[164:167], 0
    v_mfma_f32_16x16x32_bf16 v[196:199], v[88:91], v[170:173], 0
    v_mfma_f32_16x16x32_bf16 v[200:203], v[92:95], v[164:167], 0
    v_mfma_f32_16x16x32_bf16 v[204:207], v[92:95], v[170:173], 0
    v_mfma_f32_16x16x32_bf16 v[208:211], v[96:99], v[164:167], 0
    v_mfma_f32_16x16x32_bf16 v[212:215], v[96:99], v[170:173], 0
    v_mfma_f32_16x16x32_bf16 v[216:219], v[100:103], v[164:167], 0
    v_mfma_f32_16x16x32_bf16 v[220:223], v[100:103], v[170:173], 0
    v_mfma_f32_16x16x32_bf16 v[224:227], v[104:107], v[164:167], 0
    v_mfma_f32_16x16x32_bf16 v[228:231], v[104:107], v[170:173], 0
    v_mfma_f32_16x16x32_bf16 v[232:235], v[108:111], v[164:167], 0
    v_mfma_f32_16x16x32_bf16 v[236:239], v[108:111], v[170:173], 0
    v_mfma_f32_16x16x16_bf16 v[240:243], v[248:249], v[168:169], v[240:243]
    v_mfma_f32_16x16x16_bf16 v[244:247], v[248:249], v[174:175], v[244:247]
    v_mfma_f32_16x16x16_bf16 v[176:179], v[128:129], v[168:169], v[176:179]
    v_mfma_f32_16x16x16_bf16 v[180:183], v[128:129], v[174:175], v[180:183]
    v_mfma_f32_16x16x16_bf16 v[184:187], v[130:131], v[168:169], v[184:187]
    v_mfma_f32_16x16x16_bf16 v[188:191], v[130:131], v[174:175], v[188:191]
    v_mfma_f32_16x16x16_bf16 v[192:195], v[132:133], v[168:169], v[192:195]
    v_mfma_f32_16x16x16_bf16 v[196:199], v[132:133], v[174:175], v[196:199]
    v_mfma_f32_16x16x16_bf16 v[200:203], v[134:135], v[168:169], v[200:203]
    v_mfma_f32_16x16x16_bf16 v[204:207], v[134:135], v[174:175], v[204:207]
    v_mfma_f32_16x16x16_bf16 v[208:211], v[136:137], v[168:169], v[208:211]
    v_mfma_f32_16x16x16_bf16 v[212:215], v[136:137], v[174:175], v[212:215]
    v_mfma_f32_16x16x16_bf16 v[216:219], v[138:139], v[168:169], v[216:219]
    v_mfma_f32_16x16x16_bf16 v[220:223], v[138:139], v[174:175], v[220:223]
    v_mfma_f32_16x16x16_bf16 v[224:227], v[140:141], v[168:169], v[224:227]
    v_mfma_f32_16x16x16_bf16 v[228:231], v[140:141], v[174:175], v[228:231]
    v_mfma_f32_16x16x16_bf16 v[232:235], v[142:143], v[168:169], v[232:235]
    v_mfma_f32_16x16x16_bf16 v[236:239], v[142:143], v[174:175], v[236:239]
    v_rcp_f32 v8, v240
    v_rcp_f32 v9, v244
    s_nop 7
    v_mul_f32 v176, v176, v8
    v_mul_f32 v177, v177, v8
    v_mul_f32 v178, v178, v8
    v_mul_f32 v179, v179, v8
    v_cvt_pk_bf16_f32 v16, v176, v177
    v_cvt_pk_bf16_f32 v17, v178, v179
    v_mul_f32 v184, v184, v8
    v_mul_f32 v185, v185, v8
    v_mul_f32 v186, v186, v8
    v_mul_f32 v187, v187, v8
    v_cvt_pk_bf16_f32 v18, v184, v185
    v_cvt_pk_bf16_f32 v19, v186, v187
    s_add_u32 s64, s32, 0x0
    buffer_store_dwordx4 v[16:19], v1, s[4:7], s64 offen offset:0 sc1
    v_mul_f32 v192, v192, v8
    v_mul_f32 v193, v193, v8
    v_mul_f32 v194, v194, v8
    v_mul_f32 v195, v195, v8
    v_cvt_pk_bf16_f32 v20, v192, v193
    v_cvt_pk_bf16_f32 v21, v194, v195
    v_mul_f32 v200, v200, v8
    v_mul_f32 v201, v201, v8
    v_mul_f32 v202, v202, v8
    v_mul_f32 v203, v203, v8
    v_cvt_pk_bf16_f32 v22, v200, v201
    v_cvt_pk_bf16_f32 v23, v202, v203
    s_add_u32 s64, s32, 0x0
    buffer_store_dwordx4 v[20:23], v1, s[4:7], s64 offen offset:1024 sc1
    v_mul_f32 v208, v208, v8
    v_mul_f32 v209, v209, v8
    v_mul_f32 v210, v210, v8
    v_mul_f32 v211, v211, v8
    v_cvt_pk_bf16_f32 v24, v208, v209
    v_cvt_pk_bf16_f32 v25, v210, v211
    v_mul_f32 v216, v216, v8
    v_mul_f32 v217, v217, v8
    v_mul_f32 v218, v218, v8
    v_mul_f32 v219, v219, v8
    v_cvt_pk_bf16_f32 v26, v216, v217
    v_cvt_pk_bf16_f32 v27, v218, v219
    s_add_u32 s64, s32, 0x0
    buffer_store_dwordx4 v[24:27], v1, s[4:7], s64 offen offset:2048 sc1
    v_mul_f32 v224, v224, v8
    v_mul_f32 v225, v225, v8
    v_mul_f32 v226, v226, v8
    v_mul_f32 v227, v227, v8
    v_cvt_pk_bf16_f32 v28, v224, v225
    v_cvt_pk_bf16_f32 v29, v226, v227
    v_mul_f32 v232, v232, v8
    v_mul_f32 v233, v233, v8
    v_mul_f32 v234, v234, v8
    v_mul_f32 v235, v235, v8
    v_cvt_pk_bf16_f32 v30, v232, v233
    v_cvt_pk_bf16_f32 v31, v234, v235
    s_add_u32 s64, s32, 0x0
    buffer_store_dwordx4 v[28:31], v1, s[4:7], s64 offen offset:3072 sc1
    v_mul_f32 v180, v180, v9
    v_mul_f32 v181, v181, v9
    v_mul_f32 v182, v182, v9
    v_mul_f32 v183, v183, v9
    v_cvt_pk_bf16_f32 v32, v180, v181
    v_cvt_pk_bf16_f32 v33, v182, v183
    v_mul_f32 v188, v188, v9
    v_mul_f32 v189, v189, v9
    v_mul_f32 v190, v190, v9
    v_mul_f32 v191, v191, v9
    v_cvt_pk_bf16_f32 v34, v188, v189
    v_cvt_pk_bf16_f32 v35, v190, v191
    s_add_u32 s64, s32, 0x20000
    buffer_store_dwordx4 v[32:35], v1, s[4:7], s64 offen offset:0 sc1
    v_mul_f32 v196, v196, v9
    v_mul_f32 v197, v197, v9
    v_mul_f32 v198, v198, v9
    v_mul_f32 v199, v199, v9
    v_cvt_pk_bf16_f32 v36, v196, v197
    v_cvt_pk_bf16_f32 v37, v198, v199
    v_mul_f32 v204, v204, v9
    v_mul_f32 v205, v205, v9
    v_mul_f32 v206, v206, v9
    v_mul_f32 v207, v207, v9
    v_cvt_pk_bf16_f32 v38, v204, v205
    v_cvt_pk_bf16_f32 v39, v206, v207
    s_add_u32 s64, s32, 0x20000
    buffer_store_dwordx4 v[36:39], v1, s[4:7], s64 offen offset:1024 sc1
    v_mul_f32 v212, v212, v9
    v_mul_f32 v213, v213, v9
    v_mul_f32 v214, v214, v9
    v_mul_f32 v215, v215, v9
    v_cvt_pk_bf16_f32 v40, v212, v213
    v_cvt_pk_bf16_f32 v41, v214, v215
    v_mul_f32 v220, v220, v9
    v_mul_f32 v221, v221, v9
    v_mul_f32 v222, v222, v9
    v_mul_f32 v223, v223, v9
    v_cvt_pk_bf16_f32 v42, v220, v221
    v_cvt_pk_bf16_f32 v43, v222, v223
    s_add_u32 s64, s32, 0x20000
    buffer_store_dwordx4 v[40:43], v1, s[4:7], s64 offen offset:2048 sc1
    v_mul_f32 v228, v228, v9
    v_mul_f32 v229, v229, v9
    v_mul_f32 v230, v230, v9
    v_mul_f32 v231, v231, v9
    v_cvt_pk_bf16_f32 v44, v228, v229
    v_cvt_pk_bf16_f32 v45, v230, v231
    v_mul_f32 v236, v236, v9
    v_mul_f32 v237, v237, v9
    v_mul_f32 v238, v238, v9
    v_mul_f32 v239, v239, v9
    v_cvt_pk_bf16_f32 v46, v236, v237
    v_cvt_pk_bf16_f32 v47, v238, v239
    s_add_u32 s64, s32, 0x20000
    buffer_store_dwordx4 v[44:47], v1, s[4:7], s64 offen offset:3072 sc1
    s_waitcnt vmcnt(0)
    v_mov_b32 v7, 1
    v_mov_b32 v8, 0
    s_mov_b64 exec, 1
    buffer_store_dword v7, v8, s[4:7], s33 offen sc1
    s_mov_b64 exec, -1
    s_add_u32 s24, s24, 8
    s_add_u32 s25, s25, 1
    s_cmp_lt_u32 s25, 1
    s_cbranch_scc1 AT0_LOOP
    s_lshl_b32 s70, s13, 1
    s_add_u32 s70, s70, s12
    s_load_dwordx2 s[44:45], s[0:1], 72
    s_mov_b32 s46, 0x21c000
    s_mov_b32 s47, 0x00020000
    s_load_dwordx2 s[48:49], s[0:1], 80
    s_mov_b32 s50, 0x21c000
    s_mov_b32 s51, 0x00020000
    s_load_dwordx2 s[52:53], s[0:1], 88
    s_mov_b32 s54, 0x21c000
    s_mov_b32 s55, 0x00020000
    s_mov_b32 s29, 0
    s_waitcnt lgkmcnt(0)
    v_mbcnt_lo_u32_b32 v0, -1, 0
    v_mbcnt_hi_u32_b32 v0, -1, v0
    s_lshl_b32 s24, s70, 2
    s_add_u32 s24, s24, s14
    s_cmp_ge_u32 s24, 108
    s_cbranch_scc1 H_A1
    v_mov_b32 v8, 0
    s_mov_b32 s64, 0x298000
F1W_135:
    buffer_load_dword v7, v8, s[4:7], s64 offen sc1
    s_add_u32 s29, s29, 1
    s_waitcnt vmcnt(0)
    v_cmp_gt_u32 vcc, 1, v7
    s_cbranch_vccz F1WD_136
    s_cmp_gt_u32 s29, 262144
    s_cbranch_scc1 F1WD_136
    s_sleep 8
    s_branch F1W_135
F1WD_136:
    s_mul_i32 s25, s14, 40960
    v_lshrrev_b32 v7, 1, v0
    v_mul_u32_u24 v2, 3456, v7
    v_and_b32 v7, 1, v0
    v_lshl_add_u32 v2, v7, 4, v2
    v_lshrrev_b32 v7, 4, v0
    v_lshlrev_b32 v3, 8, v7
    v_bfe_u32 v7, v0, 2, 2
    v_lshl_add_u32 v3, v7, 5, v3
    v_and_b32 v7, 3, v0
    v_lshl_add_u32 v3, v7, 3, v3
    v_add_u32 v3, s25, v3
    v_and_b32 v7, 7, v0
    v_lshlrev_b32 v7, 2, v7
    s_mov_b32 s64, 0x5400000
    buffer_load_dword v4, v7, s[4:7], s64 offen sc1
    s_waitcnt vmcnt(0)
    v_mul_u32_u24 v4, 1280, v4
    v_lshrrev_b32 v7, 4, v0
    v_lshl_add_u32 v4, v7, 4, v4
    s_mov_b32 s65, 0x0
    buffer_load_dwordx4 v[16:19], v4, s[4:7], s65 offen offset:0 sc1
    buffer_load_dwordx4 v[20:23], v4, s[4:7], s65 offen offset:64 sc1
    buffer_load_dwordx4 v[24:27], v4, s[4:7], s65 offen offset:128 sc1
    buffer_load_dwordx4 v[28:31], v4, s[4:7], s65 offen offset:192 sc1
    buffer_load_dwordx4 v[32:35], v4, s[4:7], s65 offen offset:256 sc1
    buffer_load_dwordx4 v[36:39], v4, s[4:7], s65 offen offset:320 sc1
    buffer_load_dwordx4 v[40:43], v4, s[4:7], s65 offen offset:384 sc1
    buffer_load_dwordx4 v[44:47], v4, s[4:7], s65 offen offset:448 sc1
    buffer_load_dwordx4 v[48:51], v4, s[4:7], s65 offen offset:512 sc1
    buffer_load_dwordx4 v[52:55], v4, s[4:7], s65 offen offset:576 sc1
    buffer_load_dwordx4 v[56:59], v4, s[4:7], s65 offen offset:640 sc1
    buffer_load_dwordx4 v[60:63], v4, s[4:7], s65 offen offset:704 sc1
    buffer_load_dwordx4 v[64:67], v4, s[4:7], s65 offen offset:768 sc1
    buffer_load_dwordx4 v[68:71], v4, s[4:7], s65 offen offset:832 sc1
    buffer_load_dwordx4 v[72:75], v4, s[4:7], s65 offen offset:896 sc1
    buffer_load_dwordx4 v[76:79], v4, s[4:7], s65 offen offset:960 sc1
    buffer_load_dwordx4 v[80:83], v4, s[4:7], s65 offen offset:1024 sc1
    buffer_load_dwordx4 v[84:87], v4, s[4:7], s65 offen offset:1088 sc1
    buffer_load_dwordx4 v[88:91], v4, s[4:7], s65 offen offset:1152 sc1
    buffer_load_dwordx4 v[92:95], v4, s[4:7], s65 offen offset:1216 sc1
    s_lshl_b32 s26, s24, 5
    s_add_u32 m0, s25, 0
    s_add_u32 s64, s26, 0x0
    buffer_load_dwordx4 v2, s[44:47], s64 offen lds
    s_add_u32 m0, s25, 1024
    s_add_u32 s64, s26, 0x1b000
    buffer_load_dwordx4 v2, s[44:47], s64 offen lds
    s_add_u32 m0, s25, 2048
    s_add_u32 s64, s26, 0x36000
    buffer_load_dwordx4 v2, s[44:47], s64 offen lds
    s_add_u32 m0, s25, 3072
    s_add_u32 s64, s26, 0x51000
    buffer_load_dwordx4 v2, s[44:47], s64 offen lds
    s_add_u32 m0, s25, 4096
    s_add_u32 s64, s26, 0x6c000
    buffer_load_dwordx4 v2, s[44:47], s64 offen lds
    s_add_u32 m0, s25, 5120
    s_add_u32 s64, s26, 0x87000
    buffer_load_dwordx4 v2, s[44:47], s64 offen lds
    s_add_u32 m0, s25, 6144
    s_add_u32 s64, s26, 0xa2000
    buffer_load_dwordx4 v2, s[44:47], s64 offen lds
    s_add_u32 m0, s25, 7168
    s_add_u32 s64, s26, 0xbd000
    buffer_load_dwordx4 v2, s[44:47], s64 offen lds
    s_add_u32 m0, s25, 8192
    s_add_u32 s64, s26, 0xd8000
    buffer_load_dwordx4 v2, s[44:47], s64 offen lds
    s_add_u32 m0, s25, 9216
    s_add_u32 s64, s26, 0xf3000
    buffer_load_dwordx4 v2, s[44:47], s64 offen lds
    s_add_u32 m0, s25, 10240
    s_add_u32 s64, s26, 0x10e000
    buffer_load_dwordx4 v2, s[44:47], s64 offen lds
    s_add_u32 m0, s25, 11264
    s_add_u32 s64, s26, 0x129000
    buffer_load_dwordx4 v2, s[44:47], s64 offen lds
    s_add_u32 m0, s25, 12288
    s_add_u32 s64, s26, 0x144000
    buffer_load_dwordx4 v2, s[44:47], s64 offen lds
    s_add_u32 m0, s25, 13312
    s_add_u32 s64, s26, 0x15f000
    buffer_load_dwordx4 v2, s[44:47], s64 offen lds
    s_add_u32 m0, s25, 14336
    s_add_u32 s64, s26, 0x17a000
    buffer_load_dwordx4 v2, s[44:47], s64 offen lds
    s_add_u32 m0, s25, 15360
    s_add_u32 s64, s26, 0x195000
    buffer_load_dwordx4 v2, s[44:47], s64 offen lds
    s_add_u32 m0, s25, 16384
    s_add_u32 s64, s26, 0x1b0000
    buffer_load_dwordx4 v2, s[44:47], s64 offen lds
    s_add_u32 m0, s25, 17408
    s_add_u32 s64, s26, 0x1cb000
    buffer_load_dwordx4 v2, s[44:47], s64 offen lds
    s_add_u32 m0, s25, 18432
    s_add_u32 s64, s26, 0x1e6000
    buffer_load_dwordx4 v2, s[44:47], s64 offen lds
    s_add_u32 m0, s25, 19456
    s_add_u32 s64, s26, 0x201000
    buffer_load_dwordx4 v2, s[44:47], s64 offen lds
    s_waitcnt vmcnt(0)
    ds_read_b64_tr_b16 v[96:97], v3 offset:0
    ds_read_b64_tr_b16 v[98:99], v3 offset:128
    ds_read_b64_tr_b16 v[100:101], v3 offset:1024
    ds_read_b64_tr_b16 v[102:103], v3 offset:1152
    ds_read_b64_tr_b16 v[104:105], v3 offset:2048
    ds_read_b64_tr_b16 v[106:107], v3 offset:2176
    ds_read_b64_tr_b16 v[108:109], v3 offset:3072
    ds_read_b64_tr_b16 v[110:111], v3 offset:3200
    ds_read_b64_tr_b16 v[112:113], v3 offset:4096
    ds_read_b64_tr_b16 v[114:115], v3 offset:4224
    ds_read_b64_tr_b16 v[116:117], v3 offset:5120
    ds_read_b64_tr_b16 v[118:119], v3 offset:5248
    s_waitcnt lgkmcnt(4)
    ds_read_b64_tr_b16 v[120:121], v3 offset:6144
    ds_read_b64_tr_b16 v[122:123], v3 offset:6272
    ds_read_b64_tr_b16 v[124:125], v3 offset:7168
    ds_read_b64_tr_b16 v[126:127], v3 offset:7296
    ds_read_b64_tr_b16 v[128:129], v3 offset:8192
    ds_read_b64_tr_b16 v[130:131], v3 offset:8320
    ds_read_b64_tr_b16 v[132:133], v3 offset:9216
    ds_read_b64_tr_b16 v[134:135], v3 offset:9344
    ds_read_b64_tr_b16 v[136:137], v3 offset:10240
    ds_read_b64_tr_b16 v[138:139], v3 offset:10368
    ds_read_b64_tr_b16 v[140:141], v3 offset:11264
    ds_read_b64_tr_b16 v[142:143], v3 offset:11392
    s_waitcnt lgkmcnt(4)
    ds_read_b64_tr_b16 v[144:145], v3 offset:12288
    ds_read_b64_tr_b16 v[146:147], v3 offset:12416
    ds_read_b64_tr_b16 v[148:149], v3 offset:13312
    ds_read_b64_tr_b16 v[150:151], v3 offset:13440
    ds_read_b64_tr_b16 v[152:153], v3 offset:14336
    ds_read_b64_tr_b16 v[154:155], v3 offset:14464
    ds_read_b64_tr_b16 v[156:157], v3 offset:15360
    ds_read_b64_tr_b16 v[158:159], v3 offset:15488
    ds_read_b64_tr_b16 v[160:161], v3 offset:16384
    ds_read_b64_tr_b16 v[162:163], v3 offset:16512
    ds_read_b64_tr_b16 v[164:165], v3 offset:17408
    ds_read_b64_tr_b16 v[166:167], v3 offset:17536
    s_waitcnt lgkmcnt(4)
    ds_read_b64_tr_b16 v[168:169], v3 offset:18432
    ds_read_b64_tr_b16 v[170:171], v3 offset:18560
    ds_read_b64_tr_b16 v[172:173], v3 offset:19456
    ds_read_b64_tr_b16 v[174:175], v3 offset:19584
    s_waitcnt lgkmcnt(0)
    s_add_u32 s25, s25, 20480
    v_add_u32 v3, 20480, v3
    s_add_u32 m0, s25, 0
    s_add_u32 s64, s26, 0x0
    buffer_load_dwordx4 v2, s[48:51], s64 offen lds
    s_add_u32 m0, s25, 1024
    s_add_u32 s64, s26, 0x1b000
    buffer_load_dwordx4 v2, s[48:51], s64 offen lds
    s_add_u32 m0, s25, 2048
    s_add_u32 s64, s26, 0x36000
    buffer_load_dwordx4 v2, s[48:51], s64 offen lds
    s_add_u32 m0, s25, 3072
    s_add_u32 s64, s26, 0x51000
    buffer_load_dwordx4 v2, s[48:51], s64 offen lds
    s_add_u32 m0, s25, 4096
    s_add_u32 s64, s26, 0x6c000
    buffer_load_dwordx4 v2, s[48:51], s64 offen lds
    s_add_u32 m0, s25, 5120
    s_add_u32 s64, s26, 0x87000
    buffer_load_dwordx4 v2, s[48:51], s64 offen lds
    s_add_u32 m0, s25, 6144
    s_add_u32 s64, s26, 0xa2000
    buffer_load_dwordx4 v2, s[48:51], s64 offen lds
    s_add_u32 m0, s25, 7168
    s_add_u32 s64, s26, 0xbd000
    buffer_load_dwordx4 v2, s[48:51], s64 offen lds
    s_add_u32 m0, s25, 8192
    s_add_u32 s64, s26, 0xd8000
    buffer_load_dwordx4 v2, s[48:51], s64 offen lds
    s_add_u32 m0, s25, 9216
    s_add_u32 s64, s26, 0xf3000
    buffer_load_dwordx4 v2, s[48:51], s64 offen lds
    s_add_u32 m0, s25, 10240
    s_add_u32 s64, s26, 0x10e000
    buffer_load_dwordx4 v2, s[48:51], s64 offen lds
    s_add_u32 m0, s25, 11264
    s_add_u32 s64, s26, 0x129000
    buffer_load_dwordx4 v2, s[48:51], s64 offen lds
    s_add_u32 m0, s25, 12288
    s_add_u32 s64, s26, 0x144000
    buffer_load_dwordx4 v2, s[48:51], s64 offen lds
    s_add_u32 m0, s25, 13312
    s_add_u32 s64, s26, 0x15f000
    buffer_load_dwordx4 v2, s[48:51], s64 offen lds
    s_add_u32 m0, s25, 14336
    s_add_u32 s64, s26, 0x17a000
    buffer_load_dwordx4 v2, s[48:51], s64 offen lds
    s_add_u32 m0, s25, 15360
    s_add_u32 s64, s26, 0x195000
    buffer_load_dwordx4 v2, s[48:51], s64 offen lds
    s_add_u32 m0, s25, 16384
    s_add_u32 s64, s26, 0x1b0000
    buffer_load_dwordx4 v2, s[48:51], s64 offen lds
    s_add_u32 m0, s25, 17408
    s_add_u32 s64, s26, 0x1cb000
    buffer_load_dwordx4 v2, s[48:51], s64 offen lds
    s_add_u32 m0, s25, 18432
    s_add_u32 s64, s26, 0x1e6000
    buffer_load_dwordx4 v2, s[48:51], s64 offen lds
    s_add_u32 m0, s25, 19456
    s_add_u32 s64, s26, 0x201000
    buffer_load_dwordx4 v2, s[48:51], s64 offen lds
    s_waitcnt vmcnt(0)
    ds_read_b64_tr_b16 v[176:177], v3 offset:0
    ds_read_b64_tr_b16 v[178:179], v3 offset:128
    ds_read_b64_tr_b16 v[180:181], v3 offset:1024
    ds_read_b64_tr_b16 v[182:183], v3 offset:1152
    ds_read_b64_tr_b16 v[184:185], v3 offset:2048
    ds_read_b64_tr_b16 v[186:187], v3 offset:2176
    ds_read_b64_tr_b16 v[188:189], v3 offset:3072
    ds_read_b64_tr_b16 v[190:191], v3 offset:3200
    ds_read_b64_tr_b16 v[192:193], v3 offset:4096
    ds_read_b64_tr_b16 v[194:195], v3 offset:4224
    ds_read_b64_tr_b16 v[196:197], v3 offset:5120
    ds_read_b64_tr_b16 v[198:199], v3 offset:5248
    s_waitcnt lgkmcnt(4)
    ds_read_b64_tr_b16 v[200:201], v3 offset:6144
    ds_read_b64_tr_b16 v[202:203], v3 offset:6272
    ds_read_b64_tr_b16 v[204:205], v3 offset:7168
    ds_read_b64_tr_b16 v[206:207], v3 offset:7296
    ds_read_b64_tr_b16 v[208:209], v3 offset:8192
    ds_read_b64_tr_b16 v[210:211], v3 offset:8320
    ds_read_b64_tr_b16 v[212:213], v3 offset:9216
    ds_read_b64_tr_b16 v[214:215], v3 offset:9344
    ds_read_b64_tr_b16 v[216:217], v3 offset:10240
    ds_read_b64_tr_b16 v[218:219], v3 offset:10368
    ds_read_b64_tr_b16 v[220:221], v3 offset:11264
    ds_read_b64_tr_b16 v[222:223], v3 offset:11392
    s_waitcnt lgkmcnt(4)
    ds_read_b64_tr_b16 v[224:225], v3 offset:12288
    ds_read_b64_tr_b16 v[226:227], v3 offset:12416
    ds_read_b64_tr_b16 v[228:229], v3 offset:13312
    ds_read_b64_tr_b16 v[230:231], v3 offset:13440
    ds_read_b64_tr_b16 v[232:233], v3 offset:14336
    ds_read_b64_tr_b16 v[234:235], v3 offset:14464
    ds_read_b64_tr_b16 v[236:237], v3 offset:15360
    ds_read_b64_tr_b16 v[238:239], v3 offset:15488
    ds_read_b64_tr_b16 v[240:241], v3 offset:16384
    ds_read_b64_tr_b16 v[242:243], v3 offset:16512
    ds_read_b64_tr_b16 v[244:245], v3 offset:17408
    ds_read_b64_tr_b16 v[246:247], v3 offset:17536
    s_waitcnt lgkmcnt(4)
    ds_read_b64_tr_b16 v[248:249], v3 offset:18432
    ds_read_b64_tr_b16 v[250:251], v3 offset:18560
    ds_read_b64_tr_b16 v[252:253], v3 offset:19456
    ds_read_b64_tr_b16 v[254:255], v3 offset:19584
    s_waitcnt lgkmcnt(0)
    v_mfma_f32_16x16x32_bf16 v[8:11], v[96:99], v[16:19], 0
    v_mfma_f32_16x16x32_bf16 v[12:15], v[176:179], v[16:19], 0
    v_mfma_f32_16x16x32_bf16 v[8:11], v[100:103], v[20:23], v[8:11]
    v_mfma_f32_16x16x32_bf16 v[12:15], v[180:183], v[20:23], v[12:15]
    v_mfma_f32_16x16x32_bf16 v[8:11], v[104:107], v[24:27], v[8:11]
    v_mfma_f32_16x16x32_bf16 v[12:15], v[184:187], v[24:27], v[12:15]
    v_mfma_f32_16x16x32_bf16 v[8:11], v[108:111], v[28:31], v[8:11]
    v_mfma_f32_16x16x32_bf16 v[12:15], v[188:191], v[28:31], v[12:15]
    v_mfma_f32_16x16x32_bf16 v[8:11], v[112:115], v[32:35], v[8:11]
    v_mfma_f32_16x16x32_bf16 v[12:15], v[192:195], v[32:35], v[12:15]
    v_mfma_f32_16x16x32_bf16 v[8:11], v[116:119], v[36:39], v[8:11]
    v_mfma_f32_16x16x32_bf16 v[12:15], v[196:199], v[36:39], v[12:15]
    v_mfma_f32_16x16x32_bf16 v[8:11], v[120:123], v[40:43], v[8:11]
    v_mfma_f32_16x16x32_bf16 v[12:15], v[200:203], v[40:43], v[12:15]
    v_mfma_f32_16x16x32_bf16 v[8:11], v[124:127], v[44:47], v[8:11]
    v_mfma_f32_16x16x32_bf16 v[12:15], v[204:207], v[44:47], v[12:15]
    v_mfma_f32_16x16x32_bf16 v[8:11], v[128:131], v[48:51], v[8:11]
    v_mfma_f32_16x16x32_bf16 v[12:15], v[208:211], v[48:51], v[12:15]
    v_mfma_f32_16x16x32_bf16 v[8:11], v[132:135], v[52:55], v[8:11]
    v_mfma_f32_16x16x32_bf16 v[12:15], v[212:215], v[52:55], v[12:15]
    v_mfma_f32_16x16x32_bf16 v[8:11], v[136:139], v[56:59], v[8:11]
    v_mfma_f32_16x16x32_bf16 v[12:15], v[216:219], v[56:59], v[12:15]
    v_mfma_f32_16x16x32_bf16 v[8:11], v[140:143], v[60:63], v[8:11]
    v_mfma_f32_16x16x32_bf16 v[12:15], v[220:223], v[60:63], v[12:15]
    v_mfma_f32_16x16x32_bf16 v[8:11], v[144:147], v[64:67], v[8:11]
    v_mfma_f32_16x16x32_bf16 v[12:15], v[224:227], v[64:67], v[12:15]
    v_mfma_f32_16x16x32_bf16 v[8:11], v[148:151], v[68:71], v[8:11]
    v_mfma_f32_16x16x32_bf16 v[12:15], v[228:231], v[68:71], v[12:15]
    v_mfma_f32_16x16x32_bf16 v[8:11], v[152:155], v[72:75], v[8:11]
    v_mfma_f32_16x16x32_bf16 v[12:15], v[232:235], v[72:75], v[12:15]
    v_mfma_f32_16x16x32_bf16 v[8:11], v[156:159], v[76:79], v[8:11]
    v_mfma_f32_16x16x32_bf16 v[12:15], v[236:239], v[76:79], v[12:15]
    v_mfma_f32_16x16x32_bf16 v[8:11], v[160:163], v[80:83], v[8:11]
    v_mfma_f32_16x16x32_bf16 v[12:15], v[240:243], v[80:83], v[12:15]
    v_mfma_f32_16x16x32_bf16 v[8:11], v[164:167], v[84:87], v[8:11]
    v_mfma_f32_16x16x32_bf16 v[12:15], v[244:247], v[84:87], v[12:15]
    v_mfma_f32_16x16x32_bf16 v[8:11], v[168:171], v[88:91], v[8:11]
    v_mfma_f32_16x16x32_bf16 v[12:15], v[248:251], v[88:91], v[12:15]
    v_mfma_f32_16x16x32_bf16 v[8:11], v[172:175], v[92:95], v[8:11]
    v_mfma_f32_16x16x32_bf16 v[12:15], v[252:255], v[92:95], v[12:15]
    s_nop 7
    v_cvt_pk_bf16_f32 v8, v8, v8
    v_lshlrev_b32 v8, 16, v8
    v_cvt_pk_bf16_f32 v12, v12, v12
    v_lshlrev_b32 v12, 16, v12
    v_mul_f32 v16, 0xbfb8aa3b, v8
    v_exp_f32 v16, v16
    s_nop 0
    v_add_f32 v16, 1.0, v16
    v_rcp_f32 v16, v16
    s_nop 0
    v_mul_f32 v8, v8, v16
    v_cvt_pk_bf16_f32 v8, v8, v8
    v_lshlrev_b32 v8, 16, v8
    v_mul_f32 v8, v8, v12
    v_cvt_pk_bf16_f32 v9, v9, v9
    v_lshlrev_b32 v9, 16, v9
    v_cvt_pk_bf16_f32 v13, v13, v13
    v_lshlrev_b32 v13, 16, v13
    v_mul_f32 v17, 0xbfb8aa3b, v9
    v_exp_f32 v17, v17
    s_nop 0
    v_add_f32 v17, 1.0, v17
    v_rcp_f32 v17, v17
    s_nop 0
    v_mul_f32 v9, v9, v17
    v_cvt_pk_bf16_f32 v9, v9, v9
    v_lshlrev_b32 v9, 16, v9
    v_mul_f32 v9, v9, v13
    v_cvt_pk_bf16_f32 v10, v10, v10
    v_lshlrev_b32 v10, 16, v10
    v_cvt_pk_bf16_f32 v14, v14, v14
    v_lshlrev_b32 v14, 16, v14
    v_mul_f32 v18, 0xbfb8aa3b, v10
    v_exp_f32 v18, v18
    s_nop 0
    v_add_f32 v18, 1.0, v18
    v_rcp_f32 v18, v18
    s_nop 0
    v_mul_f32 v10, v10, v18
    v_cvt_pk_bf16_f32 v10, v10, v10
    v_lshlrev_b32 v10, 16, v10
    v_mul_f32 v10, v10, v14
    v_cvt_pk_bf16_f32 v11, v11, v11
    v_lshlrev_b32 v11, 16, v11
    v_cvt_pk_bf16_f32 v15, v15, v15
    v_lshlrev_b32 v15, 16, v15
    v_mul_f32 v19, 0xbfb8aa3b, v11
    v_exp_f32 v19, v19
    s_nop 0
    v_add_f32 v19, 1.0, v19
    v_rcp_f32 v19, v19
    s_nop 0
    v_mul_f32 v11, v11, v19
    v_cvt_pk_bf16_f32 v11, v11, v11
    v_lshlrev_b32 v11, 16, v11
    v_mul_f32 v11, v11, v15
    v_cvt_pk_bf16_f32 v16, v8, v9
    v_cvt_pk_bf16_f32 v17, v10, v11
    s_lshr_b32 s65, s24, 1
    s_lshl_b32 s65, s65, 10
    s_and_b32 s66, s24, 1
    s_lshl_b32 s66, s66, 3
    s_add_u32 s65, s65, s66
    s_add_u32 s65, s65, 0x5401000
    v_lshlrev_b32 v4, 4, v0
    buffer_store_dwordx2 v[16:17], v4, s[4:7], s65 offen sc1
    s_waitcnt vmcnt(0)
    v_mov_b32 v7, 1
    v_mov_b32 v8, 0
    s_mov_b32 s64, 0x298080
    s_mov_b64 exec, 1
    buffer_atomic_add v7, v8, s[4:7], s64 offen sc1
    s_mov_b64 exec, -1
H_A1:
    v_mbcnt_lo_u32_b32 v0, -1, 0
    v_mbcnt_hi_u32_b32 v0, -1, v0
    s_mov_b32 s29, 0
    v_lshlrev_b32 v1, 4, v0
    v_lshrrev_b32 v5, 4, v0
    v_lshlrev_b32 v2, 7, v5
    v_and_b32 v5, 7, v0
    v_lshl_add_u32 v2, v5, 4, v2
    v_bfe_u32 v5, v0, 4, 1
    v_lshlrev_b32 v3, 7, v5
    v_and_b32 v5, 15, v0
    v_lshl_add_u32 v3, v5, 3, v3
    s_mov_b32 s34, 0x3e0293ee
    s_mov_b32 s35, 0x3e0293ee
    s_mov_b32 s36, -1
    s_mov_b32 s37, 0
    v_lshrrev_b32 v5, 4, v0
    v_lshlrev_b32 v5, 2, v5
    v_and_b32 v6, 15, v0
    v_add_u32 v7, 0, v5
    v_cmp_le_u32 s[38:39], v7, v6
    v_add_u32 v7, 1, v5
    v_cmp_le_u32 s[40:41], v7, v6
    v_add_u32 v7, 2, v5
    v_cmp_le_u32 s[42:43], v7, v6
    v_add_u32 v7, 3, v5
    v_cmp_le_u32 s[44:45], v7, v6
    v_mov_b32 v248, 0x3f803f80
    v_mov_b32 v249, 0x3f803f80
    v_mov_b32 v250, 0x3f803f80
    v_mov_b32 v251, 0x3f803f80
    s_lshl_b32 s24, s12, 2
    s_add_u32 s24, s24, s14
    s_add_u32 s24, s24, 8
    s_mov_b32 s25, 1
AT1_LOOP:
    s_lshl_b32 s64, s24, 5
    s_add_u32 s64, s64, s13
    s_lshl_b32 s26, s64, 13
    s_add_u32 s26, s26, 0x3400000
    s_lshl_b32 s27, s64, 14
    s_add_u32 s27, s27, 0x1400000
    s_lshl_b32 s65, s64, 11
    s_add_u32 s30, s65, 0x640000
    s_add_u32 s31, s65, 0xa40000
    s_lshl_b32 s33, s64, 2
    s_add_u32 s33, s33, 0x296000
    s_lshl_b32 s32, s24, 18
    s_lshl_b32 s65, s13, 12
    s_add_u32 s32, s32, s65
    s_add_u32 s32, s32, 0x4400000
    s_lshr_b32 s65, s24, 2
    s_lshl_b32 s65, s65, 9
    s_lshl_b32 s66, s13, 4
    s_add_u32 s65, s65, s66
    s_add_u32 s65, s65, 0x291000
    s_lshr_b32 s66, s24, 1
    s_lshl_b32 s66, s66, 8
    s_lshl_b32 s64, s13, 3
    s_add_u32 s66, s66, s64
    s_add_u32 s66, s66, 0x293ff4
    v_lshlrev_b32 v5, 2, v0
    v_mov_b32 v6, s65
    v_mov_b32 v7, s66
    v_cmp_gt_u32 vcc, 3, v0
    s_nop 1
    v_cndmask_b32 v6, v7, v6, vcc
    v_add_u32 v4, v5, v6
    s_mov_b32 s64, 0
    s_mov_b64 exec, 7
AT1_F_137:
    buffer_load_dword v5, v4, s[4:7], s64 offen sc1
    s_add_u32 s29, s29, 1
    s_waitcnt vmcnt(0)
    v_cmp_eq_u32 vcc, 0, v5
    s_cbranch_vccz AT1_FD_138
    s_cmp_gt_u32 s29, 262144
    s_cbranch_scc1 AT1_FD_138
    s_sleep 4
    s_branch AT1_F_137
AT1_FD_138:
    s_mov_b64 exec, -1
    buffer_load_dwordx4 v[16:19], v1, s[4:7], s26 offen offset:0
    buffer_load_dwordx4 v[20:23], v1, s[4:7], s26 offen offset:1024
    buffer_load_dwordx4 v[24:27], v1, s[4:7], s26 offen offset:2048
    buffer_load_dwordx4 v[28:31], v1, s[4:7], s26 offen offset:3072
    s_add_u32 s26, s26, 4096
    buffer_load_dwordx4 v[32:35], v1, s[4:7], s26 offen offset:0
    buffer_load_dwordx4 v[36:39], v1, s[4:7], s26 offen offset:1024
    buffer_load_dwordx4 v[40:43], v1, s[4:7], s26 offen offset:2048
    buffer_load_dwordx4 v[44:47], v1, s[4:7], s26 offen offset:3072
    buffer_load_dwordx4 v[48:51], v1, s[4:7], s27 offen offset:0
    buffer_load_dwordx4 v[52:55], v1, s[4:7], s27 offen offset:1024
    buffer_load_dwordx4 v[56:59], v1, s[4:7], s27 offen offset:2048
    buffer_load_dwordx4 v[60:63], v1, s[4:7], s27 offen offset:3072
    s_add_u32 s27, s27, 4096
    buffer_load_dwordx4 v[64:67], v1, s[4:7], s27 offen offset:0
    buffer_load_dwordx4 v[68:71], v1, s[4:7], s27 offen offset:1024
    buffer_load_dwordx4 v[72:75], v1, s[4:7], s27 offen offset:2048
    buffer_load_dwordx4 v[76:79], v1, s[4:7], s27 offen offset:3072
    s_add_u32 s27, s27, 4096
    buffer_load_dwordx4 v[80:83], v1, s[4:7], s27 offen offset:0
    buffer_load_dwordx4 v[84:87], v1, s[4:7], s27 offen offset:1024
    buffer_load_dwordx4 v[88:91], v1, s[4:7], s27 offen offset:2048
    buffer_load_dwordx4 v[92:95], v1, s[4:7], s27 offen offset:3072
    s_add_u32 s27, s27, 4096
    buffer_load_dwordx4 v[96:99], v1, s[4:7], s27 offen offset:0
    buffer_load_dwordx4 v[100:103], v1, s[4:7], s27 offen offset:1024
    buffer_load_dwordx4 v[104:107], v1, s[4:7], s27 offen offset:2048
    buffer_load_dwordx4 v[108:111], v1, s[4:7], s27 offen offset:3072
    s_mov_b64 exec, 0x18
AT1_G_139:
    buffer_load_dword v5, v4, s[4:7], s64 offen sc1
    s_add_u32 s29, s29, 1
    s_waitcnt vmcnt(0)
    v_cmp_eq_u32 vcc, 0, v5
    s_cbranch_vccz AT1_GD_140
    s_cmp_gt_u32 s29, 262144
    s_cbranch_scc1 AT1_GD_140
    s_sleep 4
    s_branch AT1_G_139
AT1_GD_140:
    s_mov_b64 exec, -1
    buffer_load_dwordx4 v[112:115], v2, s[4:7], s30 offen offset:0
    buffer_load_dwordx4 v[116:119], v2, s[4:7], s30 offen offset:512
    buffer_load_dwordx4 v[120:123], v2, s[4:7], s30 offen offset:1024
    buffer_load_dwordx4 v[124:127], v2, s[4:7], s30 offen offset:1536
    buffer_load_dwordx2 v[128:129], v3, s[4:7], s31 offen offset:0
    buffer_load_dwordx2 v[130:131], v3, s[4:7], s31 offen offset:256
    buffer_load_dwordx2 v[132:133], v3, s[4:7], s31 offen offset:512
    buffer_load_dwordx2 v[134:135], v3, s[4:7], s31 offen offset:768
    buffer_load_dwordx2 v[136:137], v3, s[4:7], s31 offen offset:1024
    buffer_load_dwordx2 v[138:139], v3, s[4:7], s31 offen offset:1280
    buffer_load_dwordx2 v[140:141], v3, s[4:7], s31 offen offset:1536
    buffer_load_dwordx2 v[142:143], v3, s[4:7], s31 offen offset:1792
    v_mfma_f32_16x16x32_bf16 v[148:151], v[48:51], v[16:19], 0
    v_mfma_f32_16x16x32_bf16 v[156:159], v[48:51], v[32:35], 0
    v_mfma_f32_16x16x32_bf16 v[160:163], v[64:67], v[32:35], 0
    v_mfma_f32_16x16x32_bf16 v[148:151], v[52:55], v[20:23], v[148:151]
    v_mfma_f32_16x16x32_bf16 v[156:159], v[52:55], v[36:39], v[156:159]
    v_mfma_f32_16x16x32_bf16 v[160:163], v[68:71], v[36:39], v[160:163]
    v_mfma_f32_16x16x32_bf16 v[148:151], v[56:59], v[24:27], v[148:151]
    v_mfma_f32_16x16x32_bf16 v[156:159], v[56:59], v[40:43], v[156:159]
    v_mfma_f32_16x16x32_bf16 v[160:163], v[72:75], v[40:43], v[160:163]
    v_mfma_f32_16x16x32_bf16 v[148:151], v[60:63], v[28:31], v[148:151]
    v_mfma_f32_16x16x32_bf16 v[156:159], v[60:63], v[44:47], v[156:159]
    v_mfma_f32_16x16x32_bf16 v[160:163], v[76:79], v[44:47], v[160:163]
    s_waitcnt vmcnt(8)
    v_mfma_f32_16x16x32_bf16 v[144:147], v[112:115], v[16:19], 0
    v_mfma_f32_16x16x32_bf16 v[152:155], v[112:115], v[32:35], 0
    v_mfma_f32_16x16x32_bf16 v[144:147], v[116:119], v[20:23], v[144:147]
    v_mfma_f32_16x16x32_bf16 v[152:155], v[116:119], v[36:39], v[152:155]
    v_mfma_f32_16x16x32_bf16 v[144:147], v[120:123], v[24:27], v[144:147]
    v_mfma_f32_16x16x32_bf16 v[152:155], v[120:123], v[40:43], v[152:155]
    v_mfma_f32_16x16x32_bf16 v[144:147], v[124:127], v[28:31], v[144:147]
    v_mfma_f32_16x16x32_bf16 v[152:155], v[124:127], v[44:47], v[152:155]
    v_mov_b32 v11, 0xff800000
    s_nop 7
    v_cndmask_b32 v148, v11, v148, s[38:39]
    v_cndmask_b32 v160, v11, v160, s[38:39]
    v_cndmask_b32 v144, v11, v144, s[36:37]
    v_cndmask_b32 v152, v11, v152, s[36:37]
    v_cndmask_b32 v149, v11, v149, s[40:41]
    v_cndmask_b32 v161, v11, v161, s[40:41]
    v_cndmask_b32 v145, v11, v145, s[36:37]
    v_cndmask_b32 v153, v11, v153, s[36:37]
    v_cndmask_b32 v150, v11, v150, s[42:43]
    v_cndmask_b32 v162, v11, v162, s[42:43]
    v_cndmask_b32 v146, v11, v146, s[36:37]
    v_cndmask_b32 v154, v11, v154, s[36:37]
    v_cndmask_b32 v151, v11, v151, s[44:45]
    v_cndmask_b32 v163, v11, v163, s[44:45]
    v_cndmask_b32 v147, v11, v147, s[36:37]
    v_cndmask_b32 v155, v11, v155, s[36:37]
    v_max3_f32 v8, v144, v145, v146
    v_max3_f32 v8, v8, v147, v148
    v_max3_f32 v8, v8, v149, v150
    v_max_f32 v8, v8, v151
    v_mov_b32 v9, v8
    s_nop 1
    v_permlane16_swap_b32 v8, v9
    v_max_f32 v8, v8, v9
    v_mov_b32 v9, v8
    s_nop 1
    v_permlane32_swap_b32 v8, v9
    v_max_f32 v8, v8, v9
    v_mul_f32 v8, s34, v8
    v_fma_f32 v144, v144, s34, -v8
    v_fma_f32 v145, v145, s34, -v8
    v_fma_f32 v146, v146, s34, -v8
    v_fma_f32 v147, v147, s34, -v8
    v_fma_f32 v148, v148, s34, -v8
    v_fma_f32 v149, v149, s34, -v8
    v_fma_f32 v150, v150, s34, -v8
    v_fma_f32 v151, v151, s34, -v8
    v_exp_f32 v144, v144
    v_exp_f32 v145, v145
    v_exp_f32 v146, v146
    v_exp_f32 v147, v147
    v_exp_f32 v148, v148
    v_exp_f32 v149, v149
    v_exp_f32 v150, v150
    v_exp_f32 v151, v151
    s_nop 0
    v_cvt_pk_bf16_f32 v164, v148, v149
    v_cvt_pk_bf16_f32 v165, v150, v151
    v_mov_b32 v166, 0
    v_mov_b32 v167, 0
    v_cvt_pk_bf16_f32 v168, v144, v145
    v_cvt_pk_bf16_f32 v169, v146, v147
    v_max3_f32 v8, v152, v153, v154
    v_max3_f32 v8, v8, v155, v156
    v_max3_f32 v8, v8, v157, v158
    v_max3_f32 v8, v8, v159, v160
    v_max3_f32 v8, v8, v161, v162
    v_max_f32 v8, v8, v163
    v_mov_b32 v9, v8
    s_nop 1
    v_permlane16_swap_b32 v8, v9
    v_max_f32 v8, v8, v9
    v_mov_b32 v9, v8
    s_nop 1
    v_permlane32_swap_b32 v8, v9
    v_max_f32 v8, v8, v9
    v_mul_f32 v8, s34, v8
    v_fma_f32 v152, v152, s34, -v8
    v_fma_f32 v153, v153, s34, -v8
    v_fma_f32 v154, v154, s34, -v8
    v_fma_f32 v155, v155, s34, -v8
    v_fma_f32 v156, v156, s34, -v8
    v_fma_f32 v157, v157, s34, -v8
    v_fma_f32 v158, v158, s34, -v8
    v_fma_f32 v159, v159, s34, -v8
    v_fma_f32 v160, v160, s34, -v8
    v_fma_f32 v161, v161, s34, -v8
    v_fma_f32 v162, v162, s34, -v8
    v_fma_f32 v163, v163, s34, -v8
    v_exp_f32 v152, v152
    v_exp_f32 v153, v153
    v_exp_f32 v154, v154
    v_exp_f32 v155, v155
    v_exp_f32 v156, v156
    v_exp_f32 v157, v157
    v_exp_f32 v158, v158
    v_exp_f32 v159, v159
    v_exp_f32 v160, v160
    v_exp_f32 v161, v161
    v_exp_f32 v162, v162
    v_exp_f32 v163, v163
    s_nop 0
    v_cvt_pk_bf16_f32 v170, v156, v157
    v_cvt_pk_bf16_f32 v171, v158, v159
    v_cvt_pk_bf16_f32 v172, v160, v161
    v_cvt_pk_bf16_f32 v173, v162, v163
    v_cvt_pk_bf16_f32 v174, v152, v153
    v_cvt_pk_bf16_f32 v175, v154, v155
    s_waitcnt vmcnt(0)
    v_mfma_f32_16x16x32_bf16 v[240:243], v[248:251], v[164:167], 0
    v_mfma_f32_16x16x32_bf16 v[244:247], v[248:251], v[170:173], 0
    v_mfma_f32_16x16x32_bf16 v[176:179], v[80:83], v[164:167], 0
    v_mfma_f32_16x16x32_bf16 v[180:183], v[80:83], v[170:173], 0
    v_mfma_f32_16x16x32_bf16 v[184:187], v[84:87], v[164:167], 0
    v_mfma_f32_16x16x32_bf16 v[188:191], v[84:87], v[170:173], 0
    v_mfma_f32_16x16x32_bf16 v[192:195], v[88:91], v[164:167], 0
    v_mfma_f32_16x16x32_bf16 v[196:199], v[88:91], v[170:173], 0
    v_mfma_f32_16x16x32_bf16 v[200:203], v[92:95], v[164:167], 0
    v_mfma_f32_16x16x32_bf16 v[204:207], v[92:95], v[170:173], 0
    v_mfma_f32_16x16x32_bf16 v[208:211], v[96:99], v[164:167], 0
    v_mfma_f32_16x16x32_bf16 v[212:215], v[96:99], v[170:173], 0
    v_mfma_f32_16x16x32_bf16 v[216:219], v[100:103], v[164:167], 0
    v_mfma_f32_16x16x32_bf16 v[220:223], v[100:103], v[170:173], 0
    v_mfma_f32_16x16x32_bf16 v[224:227], v[104:107], v[164:167], 0
    v_mfma_f32_16x16x32_bf16 v[228:231], v[104:107], v[170:173], 0
    v_mfma_f32_16x16x32_bf16 v[232:235], v[108:111], v[164:167], 0
    v_mfma_f32_16x16x32_bf16 v[236:239], v[108:111], v[170:173], 0
    v_mfma_f32_16x16x16_bf16 v[240:243], v[248:249], v[168:169], v[240:243]
    v_mfma_f32_16x16x16_bf16 v[244:247], v[248:249], v[174:175], v[244:247]
    v_mfma_f32_16x16x16_bf16 v[176:179], v[128:129], v[168:169], v[176:179]
    v_mfma_f32_16x16x16_bf16 v[180:183], v[128:129], v[174:175], v[180:183]
    v_mfma_f32_16x16x16_bf16 v[184:187], v[130:131], v[168:169], v[184:187]
    v_mfma_f32_16x16x16_bf16 v[188:191], v[130:131], v[174:175], v[188:191]
    v_mfma_f32_16x16x16_bf16 v[192:195], v[132:133], v[168:169], v[192:195]
    v_mfma_f32_16x16x16_bf16 v[196:199], v[132:133], v[174:175], v[196:199]
    v_mfma_f32_16x16x16_bf16 v[200:203], v[134:135], v[168:169], v[200:203]
    v_mfma_f32_16x16x16_bf16 v[204:207], v[134:135], v[174:175], v[204:207]
    v_mfma_f32_16x16x16_bf16 v[208:211], v[136:137], v[168:169], v[208:211]
    v_mfma_f32_16x16x16_bf16 v[212:215], v[136:137], v[174:175], v[212:215]
    v_mfma_f32_16x16x16_bf16 v[216:219], v[138:139], v[168:169], v[216:219]
    v_mfma_f32_16x16x16_bf16 v[220:223], v[138:139], v[174:175], v[220:223]
    v_mfma_f32_16x16x16_bf16 v[224:227], v[140:141], v[168:169], v[224:227]
    v_mfma_f32_16x16x16_bf16 v[228:231], v[140:141], v[174:175], v[228:231]
    v_mfma_f32_16x16x16_bf16 v[232:235], v[142:143], v[168:169], v[232:235]
    v_mfma_f32_16x16x16_bf16 v[236:239], v[142:143], v[174:175], v[236:239]
    v_rcp_f32 v8, v240
    v_rcp_f32 v9, v244
    s_nop 7
    v_mul_f32 v176, v176, v8
    v_mul_f32 v177, v177, v8
    v_mul_f32 v178, v178, v8
    v_mul_f32 v179, v179, v8
    v_cvt_pk_bf16_f32 v16, v176, v177
    v_cvt_pk_bf16_f32 v17, v178, v179
    v_mul_f32 v184, v184, v8
    v_mul_f32 v185, v185, v8
    v_mul_f32 v186, v186, v8
    v_mul_f32 v187, v187, v8
    v_cvt_pk_bf16_f32 v18, v184, v185
    v_cvt_pk_bf16_f32 v19, v186, v187
    s_add_u32 s64, s32, 0x0
    buffer_store_dwordx4 v[16:19], v1, s[4:7], s64 offen offset:0 sc1
    v_mul_f32 v192, v192, v8
    v_mul_f32 v193, v193, v8
    v_mul_f32 v194, v194, v8
    v_mul_f32 v195, v195, v8
    v_cvt_pk_bf16_f32 v20, v192, v193
    v_cvt_pk_bf16_f32 v21, v194, v195
    v_mul_f32 v200, v200, v8
    v_mul_f32 v201, v201, v8
    v_mul_f32 v202, v202, v8
    v_mul_f32 v203, v203, v8
    v_cvt_pk_bf16_f32 v22, v200, v201
    v_cvt_pk_bf16_f32 v23, v202, v203
    s_add_u32 s64, s32, 0x0
    buffer_store_dwordx4 v[20:23], v1, s[4:7], s64 offen offset:1024 sc1
    v_mul_f32 v208, v208, v8
    v_mul_f32 v209, v209, v8
    v_mul_f32 v210, v210, v8
    v_mul_f32 v211, v211, v8
    v_cvt_pk_bf16_f32 v24, v208, v209
    v_cvt_pk_bf16_f32 v25, v210, v211
    v_mul_f32 v216, v216, v8
    v_mul_f32 v217, v217, v8
    v_mul_f32 v218, v218, v8
    v_mul_f32 v219, v219, v8
    v_cvt_pk_bf16_f32 v26, v216, v217
    v_cvt_pk_bf16_f32 v27, v218, v219
    s_add_u32 s64, s32, 0x0
    buffer_store_dwordx4 v[24:27], v1, s[4:7], s64 offen offset:2048 sc1
    v_mul_f32 v224, v224, v8
    v_mul_f32 v225, v225, v8
    v_mul_f32 v226, v226, v8
    v_mul_f32 v227, v227, v8
    v_cvt_pk_bf16_f32 v28, v224, v225
    v_cvt_pk_bf16_f32 v29, v226, v227
    v_mul_f32 v232, v232, v8
    v_mul_f32 v233, v233, v8
    v_mul_f32 v234, v234, v8
    v_mul_f32 v235, v235, v8
    v_cvt_pk_bf16_f32 v30, v232, v233
    v_cvt_pk_bf16_f32 v31, v234, v235
    s_add_u32 s64, s32, 0x0
    buffer_store_dwordx4 v[28:31], v1, s[4:7], s64 offen offset:3072 sc1
    v_mul_f32 v180, v180, v9
    v_mul_f32 v181, v181, v9
    v_mul_f32 v182, v182, v9
    v_mul_f32 v183, v183, v9
    v_cvt_pk_bf16_f32 v32, v180, v181
    v_cvt_pk_bf16_f32 v33, v182, v183
    v_mul_f32 v188, v188, v9
    v_mul_f32 v189, v189, v9
    v_mul_f32 v190, v190, v9
    v_mul_f32 v191, v191, v9
    v_cvt_pk_bf16_f32 v34, v188, v189
    v_cvt_pk_bf16_f32 v35, v190, v191
    s_add_u32 s64, s32, 0x20000
    buffer_store_dwordx4 v[32:35], v1, s[4:7], s64 offen offset:0 sc1
    v_mul_f32 v196, v196, v9
    v_mul_f32 v197, v197, v9
    v_mul_f32 v198, v198, v9
    v_mul_f32 v199, v199, v9
    v_cvt_pk_bf16_f32 v36, v196, v197
    v_cvt_pk_bf16_f32 v37, v198, v199
    v_mul_f32 v204, v204, v9
    v_mul_f32 v205, v205, v9
    v_mul_f32 v206, v206, v9
    v_mul_f32 v207, v207, v9
    v_cvt_pk_bf16_f32 v38, v204, v205
    v_cvt_pk_bf16_f32 v39, v206, v207
    s_add_u32 s64, s32, 0x20000
    buffer_store_dwordx4 v[36:39], v1, s[4:7], s64 offen offset:1024 sc1
    v_mul_f32 v212, v212, v9
    v_mul_f32 v213, v213, v9
    v_mul_f32 v214, v214, v9
    v_mul_f32 v215, v215, v9
    v_cvt_pk_bf16_f32 v40, v212, v213
    v_cvt_pk_bf16_f32 v41, v214, v215
    v_mul_f32 v220, v220, v9
    v_mul_f32 v221, v221, v9
    v_mul_f32 v222, v222, v9
    v_mul_f32 v223, v223, v9
    v_cvt_pk_bf16_f32 v42, v220, v221
    v_cvt_pk_bf16_f32 v43, v222, v223
    s_add_u32 s64, s32, 0x20000
    buffer_store_dwordx4 v[40:43], v1, s[4:7], s64 offen offset:2048 sc1
    v_mul_f32 v228, v228, v9
    v_mul_f32 v229, v229, v9
    v_mul_f32 v230, v230, v9
    v_mul_f32 v231, v231, v9
    v_cvt_pk_bf16_f32 v44, v228, v229
    v_cvt_pk_bf16_f32 v45, v230, v231
    v_mul_f32 v236, v236, v9
    v_mul_f32 v237, v237, v9
    v_mul_f32 v238, v238, v9
    v_mul_f32 v239, v239, v9
    v_cvt_pk_bf16_f32 v46, v236, v237
    v_cvt_pk_bf16_f32 v47, v238, v239
    s_add_u32 s64, s32, 0x20000
    buffer_store_dwordx4 v[44:47], v1, s[4:7], s64 offen offset:3072 sc1
    s_waitcnt vmcnt(0)
    v_mov_b32 v7, 1
    v_mov_b32 v8, 0
    s_mov_b64 exec, 1
    buffer_store_dword v7, v8, s[4:7], s33 offen sc1
    s_mov_b64 exec, -1
    s_add_u32 s24, s24, 8
    s_add_u32 s25, s25, 1
    s_cmp_lt_u32 s25, 2
    s_cbranch_scc1 AT1_LOOP
    s_lshl_b32 s70, s13, 1
    s_add_u32 s70, s70, s12
    s_load_dwordx2 s[44:45], s[0:1], 72
    s_mov_b32 s46, 0x21c000
    s_mov_b32 s47, 0x00020000
    s_load_dwordx2 s[48:49], s[0:1], 80
    s_mov_b32 s50, 0x21c000
    s_mov_b32 s51, 0x00020000
    s_load_dwordx2 s[52:53], s[0:1], 88
    s_mov_b32 s54, 0x21c000
    s_mov_b32 s55, 0x00020000
    s_mov_b32 s29, 0
    s_waitcnt lgkmcnt(0)
    v_mbcnt_lo_u32_b32 v0, -1, 0
    v_mbcnt_hi_u32_b32 v0, -1, v0
    s_cmp_lg_u32 s14, 0
    s_cbranch_scc1 H_ATT
    s_cmp_ge_u32 s70, 40
    s_cbranch_scc1 H_ATT
    s_mov_b32 s24, s70
    v_mov_b32 v8, 0
    s_mov_b32 s64, 0x298080
F2W_141:
    buffer_load_dword v7, v8, s[4:7], s64 offen sc1
    s_add_u32 s29, s29, 1
    s_waitcnt vmcnt(0)
    v_mov_b32 v9, 108
    v_cmp_gt_u32 vcc, v9, v7
    s_cbranch_vccz F2WD_142
    s_cmp_gt_u32 s29, 262144
    s_cbranch_scc1 F2WD_142
    s_sleep 8
    s_branch F2W_141
F2WD_142:
    s_mov_b32 s25, 0
    v_lshrrev_b32 v7, 1, v0
    v_mul_u32_u24 v2, 1280, v7
    v_and_b32 v7, 1, v0
    v_lshl_add_u32 v2, v7, 4, v2
    v_lshrrev_b32 v7, 4, v0
    v_lshlrev_b32 v3, 7, v7
    v_bfe_u32 v7, v0, 2, 2
    v_lshl_add_u32 v3, v7, 5, v3
    v_and_b32 v7, 3, v0
    v_lshl_add_u32 v3, v7, 3, v3
    v_add_u32 v3, s25, v3
    v_lshlrev_b32 v4, 4, v0
    s_mov_b32 s65, 0x5401000
    buffer_load_dwordx4 v[16:19], v4, s[4:7], s65 offen offset:0 sc1
    buffer_load_dwordx4 v[20:23], v4, s[4:7], s65 offen offset:1024 sc1
    buffer_load_dwordx4 v[24:27], v4, s[4:7], s65 offen offset:2048 sc1
    buffer_load_dwordx4 v[28:31], v4, s[4:7], s65 offen offset:3072 sc1
    s_add_u32 s65, s65, 4096
    buffer_load_dwordx4 v[32:35], v4, s[4:7], s65 offen offset:0 sc1
    buffer_load_dwordx4 v[36:39], v4, s[4:7], s65 offen offset:1024 sc1
    buffer_load_dwordx4 v[40:43], v4, s[4:7], s65 offen offset:2048 sc1
    buffer_load_dwordx4 v[44:47], v4, s[4:7], s65 offen offset:3072 sc1
    s_add_u32 s65, s65, 4096
    buffer_load_dwordx4 v[48:51], v4, s[4:7], s65 offen offset:0 sc1
    buffer_load_dwordx4 v[52:55], v4, s[4:7], s65 offen offset:1024 sc1
    buffer_load_dwordx4 v[56:59], v4, s[4:7], s65 offen offset:2048 sc1
    buffer_load_dwordx4 v[60:63], v4, s[4:7], s65 offen offset:3072 sc1
    s_add_u32 s65, s65, 4096
    buffer_load_dwordx4 v[64:67], v4, s[4:7], s65 offen offset:0 sc1
    buffer_load_dwordx4 v[68:71], v4, s[4:7], s65 offen offset:1024 sc1
    buffer_load_dwordx4 v[72:75], v4, s[4:7], s65 offen offset:2048 sc1
    buffer_load_dwordx4 v[76:79], v4, s[4:7], s65 offen offset:3072 sc1
    s_add_u32 s65, s65, 4096
    buffer_load_dwordx4 v[80:83], v4, s[4:7], s65 offen offset:0 sc1
    buffer_load_dwordx4 v[84:87], v4, s[4:7], s65 offen offset:1024 sc1
    buffer_load_dwordx4 v[88:91], v4, s[4:7], s65 offen offset:2048 sc1
    buffer_load_dwordx4 v[92:95], v4, s[4:7], s65 offen offset:3072 sc1
    s_add_u32 s65, s65, 4096
    buffer_load_dwordx4 v[96:99], v4, s[4:7], s65 offen offset:0 sc1
    buffer_load_dwordx4 v[100:103], v4, s[4:7], s65 offen offset:1024 sc1
    buffer_load_dwordx4 v[104:107], v4, s[4:7], s65 offen offset:2048 sc1
    buffer_load_dwordx4 v[108:111], v4, s[4:7], s65 offen offset:3072 sc1
    s_add_u32 s65, s65, 4096
    buffer_load_dwordx4 v[112:115], v4, s[4:7], s65 offen offset:0 sc1
    buffer_load_dwordx4 v[116:119], v4, s[4:7], s65 offen offset:1024 sc1
    buffer_load_dwordx4 v[120:123], v4, s[4:7], s65 offen offset:2048 sc1
    buffer_load_dwordx4 v[124:127], v4, s[4:7], s65 offen offset:3072 sc1
    s_add_u32 s65, s65, 4096
    buffer_load_dwordx4 v[128:131], v4, s[4:7], s65 offen offset:0 sc1
    buffer_load_dwordx4 v[132:135], v4, s[4:7], s65 offen offset:1024 sc1
    buffer_load_dwordx4 v[136:139], v4, s[4:7], s65 offen offset:2048 sc1
    buffer_load_dwordx4 v[140:143], v4, s[4:7], s65 offen offset:3072 sc1
    s_add_u32 s65, s65, 4096
    buffer_load_dwordx4 v[144:147], v4, s[4:7], s65 offen offset:0 sc1
    buffer_load_dwordx4 v[148:151], v4, s[4:7], s65 offen offset:1024 sc1
    buffer_load_dwordx4 v[152:155], v4, s[4:7], s65 offen offset:2048 sc1
    buffer_load_dwordx4 v[156:159], v4, s[4:7], s65 offen offset:3072 sc1
    s_add_u32 s65, s65, 4096
    buffer_load_dwordx4 v[160:163], v4, s[4:7], s65 offen offset:0 sc1
    buffer_load_dwordx4 v[164:167], v4, s[4:7], s65 offen offset:1024 sc1
    buffer_load_dwordx4 v[168:171], v4, s[4:7], s65 offen offset:2048 sc1
    buffer_load_dwordx4 v[172:175], v4, s[4:7], s65 offen offset:3072 sc1
    s_add_u32 s65, s65, 4096
    buffer_load_dwordx4 v[176:179], v4, s[4:7], s65 offen offset:0 sc1
    s_waitcnt vmcnt(20)
    buffer_load_dwordx4 v[180:183], v4, s[4:7], s65 offen offset:1024 sc1
    buffer_load_dwordx4 v[184:187], v4, s[4:7], s65 offen offset:2048 sc1
    buffer_load_dwordx4 v[188:191], v4, s[4:7], s65 offen offset:3072 sc1
    s_add_u32 s65, s65, 4096
    buffer_load_dwordx4 v[192:195], v4, s[4:7], s65 offen offset:0 sc1
    buffer_load_dwordx4 v[196:199], v4, s[4:7], s65 offen offset:1024 sc1
    buffer_load_dwordx4 v[200:203], v4, s[4:7], s65 offen offset:2048 sc1
    buffer_load_dwordx4 v[204:207], v4, s[4:7], s65 offen offset:3072 sc1
    s_add_u32 s65, s65, 4096
    buffer_load_dwordx4 v[208:211], v4, s[4:7], s65 offen offset:0 sc1
    buffer_load_dwordx4 v[212:215], v4, s[4:7], s65 offen offset:1024 sc1
    buffer_load_dwordx4 v[216:219], v4, s[4:7], s65 offen offset:2048 sc1
    buffer_load_dwordx4 v[220:223], v4, s[4:7], s65 offen offset:3072 sc1
    s_add_u32 s65, s65, 4096
    buffer_load_dwordx4 v[224:227], v4, s[4:7], s65 offen offset:0 sc1
    buffer_load_dwordx4 v[228:231], v4, s[4:7], s65 offen offset:1024 sc1
    s_waitcnt vmcnt(0)
    s_lshl_b32 s26, s24, 5
    s_add_u32 m0, s25, 0
    s_add_u32 s64, s26, 0x0
    buffer_load_dwordx4 v2, s[52:55], s64 offen lds
    s_add_u32 m0, s25, 1024
    s_add_u32 s64, s26, 0xa000
    buffer_load_dwordx4 v2, s[52:55], s64 offen lds
    s_add_u32 m0, s25, 2048
    s_add_u32 s64, s26, 0x14000
    buffer_load_dwordx4 v2, s[52:55], s64 offen lds
    s_add_u32 m0, s25, 3072
    s_add_u32 s64, s26, 0x1e000
    buffer_load_dwordx4 v2, s[52:55], s64 offen lds
    s_add_u32 m0, s25, 4096
    s_add_u32 s64, s26, 0x28000
    buffer_load_dwordx4 v2, s[52:55], s64 offen lds
    s_add_u32 m0, s25, 5120
    s_add_u32 s64, s26, 0x32000
    buffer_load_dwordx4 v2, s[52:55], s64 offen lds
    s_add_u32 m0, s25, 6144
    s_add_u32 s64, s26, 0x3c000
    buffer_load_dwordx4 v2, s[52:55], s64 offen lds
    s_add_u32 m0, s25, 7168
    s_add_u32 s64, s26, 0x46000
    buffer_load_dwordx4 v2, s[52:55], s64 offen lds
    s_add_u32 m0, s25, 8192
    s_add_u32 s64, s26, 0x50000
    buffer_load_dwordx4 v2, s[52:55], s64 offen lds
    s_add_u32 m0, s25, 9216
    s_add_u32 s64, s26, 0x5a000
    buffer_load_dwordx4 v2, s[52:55], s64 offen lds
    s_add_u32 m0, s25, 10240
    s_add_u32 s64, s26, 0x64000
    buffer_load_dwordx4 v2, s[52:55], s64 offen lds
    s_add_u32 m0, s25, 11264
    s_add_u32 s64, s26, 0x6e000
    buffer_load_dwordx4 v2, s[52:55], s64 offen lds
    s_add_u32 m0, s25, 12288
    s_add_u32 s64, s26, 0x78000
    buffer_load_dwordx4 v2, s[52:55], s64 offen lds
    s_add_u32 m0, s25, 13312
    s_add_u32 s64, s26, 0x82000
    buffer_load_dwordx4 v2, s[52:55], s64 offen lds
    s_add_u32 m0, s25, 14336
    s_add_u32 s64, s26, 0x8c000
    buffer_load_dwordx4 v2, s[52:55], s64 offen lds
    s_add_u32 m0, s25, 15360
    s_add_u32 s64, s26, 0x96000
    buffer_load_dwordx4 v2, s[52:55], s64 offen lds
    s_add_u32 m0, s25, 16384
    s_add_u32 s64, s26, 0xa0000
    buffer_load_dwordx4 v2, s[52:55], s64 offen lds
    s_add_u32 m0, s25, 17408
    s_add_u32 s64, s26, 0xaa000
    buffer_load_dwordx4 v2, s[52:55], s64 offen lds
    s_add_u32 m0, s25, 18432
    s_add_u32 s64, s26, 0xb4000
    buffer_load_dwordx4 v2, s[52:55], s64 offen lds
    s_add_u32 m0, s25, 19456
    s_add_u32 s64, s26, 0xbe000
    buffer_load_dwordx4 v2, s[52:55], s64 offen lds
    s_add_u32 m0, s25, 20480
    s_add_u32 s64, s26, 0xc8000
    buffer_load_dwordx4 v2, s[52:55], s64 offen lds
    s_add_u32 m0, s25, 21504
    s_add_u32 s64, s26, 0xd2000
    buffer_load_dwordx4 v2, s[52:55], s64 offen lds
    s_add_u32 m0, s25, 22528
    s_add_u32 s64, s26, 0xdc000
    buffer_load_dwordx4 v2, s[52:55], s64 offen lds
    s_add_u32 m0, s25, 23552
    s_add_u32 s64, s26, 0xe6000
    buffer_load_dwordx4 v2, s[52:55], s64 offen lds
    s_add_u32 m0, s25, 24576
    s_add_u32 s64, s26, 0xf0000
    buffer_load_dwordx4 v2, s[52:55], s64 offen lds
    s_add_u32 m0, s25, 25600
    s_add_u32 s64, s26, 0xfa000
    buffer_load_dwordx4 v2, s[52:55], s64 offen lds
    s_add_u32 m0, s25, 26624
    s_add_u32 s64, s26, 0x104000
    buffer_load_dwordx4 v2, s[52:55], s64 offen lds
    s_add_u32 m0, s25, 27648
    s_add_u32 s64, s26, 0x10e000
    buffer_load_dwordx4 v2, s[52:55], s64 offen lds
    s_add_u32 m0, s25, 28672
    s_add_u32 s64, s26, 0x118000
    buffer_load_dwordx4 v2, s[52:55], s64 offen lds
    s_add_u32 m0, s25, 29696
    s_add_u32 s64, s26, 0x122000
    buffer_load_dwordx4 v2, s[52:55], s64 offen lds
    s_add_u32 m0, s25, 30720
    s_add_u32 s64, s26, 0x12c000
    buffer_load_dwordx4 v2, s[52:55], s64 offen lds
    s_add_u32 m0, s25, 31744
    s_add_u32 s64, s26, 0x136000
    buffer_load_dwordx4 v2, s[52:55], s64 offen lds
    s_add_u32 m0, s25, 32768
    s_add_u32 s64, s26, 0x140000
    buffer_load_dwordx4 v2, s[52:55], s64 offen lds
    s_add_u32 m0, s25, 33792
    s_add_u32 s64, s26, 0x14a000
    buffer_load_dwordx4 v2, s[52:55], s64 offen lds
    s_add_u32 m0, s25, 34816
    s_add_u32 s64, s26, 0x154000
    buffer_load_dwordx4 v2, s[52:55], s64 offen lds
    s_add_u32 m0, s25, 35840
    s_add_u32 s64, s26, 0x15e000
    buffer_load_dwordx4 v2, s[52:55], s64 offen lds
    s_add_u32 m0, s25, 36864
    s_add_u32 s64, s26, 0x168000
    buffer_load_dwordx4 v2, s[52:55], s64 offen lds
    s_add_u32 m0, s25, 37888
    s_add_u32 s64, s26, 0x172000
    buffer_load_dwordx4 v2, s[52:55], s64 offen lds
    s_add_u32 m0, s25, 38912
    s_add_u32 s64, s26, 0x17c000
    buffer_load_dwordx4 v2, s[52:55], s64 offen lds
    s_add_u32 m0, s25, 39936
    s_add_u32 s64, s26, 0x186000
    buffer_load_dwordx4 v2, s[52:55], s64 offen lds
    s_add_u32 m0, s25, 40960
    s_add_u32 s64, s26, 0x190000
    buffer_load_dwordx4 v2, s[52:55], s64 offen lds
    s_waitcnt vmcnt(20)
    s_add_u32 m0, s25, 41984
    s_add_u32 s64, s26, 0x19a000
    buffer_load_dwordx4 v2, s[52:55], s64 offen lds
    s_add_u32 m0, s25, 43008
    s_add_u32 s64, s26, 0x1a4000
    buffer_load_dwordx4 v2, s[52:55], s64 offen lds
    s_add_u32 m0, s25, 44032
    s_add_u32 s64, s26, 0x1ae000
    buffer_load_dwordx4 v2, s[52:55], s64 offen lds
    s_add_u32 m0, s25, 45056
    s_add_u32 s64, s26, 0x1b8000
    buffer_load_dwordx4 v2, s[52:55], s64 offen lds
    s_add_u32 m0, s25, 46080
    s_add_u32 s64, s26, 0x1c2000
    buffer_load_dwordx4 v2, s[52:55], s64 offen lds
    s_add_u32 m0, s25, 47104
    s_add_u32 s64, s26, 0x1cc000
    buffer_load_dwordx4 v2, s[52:55], s64 offen lds
    s_add_u32 m0, s25, 48128
    s_add_u32 s64, s26, 0x1d6000
    buffer_load_dwordx4 v2, s[52:55], s64 offen lds
    s_add_u32 m0, s25, 49152
    s_add_u32 s64, s26, 0x1e0000
    buffer_load_dwordx4 v2, s[52:55], s64 offen lds
    s_add_u32 m0, s25, 50176
    s_add_u32 s64, s26, 0x1ea000
    buffer_load_dwordx4 v2, s[52:55], s64 offen lds
    s_add_u32 m0, s25, 51200
    s_add_u32 s64, s26, 0x1f4000
    buffer_load_dwordx4 v2, s[52:55], s64 offen lds
    s_add_u32 m0, s25, 52224
    s_add_u32 s64, s26, 0x1fe000
    buffer_load_dwordx4 v2, s[52:55], s64 offen lds
    s_add_u32 m0, s25, 53248
    s_add_u32 s64, s26, 0x208000
    buffer_load_dwordx4 v2, s[52:55], s64 offen lds
    s_add_u32 m0, s25, 54272
    s_add_u32 s64, s26, 0x212000
    buffer_load_dwordx4 v2, s[52:55], s64 offen lds
    s_waitcnt vmcnt(0)
    ds_read_b64_tr_b16 v[232:233], v3 offset:0
    ds_read_b64_tr_b16 v[234:235], v3 offset:512
    s_waitcnt lgkmcnt(0)
    v_mfma_f32_16x16x32_bf16 v[8:11], v[232:235], v[16:19], 0
    ds_read_b64_tr_b16 v[236:237], v3 offset:1024
    ds_read_b64_tr_b16 v[238:239], v3 offset:1536
    s_waitcnt lgkmcnt(0)
    v_mfma_f32_16x16x32_bf16 v[8:11], v[236:239], v[20:23], v[8:11]
    ds_read_b64_tr_b16 v[240:241], v3 offset:2048
    ds_read_b64_tr_b16 v[242:243], v3 offset:2560
    s_waitcnt lgkmcnt(0)
    v_mfma_f32_16x16x32_bf16 v[8:11], v[240:243], v[24:27], v[8:11]
    ds_read_b64_tr_b16 v[244:245], v3 offset:3072
    ds_read_b64_tr_b16 v[246:247], v3 offset:3584
    s_waitcnt lgkmcnt(0)
    v_mfma_f32_16x16x32_bf16 v[8:11], v[244:247], v[28:31], v[8:11]
    ds_read_b64_tr_b16 v[232:233], v3 offset:4096
    ds_read_b64_tr_b16 v[234:235], v3 offset:4608
    s_waitcnt lgkmcnt(0)
    v_mfma_f32_16x16x32_bf16 v[8:11], v[232:235], v[32:35], v[8:11]
    ds_read_b64_tr_b16 v[236:237], v3 offset:5120
    ds_read_b64_tr_b16 v[238:239], v3 offset:5632
    s_waitcnt lgkmcnt(0)
    v_mfma_f32_16x16x32_bf16 v[8:11], v[236:239], v[36:39], v[8:11]
    ds_read_b64_tr_b16 v[240:241], v3 offset:6144
    ds_read_b64_tr_b16 v[242:243], v3 offset:6656
    s_waitcnt lgkmcnt(0)
    v_mfma_f32_16x16x32_bf16 v[8:11], v[240:243], v[40:43], v[8:11]
    ds_read_b64_tr_b16 v[244:245], v3 offset:7168
    ds_read_b64_tr_b16 v[246:247], v3 offset:7680
    s_waitcnt lgkmcnt(0)
    v_mfma_f32_16x16x32_bf16 v[8:11], v[244:247], v[44:47], v[8:11]
    ds_read_b64_tr_b16 v[232:233], v3 offset:8192
    ds_read_b64_tr_b16 v[234:235], v3 offset:8704
    s_waitcnt lgkmcnt(0)
    v_mfma_f32_16x16x32_bf16 v[8:11], v[232:235], v[48:51], v[8:11]
    ds_read_b64_tr_b16 v[236:237], v3 offset:9216
    ds_read_b64_tr_b16 v[238:239], v3 offset:9728
    s_waitcnt lgkmcnt(0)
    v_mfma_f32_16x16x32_bf16 v[8:11], v[236:239], v[52:55], v[8:11]
    ds_read_b64_tr_b16 v[240:241], v3 offset:10240
    ds_read_b64_tr_b16 v[242:243], v3 offset:10752
    s_waitcnt lgkmcnt(0)
    v_mfma_f32_16x16x32_bf16 v[8:11], v[240:243], v[56:59], v[8:11]
    ds_read_b64_tr_b16 v[244:245], v3 offset:11264
    ds_read_b64_tr_b16 v[246:247], v3 offset:11776
    s_waitcnt lgkmcnt(0)
    v_mfma_f32_16x16x32_bf16 v[8:11], v[244:247], v[60:63], v[8:11]
    ds_read_b64_tr_b16 v[232:233], v3 offset:12288
    ds_read_b64_tr_b16 v[234:235], v3 offset:12800
    s_waitcnt lgkmcnt(0)
    v_mfma_f32_16x16x32_bf16 v[8:11], v[232:235], v[64:67], v[8:11]
    ds_read_b64_tr_b16 v[236:237], v3 offset:13312
    ds_read_b64_tr_b16 v[238:239], v3 offset:13824
    s_waitcnt lgkmcnt(0)
    v_mfma_f32_16x16x32_bf16 v[8:11], v[236:239], v[68:71], v[8:11]
    ds_read_b64_tr_b16 v[240:241], v3 offset:14336
    ds_read_b64_tr_b16 v[242:243], v3 offset:14848
    s_waitcnt lgkmcnt(0)
    v_mfma_f32_16x16x32_bf16 v[8:11], v[240:243], v[72:75], v[8:11]
    ds_read_b64_tr_b16 v[244:245], v3 offset:15360
    ds_read_b64_tr_b16 v[246:247], v3 offset:15872
    s_waitcnt lgkmcnt(0)
    v_mfma_f32_16x16x32_bf16 v[8:11], v[244:247], v[76:79], v[8:11]
    ds_read_b64_tr_b16 v[232:233], v3 offset:16384
    ds_read_b64_tr_b16 v[234:235], v3 offset:16896
    s_waitcnt lgkmcnt(0)
    v_mfma_f32_16x16x32_bf16 v[8:11], v[232:235], v[80:83], v[8:11]
    ds_read_b64_tr_b16 v[236:237], v3 offset:17408
    ds_read_b64_tr_b16 v[238:239], v3 offset:17920
    s_waitcnt lgkmcnt(0)
    v_mfma_f32_16x16x32_bf16 v[8:11], v[236:239], v[84:87], v[8:11]
    ds_read_b64_tr_b16 v[240:241], v3 offset:18432
    ds_read_b64_tr_b16 v[242:243], v3 offset:18944
    s_waitcnt lgkmcnt(0)
    v_mfma_f32_16x16x32_bf16 v[8:11], v[240:243], v[88:91], v[8:11]
    ds_read_b64_tr_b16 v[244:245], v3 offset:19456
    ds_read_b64_tr_b16 v[246:247], v3 offset:19968
    s_waitcnt lgkmcnt(0)
    v_mfma_f32_16x16x32_bf16 v[8:11], v[244:247], v[92:95], v[8:11]
    ds_read_b64_tr_b16 v[232:233], v3 offset:20480
    ds_read_b64_tr_b16 v[234:235], v3 offset:20992
    s_waitcnt lgkmcnt(0)
    v_mfma_f32_16x16x32_bf16 v[8:11], v[232:235], v[96:99], v[8:11]
    ds_read_b64_tr_b16 v[236:237], v3 offset:21504
    ds_read_b64_tr_b16 v[238:239], v3 offset:22016
    s_waitcnt lgkmcnt(0)
    v_mfma_f32_16x16x32_bf16 v[8:11], v[236:239], v[100:103], v[8:11]
    ds_read_b64_tr_b16 v[240:241], v3 offset:22528
    ds_read_b64_tr_b16 v[242:243], v3 offset:23040
    s_waitcnt lgkmcnt(0)
    v_mfma_f32_16x16x32_bf16 v[8:11], v[240:243], v[104:107], v[8:11]
    ds_read_b64_tr_b16 v[244:245], v3 offset:23552
    ds_read_b64_tr_b16 v[246:247], v3 offset:24064
    s_waitcnt lgkmcnt(0)
    v_mfma_f32_16x16x32_bf16 v[8:11], v[244:247], v[108:111], v[8:11]
    ds_read_b64_tr_b16 v[232:233], v3 offset:24576
    ds_read_b64_tr_b16 v[234:235], v3 offset:25088
    s_waitcnt lgkmcnt(0)
    v_mfma_f32_16x16x32_bf16 v[8:11], v[232:235], v[112:115], v[8:11]
    ds_read_b64_tr_b16 v[236:237], v3 offset:25600
    ds_read_b64_tr_b16 v[238:239], v3 offset:26112
    s_waitcnt lgkmcnt(0)
    v_mfma_f32_16x16x32_bf16 v[8:11], v[236:239], v[116:119], v[8:11]
    ds_read_b64_tr_b16 v[240:241], v3 offset:26624
    ds_read_b64_tr_b16 v[242:243], v3 offset:27136
    s_waitcnt lgkmcnt(0)
    v_mfma_f32_16x16x32_bf16 v[8:11], v[240:243], v[120:123], v[8:11]
    ds_read_b64_tr_b16 v[244:245], v3 offset:27648
    ds_read_b64_tr_b16 v[246:247], v3 offset:28160
    s_waitcnt lgkmcnt(0)
    v_mfma_f32_16x16x32_bf16 v[8:11], v[244:247], v[124:127], v[8:11]
    ds_read_b64_tr_b16 v[232:233], v3 offset:28672
    ds_read_b64_tr_b16 v[234:235], v3 offset:29184
    s_waitcnt lgkmcnt(0)
    v_mfma_f32_16x16x32_bf16 v[8:11], v[232:235], v[128:131], v[8:11]
    ds_read_b64_tr_b16 v[236:237], v3 offset:29696
    ds_read_b64_tr_b16 v[238:239], v3 offset:30208
    s_waitcnt lgkmcnt(0)
    v_mfma_f32_16x16x32_bf16 v[8:11], v[236:239], v[132:135], v[8:11]
    ds_read_b64_tr_b16 v[240:241], v3 offset:30720
    ds_read_b64_tr_b16 v[242:243], v3 offset:31232
    s_waitcnt lgkmcnt(0)
    v_mfma_f32_16x16x32_bf16 v[8:11], v[240:243], v[136:139], v[8:11]
    ds_read_b64_tr_b16 v[244:245], v3 offset:31744
    ds_read_b64_tr_b16 v[246:247], v3 offset:32256
    s_waitcnt lgkmcnt(0)
    v_mfma_f32_16x16x32_bf16 v[8:11], v[244:247], v[140:143], v[8:11]
    ds_read_b64_tr_b16 v[232:233], v3 offset:32768
    ds_read_b64_tr_b16 v[234:235], v3 offset:33280
    s_waitcnt lgkmcnt(0)
    v_mfma_f32_16x16x32_bf16 v[8:11], v[232:235], v[144:147], v[8:11]
    ds_read_b64_tr_b16 v[236:237], v3 offset:33792
    ds_read_b64_tr_b16 v[238:239], v3 offset:34304
    s_waitcnt lgkmcnt(0)
    v_mfma_f32_16x16x32_bf16 v[8:11], v[236:239], v[148:151], v[8:11]
    ds_read_b64_tr_b16 v[240:241], v3 offset:34816
    ds_read_b64_tr_b16 v[242:243], v3 offset:35328
    s_waitcnt lgkmcnt(0)
    v_mfma_f32_16x16x32_bf16 v[8:11], v[240:243], v[152:155], v[8:11]
    ds_read_b64_tr_b16 v[244:245], v3 offset:35840
    ds_read_b64_tr_b16 v[246:247], v3 offset:36352
    s_waitcnt lgkmcnt(0)
    v_mfma_f32_16x16x32_bf16 v[8:11], v[244:247], v[156:159], v[8:11]
    ds_read_b64_tr_b16 v[232:233], v3 offset:36864
    ds_read_b64_tr_b16 v[234:235], v3 offset:37376
    s_waitcnt lgkmcnt(0)
    v_mfma_f32_16x16x32_bf16 v[8:11], v[232:235], v[160:163], v[8:11]
    ds_read_b64_tr_b16 v[236:237], v3 offset:37888
    ds_read_b64_tr_b16 v[238:239], v3 offset:38400
    s_waitcnt lgkmcnt(0)
    v_mfma_f32_16x16x32_bf16 v[8:11], v[236:239], v[164:167], v[8:11]
    ds_read_b64_tr_b16 v[240:241], v3 offset:38912
    ds_read_b64_tr_b16 v[242:243], v3 offset:39424
    s_waitcnt lgkmcnt(0)
    v_mfma_f32_16x16x32_bf16 v[8:11], v[240:243], v[168:171], v[8:11]
    ds_read_b64_tr_b16 v[244:245], v3 offset:39936
    ds_read_b64_tr_b16 v[246:247], v3 offset:40448
    s_waitcnt lgkmcnt(0)
    v_mfma_f32_16x16x32_bf16 v[8:11], v[244:247], v[172:175], v[8:11]
    ds_read_b64_tr_b16 v[232:233], v3 offset:40960
    ds_read_b64_tr_b16 v[234:235], v3 offset:41472
    s_waitcnt lgkmcnt(0)
    v_mfma_f32_16x16x32_bf16 v[8:11], v[232:235], v[176:179], v[8:11]
    ds_read_b64_tr_b16 v[236:237], v3 offset:41984
    ds_read_b64_tr_b16 v[238:239], v3 offset:42496
    s_waitcnt lgkmcnt(0)
    v_mfma_f32_16x16x32_bf16 v[8:11], v[236:239], v[180:183], v[8:11]
    ds_read_b64_tr_b16 v[240:241], v3 offset:43008
    ds_read_b64_tr_b16 v[242:243], v3 offset:43520
    s_waitcnt lgkmcnt(0)
    v_mfma_f32_16x16x32_bf16 v[8:11], v[240:243], v[184:187], v[8:11]
    ds_read_b64_tr_b16 v[244:245], v3 offset:44032
    ds_read_b64_tr_b16 v[246:247], v3 offset:44544
    s_waitcnt lgkmcnt(0)
    v_mfma_f32_16x16x32_bf16 v[8:11], v[244:247], v[188:191], v[8:11]
    ds_read_b64_tr_b16 v[232:233], v3 offset:45056
    ds_read_b64_tr_b16 v[234:235], v3 offset:45568
    s_waitcnt lgkmcnt(0)
    v_mfma_f32_16x16x32_bf16 v[8:11], v[232:235], v[192:195], v[8:11]
    ds_read_b64_tr_b16 v[236:237], v3 offset:46080
    ds_read_b64_tr_b16 v[238:239], v3 offset:46592
    s_waitcnt lgkmcnt(0)
    v_mfma_f32_16x16x32_bf16 v[8:11], v[236:239], v[196:199], v[8:11]
    ds_read_b64_tr_b16 v[240:241], v3 offset:47104
    ds_read_b64_tr_b16 v[242:243], v3 offset:47616
    s_waitcnt lgkmcnt(0)
    v_mfma_f32_16x16x32_bf16 v[8:11], v[240:243], v[200:203], v[8:11]
    ds_read_b64_tr_b16 v[244:245], v3 offset:48128
    ds_read_b64_tr_b16 v[246:247], v3 offset:48640
    s_waitcnt lgkmcnt(0)
    v_mfma_f32_16x16x32_bf16 v[8:11], v[244:247], v[204:207], v[8:11]
    ds_read_b64_tr_b16 v[232:233], v3 offset:49152
    ds_read_b64_tr_b16 v[234:235], v3 offset:49664
    s_waitcnt lgkmcnt(0)
    v_mfma_f32_16x16x32_bf16 v[8:11], v[232:235], v[208:211], v[8:11]
    ds_read_b64_tr_b16 v[236:237], v3 offset:50176
    ds_read_b64_tr_b16 v[238:239], v3 offset:50688
    s_waitcnt lgkmcnt(0)
    v_mfma_f32_16x16x32_bf16 v[8:11], v[236:239], v[212:215], v[8:11]
    ds_read_b64_tr_b16 v[240:241], v3 offset:51200
    ds_read_b64_tr_b16 v[242:243], v3 offset:51712
    s_waitcnt lgkmcnt(0)
    v_mfma_f32_16x16x32_bf16 v[8:11], v[240:243], v[216:219], v[8:11]
    ds_read_b64_tr_b16 v[244:245], v3 offset:52224
    ds_read_b64_tr_b16 v[246:247], v3 offset:52736
    s_waitcnt lgkmcnt(0)
    v_mfma_f32_16x16x32_bf16 v[8:11], v[244:247], v[220:223], v[8:11]
    ds_read_b64_tr_b16 v[232:233], v3 offset:53248
    ds_read_b64_tr_b16 v[234:235], v3 offset:53760
    s_waitcnt lgkmcnt(0)
    v_mfma_f32_16x16x32_bf16 v[8:11], v[232:235], v[224:227], v[8:11]
    ds_read_b64_tr_b16 v[236:237], v3 offset:54272
    ds_read_b64_tr_b16 v[238:239], v3 offset:54784
    s_waitcnt lgkmcnt(0)
    v_mfma_f32_16x16x32_bf16 v[8:11], v[236:239], v[228:231], v[8:11]
    v_and_b32 v7, 7, v0
    v_lshlrev_b32 v7, 2, v7
    s_mov_b32 s64, 0x5400020
    buffer_load_dword v12, v7, s[4:7], s64 offen sc1
    s_waitcnt vmcnt(0)
    s_nop 7
    v_cvt_pk_bf16_f32 v8, v8, v8
    v_lshlrev_b32 v8, 16, v8
    v_mul_f32 v8, v8, v12
    v_cvt_pk_bf16_f32 v8, v8, v8
    v_lshlrev_b32 v8, 16, v8
    v_cvt_pk_bf16_f32 v9, v9, v9
    v_lshlrev_b32 v9, 16, v9
    v_mul_f32 v9, v9, v12
    v_cvt_pk_bf16_f32 v9, v9, v9
    v_lshlrev_b32 v9, 16, v9
    v_cvt_pk_bf16_f32 v10, v10, v10
    v_lshlrev_b32 v10, 16, v10
    v_mul_f32 v10, v10, v12
    v_cvt_pk_bf16_f32 v10, v10, v10
    v_lshlrev_b32 v10, 16, v10
    v_cvt_pk_bf16_f32 v11, v11, v11
    v_lshlrev_b32 v11, 16, v11
    v_mul_f32 v11, v11, v12
    v_cvt_pk_bf16_f32 v11, v11, v11
    v_lshlrev_b32 v11, 16, v11
    v_and_b32 v7, 7, v0
    v_mul_u32_u24 v7, 2560, v7
    v_lshrrev_b32 v13, 4, v0
    v_lshl_add_u32 v7, v13, 4, v7
    s_lshl_b32 s64, s24, 6
    s_add_u32 s64, s64, 0x5410000
    s_mov_b32 s68, 0x00ff00ff
    s_mov_b32 s69, 0x00ff00ff
    s_mov_b64 exec, s[68:69]
    buffer_store_dwordx4 v[8:11], v7, s[4:7], s64 offen sc1
    s_mov_b64 exec, -1
    s_waitcnt vmcnt(0)
    v_mov_b32 v7, 1
    v_mov_b32 v8, 0
    s_mov_b32 s64, 0x298100
    s_mov_b64 exec, 1
    buffer_atomic_add v7, v8, s[4:7], s64 offen sc1
    s_mov_b64 exec, -1
H_ATT:
    v_mbcnt_lo_u32_b32 v0, -1, 0
    v_mbcnt_hi_u32_b32 v0, -1, v0
    s_mov_b32 s29, 0
    v_lshlrev_b32 v1, 4, v0
    v_lshrrev_b32 v5, 4, v0
    v_lshlrev_b32 v2, 7, v5
    v_and_b32 v5, 7, v0
    v_lshl_add_u32 v2, v5, 4, v2
    v_bfe_u32 v5, v0, 4, 1
    v_lshlrev_b32 v3, 7, v5
    v_and_b32 v5, 15, v0
    v_lshl_add_u32 v3, v5, 3, v3
    s_mov_b32 s34, 0x3e0293ee
    s_mov_b32 s35, 0x3e0293ee
    s_mov_b32 s36, -1
    s_mov_b32 s37, 0
    v_lshrrev_b32 v5, 4, v0
    v_lshlrev_b32 v5, 2, v5
    v_and_b32 v6, 15, v0
    v_add_u32 v7, 0, v5
    v_cmp_le_u32 s[38:39], v7, v6
    v_add_u32 v7, 1, v5
    v_cmp_le_u32 s[40:41], v7, v6
    v_add_u32 v7, 2, v5
    v_cmp_le_u32 s[42:43], v7, v6
    v_add_u32 v7, 3, v5
    v_cmp_le_u32 s[44:45], v7, v6
    v_mov_b32 v248, 0x3f803f80
    v_mov_b32 v249, 0x3f803f80
    v_mov_b32 v250, 0x3f803f80
    v_mov_b32 v251, 0x3f803f80
    s_lshl_b32 s24, s12, 2
    s_add_u32 s24, s24, s14
    s_add_u32 s24, s24, 16
    s_mov_b32 s25, 2
AT2_LOOP:
    s_lshl_b32 s64, s24, 5
    s_add_u32 s64, s64, s13
    s_lshl_b32 s26, s64, 13
    s_add_u32 s26, s26, 0x3400000
    s_lshl_b32 s27, s64, 14
    s_add_u32 s27, s27, 0x1400000
    s_lshl_b32 s65, s64, 11
    s_add_u32 s30, s65, 0x640000
    s_add_u32 s31, s65, 0xa40000
    s_lshl_b32 s33, s64, 2
    s_add_u32 s33, s33, 0x296000
    s_lshl_b32 s32, s24, 18
    s_lshl_b32 s65, s13, 12
    s_add_u32 s32, s32, s65
    s_add_u32 s32, s32, 0x4400000
    s_lshr_b32 s65, s24, 2
    s_lshl_b32 s65, s65, 9
    s_lshl_b32 s66, s13, 4
    s_add_u32 s65, s65, s66
    s_add_u32 s65, s65, 0x291000
    s_lshr_b32 s66, s24, 1
    s_lshl_b32 s66, s66, 8
    s_lshl_b32 s64, s13, 3
    s_add_u32 s66, s66, s64
    s_add_u32 s66, s66, 0x293ff4
    v_lshlrev_b32 v5, 2, v0
    v_mov_b32 v6, s65
    v_mov_b32 v7, s66
    v_cmp_gt_u32 vcc, 3, v0
    s_nop 1
    v_cndmask_b32 v6, v7, v6, vcc
    v_add_u32 v4, v5, v6
    s_mov_b32 s64, 0
    s_mov_b64 exec, 7
AT2_F_143:
    buffer_load_dword v5, v4, s[4:7], s64 offen sc1
    s_add_u32 s29, s29, 1
    s_waitcnt vmcnt(0)
    v_cmp_eq_u32 vcc, 0, v5
    s_cbranch_vccz AT2_FD_144
    s_cmp_gt_u32 s29, 262144
    s_cbranch_scc1 AT2_FD_144
    s_sleep 4
    s_branch AT2_F_143
AT2_FD_144:
    s_mov_b64 exec, -1
    buffer_load_dwordx4 v[16:19], v1, s[4:7], s26 offen offset:0
    buffer_load_dwordx4 v[20:23], v1, s[4:7], s26 offen offset:1024
    buffer_load_dwordx4 v[24:27], v1, s[4:7], s26 offen offset:2048
    buffer_load_dwordx4 v[28:31], v1, s[4:7], s26 offen offset:3072
    s_add_u32 s26, s26, 4096
    buffer_load_dwordx4 v[32:35], v1, s[4:7], s26 offen offset:0
    buffer_load_dwordx4 v[36:39], v1, s[4:7], s26 offen offset:1024
    buffer_load_dwordx4 v[40:43], v1, s[4:7], s26 offen offset:2048
    buffer_load_dwordx4 v[44:47], v1, s[4:7], s26 offen offset:3072
    buffer_load_dwordx4 v[48:51], v1, s[4:7], s27 offen offset:0
    buffer_load_dwordx4 v[52:55], v1, s[4:7], s27 offen offset:1024
    buffer_load_dwordx4 v[56:59], v1, s[4:7], s27 offen offset:2048
    buffer_load_dwordx4 v[60:63], v1, s[4:7], s27 offen offset:3072
    s_add_u32 s27, s27, 4096
    buffer_load_dwordx4 v[64:67], v1, s[4:7], s27 offen offset:0
    buffer_load_dwordx4 v[68:71], v1, s[4:7], s27 offen offset:1024
    buffer_load_dwordx4 v[72:75], v1, s[4:7], s27 offen offset:2048
    buffer_load_dwordx4 v[76:79], v1, s[4:7], s27 offen offset:3072
    s_add_u32 s27, s27, 4096
    buffer_load_dwordx4 v[80:83], v1, s[4:7], s27 offen offset:0
    buffer_load_dwordx4 v[84:87], v1, s[4:7], s27 offen offset:1024
    buffer_load_dwordx4 v[88:91], v1, s[4:7], s27 offen offset:2048
    buffer_load_dwordx4 v[92:95], v1, s[4:7], s27 offen offset:3072
    s_add_u32 s27, s27, 4096
    buffer_load_dwordx4 v[96:99], v1, s[4:7], s27 offen offset:0
    buffer_load_dwordx4 v[100:103], v1, s[4:7], s27 offen offset:1024
    buffer_load_dwordx4 v[104:107], v1, s[4:7], s27 offen offset:2048
    buffer_load_dwordx4 v[108:111], v1, s[4:7], s27 offen offset:3072
    s_mov_b64 exec, 0x18
AT2_G_145:
    buffer_load_dword v5, v4, s[4:7], s64 offen sc1
    s_add_u32 s29, s29, 1
    s_waitcnt vmcnt(0)
    v_cmp_eq_u32 vcc, 0, v5
    s_cbranch_vccz AT2_GD_146
    s_cmp_gt_u32 s29, 262144
    s_cbranch_scc1 AT2_GD_146
    s_sleep 4
    s_branch AT2_G_145
AT2_GD_146:
    s_mov_b64 exec, -1
    buffer_load_dwordx4 v[112:115], v2, s[4:7], s30 offen offset:0
    buffer_load_dwordx4 v[116:119], v2, s[4:7], s30 offen offset:512
    buffer_load_dwordx4 v[120:123], v2, s[4:7], s30 offen offset:1024
    buffer_load_dwordx4 v[124:127], v2, s[4:7], s30 offen offset:1536
    buffer_load_dwordx2 v[128:129], v3, s[4:7], s31 offen offset:0
    buffer_load_dwordx2 v[130:131], v3, s[4:7], s31 offen offset:256
    buffer_load_dwordx2 v[132:133], v3, s[4:7], s31 offen offset:512
    buffer_load_dwordx2 v[134:135], v3, s[4:7], s31 offen offset:768
    buffer_load_dwordx2 v[136:137], v3, s[4:7], s31 offen offset:1024
    buffer_load_dwordx2 v[138:139], v3, s[4:7], s31 offen offset:1280
    buffer_load_dwordx2 v[140:141], v3, s[4:7], s31 offen offset:1536
    buffer_load_dwordx2 v[142:143], v3, s[4:7], s31 offen offset:1792
    v_mfma_f32_16x16x32_bf16 v[148:151], v[48:51], v[16:19], 0
    v_mfma_f32_16x16x32_bf16 v[156:159], v[48:51], v[32:35], 0
    v_mfma_f32_16x16x32_bf16 v[160:163], v[64:67], v[32:35], 0
    v_mfma_f32_16x16x32_bf16 v[148:151], v[52:55], v[20:23], v[148:151]
    v_mfma_f32_16x16x32_bf16 v[156:159], v[52:55], v[36:39], v[156:159]
    v_mfma_f32_16x16x32_bf16 v[160:163], v[68:71], v[36:39], v[160:163]
    v_mfma_f32_16x16x32_bf16 v[148:151], v[56:59], v[24:27], v[148:151]
    v_mfma_f32_16x16x32_bf16 v[156:159], v[56:59], v[40:43], v[156:159]
    v_mfma_f32_16x16x32_bf16 v[160:163], v[72:75], v[40:43], v[160:163]
    v_mfma_f32_16x16x32_bf16 v[148:151], v[60:63], v[28:31], v[148:151]
    v_mfma_f32_16x16x32_bf16 v[156:159], v[60:63], v[44:47], v[156:159]
    v_mfma_f32_16x16x32_bf16 v[160:163], v[76:79], v[44:47], v[160:163]
    s_waitcnt vmcnt(8)
    v_mfma_f32_16x16x32_bf16 v[144:147], v[112:115], v[16:19], 0
    v_mfma_f32_16x16x32_bf16 v[152:155], v[112:115], v[32:35], 0
    v_mfma_f32_16x16x32_bf16 v[144:147], v[116:119], v[20:23], v[144:147]
    v_mfma_f32_16x16x32_bf16 v[152:155], v[116:119], v[36:39], v[152:155]
    v_mfma_f32_16x16x32_bf16 v[144:147], v[120:123], v[24:27], v[144:147]
    v_mfma_f32_16x16x32_bf16 v[152:155], v[120:123], v[40:43], v[152:155]
    v_mfma_f32_16x16x32_bf16 v[144:147], v[124:127], v[28:31], v[144:147]
    v_mfma_f32_16x16x32_bf16 v[152:155], v[124:127], v[44:47], v[152:155]
    v_mov_b32 v11, 0xff800000
    s_nop 7
    v_cndmask_b32 v148, v11, v148, s[38:39]
    v_cndmask_b32 v160, v11, v160, s[38:39]
    v_cndmask_b32 v144, v11, v144, s[36:37]
    v_cndmask_b32 v152, v11, v152, s[36:37]
    v_cndmask_b32 v149, v11, v149, s[40:41]
    v_cndmask_b32 v161, v11, v161, s[40:41]
    v_cndmask_b32 v145, v11, v145, s[36:37]
    v_cndmask_b32 v153, v11, v153, s[36:37]
    v_cndmask_b32 v150, v11, v150, s[42:43]
    v_cndmask_b32 v162, v11, v162, s[42:43]
    v_cndmask_b32 v146, v11, v146, s[36:37]
    v_cndmask_b32 v154, v11, v154, s[36:37]
    v_cndmask_b32 v151, v11, v151, s[44:45]
    v_cndmask_b32 v163, v11, v163, s[44:45]
    v_cndmask_b32 v147, v11, v147, s[36:37]
    v_cndmask_b32 v155, v11, v155, s[36:37]
    v_max3_f32 v8, v144, v145, v146
    v_max3_f32 v8, v8, v147, v148
    v_max3_f32 v8, v8, v149, v150
    v_max_f32 v8, v8, v151
    v_mov_b32 v9, v8
    s_nop 1
    v_permlane16_swap_b32 v8, v9
    v_max_f32 v8, v8, v9
    v_mov_b32 v9, v8
    s_nop 1
    v_permlane32_swap_b32 v8, v9
    v_max_f32 v8, v8, v9
    v_mul_f32 v8, s34, v8
    v_fma_f32 v144, v144, s34, -v8
    v_fma_f32 v145, v145, s34, -v8
    v_fma_f32 v146, v146, s34, -v8
    v_fma_f32 v147, v147, s34, -v8
    v_fma_f32 v148, v148, s34, -v8
    v_fma_f32 v149, v149, s34, -v8
    v_fma_f32 v150, v150, s34, -v8
    v_fma_f32 v151, v151, s34, -v8
    v_exp_f32 v144, v144
    v_exp_f32 v145, v145
    v_exp_f32 v146, v146
    v_exp_f32 v147, v147
    v_exp_f32 v148, v148
    v_exp_f32 v149, v149
    v_exp_f32 v150, v150
    v_exp_f32 v151, v151
    s_nop 0
    v_cvt_pk_bf16_f32 v164, v148, v149
    v_cvt_pk_bf16_f32 v165, v150, v151
    v_mov_b32 v166, 0
    v_mov_b32 v167, 0
    v_cvt_pk_bf16_f32 v168, v144, v145
    v_cvt_pk_bf16_f32 v169, v146, v147
    v_max3_f32 v8, v152, v153, v154
    v_max3_f32 v8, v8, v155, v156
    v_max3_f32 v8, v8, v157, v158
    v_max3_f32 v8, v8, v159, v160
    v_max3_f32 v8, v8, v161, v162
    v_max_f32 v8, v8, v163
    v_mov_b32 v9, v8
    s_nop 1
    v_permlane16_swap_b32 v8, v9
    v_max_f32 v8, v8, v9
    v_mov_b32 v9, v8
    s_nop 1
    v_permlane32_swap_b32 v8, v9
    v_max_f32 v8, v8, v9
    v_mul_f32 v8, s34, v8
    v_fma_f32 v152, v152, s34, -v8
    v_fma_f32 v153, v153, s34, -v8
    v_fma_f32 v154, v154, s34, -v8
    v_fma_f32 v155, v155, s34, -v8
    v_fma_f32 v156, v156, s34, -v8
    v_fma_f32 v157, v157, s34, -v8
    v_fma_f32 v158, v158, s34, -v8
    v_fma_f32 v159, v159, s34, -v8
    v_fma_f32 v160, v160, s34, -v8
    v_fma_f32 v161, v161, s34, -v8
    v_fma_f32 v162, v162, s34, -v8
    v_fma_f32 v163, v163, s34, -v8
    v_exp_f32 v152, v152
    v_exp_f32 v153, v153
    v_exp_f32 v154, v154
    v_exp_f32 v155, v155
    v_exp_f32 v156, v156
    v_exp_f32 v157, v157
    v_exp_f32 v158, v158
    v_exp_f32 v159, v159
    v_exp_f32 v160, v160
    v_exp_f32 v161, v161
    v_exp_f32 v162, v162
    v_exp_f32 v163, v163
    s_nop 0
    v_cvt_pk_bf16_f32 v170, v156, v157
    v_cvt_pk_bf16_f32 v171, v158, v159
    v_cvt_pk_bf16_f32 v172, v160, v161
    v_cvt_pk_bf16_f32 v173, v162, v163
    v_cvt_pk_bf16_f32 v174, v152, v153
    v_cvt_pk_bf16_f32 v175, v154, v155
    s_waitcnt vmcnt(0)
    v_mfma_f32_16x16x32_bf16 v[240:243], v[248:251], v[164:167], 0
    v_mfma_f32_16x16x32_bf16 v[244:247], v[248:251], v[170:173], 0
    v_mfma_f32_16x16x32_bf16 v[176:179], v[80:83], v[164:167], 0
    v_mfma_f32_16x16x32_bf16 v[180:183], v[80:83], v[170:173], 0
    v_mfma_f32_16x16x32_bf16 v[184:187], v[84:87], v[164:167], 0
    v_mfma_f32_16x16x32_bf16 v[188:191], v[84:87], v[170:173], 0
    v_mfma_f32_16x16x32_bf16 v[192:195], v[88:91], v[164:167], 0
    v_mfma_f32_16x16x32_bf16 v[196:199], v[88:91], v[170:173], 0
    v_mfma_f32_16x16x32_bf16 v[200:203], v[92:95], v[164:167], 0
    v_mfma_f32_16x16x32_bf16 v[204:207], v[92:95], v[170:173], 0
    v_mfma_f32_16x16x32_bf16 v[208:211], v[96:99], v[164:167], 0
    v_mfma_f32_16x16x32_bf16 v[212:215], v[96:99], v[170:173], 0
    v_mfma_f32_16x16x32_bf16 v[216:219], v[100:103], v[164:167], 0
    v_mfma_f32_16x16x32_bf16 v[220:223], v[100:103], v[170:173], 0
    v_mfma_f32_16x16x32_bf16 v[224:227], v[104:107], v[164:167], 0
    v_mfma_f32_16x16x32_bf16 v[228:231], v[104:107], v[170:173], 0
    v_mfma_f32_16x16x32_bf16 v[232:235], v[108:111], v[164:167], 0
    v_mfma_f32_16x16x32_bf16 v[236:239], v[108:111], v[170:173], 0
    v_mfma_f32_16x16x16_bf16 v[240:243], v[248:249], v[168:169], v[240:243]
    v_mfma_f32_16x16x16_bf16 v[244:247], v[248:249], v[174:175], v[244:247]
    v_mfma_f32_16x16x16_bf16 v[176:179], v[128:129], v[168:169], v[176:179]
    v_mfma_f32_16x16x16_bf16 v[180:183], v[128:129], v[174:175], v[180:183]
    v_mfma_f32_16x16x16_bf16 v[184:187], v[130:131], v[168:169], v[184:187]
    v_mfma_f32_16x16x16_bf16 v[188:191], v[130:131], v[174:175], v[188:191]
    v_mfma_f32_16x16x16_bf16 v[192:195], v[132:133], v[168:169], v[192:195]
    v_mfma_f32_16x16x16_bf16 v[196:199], v[132:133], v[174:175], v[196:199]
    v_mfma_f32_16x16x16_bf16 v[200:203], v[134:135], v[168:169], v[200:203]
    v_mfma_f32_16x16x16_bf16 v[204:207], v[134:135], v[174:175], v[204:207]
    v_mfma_f32_16x16x16_bf16 v[208:211], v[136:137], v[168:169], v[208:211]
    v_mfma_f32_16x16x16_bf16 v[212:215], v[136:137], v[174:175], v[212:215]
    v_mfma_f32_16x16x16_bf16 v[216:219], v[138:139], v[168:169], v[216:219]
    v_mfma_f32_16x16x16_bf16 v[220:223], v[138:139], v[174:175], v[220:223]
    v_mfma_f32_16x16x16_bf16 v[224:227], v[140:141], v[168:169], v[224:227]
    v_mfma_f32_16x16x16_bf16 v[228:231], v[140:141], v[174:175], v[228:231]
    v_mfma_f32_16x16x16_bf16 v[232:235], v[142:143], v[168:169], v[232:235]
    v_mfma_f32_16x16x16_bf16 v[236:239], v[142:143], v[174:175], v[236:239]
    v_rcp_f32 v8, v240
    v_rcp_f32 v9, v244
    s_nop 7
    v_mul_f32 v176, v176, v8
    v_mul_f32 v177, v177, v8
    v_mul_f32 v178, v178, v8
    v_mul_f32 v179, v179, v8
    v_cvt_pk_bf16_f32 v16, v176, v177
    v_cvt_pk_bf16_f32 v17, v178, v179
    v_mul_f32 v184, v184, v8
    v_mul_f32 v185, v185, v8
    v_mul_f32 v186, v186, v8
    v_mul_f32 v187, v187, v8
    v_cvt_pk_bf16_f32 v18, v184, v185
    v_cvt_pk_bf16_f32 v19, v186, v187
    s_add_u32 s64, s32, 0x0
    buffer_store_dwordx4 v[16:19], v1, s[4:7], s64 offen offset:0 sc1
    v_mul_f32 v192, v192, v8
    v_mul_f32 v193, v193, v8
    v_mul_f32 v194, v194, v8
    v_mul_f32 v195, v195, v8
    v_cvt_pk_bf16_f32 v20, v192, v193
    v_cvt_pk_bf16_f32 v21, v194, v195
    v_mul_f32 v200, v200, v8
    v_mul_f32 v201, v201, v8
    v_mul_f32 v202, v202, v8
    v_mul_f32 v203, v203, v8
    v_cvt_pk_bf16_f32 v22, v200, v201
    v_cvt_pk_bf16_f32 v23, v202, v203
    s_add_u32 s64, s32, 0x0
    buffer_store_dwordx4 v[20:23], v1, s[4:7], s64 offen offset:1024 sc1
    v_mul_f32 v208, v208, v8
    v_mul_f32 v209, v209, v8
    v_mul_f32 v210, v210, v8
    v_mul_f32 v211, v211, v8
    v_cvt_pk_bf16_f32 v24, v208, v209
    v_cvt_pk_bf16_f32 v25, v210, v211
    v_mul_f32 v216, v216, v8
    v_mul_f32 v217, v217, v8
    v_mul_f32 v218, v218, v8
    v_mul_f32 v219, v219, v8
    v_cvt_pk_bf16_f32 v26, v216, v217
    v_cvt_pk_bf16_f32 v27, v218, v219
    s_add_u32 s64, s32, 0x0
    buffer_store_dwordx4 v[24:27], v1, s[4:7], s64 offen offset:2048 sc1
    v_mul_f32 v224, v224, v8
    v_mul_f32 v225, v225, v8
    v_mul_f32 v226, v226, v8
    v_mul_f32 v227, v227, v8
    v_cvt_pk_bf16_f32 v28, v224, v225
    v_cvt_pk_bf16_f32 v29, v226, v227
    v_mul_f32 v232, v232, v8
    v_mul_f32 v233, v233, v8
    v_mul_f32 v234, v234, v8
    v_mul_f32 v235, v235, v8
    v_cvt_pk_bf16_f32 v30, v232, v233
    v_cvt_pk_bf16_f32 v31, v234, v235
    s_add_u32 s64, s32, 0x0
    buffer_store_dwordx4 v[28:31], v1, s[4:7], s64 offen offset:3072 sc1
    v_mul_f32 v180, v180, v9
    v_mul_f32 v181, v181, v9
    v_mul_f32 v182, v182, v9
    v_mul_f32 v183, v183, v9
    v_cvt_pk_bf16_f32 v32, v180, v181
    v_cvt_pk_bf16_f32 v33, v182, v183
    v_mul_f32 v188, v188, v9
    v_mul_f32 v189, v189, v9
    v_mul_f32 v190, v190, v9
    v_mul_f32 v191, v191, v9
    v_cvt_pk_bf16_f32 v34, v188, v189
    v_cvt_pk_bf16_f32 v35, v190, v191
    s_add_u32 s64, s32, 0x20000
    buffer_store_dwordx4 v[32:35], v1, s[4:7], s64 offen offset:0 sc1
    v_mul_f32 v196, v196, v9
    v_mul_f32 v197, v197, v9
    v_mul_f32 v198, v198, v9
    v_mul_f32 v199, v199, v9
    v_cvt_pk_bf16_f32 v36, v196, v197
    v_cvt_pk_bf16_f32 v37, v198, v199
    v_mul_f32 v204, v204, v9
    v_mul_f32 v205, v205, v9
    v_mul_f32 v206, v206, v9
    v_mul_f32 v207, v207, v9
    v_cvt_pk_bf16_f32 v38, v204, v205
    v_cvt_pk_bf16_f32 v39, v206, v207
    s_add_u32 s64, s32, 0x20000
    buffer_store_dwordx4 v[36:39], v1, s[4:7], s64 offen offset:1024 sc1
    v_mul_f32 v212, v212, v9
    v_mul_f32 v213, v213, v9
    v_mul_f32 v214, v214, v9
    v_mul_f32 v215, v215, v9
    v_cvt_pk_bf16_f32 v40, v212, v213
    v_cvt_pk_bf16_f32 v41, v214, v215
    v_mul_f32 v220, v220, v9
    v_mul_f32 v221, v221, v9
    v_mul_f32 v222, v222, v9
    v_mul_f32 v223, v223, v9
    v_cvt_pk_bf16_f32 v42, v220, v221
    v_cvt_pk_bf16_f32 v43, v222, v223
    s_add_u32 s64, s32, 0x20000
    buffer_store_dwordx4 v[40:43], v1, s[4:7], s64 offen offset:2048 sc1
    v_mul_f32 v228, v228, v9
    v_mul_f32 v229, v229, v9
    v_mul_f32 v230, v230, v9
    v_mul_f32 v231, v231, v9
    v_cvt_pk_bf16_f32 v44, v228, v229
    v_cvt_pk_bf16_f32 v45, v230, v231
    v_mul_f32 v236, v236, v9
    v_mul_f32 v237, v237, v9
    v_mul_f32 v238, v238, v9
    v_mul_f32 v239, v239, v9
    v_cvt_pk_bf16_f32 v46, v236, v237
    v_cvt_pk_bf16_f32 v47, v238, v239
    s_add_u32 s64, s32, 0x20000
    buffer_store_dwordx4 v[44:47], v1, s[4:7], s64 offen offset:3072 sc1
    s_waitcnt vmcnt(0)
    v_mov_b32 v7, 1
    v_mov_b32 v8, 0
    s_mov_b64 exec, 1
    buffer_store_dword v7, v8, s[4:7], s33 offen sc1
    s_mov_b64 exec, -1
    s_add_u32 s24, s24, 8
    s_add_u32 s25, s25, 1
    s_cmp_lt_u32 s25, 8
    s_cbranch_scc1 AT2_LOOP
M_EXIT:
    s_endpgm
.section .rodata,"a"
.p2align 6
.amdhsa_kernel main_kernel
  .amdhsa_next_free_vgpr 512
  .amdhsa_next_free_sgpr 102
  .amdhsa_accum_offset 256
  .amdhsa_group_segment_fixed_size 0
  .amdhsa_kernarg_size 120
  .amdhsa_user_sgpr_count 2
  .amdhsa_user_sgpr_kernarg_segment_ptr 1
  .amdhsa_system_sgpr_workgroup_id_x 1
.end_amdhsa_kernel
```

```asm
; @launch kernel=main_kernel grid=(256,1,1) block=(256,1,1) lds=163840
.amdgcn_target "amdgcn-amd-amdhsa--gfx950"
.text
.globl main_kernel
.p2align 8
.type main_kernel,@function
main_kernel:
    s_cmp_ge_u32 s2, 256
    s_cbranch_scc1 M_EXIT
    s_load_dwordx2 s[4:5], s[0:1], 112
    s_mov_b32 s6, 0x10000000
    s_mov_b32 s7, 0x00020000
    s_load_dwordx2 s[60:61], s[0:1], 104
    s_mov_b32 s62, 256
    s_mov_b32 s63, 0x00020000
    v_lshrrev_b32 v1, 6, v0
    v_and_b32 v0, 63, v0
    s_nop 0
    v_readfirstlane_b32 s14, v1
    s_getreg_b32 s98, hwreg(HW_REG_XCC_ID)
    s_and_b32 s98, s98, 7
    s_mov_b32 s97, 0
    s_mov_b32 s95, 4
    s_waitcnt lgkmcnt(0)
    s_cmp_lg_u32 s14, 0
    s_cbranch_scc1 NOMEAS_1
    s_and_b32 s64, s2, 0xfffffffd
    s_cmp_lg_u32 s64, 1
    s_cbranch_scc1 NOMEAS_1
    s_lshr_b32 s70, s2, 1
    s_mov_b32 s72, s60
    s_mov_b32 s73, s61
    s_mov_b32 s74, s62
    s_mov_b32 s75, s63
    s_lshl_b32 s60, s70, 21
    s_add_u32 s60, s60, 0x6001800
    v_mov_b32 v60, 0
    v_mov_b32 v61, -1
    s_mov_b32 s66, 0x7fffffff
    s_mov_b32 s67, 0x7fffffff
    s_mov_b32 s68, 0x7fffffff
    s_mov_b32 s69, 0x7fffffff
    s_mov_b64 exec, 1
    s_add_u32 s61, s60, 0
    s_memtime s[62:63]
    s_waitcnt lgkmcnt(0)
    buffer_store_dword v61, v60, s[4:7], s61 offen offset:0 sc1
    s_waitcnt vmcnt(0)
    s_memtime s[64:65]
    s_waitcnt lgkmcnt(0)
    s_sub_u32 s62, s64, s62
    s_min_u32 s66, s66, s62
    s_add_u32 s61, s60, 8192
    s_memtime s[62:63]
    s_waitcnt lgkmcnt(0)
    buffer_store_dword v61, v60, s[4:7], s61 offen offset:0 sc1
    s_waitcnt vmcnt(0)
    s_memtime s[64:65]
    s_waitcnt lgkmcnt(0)
    s_sub_u32 s62, s64, s62
    s_min_u32 s67, s67, s62
    s_add_u32 s61, s60, 16384
    s_memtime s[62:63]
    s_waitcnt lgkmcnt(0)
    buffer_store_dword v61, v60, s[4:7], s61 offen offset:0 sc1
    s_waitcnt vmcnt(0)
    s_memtime s[64:65]
    s_waitcnt lgkmcnt(0)
    s_sub_u32 s62, s64, s62
    s_min_u32 s68, s68, s62
    s_add_u32 s61, s60, 24576
    s_memtime s[62:63]
    s_waitcnt lgkmcnt(0)
    buffer_store_dword v61, v60, s[4:7], s61 offen offset:0 sc1
    s_waitcnt vmcnt(0)
    s_memtime s[64:65]
    s_waitcnt lgkmcnt(0)
    s_sub_u32 s62, s64, s62
    s_min_u32 s69, s69, s62
    s_add_u32 s61, s60, 0
    s_memtime s[62:63]
    s_waitcnt lgkmcnt(0)
    buffer_store_dword v61, v60, s[4:7], s61 offen offset:128 sc1
    s_waitcnt vmcnt(0)
    s_memtime s[64:65]
    s_waitcnt lgkmcnt(0)
    s_sub_u32 s62, s64, s62
    s_min_u32 s66, s66, s62
    s_add_u32 s61, s60, 8192
    s_memtime s[62:63]
    s_waitcnt lgkmcnt(0)
    buffer_store_dword v61, v60, s[4:7], s61 offen offset:128 sc1
    s_waitcnt vmcnt(0)
    s_memtime s[64:65]
    s_waitcnt lgkmcnt(0)
    s_sub_u32 s62, s64, s62
    s_min_u32 s67, s67, s62
    s_add_u32 s61, s60, 16384
    s_memtime s[62:63]
    s_waitcnt lgkmcnt(0)
    buffer_store_dword v61, v60, s[4:7], s61 offen offset:128 sc1
    s_waitcnt vmcnt(0)
    s_memtime s[64:65]
    s_waitcnt lgkmcnt(0)
    s_sub_u32 s62, s64, s62
    s_min_u32 s68, s68, s62
    s_add_u32 s61, s60, 24576
    s_memtime s[62:63]
    s_waitcnt lgkmcnt(0)
    buffer_store_dword v61, v60, s[4:7], s61 offen offset:128 sc1
    s_waitcnt vmcnt(0)
    s_memtime s[64:65]
    s_waitcnt lgkmcnt(0)
    s_sub_u32 s62, s64, s62
    s_min_u32 s69, s69, s62
    s_mov_b64 exec, -1
    s_mov_b32 s60, 0
    s_mov_b32 s61, s66
    s_cmp_lt_u32 s67, s61
    s_cselect_b32 s60, 1, s60
    s_min_u32 s61, s61, s67
    s_cmp_lt_u32 s68, s61
    s_cselect_b32 s60, 2, s60
    s_min_u32 s61, s61, s68
    s_cmp_lt_u32 s69, s61
    s_cselect_b32 s60, 3, s60
    s_min_u32 s61, s61, s69
    s_and_b32 s61, s98, 1
    s_lshl_b32 s61, s61, 1
    s_lshr_b32 s62, s98, 2
    s_add_u32 s61, s61, s62
    s_xor_b32 s60, s60, s61
    s_add_u32 s71, s60, 1
    s_mov_b32 s60, s72
    s_mov_b32 s61, s73
    s_mov_b32 s62, s74
    s_mov_b32 s63, s75
    s_lshl_b32 s70, s70, 2
    s_add_u32 s70, s70, 132
    v_mov_b32 v61, s71
    s_mov_b64 exec, 1
    buffer_store_dword v61, off, s[60:63], s70 sc1
    s_mov_b64 exec, -1
NOMEAS_1:
    s_cmp_lg_u32 s14, 0
    s_cbranch_scc1 M_TICKW
    s_mul_i32 s64, s98, 32
    s_add_u32 s64, s64, 0x0
    v_mov_b32 v1, 0
    v_mov_b32 v2, 1
    s_mov_b64 exec, 1
    buffer_atomic_add v2, v1, s[60:63], s64 offen sc0
    s_waitcnt vmcnt(0)
    ds_write_b32 v1, v2
    s_waitcnt lgkmcnt(0)
    s_mov_b64 exec, -1
M_TICKW:
    s_barrier
    v_mov_b32 v1, 0
    ds_read_b32 v2, v1
    s_waitcnt lgkmcnt(0)
    v_readfirstlane_b32 s99, v2
    s_barrier
    s_cmp_ge_u32 s99, 32
    s_cbranch_scc1 M_SLOW0
    s_mov_b32 s12, s98
    s_cmp_eq_u32 s12, 0
    s_cbranch_scc1 XOK_2
    s_cmp_eq_u32 s12, 2
    s_cbranch_scc0 M_FH
    s_mov_b32 s12, 1
XOK_2:
    s_mov_b32 s13, s99
    s_branch M_REC
M_FH:
    s_sub_u32 s96, s98, 1
    s_cmp_gt_u32 s98, 2
    s_cselect_b32 s64, 1, 0
    s_sub_u32 s96, s96, s64
    s_lshl_b32 s96, s96, 5
    s_add_u32 s96, s96, s99
    s_branch M_HELP
M_SLOW0:
    v_mbcnt_lo_u32_b32 v0, -1, 0
    v_mbcnt_hi_u32_b32 v0, -1, v0
    v_mul_u32_u24 v8, 32, v0
    s_mov_b32 s64, 0x0
    s_mov_b32 s65, 0
    s_mov_b64 exec, 0xff
TK_3:
    buffer_load_dword v9, v8, s[60:63], s64 offen sc1
    s_add_u32 s65, s65, 1
    s_waitcnt vmcnt(0)
    s_mov_b32 s66, 0
    v_readlane_b32 s67, v9, 0
    s_add_u32 s66, s66, s67
    v_readlane_b32 s67, v9, 1
    s_add_u32 s66, s66, s67
    v_readlane_b32 s67, v9, 2
    s_add_u32 s66, s66, s67
    v_readlane_b32 s67, v9, 3
    s_add_u32 s66, s66, s67
    v_readlane_b32 s67, v9, 4
    s_add_u32 s66, s66, s67
    v_readlane_b32 s67, v9, 5
    s_add_u32 s66, s66, s67
    v_readlane_b32 s67, v9, 6
    s_add_u32 s66, s66, s67
    v_readlane_b32 s67, v9, 7
    s_add_u32 s66, s66, s67
    s_cmp_ge_u32 s66, 256
    s_cbranch_scc1 TKD_4
    s_cmp_gt_u32 s65, 262144
    s_cbranch_scc0 TK_3
TKD_4:
    v_cmp_ne_u32 vcc, 32, v9
    s_mov_b64 exec, -1
M_SLOW:
    s_waitcnt vmcnt(0) lgkmcnt(0)
    s_barrier
    s_cmp_lg_u32 s14, 0
    s_cbranch_scc1 M_SLOWB
    v_mov_b32 v8, 1
    s_mov_b64 exec, 1
    buffer_atomic_add v8, off, s[60:63], 12 sc1
    s_mov_b64 exec, -1
M_SLOWB:
    s_mov_b32 s95, 12
    s_mov_b32 s65, 0
SB_5:
    buffer_load_dword v8, off, s[60:63], s95 sc1
    s_add_u32 s65, s65, 1
    s_waitcnt vmcnt(0)
    v_readfirstlane_b32 s64, v8
    s_cmp_ge_u32 s64, 256
    s_cbranch_scc1 SBD_6
    s_cmp_gt_u32 s65, 65536
    s_cbranch_scc1 SBD_6
    s_sleep 4
    s_branch SB_5
SBD_6:
    s_mov_b32 s95, 8
    s_mov_b32 s97, 1
    s_cmp_lt_u32 s2, 64
    s_cbranch_scc0 M_SH
    s_lshr_b32 s12, s2, 5
    s_and_b32 s13, s2, 31
    s_branch M_REC
M_SH:
    s_sub_u32 s96, s2, 64
    s_branch M_HELP
M_REC:
    v_mbcnt_lo_u32_b32 v0, -1, 0
    v_mbcnt_hi_u32_b32 v0, -1, v0
    s_load_dwordx2 s[44:45], s[0:1], 16
    s_mov_b32 s46, 0x500000
    s_mov_b32 s47, 0x00020000
    s_load_dwordx2 s[48:49], s[0:1], 24
    s_mov_b32 s50, 0x500000
    s_mov_b32 s51, 0x00020000
    s_load_dwordx2 s[52:53], s[0:1], 32
    s_mov_b32 s54, 0x500000
    s_mov_b32 s55, 0x00020000
    s_load_dwordx2 s[56:57], s[0:1], 40
    s_mov_b32 s58, 0x500000
    s_mov_b32 s59, 0x00020000
    s_waitcnt lgkmcnt(0)
    v_and_b32 v0, 63, v0
    v_lshlrev_b32 v1, 4, v0
    s_mul_i32 s64, s14, 36864
    s_add_u32 s64, s64, 16384
    v_add_u32 v2, s64, v1
    v_bfe_u32 v8, v0, 4, 1
    v_mul_u32_u24 v8, 1152, v8
    v_lshrrev_b32 v9, 5, v0
    v_lshlrev_b32 v9, 4, v9
    v_and_b32 v10, 15, v0
    v_add_u32 v9, v9, v10
    s_lshl_b32 s64, s14, 5
    v_add_u32 v9, s64, v9
    v_lshl_add_u32 v8, v9, 3, v8
    v_add_u32 v3, 8192, v8
    v_and_b32 v8, 1, v0
    v_mul_u32_u24 v8, 1152, v8
    v_lshrrev_b32 v9, 4, v0
    v_lshlrev_b32 v9, 2, v9
    v_bfe_u32 v10, v0, 2, 2
    v_add_u32 v9, v9, v10
    v_lshl_add_u32 v8, v9, 3, v8
    v_add_u32 v4, 8192, v8
    v_and_b32 v8, 7, v0
    v_mul_u32_u24 v8, 288, v8
    v_bfe_u32 v9, v0, 3, 1
    v_lshl_add_u32 v8, v9, 5, v8
    v_lshrrev_b32 v9, 4, v0
    v_lshl_add_u32 v8, v9, 3, v8
    s_lshl_b32 s64, s14, 6
    s_add_u32 s64, s64, 12800
    v_add_u32 v5, s64, v8
    s_mov_b32 s32, 0x00ff00ff
    s_mov_b32 s33, 0x00ff00ff
    s_mov_b32 s34, -1
    s_mov_b32 s35, 0
    s_mov_b32 s36, 0x00010001
    s_mov_b32 s37, 0x00010001
    v_mov_b32 v8, 0xeeee
    v_mov_b32 v9, 0x4444
    v_cndmask_b32 v6, v8, v9, s[32:33]
    v_lshrrev_b32 v8, 5, v0
    v_lshlrev_b32 v8, 13, v8
    v_bfe_u32 v9, v0, 3, 1
    v_lshl_add_u32 v8, v9, 12, v8
    v_and_b32 v9, 7, v0
    v_lshl_add_u32 v8, v9, 4, v8
    v_bfe_u32 v9, v0, 4, 1
    v_lshl_add_u32 v7, v9, 3, v8
    s_mov_b32 s10, 0x3e0293ee
    s_mov_b32 s11, 0x3e0293ee
    s_cmp_eq_u32 s14, 0
    s_cselect_b32 s42, 1, 0
    s_cmp_ge_u32 s13, 24
    s_cselect_b32 s65, 1, 0
    s_cmp_eq_u32 s14, 1
    s_cselect_b32 s65, s65, 0
    s_or_b32 s42, s42, s65
    s_lshl_b32 s65, s65, 3
    s_add_u32 s64, s13, s65
    s_cmp_eq_u32 s64, 39
    s_cselect_b32 s22, s42, 0
    s_mul_i32 s24, s12, 163840
    s_add_u32 s24, s24, 0x300000
    s_lshl_b32 s67, s13, 7
    s_add_u32 s26, s24, s67
    s_lshl_b32 s67, s14, 14
    s_add_u32 s23, s26, s67
    s_add_u32 s25, s23, 0x10000
    s_lshl_b32 s67, s14, 13
    s_add_u32 s26, s26, s67
    s_add_u32 s26, s26, 0x20000
    s_lshl_b32 s67, s64, 12
    s_add_u32 s24, s24, s67
    s_lshl_b32 s64, s64, 7
    s_lshl_b32 s65, s12, 13
    s_add_u32 s17, s65, 0x5900000
    s_add_u32 s18, s17, s64
    s_lshl_b32 s65, s12, 21
    s_add_u32 s66, s65, 0x6000000
    s_add_u32 s21, s66, s64
    s_xor_b32 s65, s65, 0x200000
    s_add_u32 s20, s65, 0x5ff8000
    s_and_b32 s64, s13, 1
    s_cmp_eq_u32 s64, s12
    s_cselect_b32 s43, 1, 0
    s_mov_b32 s43, 0
    s_lshl_b32 s64, s13, 4
    s_add_u32 s69, s64, 0x291000
    s_lshl_b32 s64, s13, 2
    s_add_u32 s70, s64, 0x294000
    s_lshl_b32 s64, s13, 14
    s_lshl_b32 s73, s14, 11
    s_lshl_b32 s65, s14, 12
    s_add_u32 s65, s65, s64
    s_add_u32 s3, s65, 0x1500000
    s_add_u32 s64, s64, s73
    s_add_u32 s28, s64, 0x1400000
    s_add_u32 s29, s64, 0x1402000
    s_lshl_b32 s64, s13, 11
    s_add_u32 s30, s64, 0x640000
    s_lshl_b32 s64, s13, 12
    s_lshl_b32 s65, s14, 10
    s_add_u32 s64, s64, s65
    s_add_u32 s31, s64, 0xa40000
    s_mul_i32 s40, s14, 36864
    s_add_u32 s40, s40, 16384
    v_bfe_u32 v95, v0, 2, 2
    v_lshlrev_b32 v88, 15, v95
    v_lshrrev_b32 v95, 5, v0
    v_lshl_add_u32 v88, v95, 14, v88
    v_bfe_u32 v95, v0, 4, 1
    v_lshl_add_u32 v88, v95, 13, v88
    v_lshlrev_b32 v95, 1, v95
    v_and_b32 v8, 3, v0
    v_xor_b32 v95, v95, v8
    v_lshl_add_u32 v88, v95, 4, v88
    v_bfe_u32 v95, v0, 2, 1
    v_mov_b32 v8, v95
    v_bfe_u32 v95, v0, 3, 1
    v_lshl_add_u32 v8, v95, 2, v8
    v_bfe_u32 v95, v0, 4, 1
    v_lshl_add_u32 v8, v95, 1, v8
    v_bfe_u32 v95, v0, 5, 1
    v_lshl_add_u32 v8, v95, 3, v8
    v_mul_u32_u24 v8, 1280, v8
    v_and_b32 v95, 3, v0
    v_lshl_add_u32 v89, v95, 4, v8
    v_lshrrev_b32 v95, 1, v0
    v_mul_u32_u24 v8, 1280, v95
    v_and_b32 v95, 1, v0
    v_lshl_add_u32 v90, v95, 4, v8
    v_lshrrev_b32 v95, 5, v0
    v_lshlrev_b32 v91, 10, v95
    v_bfe_u32 v95, v0, 2, 1
    v_lshl_add_u32 v91, v95, 8, v91
    v_bfe_u32 v95, v0, 4, 1
    v_lshl_add_u32 v91, v95, 6, v91
    v_bfe_u32 v95, v0, 3, 1
    v_lshl_add_u32 v91, v95, 7, v91
    v_and_b32 v95, 1, v0
    v_lshl_add_u32 v91, v95, 3, v91
    v_bfe_u32 v95, v0, 1, 1
    v_lshl_add_u32 v91, v95, 4, v91
    v_add_u32 v91, s40, v91
    v_bfe_u32 v95, v0, 2, 1
    v_lshlrev_b32 v95, 5, v95
    v_sub_u32 v92, 32, v95
    v_add_u32 v92, v92, v91
    v_add_u32 v91, v91, v95
    v_lshrrev_b32 v95, 5, v0
    v_lshlrev_b32 v93, 9, v95
    v_bfe_u32 v95, v0, 4, 1
    v_lshl_add_u32 v93, v95, 7, v93
    v_bfe_u32 v95, v0, 2, 1
    v_lshl_add_u32 v93, v95, 6, v93
    v_bfe_u32 v95, v0, 3, 1
    v_lshl_add_u32 v93, v95, 5, v93
    v_and_b32 v95, 3, v0
    v_lshl_add_u32 v93, v95, 3, v93
    v_add_u32 v93, s40, v93
    v_lshrrev_b32 v95, 4, v0
    v_lshlrev_b32 v94, 8, v95
    v_bfe_u32 v95, v0, 2, 2
    v_lshl_add_u32 v94, v95, 5, v94
    v_and_b32 v95, 3, v0
    v_lshl_add_u32 v94, v95, 3, v94
    v_add_u32 v94, s40, v94
    s_lshl_b32 s64, s13, 8
    s_lshl_b32 s65, s14, 6
    s_add_u32 s64, s64, s65
    s_mul_i32 s65, s12, 2621440
    s_add_u32 s71, s64, s65
    s_sub_u32 s65, 2621440, s65
    s_add_u32 s72, s64, s65
    s_mul_i32 s39, s13, 163840
    s_mul_i32 s64, s12, 640
    s_add_u32 s39, s39, s64
    s_lshl_b32 s64, s14, 5
    s_add_u32 s41, s39, s64
    s_add_u32 s41, s41, 0x200
    s_lshl_b32 s64, s14, 6
    s_add_u32 s39, s39, s64
    s_add_u32 m0, s40, 0
    s_add_u32 s64, s71, 0x0
    buffer_load_dwordx4 v88, s[44:47], s64 offen lds
    s_add_u32 m0, s40, 1024
    s_add_u32 s64, s71, 0x20000
    buffer_load_dwordx4 v88, s[44:47], s64 offen lds
    s_add_u32 m0, s40, 2048
    s_add_u32 s64, s71, 0x40000
    buffer_load_dwordx4 v88, s[44:47], s64 offen lds
    s_add_u32 m0, s40, 3072
    s_add_u32 s64, s71, 0x60000
    buffer_load_dwordx4 v88, s[44:47], s64 offen lds
    s_add_u32 m0, s40, 4096
    s_add_u32 s64, s71, 0x80000
    buffer_load_dwordx4 v88, s[44:47], s64 offen lds
    s_add_u32 m0, s40, 5120
    s_add_u32 s64, s71, 0xa0000
    buffer_load_dwordx4 v88, s[44:47], s64 offen lds
    s_add_u32 m0, s40, 6144
    s_add_u32 s64, s71, 0xc0000
    buffer_load_dwordx4 v88, s[44:47], s64 offen lds
    s_add_u32 m0, s40, 7168
    s_add_u32 s64, s71, 0xe0000
    buffer_load_dwordx4 v88, s[44:47], s64 offen lds
    s_add_u32 m0, s40, 8192
    s_add_u32 s64, s71, 0x100000
    buffer_load_dwordx4 v88, s[44:47], s64 offen lds
    s_add_u32 m0, s40, 9216
    s_add_u32 s64, s71, 0x120000
    buffer_load_dwordx4 v88, s[44:47], s64 offen lds
    s_add_u32 m0, s40, 10240
    s_add_u32 s64, s71, 0x140000
    buffer_load_dwordx4 v88, s[44:47], s64 offen lds
    s_add_u32 m0, s40, 11264
    s_add_u32 s64, s71, 0x160000
    buffer_load_dwordx4 v88, s[44:47], s64 offen lds
    s_add_u32 m0, s40, 12288
    s_add_u32 s64, s71, 0x180000
    buffer_load_dwordx4 v88, s[44:47], s64 offen lds
    s_add_u32 m0, s40, 13312
    s_add_u32 s64, s71, 0x1a0000
    buffer_load_dwordx4 v88, s[44:47], s64 offen lds
    s_add_u32 m0, s40, 14336
    s_add_u32 s64, s71, 0x1c0000
    buffer_load_dwordx4 v88, s[44:47], s64 offen lds
    s_add_u32 m0, s40, 15360
    s_add_u32 s64, s71, 0x1e0000
    buffer_load_dwordx4 v88, s[44:47], s64 offen lds
    s_add_u32 m0, s40, 16384
    s_add_u32 s64, s71, 0x200000
    buffer_load_dwordx4 v88, s[44:47], s64 offen lds
    s_add_u32 m0, s40, 17408
    s_add_u32 s64, s71, 0x220000
    buffer_load_dwordx4 v88, s[44:47], s64 offen lds
    s_add_u32 m0, s40, 18432
    s_add_u32 s64, s71, 0x240000
    buffer_load_dwordx4 v88, s[44:47], s64 offen lds
    s_add_u32 m0, s40, 19456
    s_add_u32 s64, s71, 0x260000
    buffer_load_dwordx4 v88, s[44:47], s64 offen lds
    s_add_u32 m0, s40, 20480
    s_add_u32 s64, s72, 0x0
    buffer_load_dwordx4 v88, s[44:47], s64 offen lds
    s_add_u32 m0, s40, 21504
    s_add_u32 s64, s72, 0x20000
    buffer_load_dwordx4 v88, s[44:47], s64 offen lds
    s_add_u32 m0, s40, 22528
    s_add_u32 s64, s72, 0x40000
    buffer_load_dwordx4 v88, s[44:47], s64 offen lds
    s_add_u32 m0, s40, 23552
    s_add_u32 s64, s72, 0x60000
    buffer_load_dwordx4 v88, s[44:47], s64 offen lds
    s_add_u32 m0, s40, 24576
    s_add_u32 s64, s72, 0x80000
    buffer_load_dwordx4 v88, s[44:47], s64 offen lds
    s_add_u32 m0, s40, 25600
    s_add_u32 s64, s72, 0xa0000
    buffer_load_dwordx4 v88, s[44:47], s64 offen lds
    s_add_u32 m0, s40, 26624
    s_add_u32 s64, s72, 0xc0000
    buffer_load_dwordx4 v88, s[44:47], s64 offen lds
    s_add_u32 m0, s40, 27648
    s_add_u32 s64, s72, 0xe0000
    buffer_load_dwordx4 v88, s[44:47], s64 offen lds
    s_add_u32 m0, s40, 28672
    s_add_u32 s64, s72, 0x100000
    buffer_load_dwordx4 v88, s[44:47], s64 offen lds
    s_add_u32 m0, s40, 29696
    s_add_u32 s64, s72, 0x120000
    buffer_load_dwordx4 v88, s[44:47], s64 offen lds
    s_add_u32 m0, s40, 30720
    s_add_u32 s64, s72, 0x140000
    buffer_load_dwordx4 v88, s[44:47], s64 offen lds
    s_add_u32 m0, s40, 31744
    s_add_u32 s64, s72, 0x160000
    buffer_load_dwordx4 v88, s[44:47], s64 offen lds
    s_add_u32 m0, s40, 32768
    s_add_u32 s64, s72, 0x180000
    buffer_load_dwordx4 v88, s[44:47], s64 offen lds
    s_add_u32 m0, s40, 33792
    s_add_u32 s64, s72, 0x1a0000
    buffer_load_dwordx4 v88, s[44:47], s64 offen lds
    s_add_u32 m0, s40, 34816
    s_add_u32 s64, s72, 0x1c0000
    buffer_load_dwordx4 v88, s[44:47], s64 offen lds
    s_add_u32 m0, s40, 35840
    s_add_u32 s64, s72, 0x1e0000
    buffer_load_dwordx4 v88, s[44:47], s64 offen lds
    s_waitcnt vmcnt(32)
    ds_read_b64_tr_b16 v[96:97], v91 offset:0
    ds_read_b64_tr_b16 v[98:99], v91 offset:512
    ds_read_b64_tr_b16 v[100:101], v91 offset:2048
    ds_read_b64_tr_b16 v[102:103], v91 offset:2560
    ds_read_b64_tr_b16 v[104:105], v92 offset:0
    ds_read_b64_tr_b16 v[106:107], v92 offset:512
    ds_read_b64_tr_b16 v[108:109], v92 offset:2048
    ds_read_b64_tr_b16 v[110:111], v92 offset:2560
    s_waitcnt lgkmcnt(0)
    s_add_u32 m0, s40, 0
    s_add_u32 s64, s72, 0x200000
    buffer_load_dwordx4 v88, s[44:47], s64 offen lds
    s_add_u32 m0, s40, 1024
    s_add_u32 s64, s72, 0x220000
    buffer_load_dwordx4 v88, s[44:47], s64 offen lds
    s_add_u32 m0, s40, 2048
    s_add_u32 s64, s72, 0x240000
    buffer_load_dwordx4 v88, s[44:47], s64 offen lds
    s_add_u32 m0, s40, 3072
    s_add_u32 s64, s72, 0x260000
    buffer_load_dwordx4 v88, s[44:47], s64 offen lds
    s_waitcnt vmcnt(32)
    ds_read_b64_tr_b16 v[112:113], v91 offset:4096
    ds_read_b64_tr_b16 v[114:115], v91 offset:4608
    ds_read_b64_tr_b16 v[116:117], v91 offset:6144
    ds_read_b64_tr_b16 v[118:119], v91 offset:6656
    ds_read_b64_tr_b16 v[120:121], v92 offset:4096
    ds_read_b64_tr_b16 v[122:123], v92 offset:4608
    ds_read_b64_tr_b16 v[124:125], v92 offset:6144
    ds_read_b64_tr_b16 v[126:127], v92 offset:6656
    s_waitcnt lgkmcnt(0)
    s_add_u32 m0, s40, 4096
    s_add_u32 s64, s72, 0x200000
    buffer_load_dwordx4 v88, s[48:51], s64 offen lds
    s_add_u32 m0, s40, 5120
    s_add_u32 s64, s72, 0x220000
    buffer_load_dwordx4 v88, s[48:51], s64 offen lds
    s_add_u32 m0, s40, 6144
    s_add_u32 s64, s72, 0x240000
    buffer_load_dwordx4 v88, s[48:51], s64 offen lds
    s_add_u32 m0, s40, 7168
    s_add_u32 s64, s72, 0x260000
    buffer_load_dwordx4 v88, s[48:51], s64 offen lds
    s_waitcnt vmcnt(32)
    ds_read_b64_tr_b16 v[128:129], v91 offset:8192
    ds_read_b64_tr_b16 v[130:131], v91 offset:8704
    ds_read_b64_tr_b16 v[132:133], v91 offset:10240
    ds_read_b64_tr_b16 v[134:135], v91 offset:10752
    ds_read_b64_tr_b16 v[136:137], v92 offset:8192
    ds_read_b64_tr_b16 v[138:139], v92 offset:8704
    ds_read_b64_tr_b16 v[140:141], v92 offset:10240
    ds_read_b64_tr_b16 v[142:143], v92 offset:10752
    s_waitcnt lgkmcnt(0)
    s_add_u32 m0, s40, 8192
    s_add_u32 s64, s71, 0x0
    buffer_load_dwordx4 v88, s[52:55], s64 offen lds
    s_add_u32 m0, s40, 9216
    s_add_u32 s64, s71, 0x20000
    buffer_load_dwordx4 v88, s[52:55], s64 offen lds
    s_add_u32 m0, s40, 10240
    s_add_u32 s64, s71, 0x40000
    buffer_load_dwordx4 v88, s[52:55], s64 offen lds
    s_add_u32 m0, s40, 11264
    s_add_u32 s64, s71, 0x60000
    buffer_load_dwordx4 v88, s[52:55], s64 offen lds
    s_waitcnt vmcnt(32)
    ds_read_b64_tr_b16 v[144:145], v91 offset:12288
    ds_read_b64_tr_b16 v[146:147], v91 offset:12800
    ds_read_b64_tr_b16 v[148:149], v91 offset:14336
    ds_read_b64_tr_b16 v[150:151], v91 offset:14848
    ds_read_b64_tr_b16 v[152:153], v92 offset:12288
    ds_read_b64_tr_b16 v[154:155], v92 offset:12800
    ds_read_b64_tr_b16 v[156:157], v92 offset:14336
    ds_read_b64_tr_b16 v[158:159], v92 offset:14848
    s_waitcnt lgkmcnt(0)
    s_add_u32 m0, s40, 12288
    s_add_u32 s64, s71, 0x80000
    buffer_load_dwordx4 v88, s[52:55], s64 offen lds
    s_add_u32 m0, s40, 13312
    s_add_u32 s64, s71, 0xa0000
    buffer_load_dwordx4 v88, s[52:55], s64 offen lds
    s_add_u32 m0, s40, 14336
    s_add_u32 s64, s71, 0xc0000
    buffer_load_dwordx4 v88, s[52:55], s64 offen lds
    s_add_u32 m0, s40, 15360
    s_add_u32 s64, s71, 0xe0000
    buffer_load_dwordx4 v88, s[52:55], s64 offen lds
    s_waitcnt vmcnt(32)
    ds_read_b64_tr_b16 v[160:161], v91 offset:16384
    ds_read_b64_tr_b16 v[162:163], v91 offset:16896
    ds_read_b64_tr_b16 v[164:165], v91 offset:18432
    ds_read_b64_tr_b16 v[166:167], v91 offset:18944
    ds_read_b64_tr_b16 v[168:169], v92 offset:16384
    ds_read_b64_tr_b16 v[170:171], v92 offset:16896
    ds_read_b64_tr_b16 v[172:173], v92 offset:18432
    ds_read_b64_tr_b16 v[174:175], v92 offset:18944
    s_waitcnt lgkmcnt(0)
    s_add_u32 m0, s40, 16384
    s_add_u32 s64, s71, 0x100000
    buffer_load_dwordx4 v88, s[52:55], s64 offen lds
    s_add_u32 m0, s40, 17408
    s_add_u32 s64, s71, 0x120000
    buffer_load_dwordx4 v88, s[52:55], s64 offen lds
    s_add_u32 m0, s40, 18432
    s_add_u32 s64, s71, 0x140000
    buffer_load_dwordx4 v88, s[52:55], s64 offen lds
    s_add_u32 m0, s40, 19456
    s_add_u32 s64, s71, 0x160000
    buffer_load_dwordx4 v88, s[52:55], s64 offen lds
    s_waitcnt vmcnt(32)
    ds_read_b64_tr_b16 v[176:177], v91 offset:20480
    ds_read_b64_tr_b16 v[178:179], v91 offset:20992
    ds_read_b64_tr_b16 v[180:181], v91 offset:22528
    ds_read_b64_tr_b16 v[182:183], v91 offset:23040
    ds_read_b64_tr_b16 v[184:185], v92 offset:20480
    ds_read_b64_tr_b16 v[186:187], v92 offset:20992
    ds_read_b64_tr_b16 v[188:189], v92 offset:22528
    ds_read_b64_tr_b16 v[190:191], v92 offset:23040
    s_waitcnt lgkmcnt(0)
    s_add_u32 m0, s40, 20480
    s_add_u32 s64, s71, 0x180000
    buffer_load_dwordx4 v88, s[52:55], s64 offen lds
    s_add_u32 m0, s40, 21504
    s_add_u32 s64, s71, 0x1a0000
    buffer_load_dwordx4 v88, s[52:55], s64 offen lds
    s_add_u32 m0, s40, 22528
    s_add_u32 s64, s71, 0x1c0000
    buffer_load_dwordx4 v88, s[52:55], s64 offen lds
    s_add_u32 m0, s40, 23552
    s_add_u32 s64, s71, 0x1e0000
    buffer_load_dwordx4 v88, s[52:55], s64 offen lds
    s_waitcnt vmcnt(32)
    ds_read_b64_tr_b16 v[192:193], v91 offset:24576
    ds_read_b64_tr_b16 v[194:195], v91 offset:25088
    ds_read_b64_tr_b16 v[196:197], v91 offset:26624
    ds_read_b64_tr_b16 v[198:199], v91 offset:27136
    ds_read_b64_tr_b16 v[200:201], v92 offset:24576
    ds_read_b64_tr_b16 v[202:203], v92 offset:25088
    ds_read_b64_tr_b16 v[204:205], v92 offset:26624
    ds_read_b64_tr_b16 v[206:207], v92 offset:27136
    s_waitcnt lgkmcnt(0)
    s_add_u32 m0, s40, 24576
    s_add_u32 s64, s71, 0x200000
    buffer_load_dwordx4 v88, s[52:55], s64 offen lds
    s_add_u32 m0, s40, 25600
    s_add_u32 s64, s71, 0x220000
    buffer_load_dwordx4 v88, s[52:55], s64 offen lds
    s_add_u32 m0, s40, 26624
    s_add_u32 s64, s71, 0x240000
    buffer_load_dwordx4 v88, s[52:55], s64 offen lds
    s_add_u32 m0, s40, 27648
    s_add_u32 s64, s71, 0x260000
    buffer_load_dwordx4 v88, s[52:55], s64 offen lds
    s_waitcnt vmcnt(32)
    ds_read_b64_tr_b16 v[208:209], v91 offset:28672
    ds_read_b64_tr_b16 v[210:211], v91 offset:29184
    ds_read_b64_tr_b16 v[212:213], v91 offset:30720
    ds_read_b64_tr_b16 v[214:215], v91 offset:31232
    ds_read_b64_tr_b16 v[216:217], v92 offset:28672
    ds_read_b64_tr_b16 v[218:219], v92 offset:29184
    ds_read_b64_tr_b16 v[220:221], v92 offset:30720
    ds_read_b64_tr_b16 v[222:223], v92 offset:31232
    s_waitcnt lgkmcnt(0)
    s_add_u32 m0, s40, 28672
    s_add_u32 s64, s72, 0x0
    buffer_load_dwordx4 v88, s[52:55], s64 offen lds
    s_add_u32 m0, s40, 29696
    s_add_u32 s64, s72, 0x20000
    buffer_load_dwordx4 v88, s[52:55], s64 offen lds
    s_add_u32 m0, s40, 30720
    s_add_u32 s64, s72, 0x40000
    buffer_load_dwordx4 v88, s[52:55], s64 offen lds
    s_add_u32 m0, s40, 31744
    s_add_u32 s64, s72, 0x60000
    buffer_load_dwordx4 v88, s[52:55], s64 offen lds
    s_waitcnt vmcnt(32)
    ds_read_b64_tr_b16 v[224:225], v91 offset:32768
    ds_read_b64_tr_b16 v[226:227], v91 offset:33280
    ds_read_b64_tr_b16 v[228:229], v91 offset:34816
    ds_read_b64_tr_b16 v[230:231], v91 offset:35328
    ds_read_b64_tr_b16 v[232:233], v92 offset:32768
    ds_read_b64_tr_b16 v[234:235], v92 offset:33280
    ds_read_b64_tr_b16 v[236:237], v92 offset:34816
    ds_read_b64_tr_b16 v[238:239], v92 offset:35328
    s_waitcnt lgkmcnt(0)
    s_add_u32 m0, s40, 32768
    s_add_u32 s64, s72, 0x80000
    buffer_load_dwordx4 v88, s[52:55], s64 offen lds
    s_add_u32 m0, s40, 33792
    s_add_u32 s64, s72, 0xa0000
    buffer_load_dwordx4 v88, s[52:55], s64 offen lds
    s_add_u32 m0, s40, 34816
    s_add_u32 s64, s72, 0xc0000
    buffer_load_dwordx4 v88, s[52:55], s64 offen lds
    s_add_u32 m0, s40, 35840
    s_add_u32 s64, s72, 0xe0000
    buffer_load_dwordx4 v88, s[52:55], s64 offen lds
    s_waitcnt vmcnt(32)
    ds_read_b64_tr_b16 v[240:241], v91 offset:0
    ds_read_b64_tr_b16 v[242:243], v91 offset:512
    ds_read_b64_tr_b16 v[244:245], v91 offset:2048
    ds_read_b64_tr_b16 v[246:247], v91 offset:2560
    ds_read_b64_tr_b16 v[248:249], v92 offset:0
    ds_read_b64_tr_b16 v[250:251], v92 offset:512
    ds_read_b64_tr_b16 v[252:253], v92 offset:2048
    ds_read_b64_tr_b16 v[254:255], v92 offset:2560
    s_waitcnt lgkmcnt(0)
    s_add_u32 m0, s40, 0
    s_add_u32 s64, s72, 0x100000
    buffer_load_dwordx4 v88, s[52:55], s64 offen lds
    s_add_u32 m0, s40, 1024
    s_add_u32 s64, s72, 0x120000
    buffer_load_dwordx4 v88, s[52:55], s64 offen lds
    s_add_u32 m0, s40, 2048
    s_add_u32 s64, s72, 0x140000
    buffer_load_dwordx4 v88, s[52:55], s64 offen lds
    s_add_u32 m0, s40, 3072
    s_add_u32 s64, s72, 0x160000
    buffer_load_dwordx4 v88, s[52:55], s64 offen lds
    s_waitcnt vmcnt(32)
    ds_read_b64_tr_b16 a[240:241], v91 offset:4096
    ds_read_b64_tr_b16 a[242:243], v91 offset:4608
    ds_read_b64_tr_b16 a[244:245], v91 offset:6144
    ds_read_b64_tr_b16 a[246:247], v91 offset:6656
    ds_read_b64_tr_b16 a[248:249], v92 offset:4096
    ds_read_b64_tr_b16 a[250:251], v92 offset:4608
    ds_read_b64_tr_b16 a[252:253], v92 offset:6144
    ds_read_b64_tr_b16 a[254:255], v92 offset:6656
    s_waitcnt lgkmcnt(0)
    s_add_u32 m0, s40, 4096
    s_add_u32 s64, s72, 0x180000
    buffer_load_dwordx4 v88, s[52:55], s64 offen lds
    s_add_u32 m0, s40, 5120
    s_add_u32 s64, s72, 0x1a0000
    buffer_load_dwordx4 v88, s[52:55], s64 offen lds
    s_add_u32 m0, s40, 6144
    s_add_u32 s64, s72, 0x1c0000
    buffer_load_dwordx4 v88, s[52:55], s64 offen lds
    s_add_u32 m0, s40, 7168
    s_add_u32 s64, s72, 0x1e0000
    buffer_load_dwordx4 v88, s[52:55], s64 offen lds
    s_waitcnt vmcnt(32)
    ds_read_b64_tr_b16 a[0:1], v91 offset:8192
    ds_read_b64_tr_b16 a[2:3], v91 offset:8704
    ds_read_b64_tr_b16 a[4:5], v91 offset:10240
    ds_read_b64_tr_b16 a[6:7], v91 offset:10752
    ds_read_b64_tr_b16 a[8:9], v92 offset:8192
    ds_read_b64_tr_b16 a[10:11], v92 offset:8704
    ds_read_b64_tr_b16 a[12:13], v92 offset:10240
    ds_read_b64_tr_b16 a[14:15], v92 offset:10752
    s_waitcnt lgkmcnt(0)
    s_add_u32 m0, s40, 8192
    s_add_u32 s64, s72, 0x200000
    buffer_load_dwordx4 v88, s[52:55], s64 offen lds
    s_add_u32 m0, s40, 9216
    s_add_u32 s64, s72, 0x220000
    buffer_load_dwordx4 v88, s[52:55], s64 offen lds
    s_add_u32 m0, s40, 10240
    s_add_u32 s64, s72, 0x240000
    buffer_load_dwordx4 v88, s[52:55], s64 offen lds
    s_add_u32 m0, s40, 11264
    s_add_u32 s64, s72, 0x260000
    buffer_load_dwordx4 v88, s[52:55], s64 offen lds
    s_waitcnt vmcnt(32)
    ds_read_b64_tr_b16 a[16:17], v91 offset:12288
    ds_read_b64_tr_b16 a[18:19], v91 offset:12800
    ds_read_b64_tr_b16 a[20:21], v91 offset:14336
    ds_read_b64_tr_b16 a[22:23], v91 offset:14848
    ds_read_b64_tr_b16 a[24:25], v92 offset:12288
    ds_read_b64_tr_b16 a[26:27], v92 offset:12800
    ds_read_b64_tr_b16 a[28:29], v92 offset:14336
    ds_read_b64_tr_b16 a[30:31], v92 offset:14848
    s_waitcnt lgkmcnt(0)
    s_add_u32 m0, s40, 12288
    s_add_u32 s64, s39, 0x0
    buffer_load_dwordx4 v89, s[56:59], s64 offen lds
    s_add_u32 m0, s40, 13312
    s_add_u32 s64, s39, 0x5000
    buffer_load_dwordx4 v89, s[56:59], s64 offen lds
    s_add_u32 m0, s40, 14336
    s_add_u32 s64, s39, 0xa000
    buffer_load_dwordx4 v89, s[56:59], s64 offen lds
    s_add_u32 m0, s40, 15360
    s_add_u32 s64, s39, 0xf000
    buffer_load_dwordx4 v89, s[56:59], s64 offen lds
    s_waitcnt vmcnt(32)
    ds_read_b64_tr_b16 a[32:33], v91 offset:16384
    ds_read_b64_tr_b16 a[34:35], v91 offset:16896
    ds_read_b64_tr_b16 a[36:37], v91 offset:18432
    ds_read_b64_tr_b16 a[38:39], v91 offset:18944
    ds_read_b64_tr_b16 a[40:41], v92 offset:16384
    ds_read_b64_tr_b16 a[42:43], v92 offset:16896
    ds_read_b64_tr_b16 a[44:45], v92 offset:18432
    ds_read_b64_tr_b16 a[46:47], v92 offset:18944
    s_waitcnt lgkmcnt(0)
    s_add_u32 m0, s40, 16384
    s_add_u32 s64, s39, 0x14000
    buffer_load_dwordx4 v89, s[56:59], s64 offen lds
    s_add_u32 m0, s40, 17408
    s_add_u32 s64, s39, 0x19000
    buffer_load_dwordx4 v89, s[56:59], s64 offen lds
    s_add_u32 m0, s40, 18432
    s_add_u32 s64, s39, 0x1e000
    buffer_load_dwordx4 v89, s[56:59], s64 offen lds
    s_add_u32 m0, s40, 19456
    s_add_u32 s64, s39, 0x23000
    buffer_load_dwordx4 v89, s[56:59], s64 offen lds
    s_waitcnt vmcnt(32)
    ds_read_b64_tr_b16 a[48:49], v91 offset:20480
    ds_read_b64_tr_b16 a[50:51], v91 offset:20992
    ds_read_b64_tr_b16 a[52:53], v91 offset:22528
    ds_read_b64_tr_b16 a[54:55], v91 offset:23040
    ds_read_b64_tr_b16 a[56:57], v92 offset:20480
    ds_read_b64_tr_b16 a[58:59], v92 offset:20992
    ds_read_b64_tr_b16 a[60:61], v92 offset:22528
    ds_read_b64_tr_b16 a[62:63], v92 offset:23040
    s_waitcnt lgkmcnt(0)
    s_add_u32 m0, s40, 20480
    s_add_u32 s64, s39, 0x100
    buffer_load_dwordx4 v89, s[56:59], s64 offen lds
    s_add_u32 m0, s40, 21504
    s_add_u32 s64, s39, 0x5100
    buffer_load_dwordx4 v89, s[56:59], s64 offen lds
    s_add_u32 m0, s40, 22528
    s_add_u32 s64, s39, 0xa100
    buffer_load_dwordx4 v89, s[56:59], s64 offen lds
    s_add_u32 m0, s40, 23552
    s_add_u32 s64, s39, 0xf100
    buffer_load_dwordx4 v89, s[56:59], s64 offen lds
    s_waitcnt vmcnt(32)
    ds_read_b64_tr_b16 a[64:65], v91 offset:24576
    ds_read_b64_tr_b16 a[66:67], v91 offset:25088
    ds_read_b64_tr_b16 a[68:69], v91 offset:26624
    ds_read_b64_tr_b16 a[70:71], v91 offset:27136
    ds_read_b64_tr_b16 a[72:73], v92 offset:24576
    ds_read_b64_tr_b16 a[74:75], v92 offset:25088
    ds_read_b64_tr_b16 a[76:77], v92 offset:26624
    ds_read_b64_tr_b16 a[78:79], v92 offset:27136
    s_waitcnt lgkmcnt(0)
    s_add_u32 m0, s40, 24576
    s_add_u32 s64, s39, 0x14100
    buffer_load_dwordx4 v89, s[56:59], s64 offen lds
    s_add_u32 m0, s40, 25600
    s_add_u32 s64, s39, 0x19100
    buffer_load_dwordx4 v89, s[56:59], s64 offen lds
    s_add_u32 m0, s40, 26624
    s_add_u32 s64, s39, 0x1e100
    buffer_load_dwordx4 v89, s[56:59], s64 offen lds
    s_add_u32 m0, s40, 27648
    s_add_u32 s64, s39, 0x23100
    buffer_load_dwordx4 v89, s[56:59], s64 offen lds
    s_waitcnt vmcnt(32)
    ds_read_b64_tr_b16 a[80:81], v91 offset:28672
    ds_read_b64_tr_b16 a[82:83], v91 offset:29184
    ds_read_b64_tr_b16 a[84:85], v91 offset:30720
    ds_read_b64_tr_b16 a[86:87], v91 offset:31232
    ds_read_b64_tr_b16 a[88:89], v92 offset:28672
    ds_read_b64_tr_b16 a[90:91], v92 offset:29184
    ds_read_b64_tr_b16 a[92:93], v92 offset:30720
    ds_read_b64_tr_b16 a[94:95], v92 offset:31232
    s_waitcnt lgkmcnt(0)
    s_add_u32 m0, s40, 28672
    s_add_u32 s64, s41, 0x0
    buffer_load_dwordx4 v90, s[56:59], s64 offen lds
    s_add_u32 m0, s40, 29696
    s_add_u32 s64, s41, 0xa000
    buffer_load_dwordx4 v90, s[56:59], s64 offen lds
    s_add_u32 m0, s40, 30720
    s_add_u32 s64, s41, 0x14000
    buffer_load_dwordx4 v90, s[56:59], s64 offen lds
    s_add_u32 m0, s40, 31744
    s_add_u32 s64, s41, 0x1e000
    buffer_load_dwordx4 v90, s[56:59], s64 offen lds
    s_waitcnt vmcnt(32)
    ds_read_b64_tr_b16 a[96:97], v91 offset:32768
    ds_read_b64_tr_b16 a[98:99], v91 offset:33280
    ds_read_b64_tr_b16 a[100:101], v91 offset:34816
    ds_read_b64_tr_b16 a[102:103], v91 offset:35328
    ds_read_b64_tr_b16 a[104:105], v92 offset:32768
    ds_read_b64_tr_b16 a[106:107], v92 offset:33280
    ds_read_b64_tr_b16 a[108:109], v92 offset:34816
    ds_read_b64_tr_b16 a[110:111], v92 offset:35328
    s_waitcnt lgkmcnt(0)
    s_add_u32 m0, s40, 32768
    s_add_u32 s64, s72, 0x180000
    buffer_load_dwordx4 v88, s[48:51], s64 offen lds
    s_add_u32 m0, s40, 33792
    s_add_u32 s64, s72, 0x1a0000
    buffer_load_dwordx4 v88, s[48:51], s64 offen lds
    s_add_u32 m0, s40, 34816
    s_add_u32 s64, s72, 0x1c0000
    buffer_load_dwordx4 v88, s[48:51], s64 offen lds
    s_add_u32 m0, s40, 35840
    s_add_u32 s64, s72, 0x1e0000
    buffer_load_dwordx4 v88, s[48:51], s64 offen lds
    s_waitcnt vmcnt(32)
    ds_read_b64_tr_b16 a[112:113], v91 offset:0
    ds_read_b64_tr_b16 a[114:115], v91 offset:512
    ds_read_b64_tr_b16 a[116:117], v91 offset:2048
    ds_read_b64_tr_b16 a[118:119], v91 offset:2560
    ds_read_b64_tr_b16 a[120:121], v92 offset:0
    ds_read_b64_tr_b16 a[122:123], v92 offset:512
    ds_read_b64_tr_b16 a[124:125], v92 offset:2048
    ds_read_b64_tr_b16 a[126:127], v92 offset:2560
    s_waitcnt lgkmcnt(0)
    s_add_u32 m0, s40, 0
    s_add_u32 s64, s71, 0x0
    buffer_load_dwordx4 v88, s[48:51], s64 offen lds
    s_add_u32 m0, s40, 1024
    s_add_u32 s64, s71, 0x20000
    buffer_load_dwordx4 v88, s[48:51], s64 offen lds
    s_add_u32 m0, s40, 2048
    s_add_u32 s64, s71, 0x40000
    buffer_load_dwordx4 v88, s[48:51], s64 offen lds
    s_add_u32 m0, s40, 3072
    s_add_u32 s64, s71, 0x60000
    buffer_load_dwordx4 v88, s[48:51], s64 offen lds
    s_waitcnt vmcnt(32)
    ds_read_b64_tr_b16 a[128:129], v91 offset:4096
    ds_read_b64_tr_b16 a[130:131], v91 offset:4608
    ds_read_b64_tr_b16 a[132:133], v91 offset:6144
    ds_read_b64_tr_b16 a[134:135], v91 offset:6656
    ds_read_b64_tr_b16 a[136:137], v92 offset:4096
    ds_read_b64_tr_b16 a[138:139], v92 offset:4608
    ds_read_b64_tr_b16 a[140:141], v92 offset:6144
    ds_read_b64_tr_b16 a[142:143], v92 offset:6656
    s_waitcnt lgkmcnt(0)
    s_add_u32 m0, s40, 4096
    s_add_u32 s64, s71, 0x80000
    buffer_load_dwordx4 v88, s[48:51], s64 offen lds
    s_add_u32 m0, s40, 5120
    s_add_u32 s64, s71, 0xa0000
    buffer_load_dwordx4 v88, s[48:51], s64 offen lds
    s_add_u32 m0, s40, 6144
    s_add_u32 s64, s71, 0xc0000
    buffer_load_dwordx4 v88, s[48:51], s64 offen lds
    s_add_u32 m0, s40, 7168
    s_add_u32 s64, s71, 0xe0000
    buffer_load_dwordx4 v88, s[48:51], s64 offen lds
    s_waitcnt vmcnt(32)
    ds_read_b64_tr_b16 a[144:145], v91 offset:8192
    ds_read_b64_tr_b16 a[146:147], v91 offset:8704
    ds_read_b64_tr_b16 a[148:149], v91 offset:10240
    ds_read_b64_tr_b16 a[150:151], v91 offset:10752
    ds_read_b64_tr_b16 a[152:153], v92 offset:8192
    ds_read_b64_tr_b16 a[154:155], v92 offset:8704
    ds_read_b64_tr_b16 a[156:157], v92 offset:10240
    ds_read_b64_tr_b16 a[158:159], v92 offset:10752
    s_waitcnt lgkmcnt(0)
    s_add_u32 m0, s40, 8192
    s_add_u32 s64, s71, 0x100000
    buffer_load_dwordx4 v88, s[48:51], s64 offen lds
    s_add_u32 m0, s40, 9216
    s_add_u32 s64, s71, 0x120000
    buffer_load_dwordx4 v88, s[48:51], s64 offen lds
    s_add_u32 m0, s40, 10240
    s_add_u32 s64, s71, 0x140000
    buffer_load_dwordx4 v88, s[48:51], s64 offen lds
    s_add_u32 m0, s40, 11264
    s_add_u32 s64, s71, 0x160000
    buffer_load_dwordx4 v88, s[48:51], s64 offen lds
    s_waitcnt vmcnt(32)
    ds_read_b64_tr_b16 a[160:161], v93 offset:12288
    ds_read_b64_tr_b16 a[162:163], v93 offset:12544
    ds_read_b64_tr_b16 a[164:165], v93 offset:13312
    ds_read_b64_tr_b16 a[166:167], v93 offset:13568
    ds_read_b64_tr_b16 a[168:169], v93 offset:14336
    ds_read_b64_tr_b16 a[170:171], v93 offset:14592
    ds_read_b64_tr_b16 a[172:173], v93 offset:15360
    ds_read_b64_tr_b16 a[174:175], v93 offset:15616
    s_waitcnt lgkmcnt(0)
    s_add_u32 m0, s40, 12288
    s_add_u32 s64, s71, 0x180000
    buffer_load_dwordx4 v88, s[48:51], s64 offen lds
    s_add_u32 m0, s40, 13312
    s_add_u32 s64, s71, 0x1a0000
    buffer_load_dwordx4 v88, s[48:51], s64 offen lds
    s_add_u32 m0, s40, 14336
    s_add_u32 s64, s71, 0x1c0000
    buffer_load_dwordx4 v88, s[48:51], s64 offen lds
    s_add_u32 m0, s40, 15360
    s_add_u32 s64, s71, 0x1e0000
    buffer_load_dwordx4 v88, s[48:51], s64 offen lds
    s_waitcnt vmcnt(32)
    ds_read_b64_tr_b16 a[176:177], v93 offset:16384
    ds_read_b64_tr_b16 a[178:179], v93 offset:16640
    ds_read_b64_tr_b16 a[180:181], v93 offset:17408
    ds_read_b64_tr_b16 a[182:183], v93 offset:17664
    ds_read_b64_tr_b16 a[184:185], v93 offset:18432
    ds_read_b64_tr_b16 a[186:187], v93 offset:18688
    ds_read_b64_tr_b16 a[188:189], v93 offset:19456
    ds_read_b64_tr_b16 a[190:191], v93 offset:19712
    s_waitcnt lgkmcnt(0)
    s_add_u32 m0, s40, 16384
    s_add_u32 s64, s71, 0x200000
    buffer_load_dwordx4 v88, s[48:51], s64 offen lds
    s_add_u32 m0, s40, 17408
    s_add_u32 s64, s71, 0x220000
    buffer_load_dwordx4 v88, s[48:51], s64 offen lds
    s_add_u32 m0, s40, 18432
    s_add_u32 s64, s71, 0x240000
    buffer_load_dwordx4 v88, s[48:51], s64 offen lds
    s_add_u32 m0, s40, 19456
    s_add_u32 s64, s71, 0x260000
    buffer_load_dwordx4 v88, s[48:51], s64 offen lds
    s_waitcnt vmcnt(32)
    ds_read_b64_tr_b16 a[192:193], v93 offset:20480
    ds_read_b64_tr_b16 a[194:195], v93 offset:20736
    ds_read_b64_tr_b16 a[196:197], v93 offset:21504
    ds_read_b64_tr_b16 a[198:199], v93 offset:21760
    ds_read_b64_tr_b16 a[200:201], v93 offset:22528
    ds_read_b64_tr_b16 a[202:203], v93 offset:22784
    ds_read_b64_tr_b16 a[204:205], v93 offset:23552
    ds_read_b64_tr_b16 a[206:207], v93 offset:23808
    s_waitcnt lgkmcnt(0)
    s_add_u32 m0, s40, 20480
    s_add_u32 s64, s72, 0x0
    buffer_load_dwordx4 v88, s[48:51], s64 offen lds
    s_add_u32 m0, s40, 21504
    s_add_u32 s64, s72, 0x20000
    buffer_load_dwordx4 v88, s[48:51], s64 offen lds
    s_add_u32 m0, s40, 22528
    s_add_u32 s64, s72, 0x40000
    buffer_load_dwordx4 v88, s[48:51], s64 offen lds
    s_add_u32 m0, s40, 23552
    s_add_u32 s64, s72, 0x60000
    buffer_load_dwordx4 v88, s[48:51], s64 offen lds
    s_waitcnt vmcnt(32)
    ds_read_b64_tr_b16 a[208:209], v93 offset:24576
    ds_read_b64_tr_b16 a[210:211], v93 offset:24832
    ds_read_b64_tr_b16 a[212:213], v93 offset:25600
    ds_read_b64_tr_b16 a[214:215], v93 offset:25856
    ds_read_b64_tr_b16 a[216:217], v93 offset:26624
    ds_read_b64_tr_b16 a[218:219], v93 offset:26880
    ds_read_b64_tr_b16 a[220:221], v93 offset:27648
    ds_read_b64_tr_b16 a[222:223], v93 offset:27904
    s_waitcnt lgkmcnt(0)
    s_add_u32 m0, s40, 24576
    s_add_u32 s64, s72, 0x80000
    buffer_load_dwordx4 v88, s[48:51], s64 offen lds
    s_add_u32 m0, s40, 25600
    s_add_u32 s64, s72, 0xa0000
    buffer_load_dwordx4 v88, s[48:51], s64 offen lds
    s_add_u32 m0, s40, 26624
    s_add_u32 s64, s72, 0xc0000
    buffer_load_dwordx4 v88, s[48:51], s64 offen lds
    s_add_u32 m0, s40, 27648
    s_add_u32 s64, s72, 0xe0000
    buffer_load_dwordx4 v88, s[48:51], s64 offen lds
    s_waitcnt vmcnt(32)
    ds_read_b64_tr_b16 a[224:225], v94 offset:28672
    ds_read_b64_tr_b16 a[226:227], v94 offset:28800
    ds_read_b64_tr_b16 a[228:229], v94 offset:29696
    ds_read_b64_tr_b16 a[230:231], v94 offset:29824
    ds_read_b64_tr_b16 a[232:233], v94 offset:30720
    ds_read_b64_tr_b16 a[234:235], v94 offset:30848
    ds_read_b64_tr_b16 a[236:237], v94 offset:31744
    ds_read_b64_tr_b16 a[238:239], v94 offset:31872
    s_waitcnt lgkmcnt(0)
    s_add_u32 m0, s40, 28672
    s_add_u32 s64, s72, 0x100000
    buffer_load_dwordx4 v88, s[48:51], s64 offen lds
    s_add_u32 m0, s40, 29696
    s_add_u32 s64, s72, 0x120000
    buffer_load_dwordx4 v88, s[48:51], s64 offen lds
    s_add_u32 m0, s40, 30720
    s_add_u32 s64, s72, 0x140000
    buffer_load_dwordx4 v88, s[48:51], s64 offen lds
    s_add_u32 m0, s40, 31744
    s_add_u32 s64, s72, 0x160000
    buffer_load_dwordx4 v88, s[48:51], s64 offen lds
    s_waitcnt vmcnt(32)
    ds_read_b64_tr_b16 v[12:13], v91 offset:32768
    ds_read_b64_tr_b16 v[14:15], v91 offset:33280
    ds_read_b64_tr_b16 v[16:17], v91 offset:34816
    ds_read_b64_tr_b16 v[18:19], v91 offset:35328
    ds_read_b64_tr_b16 v[20:21], v92 offset:32768
    ds_read_b64_tr_b16 v[22:23], v92 offset:33280
    ds_read_b64_tr_b16 v[24:25], v92 offset:34816
    ds_read_b64_tr_b16 v[26:27], v92 offset:35328
    s_waitcnt lgkmcnt(0)
    ds_write_b128 v2, v[12:15] offset:32768
    ds_write_b128 v2, v[16:19] offset:33792
    ds_write_b128 v2, v[20:23] offset:34816
    ds_write_b128 v2, v[24:27] offset:35840
    s_waitcnt lgkmcnt(0)
    s_waitcnt vmcnt(28)
    ds_read_b64_tr_b16 v[12:13], v91 offset:0
    ds_read_b64_tr_b16 v[14:15], v91 offset:512
    ds_read_b64_tr_b16 v[16:17], v91 offset:2048
    ds_read_b64_tr_b16 v[18:19], v91 offset:2560
    ds_read_b64_tr_b16 v[20:21], v92 offset:0
    ds_read_b64_tr_b16 v[22:23], v92 offset:512
    ds_read_b64_tr_b16 v[24:25], v92 offset:2048
    ds_read_b64_tr_b16 v[26:27], v92 offset:2560
    s_waitcnt lgkmcnt(0)
    ds_write_b128 v2, v[12:15] offset:0
    ds_write_b128 v2, v[16:19] offset:1024
    ds_write_b128 v2, v[20:23] offset:2048
    ds_write_b128 v2, v[24:27] offset:3072
    s_waitcnt lgkmcnt(0)
    s_waitcnt vmcnt(24)
    ds_read_b64_tr_b16 v[12:13], v91 offset:4096
    ds_read_b64_tr_b16 v[14:15], v91 offset:4608
    ds_read_b64_tr_b16 v[16:17], v91 offset:6144
    ds_read_b64_tr_b16 v[18:19], v91 offset:6656
    ds_read_b64_tr_b16 v[20:21], v92 offset:4096
    ds_read_b64_tr_b16 v[22:23], v92 offset:4608
    ds_read_b64_tr_b16 v[24:25], v92 offset:6144
    ds_read_b64_tr_b16 v[26:27], v92 offset:6656
    s_waitcnt lgkmcnt(0)
    ds_write_b128 v2, v[12:15] offset:4096
    ds_write_b128 v2, v[16:19] offset:5120
    ds_write_b128 v2, v[20:23] offset:6144
    ds_write_b128 v2, v[24:27] offset:7168
    s_waitcnt lgkmcnt(0)
    s_waitcnt vmcnt(20)
    ds_read_b64_tr_b16 v[12:13], v91 offset:8192
    ds_read_b64_tr_b16 v[14:15], v91 offset:8704
    ds_read_b64_tr_b16 v[16:17], v91 offset:10240
    ds_read_b64_tr_b16 v[18:19], v91 offset:10752
    ds_read_b64_tr_b16 v[20:21], v92 offset:8192
    ds_read_b64_tr_b16 v[22:23], v92 offset:8704
    ds_read_b64_tr_b16 v[24:25], v92 offset:10240
    ds_read_b64_tr_b16 v[26:27], v92 offset:10752
    s_waitcnt lgkmcnt(0)
    ds_write_b128 v2, v[12:15] offset:8192
    ds_write_b128 v2, v[16:19] offset:9216
    ds_write_b128 v2, v[20:23] offset:10240
    ds_write_b128 v2, v[24:27] offset:11264
    s_waitcnt lgkmcnt(0)
    s_waitcnt vmcnt(16)
    ds_read_b64_tr_b16 v[12:13], v91 offset:12288
    ds_read_b64_tr_b16 v[14:15], v91 offset:12800
    ds_read_b64_tr_b16 v[16:17], v91 offset:14336
    ds_read_b64_tr_b16 v[18:19], v91 offset:14848
    ds_read_b64_tr_b16 v[20:21], v92 offset:12288
    ds_read_b64_tr_b16 v[22:23], v92 offset:12800
    ds_read_b64_tr_b16 v[24:25], v92 offset:14336
    ds_read_b64_tr_b16 v[26:27], v92 offset:14848
    s_waitcnt lgkmcnt(0)
    ds_write_b128 v2, v[12:15] offset:12288
    ds_write_b128 v2, v[16:19] offset:13312
    ds_write_b128 v2, v[20:23] offset:14336
    ds_write_b128 v2, v[24:27] offset:15360
    s_waitcnt lgkmcnt(0)
    s_waitcnt vmcnt(12)
    ds_read_b64_tr_b16 v[12:13], v91 offset:16384
    ds_read_b64_tr_b16 v[14:15], v91 offset:16896
    ds_read_b64_tr_b16 v[16:17], v91 offset:18432
    ds_read_b64_tr_b16 v[18:19], v91 offset:18944
    ds_read_b64_tr_b16 v[20:21], v92 offset:16384
    ds_read_b64_tr_b16 v[22:23], v92 offset:16896
    ds_read_b64_tr_b16 v[24:25], v92 offset:18432
    ds_read_b64_tr_b16 v[26:27], v92 offset:18944
    s_waitcnt lgkmcnt(0)
    ds_write_b128 v2, v[12:15] offset:16384
    ds_write_b128 v2, v[16:19] offset:17408
    ds_write_b128 v2, v[20:23] offset:18432
    ds_write_b128 v2, v[24:27] offset:19456
    s_waitcnt lgkmcnt(0)
    s_waitcnt vmcnt(8)
    ds_read_b64_tr_b16 v[12:13], v91 offset:20480
    ds_read_b64_tr_b16 v[14:15], v91 offset:20992
    ds_read_b64_tr_b16 v[16:17], v91 offset:22528
    ds_read_b64_tr_b16 v[18:19], v91 offset:23040
    ds_read_b64_tr_b16 v[20:21], v92 offset:20480
    ds_read_b64_tr_b16 v[22:23], v92 offset:20992
    ds_read_b64_tr_b16 v[24:25], v92 offset:22528
    ds_read_b64_tr_b16 v[26:27], v92 offset:23040
    s_waitcnt lgkmcnt(0)
    ds_write_b128 v2, v[12:15] offset:20480
    ds_write_b128 v2, v[16:19] offset:21504
    ds_write_b128 v2, v[20:23] offset:22528
    ds_write_b128 v2, v[24:27] offset:23552
    s_waitcnt lgkmcnt(0)
    s_waitcnt vmcnt(4)
    ds_read_b64_tr_b16 v[12:13], v91 offset:24576
    ds_read_b64_tr_b16 v[14:15], v91 offset:25088
    ds_read_b64_tr_b16 v[16:17], v91 offset:26624
    ds_read_b64_tr_b16 v[18:19], v91 offset:27136
    ds_read_b64_tr_b16 v[20:21], v92 offset:24576
    ds_read_b64_tr_b16 v[22:23], v92 offset:25088
    ds_read_b64_tr_b16 v[24:25], v92 offset:26624
    ds_read_b64_tr_b16 v[26:27], v92 offset:27136
    s_waitcnt lgkmcnt(0)
    ds_write_b128 v2, v[12:15] offset:24576
    ds_write_b128 v2, v[16:19] offset:25600
    ds_write_b128 v2, v[20:23] offset:26624
    ds_write_b128 v2, v[24:27] offset:27648
    s_waitcnt lgkmcnt(0)
    s_waitcnt vmcnt(0)
    ds_read_b64_tr_b16 v[12:13], v91 offset:28672
    ds_read_b64_tr_b16 v[14:15], v91 offset:29184
    ds_read_b64_tr_b16 v[16:17], v91 offset:30720
    ds_read_b64_tr_b16 v[18:19], v91 offset:31232
    ds_read_b64_tr_b16 v[20:21], v92 offset:28672
    ds_read_b64_tr_b16 v[22:23], v92 offset:29184
    ds_read_b64_tr_b16 v[24:25], v92 offset:30720
    ds_read_b64_tr_b16 v[26:27], v92 offset:31232
    s_waitcnt lgkmcnt(0)
    ds_write_b128 v2, v[12:15] offset:28672
    ds_write_b128 v2, v[16:19] offset:29696
    ds_write_b128 v2, v[20:23] offset:30720
    ds_write_b128 v2, v[24:27] offset:31744
    s_waitcnt lgkmcnt(0)
    s_cmp_lg_u32 s97, 0
    s_cbranch_scc1 CM_7
    v_mbcnt_lo_u32_b32 v0, -1, 0
    v_mbcnt_hi_u32_b32 v0, -1, v0
    v_mul_u32_u24 v8, 32, v0
    s_mov_b32 s64, 0x0
    s_mov_b32 s65, 0
    s_mov_b64 exec, 0xff
TK_8:
    buffer_load_dword v9, v8, s[60:63], s64 offen sc1
    s_add_u32 s65, s65, 1
    s_waitcnt vmcnt(0)
    s_mov_b32 s66, 0
    v_readlane_b32 s67, v9, 0
    s_add_u32 s66, s66, s67
    v_readlane_b32 s67, v9, 1
    s_add_u32 s66, s66, s67
    v_readlane_b32 s67, v9, 2
    s_add_u32 s66, s66, s67
    v_readlane_b32 s67, v9, 3
    s_add_u32 s66, s66, s67
    v_readlane_b32 s67, v9, 4
    s_add_u32 s66, s66, s67
    v_readlane_b32 s67, v9, 5
    s_add_u32 s66, s66, s67
    v_readlane_b32 s67, v9, 6
    s_add_u32 s66, s66, s67
    v_readlane_b32 s67, v9, 7
    s_add_u32 s66, s66, s67
    s_cmp_ge_u32 s66, 256
    s_cbranch_scc1 TKD_9
    s_cmp_gt_u32 s65, 262144
    s_cbranch_scc0 TK_8
TKD_9:
    v_cmp_ne_u32 vcc, 32, v9
    s_mov_b64 exec, -1
    s_cbranch_vccnz M_SLOW
CM_7:
    s_mov_b32 s65, 0
RI_10:
    buffer_load_dword v8, off, s[60:63], s95 sc1
    s_add_u32 s65, s65, 1
    s_waitcnt vmcnt(0)
    v_readfirstlane_b32 s64, v8
    s_cmp_ge_u32 s64, 192
    s_cbranch_scc1 RID_11
    s_cmp_gt_u32 s65, 65536
    s_cbranch_scc1 RID_11
    s_sleep 4
    s_branch RI_10
RID_11:
    s_mov_b32 s38, 0x3f80
    s_mov_b32 s53, 0
    s_cmp_eq_u32 s14, 2
    s_cselect_b32 s52, 1024, 0
    s_mov_b32 s44, 0x3030303
    s_mov_b32 s45, 0x3030303
    s_mov_b32 s46, 0xc0c0c0c
    s_mov_b32 s47, 0xc0c0c0c
    s_mov_b32 s48, 0x30303030
    s_mov_b32 s49, 0x30303030
    s_mov_b32 s50, 0xc0c0c0c0
    s_mov_b32 s51, 0xc0c0c0c0
    v_and_b32 v8, 7, v0
    v_mul_u32_u24 v8, 288, v8
    v_lshrrev_b32 v9, 4, v0
    v_lshl_add_u32 v8, v9, 4, v8
    v_add_u32 v0, 12800, v8
    s_mov_b32 s68, 0
    s_mov_b32 s40, 0
    s_mov_b32 s65, 0
CW_12:
    buffer_load_dwordx2 v[8:9], off, s[60:63], 0 offset:132 sc1
    s_add_u32 s65, s65, 1
    s_waitcnt vmcnt(0)
    v_readfirstlane_b32 s66, v8
    v_readfirstlane_b32 s67, v9
    s_min_u32 s64, s66, s67
    s_cmp_lg_u32 s64, 0
    s_cbranch_scc1 CWD_13
    s_cmp_gt_u32 s65, 65536
    s_cbranch_scc1 CWD_13
    s_sleep 4
    s_branch CW_12
CWD_13:
    s_sub_u32 s66, s66, 1
    s_and_b32 s66, s66, 3
    s_sub_u32 s67, s67, 1
    s_and_b32 s67, s67, 3
    s_mov_b32 s64, s66
    s_mov_b32 s65, s67
    s_cmp_eq_u32 s12, 0
    s_cselect_b32 s66, s65, s64
    s_cselect_b32 s64, s64, s65
    s_and_b32 s64, s64, 3
    s_lshl_b32 s64, s64, 13
    s_and_b32 s66, s66, 3
    s_lshl_b32 s66, s66, 13
    s_add_u32 s21, s21, s64
    s_add_u32 s20, s20, s66
    s_cmp_eq_u32 s42, 0
    s_cselect_b32 s18, 0x40000000, s18
    s_cselect_b32 s21, 0x40000000, s21
    s_lshl_b32 s65, s12, 7
    s_add_u32 s65, s65, 0x29a000
    s_cmp_eq_u32 s22, 0
    s_cselect_b32 s22, 0x40000000, s65
    s_lshl_b32 s64, s13, 2
    s_add_u32 s64, s64, s14
    s_cmp_ge_u32 s64, 40
    s_cselect_b32 s65, 40, 0
    s_sub_u32 s64, s64, s65
    s_cmp_ge_u32 s64, 40
    s_cselect_b32 s65, 40, 0
    s_sub_u32 s64, s64, s65
    s_cmp_ge_u32 s64, 40
    s_cselect_b32 s65, 40, 0
    s_sub_u32 s64, s64, s65
    s_lshl_b32 s27, s64, 7
    s_add_u32 s19, s27, 0x4000
    v_mov_b32 v29, 0
FSPIN_14:
    buffer_load_dwordx2 v[12:13], v29, s[4:7], s69 offen sc1
    s_add_u32 s68, s68, 1
    s_waitcnt vmcnt(0)
    v_and_b32 v12, v12, v13
    v_cmp_eq_u32 vcc, 0, v12
    s_cbranch_vccz FDONE_15
    s_cmp_gt_u32 s68, 262144
    s_cbranch_scc0 FSPIN_14
FDONE_15:
    s_barrier
    s_mov_b32 m0, s73
    s_nop 0
    buffer_load_dwordx4 v1, s[4:7], s28 offen lds
    buffer_load_dwordx4 v1, s[4:7], s28 offen offset:1024 lds
    s_mov_b32 m0, 16128
    v_lshlrev_b32 v12, 2, v1
    s_add_u32 s65, s3, 0xfff80000
    buffer_load_dword v12, s[4:7], s65 offen lds
    s_mov_b32 s15, 0
    s_mov_b32 s16, 0
    s_add_u32 s66, s17, s52
    buffer_load_dwordx4 v[12:15], v1, s[4:7], s66 offen sc1
    buffer_load_dwordx4 v[16:19], v1, s[4:7], s17 offen offset:2048 sc1
    v_add_u32 v29, s52, v1
    s_waitcnt vmcnt(0)
    ds_write_b128 v29, v[12:15] offset:12800
    ds_write_b128 v1, v[16:19] offset:15104
    s_waitcnt lgkmcnt(0)
    v_mov_b64 v[32:33], 0
    v_mov_b64 v[34:35], 0
    v_mov_b64 v[36:37], 0
    v_mov_b64 v[38:39], 0
    v_mov_b64 v[40:41], 0
    v_mov_b64 v[42:43], 0
    v_mov_b64 v[44:45], 0
    v_mov_b64 v[46:47], 0
    v_mov_b64 v[48:49], 0
    v_mov_b64 v[50:51], 0
    v_mov_b64 v[52:53], 0
    v_mov_b64 v[54:55], 0
    v_mov_b32 v9, 0x40000000
    ds_read_b128 v[56:59], v2 offset:0
    ds_read_b128 v[60:63], v2 offset:1024
    ds_read_b128 v[64:67], v2 offset:2048
    ds_read_b128 v[68:71], v2 offset:3072
    s_cmp_eq_u32 s97, 0
    s_cbranch_scc1 REC_LOOP
    s_branch REC_LOOP_S
REC_POLL_S:
    s_cmp_lg_u32 s14, 3
    s_cbranch_scc1 NOFLG_16
    s_add_u32 s64, s15, 2
    s_and_b32 s65, s64, 0x43
    s_cmp_lg_u32 s65, 0
    s_cbranch_scc1 NOFLG_16
    s_lshl_b32 s64, s64, 7
    s_add_u32 s64, s64, s69
    v_mov_b32 v29, 0
FSPIN_17:
    buffer_load_dwordx2 v[12:13], v29, s[4:7], s64 offen sc1
    s_add_u32 s68, s68, 1
    s_waitcnt vmcnt(0)
    v_and_b32 v12, v12, v13
    v_cmp_eq_u32 vcc, 0, v12
    s_cbranch_vccz FDONE_18
    s_cmp_gt_u32 s68, 262144
    s_cbranch_scc0 FSPIN_17
FDONE_18:
NOFLG_16:
    s_add_u32 s66, s17, s52
    v_add_u32 v10, s52, v1
    s_xor_b32 s16, s16, 1
    v_mov_b64 v[32:33], 0
    v_mov_b64 v[34:35], 0
    v_mov_b64 v[36:37], 0
    v_mov_b64 v[38:39], 0
    v_mov_b64 v[40:41], 0
    v_mov_b64 v[42:43], 0
    v_mov_b64 v[44:45], 0
    v_mov_b64 v[46:47], 0
    v_mov_b64 v[48:49], 0
    v_mov_b64 v[50:51], 0
    v_mov_b64 v[52:53], 0
    v_mov_b64 v[54:55], 0
    ds_read_b128 v[56:59], v2 offset:0
    ds_read_b128 v[60:63], v2 offset:1024
    ds_read_b128 v[64:67], v2 offset:2048
    ds_read_b128 v[68:71], v2 offset:3072
    s_barrier
    s_cmp_lt_u32 s15, 63
    s_cbranch_scc0 REC_END
    s_nop 14
    buffer_load_dwordx4 v[20:23], v1, s[4:7], s66 offen offset:0 sc1
    s_nop 7
    buffer_load_dwordx4 v[24:27], v1, s[4:7], s66 offen offset:0 sc1
    s_nop 7
    buffer_load_dwordx4 v[28:31], v1, s[4:7], s66 offen offset:0 sc1
IPOLL_20:
    s_waitcnt vmcnt(2)
    ds_write_b128 v10, v[20:23] offset:12800
    v_max3_u32 v11, v20, v21, v22
    v_max_u32 v11, v11, v23
    v_cmp_eq_u32 vcc, -1, v11
    s_cbranch_vccz IOK_19
    buffer_load_dwordx4 v[20:23], v1, s[4:7], s66 offen offset:0 sc1
    s_waitcnt vmcnt(2)
    ds_write_b128 v10, v[24:27] offset:12800
    v_max3_u32 v11, v24, v25, v26
    v_max_u32 v11, v11, v27
    v_cmp_eq_u32 vcc, -1, v11
    s_cbranch_vccz IOK_19
    buffer_load_dwordx4 v[24:27], v1, s[4:7], s66 offen offset:0 sc1
    s_waitcnt vmcnt(2)
    ds_write_b128 v10, v[28:31] offset:12800
    v_max3_u32 v11, v28, v29, v30
    v_max_u32 v11, v11, v31
    v_cmp_eq_u32 vcc, -1, v11
    s_add_u32 s68, s68, 1
    s_add_u32 s53, s53, 1
    s_cmp_gt_u32 s68, 262144
    s_cbranch_scc1 IOK_19
    s_cbranch_vccz IOK_19
    buffer_load_dwordx4 v[28:31], v1, s[4:7], s66 offen offset:0 sc1
    s_branch IPOLL_20
IOK_19:
    s_waitcnt lgkmcnt(0)
REC_LOOP_S:
    s_barrier
    ds_read_b128 v[12:15], v1 offset:12800
    ds_read_b128 v[16:19], v1 offset:13824
    buffer_load_dwordx4 v[20:23], v1, s[4:7], s17 offen offset:2048
    ds_read_b128 v[72:75], v2 offset:4096
    ds_read_b128 v[76:79], v2 offset:5120
    ds_read_b128 v[80:83], v2 offset:6144
    ds_read_b128 v[84:87], v2 offset:7168
    s_add_u32 s74, s17, 0x1000
    s_add_u32 s20, s20, 0x8000
    s_add_u32 s75, s20, 0x1000
    s_mov_b32 m0, 16128
    s_add_u32 s65, s20, s27
    s_waitcnt lgkmcnt(5)
    v_smfmac_f32_16x16x64_bf16 v[32:35], v[12:15], v[96:103], v6
    buffer_load_dwordx4 v[24:27], v1, s[4:7], s17 offen offset:3072
    v_smfmac_f32_16x16x64_bf16 v[36:39], v[12:15], v[104:111], v6
    v_smfmac_f32_16x16x64_bf16 v[40:43], v[12:15], v[56:63], v6
    buffer_load_dwordx4 v[28:31], v1, s[4:7], s74 offen offset:0
    ds_read_b128 v[56:59], v2 offset:8192
    ds_read_b128 v[60:63], v2 offset:9216
    v_smfmac_f32_16x16x64_bf16 v[44:47], v[12:15], v[64:71], v6
    ds_read_b128 v[64:67], v2 offset:10240
    ds_read_b128 v[68:71], v2 offset:11264
    s_waitcnt lgkmcnt(8)
    v_smfmac_f32_16x16x64_bf16 v[48:51], v[12:15], a[0:7], v6
    v_smfmac_f32_16x16x64_bf16 v[52:55], v[12:15], a[8:15], v6
    buffer_load_dwordx4 v[12:15], v1, s[4:7], s20 offen offset:0
    buffer_load_dword off, s[4:7], s65 lds
    v_smfmac_f32_16x16x64_bf16 v[32:35], v[16:19], v[112:119], v6
    v_smfmac_f32_16x16x64_bf16 v[36:39], v[16:19], v[120:127], v6
    s_waitcnt lgkmcnt(4)
    v_smfmac_f32_16x16x64_bf16 v[40:43], v[16:19], v[72:79], v6
    ds_read_b128 v[72:75], v2 offset:12288
    ds_read_b128 v[76:79], v2 offset:13312
    v_smfmac_f32_16x16x64_bf16 v[44:47], v[16:19], v[80:87], v6
    ds_read_b128 v[80:83], v2 offset:14336
    ds_read_b128 v[84:87], v2 offset:15360
    s_waitcnt vmcnt(4)
    v_cmp_eq_u32 vcc, -1, v23
    v_smfmac_f32_16x16x64_bf16 v[48:51], v[16:19], a[16:23], v6
    v_smfmac_f32_16x16x64_bf16 v[52:55], v[16:19], a[24:31], v6
    s_cbranch_vccnz RETRY_21
BACK_22:
    buffer_load_dwordx4 v[16:19], v1, s[4:7], s20 offen offset:1024
    v_smfmac_f32_16x16x64_bf16 v[32:35], v[20:23], v[128:135], v6
    v_smfmac_f32_16x16x64_bf16 v[36:39], v[20:23], v[136:143], v6
    s_waitcnt lgkmcnt(4)
    v_smfmac_f32_16x16x64_bf16 v[40:43], v[20:23], v[56:63], v6
    ds_read_b128 v[56:59], v2 offset:16384
    ds_read_b128 v[60:63], v2 offset:17408
    v_smfmac_f32_16x16x64_bf16 v[44:47], v[20:23], v[64:71], v6
    ds_read_b128 v[64:67], v2 offset:18432
    ds_read_b128 v[68:71], v2 offset:19456
    s_waitcnt vmcnt(4)
    v_cmp_eq_u32 vcc, -1, v27
    v_smfmac_f32_16x16x64_bf16 v[48:51], v[20:23], a[32:39], v6
    v_smfmac_f32_16x16x64_bf16 v[52:55], v[20:23], a[40:47], v6
    s_cbranch_vccnz RETRY_23
BACK_24:
    buffer_load_dwordx4 v[20:23], v1, s[4:7], s20 offen offset:2048
    v_smfmac_f32_16x16x64_bf16 v[32:35], v[24:27], v[144:151], v6
    v_smfmac_f32_16x16x64_bf16 v[36:39], v[24:27], v[152:159], v6
    s_waitcnt lgkmcnt(4)
    v_smfmac_f32_16x16x64_bf16 v[40:43], v[24:27], v[72:79], v6
    ds_read_b128 v[72:75], v2 offset:20480
    ds_read_b128 v[76:79], v2 offset:21504
    v_smfmac_f32_16x16x64_bf16 v[44:47], v[24:27], v[80:87], v6
    ds_read_b128 v[80:83], v2 offset:22528
    ds_read_b128 v[84:87], v2 offset:23552
    s_waitcnt vmcnt(4)
    v_cmp_eq_u32 vcc, -1, v31
    v_smfmac_f32_16x16x64_bf16 v[48:51], v[24:27], a[48:55], v6
    v_smfmac_f32_16x16x64_bf16 v[52:55], v[24:27], a[56:63], v6
    s_cbranch_vccnz RETRY_25
BACK_26:
    buffer_load_dwordx4 v[24:27], v1, s[4:7], s20 offen offset:3072
    v_smfmac_f32_16x16x64_bf16 v[32:35], v[28:31], v[160:167], v6
    v_smfmac_f32_16x16x64_bf16 v[36:39], v[28:31], v[168:175], v6
    s_waitcnt lgkmcnt(4)
    v_smfmac_f32_16x16x64_bf16 v[40:43], v[28:31], v[56:63], v6
    ds_read_b128 v[56:59], v2 offset:24576
    ds_read_b128 v[60:63], v2 offset:25600
    v_smfmac_f32_16x16x64_bf16 v[44:47], v[28:31], v[64:71], v6
    ds_read_b128 v[64:67], v2 offset:26624
    ds_read_b128 v[68:71], v2 offset:27648
    s_waitcnt vmcnt(4)
    v_cmp_eq_u32 vcc, -1, v15
    v_smfmac_f32_16x16x64_bf16 v[48:51], v[28:31], a[64:71], v6
    v_smfmac_f32_16x16x64_bf16 v[52:55], v[28:31], a[72:79], v6
    s_cbranch_vccnz RETRY_27
BACK_28:
    buffer_load_dwordx4 v[28:31], v1, s[4:7], s75 offen offset:0
    v_smfmac_f32_16x16x64_bf16 v[32:35], v[12:15], v[176:183], v6
    s_waitcnt vmcnt(3)
    v_cmp_eq_u32 vcc, -1, v19
    v_smfmac_f32_16x16x64_bf16 v[36:39], v[12:15], v[184:191], v6
    s_waitcnt lgkmcnt(4)
    v_smfmac_f32_16x16x64_bf16 v[40:43], v[12:15], v[72:79], v6
    ds_read_b128 v[72:75], v2 offset:28672
    ds_read_b128 v[76:79], v2 offset:29696
    v_smfmac_f32_16x16x64_bf16 v[44:47], v[12:15], v[80:87], v6
    ds_read_b128 v[80:83], v2 offset:30720
    ds_read_b128 v[84:87], v2 offset:31744
    buffer_load_dwordx4 v[88:91], v1, s[4:7], s29 offen offset:0
    s_cbranch_vccnz RETRY_29
BACK_30:
    v_smfmac_f32_16x16x64_bf16 v[32:35], v[16:19], v[192:199], v6
    s_waitcnt vmcnt(3)
    v_cmp_eq_u32 vcc, -1, v23
    v_smfmac_f32_16x16x64_bf16 v[36:39], v[16:19], v[200:207], v6
    s_waitcnt lgkmcnt(4)
    v_smfmac_f32_16x16x64_bf16 v[40:43], v[16:19], v[56:63], v6
    ds_read_b128 v[56:59], v2 offset:32768
    ds_read_b128 v[60:63], v2 offset:33792
    v_smfmac_f32_16x16x64_bf16 v[44:47], v[16:19], v[64:71], v6
    ds_read_b128 v[64:67], v2 offset:34816
    ds_read_b128 v[68:71], v2 offset:35840
    s_cbranch_vccnz RETRY_31
BACK_32:
    v_smfmac_f32_16x16x64_bf16 v[32:35], v[20:23], v[208:215], v6
    s_waitcnt vmcnt(2)
    v_cmp_eq_u32 vcc, -1, v27
    v_smfmac_f32_16x16x64_bf16 v[36:39], v[20:23], v[216:223], v6
    s_waitcnt lgkmcnt(4)
    v_smfmac_f32_16x16x64_bf16 v[40:43], v[20:23], v[72:79], v6
    ds_read_b128 v[72:75], v1 offset:0
    ds_read_b128 v[76:79], v1 offset:4096
    v_smfmac_f32_16x16x64_bf16 v[44:47], v[20:23], v[80:87], v6
    ds_read_b128 v[80:83], v1 offset:1024
    ds_read_b128 v[84:87], v1 offset:5120
    buffer_load_dwordx4 v[92:95], v1, s[4:7], s29 offen offset:1024
    s_cbranch_vccnz RETRY_33
BACK_34:
    v_smfmac_f32_16x16x64_bf16 v[32:35], v[24:27], v[224:231], v6
    s_waitcnt vmcnt(2)
    v_cmp_eq_u32 vcc, -1, v31
    v_smfmac_f32_16x16x64_bf16 v[36:39], v[24:27], v[232:239], v6
    s_waitcnt lgkmcnt(4)
    v_smfmac_f32_16x16x64_bf16 v[40:43], v[24:27], v[56:63], v6
    ds_read_b128 v[56:59], v1 offset:2048
    ds_read_b128 v[60:63], v1 offset:6144
    v_smfmac_f32_16x16x64_bf16 v[44:47], v[24:27], v[64:71], v6
    ds_read_b128 v[64:67], v1 offset:3072
    ds_read_b128 v[68:71], v1 offset:7168
    s_cbranch_vccnz RETRY_35
BACK_36:
    v_smfmac_f32_16x16x64_bf16 v[32:35], v[28:31], v[240:247], v6
    v_smfmac_f32_16x16x64_bf16 v[36:39], v[28:31], v[248:255], v6
    v_smfmac_f32_16x16x64_bf16 v[40:43], v[28:31], a[240:247], v6
    v_smfmac_f32_16x16x64_bf16 v[44:47], v[28:31], a[248:255], v6
    v_lshlrev_b32 v8, 2, v1
    s_add_u32 s65, s17, s19
    buffer_load_dword v8, s[4:7], s3 offen lds
    buffer_load_dword off, s[4:7], s65 sc1 lds
    buffer_store_dword v6, off, s[4:7], s22 sc1
    s_add_u32 s22, s22, 256
    v_permlane32_swap_b32 v32, v36
    v_permlane32_swap_b32 v33, v37
    v_permlane32_swap_b32 v34, v38
    v_permlane32_swap_b32 v35, v39
    v_pk_add_f32 v[32:33], v[32:33], v[36:37]
    v_pk_add_f32 v[34:35], v[34:35], v[38:39]
    v_cvt_pk_bf16_f32 v36, v32, v33
    v_cvt_pk_bf16_f32 v37, v34, v35
    ds_write_b64 v3, v[36:37] offset:0
    v_permlane32_swap_b32 v40, v44
    v_permlane32_swap_b32 v41, v45
    v_permlane32_swap_b32 v42, v46
    v_permlane32_swap_b32 v43, v47
    v_pk_add_f32 v[40:41], v[40:41], v[44:45]
    v_pk_add_f32 v[42:43], v[42:43], v[46:47]
    v_cvt_pk_bf16_f32 v44, v40, v41
    v_cvt_pk_bf16_f32 v45, v42, v43
    ds_write_b64 v3, v[44:45] offset:2304
    v_smfmac_f32_16x16x64_bf16 v[48:51], v[12:15], a[80:87], v6
    v_smfmac_f32_16x16x64_bf16 v[52:55], v[12:15], a[88:95], v6
    v_smfmac_f32_16x16x64_bf16 v[48:51], v[16:19], a[96:103], v6
    v_smfmac_f32_16x16x64_bf16 v[52:55], v[16:19], a[104:111], v6
    s_waitcnt lgkmcnt(0)
    s_barrier
    ds_read_b64_tr_b16 v[32:33], v4 offset:0
    ds_read_b64_tr_b16 v[34:35], v4 offset:128
    ds_read_b64_tr_b16 v[36:37], v4 offset:256
    ds_read_b64_tr_b16 v[38:39], v4 offset:384
    v_smfmac_f32_16x16x64_bf16 v[48:51], v[20:23], a[112:119], v6
    v_smfmac_f32_16x16x64_bf16 v[52:55], v[20:23], a[120:127], v6
    ds_read_b64_tr_b16 v[40:41], v4 offset:512
    ds_read_b64_tr_b16 v[42:43], v4 offset:640
    ds_read_b64_tr_b16 v[44:45], v4 offset:768
    ds_read_b64_tr_b16 v[46:47], v4 offset:896
    v_smfmac_f32_16x16x64_bf16 v[48:51], v[24:27], a[128:135], v6
    v_smfmac_f32_16x16x64_bf16 v[52:55], v[24:27], a[136:143], v6
    s_waitcnt lgkmcnt(4)
    v_mfma_f32_16x16x32_bf16 v[8:11], v[72:75], v[32:35], 0
    ds_read_b64_tr_b16 v[12:13], v4 offset:2304
    ds_read_b64_tr_b16 v[14:15], v4 offset:2432
    v_mfma_f32_16x16x32_bf16 v[8:11], v[80:83], v[36:39], v[8:11]
    ds_read_b64_tr_b16 v[16:17], v4 offset:2560
    ds_read_b64_tr_b16 v[18:19], v4 offset:2688
    s_waitcnt lgkmcnt(4)
    v_mfma_f32_16x16x32_bf16 v[8:11], v[56:59], v[40:43], v[8:11]
    ds_read_b64_tr_b16 v[56:57], v4 offset:2816
    ds_read_b64_tr_b16 v[58:59], v4 offset:2944
    v_mfma_f32_16x16x32_bf16 v[8:11], v[64:67], v[44:47], v[8:11]
    ds_read_b64_tr_b16 v[64:65], v4 offset:3072
    ds_read_b64_tr_b16 v[66:67], v4 offset:3200
    v_mfma_f32_16x16x32_bf16 v[72:75], v[76:79], v[32:35], 0
    v_mfma_f32_16x16x32_bf16 v[72:75], v[84:87], v[36:39], v[72:75]
    v_mfma_f32_16x16x32_bf16 v[72:75], v[60:63], v[40:43], v[72:75]
    v_mfma_f32_16x16x32_bf16 v[72:75], v[68:71], v[44:47], v[72:75]
    s_waitcnt lgkmcnt(4)
    v_mfma_f32_16x16x32_bf16 v[80:83], v[12:15], v[32:35], 0
    v_mfma_f32_16x16x32_bf16 v[80:83], v[16:19], v[36:39], v[80:83]
    s_waitcnt lgkmcnt(0)
    v_mfma_f32_16x16x32_bf16 v[80:83], v[56:59], v[40:43], v[80:83]
    v_mfma_f32_16x16x32_bf16 v[80:83], v[64:67], v[44:47], v[80:83]
    v_smfmac_f32_16x16x64_bf16 v[48:51], v[28:31], a[144:151], v6
    v_smfmac_f32_16x16x64_bf16 v[52:55], v[28:31], a[152:159], v6
    v_mov_b32 v24, 0x3f803f80
    v_mov_b32 v25, 0x3f803f80
    v_mov_b32 v26, 0x3f803f80
    v_mov_b32 v27, 0x3f803f80
    v_max3_f32 v20, v8, v9, v10
    v_max3_f32 v21, v11, v72, v73
    v_max3_f32 v20, v20, v21, v74
    v_max3_f32 v21, v80, v81, v82
    v_max3_f32 v20, v20, v75, v83
    v_max_f32 v20, v20, v21
    v_mov_b32 v21, v20
    v_cvt_pk_bf16_f32 v48, v48, v49
    v_cvt_pk_bf16_f32 v49, v50, v51
    v_permlane16_swap_b32 v20, v21
    v_max_f32 v20, v20, v21
    v_mov_b32 v21, v20
    v_cvt_pk_bf16_f32 v50, v52, v53
    v_cvt_pk_bf16_f32 v51, v54, v55
    v_permlane32_swap_b32 v20, v21
    v_max_f32 v20, v20, v21
    v_mul_f32 v22, s10, v20
    v_pk_fma_f32 v[8:9], v[8:9], s[10:11], v[22:23] op_sel_hi:[1,1,0] neg_lo:[0,0,1] neg_hi:[0,0,1]
    v_pk_fma_f32 v[10:11], v[10:11], s[10:11], v[22:23] op_sel_hi:[1,1,0] neg_lo:[0,0,1] neg_hi:[0,0,1]
    v_pk_fma_f32 v[72:73], v[72:73], s[10:11], v[22:23] op_sel_hi:[1,1,0] neg_lo:[0,0,1] neg_hi:[0,0,1]
    v_pk_fma_f32 v[74:75], v[74:75], s[10:11], v[22:23] op_sel_hi:[1,1,0] neg_lo:[0,0,1] neg_hi:[0,0,1]
    v_pk_fma_f32 v[80:81], v[80:81], s[10:11], v[22:23] op_sel_hi:[1,1,0] neg_lo:[0,0,1] neg_hi:[0,0,1]
    v_pk_fma_f32 v[82:83], v[82:83], s[10:11], v[22:23] op_sel_hi:[1,1,0] neg_lo:[0,0,1] neg_hi:[0,0,1]
    v_exp_f32 v8, v8
    v_exp_f32 v9, v9
    v_exp_f32 v10, v10
    v_exp_f32 v11, v11
    v_exp_f32 v72, v72
    v_exp_f32 v73, v73
    v_exp_f32 v74, v74
    v_exp_f32 v75, v75
    v_cvt_pk_bf16_f32 v32, v8, v9
    v_cvt_pk_bf16_f32 v33, v10, v11
    v_exp_f32 v80, v80
    v_exp_f32 v81, v81
    v_exp_f32 v82, v82
    v_exp_f32 v83, v83
    v_cvt_pk_bf16_f32 v34, v72, v73
    v_cvt_pk_bf16_f32 v35, v74, v75
    v_cndmask_b32 v12, 0, v24, s[34:35]
    v_cndmask_b32 v13, 0, v24, s[34:35]
    s_waitcnt vmcnt(3)
    v_mfma_f32_16x16x32_bf16 v[8:11], v[24:27], v[32:35], 0
    v_cvt_pk_bf16_f32 v36, v80, v81
    v_mfma_f32_16x16x32_bf16 v[40:43], v[88:91], v[32:35], 0
    v_cvt_pk_bf16_f32 v37, v82, v83
    v_mfma_f32_16x16x32_bf16 v[44:47], v[92:95], v[32:35], 0
    v_mfma_f32_16x16x16_bf16 v[8:11], v[12:13], v[36:37], v[8:11]
    v_mov_b64 v[72:73], 0
    v_mfma_f32_16x16x16_bf16 v[40:43], v[48:49], v[36:37], v[40:43]
    v_mov_b64 v[74:75], 0
    v_mfma_f32_16x16x16_bf16 v[44:47], v[50:51], v[36:37], v[44:47]
    v_mov_b64 v[76:77], 0
    v_mov_b64 v[78:79], 0
    v_mov_b64 v[80:81], 0
    v_mov_b64 v[82:83], 0
    v_rcp_f32 v22, v8
    s_nop 2
    v_cndmask_b32 v40, v44, v40, s[32:33]
    v_cndmask_b32 v41, v45, v41, s[32:33]
    v_cndmask_b32 v42, v46, v42, s[32:33]
    v_cndmask_b32 v43, v47, v43, s[32:33]
    v_pk_mul_f32 v[40:41], v[40:41], v[22:23] op_sel_hi:[1,0]
    v_pk_mul_f32 v[42:43], v[42:43], v[22:23] op_sel_hi:[1,0]
    v_cvt_pk_bf16_f32 v44, v40, v41
    v_cvt_pk_bf16_f32 v45, v42, v43
    ds_write_b64 v5, v[44:45]
    s_mov_b32 m0, s73
    s_add_u32 s28, s28, 0x80000
    buffer_load_dwordx4 v1, s[4:7], s28 offen lds
    buffer_load_dwordx4 v1, s[4:7], s28 offen offset:1024 lds
    v_and_b32 v9, 0x70, v1
    v_bfe_u32 v29, v1, 8, 1
    v_lshl_add_u32 v9, v29, 3, v9
    v_bfe_u32 v29, v1, 9, 1
    v_lshl_add_u32 v9, v29, 2, v9
    v_mov_b32 v29, 0x40000000
    s_waitcnt lgkmcnt(0)
    s_barrier
    ds_read_b128 v[12:15], v0 offset:0
    ds_read_b128 v[16:19], v0 offset:64
    ds_read_b128 v[20:23], v0 offset:128
    ds_read_b128 v[24:27], v0 offset:192
    v_cndmask_b32 v9, v29, v9, s[32:33]
    v_and_b32 v29, 16, v1
    v_lshlrev_b32 v29, v29, s38
    v_cndmask_b32 v88, 0, v29, s[44:45]
    v_cndmask_b32 v89, 0, v29, s[46:47]
    v_cndmask_b32 v90, 0, v29, s[48:49]
    v_cndmask_b32 v91, 0, v29, s[50:51]
    s_waitcnt lgkmcnt(3)
    v_smfmac_f32_16x16x64_bf16 v[72:75], v[12:15], a[160:167], v6
    s_waitcnt lgkmcnt(2)
    v_smfmac_f32_16x16x64_bf16 v[72:75], v[16:19], a[168:175], v6
    s_waitcnt lgkmcnt(1)
    v_smfmac_f32_16x16x64_bf16 v[72:75], v[20:23], a[176:183], v6
    s_waitcnt lgkmcnt(0)
    v_smfmac_f32_16x16x64_bf16 v[72:75], v[24:27], a[184:191], v6
    v_smfmac_f32_16x16x64_bf16 v[76:79], v[12:15], a[192:199], v6
    v_smfmac_f32_16x16x64_bf16 v[76:79], v[16:19], a[200:207], v6
    v_cvt_pk_bf16_f32 v72, v72, v73
    v_smfmac_f32_16x16x64_bf16 v[76:79], v[20:23], a[208:215], v6
    v_cvt_pk_bf16_f32 v73, v74, v75
    v_smfmac_f32_16x16x64_bf16 v[76:79], v[24:27], a[216:223], v6
    v_and_or_b32 v72, v72, -2, s16
    v_mfma_f32_16x16x32_bf16 v[80:83], v[12:15], a[224:227], 0
    buffer_store_dwordx2 v[72:73], v7, s[4:7], s23 offen sc1
    v_mfma_f32_16x16x32_bf16 v[80:83], v[16:19], a[228:231], v[80:83]
    v_mfma_f32_16x16x32_bf16 v[80:83], v[20:23], a[232:235], v[80:83]
    v_cvt_pk_bf16_f32 v76, v76, v77
    v_cvt_pk_bf16_f32 v77, v78, v79
    v_mfma_f32_16x16x32_bf16 v[80:83], v[24:27], a[236:239], v[80:83]
    v_and_or_b32 v76, v76, -2, s16
    buffer_store_dwordx2 v[76:77], v7, s[4:7], s25 offen sc1
    s_add_u32 s17, s17, 0x4000
    s_add_u32 s3, s3, 0x80000
    s_add_u32 s29, s29, 0x80000
    s_add_u32 s18, s18, 0x4000
    s_add_u32 s21, s21, 0x8000
    s_add_u32 s15, s15, 1
    s_nop 0
    v_cvt_pk_bf16_f32 v80, v80, v81
    v_cvt_pk_bf16_f32 v81, v82, v83
    v_and_or_b32 v80, v80, -2, s16
    s_mov_b64 exec, s[34:35]
    buffer_store_dwordx2 v[80:81], v7, s[4:7], s26 offen sc1
    s_mov_b64 exec, -1
    s_cmp_lg_u32 s42, 0
    s_cbranch_scc1 OWN_38
    s_cmp_lt_u32 s14, 2
    s_cbranch_scc1 IDLE_37
    s_branch REC_POLL_S
OWN_38:
    s_nop 15
    s_nop 13
    buffer_load_dwordx4 v[12:15], v1, s[4:7], s24 offen offset:0 sc1
    buffer_load_dwordx4 v[16:19], v1, s[4:7], s24 offen offset:1024 sc1
    buffer_load_dwordx4 v[20:23], v1, s[4:7], s24 offen offset:2048 sc1
    buffer_load_dwordx4 v[24:27], v1, s[4:7], s24 offen offset:3072 sc1
    ds_read_b128 v[56:59], v2 offset:0
    ds_read_b128 v[60:63], v2 offset:1024
    ds_read_b128 v[64:67], v2 offset:2048
    ds_read_b128 v[68:71], v2 offset:3072
    v_mov_b64 v[32:33], 0
    v_mov_b64 v[34:35], 0
    v_mov_b64 v[36:37], 0
    v_mov_b64 v[38:39], 0
    v_mov_b64 v[40:41], 0
    v_mov_b64 v[42:43], 0
    v_mov_b64 v[44:45], 0
    v_mov_b64 v[46:47], 0
    buffer_load_dwordx4 v[72:75], v1, s[4:7], s24 offen offset:0 sc1
    buffer_load_dwordx4 v[76:79], v1, s[4:7], s24 offen offset:1024 sc1
    buffer_load_dwordx4 v[80:83], v1, s[4:7], s24 offen offset:2048 sc1
    buffer_load_dwordx4 v[84:87], v1, s[4:7], s24 offen offset:3072 sc1
    v_mov_b64 v[48:49], 0
    v_mov_b64 v[50:51], 0
    v_mov_b64 v[52:53], 0
    v_mov_b64 v[54:55], 0
OPOLL_40:
    s_waitcnt vmcnt(7)
    v_mfma_f32_16x16x32_bf16 v[92:95], v[12:15], v[88:91], 0
    v_bitop3_b32 v10, v12, v14, s16 bitop3:0x7e
    s_waitcnt vmcnt(6)
    v_mfma_f32_16x16x32_bf16 v[92:95], v[16:19], v[88:91], v[92:95]
    v_bitop3_b32 v11, v16, v18, s16 bitop3:0x7e
    s_waitcnt vmcnt(5)
    v_mfma_f32_16x16x32_bf16 v[92:95], v[20:23], v[88:91], v[92:95]
    v_bitop3_b32 v30, v20, v22, s16 bitop3:0x7e
    s_waitcnt vmcnt(4)
    v_mfma_f32_16x16x32_bf16 v[92:95], v[24:27], v[88:91], v[92:95]
    v_bitop3_b32 v31, v24, v26, s16 bitop3:0x7e
    v_or3_b32 v10, v10, v11, v30
    v_bitop3_b32 v10, v10, v31, 1 bitop3:0xa8
    v_cmp_ne_u32 vcc, 0, v10
    s_nop 3
    s_cbranch_vccz ODONE_39
    s_add_u32 s40, s40, 1
    buffer_load_dwordx4 v[12:15], v1, s[4:7], s24 offen offset:0 sc1
    buffer_load_dwordx4 v[16:19], v1, s[4:7], s24 offen offset:1024 sc1
    buffer_load_dwordx4 v[20:23], v1, s[4:7], s24 offen offset:2048 sc1
    buffer_load_dwordx4 v[24:27], v1, s[4:7], s24 offen offset:3072 sc1
    s_waitcnt vmcnt(7)
    v_mfma_f32_16x16x32_bf16 v[92:95], v[72:75], v[88:91], 0
    v_bitop3_b32 v10, v72, v74, s16 bitop3:0x7e
    s_waitcnt vmcnt(6)
    v_mfma_f32_16x16x32_bf16 v[92:95], v[76:79], v[88:91], v[92:95]
    v_bitop3_b32 v11, v76, v78, s16 bitop3:0x7e
    s_waitcnt vmcnt(5)
    v_mfma_f32_16x16x32_bf16 v[92:95], v[80:83], v[88:91], v[92:95]
    v_bitop3_b32 v30, v80, v82, s16 bitop3:0x7e
    s_waitcnt vmcnt(4)
    v_mfma_f32_16x16x32_bf16 v[92:95], v[84:87], v[88:91], v[92:95]
    v_bitop3_b32 v31, v84, v86, s16 bitop3:0x7e
    v_or3_b32 v10, v10, v11, v30
    v_bitop3_b32 v10, v10, v31, 1 bitop3:0xa8
    v_cmp_ne_u32 vcc, 0, v10
    s_add_u32 s68, s68, 1
    s_cmp_gt_u32 s68, 262144
    s_cbranch_scc1 ODONE_39
    s_nop 0
    s_cbranch_vccz ODONE_39
    s_add_u32 s40, s40, 1
    buffer_load_dwordx4 v[72:75], v1, s[4:7], s24 offen offset:0 sc1
    buffer_load_dwordx4 v[76:79], v1, s[4:7], s24 offen offset:1024 sc1
    buffer_load_dwordx4 v[80:83], v1, s[4:7], s24 offen offset:2048 sc1
    buffer_load_dwordx4 v[84:87], v1, s[4:7], s24 offen offset:3072 sc1
    s_branch OPOLL_40
ODONE_39:
    v_permlane32_swap_b32 v92, v94
    v_permlane32_swap_b32 v93, v95
    v_add_f32 v92, v92, v94
    v_add_f32 v93, v93, v95
    v_cvt_pk_bf16_f32 v8, v92, v93
    buffer_store_dword v8, v9, s[4:7], s18 offen sc1
    s_barrier
    s_nop 15
    s_nop 15
    s_nop 12
    buffer_store_dword v8, v9, s[4:7], s21 offen sc1
    s_cmp_lt_u32 s15, 61
    s_cbranch_scc1 EFLG_41
    buffer_store_dword v6, off, s[4:7], s22 sc1
EFLG_41:
    s_xor_b32 s16, s16, 1
    s_waitcnt vmcnt(2) lgkmcnt(0)
    s_cmp_lt_u32 s15, 63
    s_cbranch_scc1 REC_LOOP_S
    s_branch REC_END
IDLE_37:
    s_barrier
    v_mov_b64 v[32:33], 0
    v_mov_b64 v[34:35], 0
    v_mov_b64 v[36:37], 0
    v_mov_b64 v[38:39], 0
    v_mov_b64 v[40:41], 0
    v_mov_b64 v[42:43], 0
    v_mov_b64 v[44:45], 0
    v_mov_b64 v[46:47], 0
    v_mov_b64 v[48:49], 0
    v_mov_b64 v[50:51], 0
    v_mov_b64 v[52:53], 0
    v_mov_b64 v[54:55], 0
    ds_read_b128 v[56:59], v2 offset:0
    ds_read_b128 v[60:63], v2 offset:1024
    ds_read_b128 v[64:67], v2 offset:2048
    ds_read_b128 v[68:71], v2 offset:3072
    s_xor_b32 s16, s16, 1
    s_waitcnt vmcnt(0)
    s_cmp_lt_u32 s15, 63
    s_cbranch_scc1 REC_LOOP_S
    s_branch REC_END
REC_TAIL_S:
RETRY_21:
SPIN_42:
    buffer_load_dwordx4 v[20:23], v1, s[4:7], s17 offen offset:2048 sc1
    buffer_load_dwordx4 v[24:27], v1, s[4:7], s17 offen offset:3072 sc1
    buffer_load_dwordx4 v[28:31], v1, s[4:7], s74 offen offset:0 sc1
    s_add_u32 s68, s68, 1
    s_add_u32 s40, s40, 1024
    s_cmp_gt_u32 s68, 262144
    s_waitcnt vmcnt(0)
    s_cbranch_scc1 BACK_22
    v_cmp_eq_u32 vcc, -1, v23
    s_cbranch_vccnz SPIN_42
    s_branch BACK_22
RETRY_23:
SPIN_43:
    buffer_load_dwordx4 v[24:27], v1, s[4:7], s17 offen offset:3072 sc1
    buffer_load_dwordx4 v[28:31], v1, s[4:7], s74 offen offset:0 sc1
    s_add_u32 s68, s68, 1
    s_add_u32 s40, s40, 1024
    s_cmp_gt_u32 s68, 262144
    s_waitcnt vmcnt(0)
    s_cbranch_scc1 BACK_24
    v_cmp_eq_u32 vcc, -1, v27
    s_cbranch_vccnz SPIN_43
    s_branch BACK_24
RETRY_25:
SPIN_44:
    buffer_load_dwordx4 v[28:31], v1, s[4:7], s74 offen offset:0 sc1
    s_add_u32 s68, s68, 1
    s_add_u32 s40, s40, 1024
    s_cmp_gt_u32 s68, 262144
    s_waitcnt vmcnt(0)
    s_cbranch_scc1 BACK_26
    v_cmp_eq_u32 vcc, -1, v31
    s_cbranch_vccnz SPIN_44
    s_branch BACK_26
RETRY_27:
SPIN_45:
    buffer_load_dwordx4 v[12:15], v1, s[4:7], s20 offen offset:0 sc1
    buffer_load_dwordx4 v[16:19], v1, s[4:7], s20 offen offset:1024 sc1
    buffer_load_dwordx4 v[20:23], v1, s[4:7], s20 offen offset:2048 sc1
    buffer_load_dwordx4 v[24:27], v1, s[4:7], s20 offen offset:3072 sc1
    s_add_u32 s68, s68, 1
    s_add_u32 s40, s40, 1048576
    s_cmp_gt_u32 s68, 262144
    s_waitcnt vmcnt(0)
    s_cbranch_scc1 BACK_28
    v_cmp_eq_u32 vcc, -1, v15
    s_cbranch_vccnz SPIN_45
    s_branch BACK_28
RETRY_29:
SPIN_46:
    buffer_load_dwordx4 v[16:19], v1, s[4:7], s20 offen offset:1024 sc1
    buffer_load_dwordx4 v[20:23], v1, s[4:7], s20 offen offset:2048 sc1
    buffer_load_dwordx4 v[24:27], v1, s[4:7], s20 offen offset:3072 sc1
    buffer_load_dwordx4 v[28:31], v1, s[4:7], s75 offen offset:0 sc1
    s_add_u32 s68, s68, 1
    s_add_u32 s40, s40, 1048576
    s_cmp_gt_u32 s68, 262144
    s_waitcnt vmcnt(0)
    s_cbranch_scc1 BACK_30
    v_cmp_eq_u32 vcc, -1, v19
    s_cbranch_vccnz SPIN_46
    s_branch BACK_30
RETRY_31:
SPIN_47:
    buffer_load_dwordx4 v[20:23], v1, s[4:7], s20 offen offset:2048 sc1
    buffer_load_dwordx4 v[24:27], v1, s[4:7], s20 offen offset:3072 sc1
    buffer_load_dwordx4 v[28:31], v1, s[4:7], s75 offen offset:0 sc1
    s_add_u32 s68, s68, 1
    s_add_u32 s40, s40, 1048576
    s_cmp_gt_u32 s68, 262144
    s_waitcnt vmcnt(0)
    s_cbranch_scc1 BACK_32
    v_cmp_eq_u32 vcc, -1, v23
    s_cbranch_vccnz SPIN_47
    s_branch BACK_32
RETRY_33:
SPIN_48:
    buffer_load_dwordx4 v[24:27], v1, s[4:7], s20 offen offset:3072 sc1
    buffer_load_dwordx4 v[28:31], v1, s[4:7], s75 offen offset:0 sc1
    s_add_u32 s68, s68, 1
    s_add_u32 s40, s40, 1048576
    s_cmp_gt_u32 s68, 262144
    s_waitcnt vmcnt(0)
    s_cbranch_scc1 BACK_34
    v_cmp_eq_u32 vcc, -1, v27
    s_cbranch_vccnz SPIN_48
    s_branch BACK_34
RETRY_35:
SPIN_49:
    buffer_load_dwordx4 v[28:31], v1, s[4:7], s75 offen offset:0 sc1
    s_add_u32 s68, s68, 1
    s_add_u32 s40, s40, 1048576
    s_cmp_gt_u32 s68, 262144
    s_waitcnt vmcnt(0)
    s_cbranch_scc1 BACK_36
    v_cmp_eq_u32 vcc, -1, v31
    s_cbranch_vccnz SPIN_49
    s_branch BACK_36
REC_POLL:
    s_cmp_lg_u32 s14, 3
    s_cbranch_scc1 NOFLG_50
    s_add_u32 s64, s15, 2
    s_and_b32 s65, s64, 0x43
    s_cmp_lg_u32 s65, 0
    s_cbranch_scc1 NOFLG_50
    s_lshl_b32 s64, s64, 7
    s_add_u32 s64, s64, s69
    v_mov_b32 v29, 0
FSPIN_51:
    buffer_load_dwordx2 v[12:13], v29, s[4:7], s64 offen sc1
    s_add_u32 s68, s68, 1
    s_waitcnt vmcnt(0)
    v_and_b32 v12, v12, v13
    v_cmp_eq_u32 vcc, 0, v12
    s_cbranch_vccz FDONE_52
    s_cmp_gt_u32 s68, 262144
    s_cbranch_scc0 FSPIN_51
FDONE_52:
NOFLG_50:
    s_add_u32 s66, s17, s52
    v_add_u32 v10, s52, v1
    s_xor_b32 s16, s16, 1
    v_mov_b64 v[32:33], 0
    v_mov_b64 v[34:35], 0
    v_mov_b64 v[36:37], 0
    v_mov_b64 v[38:39], 0
    v_mov_b64 v[40:41], 0
    v_mov_b64 v[42:43], 0
    v_mov_b64 v[44:45], 0
    v_mov_b64 v[46:47], 0
    v_mov_b64 v[48:49], 0
    v_mov_b64 v[50:51], 0
    v_mov_b64 v[52:53], 0
    v_mov_b64 v[54:55], 0
    ds_read_b128 v[56:59], v2 offset:0
    ds_read_b128 v[60:63], v2 offset:1024
    ds_read_b128 v[64:67], v2 offset:2048
    ds_read_b128 v[68:71], v2 offset:3072
    s_barrier
    s_cmp_lt_u32 s15, 63
    s_cbranch_scc0 REC_END
    s_nop 14
    buffer_load_dwordx4 v[20:23], v1, s[4:7], s66 offen offset:0 sc1
    s_nop 7
    buffer_load_dwordx4 v[24:27], v1, s[4:7], s66 offen offset:0 sc1
    s_nop 7
    buffer_load_dwordx4 v[28:31], v1, s[4:7], s66 offen offset:0 sc1
IPOLL_54:
    s_waitcnt vmcnt(2)
    ds_write_b128 v10, v[20:23] offset:12800
    v_max3_u32 v11, v20, v21, v22
    v_max_u32 v11, v11, v23
    v_cmp_eq_u32 vcc, -1, v11
    s_cbranch_vccz IOK_53
    buffer_load_dwordx4 v[20:23], v1, s[4:7], s66 offen offset:0 sc1
    s_waitcnt vmcnt(2)
    ds_write_b128 v10, v[24:27] offset:12800
    v_max3_u32 v11, v24, v25, v26
    v_max_u32 v11, v11, v27
    v_cmp_eq_u32 vcc, -1, v11
    s_cbranch_vccz IOK_53
    buffer_load_dwordx4 v[24:27], v1, s[4:7], s66 offen offset:0 sc1
    s_waitcnt vmcnt(2)
    ds_write_b128 v10, v[28:31] offset:12800
    v_max3_u32 v11, v28, v29, v30
    v_max_u32 v11, v11, v31
    v_cmp_eq_u32 vcc, -1, v11
    s_add_u32 s68, s68, 1
    s_add_u32 s53, s53, 1
    s_cmp_gt_u32 s68, 262144
    s_cbranch_scc1 IOK_53
    s_cbranch_vccz IOK_53
    buffer_load_dwordx4 v[28:31], v1, s[4:7], s66 offen offset:0 sc1
    s_branch IPOLL_54
IOK_53:
    s_waitcnt lgkmcnt(0)
REC_LOOP:
    s_barrier
    ds_read_b128 v[12:15], v1 offset:12800
    ds_read_b128 v[16:19], v1 offset:13824
    buffer_load_dwordx4 v[20:23], v1, s[4:7], s17 offen offset:2048
    ds_read_b128 v[72:75], v2 offset:4096
    ds_read_b128 v[76:79], v2 offset:5120
    ds_read_b128 v[80:83], v2 offset:6144
    ds_read_b128 v[84:87], v2 offset:7168
    s_add_u32 s74, s17, 0x1000
    s_add_u32 s20, s20, 0x8000
    s_add_u32 s75, s20, 0x1000
    s_mov_b32 m0, 16128
    s_add_u32 s65, s20, s27
    s_waitcnt lgkmcnt(5)
    v_smfmac_f32_16x16x64_bf16 v[32:35], v[12:15], v[96:103], v6
    buffer_load_dwordx4 v[24:27], v1, s[4:7], s17 offen offset:3072
    v_smfmac_f32_16x16x64_bf16 v[36:39], v[12:15], v[104:111], v6
    v_smfmac_f32_16x16x64_bf16 v[40:43], v[12:15], v[56:63], v6
    buffer_load_dwordx4 v[28:31], v1, s[4:7], s74 offen offset:0
    ds_read_b128 v[56:59], v2 offset:8192
    ds_read_b128 v[60:63], v2 offset:9216
    v_smfmac_f32_16x16x64_bf16 v[44:47], v[12:15], v[64:71], v6
    ds_read_b128 v[64:67], v2 offset:10240
    ds_read_b128 v[68:71], v2 offset:11264
    s_waitcnt lgkmcnt(8)
    v_smfmac_f32_16x16x64_bf16 v[48:51], v[12:15], a[0:7], v6
    v_smfmac_f32_16x16x64_bf16 v[52:55], v[12:15], a[8:15], v6
    buffer_load_dwordx4 v[12:15], v1, s[4:7], s20 offen offset:0
    buffer_load_dword off, s[4:7], s65 lds
    v_smfmac_f32_16x16x64_bf16 v[32:35], v[16:19], v[112:119], v6
    v_smfmac_f32_16x16x64_bf16 v[36:39], v[16:19], v[120:127], v6
    s_waitcnt lgkmcnt(4)
    v_smfmac_f32_16x16x64_bf16 v[40:43], v[16:19], v[72:79], v6
    ds_read_b128 v[72:75], v2 offset:12288
    ds_read_b128 v[76:79], v2 offset:13312
    v_smfmac_f32_16x16x64_bf16 v[44:47], v[16:19], v[80:87], v6
    ds_read_b128 v[80:83], v2 offset:14336
    ds_read_b128 v[84:87], v2 offset:15360
    s_waitcnt vmcnt(4)
    v_cmp_eq_u32 vcc, -1, v23
    v_smfmac_f32_16x16x64_bf16 v[48:51], v[16:19], a[16:23], v6
    v_smfmac_f32_16x16x64_bf16 v[52:55], v[16:19], a[24:31], v6
    s_cbranch_vccnz RETRY_55
BACK_56:
    buffer_load_dwordx4 v[16:19], v1, s[4:7], s20 offen offset:1024
    v_smfmac_f32_16x16x64_bf16 v[32:35], v[20:23], v[128:135], v6
    v_smfmac_f32_16x16x64_bf16 v[36:39], v[20:23], v[136:143], v6
    s_waitcnt lgkmcnt(4)
    v_smfmac_f32_16x16x64_bf16 v[40:43], v[20:23], v[56:63], v6
    ds_read_b128 v[56:59], v2 offset:16384
    ds_read_b128 v[60:63], v2 offset:17408
    v_smfmac_f32_16x16x64_bf16 v[44:47], v[20:23], v[64:71], v6
    ds_read_b128 v[64:67], v2 offset:18432
    ds_read_b128 v[68:71], v2 offset:19456
    s_waitcnt vmcnt(4)
    v_cmp_eq_u32 vcc, -1, v27
    v_smfmac_f32_16x16x64_bf16 v[48:51], v[20:23], a[32:39], v6
    v_smfmac_f32_16x16x64_bf16 v[52:55], v[20:23], a[40:47], v6
    s_cbranch_vccnz RETRY_57
BACK_58:
    buffer_load_dwordx4 v[20:23], v1, s[4:7], s20 offen offset:2048
    v_smfmac_f32_16x16x64_bf16 v[32:35], v[24:27], v[144:151], v6
    v_smfmac_f32_16x16x64_bf16 v[36:39], v[24:27], v[152:159], v6
    s_waitcnt lgkmcnt(4)
    v_smfmac_f32_16x16x64_bf16 v[40:43], v[24:27], v[72:79], v6
    ds_read_b128 v[72:75], v2 offset:20480
    ds_read_b128 v[76:79], v2 offset:21504
    v_smfmac_f32_16x16x64_bf16 v[44:47], v[24:27], v[80:87], v6
    ds_read_b128 v[80:83], v2 offset:22528
    ds_read_b128 v[84:87], v2 offset:23552
    s_waitcnt vmcnt(4)
    v_cmp_eq_u32 vcc, -1, v31
    v_smfmac_f32_16x16x64_bf16 v[48:51], v[24:27], a[48:55], v6
    v_smfmac_f32_16x16x64_bf16 v[52:55], v[24:27], a[56:63], v6
    s_cbranch_vccnz RETRY_59
BACK_60:
    buffer_load_dwordx4 v[24:27], v1, s[4:7], s20 offen offset:3072
    v_smfmac_f32_16x16x64_bf16 v[32:35], v[28:31], v[160:167], v6
    v_smfmac_f32_16x16x64_bf16 v[36:39], v[28:31], v[168:175], v6
    s_waitcnt lgkmcnt(4)
    v_smfmac_f32_16x16x64_bf16 v[40:43], v[28:31], v[56:63], v6
    ds_read_b128 v[56:59], v2 offset:24576
    ds_read_b128 v[60:63], v2 offset:25600
    v_smfmac_f32_16x16x64_bf16 v[44:47], v[28:31], v[64:71], v6
    ds_read_b128 v[64:67], v2 offset:26624
    ds_read_b128 v[68:71], v2 offset:27648
    s_waitcnt vmcnt(4)
    v_cmp_eq_u32 vcc, -1, v15
    v_smfmac_f32_16x16x64_bf16 v[48:51], v[28:31], a[64:71], v6
    v_smfmac_f32_16x16x64_bf16 v[52:55], v[28:31], a[72:79], v6
    s_cbranch_vccnz RETRY_61
BACK_62:
    buffer_load_dwordx4 v[28:31], v1, s[4:7], s75 offen offset:0
    v_smfmac_f32_16x16x64_bf16 v[32:35], v[12:15], v[176:183], v6
    s_waitcnt vmcnt(3)
    v_cmp_eq_u32 vcc, -1, v19
    v_smfmac_f32_16x16x64_bf16 v[36:39], v[12:15], v[184:191], v6
    s_waitcnt lgkmcnt(4)
    v_smfmac_f32_16x16x64_bf16 v[40:43], v[12:15], v[72:79], v6
    ds_read_b128 v[72:75], v2 offset:28672
    ds_read_b128 v[76:79], v2 offset:29696
    v_smfmac_f32_16x16x64_bf16 v[44:47], v[12:15], v[80:87], v6
    ds_read_b128 v[80:83], v2 offset:30720
    ds_read_b128 v[84:87], v2 offset:31744
    buffer_load_dwordx4 v[88:91], v1, s[4:7], s29 offen offset:0
    s_cbranch_vccnz RETRY_63
BACK_64:
    v_smfmac_f32_16x16x64_bf16 v[32:35], v[16:19], v[192:199], v6
    s_waitcnt vmcnt(3)
    v_cmp_eq_u32 vcc, -1, v23
    v_smfmac_f32_16x16x64_bf16 v[36:39], v[16:19], v[200:207], v6
    s_waitcnt lgkmcnt(4)
    v_smfmac_f32_16x16x64_bf16 v[40:43], v[16:19], v[56:63], v6
    ds_read_b128 v[56:59], v2 offset:32768
    ds_read_b128 v[60:63], v2 offset:33792
    v_smfmac_f32_16x16x64_bf16 v[44:47], v[16:19], v[64:71], v6
    ds_read_b128 v[64:67], v2 offset:34816
    ds_read_b128 v[68:71], v2 offset:35840
    s_cbranch_vccnz RETRY_65
BACK_66:
    v_smfmac_f32_16x16x64_bf16 v[32:35], v[20:23], v[208:215], v6
    s_waitcnt vmcnt(2)
    v_cmp_eq_u32 vcc, -1, v27
    v_smfmac_f32_16x16x64_bf16 v[36:39], v[20:23], v[216:223], v6
    s_waitcnt lgkmcnt(4)
    v_smfmac_f32_16x16x64_bf16 v[40:43], v[20:23], v[72:79], v6
    ds_read_b128 v[72:75], v1 offset:0
    ds_read_b128 v[76:79], v1 offset:4096
    v_smfmac_f32_16x16x64_bf16 v[44:47], v[20:23], v[80:87], v6
    ds_read_b128 v[80:83], v1 offset:1024
    ds_read_b128 v[84:87], v1 offset:5120
    buffer_load_dwordx4 v[92:95], v1, s[4:7], s29 offen offset:1024
    s_cbranch_vccnz RETRY_67
BACK_68:
    v_smfmac_f32_16x16x64_bf16 v[32:35], v[24:27], v[224:231], v6
    s_waitcnt vmcnt(2)
    v_cmp_eq_u32 vcc, -1, v31
    v_smfmac_f32_16x16x64_bf16 v[36:39], v[24:27], v[232:239], v6
    s_waitcnt lgkmcnt(4)
    v_smfmac_f32_16x16x64_bf16 v[40:43], v[24:27], v[56:63], v6
    ds_read_b128 v[56:59], v1 offset:2048
    ds_read_b128 v[60:63], v1 offset:6144
    v_smfmac_f32_16x16x64_bf16 v[44:47], v[24:27], v[64:71], v6
    ds_read_b128 v[64:67], v1 offset:3072
    ds_read_b128 v[68:71], v1 offset:7168
    s_cbranch_vccnz RETRY_69
BACK_70:
    v_smfmac_f32_16x16x64_bf16 v[32:35], v[28:31], v[240:247], v6
    v_smfmac_f32_16x16x64_bf16 v[36:39], v[28:31], v[248:255], v6
    v_smfmac_f32_16x16x64_bf16 v[40:43], v[28:31], a[240:247], v6
    v_smfmac_f32_16x16x64_bf16 v[44:47], v[28:31], a[248:255], v6
    v_lshlrev_b32 v8, 2, v1
    s_add_u32 s65, s17, s19
    buffer_load_dword v8, s[4:7], s3 offen lds
    buffer_load_dword off, s[4:7], s65 sc1 lds
    buffer_store_dword v6, off, s[4:7], s22 sc1
    s_add_u32 s22, s22, 256
    v_permlane32_swap_b32 v32, v36
    v_permlane32_swap_b32 v33, v37
    v_permlane32_swap_b32 v34, v38
    v_permlane32_swap_b32 v35, v39
    v_pk_add_f32 v[32:33], v[32:33], v[36:37]
    v_pk_add_f32 v[34:35], v[34:35], v[38:39]
    v_cvt_pk_bf16_f32 v36, v32, v33
    v_cvt_pk_bf16_f32 v37, v34, v35
    ds_write_b64 v3, v[36:37] offset:0
    v_permlane32_swap_b32 v40, v44
    v_permlane32_swap_b32 v41, v45
    v_permlane32_swap_b32 v42, v46
    v_permlane32_swap_b32 v43, v47
    v_pk_add_f32 v[40:41], v[40:41], v[44:45]
    v_pk_add_f32 v[42:43], v[42:43], v[46:47]
    v_cvt_pk_bf16_f32 v44, v40, v41
    v_cvt_pk_bf16_f32 v45, v42, v43
    ds_write_b64 v3, v[44:45] offset:2304
    v_smfmac_f32_16x16x64_bf16 v[48:51], v[12:15], a[80:87], v6
    v_smfmac_f32_16x16x64_bf16 v[52:55], v[12:15], a[88:95], v6
    v_smfmac_f32_16x16x64_bf16 v[48:51], v[16:19], a[96:103], v6
    v_smfmac_f32_16x16x64_bf16 v[52:55], v[16:19], a[104:111], v6
    s_waitcnt lgkmcnt(0)
    s_barrier
    ds_read_b64_tr_b16 v[32:33], v4 offset:0
    ds_read_b64_tr_b16 v[34:35], v4 offset:128
    ds_read_b64_tr_b16 v[36:37], v4 offset:256
    ds_read_b64_tr_b16 v[38:39], v4 offset:384
    v_smfmac_f32_16x16x64_bf16 v[48:51], v[20:23], a[112:119], v6
    v_smfmac_f32_16x16x64_bf16 v[52:55], v[20:23], a[120:127], v6
    ds_read_b64_tr_b16 v[40:41], v4 offset:512
    ds_read_b64_tr_b16 v[42:43], v4 offset:640
    ds_read_b64_tr_b16 v[44:45], v4 offset:768
    ds_read_b64_tr_b16 v[46:47], v4 offset:896
    v_smfmac_f32_16x16x64_bf16 v[48:51], v[24:27], a[128:135], v6
    v_smfmac_f32_16x16x64_bf16 v[52:55], v[24:27], a[136:143], v6
    s_waitcnt lgkmcnt(4)
    v_mfma_f32_16x16x32_bf16 v[8:11], v[72:75], v[32:35], 0
    ds_read_b64_tr_b16 v[12:13], v4 offset:2304
    ds_read_b64_tr_b16 v[14:15], v4 offset:2432
    v_mfma_f32_16x16x32_bf16 v[8:11], v[80:83], v[36:39], v[8:11]
    ds_read_b64_tr_b16 v[16:17], v4 offset:2560
    ds_read_b64_tr_b16 v[18:19], v4 offset:2688
    s_waitcnt lgkmcnt(4)
    v_mfma_f32_16x16x32_bf16 v[8:11], v[56:59], v[40:43], v[8:11]
    ds_read_b64_tr_b16 v[56:57], v4 offset:2816
    ds_read_b64_tr_b16 v[58:59], v4 offset:2944
    v_mfma_f32_16x16x32_bf16 v[8:11], v[64:67], v[44:47], v[8:11]
    ds_read_b64_tr_b16 v[64:65], v4 offset:3072
    ds_read_b64_tr_b16 v[66:67], v4 offset:3200
    v_mfma_f32_16x16x32_bf16 v[72:75], v[76:79], v[32:35], 0
    v_mfma_f32_16x16x32_bf16 v[72:75], v[84:87], v[36:39], v[72:75]
    v_mfma_f32_16x16x32_bf16 v[72:75], v[60:63], v[40:43], v[72:75]
    v_mfma_f32_16x16x32_bf16 v[72:75], v[68:71], v[44:47], v[72:75]
    s_waitcnt lgkmcnt(4)
    v_mfma_f32_16x16x32_bf16 v[80:83], v[12:15], v[32:35], 0
    v_mfma_f32_16x16x32_bf16 v[80:83], v[16:19], v[36:39], v[80:83]
    s_waitcnt lgkmcnt(0)
    v_mfma_f32_16x16x32_bf16 v[80:83], v[56:59], v[40:43], v[80:83]
    v_mfma_f32_16x16x32_bf16 v[80:83], v[64:67], v[44:47], v[80:83]
    v_smfmac_f32_16x16x64_bf16 v[48:51], v[28:31], a[144:151], v6
    v_smfmac_f32_16x16x64_bf16 v[52:55], v[28:31], a[152:159], v6
    v_mov_b32 v24, 0x3f803f80
    v_mov_b32 v25, 0x3f803f80
    v_mov_b32 v26, 0x3f803f80
    v_mov_b32 v27, 0x3f803f80
    v_max3_f32 v20, v8, v9, v10
    v_max3_f32 v21, v11, v72, v73
    v_max3_f32 v20, v20, v21, v74
    v_max3_f32 v21, v80, v81, v82
    v_max3_f32 v20, v20, v75, v83
    v_max_f32 v20, v20, v21
    v_mov_b32 v21, v20
    v_cvt_pk_bf16_f32 v48, v48, v49
    v_cvt_pk_bf16_f32 v49, v50, v51
    v_permlane16_swap_b32 v20, v21
    v_max_f32 v20, v20, v21
    v_mov_b32 v21, v20
    v_cvt_pk_bf16_f32 v50, v52, v53
    v_cvt_pk_bf16_f32 v51, v54, v55
    v_permlane32_swap_b32 v20, v21
    v_max_f32 v20, v20, v21
    v_mul_f32 v22, s10, v20
    v_pk_fma_f32 v[8:9], v[8:9], s[10:11], v[22:23] op_sel_hi:[1,1,0] neg_lo:[0,0,1] neg_hi:[0,0,1]
    v_pk_fma_f32 v[10:11], v[10:11], s[10:11], v[22:23] op_sel_hi:[1,1,0] neg_lo:[0,0,1] neg_hi:[0,0,1]
    v_pk_fma_f32 v[72:73], v[72:73], s[10:11], v[22:23] op_sel_hi:[1,1,0] neg_lo:[0,0,1] neg_hi:[0,0,1]
    v_pk_fma_f32 v[74:75], v[74:75], s[10:11], v[22:23] op_sel_hi:[1,1,0] neg_lo:[0,0,1] neg_hi:[0,0,1]
    v_pk_fma_f32 v[80:81], v[80:81], s[10:11], v[22:23] op_sel_hi:[1,1,0] neg_lo:[0,0,1] neg_hi:[0,0,1]
    v_pk_fma_f32 v[82:83], v[82:83], s[10:11], v[22:23] op_sel_hi:[1,1,0] neg_lo:[0,0,1] neg_hi:[0,0,1]
    v_exp_f32 v8, v8
    v_exp_f32 v9, v9
    v_exp_f32 v10, v10
    v_exp_f32 v11, v11
    v_exp_f32 v72, v72
    v_exp_f32 v73, v73
    v_exp_f32 v74, v74
    v_exp_f32 v75, v75
    v_cvt_pk_bf16_f32 v32, v8, v9
    v_cvt_pk_bf16_f32 v33, v10, v11
    v_exp_f32 v80, v80
    v_exp_f32 v81, v81
    v_exp_f32 v82, v82
    v_exp_f32 v83, v83
    v_cvt_pk_bf16_f32 v34, v72, v73
    v_cvt_pk_bf16_f32 v35, v74, v75
    v_cndmask_b32 v12, 0, v24, s[34:35]
    v_cndmask_b32 v13, 0, v24, s[34:35]
    s_waitcnt vmcnt(3)
    v_mfma_f32_16x16x32_bf16 v[8:11], v[24:27], v[32:35], 0
    v_cvt_pk_bf16_f32 v36, v80, v81
    v_mfma_f32_16x16x32_bf16 v[40:43], v[88:91], v[32:35], 0
    v_cvt_pk_bf16_f32 v37, v82, v83
    v_mfma_f32_16x16x32_bf16 v[44:47], v[92:95], v[32:35], 0
    v_mfma_f32_16x16x16_bf16 v[8:11], v[12:13], v[36:37], v[8:11]
    v_mov_b64 v[72:73], 0
    v_mfma_f32_16x16x16_bf16 v[40:43], v[48:49], v[36:37], v[40:43]
    v_mov_b64 v[74:75], 0
    v_mfma_f32_16x16x16_bf16 v[44:47], v[50:51], v[36:37], v[44:47]
    v_mov_b64 v[76:77], 0
    v_mov_b64 v[78:79], 0
    v_mov_b64 v[80:81], 0
    v_mov_b64 v[82:83], 0
    v_rcp_f32 v22, v8
    s_nop 2
    v_cndmask_b32 v40, v44, v40, s[32:33]
    v_cndmask_b32 v41, v45, v41, s[32:33]
    v_cndmask_b32 v42, v46, v42, s[32:33]
    v_cndmask_b32 v43, v47, v43, s[32:33]
    v_pk_mul_f32 v[40:41], v[40:41], v[22:23] op_sel_hi:[1,0]
    v_pk_mul_f32 v[42:43], v[42:43], v[22:23] op_sel_hi:[1,0]
    v_cvt_pk_bf16_f32 v44, v40, v41
    v_cvt_pk_bf16_f32 v45, v42, v43
    ds_write_b64 v5, v[44:45]
    s_mov_b32 m0, s73
    s_add_u32 s28, s28, 0x80000
    buffer_load_dwordx4 v1, s[4:7], s28 offen lds
    buffer_load_dwordx4 v1, s[4:7], s28 offen offset:1024 lds
    v_and_b32 v9, 0x70, v1
    v_bfe_u32 v29, v1, 8, 1
    v_lshl_add_u32 v9, v29, 3, v9
    v_bfe_u32 v29, v1, 9, 1
    v_lshl_add_u32 v9, v29, 2, v9
    v_mov_b32 v29, 0x40000000
    s_waitcnt lgkmcnt(0)
    s_barrier
    ds_read_b128 v[12:15], v0 offset:0
    ds_read_b128 v[16:19], v0 offset:64
    ds_read_b128 v[20:23], v0 offset:128
    ds_read_b128 v[24:27], v0 offset:192
    v_cndmask_b32 v9, v29, v9, s[32:33]
    v_and_b32 v29, 16, v1
    v_lshlrev_b32 v29, v29, s38
    v_cndmask_b32 v88, 0, v29, s[44:45]
    v_cndmask_b32 v89, 0, v29, s[46:47]
    v_cndmask_b32 v90, 0, v29, s[48:49]
    v_cndmask_b32 v91, 0, v29, s[50:51]
    s_waitcnt lgkmcnt(3)
    v_smfmac_f32_16x16x64_bf16 v[72:75], v[12:15], a[160:167], v6
    s_waitcnt lgkmcnt(2)
    v_smfmac_f32_16x16x64_bf16 v[72:75], v[16:19], a[168:175], v6
    s_waitcnt lgkmcnt(1)
    v_smfmac_f32_16x16x64_bf16 v[72:75], v[20:23], a[176:183], v6
    s_waitcnt lgkmcnt(0)
    v_smfmac_f32_16x16x64_bf16 v[72:75], v[24:27], a[184:191], v6
    v_smfmac_f32_16x16x64_bf16 v[76:79], v[12:15], a[192:199], v6
    v_smfmac_f32_16x16x64_bf16 v[76:79], v[16:19], a[200:207], v6
    v_cvt_pk_bf16_f32 v72, v72, v73
    v_smfmac_f32_16x16x64_bf16 v[76:79], v[20:23], a[208:215], v6
    v_cvt_pk_bf16_f32 v73, v74, v75
    v_smfmac_f32_16x16x64_bf16 v[76:79], v[24:27], a[216:223], v6
    v_and_or_b32 v72, v72, -2, s16
    v_mfma_f32_16x16x32_bf16 v[80:83], v[12:15], a[224:227], 0
    buffer_store_dwordx2 v[72:73], v7, s[4:7], s23 offen
    v_mfma_f32_16x16x32_bf16 v[80:83], v[16:19], a[228:231], v[80:83]
    v_mfma_f32_16x16x32_bf16 v[80:83], v[20:23], a[232:235], v[80:83]
    v_cvt_pk_bf16_f32 v76, v76, v77
    v_cvt_pk_bf16_f32 v77, v78, v79
    v_mfma_f32_16x16x32_bf16 v[80:83], v[24:27], a[236:239], v[80:83]
    v_and_or_b32 v76, v76, -2, s16
    buffer_store_dwordx2 v[76:77], v7, s[4:7], s25 offen
    s_add_u32 s17, s17, 0x4000
    s_add_u32 s3, s3, 0x80000
    s_add_u32 s29, s29, 0x80000
    s_add_u32 s18, s18, 0x4000
    s_add_u32 s21, s21, 0x8000
    s_add_u32 s15, s15, 1
    s_nop 0
    v_cvt_pk_bf16_f32 v80, v80, v81
    v_cvt_pk_bf16_f32 v81, v82, v83
    v_and_or_b32 v80, v80, -2, s16
    s_mov_b64 exec, s[34:35]
    buffer_store_dwordx2 v[80:81], v7, s[4:7], s26 offen
    s_mov_b64 exec, -1
    s_cmp_lg_u32 s42, 0
    s_cbranch_scc1 OWN_72
    s_cmp_lt_u32 s14, 2
    s_cbranch_scc1 IDLE_71
    s_branch REC_POLL
OWN_72:
    s_nop 15
    s_nop 13
    buffer_load_dwordx4 v[12:15], v1, s[4:7], s24 offen offset:0 sc1
    buffer_load_dwordx4 v[16:19], v1, s[4:7], s24 offen offset:1024 sc1
    buffer_load_dwordx4 v[20:23], v1, s[4:7], s24 offen offset:2048 sc1
    buffer_load_dwordx4 v[24:27], v1, s[4:7], s24 offen offset:3072 sc1
    ds_read_b128 v[56:59], v2 offset:0
    ds_read_b128 v[60:63], v2 offset:1024
    ds_read_b128 v[64:67], v2 offset:2048
    ds_read_b128 v[68:71], v2 offset:3072
    v_mov_b64 v[32:33], 0
    v_mov_b64 v[34:35], 0
    v_mov_b64 v[36:37], 0
    v_mov_b64 v[38:39], 0
    v_mov_b64 v[40:41], 0
    v_mov_b64 v[42:43], 0
    v_mov_b64 v[44:45], 0
    v_mov_b64 v[46:47], 0
    buffer_load_dwordx4 v[72:75], v1, s[4:7], s24 offen offset:0 sc1
    buffer_load_dwordx4 v[76:79], v1, s[4:7], s24 offen offset:1024 sc1
    buffer_load_dwordx4 v[80:83], v1, s[4:7], s24 offen offset:2048 sc1
    buffer_load_dwordx4 v[84:87], v1, s[4:7], s24 offen offset:3072 sc1
    v_mov_b64 v[48:49], 0
    v_mov_b64 v[50:51], 0
    v_mov_b64 v[52:53], 0
    v_mov_b64 v[54:55], 0
OPOLL_74:
    s_waitcnt vmcnt(7)
    v_mfma_f32_16x16x32_bf16 v[92:95], v[12:15], v[88:91], 0
    v_bitop3_b32 v10, v12, v14, s16 bitop3:0x7e
    s_waitcnt vmcnt(6)
    v_mfma_f32_16x16x32_bf16 v[92:95], v[16:19], v[88:91], v[92:95]
    v_bitop3_b32 v11, v16, v18, s16 bitop3:0x7e
    s_waitcnt vmcnt(5)
    v_mfma_f32_16x16x32_bf16 v[92:95], v[20:23], v[88:91], v[92:95]
    v_bitop3_b32 v30, v20, v22, s16 bitop3:0x7e
    s_waitcnt vmcnt(4)
    v_mfma_f32_16x16x32_bf16 v[92:95], v[24:27], v[88:91], v[92:95]
    v_bitop3_b32 v31, v24, v26, s16 bitop3:0x7e
    v_or3_b32 v10, v10, v11, v30
    v_bitop3_b32 v10, v10, v31, 1 bitop3:0xa8
    v_cmp_ne_u32 vcc, 0, v10
    s_nop 3
    s_cbranch_vccz ODONE_73
    s_add_u32 s40, s40, 1
    buffer_load_dwordx4 v[12:15], v1, s[4:7], s24 offen offset:0 sc1
    buffer_load_dwordx4 v[16:19], v1, s[4:7], s24 offen offset:1024 sc1
    buffer_load_dwordx4 v[20:23], v1, s[4:7], s24 offen offset:2048 sc1
    buffer_load_dwordx4 v[24:27], v1, s[4:7], s24 offen offset:3072 sc1
    s_waitcnt vmcnt(7)
    v_mfma_f32_16x16x32_bf16 v[92:95], v[72:75], v[88:91], 0
    v_bitop3_b32 v10, v72, v74, s16 bitop3:0x7e
    s_waitcnt vmcnt(6)
    v_mfma_f32_16x16x32_bf16 v[92:95], v[76:79], v[88:91], v[92:95]
    v_bitop3_b32 v11, v76, v78, s16 bitop3:0x7e
    s_waitcnt vmcnt(5)
    v_mfma_f32_16x16x32_bf16 v[92:95], v[80:83], v[88:91], v[92:95]
    v_bitop3_b32 v30, v80, v82, s16 bitop3:0x7e
    s_waitcnt vmcnt(4)
    v_mfma_f32_16x16x32_bf16 v[92:95], v[84:87], v[88:91], v[92:95]
    v_bitop3_b32 v31, v84, v86, s16 bitop3:0x7e
    v_or3_b32 v10, v10, v11, v30
    v_bitop3_b32 v10, v10, v31, 1 bitop3:0xa8
    v_cmp_ne_u32 vcc, 0, v10
    s_add_u32 s68, s68, 1
    s_cmp_gt_u32 s68, 262144
    s_cbranch_scc1 ODONE_73
    s_nop 0
    s_cbranch_vccz ODONE_73
    s_add_u32 s40, s40, 1
    buffer_load_dwordx4 v[72:75], v1, s[4:7], s24 offen offset:0 sc1
    buffer_load_dwordx4 v[76:79], v1, s[4:7], s24 offen offset:1024 sc1
    buffer_load_dwordx4 v[80:83], v1, s[4:7], s24 offen offset:2048 sc1
    buffer_load_dwordx4 v[84:87], v1, s[4:7], s24 offen offset:3072 sc1
    s_branch OPOLL_74
ODONE_73:
    v_permlane32_swap_b32 v92, v94
    v_permlane32_swap_b32 v93, v95
    v_add_f32 v92, v92, v94
    v_add_f32 v93, v93, v95
    v_cvt_pk_bf16_f32 v8, v92, v93
    buffer_store_dword v8, v9, s[4:7], s18 offen
    s_barrier
    s_nop 15
    s_nop 15
    s_nop 12
    buffer_store_dword v8, v9, s[4:7], s21 offen sc1
    s_cmp_lt_u32 s15, 61
    s_cbranch_scc1 EFLG_75
    buffer_store_dword v6, off, s[4:7], s22 sc1
EFLG_75:
    s_xor_b32 s16, s16, 1
    s_waitcnt vmcnt(2) lgkmcnt(0)
    s_cmp_lt_u32 s15, 63
    s_cbranch_scc1 REC_LOOP
    s_branch REC_END
IDLE_71:
    s_barrier
    v_mov_b64 v[32:33], 0
    v_mov_b64 v[34:35], 0
    v_mov_b64 v[36:37], 0
    v_mov_b64 v[38:39], 0
    v_mov_b64 v[40:41], 0
    v_mov_b64 v[42:43], 0
    v_mov_b64 v[44:45], 0
    v_mov_b64 v[46:47], 0
    v_mov_b64 v[48:49], 0
    v_mov_b64 v[50:51], 0
    v_mov_b64 v[52:53], 0
    v_mov_b64 v[54:55], 0
    ds_read_b128 v[56:59], v2 offset:0
    ds_read_b128 v[60:63], v2 offset:1024
    ds_read_b128 v[64:67], v2 offset:2048
    ds_read_b128 v[68:71], v2 offset:3072
    s_xor_b32 s16, s16, 1
    s_waitcnt vmcnt(0)
    s_cmp_lt_u32 s15, 63
    s_cbranch_scc1 REC_LOOP
    s_branch REC_END
REC_TAIL:
RETRY_55:
SPIN_76:
    buffer_load_dwordx4 v[20:23], v1, s[4:7], s17 offen offset:2048 sc1
    buffer_load_dwordx4 v[24:27], v1, s[4:7], s17 offen offset:3072 sc1
    buffer_load_dwordx4 v[28:31], v1, s[4:7], s74 offen offset:0 sc1
    s_add_u32 s68, s68, 1
    s_add_u32 s40, s40, 1024
    s_cmp_gt_u32 s68, 262144
    s_waitcnt vmcnt(0)
    s_cbranch_scc1 BACK_56
    v_cmp_eq_u32 vcc, -1, v23
    s_cbranch_vccnz SPIN_76
    s_branch BACK_56
RETRY_57:
SPIN_77:
    buffer_load_dwordx4 v[24:27], v1, s[4:7], s17 offen offset:3072 sc1
    buffer_load_dwordx4 v[28:31], v1, s[4:7], s74 offen offset:0 sc1
    s_add_u32 s68, s68, 1
    s_add_u32 s40, s40, 1024
    s_cmp_gt_u32 s68, 262144
    s_waitcnt vmcnt(0)
    s_cbranch_scc1 BACK_58
    v_cmp_eq_u32 vcc, -1, v27
    s_cbranch_vccnz SPIN_77
    s_branch BACK_58
RETRY_59:
SPIN_78:
    buffer_load_dwordx4 v[28:31], v1, s[4:7], s74 offen offset:0 sc1
    s_add_u32 s68, s68, 1
    s_add_u32 s40, s40, 1024
    s_cmp_gt_u32 s68, 262144
    s_waitcnt vmcnt(0)
    s_cbranch_scc1 BACK_60
    v_cmp_eq_u32 vcc, -1, v31
    s_cbranch_vccnz SPIN_78
    s_branch BACK_60
RETRY_61:
SPIN_79:
    buffer_load_dwordx4 v[12:15], v1, s[4:7], s20 offen offset:0 sc1
    buffer_load_dwordx4 v[16:19], v1, s[4:7], s20 offen offset:1024 sc1
    buffer_load_dwordx4 v[20:23], v1, s[4:7], s20 offen offset:2048 sc1
    buffer_load_dwordx4 v[24:27], v1, s[4:7], s20 offen offset:3072 sc1
    s_add_u32 s68, s68, 1
    s_add_u32 s40, s40, 1048576
    s_cmp_gt_u32 s68, 262144
    s_waitcnt vmcnt(0)
    s_cbranch_scc1 BACK_62
    v_cmp_eq_u32 vcc, -1, v15
    s_cbranch_vccnz SPIN_79
    s_branch BACK_62
RETRY_63:
SPIN_80:
    buffer_load_dwordx4 v[16:19], v1, s[4:7], s20 offen offset:1024 sc1
    buffer_load_dwordx4 v[20:23], v1, s[4:7], s20 offen offset:2048 sc1
    buffer_load_dwordx4 v[24:27], v1, s[4:7], s20 offen offset:3072 sc1
    buffer_load_dwordx4 v[28:31], v1, s[4:7], s75 offen offset:0 sc1
    s_add_u32 s68, s68, 1
    s_add_u32 s40, s40, 1048576
    s_cmp_gt_u32 s68, 262144
    s_waitcnt vmcnt(0)
    s_cbranch_scc1 BACK_64
    v_cmp_eq_u32 vcc, -1, v19
    s_cbranch_vccnz SPIN_80
    s_branch BACK_64
RETRY_65:
SPIN_81:
    buffer_load_dwordx4 v[20:23], v1, s[4:7], s20 offen offset:2048 sc1
    buffer_load_dwordx4 v[24:27], v1, s[4:7], s20 offen offset:3072 sc1
    buffer_load_dwordx4 v[28:31], v1, s[4:7], s75 offen offset:0 sc1
    s_add_u32 s68, s68, 1
    s_add_u32 s40, s40, 1048576
    s_cmp_gt_u32 s68, 262144
    s_waitcnt vmcnt(0)
    s_cbranch_scc1 BACK_66
    v_cmp_eq_u32 vcc, -1, v23
    s_cbranch_vccnz SPIN_81
    s_branch BACK_66
RETRY_67:
SPIN_82:
    buffer_load_dwordx4 v[24:27], v1, s[4:7], s20 offen offset:3072 sc1
    buffer_load_dwordx4 v[28:31], v1, s[4:7], s75 offen offset:0 sc1
    s_add_u32 s68, s68, 1
    s_add_u32 s40, s40, 1048576
    s_cmp_gt_u32 s68, 262144
    s_waitcnt vmcnt(0)
    s_cbranch_scc1 BACK_68
    v_cmp_eq_u32 vcc, -1, v27
    s_cbranch_vccnz SPIN_82
    s_branch BACK_68
RETRY_69:
SPIN_83:
    buffer_load_dwordx4 v[28:31], v1, s[4:7], s75 offen offset:0 sc1
    s_add_u32 s68, s68, 1
    s_add_u32 s40, s40, 1048576
    s_cmp_gt_u32 s68, 262144
    s_waitcnt vmcnt(0)
    s_cbranch_scc1 BACK_70
    v_cmp_eq_u32 vcc, -1, v31
    s_cbranch_vccnz SPIN_83
    s_branch BACK_70
REC_END:
    s_branch M_EXIT
M_HELP:
    v_mbcnt_lo_u32_b32 v0, -1, 0
    v_mbcnt_hi_u32_b32 v0, -1, v0
    s_load_dwordx2 s[16:17], s[0:1], 0
    s_mov_b32 s18, 2621440
    s_mov_b32 s19, 0x00020000
    s_load_dwordx2 s[20:21], s[0:1], 64
    s_mov_b32 s22, 1280
    s_mov_b32 s23, 0x00020000
    s_load_dwordx2 s[24:25], s[0:1], 8
    s_mov_b32 s26, 10240
    s_mov_b32 s27, 0x00020000
    s_lshl_b32 s28, s96, 2
    s_add_u32 s28, s28, s14
    s_mul_i32 s28, s28, 3
    v_lshlrev_b32 v3, 4, v0
    v_lshlrev_b32 v4, 2, v0
    s_waitcnt lgkmcnt(0)
    s_add_u32 s29, s28, 0
    s_mul_i32 s33, s29, 1280
    buffer_load_dwordx4 v[10:13], v3, s[16:19], s33 offen
    buffer_load_dword v14, v4, s[16:19], s33 offen offset:1024
    s_add_u32 s29, s28, 1
    s_mul_i32 s34, s29, 1280
    buffer_load_dwordx4 v[16:19], v3, s[16:19], s34 offen
    buffer_load_dword v20, v4, s[16:19], s34 offen offset:1024
    s_add_u32 s29, s28, 2
    s_mul_i32 s35, s29, 1280
    buffer_load_dwordx4 v[22:25], v3, s[16:19], s35 offen
    buffer_load_dword v26, v4, s[16:19], s35 offen offset:1024
    buffer_load_dwordx4 v[28:31], v3, s[20:23], 0 offen
    buffer_load_dword v32, v4, s[20:23], 0 offen offset:1024
    s_cmp_ge_u32 s96, 10
    s_cbranch_scc1 INM0_84
    v_and_b32 v5, 7, v0
    v_mul_u32_u24 v5, 1280, v5
    v_lshrrev_b32 v6, 4, v0
    v_lshl_add_u32 v5, v6, 5, v5
    v_bfe_u32 v6, v0, 3, 1
    v_lshl_add_u32 v5, v6, 4, v5
    s_lshl_b32 s29, s96, 7
    buffer_load_dwordx4 v[34:37], v5, s[24:27], s29 offen
INM0_84:
    s_waitcnt vmcnt(0)
    s_add_u32 s29, s28, 0
    s_cmp_ge_u32 s29, 2048
    s_cbranch_scc1 INR_85
    v_lshlrev_b32 v50, 16, v10
    v_and_b32 v60, 0xffff0000, v10
    v_lshlrev_b32 v51, 16, v11
    v_and_b32 v61, 0xffff0000, v11
    v_lshlrev_b32 v52, 16, v12
    v_and_b32 v62, 0xffff0000, v12
    v_lshlrev_b32 v53, 16, v13
    v_and_b32 v63, 0xffff0000, v13
    v_lshlrev_b32 v54, 16, v14
    v_and_b32 v64, 0xffff0000, v14
    v_add_f32 v70, v50, v60
    v_add_f32 v70, v70, v51
    v_add_f32 v70, v70, v61
    v_add_f32 v70, v70, v52
    v_add_f32 v70, v70, v62
    v_add_f32 v70, v70, v53
    v_add_f32 v70, v70, v63
    v_add_f32 v70, v70, v54
    v_add_f32 v70, v70, v64
    s_nop 1
    v_add_f32_dpp v70, v70, v70 quad_perm:[1,0,3,2] row_mask:0xf bank_mask:0xf
    s_nop 1
    v_add_f32_dpp v70, v70, v70 quad_perm:[2,3,0,1] row_mask:0xf bank_mask:0xf
    s_nop 1
    v_add_f32_dpp v70, v70, v70 row_half_mirror row_mask:0xf bank_mask:0xf
    s_nop 1
    v_add_f32_dpp v70, v70, v70 row_mirror row_mask:0xf bank_mask:0xf
    v_mov_b32 v71, v70
    s_nop 1
    v_permlane16_swap_b32 v70, v71
    v_add_f32 v70, v70, v71
    v_mov_b32 v71, v70
    s_nop 1
    v_permlane32_swap_b32 v70, v71
    v_add_f32 v70, v70, v71
    v_mul_f32 v72, 0x3acccccd, v70
    v_mov_b32 v73, 0
    v_sub_f32 v74, v50, v72
    v_fmac_f32 v73, v74, v74
    v_sub_f32 v74, v60, v72
    v_fmac_f32 v73, v74, v74
    v_sub_f32 v74, v51, v72
    v_fmac_f32 v73, v74, v74
    v_sub_f32 v74, v61, v72
    v_fmac_f32 v73, v74, v74
    v_sub_f32 v74, v52, v72
    v_fmac_f32 v73, v74, v74
    v_sub_f32 v74, v62, v72
    v_fmac_f32 v73, v74, v74
    v_sub_f32 v74, v53, v72
    v_fmac_f32 v73, v74, v74
    v_sub_f32 v74, v63, v72
    v_fmac_f32 v73, v74, v74
    v_sub_f32 v74, v54, v72
    v_fmac_f32 v73, v74, v74
    v_sub_f32 v74, v64, v72
    v_fmac_f32 v73, v74, v74
    s_nop 1
    v_add_f32_dpp v73, v73, v73 quad_perm:[1,0,3,2] row_mask:0xf bank_mask:0xf
    s_nop 1
    v_add_f32_dpp v73, v73, v73 quad_perm:[2,3,0,1] row_mask:0xf bank_mask:0xf
    s_nop 1
    v_add_f32_dpp v73, v73, v73 row_half_mirror row_mask:0xf bank_mask:0xf
    s_nop 1
    v_add_f32_dpp v73, v73, v73 row_mirror row_mask:0xf bank_mask:0xf
    v_mov_b32 v71, v73
    s_nop 1
    v_permlane16_swap_b32 v73, v71
    v_add_f32 v73, v73, v71
    v_mov_b32 v71, v73
    s_nop 1
    v_permlane32_swap_b32 v73, v71
    v_add_f32 v73, v73, v71
    v_mul_f32 v73, 0x3acccccd, v73
    v_cvt_pk_bf16_f32 v72, v72, v72
    v_lshlrev_b32 v72, 16, v72
    v_cvt_pk_bf16_f32 v73, v73, v73
    v_lshlrev_b32 v73, 16, v73
    v_add_f32 v73, 0x3727c5ac, v73
    v_cvt_pk_bf16_f32 v73, v73, v73
    v_lshlrev_b32 v73, 16, v73
    v_sqrt_f32 v73, v73
    s_nop 0
    v_cvt_pk_bf16_f32 v73, v73, v73
    v_lshlrev_b32 v73, 16, v73
    v_rcp_f32 v75, v73
    s_nop 0
    v_mov_b32 v76, 0
    v_sub_f32 v50, v50, v72
    v_cvt_pk_bf16_f32 v50, v50, v50
    v_lshlrev_b32 v50, 16, v50
    v_mul_f32 v74, v50, v75
    v_fma_f32 v77, -v74, v73, v50
    v_fma_f32 v50, v77, v75, v74
    v_sub_f32 v60, v60, v72
    v_cvt_pk_bf16_f32 v60, v60, v60
    v_lshlrev_b32 v60, 16, v60
    v_mul_f32 v74, v60, v75
    v_fma_f32 v77, -v74, v73, v60
    v_fma_f32 v60, v77, v75, v74
    v_cvt_pk_bf16_f32 v10, v50, v60
    v_lshlrev_b32 v74, 16, v10
    v_lshlrev_b32 v77, 16, v28
    v_fmac_f32 v76, v74, v77
    v_and_b32 v74, 0xffff0000, v10
    v_and_b32 v77, 0xffff0000, v28
    v_fmac_f32 v76, v74, v77
    v_sub_f32 v51, v51, v72
    v_cvt_pk_bf16_f32 v51, v51, v51
    v_lshlrev_b32 v51, 16, v51
    v_mul_f32 v74, v51, v75
    v_fma_f32 v77, -v74, v73, v51
    v_fma_f32 v51, v77, v75, v74
    v_sub_f32 v61, v61, v72
    v_cvt_pk_bf16_f32 v61, v61, v61
    v_lshlrev_b32 v61, 16, v61
    v_mul_f32 v74, v61, v75
    v_fma_f32 v77, -v74, v73, v61
    v_fma_f32 v61, v77, v75, v74
    v_cvt_pk_bf16_f32 v11, v51, v61
    v_lshlrev_b32 v74, 16, v11
    v_lshlrev_b32 v77, 16, v29
    v_fmac_f32 v76, v74, v77
    v_and_b32 v74, 0xffff0000, v11
    v_and_b32 v77, 0xffff0000, v29
    v_fmac_f32 v76, v74, v77
    v_sub_f32 v52, v52, v72
    v_cvt_pk_bf16_f32 v52, v52, v52
    v_lshlrev_b32 v52, 16, v52
    v_mul_f32 v74, v52, v75
    v_fma_f32 v77, -v74, v73, v52
    v_fma_f32 v52, v77, v75, v74
    v_sub_f32 v62, v62, v72
    v_cvt_pk_bf16_f32 v62, v62, v62
    v_lshlrev_b32 v62, 16, v62
    v_mul_f32 v74, v62, v75
    v_fma_f32 v77, -v74, v73, v62
    v_fma_f32 v62, v77, v75, v74
    v_cvt_pk_bf16_f32 v12, v52, v62
    v_lshlrev_b32 v74, 16, v12
    v_lshlrev_b32 v77, 16, v30
    v_fmac_f32 v76, v74, v77
    v_and_b32 v74, 0xffff0000, v12
    v_and_b32 v77, 0xffff0000, v30
    v_fmac_f32 v76, v74, v77
    v_sub_f32 v53, v53, v72
    v_cvt_pk_bf16_f32 v53, v53, v53
    v_lshlrev_b32 v53, 16, v53
    v_mul_f32 v74, v53, v75
    v_fma_f32 v77, -v74, v73, v53
    v_fma_f32 v53, v77, v75, v74
    v_sub_f32 v63, v63, v72
    v_cvt_pk_bf16_f32 v63, v63, v63
    v_lshlrev_b32 v63, 16, v63
    v_mul_f32 v74, v63, v75
    v_fma_f32 v77, -v74, v73, v63
    v_fma_f32 v63, v77, v75, v74
    v_cvt_pk_bf16_f32 v13, v53, v63
    v_lshlrev_b32 v74, 16, v13
    v_lshlrev_b32 v77, 16, v31
    v_fmac_f32 v76, v74, v77
    v_and_b32 v74, 0xffff0000, v13
    v_and_b32 v77, 0xffff0000, v31
    v_fmac_f32 v76, v74, v77
    v_sub_f32 v54, v54, v72
    v_cvt_pk_bf16_f32 v54, v54, v54
    v_lshlrev_b32 v54, 16, v54
    v_mul_f32 v74, v54, v75
    v_fma_f32 v77, -v74, v73, v54
    v_fma_f32 v54, v77, v75, v74
    v_sub_f32 v64, v64, v72
    v_cvt_pk_bf16_f32 v64, v64, v64
    v_lshlrev_b32 v64, 16, v64
    v_mul_f32 v74, v64, v75
    v_fma_f32 v77, -v74, v73, v64
    v_fma_f32 v64, v77, v75, v74
    v_cvt_pk_bf16_f32 v14, v54, v64
    v_lshlrev_b32 v74, 16, v14
    v_lshlrev_b32 v77, 16, v32
    v_fmac_f32 v76, v74, v77
    v_and_b32 v74, 0xffff0000, v14
    v_and_b32 v77, 0xffff0000, v32
    v_fmac_f32 v76, v74, v77
    s_add_u32 s30, s33, 0x0
    buffer_store_dwordx4 v[10:13], v3, s[4:7], s30 offen sc1
    buffer_store_dword v14, v4, s[4:7], s30 offen offset:1024 sc1
    s_nop 1
    v_add_f32_dpp v76, v76, v76 quad_perm:[1,0,3,2] row_mask:0xf bank_mask:0xf
    s_nop 1
    v_add_f32_dpp v76, v76, v76 quad_perm:[2,3,0,1] row_mask:0xf bank_mask:0xf
    s_nop 1
    v_add_f32_dpp v76, v76, v76 row_half_mirror row_mask:0xf bank_mask:0xf
    s_nop 1
    v_add_f32_dpp v76, v76, v76 row_mirror row_mask:0xf bank_mask:0xf
    v_mov_b32 v71, v76
    s_nop 1
    v_permlane16_swap_b32 v76, v71
    v_add_f32 v76, v76, v71
    v_mov_b32 v71, v76
    s_nop 1
    v_permlane32_swap_b32 v76, v71
    v_add_f32 v76, v76, v71
    v_cvt_pk_bf16_f32 v76, v76, v76
    v_lshlrev_b32 v76, 16, v76
    s_lshl_b32 s30, s29, 2
    s_add_u32 s30, s30, 0x280000
    s_mov_b64 exec, 1
    buffer_store_dword v76, off, s[4:7], s30 sc1
    s_mov_b64 exec, -1
INR_85:
    s_add_u32 s29, s28, 1
    s_cmp_ge_u32 s29, 2048
    s_cbranch_scc1 INR_86
    v_lshlrev_b32 v50, 16, v16
    v_and_b32 v60, 0xffff0000, v16
    v_lshlrev_b32 v51, 16, v17
    v_and_b32 v61, 0xffff0000, v17
    v_lshlrev_b32 v52, 16, v18
    v_and_b32 v62, 0xffff0000, v18
    v_lshlrev_b32 v53, 16, v19
    v_and_b32 v63, 0xffff0000, v19
    v_lshlrev_b32 v54, 16, v20
    v_and_b32 v64, 0xffff0000, v20
    v_add_f32 v70, v50, v60
    v_add_f32 v70, v70, v51
    v_add_f32 v70, v70, v61
    v_add_f32 v70, v70, v52
    v_add_f32 v70, v70, v62
    v_add_f32 v70, v70, v53
    v_add_f32 v70, v70, v63
    v_add_f32 v70, v70, v54
    v_add_f32 v70, v70, v64
    s_nop 1
    v_add_f32_dpp v70, v70, v70 quad_perm:[1,0,3,2] row_mask:0xf bank_mask:0xf
    s_nop 1
    v_add_f32_dpp v70, v70, v70 quad_perm:[2,3,0,1] row_mask:0xf bank_mask:0xf
    s_nop 1
    v_add_f32_dpp v70, v70, v70 row_half_mirror row_mask:0xf bank_mask:0xf
    s_nop 1
    v_add_f32_dpp v70, v70, v70 row_mirror row_mask:0xf bank_mask:0xf
    v_mov_b32 v71, v70
    s_nop 1
    v_permlane16_swap_b32 v70, v71
    v_add_f32 v70, v70, v71
    v_mov_b32 v71, v70
    s_nop 1
    v_permlane32_swap_b32 v70, v71
    v_add_f32 v70, v70, v71
    v_mul_f32 v72, 0x3acccccd, v70
    v_mov_b32 v73, 0
    v_sub_f32 v74, v50, v72
    v_fmac_f32 v73, v74, v74
    v_sub_f32 v74, v60, v72
    v_fmac_f32 v73, v74, v74
    v_sub_f32 v74, v51, v72
    v_fmac_f32 v73, v74, v74
    v_sub_f32 v74, v61, v72
    v_fmac_f32 v73, v74, v74
    v_sub_f32 v74, v52, v72
    v_fmac_f32 v73, v74, v74
    v_sub_f32 v74, v62, v72
    v_fmac_f32 v73, v74, v74
    v_sub_f32 v74, v53, v72
    v_fmac_f32 v73, v74, v74
    v_sub_f32 v74, v63, v72
    v_fmac_f32 v73, v74, v74
    v_sub_f32 v74, v54, v72
    v_fmac_f32 v73, v74, v74
    v_sub_f32 v74, v64, v72
    v_fmac_f32 v73, v74, v74
    s_nop 1
    v_add_f32_dpp v73, v73, v73 quad_perm:[1,0,3,2] row_mask:0xf bank_mask:0xf
    s_nop 1
    v_add_f32_dpp v73, v73, v73 quad_perm:[2,3,0,1] row_mask:0xf bank_mask:0xf
    s_nop 1
    v_add_f32_dpp v73, v73, v73 row_half_mirror row_mask:0xf bank_mask:0xf
    s_nop 1
    v_add_f32_dpp v73, v73, v73 row_mirror row_mask:0xf bank_mask:0xf
    v_mov_b32 v71, v73
    s_nop 1
    v_permlane16_swap_b32 v73, v71
    v_add_f32 v73, v73, v71
    v_mov_b32 v71, v73
    s_nop 1
    v_permlane32_swap_b32 v73, v71
    v_add_f32 v73, v73, v71
    v_mul_f32 v73, 0x3acccccd, v73
    v_cvt_pk_bf16_f32 v72, v72, v72
    v_lshlrev_b32 v72, 16, v72
    v_cvt_pk_bf16_f32 v73, v73, v73
    v_lshlrev_b32 v73, 16, v73
    v_add_f32 v73, 0x3727c5ac, v73
    v_cvt_pk_bf16_f32 v73, v73, v73
    v_lshlrev_b32 v73, 16, v73
    v_sqrt_f32 v73, v73
    s_nop 0
    v_cvt_pk_bf16_f32 v73, v73, v73
    v_lshlrev_b32 v73, 16, v73
    v_rcp_f32 v75, v73
    s_nop 0
    v_mov_b32 v76, 0
    v_sub_f32 v50, v50, v72
    v_cvt_pk_bf16_f32 v50, v50, v50
    v_lshlrev_b32 v50, 16, v50
    v_mul_f32 v74, v50, v75
    v_fma_f32 v77, -v74, v73, v50
    v_fma_f32 v50, v77, v75, v74
    v_sub_f32 v60, v60, v72
    v_cvt_pk_bf16_f32 v60, v60, v60
    v_lshlrev_b32 v60, 16, v60
    v_mul_f32 v74, v60, v75
    v_fma_f32 v77, -v74, v73, v60
    v_fma_f32 v60, v77, v75, v74
    v_cvt_pk_bf16_f32 v16, v50, v60
    v_lshlrev_b32 v74, 16, v16
    v_lshlrev_b32 v77, 16, v28
    v_fmac_f32 v76, v74, v77
    v_and_b32 v74, 0xffff0000, v16
    v_and_b32 v77, 0xffff0000, v28
    v_fmac_f32 v76, v74, v77
    v_sub_f32 v51, v51, v72
    v_cvt_pk_bf16_f32 v51, v51, v51
    v_lshlrev_b32 v51, 16, v51
    v_mul_f32 v74, v51, v75
    v_fma_f32 v77, -v74, v73, v51
    v_fma_f32 v51, v77, v75, v74
    v_sub_f32 v61, v61, v72
    v_cvt_pk_bf16_f32 v61, v61, v61
    v_lshlrev_b32 v61, 16, v61
    v_mul_f32 v74, v61, v75
    v_fma_f32 v77, -v74, v73, v61
    v_fma_f32 v61, v77, v75, v74
    v_cvt_pk_bf16_f32 v17, v51, v61
    v_lshlrev_b32 v74, 16, v17
    v_lshlrev_b32 v77, 16, v29
    v_fmac_f32 v76, v74, v77
    v_and_b32 v74, 0xffff0000, v17
    v_and_b32 v77, 0xffff0000, v29
    v_fmac_f32 v76, v74, v77
    v_sub_f32 v52, v52, v72
    v_cvt_pk_bf16_f32 v52, v52, v52
    v_lshlrev_b32 v52, 16, v52
    v_mul_f32 v74, v52, v75
    v_fma_f32 v77, -v74, v73, v52
    v_fma_f32 v52, v77, v75, v74
    v_sub_f32 v62, v62, v72
    v_cvt_pk_bf16_f32 v62, v62, v62
    v_lshlrev_b32 v62, 16, v62
    v_mul_f32 v74, v62, v75
    v_fma_f32 v77, -v74, v73, v62
    v_fma_f32 v62, v77, v75, v74
    v_cvt_pk_bf16_f32 v18, v52, v62
    v_lshlrev_b32 v74, 16, v18
    v_lshlrev_b32 v77, 16, v30
    v_fmac_f32 v76, v74, v77
    v_and_b32 v74, 0xffff0000, v18
    v_and_b32 v77, 0xffff0000, v30
    v_fmac_f32 v76, v74, v77
    v_sub_f32 v53, v53, v72
    v_cvt_pk_bf16_f32 v53, v53, v53
    v_lshlrev_b32 v53, 16, v53
    v_mul_f32 v74, v53, v75
    v_fma_f32 v77, -v74, v73, v53
    v_fma_f32 v53, v77, v75, v74
    v_sub_f32 v63, v63, v72
    v_cvt_pk_bf16_f32 v63, v63, v63
    v_lshlrev_b32 v63, 16, v63
    v_mul_f32 v74, v63, v75
    v_fma_f32 v77, -v74, v73, v63
    v_fma_f32 v63, v77, v75, v74
    v_cvt_pk_bf16_f32 v19, v53, v63
    v_lshlrev_b32 v74, 16, v19
    v_lshlrev_b32 v77, 16, v31
    v_fmac_f32 v76, v74, v77
    v_and_b32 v74, 0xffff0000, v19
    v_and_b32 v77, 0xffff0000, v31
    v_fmac_f32 v76, v74, v77
    v_sub_f32 v54, v54, v72
    v_cvt_pk_bf16_f32 v54, v54, v54
    v_lshlrev_b32 v54, 16, v54
    v_mul_f32 v74, v54, v75
    v_fma_f32 v77, -v74, v73, v54
    v_fma_f32 v54, v77, v75, v74
    v_sub_f32 v64, v64, v72
    v_cvt_pk_bf16_f32 v64, v64, v64
    v_lshlrev_b32 v64, 16, v64
    v_mul_f32 v74, v64, v75
    v_fma_f32 v77, -v74, v73, v64
    v_fma_f32 v64, v77, v75, v74
    v_cvt_pk_bf16_f32 v20, v54, v64
    v_lshlrev_b32 v74, 16, v20
    v_lshlrev_b32 v77, 16, v32
    v_fmac_f32 v76, v74, v77
    v_and_b32 v74, 0xffff0000, v20
    v_and_b32 v77, 0xffff0000, v32
    v_fmac_f32 v76, v74, v77
    s_add_u32 s30, s34, 0x0
    buffer_store_dwordx4 v[16:19], v3, s[4:7], s30 offen sc1
    buffer_store_dword v20, v4, s[4:7], s30 offen offset:1024 sc1
    s_nop 1
    v_add_f32_dpp v76, v76, v76 quad_perm:[1,0,3,2] row_mask:0xf bank_mask:0xf
    s_nop 1
    v_add_f32_dpp v76, v76, v76 quad_perm:[2,3,0,1] row_mask:0xf bank_mask:0xf
    s_nop 1
    v_add_f32_dpp v76, v76, v76 row_half_mirror row_mask:0xf bank_mask:0xf
    s_nop 1
    v_add_f32_dpp v76, v76, v76 row_mirror row_mask:0xf bank_mask:0xf
    v_mov_b32 v71, v76
    s_nop 1
    v_permlane16_swap_b32 v76, v71
    v_add_f32 v76, v76, v71
    v_mov_b32 v71, v76
    s_nop 1
    v_permlane32_swap_b32 v76, v71
    v_add_f32 v76, v76, v71
    v_cvt_pk_bf16_f32 v76, v76, v76
    v_lshlrev_b32 v76, 16, v76
    s_lshl_b32 s30, s29, 2
    s_add_u32 s30, s30, 0x280000
    s_mov_b64 exec, 1
    buffer_store_dword v76, off, s[4:7], s30 sc1
    s_mov_b64 exec, -1
INR_86:
    s_add_u32 s29, s28, 2
    s_cmp_ge_u32 s29, 2048
    s_cbranch_scc1 INR_87
    v_lshlrev_b32 v50, 16, v22
    v_and_b32 v60, 0xffff0000, v22
    v_lshlrev_b32 v51, 16, v23
    v_and_b32 v61, 0xffff0000, v23
    v_lshlrev_b32 v52, 16, v24
    v_and_b32 v62, 0xffff0000, v24
    v_lshlrev_b32 v53, 16, v25
    v_and_b32 v63, 0xffff0000, v25
    v_lshlrev_b32 v54, 16, v26
    v_and_b32 v64, 0xffff0000, v26
    v_add_f32 v70, v50, v60
    v_add_f32 v70, v70, v51
    v_add_f32 v70, v70, v61
    v_add_f32 v70, v70, v52
    v_add_f32 v70, v70, v62
    v_add_f32 v70, v70, v53
    v_add_f32 v70, v70, v63
    v_add_f32 v70, v70, v54
    v_add_f32 v70, v70, v64
    s_nop 1
    v_add_f32_dpp v70, v70, v70 quad_perm:[1,0,3,2] row_mask:0xf bank_mask:0xf
    s_nop 1
    v_add_f32_dpp v70, v70, v70 quad_perm:[2,3,0,1] row_mask:0xf bank_mask:0xf
    s_nop 1
    v_add_f32_dpp v70, v70, v70 row_half_mirror row_mask:0xf bank_mask:0xf
    s_nop 1
    v_add_f32_dpp v70, v70, v70 row_mirror row_mask:0xf bank_mask:0xf
    v_mov_b32 v71, v70
    s_nop 1
    v_permlane16_swap_b32 v70, v71
    v_add_f32 v70, v70, v71
    v_mov_b32 v71, v70
    s_nop 1
    v_permlane32_swap_b32 v70, v71
    v_add_f32 v70, v70, v71
    v_mul_f32 v72, 0x3acccccd, v70
    v_mov_b32 v73, 0
    v_sub_f32 v74, v50, v72
    v_fmac_f32 v73, v74, v74
    v_sub_f32 v74, v60, v72
    v_fmac_f32 v73, v74, v74
    v_sub_f32 v74, v51, v72
    v_fmac_f32 v73, v74, v74
    v_sub_f32 v74, v61, v72
    v_fmac_f32 v73, v74, v74
    v_sub_f32 v74, v52, v72
    v_fmac_f32 v73, v74, v74
    v_sub_f32 v74, v62, v72
    v_fmac_f32 v73, v74, v74
    v_sub_f32 v74, v53, v72
    v_fmac_f32 v73, v74, v74
    v_sub_f32 v74, v63, v72
    v_fmac_f32 v73, v74, v74
    v_sub_f32 v74, v54, v72
    v_fmac_f32 v73, v74, v74
    v_sub_f32 v74, v64, v72
    v_fmac_f32 v73, v74, v74
    s_nop 1
    v_add_f32_dpp v73, v73, v73 quad_perm:[1,0,3,2] row_mask:0xf bank_mask:0xf
    s_nop 1
    v_add_f32_dpp v73, v73, v73 quad_perm:[2,3,0,1] row_mask:0xf bank_mask:0xf
    s_nop 1
    v_add_f32_dpp v73, v73, v73 row_half_mirror row_mask:0xf bank_mask:0xf
    s_nop 1
    v_add_f32_dpp v73, v73, v73 row_mirror row_mask:0xf bank_mask:0xf
    v_mov_b32 v71, v73
    s_nop 1
    v_permlane16_swap_b32 v73, v71
    v_add_f32 v73, v73, v71
    v_mov_b32 v71, v73
    s_nop 1
    v_permlane32_swap_b32 v73, v71
    v_add_f32 v73, v73, v71
    v_mul_f32 v73, 0x3acccccd, v73
    v_cvt_pk_bf16_f32 v72, v72, v72
    v_lshlrev_b32 v72, 16, v72
    v_cvt_pk_bf16_f32 v73, v73, v73
    v_lshlrev_b32 v73, 16, v73
    v_add_f32 v73, 0x3727c5ac, v73
    v_cvt_pk_bf16_f32 v73, v73, v73
    v_lshlrev_b32 v73, 16, v73
    v_sqrt_f32 v73, v73
    s_nop 0
    v_cvt_pk_bf16_f32 v73, v73, v73
    v_lshlrev_b32 v73, 16, v73
    v_rcp_f32 v75, v73
    s_nop 0
    v_mov_b32 v76, 0
    v_sub_f32 v50, v50, v72
    v_cvt_pk_bf16_f32 v50, v50, v50
    v_lshlrev_b32 v50, 16, v50
    v_mul_f32 v74, v50, v75
    v_fma_f32 v77, -v74, v73, v50
    v_fma_f32 v50, v77, v75, v74
    v_sub_f32 v60, v60, v72
    v_cvt_pk_bf16_f32 v60, v60, v60
    v_lshlrev_b32 v60, 16, v60
    v_mul_f32 v74, v60, v75
    v_fma_f32 v77, -v74, v73, v60
    v_fma_f32 v60, v77, v75, v74
    v_cvt_pk_bf16_f32 v22, v50, v60
    v_lshlrev_b32 v74, 16, v22
    v_lshlrev_b32 v77, 16, v28
    v_fmac_f32 v76, v74, v77
    v_and_b32 v74, 0xffff0000, v22
    v_and_b32 v77, 0xffff0000, v28
    v_fmac_f32 v76, v74, v77
    v_sub_f32 v51, v51, v72
    v_cvt_pk_bf16_f32 v51, v51, v51
    v_lshlrev_b32 v51, 16, v51
    v_mul_f32 v74, v51, v75
    v_fma_f32 v77, -v74, v73, v51
    v_fma_f32 v51, v77, v75, v74
    v_sub_f32 v61, v61, v72
    v_cvt_pk_bf16_f32 v61, v61, v61
    v_lshlrev_b32 v61, 16, v61
    v_mul_f32 v74, v61, v75
    v_fma_f32 v77, -v74, v73, v61
    v_fma_f32 v61, v77, v75, v74
    v_cvt_pk_bf16_f32 v23, v51, v61
    v_lshlrev_b32 v74, 16, v23
    v_lshlrev_b32 v77, 16, v29
    v_fmac_f32 v76, v74, v77
    v_and_b32 v74, 0xffff0000, v23
    v_and_b32 v77, 0xffff0000, v29
    v_fmac_f32 v76, v74, v77
    v_sub_f32 v52, v52, v72
    v_cvt_pk_bf16_f32 v52, v52, v52
    v_lshlrev_b32 v52, 16, v52
    v_mul_f32 v74, v52, v75
    v_fma_f32 v77, -v74, v73, v52
    v_fma_f32 v52, v77, v75, v74
    v_sub_f32 v62, v62, v72
    v_cvt_pk_bf16_f32 v62, v62, v62
    v_lshlrev_b32 v62, 16, v62
    v_mul_f32 v74, v62, v75
    v_fma_f32 v77, -v74, v73, v62
    v_fma_f32 v62, v77, v75, v74
    v_cvt_pk_bf16_f32 v24, v52, v62
    v_lshlrev_b32 v74, 16, v24
    v_lshlrev_b32 v77, 16, v30
    v_fmac_f32 v76, v74, v77
    v_and_b32 v74, 0xffff0000, v24
    v_and_b32 v77, 0xffff0000, v30
    v_fmac_f32 v76, v74, v77
    v_sub_f32 v53, v53, v72
    v_cvt_pk_bf16_f32 v53, v53, v53
    v_lshlrev_b32 v53, 16, v53
    v_mul_f32 v74, v53, v75
    v_fma_f32 v77, -v74, v73, v53
    v_fma_f32 v53, v77, v75, v74
    v_sub_f32 v63, v63, v72
    v_cvt_pk_bf16_f32 v63, v63, v63
    v_lshlrev_b32 v63, 16, v63
    v_mul_f32 v74, v63, v75
    v_fma_f32 v77, -v74, v73, v63
    v_fma_f32 v63, v77, v75, v74
    v_cvt_pk_bf16_f32 v25, v53, v63
    v_lshlrev_b32 v74, 16, v25
    v_lshlrev_b32 v77, 16, v31
    v_fmac_f32 v76, v74, v77
    v_and_b32 v74, 0xffff0000, v25
    v_and_b32 v77, 0xffff0000, v31
    v_fmac_f32 v76, v74, v77
    v_sub_f32 v54, v54, v72
    v_cvt_pk_bf16_f32 v54, v54, v54
    v_lshlrev_b32 v54, 16, v54
    v_mul_f32 v74, v54, v75
    v_fma_f32 v77, -v74, v73, v54
    v_fma_f32 v54, v77, v75, v74
    v_sub_f32 v64, v64, v72
    v_cvt_pk_bf16_f32 v64, v64, v64
    v_lshlrev_b32 v64, 16, v64
    v_mul_f32 v74, v64, v75
    v_fma_f32 v77, -v74, v73, v64
    v_fma_f32 v64, v77, v75, v74
    v_cvt_pk_bf16_f32 v26, v54, v64
    v_lshlrev_b32 v74, 16, v26
    v_lshlrev_b32 v77, 16, v32
    v_fmac_f32 v76, v74, v77
    v_and_b32 v74, 0xffff0000, v26
    v_and_b32 v77, 0xffff0000, v32
    v_fmac_f32 v76, v74, v77
    s_add_u32 s30, s35, 0x0
    buffer_store_dwordx4 v[22:25], v3, s[4:7], s30 offen sc1
    buffer_store_dword v26, v4, s[4:7], s30 offen offset:1024 sc1
    s_nop 1
    v_add_f32_dpp v76, v76, v76 quad_perm:[1,0,3,2] row_mask:0xf bank_mask:0xf
    s_nop 1
    v_add_f32_dpp v76, v76, v76 quad_perm:[2,3,0,1] row_mask:0xf bank_mask:0xf
    s_nop 1
    v_add_f32_dpp v76, v76, v76 row_half_mirror row_mask:0xf bank_mask:0xf
    s_nop 1
    v_add_f32_dpp v76, v76, v76 row_mirror row_mask:0xf bank_mask:0xf
    v_mov_b32 v71, v76
    s_nop 1
    v_permlane16_swap_b32 v76, v71
    v_add_f32 v76, v76, v71
    v_mov_b32 v71, v76
    s_nop 1
    v_permlane32_swap_b32 v76, v71
    v_add_f32 v76, v76, v71
    v_cvt_pk_bf16_f32 v76, v76, v76
    v_lshlrev_b32 v76, 16, v76
    s_lshl_b32 s30, s29, 2
    s_add_u32 s30, s30, 0x280000
    s_mov_b64 exec, 1
    buffer_store_dword v76, off, s[4:7], s30 sc1
    s_mov_b64 exec, -1
INR_87:
    s_lshl_b32 s29, s96, 2
    s_add_u32 s29, s29, s14
    s_lshl_b32 s29, s29, 6
    v_add_u32 v5, s29, v0
    v_lshlrev_b32 v6, 4, v5
    v_mov_b32 v40, -1
    v_mov_b32 v44, 0
    v_mov_b32 v41, -1
    v_mov_b32 v45, 0
    v_mov_b32 v42, -1
    v_mov_b32 v46, 0
    v_mov_b32 v43, -1
    v_mov_b32 v47, 0
    v_cmp_gt_u32 vcc, 0x1000, v5
    s_nop 0
    s_and_saveexec_b64 s[38:39], vcc
    s_cbranch_execz INF_88
    s_mov_b32 s30, 0x290000
    buffer_store_dwordx4 v[44:47], v6, s[4:7], s30 offen sc1
INF_88:
    s_mov_b64 exec, s[38:39]
    v_cmp_gt_u32 vcc, 0x5000, v5
    s_nop 0
    s_and_saveexec_b64 s[38:39], vcc
    s_cbranch_execz INF_89
    s_mov_b32 s30, 0x300000
    buffer_store_dwordx4 v[40:43], v6, s[4:7], s30 offen sc1
INF_89:
    s_mov_b64 exec, s[38:39]
    v_lshrrev_b32 v7, 6, v5
    v_mul_u32_u24 v7, 52429, v7
    v_lshrrev_b32 v7, 18, v7
    v_mul_u32_u24 v8, 320, v7
    v_sub_u32 v8, v5, v8
    v_lshlrev_b32 v48, 4, v8
    v_lshl_add_u32 v49, v7, 13, v48
    v_cmp_gt_u32 vcc, 0xa000, v5
    s_nop 0
    s_and_saveexec_b64 s[38:39], vcc
    s_cbranch_execz INF_90
    s_mov_b32 s30, 0x5904000
    buffer_store_dwordx4 v[40:43], v49, s[4:7], s30 offen sc1
INF_90:
    s_mov_b64 exec, s[38:39]
    s_mov_b32 s65, 0
CW_91:
    buffer_load_dwordx2 v[8:9], off, s[60:63], 0 offset:132 sc1
    s_add_u32 s65, s65, 1
    s_waitcnt vmcnt(0)
    v_readfirstlane_b32 s31, v8
    v_readfirstlane_b32 s32, v9
    s_min_u32 s64, s31, s32
    s_cmp_lg_u32 s64, 0
    s_cbranch_scc1 CWD_92
    s_cmp_gt_u32 s65, 65536
    s_cbranch_scc1 CWD_92
    s_sleep 4
    s_branch CW_91
CWD_92:
    s_sub_u32 s31, s31, 1
    s_and_b32 s31, s31, 3
    s_sub_u32 s32, s32, 1
    s_and_b32 s32, s32, 3
    s_lshl_b32 s31, s31, 13
    s_lshl_b32 s32, s32, 13
    s_add_u32 s32, s32, 0x200000
    v_and_b32 v8, 1, v7
    v_cmp_eq_u32 vcc, 1, v8
    v_mov_b32 v8, s31
    v_mov_b32 v9, s32
    v_cndmask_b32 v8, v8, v9, vcc
    v_lshrrev_b32 v9, 1, v7
    v_lshl_add_u32 v8, v9, 15, v8
    v_add_u32 v49, v8, v48
    v_cmp_le_u32 vcc, 640, v5
    v_mov_b32 v9, 0x40000000
    s_nop 0
    v_cndmask_b32 v49, v9, v49, vcc
    v_cmp_gt_u32 vcc, 0xa000, v5
    s_nop 0
    s_and_saveexec_b64 s[38:39], vcc
    s_cbranch_execz INF_93
    s_mov_b32 s30, 0x6000000
    buffer_store_dwordx4 v[40:43], v49, s[4:7], s30 offen sc1
INF_93:
    s_mov_b64 exec, s[38:39]
    s_cmp_ge_u32 s96, 10
    s_cbranch_scc1 INM1_94
    s_cmp_ge_u32 s14, 2
    s_cbranch_scc1 INM1_94
    s_cmp_ge_u32 s96, 5
    s_cselect_b32 s36, 1, 0
    s_mul_i32 s29, s36, 5
    s_sub_u32 s29, s96, s29
    s_lshl_b32 s29, s29, 10
    s_lshl_b32 s30, s36, 13
    s_add_u32 s30, s30, 0x5900000
    s_cmp_eq_u32 s36, 0
    s_cselect_b32 s37, s31, s32
    s_add_u32 s37, s37, 0x6000000
    s_cmp_eq_u32 s14, 0
    s_cselect_b32 s30, s30, s37
    s_add_u32 s30, s30, s29
    buffer_store_dwordx4 v[34:37], v3, s[4:7], s30 offen sc1
INM1_94:
    s_waitcnt vmcnt(0)
    s_barrier
    s_cmp_lg_u32 s14, 0
    s_cbranch_scc1 INE_95
    s_cmp_lg_u32 s96, 10
    s_cbranch_scc1 ING_96
    v_mov_b32 v44, 1
    v_lshlrev_b32 v6, 7, v0
    s_mov_b32 s30, 0x29a000
    s_mov_b64 exec, 3
    buffer_store_dword v44, v6, s[4:7], s30 offen sc1
    s_mov_b64 exec, -1
    s_waitcnt vmcnt(0)
ING_96:
    v_mov_b32 v8, 1
    s_mov_b64 exec, 1
    buffer_atomic_add v8, off, s[60:63], s95 sc1
    s_mov_b64 exec, -1
INE_95:
    v_mbcnt_lo_u32_b32 v0, -1, 0
    v_mbcnt_hi_u32_b32 v0, -1, v0
    s_and_b32 s12, s96, 1
    s_lshr_b32 s3, s96, 1
    s_and_b32 s13, s3, 31
    s_lshr_b32 s3, s3, 5
    s_load_dwordx4 s[48:51], s[0:1], 16
    s_load_dwordx2 s[52:53], s[0:1], 32
    s_waitcnt lgkmcnt(0)
    s_mov_b32 s46, 5242880
    s_mov_b32 s47, 0x00020000
    s_cmp_eq_u32 s3, 0
    s_cbranch_scc1 H_E0
    s_cmp_eq_u32 s3, 1
    s_cbranch_scc1 H_E1
    s_cmp_eq_u32 s3, 2
    s_cbranch_scc1 H_E2
    s_branch M_EXIT
H_E0:
    s_mov_b32 s44, s50
    s_mov_b32 s45, s51
    s_lshl_b32 s16, s13, 14
    s_mov_b32 s17, 0x80000
    s_lshl_b32 s64, s14, 10
    s_add_u32 s16, s16, 0x1400000
    s_add_u32 s16, s16, s64
    s_mul_i32 s64, s12, s17
    s_lshl_b32 s64, s64, 2
    s_add_u32 s16, s16, s64
    s_lshl_b32 s18, s13, 4
    s_add_u32 s18, s18, 0x291000
    s_branch G_T
H_E1:
    s_mov_b32 s44, s52
    s_mov_b32 s45, s53
    s_lshl_b32 s16, s13, 14
    s_mov_b32 s17, 0x80000
    s_lshl_b32 s64, s14, 11
    s_add_u32 s16, s16, 0x1402000
    s_add_u32 s16, s16, s64
    s_mul_i32 s64, s12, s17
    s_lshl_b32 s64, s64, 2
    s_add_u32 s16, s16, s64
    s_lshl_b32 s18, s13, 4
    s_add_u32 s18, s18, 0x291004
    s_branch G_N
H_E2:
    s_mov_b32 s44, s48
    s_mov_b32 s45, s49
    s_lshl_b32 s16, s13, 13
    s_mov_b32 s17, 0x40000
    s_lshl_b32 s64, s14, 10
    s_add_u32 s16, s16, 0x3400000
    s_add_u32 s16, s16, s64
    s_mul_i32 s64, s12, s17
    s_lshl_b32 s64, s64, 2
    s_add_u32 s16, s16, s64
    s_lshl_b32 s18, s13, 4
    s_add_u32 s18, s18, 0x291008
    s_branch G_T
G_T:
    s_lshl_b32 s65, s13, 8
    s_lshl_b32 s66, s14, 6
    s_add_u32 s20, s65, s66
    s_mul_i32 s21, s14, 36864
    v_lshrrev_b32 v6, 2, v0
    v_mul_u32_u24 v5, 8192, v6
    v_lshrrev_b32 v6, 5, v0
    v_lshlrev_b32 v6, 1, v6
    v_and_b32 v7, 3, v0
    v_xor_b32 v6, v6, v7
    v_lshl_add_u32 v5, v6, 4, v5
    v_lshrrev_b32 v6, 5, v0
    v_lshlrev_b32 v3, 10, v6
    v_bfe_u32 v6, v0, 2, 2
    v_lshl_add_u32 v3, v6, 6, v3
    v_and_b32 v6, 3, v0
    v_lshl_add_u32 v3, v6, 3, v3
    v_bfe_u32 v6, v0, 4, 1
    v_lshl_add_u32 v3, v6, 9, v3
    v_add_u32 v3, s21, v3
    v_lshlrev_b32 v6, 5, v6
    v_sub_u32 v4, 32, v6
    v_add_u32 v4, v4, v3
    v_add_u32 v3, v3, v6
    s_add_u32 m0, s21, 0
    s_add_u32 s64, s20, 0x0
    buffer_load_dwordx4 v5, s[44:47], s64 offen lds
    s_add_u32 m0, s21, 1024
    s_add_u32 s64, s20, 0x20000
    buffer_load_dwordx4 v5, s[44:47], s64 offen lds
    s_add_u32 m0, s21, 2048
    s_add_u32 s64, s20, 0x40000
    buffer_load_dwordx4 v5, s[44:47], s64 offen lds
    s_add_u32 m0, s21, 3072
    s_add_u32 s64, s20, 0x60000
    buffer_load_dwordx4 v5, s[44:47], s64 offen lds
    s_add_u32 m0, s21, 4096
    s_add_u32 s64, s20, 0x80000
    buffer_load_dwordx4 v5, s[44:47], s64 offen lds
    s_add_u32 m0, s21, 5120
    s_add_u32 s64, s20, 0xa0000
    buffer_load_dwordx4 v5, s[44:47], s64 offen lds
    s_add_u32 m0, s21, 6144
    s_add_u32 s64, s20, 0xc0000
    buffer_load_dwordx4 v5, s[44:47], s64 offen lds
    s_add_u32 m0, s21, 7168
    s_add_u32 s64, s20, 0xe0000
    buffer_load_dwordx4 v5, s[44:47], s64 offen lds
    s_add_u32 m0, s21, 8192
    s_add_u32 s64, s20, 0x100000
    buffer_load_dwordx4 v5, s[44:47], s64 offen lds
    s_add_u32 m0, s21, 9216
    s_add_u32 s64, s20, 0x120000
    buffer_load_dwordx4 v5, s[44:47], s64 offen lds
    s_add_u32 m0, s21, 10240
    s_add_u32 s64, s20, 0x140000
    buffer_load_dwordx4 v5, s[44:47], s64 offen lds
    s_add_u32 m0, s21, 11264
    s_add_u32 s64, s20, 0x160000
    buffer_load_dwordx4 v5, s[44:47], s64 offen lds
    s_add_u32 m0, s21, 12288
    s_add_u32 s64, s20, 0x180000
    buffer_load_dwordx4 v5, s[44:47], s64 offen lds
    s_add_u32 m0, s21, 13312
    s_add_u32 s64, s20, 0x1a0000
    buffer_load_dwordx4 v5, s[44:47], s64 offen lds
    s_add_u32 m0, s21, 14336
    s_add_u32 s64, s20, 0x1c0000
    buffer_load_dwordx4 v5, s[44:47], s64 offen lds
    s_add_u32 m0, s21, 15360
    s_add_u32 s64, s20, 0x1e0000
    buffer_load_dwordx4 v5, s[44:47], s64 offen lds
    s_add_u32 m0, s21, 16384
    s_add_u32 s64, s20, 0x200000
    buffer_load_dwordx4 v5, s[44:47], s64 offen lds
    s_add_u32 m0, s21, 17408
    s_add_u32 s64, s20, 0x220000
    buffer_load_dwordx4 v5, s[44:47], s64 offen lds
    s_add_u32 m0, s21, 18432
    s_add_u32 s64, s20, 0x240000
    buffer_load_dwordx4 v5, s[44:47], s64 offen lds
    s_add_u32 m0, s21, 19456
    s_add_u32 s64, s20, 0x260000
    buffer_load_dwordx4 v5, s[44:47], s64 offen lds
    s_add_u32 m0, s21, 20480
    s_add_u32 s64, s20, 0x280000
    buffer_load_dwordx4 v5, s[44:47], s64 offen lds
    s_add_u32 m0, s21, 21504
    s_add_u32 s64, s20, 0x2a0000
    buffer_load_dwordx4 v5, s[44:47], s64 offen lds
    s_add_u32 m0, s21, 22528
    s_add_u32 s64, s20, 0x2c0000
    buffer_load_dwordx4 v5, s[44:47], s64 offen lds
    s_add_u32 m0, s21, 23552
    s_add_u32 s64, s20, 0x2e0000
    buffer_load_dwordx4 v5, s[44:47], s64 offen lds
    s_add_u32 m0, s21, 24576
    s_add_u32 s64, s20, 0x300000
    buffer_load_dwordx4 v5, s[44:47], s64 offen lds
    s_add_u32 m0, s21, 25600
    s_add_u32 s64, s20, 0x320000
    buffer_load_dwordx4 v5, s[44:47], s64 offen lds
    s_add_u32 m0, s21, 26624
    s_add_u32 s64, s20, 0x340000
    buffer_load_dwordx4 v5, s[44:47], s64 offen lds
    s_add_u32 m0, s21, 27648
    s_add_u32 s64, s20, 0x360000
    buffer_load_dwordx4 v5, s[44:47], s64 offen lds
    s_add_u32 m0, s21, 28672
    s_add_u32 s64, s20, 0x380000
    buffer_load_dwordx4 v5, s[44:47], s64 offen lds
    s_add_u32 m0, s21, 29696
    s_add_u32 s64, s20, 0x3a0000
    buffer_load_dwordx4 v5, s[44:47], s64 offen lds
    s_add_u32 m0, s21, 30720
    s_add_u32 s64, s20, 0x3c0000
    buffer_load_dwordx4 v5, s[44:47], s64 offen lds
    s_add_u32 m0, s21, 31744
    s_add_u32 s64, s20, 0x3e0000
    buffer_load_dwordx4 v5, s[44:47], s64 offen lds
    s_add_u32 m0, s21, 32768
    s_add_u32 s64, s20, 0x400000
    buffer_load_dwordx4 v5, s[44:47], s64 offen lds
    s_add_u32 m0, s21, 33792
    s_add_u32 s64, s20, 0x420000
    buffer_load_dwordx4 v5, s[44:47], s64 offen lds
    s_add_u32 m0, s21, 34816
    s_add_u32 s64, s20, 0x440000
    buffer_load_dwordx4 v5, s[44:47], s64 offen lds
    s_add_u32 m0, s21, 35840
    s_add_u32 s64, s20, 0x460000
    buffer_load_dwordx4 v5, s[44:47], s64 offen lds
    s_waitcnt vmcnt(32)
    ds_read_b64_tr_b16 v[96:97], v3 offset:0
    ds_read_b64_tr_b16 v[98:99], v3 offset:256
    ds_read_b64_tr_b16 v[100:101], v4 offset:0
    ds_read_b64_tr_b16 v[102:103], v4 offset:256
    ds_read_b64_tr_b16 v[104:105], v3 offset:2048
    ds_read_b64_tr_b16 v[106:107], v3 offset:2304
    ds_read_b64_tr_b16 v[108:109], v4 offset:2048
    ds_read_b64_tr_b16 v[110:111], v4 offset:2304
    s_waitcnt lgkmcnt(0)
    s_add_u32 m0, s21, 0
    s_add_u32 s64, s20, 0x480000
    buffer_load_dwordx4 v5, s[44:47], s64 offen lds
    s_add_u32 m0, s21, 1024
    s_add_u32 s64, s20, 0x4a0000
    buffer_load_dwordx4 v5, s[44:47], s64 offen lds
    s_add_u32 m0, s21, 2048
    s_add_u32 s64, s20, 0x4c0000
    buffer_load_dwordx4 v5, s[44:47], s64 offen lds
    s_add_u32 m0, s21, 3072
    s_add_u32 s64, s20, 0x4e0000
    buffer_load_dwordx4 v5, s[44:47], s64 offen lds
    s_waitcnt vmcnt(32)
    ds_read_b64_tr_b16 v[112:113], v3 offset:4096
    ds_read_b64_tr_b16 v[114:115], v3 offset:4352
    ds_read_b64_tr_b16 v[116:117], v4 offset:4096
    ds_read_b64_tr_b16 v[118:119], v4 offset:4352
    ds_read_b64_tr_b16 v[120:121], v3 offset:6144
    ds_read_b64_tr_b16 v[122:123], v3 offset:6400
    ds_read_b64_tr_b16 v[124:125], v4 offset:6144
    ds_read_b64_tr_b16 v[126:127], v4 offset:6400
    s_waitcnt lgkmcnt(0)
    s_waitcnt vmcnt(28)
    ds_read_b64_tr_b16 v[128:129], v3 offset:8192
    ds_read_b64_tr_b16 v[130:131], v3 offset:8448
    ds_read_b64_tr_b16 v[132:133], v4 offset:8192
    ds_read_b64_tr_b16 v[134:135], v4 offset:8448
    ds_read_b64_tr_b16 v[136:137], v3 offset:10240
    ds_read_b64_tr_b16 v[138:139], v3 offset:10496
    ds_read_b64_tr_b16 v[140:141], v4 offset:10240
    ds_read_b64_tr_b16 v[142:143], v4 offset:10496
    s_waitcnt lgkmcnt(0)
    s_waitcnt vmcnt(24)
    ds_read_b64_tr_b16 v[144:145], v3 offset:12288
    ds_read_b64_tr_b16 v[146:147], v3 offset:12544
    ds_read_b64_tr_b16 v[148:149], v4 offset:12288
    ds_read_b64_tr_b16 v[150:151], v4 offset:12544
    ds_read_b64_tr_b16 v[152:153], v3 offset:14336
    ds_read_b64_tr_b16 v[154:155], v3 offset:14592
    ds_read_b64_tr_b16 v[156:157], v4 offset:14336
    ds_read_b64_tr_b16 v[158:159], v4 offset:14592
    s_waitcnt lgkmcnt(0)
    s_waitcnt vmcnt(20)
    ds_read_b64_tr_b16 v[160:161], v3 offset:16384
    ds_read_b64_tr_b16 v[162:163], v3 offset:16640
    ds_read_b64_tr_b16 v[164:165], v4 offset:16384
    ds_read_b64_tr_b16 v[166:167], v4 offset:16640
    ds_read_b64_tr_b16 v[168:169], v3 offset:18432
    ds_read_b64_tr_b16 v[170:171], v3 offset:18688
    ds_read_b64_tr_b16 v[172:173], v4 offset:18432
    ds_read_b64_tr_b16 v[174:175], v4 offset:18688
    s_waitcnt lgkmcnt(0)
    s_waitcnt vmcnt(16)
    ds_read_b64_tr_b16 v[176:177], v3 offset:20480
    ds_read_b64_tr_b16 v[178:179], v3 offset:20736
    ds_read_b64_tr_b16 v[180:181], v4 offset:20480
    ds_read_b64_tr_b16 v[182:183], v4 offset:20736
    ds_read_b64_tr_b16 v[184:185], v3 offset:22528
    ds_read_b64_tr_b16 v[186:187], v3 offset:22784
    ds_read_b64_tr_b16 v[188:189], v4 offset:22528
    ds_read_b64_tr_b16 v[190:191], v4 offset:22784
    s_waitcnt lgkmcnt(0)
    s_waitcnt vmcnt(12)
    ds_read_b64_tr_b16 v[192:193], v3 offset:24576
    ds_read_b64_tr_b16 v[194:195], v3 offset:24832
    ds_read_b64_tr_b16 v[196:197], v4 offset:24576
    ds_read_b64_tr_b16 v[198:199], v4 offset:24832
    ds_read_b64_tr_b16 v[200:201], v3 offset:26624
    ds_read_b64_tr_b16 v[202:203], v3 offset:26880
    ds_read_b64_tr_b16 v[204:205], v4 offset:26624
    ds_read_b64_tr_b16 v[206:207], v4 offset:26880
    s_waitcnt lgkmcnt(0)
    s_waitcnt vmcnt(8)
    ds_read_b64_tr_b16 v[208:209], v3 offset:28672
    ds_read_b64_tr_b16 v[210:211], v3 offset:28928
    ds_read_b64_tr_b16 v[212:213], v4 offset:28672
    ds_read_b64_tr_b16 v[214:215], v4 offset:28928
    ds_read_b64_tr_b16 v[216:217], v3 offset:30720
    ds_read_b64_tr_b16 v[218:219], v3 offset:30976
    ds_read_b64_tr_b16 v[220:221], v4 offset:30720
    ds_read_b64_tr_b16 v[222:223], v4 offset:30976
    s_waitcnt lgkmcnt(0)
    s_waitcnt vmcnt(4)
    ds_read_b64_tr_b16 v[224:225], v3 offset:32768
    ds_read_b64_tr_b16 v[226:227], v3 offset:33024
    ds_read_b64_tr_b16 v[228:229], v4 offset:32768
    ds_read_b64_tr_b16 v[230:231], v4 offset:33024
    ds_read_b64_tr_b16 v[232:233], v3 offset:34816
    ds_read_b64_tr_b16 v[234:235], v3 offset:35072
    ds_read_b64_tr_b16 v[236:237], v4 offset:34816
    ds_read_b64_tr_b16 v[238:239], v4 offset:35072
    s_waitcnt lgkmcnt(0)
    s_waitcnt vmcnt(0)
    ds_read_b64_tr_b16 v[240:241], v3 offset:0
    ds_read_b64_tr_b16 v[242:243], v3 offset:256
    ds_read_b64_tr_b16 v[244:245], v4 offset:0
    ds_read_b64_tr_b16 v[246:247], v4 offset:256
    ds_read_b64_tr_b16 v[248:249], v3 offset:2048
    ds_read_b64_tr_b16 v[250:251], v3 offset:2304
    ds_read_b64_tr_b16 v[252:253], v4 offset:2048
    ds_read_b64_tr_b16 v[254:255], v4 offset:2304
    s_waitcnt lgkmcnt(0)
    s_cmp_lg_u32 s97, 0
    s_cbranch_scc1 CM_97
    v_mbcnt_lo_u32_b32 v0, -1, 0
    v_mbcnt_hi_u32_b32 v0, -1, v0
    v_mul_u32_u24 v8, 32, v0
    s_mov_b32 s64, 0x0
    s_mov_b32 s65, 0
    s_mov_b64 exec, 0xff
TK_98:
    buffer_load_dword v9, v8, s[60:63], s64 offen sc1
    s_add_u32 s65, s65, 1
    s_waitcnt vmcnt(0)
    s_mov_b32 s66, 0
    v_readlane_b32 s67, v9, 0
    s_add_u32 s66, s66, s67
    v_readlane_b32 s67, v9, 1
    s_add_u32 s66, s66, s67
    v_readlane_b32 s67, v9, 2
    s_add_u32 s66, s66, s67
    v_readlane_b32 s67, v9, 3
    s_add_u32 s66, s66, s67
    v_readlane_b32 s67, v9, 4
    s_add_u32 s66, s66, s67
    v_readlane_b32 s67, v9, 5
    s_add_u32 s66, s66, s67
    v_readlane_b32 s67, v9, 6
    s_add_u32 s66, s66, s67
    v_readlane_b32 s67, v9, 7
    s_add_u32 s66, s66, s67
    s_cmp_ge_u32 s66, 256
    s_cbranch_scc1 TKD_99
    s_cmp_gt_u32 s65, 262144
    s_cbranch_scc0 TK_98
TKD_99:
    v_cmp_ne_u32 vcc, 32, v9
    s_mov_b64 exec, -1
    s_cbranch_vccnz M_SLOW
CM_97:
    s_mov_b32 s65, 0
GI_100:
    buffer_load_dword v8, off, s[60:63], s95 sc1
    s_add_u32 s65, s65, 1
    s_waitcnt vmcnt(0)
    v_readfirstlane_b32 s64, v8
    s_cmp_ge_u32 s64, 192
    s_cbranch_scc1 GID_101
    s_cmp_gt_u32 s65, 65536
    s_cbranch_scc1 GID_101
    s_sleep 4
    s_branch GI_100
GID_101:
    v_mbcnt_lo_u32_b32 v0, -1, 0
    v_mbcnt_hi_u32_b32 v0, -1, v0
    s_cmp_lg_u32 s3, 2
    s_cbranch_scc1 NOSEL_102
    s_or_b32 s64, s13, s12
    s_or_b32 s64, s64, s14
    s_cmp_lg_u32 s64, 0
    s_cbranch_scc1 NOSEL_102
    s_mov_b32 s29, 0
    v_lshlrev_b32 v1, 4, v0
    s_mov_b32 s64, 0x280000
    buffer_load_dwordx4 v[16:19], v1, s[4:7], s64 offen offset:0 sc1
    buffer_load_dwordx4 v[20:23], v1, s[4:7], s64 offen offset:1024 sc1
    buffer_load_dwordx4 v[24:27], v1, s[4:7], s64 offen offset:2048 sc1
    buffer_load_dwordx4 v[28:31], v1, s[4:7], s64 offen offset:3072 sc1
    s_add_u32 s64, s64, 4096
    buffer_load_dwordx4 v[32:35], v1, s[4:7], s64 offen offset:0 sc1
    buffer_load_dwordx4 v[36:39], v1, s[4:7], s64 offen offset:1024 sc1
    buffer_load_dwordx4 v[40:43], v1, s[4:7], s64 offen offset:2048 sc1
    buffer_load_dwordx4 v[44:47], v1, s[4:7], s64 offen offset:3072 sc1
    s_waitcnt vmcnt(0)
    v_lshlrev_b32 v2, 2, v0
    v_ashrrev_i32 v3, 31, v16
    v_or_b32 v3, 0x80000000, v3
    v_xor_b32 v16, v16, v3
    v_and_b32 v16, 0xffff0000, v16
    v_sub_u32 v3, 65535, v2
    v_or_b32 v16, v16, v3
    v_ashrrev_i32 v3, 31, v17
    v_or_b32 v3, 0x80000000, v3
    v_xor_b32 v17, v17, v3
    v_and_b32 v17, 0xffff0000, v17
    v_sub_u32 v3, 65534, v2
    v_or_b32 v17, v17, v3
    v_ashrrev_i32 v3, 31, v18
    v_or_b32 v3, 0x80000000, v3
    v_xor_b32 v18, v18, v3
    v_and_b32 v18, 0xffff0000, v18
    v_sub_u32 v3, 65533, v2
    v_or_b32 v18, v18, v3
    v_ashrrev_i32 v3, 31, v19
    v_or_b32 v3, 0x80000000, v3
    v_xor_b32 v19, v19, v3
    v_and_b32 v19, 0xffff0000, v19
    v_sub_u32 v3, 65532, v2
    v_or_b32 v19, v19, v3
    v_ashrrev_i32 v3, 31, v20
    v_or_b32 v3, 0x80000000, v3
    v_xor_b32 v20, v20, v3
    v_and_b32 v20, 0xffff0000, v20
    v_sub_u32 v3, 65279, v2
    v_or_b32 v20, v20, v3
    v_ashrrev_i32 v3, 31, v21
    v_or_b32 v3, 0x80000000, v3
    v_xor_b32 v21, v21, v3
    v_and_b32 v21, 0xffff0000, v21
    v_sub_u32 v3, 65278, v2
    v_or_b32 v21, v21, v3
    v_ashrrev_i32 v3, 31, v22
    v_or_b32 v3, 0x80000000, v3
    v_xor_b32 v22, v22, v3
    v_and_b32 v22, 0xffff0000, v22
    v_sub_u32 v3, 65277, v2
    v_or_b32 v22, v22, v3
    v_ashrrev_i32 v3, 31, v23
    v_or_b32 v3, 0x80000000, v3
    v_xor_b32 v23, v23, v3
    v_and_b32 v23, 0xffff0000, v23
    v_sub_u32 v3, 65276, v2
    v_or_b32 v23, v23, v3
    v_ashrrev_i32 v3, 31, v24
    v_or_b32 v3, 0x80000000, v3
    v_xor_b32 v24, v24, v3
    v_and_b32 v24, 0xffff0000, v24
    v_sub_u32 v3, 65023, v2
    v_or_b32 v24, v24, v3
    v_ashrrev_i32 v3, 31, v25
    v_or_b32 v3, 0x80000000, v3
    v_xor_b32 v25, v25, v3
    v_and_b32 v25, 0xffff0000, v25
    v_sub_u32 v3, 65022, v2
    v_or_b32 v25, v25, v3
    v_ashrrev_i32 v3, 31, v26
    v_or_b32 v3, 0x80000000, v3
    v_xor_b32 v26, v26, v3
    v_and_b32 v26, 0xffff0000, v26
    v_sub_u32 v3, 65021, v2
    v_or_b32 v26, v26, v3
    v_ashrrev_i32 v3, 31, v27
    v_or_b32 v3, 0x80000000, v3
    v_xor_b32 v27, v27, v3
    v_and_b32 v27, 0xffff0000, v27
    v_sub_u32 v3, 65020, v2
    v_or_b32 v27, v27, v3
    v_ashrrev_i32 v3, 31, v28
    v_or_b32 v3, 0x80000000, v3
    v_xor_b32 v28, v28, v3
    v_and_b32 v28, 0xffff0000, v28
    v_sub_u32 v3, 64767, v2
    v_or_b32 v28, v28, v3
    v_ashrrev_i32 v3, 31, v29
    v_or_b32 v3, 0x80000000, v3
    v_xor_b32 v29, v29, v3
    v_and_b32 v29, 0xffff0000, v29
    v_sub_u32 v3, 64766, v2
    v_or_b32 v29, v29, v3
    v_ashrrev_i32 v3, 31, v30
    v_or_b32 v3, 0x80000000, v3
    v_xor_b32 v30, v30, v3
    v_and_b32 v30, 0xffff0000, v30
    v_sub_u32 v3, 64765, v2
    v_or_b32 v30, v30, v3
    v_ashrrev_i32 v3, 31, v31
    v_or_b32 v3, 0x80000000, v3
    v_xor_b32 v31, v31, v3
    v_and_b32 v31, 0xffff0000, v31
    v_sub_u32 v3, 64764, v2
    v_or_b32 v31, v31, v3
    v_ashrrev_i32 v3, 31, v32
    v_or_b32 v3, 0x80000000, v3
    v_xor_b32 v32, v32, v3
    v_and_b32 v32, 0xffff0000, v32
    v_sub_u32 v3, 64511, v2
    v_or_b32 v32, v32, v3
    v_ashrrev_i32 v3, 31, v33
    v_or_b32 v3, 0x80000000, v3
    v_xor_b32 v33, v33, v3
    v_and_b32 v33, 0xffff0000, v33
    v_sub_u32 v3, 64510, v2
    v_or_b32 v33, v33, v3
    v_ashrrev_i32 v3, 31, v34
    v_or_b32 v3, 0x80000000, v3
    v_xor_b32 v34, v34, v3
    v_and_b32 v34, 0xffff0000, v34
    v_sub_u32 v3, 64509, v2
    v_or_b32 v34, v34, v3
    v_ashrrev_i32 v3, 31, v35
    v_or_b32 v3, 0x80000000, v3
    v_xor_b32 v35, v35, v3
    v_and_b32 v35, 0xffff0000, v35
    v_sub_u32 v3, 64508, v2
    v_or_b32 v35, v35, v3
    v_ashrrev_i32 v3, 31, v36
    v_or_b32 v3, 0x80000000, v3
    v_xor_b32 v36, v36, v3
    v_and_b32 v36, 0xffff0000, v36
    v_sub_u32 v3, 64255, v2
    v_or_b32 v36, v36, v3
    v_ashrrev_i32 v3, 31, v37
    v_or_b32 v3, 0x80000000, v3
    v_xor_b32 v37, v37, v3
    v_and_b32 v37, 0xffff0000, v37
    v_sub_u32 v3, 64254, v2
    v_or_b32 v37, v37, v3
    v_ashrrev_i32 v3, 31, v38
    v_or_b32 v3, 0x80000000, v3
    v_xor_b32 v38, v38, v3
    v_and_b32 v38, 0xffff0000, v38
    v_sub_u32 v3, 64253, v2
    v_or_b32 v38, v38, v3
    v_ashrrev_i32 v3, 31, v39
    v_or_b32 v3, 0x80000000, v3
    v_xor_b32 v39, v39, v3
    v_and_b32 v39, 0xffff0000, v39
    v_sub_u32 v3, 64252, v2
    v_or_b32 v39, v39, v3
    v_ashrrev_i32 v3, 31, v40
    v_or_b32 v3, 0x80000000, v3
    v_xor_b32 v40, v40, v3
    v_and_b32 v40, 0xffff0000, v40
    v_sub_u32 v3, 63999, v2
    v_or_b32 v40, v40, v3
    v_ashrrev_i32 v3, 31, v41
    v_or_b32 v3, 0x80000000, v3
    v_xor_b32 v41, v41, v3
    v_and_b32 v41, 0xffff0000, v41
    v_sub_u32 v3, 63998, v2
    v_or_b32 v41, v41, v3
    v_ashrrev_i32 v3, 31, v42
    v_or_b32 v3, 0x80000000, v3
    v_xor_b32 v42, v42, v3
    v_and_b32 v42, 0xffff0000, v42
    v_sub_u32 v3, 63997, v2
    v_or_b32 v42, v42, v3
    v_ashrrev_i32 v3, 31, v43
    v_or_b32 v3, 0x80000000, v3
    v_xor_b32 v43, v43, v3
    v_and_b32 v43, 0xffff0000, v43
    v_sub_u32 v3, 63996, v2
    v_or_b32 v43, v43, v3
    v_ashrrev_i32 v3, 31, v44
    v_or_b32 v3, 0x80000000, v3
    v_xor_b32 v44, v44, v3
    v_and_b32 v44, 0xffff0000, v44
    v_sub_u32 v3, 63743, v2
    v_or_b32 v44, v44, v3
    v_ashrrev_i32 v3, 31, v45
    v_or_b32 v3, 0x80000000, v3
    v_xor_b32 v45, v45, v3
    v_and_b32 v45, 0xffff0000, v45
    v_sub_u32 v3, 63742, v2
    v_or_b32 v45, v45, v3
    v_ashrrev_i32 v3, 31, v46
    v_or_b32 v3, 0x80000000, v3
    v_xor_b32 v46, v46, v3
    v_and_b32 v46, 0xffff0000, v46
    v_sub_u32 v3, 63741, v2
    v_or_b32 v46, v46, v3
    v_ashrrev_i32 v3, 31, v47
    v_or_b32 v3, 0x80000000, v3
    v_xor_b32 v47, v47, v3
    v_and_b32 v47, 0xffff0000, v47
    v_sub_u32 v3, 63740, v2
    v_or_b32 v47, v47, v3
    v_max3_u32 v4, v16, v17, v18
    v_max3_u32 v4, v4, v19, v20
    v_max3_u32 v4, v4, v21, v22
    v_max3_u32 v4, v4, v23, v24
    v_max3_u32 v4, v4, v25, v26
    v_max3_u32 v4, v4, v27, v28
    v_max3_u32 v4, v4, v29, v30
    v_max3_u32 v4, v4, v31, v32
    v_max3_u32 v4, v4, v33, v34
    v_max3_u32 v4, v4, v35, v36
    v_max3_u32 v4, v4, v37, v38
    v_max3_u32 v4, v4, v39, v40
    v_max3_u32 v4, v4, v41, v42
    v_max3_u32 v4, v4, v43, v44
    v_max3_u32 v4, v4, v45, v46
    v_max_u32 v4, v4, v47
    s_nop 1
    v_max_u32_dpp v4, v4, v4 quad_perm:[1,0,3,2] row_mask:0xf bank_mask:0xf
    s_nop 1
    v_max_u32_dpp v4, v4, v4 quad_perm:[2,3,0,1] row_mask:0xf bank_mask:0xf
    s_nop 1
    v_max_u32_dpp v4, v4, v4 row_half_mirror row_mask:0xf bank_mask:0xf
    s_nop 1
    v_max_u32_dpp v4, v4, v4 row_mirror row_mask:0xf bank_mask:0xf
    v_mov_b32 v5, v4
    s_nop 1
    v_permlane16_swap_b32 v4, v5
    v_max_u32 v4, v4, v5
    v_mov_b32 v5, v4
    s_nop 1
    v_permlane32_swap_b32 v4, v5
    v_max_u32 v4, v4, v5
    v_mov_b32 v56, v4
    v_cmp_eq_u32 vcc, v4, v16
    s_nop 1
    v_cndmask_b32 v16, v16, 0, vcc
    v_cmp_eq_u32 vcc, v4, v17
    s_nop 1
    v_cndmask_b32 v17, v17, 0, vcc
    v_cmp_eq_u32 vcc, v4, v18
    s_nop 1
    v_cndmask_b32 v18, v18, 0, vcc
    v_cmp_eq_u32 vcc, v4, v19
    s_nop 1
    v_cndmask_b32 v19, v19, 0, vcc
    v_cmp_eq_u32 vcc, v4, v20
    s_nop 1
    v_cndmask_b32 v20, v20, 0, vcc
    v_cmp_eq_u32 vcc, v4, v21
    s_nop 1
    v_cndmask_b32 v21, v21, 0, vcc
    v_cmp_eq_u32 vcc, v4, v22
    s_nop 1
    v_cndmask_b32 v22, v22, 0, vcc
    v_cmp_eq_u32 vcc, v4, v23
    s_nop 1
    v_cndmask_b32 v23, v23, 0, vcc
    v_cmp_eq_u32 vcc, v4, v24
    s_nop 1
    v_cndmask_b32 v24, v24, 0, vcc
    v_cmp_eq_u32 vcc, v4, v25
    s_nop 1
    v_cndmask_b32 v25, v25, 0, vcc
    v_cmp_eq_u32 vcc, v4, v26
    s_nop 1
    v_cndmask_b32 v26, v26, 0, vcc
    v_cmp_eq_u32 vcc, v4, v27
    s_nop 1
    v_cndmask_b32 v27, v27, 0, vcc
    v_cmp_eq_u32 vcc, v4, v28
    s_nop 1
    v_cndmask_b32 v28, v28, 0, vcc
    v_cmp_eq_u32 vcc, v4, v29
    s_nop 1
    v_cndmask_b32 v29, v29, 0, vcc
    v_cmp_eq_u32 vcc, v4, v30
    s_nop 1
    v_cndmask_b32 v30, v30, 0, vcc
    v_cmp_eq_u32 vcc, v4, v31
    s_nop 1
    v_cndmask_b32 v31, v31, 0, vcc
    v_cmp_eq_u32 vcc, v4, v32
    s_nop 1
    v_cndmask_b32 v32, v32, 0, vcc
    v_cmp_eq_u32 vcc, v4, v33
    s_nop 1
    v_cndmask_b32 v33, v33, 0, vcc
    v_cmp_eq_u32 vcc, v4, v34
    s_nop 1
    v_cndmask_b32 v34, v34, 0, vcc
    v_cmp_eq_u32 vcc, v4, v35
    s_nop 1
    v_cndmask_b32 v35, v35, 0, vcc
    v_cmp_eq_u32 vcc, v4, v36
    s_nop 1
    v_cndmask_b32 v36, v36, 0, vcc
    v_cmp_eq_u32 vcc, v4, v37
    s_nop 1
    v_cndmask_b32 v37, v37, 0, vcc
    v_cmp_eq_u32 vcc, v4, v38
    s_nop 1
    v_cndmask_b32 v38, v38, 0, vcc
    v_cmp_eq_u32 vcc, v4, v39
    s_nop 1
    v_cndmask_b32 v39, v39, 0, vcc
    v_cmp_eq_u32 vcc, v4, v40
    s_nop 1
    v_cndmask_b32 v40, v40, 0, vcc
    v_cmp_eq_u32 vcc, v4, v41
    s_nop 1
    v_cndmask_b32 v41, v41, 0, vcc
    v_cmp_eq_u32 vcc, v4, v42
    s_nop 1
    v_cndmask_b32 v42, v42, 0, vcc
    v_cmp_eq_u32 vcc, v4, v43
    s_nop 1
    v_cndmask_b32 v43, v43, 0, vcc
    v_cmp_eq_u32 vcc, v4, v44
    s_nop 1
    v_cndmask_b32 v44, v44, 0, vcc
    v_cmp_eq_u32 vcc, v4, v45
    s_nop 1
    v_cndmask_b32 v45, v45, 0, vcc
    v_cmp_eq_u32 vcc, v4, v46
    s_nop 1
    v_cndmask_b32 v46, v46, 0, vcc
    v_cmp_eq_u32 vcc, v4, v47
    s_nop 1
    v_cndmask_b32 v47, v47, 0, vcc
    v_max3_u32 v4, v16, v17, v18
    v_max3_u32 v4, v4, v19, v20
    v_max3_u32 v4, v4, v21, v22
    v_max3_u32 v4, v4, v23, v24
    v_max3_u32 v4, v4, v25, v26
    v_max3_u32 v4, v4, v27, v28
    v_max3_u32 v4, v4, v29, v30
    v_max3_u32 v4, v4, v31, v32
    v_max3_u32 v4, v4, v33, v34
    v_max3_u32 v4, v4, v35, v36
    v_max3_u32 v4, v4, v37, v38
    v_max3_u32 v4, v4, v39, v40
    v_max3_u32 v4, v4, v41, v42
    v_max3_u32 v4, v4, v43, v44
    v_max3_u32 v4, v4, v45, v46
    v_max_u32 v4, v4, v47
    s_nop 1
    v_max_u32_dpp v4, v4, v4 quad_perm:[1,0,3,2] row_mask:0xf bank_mask:0xf
    s_nop 1
    v_max_u32_dpp v4, v4, v4 quad_perm:[2,3,0,1] row_mask:0xf bank_mask:0xf
    s_nop 1
    v_max_u32_dpp v4, v4, v4 row_half_mirror row_mask:0xf bank_mask:0xf
    s_nop 1
    v_max_u32_dpp v4, v4, v4 row_mirror row_mask:0xf bank_mask:0xf
    v_mov_b32 v5, v4
    s_nop 1
    v_permlane16_swap_b32 v4, v5
    v_max_u32 v4, v4, v5
    v_mov_b32 v5, v4
    s_nop 1
    v_permlane32_swap_b32 v4, v5
    v_max_u32 v4, v4, v5
    v_mov_b32 v57, v4
    v_cmp_eq_u32 vcc, v4, v16
    s_nop 1
    v_cndmask_b32 v16, v16, 0, vcc
    v_cmp_eq_u32 vcc, v4, v17
    s_nop 1
    v_cndmask_b32 v17, v17, 0, vcc
    v_cmp_eq_u32 vcc, v4, v18
    s_nop 1
    v_cndmask_b32 v18, v18, 0, vcc
    v_cmp_eq_u32 vcc, v4, v19
    s_nop 1
    v_cndmask_b32 v19, v19, 0, vcc
    v_cmp_eq_u32 vcc, v4, v20
    s_nop 1
    v_cndmask_b32 v20, v20, 0, vcc
    v_cmp_eq_u32 vcc, v4, v21
    s_nop 1
    v_cndmask_b32 v21, v21, 0, vcc
    v_cmp_eq_u32 vcc, v4, v22
    s_nop 1
    v_cndmask_b32 v22, v22, 0, vcc
    v_cmp_eq_u32 vcc, v4, v23
    s_nop 1
    v_cndmask_b32 v23, v23, 0, vcc
    v_cmp_eq_u32 vcc, v4, v24
    s_nop 1
    v_cndmask_b32 v24, v24, 0, vcc
    v_cmp_eq_u32 vcc, v4, v25
    s_nop 1
    v_cndmask_b32 v25, v25, 0, vcc
    v_cmp_eq_u32 vcc, v4, v26
    s_nop 1
    v_cndmask_b32 v26, v26, 0, vcc
    v_cmp_eq_u32 vcc, v4, v27
    s_nop 1
    v_cndmask_b32 v27, v27, 0, vcc
    v_cmp_eq_u32 vcc, v4, v28
    s_nop 1
    v_cndmask_b32 v28, v28, 0, vcc
    v_cmp_eq_u32 vcc, v4, v29
    s_nop 1
    v_cndmask_b32 v29, v29, 0, vcc
    v_cmp_eq_u32 vcc, v4, v30
    s_nop 1
    v_cndmask_b32 v30, v30, 0, vcc
    v_cmp_eq_u32 vcc, v4, v31
    s_nop 1
    v_cndmask_b32 v31, v31, 0, vcc
    v_cmp_eq_u32 vcc, v4, v32
    s_nop 1
    v_cndmask_b32 v32, v32, 0, vcc
    v_cmp_eq_u32 vcc, v4, v33
    s_nop 1
    v_cndmask_b32 v33, v33, 0, vcc
    v_cmp_eq_u32 vcc, v4, v34
    s_nop 1
    v_cndmask_b32 v34, v34, 0, vcc
    v_cmp_eq_u32 vcc, v4, v35
    s_nop 1
    v_cndmask_b32 v35, v35, 0, vcc
    v_cmp_eq_u32 vcc, v4, v36
    s_nop 1
    v_cndmask_b32 v36, v36, 0, vcc
    v_cmp_eq_u32 vcc, v4, v37
    s_nop 1
    v_cndmask_b32 v37, v37, 0, vcc
    v_cmp_eq_u32 vcc, v4, v38
    s_nop 1
    v_cndmask_b32 v38, v38, 0, vcc
    v_cmp_eq_u32 vcc, v4, v39
    s_nop 1
    v_cndmask_b32 v39, v39, 0, vcc
    v_cmp_eq_u32 vcc, v4, v40
    s_nop 1
    v_cndmask_b32 v40, v40, 0, vcc
    v_cmp_eq_u32 vcc, v4, v41
    s_nop 1
    v_cndmask_b32 v41, v41, 0, vcc
    v_cmp_eq_u32 vcc, v4, v42
    s_nop 1
    v_cndmask_b32 v42, v42, 0, vcc
    v_cmp_eq_u32 vcc, v4, v43
    s_nop 1
    v_cndmask_b32 v43, v43, 0, vcc
    v_cmp_eq_u32 vcc, v4, v44
    s_nop 1
    v_cndmask_b32 v44, v44, 0, vcc
    v_cmp_eq_u32 vcc, v4, v45
    s_nop 1
    v_cndmask_b32 v45, v45, 0, vcc
    v_cmp_eq_u32 vcc, v4, v46
    s_nop 1
    v_cndmask_b32 v46, v46, 0, vcc
    v_cmp_eq_u32 vcc, v4, v47
    s_nop 1
    v_cndmask_b32 v47, v47, 0, vcc
    v_max3_u32 v4, v16, v17, v18
    v_max3_u32 v4, v4, v19, v20
    v_max3_u32 v4, v4, v21, v22
    v_max3_u32 v4, v4, v23, v24
    v_max3_u32 v4, v4, v25, v26
    v_max3_u32 v4, v4, v27, v28
    v_max3_u32 v4, v4, v29, v30
    v_max3_u32 v4, v4, v31, v32
    v_max3_u32 v4, v4, v33, v34
    v_max3_u32 v4, v4, v35, v36
    v_max3_u32 v4, v4, v37, v38
    v_max3_u32 v4, v4, v39, v40
    v_max3_u32 v4, v4, v41, v42
    v_max3_u32 v4, v4, v43, v44
    v_max3_u32 v4, v4, v45, v46
    v_max_u32 v4, v4, v47
    s_nop 1
    v_max_u32_dpp v4, v4, v4 quad_perm:[1,0,3,2] row_mask:0xf bank_mask:0xf
    s_nop 1
    v_max_u32_dpp v4, v4, v4 quad_perm:[2,3,0,1] row_mask:0xf bank_mask:0xf
    s_nop 1
    v_max_u32_dpp v4, v4, v4 row_half_mirror row_mask:0xf bank_mask:0xf
    s_nop 1
    v_max_u32_dpp v4, v4, v4 row_mirror row_mask:0xf bank_mask:0xf
    v_mov_b32 v5, v4
    s_nop 1
    v_permlane16_swap_b32 v4, v5
    v_max_u32 v4, v4, v5
    v_mov_b32 v5, v4
    s_nop 1
    v_permlane32_swap_b32 v4, v5
    v_max_u32 v4, v4, v5
    v_mov_b32 v58, v4
    v_cmp_eq_u32 vcc, v4, v16
    s_nop 1
    v_cndmask_b32 v16, v16, 0, vcc
    v_cmp_eq_u32 vcc, v4, v17
    s_nop 1
    v_cndmask_b32 v17, v17, 0, vcc
    v_cmp_eq_u32 vcc, v4, v18
    s_nop 1
    v_cndmask_b32 v18, v18, 0, vcc
    v_cmp_eq_u32 vcc, v4, v19
    s_nop 1
    v_cndmask_b32 v19, v19, 0, vcc
    v_cmp_eq_u32 vcc, v4, v20
    s_nop 1
    v_cndmask_b32 v20, v20, 0, vcc
    v_cmp_eq_u32 vcc, v4, v21
    s_nop 1
    v_cndmask_b32 v21, v21, 0, vcc
    v_cmp_eq_u32 vcc, v4, v22
    s_nop 1
    v_cndmask_b32 v22, v22, 0, vcc
    v_cmp_eq_u32 vcc, v4, v23
    s_nop 1
    v_cndmask_b32 v23, v23, 0, vcc
    v_cmp_eq_u32 vcc, v4, v24
    s_nop 1
    v_cndmask_b32 v24, v24, 0, vcc
    v_cmp_eq_u32 vcc, v4, v25
    s_nop 1
    v_cndmask_b32 v25, v25, 0, vcc
    v_cmp_eq_u32 vcc, v4, v26
    s_nop 1
    v_cndmask_b32 v26, v26, 0, vcc
    v_cmp_eq_u32 vcc, v4, v27
    s_nop 1
    v_cndmask_b32 v27, v27, 0, vcc
    v_cmp_eq_u32 vcc, v4, v28
    s_nop 1
    v_cndmask_b32 v28, v28, 0, vcc
    v_cmp_eq_u32 vcc, v4, v29
    s_nop 1
    v_cndmask_b32 v29, v29, 0, vcc
    v_cmp_eq_u32 vcc, v4, v30
    s_nop 1
    v_cndmask_b32 v30, v30, 0, vcc
    v_cmp_eq_u32 vcc, v4, v31
    s_nop 1
    v_cndmask_b32 v31, v31, 0, vcc
    v_cmp_eq_u32 vcc, v4, v32
    s_nop 1
    v_cndmask_b32 v32, v32, 0, vcc
    v_cmp_eq_u32 vcc, v4, v33
    s_nop 1
    v_cndmask_b32 v33, v33, 0, vcc
    v_cmp_eq_u32 vcc, v4, v34
    s_nop 1
    v_cndmask_b32 v34, v34, 0, vcc
    v_cmp_eq_u32 vcc, v4, v35
    s_nop 1
    v_cndmask_b32 v35, v35, 0, vcc
    v_cmp_eq_u32 vcc, v4, v36
    s_nop 1
    v_cndmask_b32 v36, v36, 0, vcc
    v_cmp_eq_u32 vcc, v4, v37
    s_nop 1
    v_cndmask_b32 v37, v37, 0, vcc
    v_cmp_eq_u32 vcc, v4, v38
    s_nop 1
    v_cndmask_b32 v38, v38, 0, vcc
    v_cmp_eq_u32 vcc, v4, v39
    s_nop 1
    v_cndmask_b32 v39, v39, 0, vcc
    v_cmp_eq_u32 vcc, v4, v40
    s_nop 1
    v_cndmask_b32 v40, v40, 0, vcc
    v_cmp_eq_u32 vcc, v4, v41
    s_nop 1
    v_cndmask_b32 v41, v41, 0, vcc
    v_cmp_eq_u32 vcc, v4, v42
    s_nop 1
    v_cndmask_b32 v42, v42, 0, vcc
    v_cmp_eq_u32 vcc, v4, v43
    s_nop 1
    v_cndmask_b32 v43, v43, 0, vcc
    v_cmp_eq_u32 vcc, v4, v44
    s_nop 1
    v_cndmask_b32 v44, v44, 0, vcc
    v_cmp_eq_u32 vcc, v4, v45
    s_nop 1
    v_cndmask_b32 v45, v45, 0, vcc
    v_cmp_eq_u32 vcc, v4, v46
    s_nop 1
    v_cndmask_b32 v46, v46, 0, vcc
    v_cmp_eq_u32 vcc, v4, v47
    s_nop 1
    v_cndmask_b32 v47, v47, 0, vcc
    v_max3_u32 v4, v16, v17, v18
    v_max3_u32 v4, v4, v19, v20
    v_max3_u32 v4, v4, v21, v22
    v_max3_u32 v4, v4, v23, v24
    v_max3_u32 v4, v4, v25, v26
    v_max3_u32 v4, v4, v27, v28
    v_max3_u32 v4, v4, v29, v30
    v_max3_u32 v4, v4, v31, v32
    v_max3_u32 v4, v4, v33, v34
    v_max3_u32 v4, v4, v35, v36
    v_max3_u32 v4, v4, v37, v38
    v_max3_u32 v4, v4, v39, v40
    v_max3_u32 v4, v4, v41, v42
    v_max3_u32 v4, v4, v43, v44
    v_max3_u32 v4, v4, v45, v46
    v_max_u32 v4, v4, v47
    s_nop 1
    v_max_u32_dpp v4, v4, v4 quad_perm:[1,0,3,2] row_mask:0xf bank_mask:0xf
    s_nop 1
    v_max_u32_dpp v4, v4, v4 quad_perm:[2,3,0,1] row_mask:0xf bank_mask:0xf
    s_nop 1
    v_max_u32_dpp v4, v4, v4 row_half_mirror row_mask:0xf bank_mask:0xf
    s_nop 1
    v_max_u32_dpp v4, v4, v4 row_mirror row_mask:0xf bank_mask:0xf
    v_mov_b32 v5, v4
    s_nop 1
    v_permlane16_swap_b32 v4, v5
    v_max_u32 v4, v4, v5
    v_mov_b32 v5, v4
    s_nop 1
    v_permlane32_swap_b32 v4, v5
    v_max_u32 v4, v4, v5
    v_mov_b32 v59, v4
    v_cmp_eq_u32 vcc, v4, v16
    s_nop 1
    v_cndmask_b32 v16, v16, 0, vcc
    v_cmp_eq_u32 vcc, v4, v17
    s_nop 1
    v_cndmask_b32 v17, v17, 0, vcc
    v_cmp_eq_u32 vcc, v4, v18
    s_nop 1
    v_cndmask_b32 v18, v18, 0, vcc
    v_cmp_eq_u32 vcc, v4, v19
    s_nop 1
    v_cndmask_b32 v19, v19, 0, vcc
    v_cmp_eq_u32 vcc, v4, v20
    s_nop 1
    v_cndmask_b32 v20, v20, 0, vcc
    v_cmp_eq_u32 vcc, v4, v21
    s_nop 1
    v_cndmask_b32 v21, v21, 0, vcc
    v_cmp_eq_u32 vcc, v4, v22
    s_nop 1
    v_cndmask_b32 v22, v22, 0, vcc
    v_cmp_eq_u32 vcc, v4, v23
    s_nop 1
    v_cndmask_b32 v23, v23, 0, vcc
    v_cmp_eq_u32 vcc, v4, v24
    s_nop 1
    v_cndmask_b32 v24, v24, 0, vcc
    v_cmp_eq_u32 vcc, v4, v25
    s_nop 1
    v_cndmask_b32 v25, v25, 0, vcc
    v_cmp_eq_u32 vcc, v4, v26
    s_nop 1
    v_cndmask_b32 v26, v26, 0, vcc
    v_cmp_eq_u32 vcc, v4, v27
    s_nop 1
    v_cndmask_b32 v27, v27, 0, vcc
    v_cmp_eq_u32 vcc, v4, v28
    s_nop 1
    v_cndmask_b32 v28, v28, 0, vcc
    v_cmp_eq_u32 vcc, v4, v29
    s_nop 1
    v_cndmask_b32 v29, v29, 0, vcc
    v_cmp_eq_u32 vcc, v4, v30
    s_nop 1
    v_cndmask_b32 v30, v30, 0, vcc
    v_cmp_eq_u32 vcc, v4, v31
    s_nop 1
    v_cndmask_b32 v31, v31, 0, vcc
    v_cmp_eq_u32 vcc, v4, v32
    s_nop 1
    v_cndmask_b32 v32, v32, 0, vcc
    v_cmp_eq_u32 vcc, v4, v33
    s_nop 1
    v_cndmask_b32 v33, v33, 0, vcc
    v_cmp_eq_u32 vcc, v4, v34
    s_nop 1
    v_cndmask_b32 v34, v34, 0, vcc
    v_cmp_eq_u32 vcc, v4, v35
    s_nop 1
    v_cndmask_b32 v35, v35, 0, vcc
    v_cmp_eq_u32 vcc, v4, v36
    s_nop 1
    v_cndmask_b32 v36, v36, 0, vcc
    v_cmp_eq_u32 vcc, v4, v37
    s_nop 1
    v_cndmask_b32 v37, v37, 0, vcc
    v_cmp_eq_u32 vcc, v4, v38
    s_nop 1
    v_cndmask_b32 v38, v38, 0, vcc
    v_cmp_eq_u32 vcc, v4, v39
    s_nop 1
    v_cndmask_b32 v39, v39, 0, vcc
    v_cmp_eq_u32 vcc, v4, v40
    s_nop 1
    v_cndmask_b32 v40, v40, 0, vcc
    v_cmp_eq_u32 vcc, v4, v41
    s_nop 1
    v_cndmask_b32 v41, v41, 0, vcc
    v_cmp_eq_u32 vcc, v4, v42
    s_nop 1
    v_cndmask_b32 v42, v42, 0, vcc
    v_cmp_eq_u32 vcc, v4, v43
    s_nop 1
    v_cndmask_b32 v43, v43, 0, vcc
    v_cmp_eq_u32 vcc, v4, v44
    s_nop 1
    v_cndmask_b32 v44, v44, 0, vcc
    v_cmp_eq_u32 vcc, v4, v45
    s_nop 1
    v_cndmask_b32 v45, v45, 0, vcc
    v_cmp_eq_u32 vcc, v4, v46
    s_nop 1
    v_cndmask_b32 v46, v46, 0, vcc
    v_cmp_eq_u32 vcc, v4, v47
    s_nop 1
    v_cndmask_b32 v47, v47, 0, vcc
    v_max3_u32 v4, v16, v17, v18
    v_max3_u32 v4, v4, v19, v20
    v_max3_u32 v4, v4, v21, v22
    v_max3_u32 v4, v4, v23, v24
    v_max3_u32 v4, v4, v25, v26
    v_max3_u32 v4, v4, v27, v28
    v_max3_u32 v4, v4, v29, v30
    v_max3_u32 v4, v4, v31, v32
    v_max3_u32 v4, v4, v33, v34
    v_max3_u32 v4, v4, v35, v36
    v_max3_u32 v4, v4, v37, v38
    v_max3_u32 v4, v4, v39, v40
    v_max3_u32 v4, v4, v41, v42
    v_max3_u32 v4, v4, v43, v44
    v_max3_u32 v4, v4, v45, v46
    v_max_u32 v4, v4, v47
    s_nop 1
    v_max_u32_dpp v4, v4, v4 quad_perm:[1,0,3,2] row_mask:0xf bank_mask:0xf
    s_nop 1
    v_max_u32_dpp v4, v4, v4 quad_perm:[2,3,0,1] row_mask:0xf bank_mask:0xf
    s_nop 1
    v_max_u32_dpp v4, v4, v4 row_half_mirror row_mask:0xf bank_mask:0xf
    s_nop 1
    v_max_u32_dpp v4, v4, v4 row_mirror row_mask:0xf bank_mask:0xf
    v_mov_b32 v5, v4
    s_nop 1
    v_permlane16_swap_b32 v4, v5
    v_max_u32 v4, v4, v5
    v_mov_b32 v5, v4
    s_nop 1
    v_permlane32_swap_b32 v4, v5
    v_max_u32 v4, v4, v5
    v_mov_b32 v60, v4
    v_cmp_eq_u32 vcc, v4, v16
    s_nop 1
    v_cndmask_b32 v16, v16, 0, vcc
    v_cmp_eq_u32 vcc, v4, v17
    s_nop 1
    v_cndmask_b32 v17, v17, 0, vcc
    v_cmp_eq_u32 vcc, v4, v18
    s_nop 1
    v_cndmask_b32 v18, v18, 0, vcc
    v_cmp_eq_u32 vcc, v4, v19
    s_nop 1
    v_cndmask_b32 v19, v19, 0, vcc
    v_cmp_eq_u32 vcc, v4, v20
    s_nop 1
    v_cndmask_b32 v20, v20, 0, vcc
    v_cmp_eq_u32 vcc, v4, v21
    s_nop 1
    v_cndmask_b32 v21, v21, 0, vcc
    v_cmp_eq_u32 vcc, v4, v22
    s_nop 1
    v_cndmask_b32 v22, v22, 0, vcc
    v_cmp_eq_u32 vcc, v4, v23
    s_nop 1
    v_cndmask_b32 v23, v23, 0, vcc
    v_cmp_eq_u32 vcc, v4, v24
    s_nop 1
    v_cndmask_b32 v24, v24, 0, vcc
    v_cmp_eq_u32 vcc, v4, v25
    s_nop 1
    v_cndmask_b32 v25, v25, 0, vcc
    v_cmp_eq_u32 vcc, v4, v26
    s_nop 1
    v_cndmask_b32 v26, v26, 0, vcc
    v_cmp_eq_u32 vcc, v4, v27
    s_nop 1
    v_cndmask_b32 v27, v27, 0, vcc
    v_cmp_eq_u32 vcc, v4, v28
    s_nop 1
    v_cndmask_b32 v28, v28, 0, vcc
    v_cmp_eq_u32 vcc, v4, v29
    s_nop 1
    v_cndmask_b32 v29, v29, 0, vcc
    v_cmp_eq_u32 vcc, v4, v30
    s_nop 1
    v_cndmask_b32 v30, v30, 0, vcc
    v_cmp_eq_u32 vcc, v4, v31
    s_nop 1
    v_cndmask_b32 v31, v31, 0, vcc
    v_cmp_eq_u32 vcc, v4, v32
    s_nop 1
    v_cndmask_b32 v32, v32, 0, vcc
    v_cmp_eq_u32 vcc, v4, v33
    s_nop 1
    v_cndmask_b32 v33, v33, 0, vcc
    v_cmp_eq_u32 vcc, v4, v34
    s_nop 1
    v_cndmask_b32 v34, v34, 0, vcc
    v_cmp_eq_u32 vcc, v4, v35
    s_nop 1
    v_cndmask_b32 v35, v35, 0, vcc
    v_cmp_eq_u32 vcc, v4, v36
    s_nop 1
    v_cndmask_b32 v36, v36, 0, vcc
    v_cmp_eq_u32 vcc, v4, v37
    s_nop 1
    v_cndmask_b32 v37, v37, 0, vcc
    v_cmp_eq_u32 vcc, v4, v38
    s_nop 1
    v_cndmask_b32 v38, v38, 0, vcc
    v_cmp_eq_u32 vcc, v4, v39
    s_nop 1
    v_cndmask_b32 v39, v39, 0, vcc
    v_cmp_eq_u32 vcc, v4, v40
    s_nop 1
    v_cndmask_b32 v40, v40, 0, vcc
    v_cmp_eq_u32 vcc, v4, v41
    s_nop 1
    v_cndmask_b32 v41, v41, 0, vcc
    v_cmp_eq_u32 vcc, v4, v42
    s_nop 1
    v_cndmask_b32 v42, v42, 0, vcc
    v_cmp_eq_u32 vcc, v4, v43
    s_nop 1
    v_cndmask_b32 v43, v43, 0, vcc
    v_cmp_eq_u32 vcc, v4, v44
    s_nop 1
    v_cndmask_b32 v44, v44, 0, vcc
    v_cmp_eq_u32 vcc, v4, v45
    s_nop 1
    v_cndmask_b32 v45, v45, 0, vcc
    v_cmp_eq_u32 vcc, v4, v46
    s_nop 1
    v_cndmask_b32 v46, v46, 0, vcc
    v_cmp_eq_u32 vcc, v4, v47
    s_nop 1
    v_cndmask_b32 v47, v47, 0, vcc
    v_max3_u32 v4, v16, v17, v18
    v_max3_u32 v4, v4, v19, v20
    v_max3_u32 v4, v4, v21, v22
    v_max3_u32 v4, v4, v23, v24
    v_max3_u32 v4, v4, v25, v26
    v_max3_u32 v4, v4, v27, v28
    v_max3_u32 v4, v4, v29, v30
    v_max3_u32 v4, v4, v31, v32
    v_max3_u32 v4, v4, v33, v34
    v_max3_u32 v4, v4, v35, v36
    v_max3_u32 v4, v4, v37, v38
    v_max3_u32 v4, v4, v39, v40
    v_max3_u32 v4, v4, v41, v42
    v_max3_u32 v4, v4, v43, v44
    v_max3_u32 v4, v4, v45, v46
    v_max_u32 v4, v4, v47
    s_nop 1
    v_max_u32_dpp v4, v4, v4 quad_perm:[1,0,3,2] row_mask:0xf bank_mask:0xf
    s_nop 1
    v_max_u32_dpp v4, v4, v4 quad_perm:[2,3,0,1] row_mask:0xf bank_mask:0xf
    s_nop 1
    v_max_u32_dpp v4, v4, v4 row_half_mirror row_mask:0xf bank_mask:0xf
    s_nop 1
    v_max_u32_dpp v4, v4, v4 row_mirror row_mask:0xf bank_mask:0xf
    v_mov_b32 v5, v4
    s_nop 1
    v_permlane16_swap_b32 v4, v5
    v_max_u32 v4, v4, v5
    v_mov_b32 v5, v4
    s_nop 1
    v_permlane32_swap_b32 v4, v5
    v_max_u32 v4, v4, v5
    v_mov_b32 v61, v4
    v_cmp_eq_u32 vcc, v4, v16
    s_nop 1
    v_cndmask_b32 v16, v16, 0, vcc
    v_cmp_eq_u32 vcc, v4, v17
    s_nop 1
    v_cndmask_b32 v17, v17, 0, vcc
    v_cmp_eq_u32 vcc, v4, v18
    s_nop 1
    v_cndmask_b32 v18, v18, 0, vcc
    v_cmp_eq_u32 vcc, v4, v19
    s_nop 1
    v_cndmask_b32 v19, v19, 0, vcc
    v_cmp_eq_u32 vcc, v4, v20
    s_nop 1
    v_cndmask_b32 v20, v20, 0, vcc
    v_cmp_eq_u32 vcc, v4, v21
    s_nop 1
    v_cndmask_b32 v21, v21, 0, vcc
    v_cmp_eq_u32 vcc, v4, v22
    s_nop 1
    v_cndmask_b32 v22, v22, 0, vcc
    v_cmp_eq_u32 vcc, v4, v23
    s_nop 1
    v_cndmask_b32 v23, v23, 0, vcc
    v_cmp_eq_u32 vcc, v4, v24
    s_nop 1
    v_cndmask_b32 v24, v24, 0, vcc
    v_cmp_eq_u32 vcc, v4, v25
    s_nop 1
    v_cndmask_b32 v25, v25, 0, vcc
    v_cmp_eq_u32 vcc, v4, v26
    s_nop 1
    v_cndmask_b32 v26, v26, 0, vcc
    v_cmp_eq_u32 vcc, v4, v27
    s_nop 1
    v_cndmask_b32 v27, v27, 0, vcc
    v_cmp_eq_u32 vcc, v4, v28
    s_nop 1
    v_cndmask_b32 v28, v28, 0, vcc
    v_cmp_eq_u32 vcc, v4, v29
    s_nop 1
    v_cndmask_b32 v29, v29, 0, vcc
    v_cmp_eq_u32 vcc, v4, v30
    s_nop 1
    v_cndmask_b32 v30, v30, 0, vcc
    v_cmp_eq_u32 vcc, v4, v31
    s_nop 1
    v_cndmask_b32 v31, v31, 0, vcc
    v_cmp_eq_u32 vcc, v4, v32
    s_nop 1
    v_cndmask_b32 v32, v32, 0, vcc
    v_cmp_eq_u32 vcc, v4, v33
    s_nop 1
    v_cndmask_b32 v33, v33, 0, vcc
    v_cmp_eq_u32 vcc, v4, v34
    s_nop 1
    v_cndmask_b32 v34, v34, 0, vcc
    v_cmp_eq_u32 vcc, v4, v35
    s_nop 1
    v_cndmask_b32 v35, v35, 0, vcc
    v_cmp_eq_u32 vcc, v4, v36
    s_nop 1
    v_cndmask_b32 v36, v36, 0, vcc
    v_cmp_eq_u32 vcc, v4, v37
    s_nop 1
    v_cndmask_b32 v37, v37, 0, vcc
    v_cmp_eq_u32 vcc, v4, v38
    s_nop 1
    v_cndmask_b32 v38, v38, 0, vcc
    v_cmp_eq_u32 vcc, v4, v39
    s_nop 1
    v_cndmask_b32 v39, v39, 0, vcc
    v_cmp_eq_u32 vcc, v4, v40
    s_nop 1
    v_cndmask_b32 v40, v40, 0, vcc
    v_cmp_eq_u32 vcc, v4, v41
    s_nop 1
    v_cndmask_b32 v41, v41, 0, vcc
    v_cmp_eq_u32 vcc, v4, v42
    s_nop 1
    v_cndmask_b32 v42, v42, 0, vcc
    v_cmp_eq_u32 vcc, v4, v43
    s_nop 1
    v_cndmask_b32 v43, v43, 0, vcc
    v_cmp_eq_u32 vcc, v4, v44
    s_nop 1
    v_cndmask_b32 v44, v44, 0, vcc
    v_cmp_eq_u32 vcc, v4, v45
    s_nop 1
    v_cndmask_b32 v45, v45, 0, vcc
    v_cmp_eq_u32 vcc, v4, v46
    s_nop 1
    v_cndmask_b32 v46, v46, 0, vcc
    v_cmp_eq_u32 vcc, v4, v47
    s_nop 1
    v_cndmask_b32 v47, v47, 0, vcc
    v_max3_u32 v4, v16, v17, v18
    v_max3_u32 v4, v4, v19, v20
    v_max3_u32 v4, v4, v21, v22
    v_max3_u32 v4, v4, v23, v24
    v_max3_u32 v4, v4, v25, v26
    v_max3_u32 v4, v4, v27, v28
    v_max3_u32 v4, v4, v29, v30
    v_max3_u32 v4, v4, v31, v32
    v_max3_u32 v4, v4, v33, v34
    v_max3_u32 v4, v4, v35, v36
    v_max3_u32 v4, v4, v37, v38
    v_max3_u32 v4, v4, v39, v40
    v_max3_u32 v4, v4, v41, v42
    v_max3_u32 v4, v4, v43, v44
    v_max3_u32 v4, v4, v45, v46
    v_max_u32 v4, v4, v47
    s_nop 1
    v_max_u32_dpp v4, v4, v4 quad_perm:[1,0,3,2] row_mask:0xf bank_mask:0xf
    s_nop 1
    v_max_u32_dpp v4, v4, v4 quad_perm:[2,3,0,1] row_mask:0xf bank_mask:0xf
    s_nop 1
    v_max_u32_dpp v4, v4, v4 row_half_mirror row_mask:0xf bank_mask:0xf
    s_nop 1
    v_max_u32_dpp v4, v4, v4 row_mirror row_mask:0xf bank_mask:0xf
    v_mov_b32 v5, v4
    s_nop 1
    v_permlane16_swap_b32 v4, v5
    v_max_u32 v4, v4, v5
    v_mov_b32 v5, v4
    s_nop 1
    v_permlane32_swap_b32 v4, v5
    v_max_u32 v4, v4, v5
    v_mov_b32 v62, v4
    v_cmp_eq_u32 vcc, v4, v16
    s_nop 1
    v_cndmask_b32 v16, v16, 0, vcc
    v_cmp_eq_u32 vcc, v4, v17
    s_nop 1
    v_cndmask_b32 v17, v17, 0, vcc
    v_cmp_eq_u32 vcc, v4, v18
    s_nop 1
    v_cndmask_b32 v18, v18, 0, vcc
    v_cmp_eq_u32 vcc, v4, v19
    s_nop 1
    v_cndmask_b32 v19, v19, 0, vcc
    v_cmp_eq_u32 vcc, v4, v20
    s_nop 1
    v_cndmask_b32 v20, v20, 0, vcc
    v_cmp_eq_u32 vcc, v4, v21
    s_nop 1
    v_cndmask_b32 v21, v21, 0, vcc
    v_cmp_eq_u32 vcc, v4, v22
    s_nop 1
    v_cndmask_b32 v22, v22, 0, vcc
    v_cmp_eq_u32 vcc, v4, v23
    s_nop 1
    v_cndmask_b32 v23, v23, 0, vcc
    v_cmp_eq_u32 vcc, v4, v24
    s_nop 1
    v_cndmask_b32 v24, v24, 0, vcc
    v_cmp_eq_u32 vcc, v4, v25
    s_nop 1
    v_cndmask_b32 v25, v25, 0, vcc
    v_cmp_eq_u32 vcc, v4, v26
    s_nop 1
    v_cndmask_b32 v26, v26, 0, vcc
    v_cmp_eq_u32 vcc, v4, v27
    s_nop 1
    v_cndmask_b32 v27, v27, 0, vcc
    v_cmp_eq_u32 vcc, v4, v28
    s_nop 1
    v_cndmask_b32 v28, v28, 0, vcc
    v_cmp_eq_u32 vcc, v4, v29
    s_nop 1
    v_cndmask_b32 v29, v29, 0, vcc
    v_cmp_eq_u32 vcc, v4, v30
    s_nop 1
    v_cndmask_b32 v30, v30, 0, vcc
    v_cmp_eq_u32 vcc, v4, v31
    s_nop 1
    v_cndmask_b32 v31, v31, 0, vcc
    v_cmp_eq_u32 vcc, v4, v32
    s_nop 1
    v_cndmask_b32 v32, v32, 0, vcc
    v_cmp_eq_u32 vcc, v4, v33
    s_nop 1
    v_cndmask_b32 v33, v33, 0, vcc
    v_cmp_eq_u32 vcc, v4, v34
    s_nop 1
    v_cndmask_b32 v34, v34, 0, vcc
    v_cmp_eq_u32 vcc, v4, v35
    s_nop 1
    v_cndmask_b32 v35, v35, 0, vcc
    v_cmp_eq_u32 vcc, v4, v36
    s_nop 1
    v_cndmask_b32 v36, v36, 0, vcc
    v_cmp_eq_u32 vcc, v4, v37
    s_nop 1
    v_cndmask_b32 v37, v37, 0, vcc
    v_cmp_eq_u32 vcc, v4, v38
    s_nop 1
    v_cndmask_b32 v38, v38, 0, vcc
    v_cmp_eq_u32 vcc, v4, v39
    s_nop 1
    v_cndmask_b32 v39, v39, 0, vcc
    v_cmp_eq_u32 vcc, v4, v40
    s_nop 1
    v_cndmask_b32 v40, v40, 0, vcc
    v_cmp_eq_u32 vcc, v4, v41
    s_nop 1
    v_cndmask_b32 v41, v41, 0, vcc
    v_cmp_eq_u32 vcc, v4, v42
    s_nop 1
    v_cndmask_b32 v42, v42, 0, vcc
    v_cmp_eq_u32 vcc, v4, v43
    s_nop 1
    v_cndmask_b32 v43, v43, 0, vcc
    v_cmp_eq_u32 vcc, v4, v44
    s_nop 1
    v_cndmask_b32 v44, v44, 0, vcc
    v_cmp_eq_u32 vcc, v4, v45
    s_nop 1
    v_cndmask_b32 v45, v45, 0, vcc
    v_cmp_eq_u32 vcc, v4, v46
    s_nop 1
    v_cndmask_b32 v46, v46, 0, vcc
    v_cmp_eq_u32 vcc, v4, v47
    s_nop 1
    v_cndmask_b32 v47, v47, 0, vcc
    v_max3_u32 v4, v16, v17, v18
    v_max3_u32 v4, v4, v19, v20
    v_max3_u32 v4, v4, v21, v22
    v_max3_u32 v4, v4, v23, v24
    v_max3_u32 v4, v4, v25, v26
    v_max3_u32 v4, v4, v27, v28
    v_max3_u32 v4, v4, v29, v30
    v_max3_u32 v4, v4, v31, v32
    v_max3_u32 v4, v4, v33, v34
    v_max3_u32 v4, v4, v35, v36
    v_max3_u32 v4, v4, v37, v38
    v_max3_u32 v4, v4, v39, v40
    v_max3_u32 v4, v4, v41, v42
    v_max3_u32 v4, v4, v43, v44
    v_max3_u32 v4, v4, v45, v46
    v_max_u32 v4, v4, v47
    s_nop 1
    v_max_u32_dpp v4, v4, v4 quad_perm:[1,0,3,2] row_mask:0xf bank_mask:0xf
    s_nop 1
    v_max_u32_dpp v4, v4, v4 quad_perm:[2,3,0,1] row_mask:0xf bank_mask:0xf
    s_nop 1
    v_max_u32_dpp v4, v4, v4 row_half_mirror row_mask:0xf bank_mask:0xf
    s_nop 1
    v_max_u32_dpp v4, v4, v4 row_mirror row_mask:0xf bank_mask:0xf
    v_mov_b32 v5, v4
    s_nop 1
    v_permlane16_swap_b32 v4, v5
    v_max_u32 v4, v4, v5
    v_mov_b32 v5, v4
    s_nop 1
    v_permlane32_swap_b32 v4, v5
    v_max_u32 v4, v4, v5
    v_mov_b32 v63, v4
    v_mov_b32 v4, v56
    v_cmp_eq_u32 vcc, 1, v0
    s_nop 1
    v_cndmask_b32 v4, v4, v57, vcc
    v_cmp_eq_u32 vcc, 2, v0
    s_nop 1
    v_cndmask_b32 v4, v4, v58, vcc
    v_cmp_eq_u32 vcc, 3, v0
    s_nop 1
    v_cndmask_b32 v4, v4, v59, vcc
    v_cmp_eq_u32 vcc, 4, v0
    s_nop 1
    v_cndmask_b32 v4, v4, v60, vcc
    v_cmp_eq_u32 vcc, 5, v0
    s_nop 1
    v_cndmask_b32 v4, v4, v61, vcc
    v_cmp_eq_u32 vcc, 6, v0
    s_nop 1
    v_cndmask_b32 v4, v4, v62, vcc
    v_cmp_eq_u32 vcc, 7, v0
    s_nop 1
    v_cndmask_b32 v4, v4, v63, vcc
    v_and_b32 v5, 0xffff, v4
    v_sub_u32 v5, 0xffff, v5
    v_and_b32 v4, 0xffff0000, v4
    v_ashrrev_i32 v3, 31, v4
    v_not_b32 v3, v3
    v_or_b32 v3, 0x80000000, v3
    v_xor_b32 v4, v4, v3
    v_and_b32 v4, 0xffff0000, v4
    v_mul_f32 v4, 0xbfb8aa3b, v4
    v_exp_f32 v4, v4
    s_nop 0
    v_add_f32 v4, 1.0, v4
    v_rcp_f32 v4, v4
    s_nop 0
    v_cvt_pk_bf16_f32 v4, v4, v4
    v_lshlrev_b32 v4, 16, v4
    v_lshlrev_b32 v6, 2, v0
    s_mov_b32 s64, 0x5400000
    s_mov_b64 exec, 0xff
    buffer_store_dword v5, v6, s[4:7], s64 offen sc1
    buffer_store_dword v4, v6, s[4:7], s64 offen offset:32 sc1
    s_mov_b64 exec, -1
    s_waitcnt vmcnt(0)
    v_mov_b32 v7, 1
    v_mov_b32 v8, 0
    s_mov_b32 s64, 0x298000
    s_mov_b64 exec, 1
    buffer_atomic_add v7, v8, s[4:7], s64 offen sc1
    s_mov_b64 exec, -1
    v_mbcnt_lo_u32_b32 v0, -1, 0
    v_mbcnt_hi_u32_b32 v0, -1, v0
NOSEL_102:
    v_lshlrev_b32 v1, 4, v0
    v_lshrrev_b32 v6, 3, v0
    v_mul_u32_u24 v2, 1280, v6
    v_and_b32 v7, 7, v0
    v_xor_b32 v7, v7, v6
    v_lshl_add_u32 v2, v7, 4, v2
    v_bfe_u32 v6, v0, 3, 1
    v_lshlrev_b32 v9, 10, v6
    v_and_b32 v6, 7, v0
    v_lshl_add_u32 v9, v6, 7, v9
    v_lshrrev_b32 v7, 4, v0
    v_xor_b32 v7, v7, v6
    v_lshl_add_u32 v3, v7, 4, v9
    v_xor_b32 v7, 4, v7
    v_lshl_add_u32 v4, v7, 4, v9
    v_add_u32 v6, 0x10000, v3
    v_add_u32 v9, 0x10000, v4
    s_barrier
    s_mul_i32 s20, s12, 163840
    s_mul_i32 s64, s14, 40960
    s_add_u32 s20, s20, s64
    s_add_u32 s20, s20, 0x0
    s_lshl_b32 s21, s14, 12
    s_add_u32 m0, s21, 0
    s_add_u32 s64, s20, 0x0
    buffer_load_dwordx4 v2, s[4:7], s64 offen lds
    s_add_u32 m0, s21, 1024
    s_add_u32 s64, s20, 0x2800
    buffer_load_dwordx4 v2, s[4:7], s64 offen lds
    s_add_u32 m0, s21, 2048
    s_add_u32 s64, s20, 0x5000
    buffer_load_dwordx4 v2, s[4:7], s64 offen lds
    s_add_u32 m0, s21, 3072
    s_add_u32 s64, s20, 0x7800
    buffer_load_dwordx4 v2, s[4:7], s64 offen lds
    s_add_u32 m0, s21, 16384
    s_add_u32 s64, s20, 0x80
    buffer_load_dwordx4 v2, s[4:7], s64 offen lds
    s_add_u32 m0, s21, 17408
    s_add_u32 s64, s20, 0x2880
    buffer_load_dwordx4 v2, s[4:7], s64 offen lds
    s_add_u32 m0, s21, 18432
    s_add_u32 s64, s20, 0x5080
    buffer_load_dwordx4 v2, s[4:7], s64 offen lds
    s_add_u32 m0, s21, 19456
    s_add_u32 s64, s20, 0x7880
    buffer_load_dwordx4 v2, s[4:7], s64 offen lds
    s_add_u32 m0, s21, 32768
    s_add_u32 s64, s20, 0x100
    buffer_load_dwordx4 v2, s[4:7], s64 offen lds
    s_add_u32 m0, s21, 33792
    s_add_u32 s64, s20, 0x2900
    buffer_load_dwordx4 v2, s[4:7], s64 offen lds
    s_add_u32 m0, s21, 34816
    s_add_u32 s64, s20, 0x5100
    buffer_load_dwordx4 v2, s[4:7], s64 offen lds
    s_add_u32 m0, s21, 35840
    s_add_u32 s64, s20, 0x7900
    buffer_load_dwordx4 v2, s[4:7], s64 offen lds
    s_add_u32 m0, s21, 49152
    s_add_u32 s64, s20, 0x180
    buffer_load_dwordx4 v2, s[4:7], s64 offen lds
    s_add_u32 m0, s21, 50176
    s_add_u32 s64, s20, 0x2980
    buffer_load_dwordx4 v2, s[4:7], s64 offen lds
    s_add_u32 m0, s21, 51200
    s_add_u32 s64, s20, 0x5180
    buffer_load_dwordx4 v2, s[4:7], s64 offen lds
    s_add_u32 m0, s21, 52224
    s_add_u32 s64, s20, 0x7980
    buffer_load_dwordx4 v2, s[4:7], s64 offen lds
    s_mov_b32 s64, 0x40000000
    buffer_store_dword v7, v1, s[4:7], s64 offen
    buffer_store_dword v7, v1, s[4:7], s64 offen
    buffer_store_dword v7, v1, s[4:7], s64 offen
    buffer_store_dword v7, v1, s[4:7], s64 offen
    buffer_store_dword v7, v1, s[4:7], s64 offen
    buffer_store_dword v7, v1, s[4:7], s64 offen
    buffer_store_dword v7, v1, s[4:7], s64 offen
    buffer_store_dword v7, v1, s[4:7], s64 offen
    s_waitcnt vmcnt(20)
    s_barrier
    ds_read_b128 a[0:3], v3 offset:0
    ds_read_b128 a[4:7], v3 offset:2048
    ds_read_b128 a[8:11], v3 offset:4096
    ds_read_b128 a[12:15], v3 offset:6144
    ds_read_b128 a[16:19], v3 offset:8192
    ds_read_b128 a[20:23], v3 offset:10240
    ds_read_b128 a[24:27], v3 offset:12288
    ds_read_b128 a[28:31], v3 offset:14336
    s_mov_b32 s19, 0
    s_mov_b32 s22, s16
    s_mov_b32 s23, 0x40000000
G_T_LOOP:
    s_waitcnt lgkmcnt(4)
    v_mfma_f32_16x16x32_bf16 v[16:19], v[96:99], a[0:3], 0
    v_mfma_f32_16x16x32_bf16 v[20:23], v[100:103], a[0:3], 0
    ds_read_b128 a[32:35], v4 offset:0
    v_mfma_f32_16x16x32_bf16 v[24:27], v[96:99], a[4:7], 0
    v_mfma_f32_16x16x32_bf16 v[28:31], v[100:103], a[4:7], 0
    ds_read_b128 a[36:39], v4 offset:2048
    v_mfma_f32_16x16x32_bf16 v[32:35], v[96:99], a[8:11], 0
    v_mfma_f32_16x16x32_bf16 v[36:39], v[100:103], a[8:11], 0
    ds_read_b128 a[40:43], v4 offset:4096
    v_mfma_f32_16x16x32_bf16 v[40:43], v[96:99], a[12:15], 0
    v_mfma_f32_16x16x32_bf16 v[44:47], v[100:103], a[12:15], 0
    ds_read_b128 a[44:47], v4 offset:6144
    s_waitcnt lgkmcnt(4)
    v_mfma_f32_16x16x32_bf16 v[48:51], v[96:99], a[16:19], 0
    v_mfma_f32_16x16x32_bf16 v[52:55], v[100:103], a[16:19], 0
    ds_read_b128 a[48:51], v4 offset:8192
    v_mfma_f32_16x16x32_bf16 v[56:59], v[96:99], a[20:23], 0
    v_mfma_f32_16x16x32_bf16 v[60:63], v[100:103], a[20:23], 0
    ds_read_b128 a[52:55], v4 offset:10240
    v_mfma_f32_16x16x32_bf16 v[64:67], v[96:99], a[24:27], 0
    v_mfma_f32_16x16x32_bf16 v[68:71], v[100:103], a[24:27], 0
    ds_read_b128 a[56:59], v4 offset:12288
    v_mfma_f32_16x16x32_bf16 v[72:75], v[96:99], a[28:31], 0
    v_mfma_f32_16x16x32_bf16 v[76:79], v[100:103], a[28:31], 0
    ds_read_b128 a[60:63], v4 offset:14336
    s_waitcnt vmcnt(16)
    s_barrier
    s_waitcnt lgkmcnt(4)
    v_mfma_f32_16x16x32_bf16 v[16:19], v[104:107], a[32:35], v[16:19]
    v_mfma_f32_16x16x32_bf16 v[20:23], v[108:111], a[32:35], v[20:23]
    ds_read_b128 a[0:3], v3 offset:16384
    s_add_u32 m0, s21, 65536
    v_mfma_f32_16x16x32_bf16 v[24:27], v[104:107], a[36:39], v[24:27]
    v_mfma_f32_16x16x32_bf16 v[28:31], v[108:111], a[36:39], v[28:31]
    ds_read_b128 a[4:7], v3 offset:18432
    s_add_u32 s64, s20, 0x200
    buffer_load_dwordx4 v2, s[4:7], s64 offen lds
    v_mfma_f32_16x16x32_bf16 v[32:35], v[104:107], a[40:43], v[32:35]
    v_mfma_f32_16x16x32_bf16 v[36:39], v[108:111], a[40:43], v[36:39]
    ds_read_b128 a[8:11], v3 offset:20480
    s_add_u32 m0, s21, 66560
    v_mfma_f32_16x16x32_bf16 v[40:43], v[104:107], a[44:47], v[40:43]
    v_mfma_f32_16x16x32_bf16 v[44:47], v[108:111], a[44:47], v[44:47]
    ds_read_b128 a[12:15], v3 offset:22528
    s_add_u32 s64, s20, 0x2a00
    buffer_load_dwordx4 v2, s[4:7], s64 offen lds
    s_waitcnt lgkmcnt(4)
    v_mfma_f32_16x16x32_bf16 v[48:51], v[104:107], a[48:51], v[48:51]
    v_mfma_f32_16x16x32_bf16 v[52:55], v[108:111], a[48:51], v[52:55]
    ds_read_b128 a[16:19], v3 offset:24576
    s_add_u32 m0, s21, 67584
    v_mfma_f32_16x16x32_bf16 v[56:59], v[104:107], a[52:55], v[56:59]
    v_mfma_f32_16x16x32_bf16 v[60:63], v[108:111], a[52:55], v[60:63]
    ds_read_b128 a[20:23], v3 offset:26624
    s_add_u32 s64, s20, 0x5200
    buffer_load_dwordx4 v2, s[4:7], s64 offen lds
    v_mfma_f32_16x16x32_bf16 v[64:67], v[104:107], a[56:59], v[64:67]
    v_mfma_f32_16x16x32_bf16 v[68:71], v[108:111], a[56:59], v[68:71]
    ds_read_b128 a[24:27], v3 offset:28672
    s_add_u32 m0, s21, 68608
    v_mfma_f32_16x16x32_bf16 v[72:75], v[104:107], a[60:63], v[72:75]
    v_mfma_f32_16x16x32_bf16 v[76:79], v[108:111], a[60:63], v[76:79]
    ds_read_b128 a[28:31], v3 offset:30720
    s_add_u32 s64, s20, 0x7a00
    buffer_load_dwordx4 v2, s[4:7], s64 offen lds
    s_waitcnt lgkmcnt(4)
    v_mfma_f32_16x16x32_bf16 v[16:19], v[112:115], a[0:3], v[16:19]
    v_mfma_f32_16x16x32_bf16 v[20:23], v[116:119], a[0:3], v[20:23]
    ds_read_b128 a[32:35], v4 offset:16384
    v_mfma_f32_16x16x32_bf16 v[24:27], v[112:115], a[4:7], v[24:27]
    v_mfma_f32_16x16x32_bf16 v[28:31], v[116:119], a[4:7], v[28:31]
    ds_read_b128 a[36:39], v4 offset:18432
    v_mfma_f32_16x16x32_bf16 v[32:35], v[112:115], a[8:11], v[32:35]
    v_mfma_f32_16x16x32_bf16 v[36:39], v[116:119], a[8:11], v[36:39]
    ds_read_b128 a[40:43], v4 offset:20480
    v_mfma_f32_16x16x32_bf16 v[40:43], v[112:115], a[12:15], v[40:43]
    v_mfma_f32_16x16x32_bf16 v[44:47], v[116:119], a[12:15], v[44:47]
    ds_read_b128 a[44:47], v4 offset:22528
    s_waitcnt lgkmcnt(4)
    v_mfma_f32_16x16x32_bf16 v[48:51], v[112:115], a[16:19], v[48:51]
    v_mfma_f32_16x16x32_bf16 v[52:55], v[116:119], a[16:19], v[52:55]
    ds_read_b128 a[48:51], v4 offset:24576
    v_mfma_f32_16x16x32_bf16 v[56:59], v[112:115], a[20:23], v[56:59]
    v_mfma_f32_16x16x32_bf16 v[60:63], v[116:119], a[20:23], v[60:63]
    ds_read_b128 a[52:55], v4 offset:26624
    v_mfma_f32_16x16x32_bf16 v[64:67], v[112:115], a[24:27], v[64:67]
    v_mfma_f32_16x16x32_bf16 v[68:71], v[116:119], a[24:27], v[68:71]
    ds_read_b128 a[56:59], v4 offset:28672
    v_mfma_f32_16x16x32_bf16 v[72:75], v[112:115], a[28:31], v[72:75]
    v_mfma_f32_16x16x32_bf16 v[76:79], v[116:119], a[28:31], v[76:79]
    ds_read_b128 a[60:63], v4 offset:30720
    s_waitcnt vmcnt(16)
    s_barrier
    s_waitcnt lgkmcnt(4)
    v_mfma_f32_16x16x32_bf16 v[16:19], v[120:123], a[32:35], v[16:19]
    v_mfma_f32_16x16x32_bf16 v[20:23], v[124:127], a[32:35], v[20:23]
    ds_read_b128 a[0:3], v3 offset:32768
    s_add_u32 m0, s21, 0
    v_mfma_f32_16x16x32_bf16 v[24:27], v[120:123], a[36:39], v[24:27]
    v_mfma_f32_16x16x32_bf16 v[28:31], v[124:127], a[36:39], v[28:31]
    ds_read_b128 a[4:7], v3 offset:34816
    s_add_u32 s64, s20, 0x280
    buffer_load_dwordx4 v2, s[4:7], s64 offen lds
    v_mfma_f32_16x16x32_bf16 v[32:35], v[120:123], a[40:43], v[32:35]
    v_mfma_f32_16x16x32_bf16 v[36:39], v[124:127], a[40:43], v[36:39]
    ds_read_b128 a[8:11], v3 offset:36864
    s_add_u32 m0, s21, 1024
    v_mfma_f32_16x16x32_bf16 v[40:43], v[120:123], a[44:47], v[40:43]
    v_mfma_f32_16x16x32_bf16 v[44:47], v[124:127], a[44:47], v[44:47]
    ds_read_b128 a[12:15], v3 offset:38912
    s_add_u32 s64, s20, 0x2a80
    buffer_load_dwordx4 v2, s[4:7], s64 offen lds
    s_waitcnt lgkmcnt(4)
    v_mfma_f32_16x16x32_bf16 v[48:51], v[120:123], a[48:51], v[48:51]
    v_mfma_f32_16x16x32_bf16 v[52:55], v[124:127], a[48:51], v[52:55]
    ds_read_b128 a[16:19], v3 offset:40960
    s_add_u32 m0, s21, 2048
    v_mfma_f32_16x16x32_bf16 v[56:59], v[120:123], a[52:55], v[56:59]
    v_mfma_f32_16x16x32_bf16 v[60:63], v[124:127], a[52:55], v[60:63]
    ds_read_b128 a[20:23], v3 offset:43008
    s_add_u32 s64, s20, 0x5280
    buffer_load_dwordx4 v2, s[4:7], s64 offen lds
    v_mfma_f32_16x16x32_bf16 v[64:67], v[120:123], a[56:59], v[64:67]
    v_mfma_f32_16x16x32_bf16 v[68:71], v[124:127], a[56:59], v[68:71]
    ds_read_b128 a[24:27], v3 offset:45056
    s_add_u32 m0, s21, 3072
    v_mfma_f32_16x16x32_bf16 v[72:75], v[120:123], a[60:63], v[72:75]
    v_mfma_f32_16x16x32_bf16 v[76:79], v[124:127], a[60:63], v[76:79]
    ds_read_b128 a[28:31], v3 offset:47104
    s_add_u32 s64, s20, 0x7a80
    buffer_load_dwordx4 v2, s[4:7], s64 offen lds
    s_waitcnt lgkmcnt(4)
    v_mfma_f32_16x16x32_bf16 v[16:19], v[128:131], a[0:3], v[16:19]
    v_mfma_f32_16x16x32_bf16 v[20:23], v[132:135], a[0:3], v[20:23]
    ds_read_b128 a[32:35], v4 offset:32768
    v_mfma_f32_16x16x32_bf16 v[24:27], v[128:131], a[4:7], v[24:27]
    v_mfma_f32_16x16x32_bf16 v[28:31], v[132:135], a[4:7], v[28:31]
    ds_read_b128 a[36:39], v4 offset:34816
    v_mfma_f32_16x16x32_bf16 v[32:35], v[128:131], a[8:11], v[32:35]
    v_mfma_f32_16x16x32_bf16 v[36:39], v[132:135], a[8:11], v[36:39]
    ds_read_b128 a[40:43], v4 offset:36864
    v_mfma_f32_16x16x32_bf16 v[40:43], v[128:131], a[12:15], v[40:43]
    v_mfma_f32_16x16x32_bf16 v[44:47], v[132:135], a[12:15], v[44:47]
    ds_read_b128 a[44:47], v4 offset:38912
    s_waitcnt lgkmcnt(4)
    v_mfma_f32_16x16x32_bf16 v[48:51], v[128:131], a[16:19], v[48:51]
    v_mfma_f32_16x16x32_bf16 v[52:55], v[132:135], a[16:19], v[52:55]
    ds_read_b128 a[48:51], v4 offset:40960
    v_mfma_f32_16x16x32_bf16 v[56:59], v[128:131], a[20:23], v[56:59]
    v_mfma_f32_16x16x32_bf16 v[60:63], v[132:135], a[20:23], v[60:63]
    ds_read_b128 a[52:55], v4 offset:43008
    v_mfma_f32_16x16x32_bf16 v[64:67], v[128:131], a[24:27], v[64:67]
    v_mfma_f32_16x16x32_bf16 v[68:71], v[132:135], a[24:27], v[68:71]
    ds_read_b128 a[56:59], v4 offset:45056
    v_mfma_f32_16x16x32_bf16 v[72:75], v[128:131], a[28:31], v[72:75]
    v_mfma_f32_16x16x32_bf16 v[76:79], v[132:135], a[28:31], v[76:79]
    ds_read_b128 a[60:63], v4 offset:47104
    s_waitcnt vmcnt(16)
    s_barrier
    s_waitcnt lgkmcnt(4)
    v_mfma_f32_16x16x32_bf16 v[16:19], v[136:139], a[32:35], v[16:19]
    v_mfma_f32_16x16x32_bf16 v[20:23], v[140:143], a[32:35], v[20:23]
    ds_read_b128 a[0:3], v3 offset:49152
    s_add_u32 m0, s21, 16384
    v_mfma_f32_16x16x32_bf16 v[24:27], v[136:139], a[36:39], v[24:27]
    v_mfma_f32_16x16x32_bf16 v[28:31], v[140:143], a[36:39], v[28:31]
    ds_read_b128 a[4:7], v3 offset:51200
    s_add_u32 s64, s20, 0x300
    buffer_load_dwordx4 v2, s[4:7], s64 offen lds
    v_mfma_f32_16x16x32_bf16 v[32:35], v[136:139], a[40:43], v[32:35]
    v_mfma_f32_16x16x32_bf16 v[36:39], v[140:143], a[40:43], v[36:39]
    ds_read_b128 a[8:11], v3 offset:53248
    s_add_u32 m0, s21, 17408
    v_mfma_f32_16x16x32_bf16 v[40:43], v[136:139], a[44:47], v[40:43]
    v_mfma_f32_16x16x32_bf16 v[44:47], v[140:143], a[44:47], v[44:47]
    ds_read_b128 a[12:15], v3 offset:55296
    s_add_u32 s64, s20, 0x2b00
    buffer_load_dwordx4 v2, s[4:7], s64 offen lds
    s_waitcnt lgkmcnt(4)
    v_mfma_f32_16x16x32_bf16 v[48:51], v[136:139], a[48:51], v[48:51]
    v_mfma_f32_16x16x32_bf16 v[52:55], v[140:143], a[48:51], v[52:55]
    ds_read_b128 a[16:19], v3 offset:57344
    s_add_u32 m0, s21, 18432
    v_mfma_f32_16x16x32_bf16 v[56:59], v[136:139], a[52:55], v[56:59]
    v_mfma_f32_16x16x32_bf16 v[60:63], v[140:143], a[52:55], v[60:63]
    ds_read_b128 a[20:23], v3 offset:59392
    s_add_u32 s64, s20, 0x5300
    buffer_load_dwordx4 v2, s[4:7], s64 offen lds
    v_mfma_f32_16x16x32_bf16 v[64:67], v[136:139], a[56:59], v[64:67]
    v_mfma_f32_16x16x32_bf16 v[68:71], v[140:143], a[56:59], v[68:71]
    ds_read_b128 a[24:27], v3 offset:61440
    s_add_u32 m0, s21, 19456
    v_mfma_f32_16x16x32_bf16 v[72:75], v[136:139], a[60:63], v[72:75]
    v_mfma_f32_16x16x32_bf16 v[76:79], v[140:143], a[60:63], v[76:79]
    ds_read_b128 a[28:31], v3 offset:63488
    s_add_u32 s64, s20, 0x7b00
    buffer_load_dwordx4 v2, s[4:7], s64 offen lds
    s_waitcnt lgkmcnt(4)
    v_mfma_f32_16x16x32_bf16 v[16:19], v[144:147], a[0:3], v[16:19]
    v_mfma_f32_16x16x32_bf16 v[20:23], v[148:151], a[0:3], v[20:23]
    ds_read_b128 a[32:35], v4 offset:49152
    v_mfma_f32_16x16x32_bf16 v[24:27], v[144:147], a[4:7], v[24:27]
    v_mfma_f32_16x16x32_bf16 v[28:31], v[148:151], a[4:7], v[28:31]
    ds_read_b128 a[36:39], v4 offset:51200
    v_mfma_f32_16x16x32_bf16 v[32:35], v[144:147], a[8:11], v[32:35]
    v_mfma_f32_16x16x32_bf16 v[36:39], v[148:151], a[8:11], v[36:39]
    ds_read_b128 a[40:43], v4 offset:53248
    v_mfma_f32_16x16x32_bf16 v[40:43], v[144:147], a[12:15], v[40:43]
    v_mfma_f32_16x16x32_bf16 v[44:47], v[148:151], a[12:15], v[44:47]
    ds_read_b128 a[44:47], v4 offset:55296
    s_waitcnt lgkmcnt(4)
    v_mfma_f32_16x16x32_bf16 v[48:51], v[144:147], a[16:19], v[48:51]
    v_mfma_f32_16x16x32_bf16 v[52:55], v[148:151], a[16:19], v[52:55]
    ds_read_b128 a[48:51], v4 offset:57344
    v_mfma_f32_16x16x32_bf16 v[56:59], v[144:147], a[20:23], v[56:59]
    v_mfma_f32_16x16x32_bf16 v[60:63], v[148:151], a[20:23], v[60:63]
    ds_read_b128 a[52:55], v4 offset:59392
    v_mfma_f32_16x16x32_bf16 v[64:67], v[144:147], a[24:27], v[64:67]
    v_mfma_f32_16x16x32_bf16 v[68:71], v[148:151], a[24:27], v[68:71]
    ds_read_b128 a[56:59], v4 offset:61440
    v_mfma_f32_16x16x32_bf16 v[72:75], v[144:147], a[28:31], v[72:75]
    v_mfma_f32_16x16x32_bf16 v[76:79], v[148:151], a[28:31], v[76:79]
    ds_read_b128 a[60:63], v4 offset:63488
    s_waitcnt vmcnt(8)
    s_barrier
    s_cmp_lg_u32 s14, 0
    s_cbranch_scc1 GF_103
    v_mov_b32 v7, 1
    v_mov_b32 v8, 0
    s_mov_b64 exec, 1
    buffer_store_dword v7, v8, s[4:7], s23 offen sc1
    s_mov_b64 exec, -1
GF_103:
    s_waitcnt lgkmcnt(4)
    v_mfma_f32_16x16x32_bf16 v[16:19], v[152:155], a[32:35], v[16:19]
    v_mfma_f32_16x16x32_bf16 v[20:23], v[156:159], a[32:35], v[20:23]
    ds_read_b128 a[0:3], v6 offset:0
    s_add_u32 m0, s21, 32768
    v_mfma_f32_16x16x32_bf16 v[24:27], v[152:155], a[36:39], v[24:27]
    v_mfma_f32_16x16x32_bf16 v[28:31], v[156:159], a[36:39], v[28:31]
    ds_read_b128 a[4:7], v6 offset:2048
    s_add_u32 s64, s20, 0x380
    buffer_load_dwordx4 v2, s[4:7], s64 offen lds
    v_mfma_f32_16x16x32_bf16 v[32:35], v[152:155], a[40:43], v[32:35]
    v_mfma_f32_16x16x32_bf16 v[36:39], v[156:159], a[40:43], v[36:39]
    ds_read_b128 a[8:11], v6 offset:4096
    s_add_u32 m0, s21, 33792
    v_mfma_f32_16x16x32_bf16 v[40:43], v[152:155], a[44:47], v[40:43]
    v_mfma_f32_16x16x32_bf16 v[44:47], v[156:159], a[44:47], v[44:47]
    ds_read_b128 a[12:15], v6 offset:6144
    s_add_u32 s64, s20, 0x2b80
    buffer_load_dwordx4 v2, s[4:7], s64 offen lds
    s_waitcnt lgkmcnt(4)
    v_mfma_f32_16x16x32_bf16 v[48:51], v[152:155], a[48:51], v[48:51]
    v_mfma_f32_16x16x32_bf16 v[52:55], v[156:159], a[48:51], v[52:55]
    ds_read_b128 a[16:19], v6 offset:8192
    s_add_u32 m0, s21, 34816
    v_mfma_f32_16x16x32_bf16 v[56:59], v[152:155], a[52:55], v[56:59]
    v_mfma_f32_16x16x32_bf16 v[60:63], v[156:159], a[52:55], v[60:63]
    ds_read_b128 a[20:23], v6 offset:10240
    s_add_u32 s64, s20, 0x5380
    buffer_load_dwordx4 v2, s[4:7], s64 offen lds
    v_mfma_f32_16x16x32_bf16 v[64:67], v[152:155], a[56:59], v[64:67]
    v_mfma_f32_16x16x32_bf16 v[68:71], v[156:159], a[56:59], v[68:71]
    ds_read_b128 a[24:27], v6 offset:12288
    s_add_u32 m0, s21, 35840
    v_mfma_f32_16x16x32_bf16 v[72:75], v[152:155], a[60:63], v[72:75]
    v_mfma_f32_16x16x32_bf16 v[76:79], v[156:159], a[60:63], v[76:79]
    ds_read_b128 a[28:31], v6 offset:14336
    s_add_u32 s64, s20, 0x7b80
    buffer_load_dwordx4 v2, s[4:7], s64 offen lds
    s_waitcnt lgkmcnt(4)
    v_mfma_f32_16x16x32_bf16 v[16:19], v[160:163], a[0:3], v[16:19]
    v_mfma_f32_16x16x32_bf16 v[20:23], v[164:167], a[0:3], v[20:23]
    ds_read_b128 a[32:35], v9 offset:0
    v_mfma_f32_16x16x32_bf16 v[24:27], v[160:163], a[4:7], v[24:27]
    v_mfma_f32_16x16x32_bf16 v[28:31], v[164:167], a[4:7], v[28:31]
    ds_read_b128 a[36:39], v9 offset:2048
    v_mfma_f32_16x16x32_bf16 v[32:35], v[160:163], a[8:11], v[32:35]
    v_mfma_f32_16x16x32_bf16 v[36:39], v[164:167], a[8:11], v[36:39]
    ds_read_b128 a[40:43], v9 offset:4096
    v_mfma_f32_16x16x32_bf16 v[40:43], v[160:163], a[12:15], v[40:43]
    v_mfma_f32_16x16x32_bf16 v[44:47], v[164:167], a[12:15], v[44:47]
    ds_read_b128 a[44:47], v9 offset:6144
    s_waitcnt lgkmcnt(4)
    v_mfma_f32_16x16x32_bf16 v[48:51], v[160:163], a[16:19], v[48:51]
    v_mfma_f32_16x16x32_bf16 v[52:55], v[164:167], a[16:19], v[52:55]
    ds_read_b128 a[48:51], v9 offset:8192
    v_mfma_f32_16x16x32_bf16 v[56:59], v[160:163], a[20:23], v[56:59]
    v_mfma_f32_16x16x32_bf16 v[60:63], v[164:167], a[20:23], v[60:63]
    ds_read_b128 a[52:55], v9 offset:10240
    v_mfma_f32_16x16x32_bf16 v[64:67], v[160:163], a[24:27], v[64:67]
    v_mfma_f32_16x16x32_bf16 v[68:71], v[164:167], a[24:27], v[68:71]
    ds_read_b128 a[56:59], v9 offset:12288
    v_mfma_f32_16x16x32_bf16 v[72:75], v[160:163], a[28:31], v[72:75]
    v_mfma_f32_16x16x32_bf16 v[76:79], v[164:167], a[28:31], v[76:79]
    ds_read_b128 a[60:63], v9 offset:14336
    s_waitcnt vmcnt(8)
    s_barrier
    s_waitcnt lgkmcnt(4)
    v_mfma_f32_16x16x32_bf16 v[16:19], v[168:171], a[32:35], v[16:19]
    v_mfma_f32_16x16x32_bf16 v[20:23], v[172:175], a[32:35], v[20:23]
    ds_read_b128 a[0:3], v3 offset:0
    s_add_u32 m0, s21, 49152
    v_mfma_f32_16x16x32_bf16 v[24:27], v[168:171], a[36:39], v[24:27]
    v_mfma_f32_16x16x32_bf16 v[28:31], v[172:175], a[36:39], v[28:31]
    ds_read_b128 a[4:7], v3 offset:2048
    s_add_u32 s64, s20, 0x400
    buffer_load_dwordx4 v2, s[4:7], s64 offen lds
    v_mfma_f32_16x16x32_bf16 v[32:35], v[168:171], a[40:43], v[32:35]
    v_mfma_f32_16x16x32_bf16 v[36:39], v[172:175], a[40:43], v[36:39]
    ds_read_b128 a[8:11], v3 offset:4096
    s_add_u32 m0, s21, 50176
    v_mfma_f32_16x16x32_bf16 v[40:43], v[168:171], a[44:47], v[40:43]
    v_mfma_f32_16x16x32_bf16 v[44:47], v[172:175], a[44:47], v[44:47]
    ds_read_b128 a[12:15], v3 offset:6144
    s_add_u32 s64, s20, 0x2c00
    buffer_load_dwordx4 v2, s[4:7], s64 offen lds
    s_waitcnt lgkmcnt(4)
    v_mfma_f32_16x16x32_bf16 v[48:51], v[168:171], a[48:51], v[48:51]
    v_mfma_f32_16x16x32_bf16 v[52:55], v[172:175], a[48:51], v[52:55]
    ds_read_b128 a[16:19], v3 offset:8192
    s_add_u32 m0, s21, 51200
    v_mfma_f32_16x16x32_bf16 v[56:59], v[168:171], a[52:55], v[56:59]
    v_mfma_f32_16x16x32_bf16 v[60:63], v[172:175], a[52:55], v[60:63]
    ds_read_b128 a[20:23], v3 offset:10240
    s_add_u32 s64, s20, 0x5400
    buffer_load_dwordx4 v2, s[4:7], s64 offen lds
    v_mfma_f32_16x16x32_bf16 v[64:67], v[168:171], a[56:59], v[64:67]
    v_mfma_f32_16x16x32_bf16 v[68:71], v[172:175], a[56:59], v[68:71]
    ds_read_b128 a[24:27], v3 offset:12288
    s_add_u32 m0, s21, 52224
    v_mfma_f32_16x16x32_bf16 v[72:75], v[168:171], a[60:63], v[72:75]
    v_mfma_f32_16x16x32_bf16 v[76:79], v[172:175], a[60:63], v[76:79]
    ds_read_b128 a[28:31], v3 offset:14336
    s_add_u32 s64, s20, 0x7c00
    buffer_load_dwordx4 v2, s[4:7], s64 offen lds
    s_waitcnt lgkmcnt(4)
    v_mfma_f32_16x16x32_bf16 v[16:19], v[176:179], a[0:3], v[16:19]
    v_mfma_f32_16x16x32_bf16 v[20:23], v[180:183], a[0:3], v[20:23]
    ds_read_b128 a[32:35], v4 offset:0
    v_mfma_f32_16x16x32_bf16 v[24:27], v[176:179], a[4:7], v[24:27]
    v_mfma_f32_16x16x32_bf16 v[28:31], v[180:183], a[4:7], v[28:31]
    ds_read_b128 a[36:39], v4 offset:2048
    v_mfma_f32_16x16x32_bf16 v[32:35], v[176:179], a[8:11], v[32:35]
    v_mfma_f32_16x16x32_bf16 v[36:39], v[180:183], a[8:11], v[36:39]
    ds_read_b128 a[40:43], v4 offset:4096
    v_mfma_f32_16x16x32_bf16 v[40:43], v[176:179], a[12:15], v[40:43]
    v_mfma_f32_16x16x32_bf16 v[44:47], v[180:183], a[12:15], v[44:47]
    ds_read_b128 a[44:47], v4 offset:6144
    s_waitcnt lgkmcnt(4)
    v_mfma_f32_16x16x32_bf16 v[48:51], v[176:179], a[16:19], v[48:51]
    v_mfma_f32_16x16x32_bf16 v[52:55], v[180:183], a[16:19], v[52:55]
    ds_read_b128 a[48:51], v4 offset:8192
    v_mfma_f32_16x16x32_bf16 v[56:59], v[176:179], a[20:23], v[56:59]
    v_mfma_f32_16x16x32_bf16 v[60:63], v[180:183], a[20:23], v[60:63]
    ds_read_b128 a[52:55], v4 offset:10240
    v_mfma_f32_16x16x32_bf16 v[64:67], v[176:179], a[24:27], v[64:67]
    v_mfma_f32_16x16x32_bf16 v[68:71], v[180:183], a[24:27], v[68:71]
    ds_read_b128 a[56:59], v4 offset:12288
    v_mfma_f32_16x16x32_bf16 v[72:75], v[176:179], a[28:31], v[72:75]
    v_mfma_f32_16x16x32_bf16 v[76:79], v[180:183], a[28:31], v[76:79]
    ds_read_b128 a[60:63], v4 offset:14336
    s_waitcnt vmcnt(8)
    s_barrier
    s_waitcnt lgkmcnt(4)
    v_mfma_f32_16x16x32_bf16 v[16:19], v[184:187], a[32:35], v[16:19]
    v_mfma_f32_16x16x32_bf16 v[20:23], v[188:191], a[32:35], v[20:23]
    ds_read_b128 a[0:3], v3 offset:16384
    s_add_u32 m0, s21, 65536
    v_mfma_f32_16x16x32_bf16 v[24:27], v[184:187], a[36:39], v[24:27]
    v_mfma_f32_16x16x32_bf16 v[28:31], v[188:191], a[36:39], v[28:31]
    ds_read_b128 a[4:7], v3 offset:18432
    s_add_u32 s64, s20, 0x480
    buffer_load_dwordx4 v2, s[4:7], s64 offen lds
    v_mfma_f32_16x16x32_bf16 v[32:35], v[184:187], a[40:43], v[32:35]
    v_mfma_f32_16x16x32_bf16 v[36:39], v[188:191], a[40:43], v[36:39]
    ds_read_b128 a[8:11], v3 offset:20480
    s_add_u32 m0, s21, 66560
    v_mfma_f32_16x16x32_bf16 v[40:43], v[184:187], a[44:47], v[40:43]
    v_mfma_f32_16x16x32_bf16 v[44:47], v[188:191], a[44:47], v[44:47]
    ds_read_b128 a[12:15], v3 offset:22528
    s_add_u32 s64, s20, 0x2c80
    buffer_load_dwordx4 v2, s[4:7], s64 offen lds
    s_waitcnt lgkmcnt(4)
    v_mfma_f32_16x16x32_bf16 v[48:51], v[184:187], a[48:51], v[48:51]
    v_mfma_f32_16x16x32_bf16 v[52:55], v[188:191], a[48:51], v[52:55]
    ds_read_b128 a[16:19], v3 offset:24576
    s_add_u32 m0, s21, 67584
    v_mfma_f32_16x16x32_bf16 v[56:59], v[184:187], a[52:55], v[56:59]
    v_mfma_f32_16x16x32_bf16 v[60:63], v[188:191], a[52:55], v[60:63]
    ds_read_b128 a[20:23], v3 offset:26624
    s_add_u32 s64, s20, 0x5480
    buffer_load_dwordx4 v2, s[4:7], s64 offen lds
    v_mfma_f32_16x16x32_bf16 v[64:67], v[184:187], a[56:59], v[64:67]
    v_mfma_f32_16x16x32_bf16 v[68:71], v[188:191], a[56:59], v[68:71]
    ds_read_b128 a[24:27], v3 offset:28672
    s_add_u32 m0, s21, 68608
    v_mfma_f32_16x16x32_bf16 v[72:75], v[184:187], a[60:63], v[72:75]
    v_mfma_f32_16x16x32_bf16 v[76:79], v[188:191], a[60:63], v[76:79]
    ds_read_b128 a[28:31], v3 offset:30720
    s_add_u32 s64, s20, 0x7c80
    buffer_load_dwordx4 v2, s[4:7], s64 offen lds
    s_waitcnt lgkmcnt(4)
    v_mfma_f32_16x16x32_bf16 v[16:19], v[192:195], a[0:3], v[16:19]
    v_mfma_f32_16x16x32_bf16 v[20:23], v[196:199], a[0:3], v[20:23]
    ds_read_b128 a[32:35], v4 offset:16384
    v_mfma_f32_16x16x32_bf16 v[24:27], v[192:195], a[4:7], v[24:27]
    v_mfma_f32_16x16x32_bf16 v[28:31], v[196:199], a[4:7], v[28:31]
    ds_read_b128 a[36:39], v4 offset:18432
    v_mfma_f32_16x16x32_bf16 v[32:35], v[192:195], a[8:11], v[32:35]
    v_mfma_f32_16x16x32_bf16 v[36:39], v[196:199], a[8:11], v[36:39]
    ds_read_b128 a[40:43], v4 offset:20480
    v_mfma_f32_16x16x32_bf16 v[40:43], v[192:195], a[12:15], v[40:43]
    v_mfma_f32_16x16x32_bf16 v[44:47], v[196:199], a[12:15], v[44:47]
    ds_read_b128 a[44:47], v4 offset:22528
    s_waitcnt lgkmcnt(4)
    v_mfma_f32_16x16x32_bf16 v[48:51], v[192:195], a[16:19], v[48:51]
    v_mfma_f32_16x16x32_bf16 v[52:55], v[196:199], a[16:19], v[52:55]
    ds_read_b128 a[48:51], v4 offset:24576
    v_mfma_f32_16x16x32_bf16 v[56:59], v[192:195], a[20:23], v[56:59]
    v_mfma_f32_16x16x32_bf16 v[60:63], v[196:199], a[20:23], v[60:63]
    ds_read_b128 a[52:55], v4 offset:26624
    v_mfma_f32_16x16x32_bf16 v[64:67], v[192:195], a[24:27], v[64:67]
    v_mfma_f32_16x16x32_bf16 v[68:71], v[196:199], a[24:27], v[68:71]
    ds_read_b128 a[56:59], v4 offset:28672
    v_mfma_f32_16x16x32_bf16 v[72:75], v[192:195], a[28:31], v[72:75]
    v_mfma_f32_16x16x32_bf16 v[76:79], v[196:199], a[28:31], v[76:79]
    ds_read_b128 a[60:63], v4 offset:30720
    s_waitcnt vmcnt(8)
    s_barrier
    s_waitcnt lgkmcnt(4)
    v_mfma_f32_16x16x32_bf16 v[16:19], v[200:203], a[32:35], v[16:19]
    v_mfma_f32_16x16x32_bf16 v[20:23], v[204:207], a[32:35], v[20:23]
    ds_read_b128 a[0:3], v3 offset:32768
    s_add_u32 m0, s21, 0
    v_mfma_f32_16x16x32_bf16 v[24:27], v[200:203], a[36:39], v[24:27]
    v_mfma_f32_16x16x32_bf16 v[28:31], v[204:207], a[36:39], v[28:31]
    ds_read_b128 a[4:7], v3 offset:34816
    s_add_u32 s64, s20, 0x50000
    buffer_load_dwordx4 v2, s[4:7], s64 offen lds
    v_mfma_f32_16x16x32_bf16 v[32:35], v[200:203], a[40:43], v[32:35]
    v_mfma_f32_16x16x32_bf16 v[36:39], v[204:207], a[40:43], v[36:39]
    ds_read_b128 a[8:11], v3 offset:36864
    s_add_u32 m0, s21, 1024
    v_mfma_f32_16x16x32_bf16 v[40:43], v[200:203], a[44:47], v[40:43]
    v_mfma_f32_16x16x32_bf16 v[44:47], v[204:207], a[44:47], v[44:47]
    ds_read_b128 a[12:15], v3 offset:38912
    s_add_u32 s64, s20, 0x52800
    buffer_load_dwordx4 v2, s[4:7], s64 offen lds
    s_waitcnt lgkmcnt(4)
    v_mfma_f32_16x16x32_bf16 v[48:51], v[200:203], a[48:51], v[48:51]
    v_mfma_f32_16x16x32_bf16 v[52:55], v[204:207], a[48:51], v[52:55]
    ds_read_b128 a[16:19], v3 offset:40960
    s_add_u32 m0, s21, 2048
    v_mfma_f32_16x16x32_bf16 v[56:59], v[200:203], a[52:55], v[56:59]
    v_mfma_f32_16x16x32_bf16 v[60:63], v[204:207], a[52:55], v[60:63]
    ds_read_b128 a[20:23], v3 offset:43008
    s_add_u32 s64, s20, 0x55000
    buffer_load_dwordx4 v2, s[4:7], s64 offen lds
    v_mfma_f32_16x16x32_bf16 v[64:67], v[200:203], a[56:59], v[64:67]
    v_mfma_f32_16x16x32_bf16 v[68:71], v[204:207], a[56:59], v[68:71]
    ds_read_b128 a[24:27], v3 offset:45056
    s_add_u32 m0, s21, 3072
    v_mfma_f32_16x16x32_bf16 v[72:75], v[200:203], a[60:63], v[72:75]
    v_mfma_f32_16x16x32_bf16 v[76:79], v[204:207], a[60:63], v[76:79]
    ds_read_b128 a[28:31], v3 offset:47104
    s_add_u32 s64, s20, 0x57800
    buffer_load_dwordx4 v2, s[4:7], s64 offen lds
    s_waitcnt lgkmcnt(4)
    v_mfma_f32_16x16x32_bf16 v[16:19], v[208:211], a[0:3], v[16:19]
    v_mfma_f32_16x16x32_bf16 v[20:23], v[212:215], a[0:3], v[20:23]
    ds_read_b128 a[32:35], v4 offset:32768
    v_mfma_f32_16x16x32_bf16 v[24:27], v[208:211], a[4:7], v[24:27]
    v_mfma_f32_16x16x32_bf16 v[28:31], v[212:215], a[4:7], v[28:31]
    ds_read_b128 a[36:39], v4 offset:34816
    v_mfma_f32_16x16x32_bf16 v[32:35], v[208:211], a[8:11], v[32:35]
    v_mfma_f32_16x16x32_bf16 v[36:39], v[212:215], a[8:11], v[36:39]
    ds_read_b128 a[40:43], v4 offset:36864
    v_mfma_f32_16x16x32_bf16 v[40:43], v[208:211], a[12:15], v[40:43]
    v_mfma_f32_16x16x32_bf16 v[44:47], v[212:215], a[12:15], v[44:47]
    ds_read_b128 a[44:47], v4 offset:38912
    s_waitcnt lgkmcnt(4)
    v_mfma_f32_16x16x32_bf16 v[48:51], v[208:211], a[16:19], v[48:51]
    v_mfma_f32_16x16x32_bf16 v[52:55], v[212:215], a[16:19], v[52:55]
    ds_read_b128 a[48:51], v4 offset:40960
    v_mfma_f32_16x16x32_bf16 v[56:59], v[208:211], a[20:23], v[56:59]
    v_mfma_f32_16x16x32_bf16 v[60:63], v[212:215], a[20:23], v[60:63]
    ds_read_b128 a[52:55], v4 offset:43008
    v_mfma_f32_16x16x32_bf16 v[64:67], v[208:211], a[24:27], v[64:67]
    v_mfma_f32_16x16x32_bf16 v[68:71], v[212:215], a[24:27], v[68:71]
    ds_read_b128 a[56:59], v4 offset:45056
    v_mfma_f32_16x16x32_bf16 v[72:75], v[208:211], a[28:31], v[72:75]
    v_mfma_f32_16x16x32_bf16 v[76:79], v[212:215], a[28:31], v[76:79]
    ds_read_b128 a[60:63], v4 offset:47104
    s_waitcnt vmcnt(8)
    s_barrier
    s_waitcnt lgkmcnt(4)
    v_mfma_f32_16x16x32_bf16 v[16:19], v[216:219], a[32:35], v[16:19]
    v_mfma_f32_16x16x32_bf16 v[20:23], v[220:223], a[32:35], v[20:23]
    ds_read_b128 a[0:3], v3 offset:49152
    s_add_u32 m0, s21, 16384
    v_mfma_f32_16x16x32_bf16 v[24:27], v[216:219], a[36:39], v[24:27]
    v_mfma_f32_16x16x32_bf16 v[28:31], v[220:223], a[36:39], v[28:31]
    ds_read_b128 a[4:7], v3 offset:51200
    s_add_u32 s64, s20, 0x50080
    buffer_load_dwordx4 v2, s[4:7], s64 offen lds
    v_mfma_f32_16x16x32_bf16 v[32:35], v[216:219], a[40:43], v[32:35]
    v_mfma_f32_16x16x32_bf16 v[36:39], v[220:223], a[40:43], v[36:39]
    ds_read_b128 a[8:11], v3 offset:53248
    s_add_u32 m0, s21, 17408
    v_mfma_f32_16x16x32_bf16 v[40:43], v[216:219], a[44:47], v[40:43]
    v_mfma_f32_16x16x32_bf16 v[44:47], v[220:223], a[44:47], v[44:47]
    ds_read_b128 a[12:15], v3 offset:55296
    s_add_u32 s64, s20, 0x52880
    buffer_load_dwordx4 v2, s[4:7], s64 offen lds
    s_waitcnt lgkmcnt(4)
    v_mfma_f32_16x16x32_bf16 v[48:51], v[216:219], a[48:51], v[48:51]
    v_mfma_f32_16x16x32_bf16 v[52:55], v[220:223], a[48:51], v[52:55]
    ds_read_b128 a[16:19], v3 offset:57344
    s_add_u32 m0, s21, 18432
    v_mfma_f32_16x16x32_bf16 v[56:59], v[216:219], a[52:55], v[56:59]
    v_mfma_f32_16x16x32_bf16 v[60:63], v[220:223], a[52:55], v[60:63]
    ds_read_b128 a[20:23], v3 offset:59392
    s_add_u32 s64, s20, 0x55080
    buffer_load_dwordx4 v2, s[4:7], s64 offen lds
    v_mfma_f32_16x16x32_bf16 v[64:67], v[216:219], a[56:59], v[64:67]
    v_mfma_f32_16x16x32_bf16 v[68:71], v[220:223], a[56:59], v[68:71]
    ds_read_b128 a[24:27], v3 offset:61440
    s_add_u32 m0, s21, 19456
    v_mfma_f32_16x16x32_bf16 v[72:75], v[216:219], a[60:63], v[72:75]
    v_mfma_f32_16x16x32_bf16 v[76:79], v[220:223], a[60:63], v[76:79]
    ds_read_b128 a[28:31], v3 offset:63488
    s_add_u32 s64, s20, 0x57880
    buffer_load_dwordx4 v2, s[4:7], s64 offen lds
    s_waitcnt lgkmcnt(4)
    v_mfma_f32_16x16x32_bf16 v[16:19], v[224:227], a[0:3], v[16:19]
    v_mfma_f32_16x16x32_bf16 v[20:23], v[228:231], a[0:3], v[20:23]
    ds_read_b128 a[32:35], v4 offset:49152
    v_mfma_f32_16x16x32_bf16 v[24:27], v[224:227], a[4:7], v[24:27]
    v_mfma_f32_16x16x32_bf16 v[28:31], v[228:231], a[4:7], v[28:31]
    ds_read_b128 a[36:39], v4 offset:51200
    v_mfma_f32_16x16x32_bf16 v[32:35], v[224:227], a[8:11], v[32:35]
    v_mfma_f32_16x16x32_bf16 v[36:39], v[228:231], a[8:11], v[36:39]
    ds_read_b128 a[40:43], v4 offset:53248
    v_mfma_f32_16x16x32_bf16 v[40:43], v[224:227], a[12:15], v[40:43]
    v_mfma_f32_16x16x32_bf16 v[44:47], v[228:231], a[12:15], v[44:47]
    ds_read_b128 a[44:47], v4 offset:55296
    s_waitcnt lgkmcnt(4)
    v_mfma_f32_16x16x32_bf16 v[48:51], v[224:227], a[16:19], v[48:51]
    v_mfma_f32_16x16x32_bf16 v[52:55], v[228:231], a[16:19], v[52:55]
    ds_read_b128 a[48:51], v4 offset:57344
    v_mfma_f32_16x16x32_bf16 v[56:59], v[224:227], a[20:23], v[56:59]
    v_mfma_f32_16x16x32_bf16 v[60:63], v[228:231], a[20:23], v[60:63]
    ds_read_b128 a[52:55], v4 offset:59392
    v_mfma_f32_16x16x32_bf16 v[64:67], v[224:227], a[24:27], v[64:67]
    v_mfma_f32_16x16x32_bf16 v[68:71], v[228:231], a[24:27], v[68:71]
    ds_read_b128 a[56:59], v4 offset:61440
    v_mfma_f32_16x16x32_bf16 v[72:75], v[224:227], a[28:31], v[72:75]
    v_mfma_f32_16x16x32_bf16 v[76:79], v[228:231], a[28:31], v[76:79]
    ds_read_b128 a[60:63], v4 offset:63488
    s_waitcnt vmcnt(8)
    s_barrier
    s_waitcnt lgkmcnt(4)
    v_mfma_f32_16x16x32_bf16 v[16:19], v[232:235], a[32:35], v[16:19]
    v_mfma_f32_16x16x32_bf16 v[20:23], v[236:239], a[32:35], v[20:23]
    ds_read_b128 a[0:3], v6 offset:0
    s_add_u32 m0, s21, 32768
    v_mfma_f32_16x16x32_bf16 v[24:27], v[232:235], a[36:39], v[24:27]
    v_mfma_f32_16x16x32_bf16 v[28:31], v[236:239], a[36:39], v[28:31]
    ds_read_b128 a[4:7], v6 offset:2048
    s_add_u32 s64, s20, 0x50100
    buffer_load_dwordx4 v2, s[4:7], s64 offen lds
    v_mfma_f32_16x16x32_bf16 v[32:35], v[232:235], a[40:43], v[32:35]
    v_mfma_f32_16x16x32_bf16 v[36:39], v[236:239], a[40:43], v[36:39]
    ds_read_b128 a[8:11], v6 offset:4096
    s_add_u32 m0, s21, 33792
    v_mfma_f32_16x16x32_bf16 v[40:43], v[232:235], a[44:47], v[40:43]
    v_mfma_f32_16x16x32_bf16 v[44:47], v[236:239], a[44:47], v[44:47]
    ds_read_b128 a[12:15], v6 offset:6144
    s_add_u32 s64, s20, 0x52900
    buffer_load_dwordx4 v2, s[4:7], s64 offen lds
    s_waitcnt lgkmcnt(4)
    v_mfma_f32_16x16x32_bf16 v[48:51], v[232:235], a[48:51], v[48:51]
    v_mfma_f32_16x16x32_bf16 v[52:55], v[236:239], a[48:51], v[52:55]
    ds_read_b128 a[16:19], v6 offset:8192
    s_add_u32 m0, s21, 34816
    v_mfma_f32_16x16x32_bf16 v[56:59], v[232:235], a[52:55], v[56:59]
    v_mfma_f32_16x16x32_bf16 v[60:63], v[236:239], a[52:55], v[60:63]
    ds_read_b128 a[20:23], v6 offset:10240
    s_add_u32 s64, s20, 0x55100
    buffer_load_dwordx4 v2, s[4:7], s64 offen lds
    v_mfma_f32_16x16x32_bf16 v[64:67], v[232:235], a[56:59], v[64:67]
    v_mfma_f32_16x16x32_bf16 v[68:71], v[236:239], a[56:59], v[68:71]
    ds_read_b128 a[24:27], v6 offset:12288
    s_add_u32 m0, s21, 35840
    v_mfma_f32_16x16x32_bf16 v[72:75], v[232:235], a[60:63], v[72:75]
    v_mfma_f32_16x16x32_bf16 v[76:79], v[236:239], a[60:63], v[76:79]
    ds_read_b128 a[28:31], v6 offset:14336
    s_add_u32 s64, s20, 0x57900
    buffer_load_dwordx4 v2, s[4:7], s64 offen lds
    s_waitcnt lgkmcnt(4)
    v_mfma_f32_16x16x32_bf16 v[16:19], v[240:243], a[0:3], v[16:19]
    v_mfma_f32_16x16x32_bf16 v[20:23], v[244:247], a[0:3], v[20:23]
    ds_read_b128 a[32:35], v9 offset:0
    v_mfma_f32_16x16x32_bf16 v[24:27], v[240:243], a[4:7], v[24:27]
    v_mfma_f32_16x16x32_bf16 v[28:31], v[244:247], a[4:7], v[28:31]
    ds_read_b128 a[36:39], v9 offset:2048
    v_mfma_f32_16x16x32_bf16 v[32:35], v[240:243], a[8:11], v[32:35]
    v_mfma_f32_16x16x32_bf16 v[36:39], v[244:247], a[8:11], v[36:39]
    ds_read_b128 a[40:43], v9 offset:4096
    v_mfma_f32_16x16x32_bf16 v[40:43], v[240:243], a[12:15], v[40:43]
    v_mfma_f32_16x16x32_bf16 v[44:47], v[244:247], a[12:15], v[44:47]
    ds_read_b128 a[44:47], v9 offset:6144
    s_waitcnt lgkmcnt(4)
    v_mfma_f32_16x16x32_bf16 v[48:51], v[240:243], a[16:19], v[48:51]
    v_mfma_f32_16x16x32_bf16 v[52:55], v[244:247], a[16:19], v[52:55]
    ds_read_b128 a[48:51], v9 offset:8192
    v_mfma_f32_16x16x32_bf16 v[56:59], v[240:243], a[20:23], v[56:59]
    v_mfma_f32_16x16x32_bf16 v[60:63], v[244:247], a[20:23], v[60:63]
    ds_read_b128 a[52:55], v9 offset:10240
    v_mfma_f32_16x16x32_bf16 v[64:67], v[240:243], a[24:27], v[64:67]
    v_mfma_f32_16x16x32_bf16 v[68:71], v[244:247], a[24:27], v[68:71]
    ds_read_b128 a[56:59], v9 offset:12288
    v_mfma_f32_16x16x32_bf16 v[72:75], v[240:243], a[28:31], v[72:75]
    v_mfma_f32_16x16x32_bf16 v[76:79], v[244:247], a[28:31], v[76:79]
    ds_read_b128 a[60:63], v9 offset:14336
    s_waitcnt vmcnt(8)
    s_barrier
    s_waitcnt lgkmcnt(4)
    v_mfma_f32_16x16x32_bf16 v[16:19], v[248:251], a[32:35], v[16:19]
    v_mfma_f32_16x16x32_bf16 v[20:23], v[252:255], a[32:35], v[20:23]
    ds_read_b128 a[0:3], v3 offset:0
    s_add_u32 m0, s21, 49152
    v_mfma_f32_16x16x32_bf16 v[24:27], v[248:251], a[36:39], v[24:27]
    v_mfma_f32_16x16x32_bf16 v[28:31], v[252:255], a[36:39], v[28:31]
    ds_read_b128 a[4:7], v3 offset:2048
    s_add_u32 s64, s20, 0x50180
    buffer_load_dwordx4 v2, s[4:7], s64 offen lds
    v_mfma_f32_16x16x32_bf16 v[32:35], v[248:251], a[40:43], v[32:35]
    v_mfma_f32_16x16x32_bf16 v[36:39], v[252:255], a[40:43], v[36:39]
    ds_read_b128 a[8:11], v3 offset:4096
    s_add_u32 m0, s21, 50176
    v_mfma_f32_16x16x32_bf16 v[40:43], v[248:251], a[44:47], v[40:43]
    v_mfma_f32_16x16x32_bf16 v[44:47], v[252:255], a[44:47], v[44:47]
    ds_read_b128 a[12:15], v3 offset:6144
    s_add_u32 s64, s20, 0x52980
    buffer_load_dwordx4 v2, s[4:7], s64 offen lds
    s_waitcnt lgkmcnt(4)
    v_mfma_f32_16x16x32_bf16 v[48:51], v[248:251], a[48:51], v[48:51]
    v_mfma_f32_16x16x32_bf16 v[52:55], v[252:255], a[48:51], v[52:55]
    ds_read_b128 a[16:19], v3 offset:8192
    s_add_u32 m0, s21, 51200
    v_mfma_f32_16x16x32_bf16 v[56:59], v[248:251], a[52:55], v[56:59]
    v_mfma_f32_16x16x32_bf16 v[60:63], v[252:255], a[52:55], v[60:63]
    ds_read_b128 a[20:23], v3 offset:10240
    s_add_u32 s64, s20, 0x55180
    buffer_load_dwordx4 v2, s[4:7], s64 offen lds
    v_mfma_f32_16x16x32_bf16 v[64:67], v[248:251], a[56:59], v[64:67]
    v_mfma_f32_16x16x32_bf16 v[68:71], v[252:255], a[56:59], v[68:71]
    ds_read_b128 a[24:27], v3 offset:12288
    s_add_u32 m0, s21, 52224
    v_mfma_f32_16x16x32_bf16 v[72:75], v[248:251], a[60:63], v[72:75]
    v_mfma_f32_16x16x32_bf16 v[76:79], v[252:255], a[60:63], v[76:79]
    ds_read_b128 a[28:31], v3 offset:14336
    s_add_u32 s64, s20, 0x57980
    buffer_load_dwordx4 v2, s[4:7], s64 offen lds
    s_nop 5
    s_mul_i32 s65, s17, 0
    s_add_u32 s65, s65, s22
    s_add_u32 s64, s65, 0
    v_cvt_pk_bf16_f32 v80, v16, v17
    v_cvt_pk_bf16_f32 v81, v18, v19
    v_cvt_pk_bf16_f32 v82, v20, v21
    v_cvt_pk_bf16_f32 v83, v22, v23
    buffer_store_dwordx4 v[80:83], v1, s[4:7], s64 offen sc1
    s_add_u32 s64, s65, 4096
    v_cvt_pk_bf16_f32 v84, v24, v25
    v_cvt_pk_bf16_f32 v85, v26, v27
    v_cvt_pk_bf16_f32 v86, v28, v29
    v_cvt_pk_bf16_f32 v87, v30, v31
    buffer_store_dwordx4 v[84:87], v1, s[4:7], s64 offen sc1
    s_mul_i32 s65, s17, 1
    s_add_u32 s65, s65, s22
    s_add_u32 s64, s65, 0
    v_cvt_pk_bf16_f32 v88, v32, v33
    v_cvt_pk_bf16_f32 v89, v34, v35
    v_cvt_pk_bf16_f32 v90, v36, v37
    v_cvt_pk_bf16_f32 v91, v38, v39
    buffer_store_dwordx4 v[88:91], v1, s[4:7], s64 offen sc1
    s_add_u32 s64, s65, 4096
    v_cvt_pk_bf16_f32 v92, v40, v41
    v_cvt_pk_bf16_f32 v93, v42, v43
    v_cvt_pk_bf16_f32 v94, v44, v45
    v_cvt_pk_bf16_f32 v95, v46, v47
    buffer_store_dwordx4 v[92:95], v1, s[4:7], s64 offen sc1
    s_mul_i32 s65, s17, 2
    s_add_u32 s65, s65, s22
    s_add_u32 s64, s65, 0
    v_cvt_pk_bf16_f32 v80, v48, v49
    v_cvt_pk_bf16_f32 v81, v50, v51
    v_cvt_pk_bf16_f32 v82, v52, v53
    v_cvt_pk_bf16_f32 v83, v54, v55
    buffer_store_dwordx4 v[80:83], v1, s[4:7], s64 offen sc1
    s_add_u32 s64, s65, 4096
    v_cvt_pk_bf16_f32 v84, v56, v57
    v_cvt_pk_bf16_f32 v85, v58, v59
    v_cvt_pk_bf16_f32 v86, v60, v61
    v_cvt_pk_bf16_f32 v87, v62, v63
    buffer_store_dwordx4 v[84:87], v1, s[4:7], s64 offen sc1
    s_mul_i32 s65, s17, 3
    s_add_u32 s65, s65, s22
    s_add_u32 s64, s65, 0
    v_cvt_pk_bf16_f32 v88, v64, v65
    v_cvt_pk_bf16_f32 v89, v66, v67
    v_cvt_pk_bf16_f32 v90, v68, v69
    v_cvt_pk_bf16_f32 v91, v70, v71
    buffer_store_dwordx4 v[88:91], v1, s[4:7], s64 offen sc1
    s_add_u32 s64, s65, 4096
    v_cvt_pk_bf16_f32 v92, v72, v73
    v_cvt_pk_bf16_f32 v93, v74, v75
    v_cvt_pk_bf16_f32 v94, v76, v77
    v_cvt_pk_bf16_f32 v95, v78, v79
    buffer_store_dwordx4 v[92:95], v1, s[4:7], s64 offen sc1
    s_lshl_b32 s64, s19, 1
    s_add_u32 s64, s64, s12
    s_lshl_b32 s64, s64, 9
    s_add_u32 s23, s18, s64
    s_lshl_b32 s64, s17, 3
    s_add_u32 s22, s22, s64
    s_add_u32 s19, s19, 1
    s_add_u32 s20, s20, 0x50000
    s_cmp_lt_u32 s19, 8
    s_cbranch_scc1 G_T_LOOP
    s_waitcnt vmcnt(0) lgkmcnt(0)
    s_barrier
    s_cmp_lg_u32 s14, 0
    s_cbranch_scc1 GF_104
    v_mov_b32 v7, 1
    v_mov_b32 v8, 0
    s_mov_b64 exec, 1
    buffer_store_dword v7, v8, s[4:7], s23 offen sc1
    s_mov_b64 exec, -1
GF_104:
    s_cmp_eq_u32 s3, 2
    s_cbranch_scc1 H_Q
    s_cmp_eq_u32 s12, 1
    s_cbranch_scc1 H_OUT
    s_lshl_b32 s88, s3, 5
    s_add_u32 s88, s88, s13
    s_mov_b32 s29, 0
    v_lshlrev_b32 v1, 4, v0
    s_mov_b32 s65, 0
CW_105:
    buffer_load_dwordx2 v[8:9], off, s[60:63], 0 offset:132 sc1
    s_add_u32 s65, s65, 1
    s_waitcnt vmcnt(0)
    v_readfirstlane_b32 s66, v8
    v_readfirstlane_b32 s67, v9
    s_min_u32 s64, s66, s67
    s_cmp_lg_u32 s64, 0
    s_cbranch_scc1 CWD_106
    s_cmp_gt_u32 s65, 65536
    s_cbranch_scc1 CWD_106
    s_sleep 4
    s_branch CW_105
CWD_106:
    s_sub_u32 s66, s66, 1
    s_and_b32 s66, s66, 3
    s_sub_u32 s67, s67, 1
    s_and_b32 s67, s67, 3
    s_mov_b32 s64, s66
    s_mov_b32 s65, s67
    s_and_b32 s64, s64, 3
    s_lshl_b32 s64, s64, 13
    s_and_b32 s65, s65, 3
    s_lshl_b32 s65, s65, 13
    s_add_u32 s25, s64, 0x6000000
    s_add_u32 s30, s65, 0x6200000
    v_bfe_u32 v4, v0, 3, 1
    v_mul_u32_u24 v2, 0x8000, v4
    v_lshrrev_b32 v4, 5, v0
    v_lshl_add_u32 v2, v4, 8, v2
    v_bfe_u32 v4, v0, 4, 1
    v_lshl_add_u32 v2, v4, 7, v2
    v_and_b32 v4, 7, v0
    v_lshl_add_u32 v2, v4, 4, v2
    v_bfe_u32 v4, v0, 3, 1
    v_lshlrev_b32 v3, 16, v4
    v_lshrrev_b32 v4, 4, v0
    v_lshl_add_u32 v3, v4, 7, v3
    v_and_b32 v4, 7, v0
    v_lshl_add_u32 v3, v4, 4, v3
    s_lshl_b32 s26, s13, 11
    s_lshl_b32 s64, s14, 9
    s_add_u32 s26, s26, s64
    s_add_u32 s26, s26, 0x640000
    s_lshl_b32 s27, s13, 3
    s_add_u32 s27, s27, 0x294000
    s_mov_b32 s28, 0x29a000
    s_mov_b32 s24, 0
    v_lshlrev_b32 v6, 7, v0
MKT_LOOP:
    s_cmp_lg_u32 s24, 10
    s_cbranch_scc1 MKH_107
    v_mov_b32 v10, v2
    v_mov_b32 v11, v3
    s_cmp_ge_u32 s88, 60
    s_cbranch_scc1 NOWO_108
    s_mov_b32 s89, s13
    s_mul_hi_u32 s65, s88, 0xccccccd
    s_mul_i32 s65, s65, 20
    s_sub_u32 s13, s88, s65
    s_load_dwordx2 s[44:45], s[0:1], 40
    s_mov_b32 s46, 0x500000
    s_mov_b32 s47, 0x00020000
    s_waitcnt lgkmcnt(0)
    s_mul_i32 s21, s14, 36864
    v_lshrrev_b32 v7, 2, v0
    v_mul_u32_u24 v4, 1280, v7
    v_bfe_u32 v7, v0, 4, 1
    v_lshlrev_b32 v7, 1, v7
    v_and_b32 v8, 3, v0
    v_xor_b32 v7, v7, v8
    v_lshl_add_u32 v4, v7, 4, v4
    v_lshrrev_b32 v7, 4, v0
    v_lshlrev_b32 v2, 8, v7
    v_bfe_u32 v7, v0, 2, 2
    v_lshl_add_u32 v2, v7, 6, v2
    v_and_b32 v7, 3, v0
    v_lshl_add_u32 v2, v7, 3, v2
    v_add_u32 v2, s21, v2
    v_bfe_u32 v7, v0, 4, 1
    v_lshlrev_b32 v7, 5, v7
    v_sub_u32 v3, 32, v7
    v_add_u32 v3, v3, v2
    v_add_u32 v2, v2, v7
    s_mul_i32 s65, s14, 1310720
    s_lshl_b32 s66, s13, 6
    s_add_u32 s65, s65, s66
    s_add_u32 m0, s21, 0
    s_add_u32 s64, s65, 0x0
    buffer_load_dwordx4 v4, s[44:47], s64 offen lds
    s_add_u32 m0, s21, 1024
    s_add_u32 s64, s65, 0x5000
    buffer_load_dwordx4 v4, s[44:47], s64 offen lds
    s_add_u32 m0, s21, 2048
    s_add_u32 s64, s65, 0xa000
    buffer_load_dwordx4 v4, s[44:47], s64 offen lds
    s_add_u32 m0, s21, 3072
    s_add_u32 s64, s65, 0xf000
    buffer_load_dwordx4 v4, s[44:47], s64 offen lds
    s_add_u32 m0, s21, 4096
    s_add_u32 s64, s65, 0x14000
    buffer_load_dwordx4 v4, s[44:47], s64 offen lds
    s_add_u32 m0, s21, 5120
    s_add_u32 s64, s65, 0x19000
    buffer_load_dwordx4 v4, s[44:47], s64 offen lds
    s_add_u32 m0, s21, 6144
    s_add_u32 s64, s65, 0x1e000
    buffer_load_dwordx4 v4, s[44:47], s64 offen lds
    s_add_u32 m0, s21, 7168
    s_add_u32 s64, s65, 0x23000
    buffer_load_dwordx4 v4, s[44:47], s64 offen lds
    s_add_u32 m0, s21, 8192
    s_add_u32 s64, s65, 0x28000
    buffer_load_dwordx4 v4, s[44:47], s64 offen lds
    s_add_u32 m0, s21, 9216
    s_add_u32 s64, s65, 0x2d000
    buffer_load_dwordx4 v4, s[44:47], s64 offen lds
    s_add_u32 m0, s21, 10240
    s_add_u32 s64, s65, 0x32000
    buffer_load_dwordx4 v4, s[44:47], s64 offen lds
    s_add_u32 m0, s21, 11264
    s_add_u32 s64, s65, 0x37000
    buffer_load_dwordx4 v4, s[44:47], s64 offen lds
    s_add_u32 m0, s21, 12288
    s_add_u32 s64, s65, 0x3c000
    buffer_load_dwordx4 v4, s[44:47], s64 offen lds
    s_add_u32 m0, s21, 13312
    s_add_u32 s64, s65, 0x41000
    buffer_load_dwordx4 v4, s[44:47], s64 offen lds
    s_add_u32 m0, s21, 14336
    s_add_u32 s64, s65, 0x46000
    buffer_load_dwordx4 v4, s[44:47], s64 offen lds
    s_add_u32 m0, s21, 15360
    s_add_u32 s64, s65, 0x4b000
    buffer_load_dwordx4 v4, s[44:47], s64 offen lds
    s_add_u32 m0, s21, 16384
    s_add_u32 s64, s65, 0x50000
    buffer_load_dwordx4 v4, s[44:47], s64 offen lds
    s_add_u32 m0, s21, 17408
    s_add_u32 s64, s65, 0x55000
    buffer_load_dwordx4 v4, s[44:47], s64 offen lds
    s_add_u32 m0, s21, 18432
    s_add_u32 s64, s65, 0x5a000
    buffer_load_dwordx4 v4, s[44:47], s64 offen lds
    s_add_u32 m0, s21, 19456
    s_add_u32 s64, s65, 0x5f000
    buffer_load_dwordx4 v4, s[44:47], s64 offen lds
    s_add_u32 m0, s21, 20480
    s_add_u32 s64, s65, 0x64000
    buffer_load_dwordx4 v4, s[44:47], s64 offen lds
    s_add_u32 m0, s21, 21504
    s_add_u32 s64, s65, 0x69000
    buffer_load_dwordx4 v4, s[44:47], s64 offen lds
    s_add_u32 m0, s21, 22528
    s_add_u32 s64, s65, 0x6e000
    buffer_load_dwordx4 v4, s[44:47], s64 offen lds
    s_add_u32 m0, s21, 23552
    s_add_u32 s64, s65, 0x73000
    buffer_load_dwordx4 v4, s[44:47], s64 offen lds
    s_add_u32 m0, s21, 24576
    s_add_u32 s64, s65, 0x78000
    buffer_load_dwordx4 v4, s[44:47], s64 offen lds
    s_add_u32 m0, s21, 25600
    s_add_u32 s64, s65, 0x7d000
    buffer_load_dwordx4 v4, s[44:47], s64 offen lds
    s_add_u32 m0, s21, 26624
    s_add_u32 s64, s65, 0x82000
    buffer_load_dwordx4 v4, s[44:47], s64 offen lds
    s_add_u32 m0, s21, 27648
    s_add_u32 s64, s65, 0x87000
    buffer_load_dwordx4 v4, s[44:47], s64 offen lds
    s_add_u32 m0, s21, 28672
    s_add_u32 s64, s65, 0x8c000
    buffer_load_dwordx4 v4, s[44:47], s64 offen lds
    s_add_u32 m0, s21, 29696
    s_add_u32 s64, s65, 0x91000
    buffer_load_dwordx4 v4, s[44:47], s64 offen lds
    s_add_u32 m0, s21, 30720
    s_add_u32 s64, s65, 0x96000
    buffer_load_dwordx4 v4, s[44:47], s64 offen lds
    s_add_u32 m0, s21, 31744
    s_add_u32 s64, s65, 0x9b000
    buffer_load_dwordx4 v4, s[44:47], s64 offen lds
    s_add_u32 m0, s21, 32768
    s_add_u32 s64, s65, 0xa0000
    buffer_load_dwordx4 v4, s[44:47], s64 offen lds
    s_add_u32 m0, s21, 33792
    s_add_u32 s64, s65, 0xa5000
    buffer_load_dwordx4 v4, s[44:47], s64 offen lds
    s_add_u32 m0, s21, 34816
    s_add_u32 s64, s65, 0xaa000
    buffer_load_dwordx4 v4, s[44:47], s64 offen lds
    s_add_u32 m0, s21, 35840
    s_add_u32 s64, s65, 0xaf000
    buffer_load_dwordx4 v4, s[44:47], s64 offen lds
    s_waitcnt vmcnt(32)
    ds_read_b64_tr_b16 a[0:1], v2 offset:0
    ds_read_b64_tr_b16 a[2:3], v2 offset:1024
    ds_read_b64_tr_b16 a[4:5], v3 offset:0
    ds_read_b64_tr_b16 a[6:7], v3 offset:1024
    ds_read_b64_tr_b16 a[8:9], v2 offset:2048
    ds_read_b64_tr_b16 a[10:11], v2 offset:3072
    ds_read_b64_tr_b16 a[12:13], v3 offset:2048
    ds_read_b64_tr_b16 a[14:15], v3 offset:3072
    s_waitcnt lgkmcnt(0)
    s_add_u32 m0, s21, 0
    s_add_u32 s64, s65, 0xb4000
    buffer_load_dwordx4 v4, s[44:47], s64 offen lds
    s_add_u32 m0, s21, 1024
    s_add_u32 s64, s65, 0xb9000
    buffer_load_dwordx4 v4, s[44:47], s64 offen lds
    s_add_u32 m0, s21, 2048
    s_add_u32 s64, s65, 0xbe000
    buffer_load_dwordx4 v4, s[44:47], s64 offen lds
    s_add_u32 m0, s21, 3072
    s_add_u32 s64, s65, 0xc3000
    buffer_load_dwordx4 v4, s[44:47], s64 offen lds
    s_waitcnt vmcnt(32)
    ds_read_b64_tr_b16 a[16:17], v2 offset:4096
    ds_read_b64_tr_b16 a[18:19], v2 offset:5120
    ds_read_b64_tr_b16 a[20:21], v3 offset:4096
    ds_read_b64_tr_b16 a[22:23], v3 offset:5120
    ds_read_b64_tr_b16 a[24:25], v2 offset:6144
    ds_read_b64_tr_b16 a[26:27], v2 offset:7168
    ds_read_b64_tr_b16 a[28:29], v3 offset:6144
    ds_read_b64_tr_b16 a[30:31], v3 offset:7168
    s_waitcnt lgkmcnt(0)
    s_add_u32 m0, s21, 4096
    s_add_u32 s64, s65, 0xc8000
    buffer_load_dwordx4 v4, s[44:47], s64 offen lds
    s_add_u32 m0, s21, 5120
    s_add_u32 s64, s65, 0xcd000
    buffer_load_dwordx4 v4, s[44:47], s64 offen lds
    s_add_u32 m0, s21, 6144
    s_add_u32 s64, s65, 0xd2000
    buffer_load_dwordx4 v4, s[44:47], s64 offen lds
    s_add_u32 m0, s21, 7168
    s_add_u32 s64, s65, 0xd7000
    buffer_load_dwordx4 v4, s[44:47], s64 offen lds
    s_waitcnt vmcnt(32)
    ds_read_b64_tr_b16 a[32:33], v2 offset:8192
    ds_read_b64_tr_b16 a[34:35], v2 offset:9216
    ds_read_b64_tr_b16 a[36:37], v3 offset:8192
    ds_read_b64_tr_b16 a[38:39], v3 offset:9216
    ds_read_b64_tr_b16 a[40:41], v2 offset:10240
    ds_read_b64_tr_b16 a[42:43], v2 offset:11264
    ds_read_b64_tr_b16 a[44:45], v3 offset:10240
    ds_read_b64_tr_b16 a[46:47], v3 offset:11264
    s_waitcnt lgkmcnt(0)
    s_add_u32 m0, s21, 8192
    s_add_u32 s64, s65, 0xdc000
    buffer_load_dwordx4 v4, s[44:47], s64 offen lds
    s_add_u32 m0, s21, 9216
    s_add_u32 s64, s65, 0xe1000
    buffer_load_dwordx4 v4, s[44:47], s64 offen lds
    s_add_u32 m0, s21, 10240
    s_add_u32 s64, s65, 0xe6000
    buffer_load_dwordx4 v4, s[44:47], s64 offen lds
    s_add_u32 m0, s21, 11264
    s_add_u32 s64, s65, 0xeb000
    buffer_load_dwordx4 v4, s[44:47], s64 offen lds
    s_waitcnt vmcnt(32)
    ds_read_b64_tr_b16 a[48:49], v2 offset:12288
    ds_read_b64_tr_b16 a[50:51], v2 offset:13312
    ds_read_b64_tr_b16 a[52:53], v3 offset:12288
    ds_read_b64_tr_b16 a[54:55], v3 offset:13312
    ds_read_b64_tr_b16 a[56:57], v2 offset:14336
    ds_read_b64_tr_b16 a[58:59], v2 offset:15360
    ds_read_b64_tr_b16 a[60:61], v3 offset:14336
    ds_read_b64_tr_b16 a[62:63], v3 offset:15360
    s_waitcnt lgkmcnt(0)
    s_add_u32 m0, s21, 12288
    s_add_u32 s64, s65, 0xf0000
    buffer_load_dwordx4 v4, s[44:47], s64 offen lds
    s_add_u32 m0, s21, 13312
    s_add_u32 s64, s65, 0xf5000
    buffer_load_dwordx4 v4, s[44:47], s64 offen lds
    s_add_u32 m0, s21, 14336
    s_add_u32 s64, s65, 0xfa000
    buffer_load_dwordx4 v4, s[44:47], s64 offen lds
    s_add_u32 m0, s21, 15360
    s_add_u32 s64, s65, 0xff000
    buffer_load_dwordx4 v4, s[44:47], s64 offen lds
    s_waitcnt vmcnt(32)
    ds_read_b64_tr_b16 a[64:65], v2 offset:16384
    ds_read_b64_tr_b16 a[66:67], v2 offset:17408
    ds_read_b64_tr_b16 a[68:69], v3 offset:16384
    ds_read_b64_tr_b16 a[70:71], v3 offset:17408
    ds_read_b64_tr_b16 a[72:73], v2 offset:18432
    ds_read_b64_tr_b16 a[74:75], v2 offset:19456
    ds_read_b64_tr_b16 a[76:77], v3 offset:18432
    ds_read_b64_tr_b16 a[78:79], v3 offset:19456
    s_waitcnt lgkmcnt(0)
    s_add_u32 m0, s21, 16384
    s_add_u32 s64, s65, 0x104000
    buffer_load_dwordx4 v4, s[44:47], s64 offen lds
    s_add_u32 m0, s21, 17408
    s_add_u32 s64, s65, 0x109000
    buffer_load_dwordx4 v4, s[44:47], s64 offen lds
    s_add_u32 m0, s21, 18432
    s_add_u32 s64, s65, 0x10e000
    buffer_load_dwordx4 v4, s[44:47], s64 offen lds
    s_add_u32 m0, s21, 19456
    s_add_u32 s64, s65, 0x113000
    buffer_load_dwordx4 v4, s[44:47], s64 offen lds
    s_waitcnt vmcnt(32)
    ds_read_b64_tr_b16 a[80:81], v2 offset:20480
    ds_read_b64_tr_b16 a[82:83], v2 offset:21504
    ds_read_b64_tr_b16 a[84:85], v3 offset:20480
    ds_read_b64_tr_b16 a[86:87], v3 offset:21504
    ds_read_b64_tr_b16 a[88:89], v2 offset:22528
    ds_read_b64_tr_b16 a[90:91], v2 offset:23552
    ds_read_b64_tr_b16 a[92:93], v3 offset:22528
    ds_read_b64_tr_b16 a[94:95], v3 offset:23552
    s_waitcnt lgkmcnt(0)
    s_add_u32 m0, s21, 20480
    s_add_u32 s64, s65, 0x118000
    buffer_load_dwordx4 v4, s[44:47], s64 offen lds
    s_add_u32 m0, s21, 21504
    s_add_u32 s64, s65, 0x11d000
    buffer_load_dwordx4 v4, s[44:47], s64 offen lds
    s_add_u32 m0, s21, 22528
    s_add_u32 s64, s65, 0x122000
    buffer_load_dwordx4 v4, s[44:47], s64 offen lds
    s_add_u32 m0, s21, 23552
    s_add_u32 s64, s65, 0x127000
    buffer_load_dwordx4 v4, s[44:47], s64 offen lds
    s_waitcnt vmcnt(32)
    ds_read_b64_tr_b16 a[96:97], v2 offset:24576
    ds_read_b64_tr_b16 a[98:99], v2 offset:25600
    ds_read_b64_tr_b16 a[100:101], v3 offset:24576
    ds_read_b64_tr_b16 a[102:103], v3 offset:25600
    ds_read_b64_tr_b16 a[104:105], v2 offset:26624
    ds_read_b64_tr_b16 a[106:107], v2 offset:27648
    ds_read_b64_tr_b16 a[108:109], v3 offset:26624
    ds_read_b64_tr_b16 a[110:111], v3 offset:27648
    s_waitcnt lgkmcnt(0)
    s_add_u32 m0, s21, 24576
    s_add_u32 s64, s65, 0x12c000
    buffer_load_dwordx4 v4, s[44:47], s64 offen lds
    s_add_u32 m0, s21, 25600
    s_add_u32 s64, s65, 0x131000
    buffer_load_dwordx4 v4, s[44:47], s64 offen lds
    s_add_u32 m0, s21, 26624
    s_add_u32 s64, s65, 0x136000
    buffer_load_dwordx4 v4, s[44:47], s64 offen lds
    s_add_u32 m0, s21, 27648
    s_add_u32 s64, s65, 0x13b000
    buffer_load_dwordx4 v4, s[44:47], s64 offen lds
    s_waitcnt vmcnt(32)
    ds_read_b64_tr_b16 a[112:113], v2 offset:28672
    ds_read_b64_tr_b16 a[114:115], v2 offset:29696
    ds_read_b64_tr_b16 a[116:117], v3 offset:28672
    ds_read_b64_tr_b16 a[118:119], v3 offset:29696
    ds_read_b64_tr_b16 a[120:121], v2 offset:30720
    ds_read_b64_tr_b16 a[122:123], v2 offset:31744
    ds_read_b64_tr_b16 a[124:125], v3 offset:30720
    ds_read_b64_tr_b16 a[126:127], v3 offset:31744
    s_waitcnt lgkmcnt(0)
    s_waitcnt vmcnt(28)
    ds_read_b64_tr_b16 a[128:129], v2 offset:32768
    ds_read_b64_tr_b16 a[130:131], v2 offset:33792
    ds_read_b64_tr_b16 a[132:133], v3 offset:32768
    ds_read_b64_tr_b16 a[134:135], v3 offset:33792
    ds_read_b64_tr_b16 a[136:137], v2 offset:34816
    ds_read_b64_tr_b16 a[138:139], v2 offset:35840
    ds_read_b64_tr_b16 a[140:141], v3 offset:34816
    ds_read_b64_tr_b16 a[142:143], v3 offset:35840
    s_waitcnt lgkmcnt(0)
    s_waitcnt vmcnt(24)
    ds_read_b64_tr_b16 a[144:145], v2 offset:0
    ds_read_b64_tr_b16 a[146:147], v2 offset:1024
    ds_read_b64_tr_b16 a[148:149], v3 offset:0
    ds_read_b64_tr_b16 a[150:151], v3 offset:1024
    ds_read_b64_tr_b16 a[152:153], v2 offset:2048
    ds_read_b64_tr_b16 a[154:155], v2 offset:3072
    ds_read_b64_tr_b16 a[156:157], v3 offset:2048
    ds_read_b64_tr_b16 a[158:159], v3 offset:3072
    s_waitcnt lgkmcnt(0)
    s_waitcnt vmcnt(20)
    ds_read_b64_tr_b16 a[160:161], v2 offset:4096
    ds_read_b64_tr_b16 a[162:163], v2 offset:5120
    ds_read_b64_tr_b16 a[164:165], v3 offset:4096
    ds_read_b64_tr_b16 a[166:167], v3 offset:5120
    ds_read_b64_tr_b16 a[168:169], v2 offset:6144
    ds_read_b64_tr_b16 a[170:171], v2 offset:7168
    ds_read_b64_tr_b16 a[172:173], v3 offset:6144
    ds_read_b64_tr_b16 a[174:175], v3 offset:7168
    s_waitcnt lgkmcnt(0)
    s_waitcnt vmcnt(16)
    ds_read_b64_tr_b16 a[176:177], v2 offset:8192
    ds_read_b64_tr_b16 a[178:179], v2 offset:9216
    ds_read_b64_tr_b16 a[180:181], v3 offset:8192
    ds_read_b64_tr_b16 a[182:183], v3 offset:9216
    ds_read_b64_tr_b16 a[184:185], v2 offset:10240
    ds_read_b64_tr_b16 a[186:187], v2 offset:11264
    ds_read_b64_tr_b16 a[188:189], v3 offset:10240
    ds_read_b64_tr_b16 a[190:191], v3 offset:11264
    s_waitcnt lgkmcnt(0)
    s_waitcnt vmcnt(12)
    ds_read_b64_tr_b16 a[192:193], v2 offset:12288
    ds_read_b64_tr_b16 a[194:195], v2 offset:13312
    ds_read_b64_tr_b16 a[196:197], v3 offset:12288
    ds_read_b64_tr_b16 a[198:199], v3 offset:13312
    ds_read_b64_tr_b16 a[200:201], v2 offset:14336
    ds_read_b64_tr_b16 a[202:203], v2 offset:15360
    ds_read_b64_tr_b16 a[204:205], v3 offset:14336
    ds_read_b64_tr_b16 a[206:207], v3 offset:15360
    s_waitcnt lgkmcnt(0)
    s_waitcnt vmcnt(8)
    ds_read_b64_tr_b16 a[208:209], v2 offset:16384
    ds_read_b64_tr_b16 a[210:211], v2 offset:17408
    ds_read_b64_tr_b16 a[212:213], v3 offset:16384
    ds_read_b64_tr_b16 a[214:215], v3 offset:17408
    ds_read_b64_tr_b16 a[216:217], v2 offset:18432
    ds_read_b64_tr_b16 a[218:219], v2 offset:19456
    ds_read_b64_tr_b16 a[220:221], v3 offset:18432
    ds_read_b64_tr_b16 a[222:223], v3 offset:19456
    s_waitcnt lgkmcnt(0)
    s_waitcnt vmcnt(4)
    ds_read_b64_tr_b16 a[224:225], v2 offset:20480
    ds_read_b64_tr_b16 a[226:227], v2 offset:21504
    ds_read_b64_tr_b16 a[228:229], v3 offset:20480
    ds_read_b64_tr_b16 a[230:231], v3 offset:21504
    ds_read_b64_tr_b16 a[232:233], v2 offset:22528
    ds_read_b64_tr_b16 a[234:235], v2 offset:23552
    ds_read_b64_tr_b16 a[236:237], v3 offset:22528
    ds_read_b64_tr_b16 a[238:239], v3 offset:23552
    s_waitcnt lgkmcnt(0)
    s_waitcnt vmcnt(0)
    ds_read_b64_tr_b16 a[240:241], v2 offset:24576
    ds_read_b64_tr_b16 a[242:243], v2 offset:25600
    ds_read_b64_tr_b16 a[244:245], v3 offset:24576
    ds_read_b64_tr_b16 a[246:247], v3 offset:25600
    ds_read_b64_tr_b16 a[248:249], v2 offset:26624
    ds_read_b64_tr_b16 a[250:251], v2 offset:27648
    ds_read_b64_tr_b16 a[252:253], v3 offset:26624
    ds_read_b64_tr_b16 a[254:255], v3 offset:27648
    s_waitcnt lgkmcnt(0)
    s_mov_b32 s13, s89
NOWO_108:
    v_mov_b32 v2, v10
    v_mov_b32 v3, v11
MKH_107:
    s_mov_b64 exec, 0xf
MKT_M_109:
    buffer_load_dword v5, v6, s[4:7], s28 offen sc1
    s_add_u32 s29, s29, 1
    s_waitcnt vmcnt(0)
    v_cmp_eq_u32 vcc, 0, v5
    s_cbranch_vccz MKT_MD_110
    s_cmp_gt_u32 s29, 262144
    s_cbranch_scc1 MKT_MD_110
    s_sleep 1
    s_branch MKT_M_109
MKT_MD_110:
    s_mov_b64 exec, -1
MKR_111:
    s_add_u32 s64, s25, 0x0
    buffer_load_dwordx4 v[16:19], v2, s[4:7], s64 offen sc1
    s_add_u32 s64, s25, 0x200
    buffer_load_dwordx4 v[20:23], v2, s[4:7], s64 offen sc1
    s_add_u32 s64, s25, 0x400
    buffer_load_dwordx4 v[24:27], v2, s[4:7], s64 offen sc1
    s_add_u32 s64, s25, 0x600
    buffer_load_dwordx4 v[28:31], v2, s[4:7], s64 offen sc1
    s_add_u32 s64, s25, 0x800
    buffer_load_dwordx4 v[32:35], v2, s[4:7], s64 offen sc1
    s_add_u32 s64, s25, 0xa00
    buffer_load_dwordx4 v[36:39], v2, s[4:7], s64 offen sc1
    s_add_u32 s64, s25, 0xc00
    buffer_load_dwordx4 v[40:43], v2, s[4:7], s64 offen sc1
    s_add_u32 s64, s25, 0xe00
    buffer_load_dwordx4 v[44:47], v2, s[4:7], s64 offen sc1
    s_add_u32 s64, s25, 0x1000
    buffer_load_dwordx4 v[48:51], v2, s[4:7], s64 offen sc1
    s_add_u32 s64, s25, 0x1200
    buffer_load_dwordx4 v[52:55], v2, s[4:7], s64 offen sc1
    s_add_u32 s64, s30, 0x0
    buffer_load_dwordx4 v[56:59], v2, s[4:7], s64 offen sc1
    s_add_u32 s64, s30, 0x200
    buffer_load_dwordx4 v[60:63], v2, s[4:7], s64 offen sc1
    s_add_u32 s64, s30, 0x400
    buffer_load_dwordx4 v[64:67], v2, s[4:7], s64 offen sc1
    s_add_u32 s64, s30, 0x600
    buffer_load_dwordx4 v[68:71], v2, s[4:7], s64 offen sc1
    s_add_u32 s64, s30, 0x800
    buffer_load_dwordx4 v[72:75], v2, s[4:7], s64 offen sc1
    s_add_u32 s64, s30, 0xa00
    buffer_load_dwordx4 v[76:79], v2, s[4:7], s64 offen sc1
    s_add_u32 s64, s30, 0xc00
    buffer_load_dwordx4 v[80:83], v2, s[4:7], s64 offen sc1
    s_add_u32 s64, s30, 0xe00
    buffer_load_dwordx4 v[84:87], v2, s[4:7], s64 offen sc1
    s_add_u32 s64, s30, 0x1000
    buffer_load_dwordx4 v[88:91], v2, s[4:7], s64 offen sc1
    s_add_u32 s64, s30, 0x1200
    buffer_load_dwordx4 v[92:95], v2, s[4:7], s64 offen sc1
    s_add_u32 s29, s29, 1
    s_waitcnt vmcnt(0)
    v_max3_u32 v4, v19, v23, v27
    v_max3_u32 v4, v4, v31, v35
    v_max3_u32 v4, v4, v39, v43
    v_max3_u32 v4, v4, v47, v51
    v_max3_u32 v4, v4, v55, v59
    v_max3_u32 v4, v4, v63, v67
    v_max3_u32 v4, v4, v71, v75
    v_max3_u32 v4, v4, v79, v83
    v_max3_u32 v4, v4, v87, v91
    v_max_u32 v4, v4, v95
    v_cmp_eq_u32 vcc, -1, v4
    s_cbranch_vccz MKO_112
    s_cmp_gt_u32 s29, 262144
    s_cbranch_scc0 MKR_111
MKO_112:
    v_mfma_f32_16x16x32_bf16 v[8:11], v[96:99], v[16:19], 0
    v_mfma_f32_16x16x32_bf16 v[12:15], v[100:103], v[16:19], 0
    v_mfma_f32_16x16x32_bf16 v[8:11], v[104:107], v[20:23], v[8:11]
    v_mfma_f32_16x16x32_bf16 v[12:15], v[108:111], v[20:23], v[12:15]
    v_mfma_f32_16x16x32_bf16 v[8:11], v[112:115], v[24:27], v[8:11]
    v_mfma_f32_16x16x32_bf16 v[12:15], v[116:119], v[24:27], v[12:15]
    v_mfma_f32_16x16x32_bf16 v[8:11], v[120:123], v[28:31], v[8:11]
    v_mfma_f32_16x16x32_bf16 v[12:15], v[124:127], v[28:31], v[12:15]
    v_mfma_f32_16x16x32_bf16 v[8:11], v[128:131], v[32:35], v[8:11]
    v_mfma_f32_16x16x32_bf16 v[12:15], v[132:135], v[32:35], v[12:15]
    v_mfma_f32_16x16x32_bf16 v[8:11], v[136:139], v[36:39], v[8:11]
    v_mfma_f32_16x16x32_bf16 v[12:15], v[140:143], v[36:39], v[12:15]
    v_mfma_f32_16x16x32_bf16 v[8:11], v[144:147], v[40:43], v[8:11]
    v_mfma_f32_16x16x32_bf16 v[12:15], v[148:151], v[40:43], v[12:15]
    v_mfma_f32_16x16x32_bf16 v[8:11], v[152:155], v[44:47], v[8:11]
    v_mfma_f32_16x16x32_bf16 v[12:15], v[156:159], v[44:47], v[12:15]
    v_mfma_f32_16x16x32_bf16 v[8:11], v[160:163], v[48:51], v[8:11]
    v_mfma_f32_16x16x32_bf16 v[12:15], v[164:167], v[48:51], v[12:15]
    v_mfma_f32_16x16x32_bf16 v[8:11], v[168:171], v[52:55], v[8:11]
    v_mfma_f32_16x16x32_bf16 v[12:15], v[172:175], v[52:55], v[12:15]
    v_mfma_f32_16x16x32_bf16 v[8:11], v[176:179], v[56:59], v[8:11]
    v_mfma_f32_16x16x32_bf16 v[12:15], v[180:183], v[56:59], v[12:15]
    v_mfma_f32_16x16x32_bf16 v[8:11], v[184:187], v[60:63], v[8:11]
    v_mfma_f32_16x16x32_bf16 v[12:15], v[188:191], v[60:63], v[12:15]
    v_mfma_f32_16x16x32_bf16 v[8:11], v[192:195], v[64:67], v[8:11]
    v_mfma_f32_16x16x32_bf16 v[12:15], v[196:199], v[64:67], v[12:15]
    v_mfma_f32_16x16x32_bf16 v[8:11], v[200:203], v[68:71], v[8:11]
    v_mfma_f32_16x16x32_bf16 v[12:15], v[204:207], v[68:71], v[12:15]
    v_mfma_f32_16x16x32_bf16 v[8:11], v[208:211], v[72:75], v[8:11]
    v_mfma_f32_16x16x32_bf16 v[12:15], v[212:215], v[72:75], v[12:15]
    v_mfma_f32_16x16x32_bf16 v[8:11], v[216:219], v[76:79], v[8:11]
    v_mfma_f32_16x16x32_bf16 v[12:15], v[220:223], v[76:79], v[12:15]
    v_mfma_f32_16x16x32_bf16 v[8:11], v[224:227], v[80:83], v[8:11]
    v_mfma_f32_16x16x32_bf16 v[12:15], v[228:231], v[80:83], v[12:15]
    v_mfma_f32_16x16x32_bf16 v[8:11], v[232:235], v[84:87], v[8:11]
    v_mfma_f32_16x16x32_bf16 v[12:15], v[236:239], v[84:87], v[12:15]
    v_mfma_f32_16x16x32_bf16 v[8:11], v[240:243], v[88:91], v[8:11]
    v_mfma_f32_16x16x32_bf16 v[12:15], v[244:247], v[88:91], v[12:15]
    v_mfma_f32_16x16x32_bf16 v[8:11], v[248:251], v[92:95], v[8:11]
    v_mfma_f32_16x16x32_bf16 v[12:15], v[252:255], v[92:95], v[12:15]
    s_nop 7
    v_cvt_pk_bf16_f32 v16, v8, v9
    v_cvt_pk_bf16_f32 v17, v10, v11
    v_cvt_pk_bf16_f32 v18, v12, v13
    v_cvt_pk_bf16_f32 v19, v14, v15
    buffer_store_dwordx4 v[16:19], v3, s[4:7], s26 offen sc1
    s_waitcnt vmcnt(0)
    s_barrier
    s_cmp_lg_u32 s14, 0
    s_cbranch_scc1 GF_113
    v_mov_b32 v7, 1
    v_mov_b32 v8, 0
    s_mov_b64 exec, 1
    buffer_store_dword v7, v8, s[4:7], s27 offen sc1
    s_mov_b64 exec, -1
GF_113:
    s_add_u32 s25, s25, 0x10000
    s_add_u32 s30, s30, 0x10000
    s_add_u32 s26, s26, 0x20000
    s_add_u32 s27, s27, 256
    s_add_u32 s28, s28, 512
    s_add_u32 s24, s24, 1
    s_cmp_lt_u32 s24, 32
    s_cbranch_scc1 MKT_LOOP
    s_cmp_ge_u32 s88, 60
    s_cbranch_scc1 M_EXIT
    s_branch H_EXTRA
G_N:
    s_lshl_b32 s65, s13, 8
    s_lshl_b32 s66, s14, 6
    s_add_u32 s20, s65, s66
    s_mul_i32 s21, s14, 36864
    v_lshrrev_b32 v6, 2, v0
    v_mul_u32_u24 v5, 8192, v6
    v_lshrrev_b32 v6, 5, v0
    v_lshlrev_b32 v6, 1, v6
    v_and_b32 v7, 3, v0
    v_xor_b32 v6, v6, v7
    v_lshl_add_u32 v5, v6, 4, v5
    v_lshrrev_b32 v6, 5, v0
    v_lshlrev_b32 v3, 10, v6
    v_bfe_u32 v6, v0, 2, 2
    v_lshl_add_u32 v3, v6, 6, v3
    v_and_b32 v6, 3, v0
    v_lshl_add_u32 v3, v6, 3, v3
    v_bfe_u32 v6, v0, 4, 1
    v_lshl_add_u32 v3, v6, 9, v3
    v_add_u32 v3, s21, v3
    v_lshlrev_b32 v6, 5, v6
    v_sub_u32 v4, 32, v6
    v_add_u32 v4, v4, v3
    v_add_u32 v3, v3, v6
    s_add_u32 m0, s21, 0
    s_add_u32 s64, s20, 0x0
    buffer_load_dwordx4 v5, s[44:47], s64 offen lds
    s_add_u32 m0, s21, 1024
    s_add_u32 s64, s20, 0x20000
    buffer_load_dwordx4 v5, s[44:47], s64 offen lds
    s_add_u32 m0, s21, 2048
    s_add_u32 s64, s20, 0x40000
    buffer_load_dwordx4 v5, s[44:47], s64 offen lds
    s_add_u32 m0, s21, 3072
    s_add_u32 s64, s20, 0x60000
    buffer_load_dwordx4 v5, s[44:47], s64 offen lds
    s_add_u32 m0, s21, 4096
    s_add_u32 s64, s20, 0x80000
    buffer_load_dwordx4 v5, s[44:47], s64 offen lds
    s_add_u32 m0, s21, 5120
    s_add_u32 s64, s20, 0xa0000
    buffer_load_dwordx4 v5, s[44:47], s64 offen lds
    s_add_u32 m0, s21, 6144
    s_add_u32 s64, s20, 0xc0000
    buffer_load_dwordx4 v5, s[44:47], s64 offen lds
    s_add_u32 m0, s21, 7168
    s_add_u32 s64, s20, 0xe0000
    buffer_load_dwordx4 v5, s[44:47], s64 offen lds
    s_add_u32 m0, s21, 8192
    s_add_u32 s64, s20, 0x100000
    buffer_load_dwordx4 v5, s[44:47], s64 offen lds
    s_add_u32 m0, s21, 9216
    s_add_u32 s64, s20, 0x120000
    buffer_load_dwordx4 v5, s[44:47], s64 offen lds
    s_add_u32 m0, s21, 10240
    s_add_u32 s64, s20, 0x140000
    buffer_load_dwordx4 v5, s[44:47], s64 offen lds
    s_add_u32 m0, s21, 11264
    s_add_u32 s64, s20, 0x160000
    buffer_load_dwordx4 v5, s[44:47], s64 offen lds
    s_add_u32 m0, s21, 12288
    s_add_u32 s64, s20, 0x180000
    buffer_load_dwordx4 v5, s[44:47], s64 offen lds
    s_add_u32 m0, s21, 13312
    s_add_u32 s64, s20, 0x1a0000
    buffer_load_dwordx4 v5, s[44:47], s64 offen lds
    s_add_u32 m0, s21, 14336
    s_add_u32 s64, s20, 0x1c0000
    buffer_load_dwordx4 v5, s[44:47], s64 offen lds
    s_add_u32 m0, s21, 15360
    s_add_u32 s64, s20, 0x1e0000
    buffer_load_dwordx4 v5, s[44:47], s64 offen lds
    s_add_u32 m0, s21, 16384
    s_add_u32 s64, s20, 0x200000
    buffer_load_dwordx4 v5, s[44:47], s64 offen lds
    s_add_u32 m0, s21, 17408
    s_add_u32 s64, s20, 0x220000
    buffer_load_dwordx4 v5, s[44:47], s64 offen lds
    s_add_u32 m0, s21, 18432
    s_add_u32 s64, s20, 0x240000
    buffer_load_dwordx4 v5, s[44:47], s64 offen lds
    s_add_u32 m0, s21, 19456
    s_add_u32 s64, s20, 0x260000
    buffer_load_dwordx4 v5, s[44:47], s64 offen lds
    s_add_u32 m0, s21, 20480
    s_add_u32 s64, s20, 0x280000
    buffer_load_dwordx4 v5, s[44:47], s64 offen lds
    s_add_u32 m0, s21, 21504
    s_add_u32 s64, s20, 0x2a0000
    buffer_load_dwordx4 v5, s[44:47], s64 offen lds
    s_add_u32 m0, s21, 22528
    s_add_u32 s64, s20, 0x2c0000
    buffer_load_dwordx4 v5, s[44:47], s64 offen lds
    s_add_u32 m0, s21, 23552
    s_add_u32 s64, s20, 0x2e0000
    buffer_load_dwordx4 v5, s[44:47], s64 offen lds
    s_add_u32 m0, s21, 24576
    s_add_u32 s64, s20, 0x300000
    buffer_load_dwordx4 v5, s[44:47], s64 offen lds
    s_add_u32 m0, s21, 25600
    s_add_u32 s64, s20, 0x320000
    buffer_load_dwordx4 v5, s[44:47], s64 offen lds
    s_add_u32 m0, s21, 26624
    s_add_u32 s64, s20, 0x340000
    buffer_load_dwordx4 v5, s[44:47], s64 offen lds
    s_add_u32 m0, s21, 27648
    s_add_u32 s64, s20, 0x360000
    buffer_load_dwordx4 v5, s[44:47], s64 offen lds
    s_add_u32 m0, s21, 28672
    s_add_u32 s64, s20, 0x380000
    buffer_load_dwordx4 v5, s[44:47], s64 offen lds
    s_add_u32 m0, s21, 29696
    s_add_u32 s64, s20, 0x3a0000
    buffer_load_dwordx4 v5, s[44:47], s64 offen lds
    s_add_u32 m0, s21, 30720
    s_add_u32 s64, s20, 0x3c0000
    buffer_load_dwordx4 v5, s[44:47], s64 offen lds
    s_add_u32 m0, s21, 31744
    s_add_u32 s64, s20, 0x3e0000
    buffer_load_dwordx4 v5, s[44:47], s64 offen lds
    s_add_u32 m0, s21, 32768
    s_add_u32 s64, s20, 0x400000
    buffer_load_dwordx4 v5, s[44:47], s64 offen lds
    s_add_u32 m0, s21, 33792
    s_add_u32 s64, s20, 0x420000
    buffer_load_dwordx4 v5, s[44:47], s64 offen lds
    s_add_u32 m0, s21, 34816
    s_add_u32 s64, s20, 0x440000
    buffer_load_dwordx4 v5, s[44:47], s64 offen lds
    s_add_u32 m0, s21, 35840
    s_add_u32 s64, s20, 0x460000
    buffer_load_dwordx4 v5, s[44:47], s64 offen lds
    s_waitcnt vmcnt(32)
    ds_read_b64_tr_b16 v[96:97], v3 offset:0
    ds_read_b64_tr_b16 v[98:99], v3 offset:256
    ds_read_b64_tr_b16 v[100:101], v4 offset:0
    ds_read_b64_tr_b16 v[102:103], v4 offset:256
    ds_read_b64_tr_b16 v[104:105], v3 offset:2048
    ds_read_b64_tr_b16 v[106:107], v3 offset:2304
    ds_read_b64_tr_b16 v[108:109], v4 offset:2048
    ds_read_b64_tr_b16 v[110:111], v4 offset:2304
    s_waitcnt lgkmcnt(0)
    s_add_u32 m0, s21, 0
    s_add_u32 s64, s20, 0x480000
    buffer_load_dwordx4 v5, s[44:47], s64 offen lds
    s_add_u32 m0, s21, 1024
    s_add_u32 s64, s20, 0x4a0000
    buffer_load_dwordx4 v5, s[44:47], s64 offen lds
    s_add_u32 m0, s21, 2048
    s_add_u32 s64, s20, 0x4c0000
    buffer_load_dwordx4 v5, s[44:47], s64 offen lds
    s_add_u32 m0, s21, 3072
    s_add_u32 s64, s20, 0x4e0000
    buffer_load_dwordx4 v5, s[44:47], s64 offen lds
    s_waitcnt vmcnt(32)
    ds_read_b64_tr_b16 v[112:113], v3 offset:4096
    ds_read_b64_tr_b16 v[114:115], v3 offset:4352
    ds_read_b64_tr_b16 v[116:117], v4 offset:4096
    ds_read_b64_tr_b16 v[118:119], v4 offset:4352
    ds_read_b64_tr_b16 v[120:121], v3 offset:6144
    ds_read_b64_tr_b16 v[122:123], v3 offset:6400
    ds_read_b64_tr_b16 v[124:125], v4 offset:6144
    ds_read_b64_tr_b16 v[126:127], v4 offset:6400
    s_waitcnt lgkmcnt(0)
    s_waitcnt vmcnt(28)
    ds_read_b64_tr_b16 v[128:129], v3 offset:8192
    ds_read_b64_tr_b16 v[130:131], v3 offset:8448
    ds_read_b64_tr_b16 v[132:133], v4 offset:8192
    ds_read_b64_tr_b16 v[134:135], v4 offset:8448
    ds_read_b64_tr_b16 v[136:137], v3 offset:10240
    ds_read_b64_tr_b16 v[138:139], v3 offset:10496
    ds_read_b64_tr_b16 v[140:141], v4 offset:10240
    ds_read_b64_tr_b16 v[142:143], v4 offset:10496
    s_waitcnt lgkmcnt(0)
    s_waitcnt vmcnt(24)
    ds_read_b64_tr_b16 v[144:145], v3 offset:12288
    ds_read_b64_tr_b16 v[146:147], v3 offset:12544
    ds_read_b64_tr_b16 v[148:149], v4 offset:12288
    ds_read_b64_tr_b16 v[150:151], v4 offset:12544
    ds_read_b64_tr_b16 v[152:153], v3 offset:14336
    ds_read_b64_tr_b16 v[154:155], v3 offset:14592
    ds_read_b64_tr_b16 v[156:157], v4 offset:14336
    ds_read_b64_tr_b16 v[158:159], v4 offset:14592
    s_waitcnt lgkmcnt(0)
    s_waitcnt vmcnt(20)
    ds_read_b64_tr_b16 v[160:161], v3 offset:16384
    ds_read_b64_tr_b16 v[162:163], v3 offset:16640
    ds_read_b64_tr_b16 v[164:165], v4 offset:16384
    ds_read_b64_tr_b16 v[166:167], v4 offset:16640
    ds_read_b64_tr_b16 v[168:169], v3 offset:18432
    ds_read_b64_tr_b16 v[170:171], v3 offset:18688
    ds_read_b64_tr_b16 v[172:173], v4 offset:18432
    ds_read_b64_tr_b16 v[174:175], v4 offset:18688
    s_waitcnt lgkmcnt(0)
    s_waitcnt vmcnt(16)
    ds_read_b64_tr_b16 v[176:177], v3 offset:20480
    ds_read_b64_tr_b16 v[178:179], v3 offset:20736
    ds_read_b64_tr_b16 v[180:181], v4 offset:20480
    ds_read_b64_tr_b16 v[182:183], v4 offset:20736
    ds_read_b64_tr_b16 v[184:185], v3 offset:22528
    ds_read_b64_tr_b16 v[186:187], v3 offset:22784
    ds_read_b64_tr_b16 v[188:189], v4 offset:22528
    ds_read_b64_tr_b16 v[190:191], v4 offset:22784
    s_waitcnt lgkmcnt(0)
    s_waitcnt vmcnt(12)
    ds_read_b64_tr_b16 v[192:193], v3 offset:24576
    ds_read_b64_tr_b16 v[194:195], v3 offset:24832
    ds_read_b64_tr_b16 v[196:197], v4 offset:24576
    ds_read_b64_tr_b16 v[198:199], v4 offset:24832
    ds_read_b64_tr_b16 v[200:201], v3 offset:26624
    ds_read_b64_tr_b16 v[202:203], v3 offset:26880
    ds_read_b64_tr_b16 v[204:205], v4 offset:26624
    ds_read_b64_tr_b16 v[206:207], v4 offset:26880
    s_waitcnt lgkmcnt(0)
    s_waitcnt vmcnt(8)
    ds_read_b64_tr_b16 v[208:209], v3 offset:28672
    ds_read_b64_tr_b16 v[210:211], v3 offset:28928
    ds_read_b64_tr_b16 v[212:213], v4 offset:28672
    ds_read_b64_tr_b16 v[214:215], v4 offset:28928
    ds_read_b64_tr_b16 v[216:217], v3 offset:30720
    ds_read_b64_tr_b16 v[218:219], v3 offset:30976
    ds_read_b64_tr_b16 v[220:221], v4 offset:30720
    ds_read_b64_tr_b16 v[222:223], v4 offset:30976
    s_waitcnt lgkmcnt(0)
    s_waitcnt vmcnt(4)
    ds_read_b64_tr_b16 v[224:225], v3 offset:32768
    ds_read_b64_tr_b16 v[226:227], v3 offset:33024
    ds_read_b64_tr_b16 v[228:229], v4 offset:32768
    ds_read_b64_tr_b16 v[230:231], v4 offset:33024
    ds_read_b64_tr_b16 v[232:233], v3 offset:34816
    ds_read_b64_tr_b16 v[234:235], v3 offset:35072
    ds_read_b64_tr_b16 v[236:237], v4 offset:34816
    ds_read_b64_tr_b16 v[238:239], v4 offset:35072
    s_waitcnt lgkmcnt(0)
    s_waitcnt vmcnt(0)
    ds_read_b64_tr_b16 v[240:241], v3 offset:0
    ds_read_b64_tr_b16 v[242:243], v3 offset:256
    ds_read_b64_tr_b16 v[244:245], v4 offset:0
    ds_read_b64_tr_b16 v[246:247], v4 offset:256
    ds_read_b64_tr_b16 v[248:249], v3 offset:2048
    ds_read_b64_tr_b16 v[250:251], v3 offset:2304
    ds_read_b64_tr_b16 v[252:253], v4 offset:2048
    ds_read_b64_tr_b16 v[254:255], v4 offset:2304
    s_waitcnt lgkmcnt(0)
    s_cmp_lg_u32 s97, 0
    s_cbranch_scc1 CM_114
    v_mbcnt_lo_u32_b32 v0, -1, 0
    v_mbcnt_hi_u32_b32 v0, -1, v0
    v_mul_u32_u24 v8, 32, v0
    s_mov_b32 s64, 0x0
    s_mov_b32 s65, 0
    s_mov_b64 exec, 0xff
TK_115:
    buffer_load_dword v9, v8, s[60:63], s64 offen sc1
    s_add_u32 s65, s65, 1
    s_waitcnt vmcnt(0)
    s_mov_b32 s66, 0
    v_readlane_b32 s67, v9, 0
    s_add_u32 s66, s66, s67
    v_readlane_b32 s67, v9, 1
    s_add_u32 s66, s66, s67
    v_readlane_b32 s67, v9, 2
    s_add_u32 s66, s66, s67
    v_readlane_b32 s67, v9, 3
    s_add_u32 s66, s66, s67
    v_readlane_b32 s67, v9, 4
    s_add_u32 s66, s66, s67
    v_readlane_b32 s67, v9, 5
    s_add_u32 s66, s66, s67
    v_readlane_b32 s67, v9, 6
    s_add_u32 s66, s66, s67
    v_readlane_b32 s67, v9, 7
    s_add_u32 s66, s66, s67
    s_cmp_ge_u32 s66, 256
    s_cbranch_scc1 TKD_116
    s_cmp_gt_u32 s65, 262144
    s_cbranch_scc0 TK_115
TKD_116:
    v_cmp_ne_u32 vcc, 32, v9
    s_mov_b64 exec, -1
    s_cbranch_vccnz M_SLOW
CM_114:
    s_mov_b32 s65, 0
GI_117:
    buffer_load_dword v8, off, s[60:63], s95 sc1
    s_add_u32 s65, s65, 1
    s_waitcnt vmcnt(0)
    v_readfirstlane_b32 s64, v8
    s_cmp_ge_u32 s64, 192
    s_cbranch_scc1 GID_118
    s_cmp_gt_u32 s65, 65536
    s_cbranch_scc1 GID_118
    s_sleep 4
    s_branch GI_117
GID_118:
    v_mbcnt_lo_u32_b32 v0, -1, 0
    v_mbcnt_hi_u32_b32 v0, -1, v0
    v_lshlrev_b32 v1, 4, v0
    v_lshrrev_b32 v6, 3, v0
    v_mul_u32_u24 v2, 1280, v6
    v_and_b32 v7, 7, v0
    v_xor_b32 v7, v7, v6
    v_lshl_add_u32 v2, v7, 4, v2
    v_bfe_u32 v6, v0, 3, 1
    v_lshlrev_b32 v9, 10, v6
    v_and_b32 v6, 7, v0
    v_lshl_add_u32 v9, v6, 7, v9
    v_lshrrev_b32 v7, 4, v0
    v_xor_b32 v7, v7, v6
    v_lshl_add_u32 v3, v7, 4, v9
    v_xor_b32 v7, 4, v7
    v_lshl_add_u32 v4, v7, 4, v9
    v_add_u32 v6, 0x10000, v3
    v_add_u32 v9, 0x10000, v4
    s_barrier
    s_mul_i32 s20, s12, 163840
    s_mul_i32 s64, s14, 40960
    s_add_u32 s20, s20, s64
    s_add_u32 s20, s20, 0x0
    s_lshl_b32 s21, s14, 12
    s_add_u32 m0, s21, 0
    s_add_u32 s64, s20, 0x0
    buffer_load_dwordx4 v2, s[4:7], s64 offen lds
    s_add_u32 m0, s21, 1024
    s_add_u32 s64, s20, 0x2800
    buffer_load_dwordx4 v2, s[4:7], s64 offen lds
    s_add_u32 m0, s21, 2048
    s_add_u32 s64, s20, 0x5000
    buffer_load_dwordx4 v2, s[4:7], s64 offen lds
    s_add_u32 m0, s21, 3072
    s_add_u32 s64, s20, 0x7800
    buffer_load_dwordx4 v2, s[4:7], s64 offen lds
    s_add_u32 m0, s21, 16384
    s_add_u32 s64, s20, 0x80
    buffer_load_dwordx4 v2, s[4:7], s64 offen lds
    s_add_u32 m0, s21, 17408
    s_add_u32 s64, s20, 0x2880
    buffer_load_dwordx4 v2, s[4:7], s64 offen lds
    s_add_u32 m0, s21, 18432
    s_add_u32 s64, s20, 0x5080
    buffer_load_dwordx4 v2, s[4:7], s64 offen lds
    s_add_u32 m0, s21, 19456
    s_add_u32 s64, s20, 0x7880
    buffer_load_dwordx4 v2, s[4:7], s64 offen lds
    s_add_u32 m0, s21, 32768
    s_add_u32 s64, s20, 0x100
    buffer_load_dwordx4 v2, s[4:7], s64 offen lds
    s_add_u32 m0, s21, 33792
    s_add_u32 s64, s20, 0x2900
    buffer_load_dwordx4 v2, s[4:7], s64 offen lds
    s_add_u32 m0, s21, 34816
    s_add_u32 s64, s20, 0x5100
    buffer_load_dwordx4 v2, s[4:7], s64 offen lds
    s_add_u32 m0, s21, 35840
    s_add_u32 s64, s20, 0x7900
    buffer_load_dwordx4 v2, s[4:7], s64 offen lds
    s_add_u32 m0, s21, 49152
    s_add_u32 s64, s20, 0x180
    buffer_load_dwordx4 v2, s[4:7], s64 offen lds
    s_add_u32 m0, s21, 50176
    s_add_u32 s64, s20, 0x2980
    buffer_load_dwordx4 v2, s[4:7], s64 offen lds
    s_add_u32 m0, s21, 51200
    s_add_u32 s64, s20, 0x5180
    buffer_load_dwordx4 v2, s[4:7], s64 offen lds
    s_add_u32 m0, s21, 52224
    s_add_u32 s64, s20, 0x7980
    buffer_load_dwordx4 v2, s[4:7], s64 offen lds
    s_mov_b32 s64, 0x40000000
    buffer_store_dword v7, v1, s[4:7], s64 offen
    buffer_store_dword v7, v1, s[4:7], s64 offen
    buffer_store_dword v7, v1, s[4:7], s64 offen
    buffer_store_dword v7, v1, s[4:7], s64 offen
    buffer_store_dword v7, v1, s[4:7], s64 offen
    buffer_store_dword v7, v1, s[4:7], s64 offen
    buffer_store_dword v7, v1, s[4:7], s64 offen
    buffer_store_dword v7, v1, s[4:7], s64 offen
    s_waitcnt vmcnt(20)
    s_barrier
    ds_read_b128 a[0:3], v3 offset:0
    ds_read_b128 a[4:7], v3 offset:2048
    ds_read_b128 a[8:11], v3 offset:4096
    ds_read_b128 a[12:15], v3 offset:6144
    ds_read_b128 a[16:19], v3 offset:8192
    ds_read_b128 a[20:23], v3 offset:10240
    ds_read_b128 a[24:27], v3 offset:12288
    ds_read_b128 a[28:31], v3 offset:14336
    s_mov_b32 s19, 0
    s_mov_b32 s22, s16
    s_mov_b32 s23, 0x40000000
G_N_LOOP:
    s_waitcnt lgkmcnt(4)
    v_mfma_f32_16x16x32_bf16 v[16:19], a[0:3], v[96:99], 0
    v_mfma_f32_16x16x32_bf16 v[20:23], a[0:3], v[100:103], 0
    ds_read_b128 a[32:35], v4 offset:0
    v_mfma_f32_16x16x32_bf16 v[24:27], a[4:7], v[96:99], 0
    v_mfma_f32_16x16x32_bf16 v[28:31], a[4:7], v[100:103], 0
    ds_read_b128 a[36:39], v4 offset:2048
    v_mfma_f32_16x16x32_bf16 v[32:35], a[8:11], v[96:99], 0
    v_mfma_f32_16x16x32_bf16 v[36:39], a[8:11], v[100:103], 0
    ds_read_b128 a[40:43], v4 offset:4096
    v_mfma_f32_16x16x32_bf16 v[40:43], a[12:15], v[96:99], 0
    v_mfma_f32_16x16x32_bf16 v[44:47], a[12:15], v[100:103], 0
    ds_read_b128 a[44:47], v4 offset:6144
    s_waitcnt lgkmcnt(4)
    v_mfma_f32_16x16x32_bf16 v[48:51], a[16:19], v[96:99], 0
    v_mfma_f32_16x16x32_bf16 v[52:55], a[16:19], v[100:103], 0
    ds_read_b128 a[48:51], v4 offset:8192
    v_mfma_f32_16x16x32_bf16 v[56:59], a[20:23], v[96:99], 0
    v_mfma_f32_16x16x32_bf16 v[60:63], a[20:23], v[100:103], 0
    ds_read_b128 a[52:55], v4 offset:10240
    v_mfma_f32_16x16x32_bf16 v[64:67], a[24:27], v[96:99], 0
    v_mfma_f32_16x16x32_bf16 v[68:71], a[24:27], v[100:103], 0
    ds_read_b128 a[56:59], v4 offset:12288
    v_mfma_f32_16x16x32_bf16 v[72:75], a[28:31], v[96:99], 0
    v_mfma_f32_16x16x32_bf16 v[76:79], a[28:31], v[100:103], 0
    ds_read_b128 a[60:63], v4 offset:14336
    s_waitcnt vmcnt(16)
    s_barrier
    s_waitcnt lgkmcnt(4)
    v_mfma_f32_16x16x32_bf16 v[16:19], a[32:35], v[104:107], v[16:19]
    v_mfma_f32_16x16x32_bf16 v[20:23], a[32:35], v[108:111], v[20:23]
    ds_read_b128 a[0:3], v3 offset:16384
    s_add_u32 m0, s21, 65536
    v_mfma_f32_16x16x32_bf16 v[24:27], a[36:39], v[104:107], v[24:27]
    v_mfma_f32_16x16x32_bf16 v[28:31], a[36:39], v[108:111], v[28:31]
    ds_read_b128 a[4:7], v3 offset:18432
    s_add_u32 s64, s20, 0x200
    buffer_load_dwordx4 v2, s[4:7], s64 offen lds
    v_mfma_f32_16x16x32_bf16 v[32:35], a[40:43], v[104:107], v[32:35]
    v_mfma_f32_16x16x32_bf16 v[36:39], a[40:43], v[108:111], v[36:39]
    ds_read_b128 a[8:11], v3 offset:20480
    s_add_u32 m0, s21, 66560
    v_mfma_f32_16x16x32_bf16 v[40:43], a[44:47], v[104:107], v[40:43]
    v_mfma_f32_16x16x32_bf16 v[44:47], a[44:47], v[108:111], v[44:47]
    ds_read_b128 a[12:15], v3 offset:22528
    s_add_u32 s64, s20, 0x2a00
    buffer_load_dwordx4 v2, s[4:7], s64 offen lds
    s_waitcnt lgkmcnt(4)
    v_mfma_f32_16x16x32_bf16 v[48:51], a[48:51], v[104:107], v[48:51]
    v_mfma_f32_16x16x32_bf16 v[52:55], a[48:51], v[108:111], v[52:55]
    ds_read_b128 a[16:19], v3 offset:24576
    s_add_u32 m0, s21, 67584
    v_mfma_f32_16x16x32_bf16 v[56:59], a[52:55], v[104:107], v[56:59]
    v_mfma_f32_16x16x32_bf16 v[60:63], a[52:55], v[108:111], v[60:63]
    ds_read_b128 a[20:23], v3 offset:26624
    s_add_u32 s64, s20, 0x5200
    buffer_load_dwordx4 v2, s[4:7], s64 offen lds
    v_mfma_f32_16x16x32_bf16 v[64:67], a[56:59], v[104:107], v[64:67]
    v_mfma_f32_16x16x32_bf16 v[68:71], a[56:59], v[108:111], v[68:71]
    ds_read_b128 a[24:27], v3 offset:28672
    s_add_u32 m0, s21, 68608
    v_mfma_f32_16x16x32_bf16 v[72:75], a[60:63], v[104:107], v[72:75]
    v_mfma_f32_16x16x32_bf16 v[76:79], a[60:63], v[108:111], v[76:79]
    ds_read_b128 a[28:31], v3 offset:30720
    s_add_u32 s64, s20, 0x7a00
    buffer_load_dwordx4 v2, s[4:7], s64 offen lds
    s_waitcnt lgkmcnt(4)
    v_mfma_f32_16x16x32_bf16 v[16:19], a[0:3], v[112:115], v[16:19]
    v_mfma_f32_16x16x32_bf16 v[20:23], a[0:3], v[116:119], v[20:23]
    ds_read_b128 a[32:35], v4 offset:16384
    v_mfma_f32_16x16x32_bf16 v[24:27], a[4:7], v[112:115], v[24:27]
    v_mfma_f32_16x16x32_bf16 v[28:31], a[4:7], v[116:119], v[28:31]
    ds_read_b128 a[36:39], v4 offset:18432
    v_mfma_f32_16x16x32_bf16 v[32:35], a[8:11], v[112:115], v[32:35]
    v_mfma_f32_16x16x32_bf16 v[36:39], a[8:11], v[116:119], v[36:39]
    ds_read_b128 a[40:43], v4 offset:20480
    v_mfma_f32_16x16x32_bf16 v[40:43], a[12:15], v[112:115], v[40:43]
    v_mfma_f32_16x16x32_bf16 v[44:47], a[12:15], v[116:119], v[44:47]
    ds_read_b128 a[44:47], v4 offset:22528
    s_waitcnt lgkmcnt(4)
    v_mfma_f32_16x16x32_bf16 v[48:51], a[16:19], v[112:115], v[48:51]
    v_mfma_f32_16x16x32_bf16 v[52:55], a[16:19], v[116:119], v[52:55]
    ds_read_b128 a[48:51], v4 offset:24576
    v_mfma_f32_16x16x32_bf16 v[56:59], a[20:23], v[112:115], v[56:59]
    v_mfma_f32_16x16x32_bf16 v[60:63], a[20:23], v[116:119], v[60:63]
    ds_read_b128 a[52:55], v4 offset:26624
    v_mfma_f32_16x16x32_bf16 v[64:67], a[24:27], v[112:115], v[64:67]
    v_mfma_f32_16x16x32_bf16 v[68:71], a[24:27], v[116:119], v[68:71]
    ds_read_b128 a[56:59], v4 offset:28672
    v_mfma_f32_16x16x32_bf16 v[72:75], a[28:31], v[112:115], v[72:75]
    v_mfma_f32_16x16x32_bf16 v[76:79], a[28:31], v[116:119], v[76:79]
    ds_read_b128 a[60:63], v4 offset:30720
    s_waitcnt vmcnt(16)
    s_barrier
    s_waitcnt lgkmcnt(4)
    v_mfma_f32_16x16x32_bf16 v[16:19], a[32:35], v[120:123], v[16:19]
    v_mfma_f32_16x16x32_bf16 v[20:23], a[32:35], v[124:127], v[20:23]
    ds_read_b128 a[0:3], v3 offset:32768
    s_add_u32 m0, s21, 0
    v_mfma_f32_16x16x32_bf16 v[24:27], a[36:39], v[120:123], v[24:27]
    v_mfma_f32_16x16x32_bf16 v[28:31], a[36:39], v[124:127], v[28:31]
    ds_read_b128 a[4:7], v3 offset:34816
    s_add_u32 s64, s20, 0x280
    buffer_load_dwordx4 v2, s[4:7], s64 offen lds
    v_mfma_f32_16x16x32_bf16 v[32:35], a[40:43], v[120:123], v[32:35]
    v_mfma_f32_16x16x32_bf16 v[36:39], a[40:43], v[124:127], v[36:39]
    ds_read_b128 a[8:11], v3 offset:36864
    s_add_u32 m0, s21, 1024
    v_mfma_f32_16x16x32_bf16 v[40:43], a[44:47], v[120:123], v[40:43]
    v_mfma_f32_16x16x32_bf16 v[44:47], a[44:47], v[124:127], v[44:47]
    ds_read_b128 a[12:15], v3 offset:38912
    s_add_u32 s64, s20, 0x2a80
    buffer_load_dwordx4 v2, s[4:7], s64 offen lds
    s_waitcnt lgkmcnt(4)
    v_mfma_f32_16x16x32_bf16 v[48:51], a[48:51], v[120:123], v[48:51]
    v_mfma_f32_16x16x32_bf16 v[52:55], a[48:51], v[124:127], v[52:55]
    ds_read_b128 a[16:19], v3 offset:40960
    s_add_u32 m0, s21, 2048
    v_mfma_f32_16x16x32_bf16 v[56:59], a[52:55], v[120:123], v[56:59]
    v_mfma_f32_16x16x32_bf16 v[60:63], a[52:55], v[124:127], v[60:63]
    ds_read_b128 a[20:23], v3 offset:43008
    s_add_u32 s64, s20, 0x5280
    buffer_load_dwordx4 v2, s[4:7], s64 offen lds
    v_mfma_f32_16x16x32_bf16 v[64:67], a[56:59], v[120:123], v[64:67]
    v_mfma_f32_16x16x32_bf16 v[68:71], a[56:59], v[124:127], v[68:71]
    ds_read_b128 a[24:27], v3 offset:45056
    s_add_u32 m0, s21, 3072
    v_mfma_f32_16x16x32_bf16 v[72:75], a[60:63], v[120:123], v[72:75]
    v_mfma_f32_16x16x32_bf16 v[76:79], a[60:63], v[124:127], v[76:79]
    ds_read_b128 a[28:31], v3 offset:47104
    s_add_u32 s64, s20, 0x7a80
    buffer_load_dwordx4 v2, s[4:7], s64 offen lds
    s_waitcnt lgkmcnt(4)
    v_mfma_f32_16x16x32_bf16 v[16:19], a[0:3], v[128:131], v[16:19]
    v_mfma_f32_16x16x32_bf16 v[20:23], a[0:3], v[132:135], v[20:23]
    ds_read_b128 a[32:35], v4 offset:32768
    v_mfma_f32_16x16x32_bf16 v[24:27], a[4:7], v[128:131], v[24:27]
    v_mfma_f32_16x16x32_bf16 v[28:31], a[4:7], v[132:135], v[28:31]
    ds_read_b128 a[36:39], v4 offset:34816
    v_mfma_f32_16x16x32_bf16 v[32:35], a[8:11], v[128:131], v[32:35]
    v_mfma_f32_16x16x32_bf16 v[36:39], a[8:11], v[132:135], v[36:39]
    ds_read_b128 a[40:43], v4 offset:36864
    v_mfma_f32_16x16x32_bf16 v[40:43], a[12:15], v[128:131], v[40:43]
    v_mfma_f32_16x16x32_bf16 v[44:47], a[12:15], v[132:135], v[44:47]
    ds_read_b128 a[44:47], v4 offset:38912
    s_waitcnt lgkmcnt(4)
    v_mfma_f32_16x16x32_bf16 v[48:51], a[16:19], v[128:131], v[48:51]
    v_mfma_f32_16x16x32_bf16 v[52:55], a[16:19], v[132:135], v[52:55]
    ds_read_b128 a[48:51], v4 offset:40960
    v_mfma_f32_16x16x32_bf16 v[56:59], a[20:23], v[128:131], v[56:59]
    v_mfma_f32_16x16x32_bf16 v[60:63], a[20:23], v[132:135], v[60:63]
    ds_read_b128 a[52:55], v4 offset:43008
    v_mfma_f32_16x16x32_bf16 v[64:67], a[24:27], v[128:131], v[64:67]
    v_mfma_f32_16x16x32_bf16 v[68:71], a[24:27], v[132:135], v[68:71]
    ds_read_b128 a[56:59], v4 offset:45056
    v_mfma_f32_16x16x32_bf16 v[72:75], a[28:31], v[128:131], v[72:75]
    v_mfma_f32_16x16x32_bf16 v[76:79], a[28:31], v[132:135], v[76:79]
    ds_read_b128 a[60:63], v4 offset:47104
    s_waitcnt vmcnt(16)
    s_barrier
    s_waitcnt lgkmcnt(4)
    v_mfma_f32_16x16x32_bf16 v[16:19], a[32:35], v[136:139], v[16:19]
    v_mfma_f32_16x16x32_bf16 v[20:23], a[32:35], v[140:143], v[20:23]
    ds_read_b128 a[0:3], v3 offset:49152
    s_add_u32 m0, s21, 16384
    v_mfma_f32_16x16x32_bf16 v[24:27], a[36:39], v[136:139], v[24:27]
    v_mfma_f32_16x16x32_bf16 v[28:31], a[36:39], v[140:143], v[28:31]
    ds_read_b128 a[4:7], v3 offset:51200
    s_add_u32 s64, s20, 0x300
    buffer_load_dwordx4 v2, s[4:7], s64 offen lds
    v_mfma_f32_16x16x32_bf16 v[32:35], a[40:43], v[136:139], v[32:35]
    v_mfma_f32_16x16x32_bf16 v[36:39], a[40:43], v[140:143], v[36:39]
    ds_read_b128 a[8:11], v3 offset:53248
    s_add_u32 m0, s21, 17408
    v_mfma_f32_16x16x32_bf16 v[40:43], a[44:47], v[136:139], v[40:43]
    v_mfma_f32_16x16x32_bf16 v[44:47], a[44:47], v[140:143], v[44:47]
    ds_read_b128 a[12:15], v3 offset:55296
    s_add_u32 s64, s20, 0x2b00
    buffer_load_dwordx4 v2, s[4:7], s64 offen lds
    s_waitcnt lgkmcnt(4)
    v_mfma_f32_16x16x32_bf16 v[48:51], a[48:51], v[136:139], v[48:51]
    v_mfma_f32_16x16x32_bf16 v[52:55], a[48:51], v[140:143], v[52:55]
    ds_read_b128 a[16:19], v3 offset:57344
    s_add_u32 m0, s21, 18432
    v_mfma_f32_16x16x32_bf16 v[56:59], a[52:55], v[136:139], v[56:59]
    v_mfma_f32_16x16x32_bf16 v[60:63], a[52:55], v[140:143], v[60:63]
    ds_read_b128 a[20:23], v3 offset:59392
    s_add_u32 s64, s20, 0x5300
    buffer_load_dwordx4 v2, s[4:7], s64 offen lds
    v_mfma_f32_16x16x32_bf16 v[64:67], a[56:59], v[136:139], v[64:67]
    v_mfma_f32_16x16x32_bf16 v[68:71], a[56:59], v[140:143], v[68:71]
    ds_read_b128 a[24:27], v3 offset:61440
    s_add_u32 m0, s21, 19456
    v_mfma_f32_16x16x32_bf16 v[72:75], a[60:63], v[136:139], v[72:75]
    v_mfma_f32_16x16x32_bf16 v[76:79], a[60:63], v[140:143], v[76:79]
    ds_read_b128 a[28:31], v3 offset:63488
    s_add_u32 s64, s20, 0x7b00
    buffer_load_dwordx4 v2, s[4:7], s64 offen lds
    s_waitcnt lgkmcnt(4)
    v_mfma_f32_16x16x32_bf16 v[16:19], a[0:3], v[144:147], v[16:19]
    v_mfma_f32_16x16x32_bf16 v[20:23], a[0:3], v[148:151], v[20:23]
    ds_read_b128 a[32:35], v4 offset:49152
    v_mfma_f32_16x16x32_bf16 v[24:27], a[4:7], v[144:147], v[24:27]
    v_mfma_f32_16x16x32_bf16 v[28:31], a[4:7], v[148:151], v[28:31]
    ds_read_b128 a[36:39], v4 offset:51200
    v_mfma_f32_16x16x32_bf16 v[32:35], a[8:11], v[144:147], v[32:35]
    v_mfma_f32_16x16x32_bf16 v[36:39], a[8:11], v[148:151], v[36:39]
    ds_read_b128 a[40:43], v4 offset:53248
    v_mfma_f32_16x16x32_bf16 v[40:43], a[12:15], v[144:147], v[40:43]
    v_mfma_f32_16x16x32_bf16 v[44:47], a[12:15], v[148:151], v[44:47]
    ds_read_b128 a[44:47], v4 offset:55296
    s_waitcnt lgkmcnt(4)
    v_mfma_f32_16x16x32_bf16 v[48:51], a[16:19], v[144:147], v[48:51]
    v_mfma_f32_16x16x32_bf16 v[52:55], a[16:19], v[148:151], v[52:55]
    ds_read_b128 a[48:51], v4 offset:57344
    v_mfma_f32_16x16x32_bf16 v[56:59], a[20:23], v[144:147], v[56:59]
    v_mfma_f32_16x16x32_bf16 v[60:63], a[20:23], v[148:151], v[60:63]
    ds_read_b128 a[52:55], v4 offset:59392
    v_mfma_f32_16x16x32_bf16 v[64:67], a[24:27], v[144:147], v[64:67]
    v_mfma_f32_16x16x32_bf16 v[68:71], a[24:27], v[148:151], v[68:71]
    ds_read_b128 a[56:59], v4 offset:61440
    v_mfma_f32_16x16x32_bf16 v[72:75], a[28:31], v[144:147], v[72:75]
    v_mfma_f32_16x16x32_bf16 v[76:79], a[28:31], v[148:151], v[76:79]
    ds_read_b128 a[60:63], v4 offset:63488
    s_waitcnt vmcnt(8)
    s_barrier
    s_cmp_lg_u32 s14, 0
    s_cbranch_scc1 GF_119
    v_mov_b32 v7, 1
    v_mov_b32 v8, 0
    s_mov_b64 exec, 1
    buffer_store_dword v7, v8, s[4:7], s23 offen sc1
    s_mov_b64 exec, -1
GF_119:
    s_waitcnt lgkmcnt(4)
    v_mfma_f32_16x16x32_bf16 v[16:19], a[32:35], v[152:155], v[16:19]
    v_mfma_f32_16x16x32_bf16 v[20:23], a[32:35], v[156:159], v[20:23]
    ds_read_b128 a[0:3], v6 offset:0
    s_add_u32 m0, s21, 32768
    v_mfma_f32_16x16x32_bf16 v[24:27], a[36:39], v[152:155], v[24:27]
    v_mfma_f32_16x16x32_bf16 v[28:31], a[36:39], v[156:159], v[28:31]
    ds_read_b128 a[4:7], v6 offset:2048
    s_add_u32 s64, s20, 0x380
    buffer_load_dwordx4 v2, s[4:7], s64 offen lds
    v_mfma_f32_16x16x32_bf16 v[32:35], a[40:43], v[152:155], v[32:35]
    v_mfma_f32_16x16x32_bf16 v[36:39], a[40:43], v[156:159], v[36:39]
    ds_read_b128 a[8:11], v6 offset:4096
    s_add_u32 m0, s21, 33792
    v_mfma_f32_16x16x32_bf16 v[40:43], a[44:47], v[152:155], v[40:43]
    v_mfma_f32_16x16x32_bf16 v[44:47], a[44:47], v[156:159], v[44:47]
    ds_read_b128 a[12:15], v6 offset:6144
    s_add_u32 s64, s20, 0x2b80
    buffer_load_dwordx4 v2, s[4:7], s64 offen lds
    s_waitcnt lgkmcnt(4)
    v_mfma_f32_16x16x32_bf16 v[48:51], a[48:51], v[152:155], v[48:51]
    v_mfma_f32_16x16x32_bf16 v[52:55], a[48:51], v[156:159], v[52:55]
    ds_read_b128 a[16:19], v6 offset:8192
    s_add_u32 m0, s21, 34816
    v_mfma_f32_16x16x32_bf16 v[56:59], a[52:55], v[152:155], v[56:59]
    v_mfma_f32_16x16x32_bf16 v[60:63], a[52:55], v[156:159], v[60:63]
    ds_read_b128 a[20:23], v6 offset:10240
    s_add_u32 s64, s20, 0x5380
    buffer_load_dwordx4 v2, s[4:7], s64 offen lds
    v_mfma_f32_16x16x32_bf16 v[64:67], a[56:59], v[152:155], v[64:67]
    v_mfma_f32_16x16x32_bf16 v[68:71], a[56:59], v[156:159], v[68:71]
    ds_read_b128 a[24:27], v6 offset:12288
    s_add_u32 m0, s21, 35840
    v_mfma_f32_16x16x32_bf16 v[72:75], a[60:63], v[152:155], v[72:75]
    v_mfma_f32_16x16x32_bf16 v[76:79], a[60:63], v[156:159], v[76:79]
    ds_read_b128 a[28:31], v6 offset:14336
    s_add_u32 s64, s20, 0x7b80
    buffer_load_dwordx4 v2, s[4:7], s64 offen lds
    s_waitcnt lgkmcnt(4)
    v_mfma_f32_16x16x32_bf16 v[16:19], a[0:3], v[160:163], v[16:19]
    v_mfma_f32_16x16x32_bf16 v[20:23], a[0:3], v[164:167], v[20:23]
    ds_read_b128 a[32:35], v9 offset:0
    v_mfma_f32_16x16x32_bf16 v[24:27], a[4:7], v[160:163], v[24:27]
    v_mfma_f32_16x16x32_bf16 v[28:31], a[4:7], v[164:167], v[28:31]
    ds_read_b128 a[36:39], v9 offset:2048
    v_mfma_f32_16x16x32_bf16 v[32:35], a[8:11], v[160:163], v[32:35]
    v_mfma_f32_16x16x32_bf16 v[36:39], a[8:11], v[164:167], v[36:39]
    ds_read_b128 a[40:43], v9 offset:4096
    v_mfma_f32_16x16x32_bf16 v[40:43], a[12:15], v[160:163], v[40:43]
    v_mfma_f32_16x16x32_bf16 v[44:47], a[12:15], v[164:167], v[44:47]
    ds_read_b128 a[44:47], v9 offset:6144
    s_waitcnt lgkmcnt(4)
    v_mfma_f32_16x16x32_bf16 v[48:51], a[16:19], v[160:163], v[48:51]
    v_mfma_f32_16x16x32_bf16 v[52:55], a[16:19], v[164:167], v[52:55]
    ds_read_b128 a[48:51], v9 offset:8192
    v_mfma_f32_16x16x32_bf16 v[56:59], a[20:23], v[160:163], v[56:59]
    v_mfma_f32_16x16x32_bf16 v[60:63], a[20:23], v[164:167], v[60:63]
    ds_read_b128 a[52:55], v9 offset:10240
    v_mfma_f32_16x16x32_bf16 v[64:67], a[24:27], v[160:163], v[64:67]
    v_mfma_f32_16x16x32_bf16 v[68:71], a[24:27], v[164:167], v[68:71]
    ds_read_b128 a[56:59], v9 offset:12288
    v_mfma_f32_16x16x32_bf16 v[72:75], a[28:31], v[160:163], v[72:75]
    v_mfma_f32_16x16x32_bf16 v[76:79], a[28:31], v[164:167], v[76:79]
    ds_read_b128 a[60:63], v9 offset:14336
    s_waitcnt vmcnt(8)
    s_barrier
    s_waitcnt lgkmcnt(4)
    v_mfma_f32_16x16x32_bf16 v[16:19], a[32:35], v[168:171], v[16:19]
    v_mfma_f32_16x16x32_bf16 v[20:23], a[32:35], v[172:175], v[20:23]
    ds_read_b128 a[0:3], v3 offset:0
    s_add_u32 m0, s21, 49152
    v_mfma_f32_16x16x32_bf16 v[24:27], a[36:39], v[168:171], v[24:27]
    v_mfma_f32_16x16x32_bf16 v[28:31], a[36:39], v[172:175], v[28:31]
    ds_read_b128 a[4:7], v3 offset:2048
    s_add_u32 s64, s20, 0x400
    buffer_load_dwordx4 v2, s[4:7], s64 offen lds
    v_mfma_f32_16x16x32_bf16 v[32:35], a[40:43], v[168:171], v[32:35]
    v_mfma_f32_16x16x32_bf16 v[36:39], a[40:43], v[172:175], v[36:39]
    ds_read_b128 a[8:11], v3 offset:4096
    s_add_u32 m0, s21, 50176
    v_mfma_f32_16x16x32_bf16 v[40:43], a[44:47], v[168:171], v[40:43]
    v_mfma_f32_16x16x32_bf16 v[44:47], a[44:47], v[172:175], v[44:47]
    ds_read_b128 a[12:15], v3 offset:6144
    s_add_u32 s64, s20, 0x2c00
    buffer_load_dwordx4 v2, s[4:7], s64 offen lds
    s_waitcnt lgkmcnt(4)
    v_mfma_f32_16x16x32_bf16 v[48:51], a[48:51], v[168:171], v[48:51]
    v_mfma_f32_16x16x32_bf16 v[52:55], a[48:51], v[172:175], v[52:55]
    ds_read_b128 a[16:19], v3 offset:8192
    s_add_u32 m0, s21, 51200
    v_mfma_f32_16x16x32_bf16 v[56:59], a[52:55], v[168:171], v[56:59]
    v_mfma_f32_16x16x32_bf16 v[60:63], a[52:55], v[172:175], v[60:63]
    ds_read_b128 a[20:23], v3 offset:10240
    s_add_u32 s64, s20, 0x5400
    buffer_load_dwordx4 v2, s[4:7], s64 offen lds
    v_mfma_f32_16x16x32_bf16 v[64:67], a[56:59], v[168:171], v[64:67]
    v_mfma_f32_16x16x32_bf16 v[68:71], a[56:59], v[172:175], v[68:71]
    ds_read_b128 a[24:27], v3 offset:12288
    s_add_u32 m0, s21, 52224
    v_mfma_f32_16x16x32_bf16 v[72:75], a[60:63], v[168:171], v[72:75]
    v_mfma_f32_16x16x32_bf16 v[76:79], a[60:63], v[172:175], v[76:79]
    ds_read_b128 a[28:31], v3 offset:14336
    s_add_u32 s64, s20, 0x7c00
    buffer_load_dwordx4 v2, s[4:7], s64 offen lds
    s_waitcnt lgkmcnt(4)
    v_mfma_f32_16x16x32_bf16 v[16:19], a[0:3], v[176:179], v[16:19]
    v_mfma_f32_16x16x32_bf16 v[20:23], a[0:3], v[180:183], v[20:23]
    ds_read_b128 a[32:35], v4 offset:0
    v_mfma_f32_16x16x32_bf16 v[24:27], a[4:7], v[176:179], v[24:27]
    v_mfma_f32_16x16x32_bf16 v[28:31], a[4:7], v[180:183], v[28:31]
    ds_read_b128 a[36:39], v4 offset:2048
    v_mfma_f32_16x16x32_bf16 v[32:35], a[8:11], v[176:179], v[32:35]
    v_mfma_f32_16x16x32_bf16 v[36:39], a[8:11], v[180:183], v[36:39]
    ds_read_b128 a[40:43], v4 offset:4096
    v_mfma_f32_16x16x32_bf16 v[40:43], a[12:15], v[176:179], v[40:43]
    v_mfma_f32_16x16x32_bf16 v[44:47], a[12:15], v[180:183], v[44:47]
    ds_read_b128 a[44:47], v4 offset:6144
    s_waitcnt lgkmcnt(4)
    v_mfma_f32_16x16x32_bf16 v[48:51], a[16:19], v[176:179], v[48:51]
    v_mfma_f32_16x16x32_bf16 v[52:55], a[16:19], v[180:183], v[52:55]
    ds_read_b128 a[48:51], v4 offset:8192
    v_mfma_f32_16x16x32_bf16 v[56:59], a[20:23], v[176:179], v[56:59]
    v_mfma_f32_16x16x32_bf16 v[60:63], a[20:23], v[180:183], v[60:63]
    ds_read_b128 a[52:55], v4 offset:10240
    v_mfma_f32_16x16x32_bf16 v[64:67], a[24:27], v[176:179], v[64:67]
    v_mfma_f32_16x16x32_bf16 v[68:71], a[24:27], v[180:183], v[68:71]
    ds_read_b128 a[56:59], v4 offset:12288
    v_mfma_f32_16x16x32_bf16 v[72:75], a[28:31], v[176:179], v[72:75]
    v_mfma_f32_16x16x32_bf16 v[76:79], a[28:31], v[180:183], v[76:79]
    ds_read_b128 a[60:63], v4 offset:14336
    s_waitcnt vmcnt(8)
    s_barrier
    s_waitcnt lgkmcnt(4)
    v_mfma_f32_16x16x32_bf16 v[16:19], a[32:35], v[184:187], v[16:19]
    v_mfma_f32_16x16x32_bf16 v[20:23], a[32:35], v[188:191], v[20:23]
    ds_read_b128 a[0:3], v3 offset:16384
    s_add_u32 m0, s21, 65536
    v_mfma_f32_16x16x32_bf16 v[24:27], a[36:39], v[184:187], v[24:27]
    v_mfma_f32_16x16x32_bf16 v[28:31], a[36:39], v[188:191], v[28:31]
    ds_read_b128 a[4:7], v3 offset:18432
    s_add_u32 s64, s20, 0x480
    buffer_load_dwordx4 v2, s[4:7], s64 offen lds
    v_mfma_f32_16x16x32_bf16 v[32:35], a[40:43], v[184:187], v[32:35]
    v_mfma_f32_16x16x32_bf16 v[36:39], a[40:43], v[188:191], v[36:39]
    ds_read_b128 a[8:11], v3 offset:20480
    s_add_u32 m0, s21, 66560
    v_mfma_f32_16x16x32_bf16 v[40:43], a[44:47], v[184:187], v[40:43]
    v_mfma_f32_16x16x32_bf16 v[44:47], a[44:47], v[188:191], v[44:47]
    ds_read_b128 a[12:15], v3 offset:22528
    s_add_u32 s64, s20, 0x2c80
    buffer_load_dwordx4 v2, s[4:7], s64 offen lds
    s_waitcnt lgkmcnt(4)
    v_mfma_f32_16x16x32_bf16 v[48:51], a[48:51], v[184:187], v[48:51]
    v_mfma_f32_16x16x32_bf16 v[52:55], a[48:51], v[188:191], v[52:55]
    ds_read_b128 a[16:19], v3 offset:24576
    s_add_u32 m0, s21, 67584
    v_mfma_f32_16x16x32_bf16 v[56:59], a[52:55], v[184:187], v[56:59]
    v_mfma_f32_16x16x32_bf16 v[60:63], a[52:55], v[188:191], v[60:63]
    ds_read_b128 a[20:23], v3 offset:26624
    s_add_u32 s64, s20, 0x5480
    buffer_load_dwordx4 v2, s[4:7], s64 offen lds
    v_mfma_f32_16x16x32_bf16 v[64:67], a[56:59], v[184:187], v[64:67]
    v_mfma_f32_16x16x32_bf16 v[68:71], a[56:59], v[188:191], v[68:71]
    ds_read_b128 a[24:27], v3 offset:28672
    s_add_u32 m0, s21, 68608
    v_mfma_f32_16x16x32_bf16 v[72:75], a[60:63], v[184:187], v[72:75]
    v_mfma_f32_16x16x32_bf16 v[76:79], a[60:63], v[188:191], v[76:79]
    ds_read_b128 a[28:31], v3 offset:30720
    s_add_u32 s64, s20, 0x7c80
    buffer_load_dwordx4 v2, s[4:7], s64 offen lds
    s_waitcnt lgkmcnt(4)
    v_mfma_f32_16x16x32_bf16 v[16:19], a[0:3], v[192:195], v[16:19]
    v_mfma_f32_16x16x32_bf16 v[20:23], a[0:3], v[196:199], v[20:23]
    ds_read_b128 a[32:35], v4 offset:16384
    v_mfma_f32_16x16x32_bf16 v[24:27], a[4:7], v[192:195], v[24:27]
    v_mfma_f32_16x16x32_bf16 v[28:31], a[4:7], v[196:199], v[28:31]
    ds_read_b128 a[36:39], v4 offset:18432
    v_mfma_f32_16x16x32_bf16 v[32:35], a[8:11], v[192:195], v[32:35]
    v_mfma_f32_16x16x32_bf16 v[36:39], a[8:11], v[196:199], v[36:39]
    ds_read_b128 a[40:43], v4 offset:20480
    v_mfma_f32_16x16x32_bf16 v[40:43], a[12:15], v[192:195], v[40:43]
    v_mfma_f32_16x16x32_bf16 v[44:47], a[12:15], v[196:199], v[44:47]
    ds_read_b128 a[44:47], v4 offset:22528
    s_waitcnt lgkmcnt(4)
    v_mfma_f32_16x16x32_bf16 v[48:51], a[16:19], v[192:195], v[48:51]
    v_mfma_f32_16x16x32_bf16 v[52:55], a[16:19], v[196:199], v[52:55]
    ds_read_b128 a[48:51], v4 offset:24576
    v_mfma_f32_16x16x32_bf16 v[56:59], a[20:23], v[192:195], v[56:59]
    v_mfma_f32_16x16x32_bf16 v[60:63], a[20:23], v[196:199], v[60:63]
    ds_read_b128 a[52:55], v4 offset:26624
    v_mfma_f32_16x16x32_bf16 v[64:67], a[24:27], v[192:195], v[64:67]
    v_mfma_f32_16x16x32_bf16 v[68:71], a[24:27], v[196:199], v[68:71]
    ds_read_b128 a[56:59], v4 offset:28672
    v_mfma_f32_16x16x32_bf16 v[72:75], a[28:31], v[192:195], v[72:75]
    v_mfma_f32_16x16x32_bf16 v[76:79], a[28:31], v[196:199], v[76:79]
    ds_read_b128 a[60:63], v4 offset:30720
    s_waitcnt vmcnt(8)
    s_barrier
    s_waitcnt lgkmcnt(4)
    v_mfma_f32_16x16x32_bf16 v[16:19], a[32:35], v[200:203], v[16:19]
    v_mfma_f32_16x16x32_bf16 v[20:23], a[32:35], v[204:207], v[20:23]
    ds_read_b128 a[0:3], v3 offset:32768
    s_add_u32 m0, s21, 0
    v_mfma_f32_16x16x32_bf16 v[24:27], a[36:39], v[200:203], v[24:27]
    v_mfma_f32_16x16x32_bf16 v[28:31], a[36:39], v[204:207], v[28:31]
    ds_read_b128 a[4:7], v3 offset:34816
    s_add_u32 s64, s20, 0x50000
    buffer_load_dwordx4 v2, s[4:7], s64 offen lds
    v_mfma_f32_16x16x32_bf16 v[32:35], a[40:43], v[200:203], v[32:35]
    v_mfma_f32_16x16x32_bf16 v[36:39], a[40:43], v[204:207], v[36:39]
    ds_read_b128 a[8:11], v3 offset:36864
    s_add_u32 m0, s21, 1024
    v_mfma_f32_16x16x32_bf16 v[40:43], a[44:47], v[200:203], v[40:43]
    v_mfma_f32_16x16x32_bf16 v[44:47], a[44:47], v[204:207], v[44:47]
    ds_read_b128 a[12:15], v3 offset:38912
    s_add_u32 s64, s20, 0x52800
    buffer_load_dwordx4 v2, s[4:7], s64 offen lds
    s_waitcnt lgkmcnt(4)
    v_mfma_f32_16x16x32_bf16 v[48:51], a[48:51], v[200:203], v[48:51]
    v_mfma_f32_16x16x32_bf16 v[52:55], a[48:51], v[204:207], v[52:55]
    ds_read_b128 a[16:19], v3 offset:40960
    s_add_u32 m0, s21, 2048
    v_mfma_f32_16x16x32_bf16 v[56:59], a[52:55], v[200:203], v[56:59]
    v_mfma_f32_16x16x32_bf16 v[60:63], a[52:55], v[204:207], v[60:63]
    ds_read_b128 a[20:23], v3 offset:43008
    s_add_u32 s64, s20, 0x55000
    buffer_load_dwordx4 v2, s[4:7], s64 offen lds
    v_mfma_f32_16x16x32_bf16 v[64:67], a[56:59], v[200:203], v[64:67]
    v_mfma_f32_16x16x32_bf16 v[68:71], a[56:59], v[204:207], v[68:71]
    ds_read_b128 a[24:27], v3 offset:45056
    s_add_u32 m0, s21, 3072
    v_mfma_f32_16x16x32_bf16 v[72:75], a[60:63], v[200:203], v[72:75]
    v_mfma_f32_16x16x32_bf16 v[76:79], a[60:63], v[204:207], v[76:79]
    ds_read_b128 a[28:31], v3 offset:47104
    s_add_u32 s64, s20, 0x57800
    buffer_load_dwordx4 v2, s[4:7], s64 offen lds
    s_waitcnt lgkmcnt(4)
    v_mfma_f32_16x16x32_bf16 v[16:19], a[0:3], v[208:211], v[16:19]
    v_mfma_f32_16x16x32_bf16 v[20:23], a[0:3], v[212:215], v[20:23]
    ds_read_b128 a[32:35], v4 offset:32768
    v_mfma_f32_16x16x32_bf16 v[24:27], a[4:7], v[208:211], v[24:27]
    v_mfma_f32_16x16x32_bf16 v[28:31], a[4:7], v[212:215], v[28:31]
    ds_read_b128 a[36:39], v4 offset:34816
    v_mfma_f32_16x16x32_bf16 v[32:35], a[8:11], v[208:211], v[32:35]
    v_mfma_f32_16x16x32_bf16 v[36:39], a[8:11], v[212:215], v[36:39]
    ds_read_b128 a[40:43], v4 offset:36864
    v_mfma_f32_16x16x32_bf16 v[40:43], a[12:15], v[208:211], v[40:43]
    v_mfma_f32_16x16x32_bf16 v[44:47], a[12:15], v[212:215], v[44:47]
    ds_read_b128 a[44:47], v4 offset:38912
    s_waitcnt lgkmcnt(4)
    v_mfma_f32_16x16x32_bf16 v[48:51], a[16:19], v[208:211], v[48:51]
    v_mfma_f32_16x16x32_bf16 v[52:55], a[16:19], v[212:215], v[52:55]
    ds_read_b128 a[48:51], v4 offset:40960
    v_mfma_f32_16x16x32_bf16 v[56:59], a[20:23], v[208:211], v[56:59]
    v_mfma_f32_16x16x32_bf16 v[60:63], a[20:23], v[212:215], v[60:63]
    ds_read_b128 a[52:55], v4 offset:43008
    v_mfma_f32_16x16x32_bf16 v[64:67], a[24:27], v[208:211], v[64:67]
    v_mfma_f32_16x16x32_bf16 v[68:71], a[24:27], v[212:215], v[68:71]
    ds_read_b128 a[56:59], v4 offset:45056
    v_mfma_f32_16x16x32_bf16 v[72:75], a[28:31], v[208:211], v[72:75]
    v_mfma_f32_16x16x32_bf16 v[76:79], a[28:31], v[212:215], v[76:79]
    ds_read_b128 a[60:63], v4 offset:47104
    s_waitcnt vmcnt(8)
    s_barrier
    s_waitcnt lgkmcnt(4)
    v_mfma_f32_16x16x32_bf16 v[16:19], a[32:35], v[216:219], v[16:19]
    v_mfma_f32_16x16x32_bf16 v[20:23], a[32:35], v[220:223], v[20:23]
    ds_read_b128 a[0:3], v3 offset:49152
    s_add_u32 m0, s21, 16384
    v_mfma_f32_16x16x32_bf16 v[24:27], a[36:39], v[216:219], v[24:27]
    v_mfma_f32_16x16x32_bf16 v[28:31], a[36:39], v[220:223], v[28:31]
    ds_read_b128 a[4:7], v3 offset:51200
    s_add_u32 s64, s20, 0x50080
    buffer_load_dwordx4 v2, s[4:7], s64 offen lds
    v_mfma_f32_16x16x32_bf16 v[32:35], a[40:43], v[216:219], v[32:35]
    v_mfma_f32_16x16x32_bf16 v[36:39], a[40:43], v[220:223], v[36:39]
    ds_read_b128 a[8:11], v3 offset:53248
    s_add_u32 m0, s21, 17408
    v_mfma_f32_16x16x32_bf16 v[40:43], a[44:47], v[216:219], v[40:43]
    v_mfma_f32_16x16x32_bf16 v[44:47], a[44:47], v[220:223], v[44:47]
    ds_read_b128 a[12:15], v3 offset:55296
    s_add_u32 s64, s20, 0x52880
    buffer_load_dwordx4 v2, s[4:7], s64 offen lds
    s_waitcnt lgkmcnt(4)
    v_mfma_f32_16x16x32_bf16 v[48:51], a[48:51], v[216:219], v[48:51]
    v_mfma_f32_16x16x32_bf16 v[52:55], a[48:51], v[220:223], v[52:55]
    ds_read_b128 a[16:19], v3 offset:57344
    s_add_u32 m0, s21, 18432
    v_mfma_f32_16x16x32_bf16 v[56:59], a[52:55], v[216:219], v[56:59]
    v_mfma_f32_16x16x32_bf16 v[60:63], a[52:55], v[220:223], v[60:63]
    ds_read_b128 a[20:23], v3 offset:59392
    s_add_u32 s64, s20, 0x55080
    buffer_load_dwordx4 v2, s[4:7], s64 offen lds
    v_mfma_f32_16x16x32_bf16 v[64:67], a[56:59], v[216:219], v[64:67]
    v_mfma_f32_16x16x32_bf16 v[68:71], a[56:59], v[220:223], v[68:71]
    ds_read_b128 a[24:27], v3 offset:61440
    s_add_u32 m0, s21, 19456
    v_mfma_f32_16x16x32_bf16 v[72:75], a[60:63], v[216:219], v[72:75]
    v_mfma_f32_16x16x32_bf16 v[76:79], a[60:63], v[220:223], v[76:79]
    ds_read_b128 a[28:31], v3 offset:63488
    s_add_u32 s64, s20, 0x57880
    buffer_load_dwordx4 v2, s[4:7], s64 offen lds
    s_waitcnt lgkmcnt(4)
    v_mfma_f32_16x16x32_bf16 v[16:19], a[0:3], v[224:227], v[16:19]
    v_mfma_f32_16x16x32_bf16 v[20:23], a[0:3], v[228:231], v[20:23]
    ds_read_b128 a[32:35], v4 offset:49152
    v_mfma_f32_16x16x32_bf16 v[24:27], a[4:7], v[224:227], v[24:27]
    v_mfma_f32_16x16x32_bf16 v[28:31], a[4:7], v[228:231], v[28:31]
    ds_read_b128 a[36:39], v4 offset:51200
    v_mfma_f32_16x16x32_bf16 v[32:35], a[8:11], v[224:227], v[32:35]
    v_mfma_f32_16x16x32_bf16 v[36:39], a[8:11], v[228:231], v[36:39]
    ds_read_b128 a[40:43], v4 offset:53248
    v_mfma_f32_16x16x32_bf16 v[40:43], a[12:15], v[224:227], v[40:43]
    v_mfma_f32_16x16x32_bf16 v[44:47], a[12:15], v[228:231], v[44:47]
    ds_read_b128 a[44:47], v4 offset:55296
    s_waitcnt lgkmcnt(4)
    v_mfma_f32_16x16x32_bf16 v[48:51], a[16:19], v[224:227], v[48:51]
    v_mfma_f32_16x16x32_bf16 v[52:55], a[16:19], v[228:231], v[52:55]
    ds_read_b128 a[48:51], v4 offset:57344
    v_mfma_f32_16x16x32_bf16 v[56:59], a[20:23], v[224:227], v[56:59]
    v_mfma_f32_16x16x32_bf16 v[60:63], a[20:23], v[228:231], v[60:63]
    ds_read_b128 a[52:55], v4 offset:59392
    v_mfma_f32_16x16x32_bf16 v[64:67], a[24:27], v[224:227], v[64:67]
    v_mfma_f32_16x16x32_bf16 v[68:71], a[24:27], v[228:231], v[68:71]
    ds_read_b128 a[56:59], v4 offset:61440
    v_mfma_f32_16x16x32_bf16 v[72:75], a[28:31], v[224:227], v[72:75]
    v_mfma_f32_16x16x32_bf16 v[76:79], a[28:31], v[228:231], v[76:79]
    ds_read_b128 a[60:63], v4 offset:63488
    s_waitcnt vmcnt(8)
    s_barrier
    s_waitcnt lgkmcnt(4)
    v_mfma_f32_16x16x32_bf16 v[16:19], a[32:35], v[232:235], v[16:19]
    v_mfma_f32_16x16x32_bf16 v[20:23], a[32:35], v[236:239], v[20:23]
    ds_read_b128 a[0:3], v6 offset:0
    s_add_u32 m0, s21, 32768
    v_mfma_f32_16x16x32_bf16 v[24:27], a[36:39], v[232:235], v[24:27]
    v_mfma_f32_16x16x32_bf16 v[28:31], a[36:39], v[236:239], v[28:31]
    ds_read_b128 a[4:7], v6 offset:2048
    s_add_u32 s64, s20, 0x50100
    buffer_load_dwordx4 v2, s[4:7], s64 offen lds
    v_mfma_f32_16x16x32_bf16 v[32:35], a[40:43], v[232:235], v[32:35]
    v_mfma_f32_16x16x32_bf16 v[36:39], a[40:43], v[236:239], v[36:39]
    ds_read_b128 a[8:11], v6 offset:4096
    s_add_u32 m0, s21, 33792
    v_mfma_f32_16x16x32_bf16 v[40:43], a[44:47], v[232:235], v[40:43]
    v_mfma_f32_16x16x32_bf16 v[44:47], a[44:47], v[236:239], v[44:47]
    ds_read_b128 a[12:15], v6 offset:6144
    s_add_u32 s64, s20, 0x52900
    buffer_load_dwordx4 v2, s[4:7], s64 offen lds
    s_waitcnt lgkmcnt(4)
    v_mfma_f32_16x16x32_bf16 v[48:51], a[48:51], v[232:235], v[48:51]
    v_mfma_f32_16x16x32_bf16 v[52:55], a[48:51], v[236:239], v[52:55]
    ds_read_b128 a[16:19], v6 offset:8192
    s_add_u32 m0, s21, 34816
    v_mfma_f32_16x16x32_bf16 v[56:59], a[52:55], v[232:235], v[56:59]
    v_mfma_f32_16x16x32_bf16 v[60:63], a[52:55], v[236:239], v[60:63]
    ds_read_b128 a[20:23], v6 offset:10240
    s_add_u32 s64, s20, 0x55100
    buffer_load_dwordx4 v2, s[4:7], s64 offen lds
    v_mfma_f32_16x16x32_bf16 v[64:67], a[56:59], v[232:235], v[64:67]
    v_mfma_f32_16x16x32_bf16 v[68:71], a[56:59], v[236:239], v[68:71]
    ds_read_b128 a[24:27], v6 offset:12288
    s_add_u32 m0, s21, 35840
    v_mfma_f32_16x16x32_bf16 v[72:75], a[60:63], v[232:235], v[72:75]
    v_mfma_f32_16x16x32_bf16 v[76:79], a[60:63], v[236:239], v[76:79]
    ds_read_b128 a[28:31], v6 offset:14336
    s_add_u32 s64, s20, 0x57900
    buffer_load_dwordx4 v2, s[4:7], s64 offen lds
    s_waitcnt lgkmcnt(4)
    v_mfma_f32_16x16x32_bf16 v[16:19], a[0:3], v[240:243], v[16:19]
    v_mfma_f32_16x16x32_bf16 v[20:23], a[0:3], v[244:247], v[20:23]
    ds_read_b128 a[32:35], v9 offset:0
    v_mfma_f32_16x16x32_bf16 v[24:27], a[4:7], v[240:243], v[24:27]
    v_mfma_f32_16x16x32_bf16 v[28:31], a[4:7], v[244:247], v[28:31]
    ds_read_b128 a[36:39], v9 offset:2048
    v_mfma_f32_16x16x32_bf16 v[32:35], a[8:11], v[240:243], v[32:35]
    v_mfma_f32_16x16x32_bf16 v[36:39], a[8:11], v[244:247], v[36:39]
    ds_read_b128 a[40:43], v9 offset:4096
    v_mfma_f32_16x16x32_bf16 v[40:43], a[12:15], v[240:243], v[40:43]
    v_mfma_f32_16x16x32_bf16 v[44:47], a[12:15], v[244:247], v[44:47]
    ds_read_b128 a[44:47], v9 offset:6144
    s_waitcnt lgkmcnt(4)
    v_mfma_f32_16x16x32_bf16 v[48:51], a[16:19], v[240:243], v[48:51]
    v_mfma_f32_16x16x32_bf16 v[52:55], a[16:19], v[244:247], v[52:55]
    ds_read_b128 a[48:51], v9 offset:8192
    v_mfma_f32_16x16x32_bf16 v[56:59], a[20:23], v[240:243], v[56:59]
    v_mfma_f32_16x16x32_bf16 v[60:63], a[20:23], v[244:247], v[60:63]
    ds_read_b128 a[52:55], v9 offset:10240
    v_mfma_f32_16x16x32_bf16 v[64:67], a[24:27], v[240:243], v[64:67]
    v_mfma_f32_16x16x32_bf16 v[68:71], a[24:27], v[244:247], v[68:71]
    ds_read_b128 a[56:59], v9 offset:12288
    v_mfma_f32_16x16x32_bf16 v[72:75], a[28:31], v[240:243], v[72:75]
    v_mfma_f32_16x16x32_bf16 v[76:79], a[28:31], v[244:247], v[76:79]
    ds_read_b128 a[60:63], v9 offset:14336
    s_waitcnt vmcnt(8)
    s_barrier
    s_waitcnt lgkmcnt(4)
    v_mfma_f32_16x16x32_bf16 v[16:19], a[32:35], v[248:251], v[16:19]
    v_mfma_f32_16x16x32_bf16 v[20:23], a[32:35], v[252:255], v[20:23]
    ds_read_b128 a[0:3], v3 offset:0
    s_add_u32 m0, s21, 49152
    v_mfma_f32_16x16x32_bf16 v[24:27], a[36:39], v[248:251], v[24:27]
    v_mfma_f32_16x16x32_bf16 v[28:31], a[36:39], v[252:255], v[28:31]
    ds_read_b128 a[4:7], v3 offset:2048
    s_add_u32 s64, s20, 0x50180
    buffer_load_dwordx4 v2, s[4:7], s64 offen lds
    v_mfma_f32_16x16x32_bf16 v[32:35], a[40:43], v[248:251], v[32:35]
    v_mfma_f32_16x16x32_bf16 v[36:39], a[40:43], v[252:255], v[36:39]
    ds_read_b128 a[8:11], v3 offset:4096
    s_add_u32 m0, s21, 50176
    v_mfma_f32_16x16x32_bf16 v[40:43], a[44:47], v[248:251], v[40:43]
    v_mfma_f32_16x16x32_bf16 v[44:47], a[44:47], v[252:255], v[44:47]
    ds_read_b128 a[12:15], v3 offset:6144
    s_add_u32 s64, s20, 0x52980
    buffer_load_dwordx4 v2, s[4:7], s64 offen lds
    s_waitcnt lgkmcnt(4)
    v_mfma_f32_16x16x32_bf16 v[48:51], a[48:51], v[248:251], v[48:51]
    v_mfma_f32_16x16x32_bf16 v[52:55], a[48:51], v[252:255], v[52:55]
    ds_read_b128 a[16:19], v3 offset:8192
    s_add_u32 m0, s21, 51200
    v_mfma_f32_16x16x32_bf16 v[56:59], a[52:55], v[248:251], v[56:59]
    v_mfma_f32_16x16x32_bf16 v[60:63], a[52:55], v[252:255], v[60:63]
    ds_read_b128 a[20:23], v3 offset:10240
    s_add_u32 s64, s20, 0x55180
    buffer_load_dwordx4 v2, s[4:7], s64 offen lds
    v_mfma_f32_16x16x32_bf16 v[64:67], a[56:59], v[248:251], v[64:67]
    v_mfma_f32_16x16x32_bf16 v[68:71], a[56:59], v[252:255], v[68:71]
    ds_read_b128 a[24:27], v3 offset:12288
    s_add_u32 m0, s21, 52224
    v_mfma_f32_16x16x32_bf16 v[72:75], a[60:63], v[248:251], v[72:75]
    v_mfma_f32_16x16x32_bf16 v[76:79], a[60:63], v[252:255], v[76:79]
    ds_read_b128 a[28:31], v3 offset:14336
    s_add_u32 s64, s20, 0x57980
    buffer_load_dwordx4 v2, s[4:7], s64 offen lds
    s_nop 5
    s_mul_i32 s65, s17, 0
    s_add_u32 s65, s65, s22
    s_add_u32 s64, s65, 0
    v_cvt_pk_bf16_f32 v80, v16, v17
    v_cvt_pk_bf16_f32 v81, v18, v19
    v_cvt_pk_bf16_f32 v82, v24, v25
    v_cvt_pk_bf16_f32 v83, v26, v27
    buffer_store_dwordx4 v[80:83], v1, s[4:7], s64 offen sc1
    s_add_u32 s64, s65, 1024
    v_cvt_pk_bf16_f32 v84, v20, v21
    v_cvt_pk_bf16_f32 v85, v22, v23
    v_cvt_pk_bf16_f32 v86, v28, v29
    v_cvt_pk_bf16_f32 v87, v30, v31
    buffer_store_dwordx4 v[84:87], v1, s[4:7], s64 offen sc1
    s_mul_i32 s65, s17, 1
    s_add_u32 s65, s65, s22
    s_add_u32 s64, s65, 0
    v_cvt_pk_bf16_f32 v88, v32, v33
    v_cvt_pk_bf16_f32 v89, v34, v35
    v_cvt_pk_bf16_f32 v90, v40, v41
    v_cvt_pk_bf16_f32 v91, v42, v43
    buffer_store_dwordx4 v[88:91], v1, s[4:7], s64 offen sc1
    s_add_u32 s64, s65, 1024
    v_cvt_pk_bf16_f32 v92, v36, v37
    v_cvt_pk_bf16_f32 v93, v38, v39
    v_cvt_pk_bf16_f32 v94, v44, v45
    v_cvt_pk_bf16_f32 v95, v46, v47
    buffer_store_dwordx4 v[92:95], v1, s[4:7], s64 offen sc1
    s_mul_i32 s65, s17, 2
    s_add_u32 s65, s65, s22
    s_add_u32 s64, s65, 0
    v_cvt_pk_bf16_f32 v80, v48, v49
    v_cvt_pk_bf16_f32 v81, v50, v51
    v_cvt_pk_bf16_f32 v82, v56, v57
    v_cvt_pk_bf16_f32 v83, v58, v59
    buffer_store_dwordx4 v[80:83], v1, s[4:7], s64 offen sc1
    s_add_u32 s64, s65, 1024
    v_cvt_pk_bf16_f32 v84, v52, v53
    v_cvt_pk_bf16_f32 v85, v54, v55
    v_cvt_pk_bf16_f32 v86, v60, v61
    v_cvt_pk_bf16_f32 v87, v62, v63
    buffer_store_dwordx4 v[84:87], v1, s[4:7], s64 offen sc1
    s_mul_i32 s65, s17, 3
    s_add_u32 s65, s65, s22
    s_add_u32 s64, s65, 0
    v_cvt_pk_bf16_f32 v88, v64, v65
    v_cvt_pk_bf16_f32 v89, v66, v67
    v_cvt_pk_bf16_f32 v90, v72, v73
    v_cvt_pk_bf16_f32 v91, v74, v75
    buffer_store_dwordx4 v[88:91], v1, s[4:7], s64 offen sc1
    s_add_u32 s64, s65, 1024
    v_cvt_pk_bf16_f32 v92, v68, v69
    v_cvt_pk_bf16_f32 v93, v70, v71
    v_cvt_pk_bf16_f32 v94, v76, v77
    v_cvt_pk_bf16_f32 v95, v78, v79
    buffer_store_dwordx4 v[92:95], v1, s[4:7], s64 offen sc1
    s_lshl_b32 s64, s19, 1
    s_add_u32 s64, s64, s12
    s_lshl_b32 s64, s64, 9
    s_add_u32 s23, s18, s64
    s_lshl_b32 s64, s17, 3
    s_add_u32 s22, s22, s64
    s_add_u32 s19, s19, 1
    s_add_u32 s20, s20, 0x50000
    s_cmp_lt_u32 s19, 8
    s_cbranch_scc1 G_N_LOOP
    s_waitcnt vmcnt(0) lgkmcnt(0)
    s_barrier
    s_cmp_lg_u32 s14, 0
    s_cbranch_scc1 GF_120
    v_mov_b32 v7, 1
    v_mov_b32 v8, 0
    s_mov_b64 exec, 1
    buffer_store_dword v7, v8, s[4:7], s23 offen sc1
    s_mov_b64 exec, -1
GF_120:
    s_cmp_eq_u32 s12, 1
    s_cbranch_scc1 H_OUT
    s_lshl_b32 s88, s3, 5
    s_add_u32 s88, s88, s13
    s_mov_b32 s29, 0
    v_lshlrev_b32 v1, 4, v0
    s_mov_b32 s65, 0
CW_121:
    buffer_load_dwordx2 v[8:9], off, s[60:63], 0 offset:132 sc1
    s_add_u32 s65, s65, 1
    s_waitcnt vmcnt(0)
    v_readfirstlane_b32 s66, v8
    v_readfirstlane_b32 s67, v9
    s_min_u32 s64, s66, s67
    s_cmp_lg_u32 s64, 0
    s_cbranch_scc1 CWD_122
    s_cmp_gt_u32 s65, 65536
    s_cbranch_scc1 CWD_122
    s_sleep 4
    s_branch CW_121
CWD_122:
    s_sub_u32 s66, s66, 1
    s_and_b32 s66, s66, 3
    s_sub_u32 s67, s67, 1
    s_and_b32 s67, s67, 3
    s_mov_b32 s64, s66
    s_mov_b32 s65, s67
    s_and_b32 s64, s64, 3
    s_lshl_b32 s64, s64, 13
    s_and_b32 s65, s65, 3
    s_lshl_b32 s65, s65, 13
    s_add_u32 s25, s64, 0x6000000
    s_add_u32 s30, s65, 0x6200000
    v_bfe_u32 v4, v0, 3, 1
    v_mul_u32_u24 v2, 0x8000, v4
    v_lshrrev_b32 v4, 5, v0
    v_lshl_add_u32 v2, v4, 8, v2
    v_bfe_u32 v4, v0, 4, 1
    v_lshl_add_u32 v2, v4, 7, v2
    v_and_b32 v4, 7, v0
    v_lshl_add_u32 v2, v4, 4, v2
    v_lshrrev_b32 v4, 5, v0
    v_lshlrev_b32 v3, 16, v4
    v_bfe_u32 v4, v0, 4, 1
    v_lshl_add_u32 v3, v4, 7, v3
    v_and_b32 v4, 15, v0
    v_lshl_add_u32 v3, v4, 3, v3
    s_lshl_b32 s26, s13, 11
    s_lshl_b32 s64, s14, 9
    s_add_u32 s26, s26, s64
    s_add_u32 s26, s26, 0xa40000
    s_lshl_b32 s27, s13, 3
    s_add_u32 s27, s27, 0x294004
    s_mov_b32 s28, 0x29a000
    s_mov_b32 s24, 0
    v_lshlrev_b32 v6, 7, v0
MKN_LOOP:
    s_cmp_lg_u32 s24, 10
    s_cbranch_scc1 MKH_123
    v_mov_b32 v10, v2
    v_mov_b32 v11, v3
    s_cmp_ge_u32 s88, 60
    s_cbranch_scc1 NOWO_124
    s_mov_b32 s89, s13
    s_mul_hi_u32 s65, s88, 0xccccccd
    s_mul_i32 s65, s65, 20
    s_sub_u32 s13, s88, s65
    s_load_dwordx2 s[44:45], s[0:1], 40
    s_mov_b32 s46, 0x500000
    s_mov_b32 s47, 0x00020000
    s_waitcnt lgkmcnt(0)
    s_mul_i32 s21, s14, 36864
    v_lshrrev_b32 v7, 2, v0
    v_mul_u32_u24 v4, 1280, v7
    v_bfe_u32 v7, v0, 4, 1
    v_lshlrev_b32 v7, 1, v7
    v_and_b32 v8, 3, v0
    v_xor_b32 v7, v7, v8
    v_lshl_add_u32 v4, v7, 4, v4
    v_lshrrev_b32 v7, 4, v0
    v_lshlrev_b32 v2, 8, v7
    v_bfe_u32 v7, v0, 2, 2
    v_lshl_add_u32 v2, v7, 6, v2
    v_and_b32 v7, 3, v0
    v_lshl_add_u32 v2, v7, 3, v2
    v_add_u32 v2, s21, v2
    v_bfe_u32 v7, v0, 4, 1
    v_lshlrev_b32 v7, 5, v7
    v_sub_u32 v3, 32, v7
    v_add_u32 v3, v3, v2
    v_add_u32 v2, v2, v7
    s_mul_i32 s65, s14, 1310720
    s_lshl_b32 s66, s13, 6
    s_add_u32 s65, s65, s66
    s_add_u32 m0, s21, 0
    s_add_u32 s64, s65, 0x0
    buffer_load_dwordx4 v4, s[44:47], s64 offen lds
    s_add_u32 m0, s21, 1024
    s_add_u32 s64, s65, 0x5000
    buffer_load_dwordx4 v4, s[44:47], s64 offen lds
    s_add_u32 m0, s21, 2048
    s_add_u32 s64, s65, 0xa000
    buffer_load_dwordx4 v4, s[44:47], s64 offen lds
    s_add_u32 m0, s21, 3072
    s_add_u32 s64, s65, 0xf000
    buffer_load_dwordx4 v4, s[44:47], s64 offen lds
    s_add_u32 m0, s21, 4096
    s_add_u32 s64, s65, 0x14000
    buffer_load_dwordx4 v4, s[44:47], s64 offen lds
    s_add_u32 m0, s21, 5120
    s_add_u32 s64, s65, 0x19000
    buffer_load_dwordx4 v4, s[44:47], s64 offen lds
    s_add_u32 m0, s21, 6144
    s_add_u32 s64, s65, 0x1e000
    buffer_load_dwordx4 v4, s[44:47], s64 offen lds
    s_add_u32 m0, s21, 7168
    s_add_u32 s64, s65, 0x23000
    buffer_load_dwordx4 v4, s[44:47], s64 offen lds
    s_add_u32 m0, s21, 8192
    s_add_u32 s64, s65, 0x28000
    buffer_load_dwordx4 v4, s[44:47], s64 offen lds
    s_add_u32 m0, s21, 9216
    s_add_u32 s64, s65, 0x2d000
    buffer_load_dwordx4 v4, s[44:47], s64 offen lds
    s_add_u32 m0, s21, 10240
    s_add_u32 s64, s65, 0x32000
    buffer_load_dwordx4 v4, s[44:47], s64 offen lds
    s_add_u32 m0, s21, 11264
    s_add_u32 s64, s65, 0x37000
    buffer_load_dwordx4 v4, s[44:47], s64 offen lds
    s_add_u32 m0, s21, 12288
    s_add_u32 s64, s65, 0x3c000
    buffer_load_dwordx4 v4, s[44:47], s64 offen lds
    s_add_u32 m0, s21, 13312
    s_add_u32 s64, s65, 0x41000
    buffer_load_dwordx4 v4, s[44:47], s64 offen lds
    s_add_u32 m0, s21, 14336
    s_add_u32 s64, s65, 0x46000
    buffer_load_dwordx4 v4, s[44:47], s64 offen lds
    s_add_u32 m0, s21, 15360
    s_add_u32 s64, s65, 0x4b000
    buffer_load_dwordx4 v4, s[44:47], s64 offen lds
    s_add_u32 m0, s21, 16384
    s_add_u32 s64, s65, 0x50000
    buffer_load_dwordx4 v4, s[44:47], s64 offen lds
    s_add_u32 m0, s21, 17408
    s_add_u32 s64, s65, 0x55000
    buffer_load_dwordx4 v4, s[44:47], s64 offen lds
    s_add_u32 m0, s21, 18432
    s_add_u32 s64, s65, 0x5a000
    buffer_load_dwordx4 v4, s[44:47], s64 offen lds
    s_add_u32 m0, s21, 19456
    s_add_u32 s64, s65, 0x5f000
    buffer_load_dwordx4 v4, s[44:47], s64 offen lds
    s_add_u32 m0, s21, 20480
    s_add_u32 s64, s65, 0x64000
    buffer_load_dwordx4 v4, s[44:47], s64 offen lds
    s_add_u32 m0, s21, 21504
    s_add_u32 s64, s65, 0x69000
    buffer_load_dwordx4 v4, s[44:47], s64 offen lds
    s_add_u32 m0, s21, 22528
    s_add_u32 s64, s65, 0x6e000
    buffer_load_dwordx4 v4, s[44:47], s64 offen lds
    s_add_u32 m0, s21, 23552
    s_add_u32 s64, s65, 0x73000
    buffer_load_dwordx4 v4, s[44:47], s64 offen lds
    s_add_u32 m0, s21, 24576
    s_add_u32 s64, s65, 0x78000
    buffer_load_dwordx4 v4, s[44:47], s64 offen lds
    s_add_u32 m0, s21, 25600
    s_add_u32 s64, s65, 0x7d000
    buffer_load_dwordx4 v4, s[44:47], s64 offen lds
    s_add_u32 m0, s21, 26624
    s_add_u32 s64, s65, 0x82000
    buffer_load_dwordx4 v4, s[44:47], s64 offen lds
    s_add_u32 m0, s21, 27648
    s_add_u32 s64, s65, 0x87000
    buffer_load_dwordx4 v4, s[44:47], s64 offen lds
    s_add_u32 m0, s21, 28672
    s_add_u32 s64, s65, 0x8c000
    buffer_load_dwordx4 v4, s[44:47], s64 offen lds
    s_add_u32 m0, s21, 29696
    s_add_u32 s64, s65, 0x91000
    buffer_load_dwordx4 v4, s[44:47], s64 offen lds
    s_add_u32 m0, s21, 30720
    s_add_u32 s64, s65, 0x96000
    buffer_load_dwordx4 v4, s[44:47], s64 offen lds
    s_add_u32 m0, s21, 31744
    s_add_u32 s64, s65, 0x9b000
    buffer_load_dwordx4 v4, s[44:47], s64 offen lds
    s_add_u32 m0, s21, 32768
    s_add_u32 s64, s65, 0xa0000
    buffer_load_dwordx4 v4, s[44:47], s64 offen lds
    s_add_u32 m0, s21, 33792
    s_add_u32 s64, s65, 0xa5000
    buffer_load_dwordx4 v4, s[44:47], s64 offen lds
    s_add_u32 m0, s21, 34816
    s_add_u32 s64, s65, 0xaa000
    buffer_load_dwordx4 v4, s[44:47], s64 offen lds
    s_add_u32 m0, s21, 35840
    s_add_u32 s64, s65, 0xaf000
    buffer_load_dwordx4 v4, s[44:47], s64 offen lds
    s_waitcnt vmcnt(32)
    ds_read_b64_tr_b16 a[0:1], v2 offset:0
    ds_read_b64_tr_b16 a[2:3], v2 offset:1024
    ds_read_b64_tr_b16 a[4:5], v3 offset:0
    ds_read_b64_tr_b16 a[6:7], v3 offset:1024
    ds_read_b64_tr_b16 a[8:9], v2 offset:2048
    ds_read_b64_tr_b16 a[10:11], v2 offset:3072
    ds_read_b64_tr_b16 a[12:13], v3 offset:2048
    ds_read_b64_tr_b16 a[14:15], v3 offset:3072
    s_waitcnt lgkmcnt(0)
    s_add_u32 m0, s21, 0
    s_add_u32 s64, s65, 0xb4000
    buffer_load_dwordx4 v4, s[44:47], s64 offen lds
    s_add_u32 m0, s21, 1024
    s_add_u32 s64, s65, 0xb9000
    buffer_load_dwordx4 v4, s[44:47], s64 offen lds
    s_add_u32 m0, s21, 2048
    s_add_u32 s64, s65, 0xbe000
    buffer_load_dwordx4 v4, s[44:47], s64 offen lds
    s_add_u32 m0, s21, 3072
    s_add_u32 s64, s65, 0xc3000
    buffer_load_dwordx4 v4, s[44:47], s64 offen lds
    s_waitcnt vmcnt(32)
    ds_read_b64_tr_b16 a[16:17], v2 offset:4096
    ds_read_b64_tr_b16 a[18:19], v2 offset:5120
    ds_read_b64_tr_b16 a[20:21], v3 offset:4096
    ds_read_b64_tr_b16 a[22:23], v3 offset:5120
    ds_read_b64_tr_b16 a[24:25], v2 offset:6144
    ds_read_b64_tr_b16 a[26:27], v2 offset:7168
    ds_read_b64_tr_b16 a[28:29], v3 offset:6144
    ds_read_b64_tr_b16 a[30:31], v3 offset:7168
    s_waitcnt lgkmcnt(0)
    s_add_u32 m0, s21, 4096
    s_add_u32 s64, s65, 0xc8000
    buffer_load_dwordx4 v4, s[44:47], s64 offen lds
    s_add_u32 m0, s21, 5120
    s_add_u32 s64, s65, 0xcd000
    buffer_load_dwordx4 v4, s[44:47], s64 offen lds
    s_add_u32 m0, s21, 6144
    s_add_u32 s64, s65, 0xd2000
    buffer_load_dwordx4 v4, s[44:47], s64 offen lds
    s_add_u32 m0, s21, 7168
    s_add_u32 s64, s65, 0xd7000
    buffer_load_dwordx4 v4, s[44:47], s64 offen lds
    s_waitcnt vmcnt(32)
    ds_read_b64_tr_b16 a[32:33], v2 offset:8192
    ds_read_b64_tr_b16 a[34:35], v2 offset:9216
    ds_read_b64_tr_b16 a[36:37], v3 offset:8192
    ds_read_b64_tr_b16 a[38:39], v3 offset:9216
    ds_read_b64_tr_b16 a[40:41], v2 offset:10240
    ds_read_b64_tr_b16 a[42:43], v2 offset:11264
    ds_read_b64_tr_b16 a[44:45], v3 offset:10240
    ds_read_b64_tr_b16 a[46:47], v3 offset:11264
    s_waitcnt lgkmcnt(0)
    s_add_u32 m0, s21, 8192
    s_add_u32 s64, s65, 0xdc000
    buffer_load_dwordx4 v4, s[44:47], s64 offen lds
    s_add_u32 m0, s21, 9216
    s_add_u32 s64, s65, 0xe1000
    buffer_load_dwordx4 v4, s[44:47], s64 offen lds
    s_add_u32 m0, s21, 10240
    s_add_u32 s64, s65, 0xe6000
    buffer_load_dwordx4 v4, s[44:47], s64 offen lds
    s_add_u32 m0, s21, 11264
    s_add_u32 s64, s65, 0xeb000
    buffer_load_dwordx4 v4, s[44:47], s64 offen lds
    s_waitcnt vmcnt(32)
    ds_read_b64_tr_b16 a[48:49], v2 offset:12288
    ds_read_b64_tr_b16 a[50:51], v2 offset:13312
    ds_read_b64_tr_b16 a[52:53], v3 offset:12288
    ds_read_b64_tr_b16 a[54:55], v3 offset:13312
    ds_read_b64_tr_b16 a[56:57], v2 offset:14336
    ds_read_b64_tr_b16 a[58:59], v2 offset:15360
    ds_read_b64_tr_b16 a[60:61], v3 offset:14336
    ds_read_b64_tr_b16 a[62:63], v3 offset:15360
    s_waitcnt lgkmcnt(0)
    s_add_u32 m0, s21, 12288
    s_add_u32 s64, s65, 0xf0000
    buffer_load_dwordx4 v4, s[44:47], s64 offen lds
    s_add_u32 m0, s21, 13312
    s_add_u32 s64, s65, 0xf5000
    buffer_load_dwordx4 v4, s[44:47], s64 offen lds
    s_add_u32 m0, s21, 14336
    s_add_u32 s64, s65, 0xfa000
    buffer_load_dwordx4 v4, s[44:47], s64 offen lds
    s_add_u32 m0, s21, 15360
    s_add_u32 s64, s65, 0xff000
    buffer_load_dwordx4 v4, s[44:47], s64 offen lds
    s_waitcnt vmcnt(32)
    ds_read_b64_tr_b16 a[64:65], v2 offset:16384
    ds_read_b64_tr_b16 a[66:67], v2 offset:17408
    ds_read_b64_tr_b16 a[68:69], v3 offset:16384
    ds_read_b64_tr_b16 a[70:71], v3 offset:17408
    ds_read_b64_tr_b16 a[72:73], v2 offset:18432
    ds_read_b64_tr_b16 a[74:75], v2 offset:19456
    ds_read_b64_tr_b16 a[76:77], v3 offset:18432
    ds_read_b64_tr_b16 a[78:79], v3 offset:19456
    s_waitcnt lgkmcnt(0)
    s_add_u32 m0, s21, 16384
    s_add_u32 s64, s65, 0x104000
    buffer_load_dwordx4 v4, s[44:47], s64 offen lds
    s_add_u32 m0, s21, 17408
    s_add_u32 s64, s65, 0x109000
    buffer_load_dwordx4 v4, s[44:47], s64 offen lds
    s_add_u32 m0, s21, 18432
    s_add_u32 s64, s65, 0x10e000
    buffer_load_dwordx4 v4, s[44:47], s64 offen lds
    s_add_u32 m0, s21, 19456
    s_add_u32 s64, s65, 0x113000
    buffer_load_dwordx4 v4, s[44:47], s64 offen lds
    s_waitcnt vmcnt(32)
    ds_read_b64_tr_b16 a[80:81], v2 offset:20480
    ds_read_b64_tr_b16 a[82:83], v2 offset:21504
    ds_read_b64_tr_b16 a[84:85], v3 offset:20480
    ds_read_b64_tr_b16 a[86:87], v3 offset:21504
    ds_read_b64_tr_b16 a[88:89], v2 offset:22528
    ds_read_b64_tr_b16 a[90:91], v2 offset:23552
    ds_read_b64_tr_b16 a[92:93], v3 offset:22528
    ds_read_b64_tr_b16 a[94:95], v3 offset:23552
    s_waitcnt lgkmcnt(0)
    s_add_u32 m0, s21, 20480
    s_add_u32 s64, s65, 0x118000
    buffer_load_dwordx4 v4, s[44:47], s64 offen lds
    s_add_u32 m0, s21, 21504
    s_add_u32 s64, s65, 0x11d000
    buffer_load_dwordx4 v4, s[44:47], s64 offen lds
    s_add_u32 m0, s21, 22528
    s_add_u32 s64, s65, 0x122000
    buffer_load_dwordx4 v4, s[44:47], s64 offen lds
    s_add_u32 m0, s21, 23552
    s_add_u32 s64, s65, 0x127000
    buffer_load_dwordx4 v4, s[44:47], s64 offen lds
    s_waitcnt vmcnt(32)
    ds_read_b64_tr_b16 a[96:97], v2 offset:24576
    ds_read_b64_tr_b16 a[98:99], v2 offset:25600
    ds_read_b64_tr_b16 a[100:101], v3 offset:24576
    ds_read_b64_tr_b16 a[102:103], v3 offset:25600
    ds_read_b64_tr_b16 a[104:105], v2 offset:26624
    ds_read_b64_tr_b16 a[106:107], v2 offset:27648
    ds_read_b64_tr_b16 a[108:109], v3 offset:26624
    ds_read_b64_tr_b16 a[110:111], v3 offset:27648
    s_waitcnt lgkmcnt(0)
    s_add_u32 m0, s21, 24576
    s_add_u32 s64, s65, 0x12c000
    buffer_load_dwordx4 v4, s[44:47], s64 offen lds
    s_add_u32 m0, s21, 25600
    s_add_u32 s64, s65, 0x131000
    buffer_load_dwordx4 v4, s[44:47], s64 offen lds
    s_add_u32 m0, s21, 26624
    s_add_u32 s64, s65, 0x136000
    buffer_load_dwordx4 v4, s[44:47], s64 offen lds
    s_add_u32 m0, s21, 27648
    s_add_u32 s64, s65, 0x13b000
    buffer_load_dwordx4 v4, s[44:47], s64 offen lds
    s_waitcnt vmcnt(32)
    ds_read_b64_tr_b16 a[112:113], v2 offset:28672
    ds_read_b64_tr_b16 a[114:115], v2 offset:29696
    ds_read_b64_tr_b16 a[116:117], v3 offset:28672
    ds_read_b64_tr_b16 a[118:119], v3 offset:29696
    ds_read_b64_tr_b16 a[120:121], v2 offset:30720
    ds_read_b64_tr_b16 a[122:123], v2 offset:31744
    ds_read_b64_tr_b16 a[124:125], v3 offset:30720
    ds_read_b64_tr_b16 a[126:127], v3 offset:31744
    s_waitcnt lgkmcnt(0)
    s_waitcnt vmcnt(28)
    ds_read_b64_tr_b16 a[128:129], v2 offset:32768
    ds_read_b64_tr_b16 a[130:131], v2 offset:33792
    ds_read_b64_tr_b16 a[132:133], v3 offset:32768
    ds_read_b64_tr_b16 a[134:135], v3 offset:33792
    ds_read_b64_tr_b16 a[136:137], v2 offset:34816
    ds_read_b64_tr_b16 a[138:139], v2 offset:35840
    ds_read_b64_tr_b16 a[140:141], v3 offset:34816
    ds_read_b64_tr_b16 a[142:143], v3 offset:35840
    s_waitcnt lgkmcnt(0)
    s_waitcnt vmcnt(24)
    ds_read_b64_tr_b16 a[144:145], v2 offset:0
    ds_read_b64_tr_b16 a[146:147], v2 offset:1024
    ds_read_b64_tr_b16 a[148:149], v3 offset:0
    ds_read_b64_tr_b16 a[150:151], v3 offset:1024
    ds_read_b64_tr_b16 a[152:153], v2 offset:2048
    ds_read_b64_tr_b16 a[154:155], v2 offset:3072
    ds_read_b64_tr_b16 a[156:157], v3 offset:2048
    ds_read_b64_tr_b16 a[158:159], v3 offset:3072
    s_waitcnt lgkmcnt(0)
    s_waitcnt vmcnt(20)
    ds_read_b64_tr_b16 a[160:161], v2 offset:4096
    ds_read_b64_tr_b16 a[162:163], v2 offset:5120
    ds_read_b64_tr_b16 a[164:165], v3 offset:4096
    ds_read_b64_tr_b16 a[166:167], v3 offset:5120
    ds_read_b64_tr_b16 a[168:169], v2 offset:6144
    ds_read_b64_tr_b16 a[170:171], v2 offset:7168
    ds_read_b64_tr_b16 a[172:173], v3 offset:6144
    ds_read_b64_tr_b16 a[174:175], v3 offset:7168
    s_waitcnt lgkmcnt(0)
    s_waitcnt vmcnt(16)
    ds_read_b64_tr_b16 a[176:177], v2 offset:8192
    ds_read_b64_tr_b16 a[178:179], v2 offset:9216
    ds_read_b64_tr_b16 a[180:181], v3 offset:8192
    ds_read_b64_tr_b16 a[182:183], v3 offset:9216
    ds_read_b64_tr_b16 a[184:185], v2 offset:10240
    ds_read_b64_tr_b16 a[186:187], v2 offset:11264
    ds_read_b64_tr_b16 a[188:189], v3 offset:10240
    ds_read_b64_tr_b16 a[190:191], v3 offset:11264
    s_waitcnt lgkmcnt(0)
    s_waitcnt vmcnt(12)
    ds_read_b64_tr_b16 a[192:193], v2 offset:12288
    ds_read_b64_tr_b16 a[194:195], v2 offset:13312
    ds_read_b64_tr_b16 a[196:197], v3 offset:12288
    ds_read_b64_tr_b16 a[198:199], v3 offset:13312
    ds_read_b64_tr_b16 a[200:201], v2 offset:14336
    ds_read_b64_tr_b16 a[202:203], v2 offset:15360
    ds_read_b64_tr_b16 a[204:205], v3 offset:14336
    ds_read_b64_tr_b16 a[206:207], v3 offset:15360
    s_waitcnt lgkmcnt(0)
    s_waitcnt vmcnt(8)
    ds_read_b64_tr_b16 a[208:209], v2 offset:16384
    ds_read_b64_tr_b16 a[210:211], v2 offset:17408
    ds_read_b64_tr_b16 a[212:213], v3 offset:16384
    ds_read_b64_tr_b16 a[214:215], v3 offset:17408
    ds_read_b64_tr_b16 a[216:217], v2 offset:18432
    ds_read_b64_tr_b16 a[218:219], v2 offset:19456
    ds_read_b64_tr_b16 a[220:221], v3 offset:18432
    ds_read_b64_tr_b16 a[222:223], v3 offset:19456
    s_waitcnt lgkmcnt(0)
    s_waitcnt vmcnt(4)
    ds_read_b64_tr_b16 a[224:225], v2 offset:20480
    ds_read_b64_tr_b16 a[226:227], v2 offset:21504
    ds_read_b64_tr_b16 a[228:229], v3 offset:20480
    ds_read_b64_tr_b16 a[230:231], v3 offset:21504
    ds_read_b64_tr_b16 a[232:233], v2 offset:22528
    ds_read_b64_tr_b16 a[234:235], v2 offset:23552
    ds_read_b64_tr_b16 a[236:237], v3 offset:22528
    ds_read_b64_tr_b16 a[238:239], v3 offset:23552
    s_waitcnt lgkmcnt(0)
    s_waitcnt vmcnt(0)
    ds_read_b64_tr_b16 a[240:241], v2 offset:24576
    ds_read_b64_tr_b16 a[242:243], v2 offset:25600
    ds_read_b64_tr_b16 a[244:245], v3 offset:24576
    ds_read_b64_tr_b16 a[246:247], v3 offset:25600
    ds_read_b64_tr_b16 a[248:249], v2 offset:26624
    ds_read_b64_tr_b16 a[250:251], v2 offset:27648
    ds_read_b64_tr_b16 a[252:253], v3 offset:26624
    ds_read_b64_tr_b16 a[254:255], v3 offset:27648
    s_waitcnt lgkmcnt(0)
    s_mov_b32 s13, s89
NOWO_124:
    v_mov_b32 v2, v10
    v_mov_b32 v3, v11
MKH_123:
    s_mov_b64 exec, 0xf
MKN_M_125:
    buffer_load_dword v5, v6, s[4:7], s28 offen sc1
    s_add_u32 s29, s29, 1
    s_waitcnt vmcnt(0)
    v_cmp_eq_u32 vcc, 0, v5
    s_cbranch_vccz MKN_MD_126
    s_cmp_gt_u32 s29, 262144
    s_cbranch_scc1 MKN_MD_126
    s_sleep 1
    s_branch MKN_M_125
MKN_MD_126:
    s_mov_b64 exec, -1
MKR_127:
    s_add_u32 s64, s25, 0x0
    buffer_load_dwordx4 v[16:19], v2, s[4:7], s64 offen sc1
    s_add_u32 s64, s25, 0x200
    buffer_load_dwordx4 v[20:23], v2, s[4:7], s64 offen sc1
    s_add_u32 s64, s25, 0x400
    buffer_load_dwordx4 v[24:27], v2, s[4:7], s64 offen sc1
    s_add_u32 s64, s25, 0x600
    buffer_load_dwordx4 v[28:31], v2, s[4:7], s64 offen sc1
    s_add_u32 s64, s25, 0x800
    buffer_load_dwordx4 v[32:35], v2, s[4:7], s64 offen sc1
    s_add_u32 s64, s25, 0xa00
    buffer_load_dwordx4 v[36:39], v2, s[4:7], s64 offen sc1
    s_add_u32 s64, s25, 0xc00
    buffer_load_dwordx4 v[40:43], v2, s[4:7], s64 offen sc1
    s_add_u32 s64, s25, 0xe00
    buffer_load_dwordx4 v[44:47], v2, s[4:7], s64 offen sc1
    s_add_u32 s64, s25, 0x1000
    buffer_load_dwordx4 v[48:51], v2, s[4:7], s64 offen sc1
    s_add_u32 s64, s25, 0x1200
    buffer_load_dwordx4 v[52:55], v2, s[4:7], s64 offen sc1
    s_add_u32 s64, s30, 0x0
    buffer_load_dwordx4 v[56:59], v2, s[4:7], s64 offen sc1
    s_add_u32 s64, s30, 0x200
    buffer_load_dwordx4 v[60:63], v2, s[4:7], s64 offen sc1
    s_add_u32 s64, s30, 0x400
    buffer_load_dwordx4 v[64:67], v2, s[4:7], s64 offen sc1
    s_add_u32 s64, s30, 0x600
    buffer_load_dwordx4 v[68:71], v2, s[4:7], s64 offen sc1
    s_add_u32 s64, s30, 0x800
    buffer_load_dwordx4 v[72:75], v2, s[4:7], s64 offen sc1
    s_add_u32 s64, s30, 0xa00
    buffer_load_dwordx4 v[76:79], v2, s[4:7], s64 offen sc1
    s_add_u32 s64, s30, 0xc00
    buffer_load_dwordx4 v[80:83], v2, s[4:7], s64 offen sc1
    s_add_u32 s64, s30, 0xe00
    buffer_load_dwordx4 v[84:87], v2, s[4:7], s64 offen sc1
    s_add_u32 s64, s30, 0x1000
    buffer_load_dwordx4 v[88:91], v2, s[4:7], s64 offen sc1
    s_add_u32 s64, s30, 0x1200
    buffer_load_dwordx4 v[92:95], v2, s[4:7], s64 offen sc1
    s_add_u32 s29, s29, 1
    s_waitcnt vmcnt(0)
    v_max3_u32 v4, v19, v23, v27
    v_max3_u32 v4, v4, v31, v35
    v_max3_u32 v4, v4, v39, v43
    v_max3_u32 v4, v4, v47, v51
    v_max3_u32 v4, v4, v55, v59
    v_max3_u32 v4, v4, v63, v67
    v_max3_u32 v4, v4, v71, v75
    v_max3_u32 v4, v4, v79, v83
    v_max3_u32 v4, v4, v87, v91
    v_max_u32 v4, v4, v95
    v_cmp_eq_u32 vcc, -1, v4
    s_cbranch_vccz MKO_128
    s_cmp_gt_u32 s29, 262144
    s_cbranch_scc0 MKR_127
MKO_128:
    v_mfma_f32_16x16x32_bf16 v[8:11], v[16:19], v[96:99], 0
    v_mfma_f32_16x16x32_bf16 v[12:15], v[16:19], v[100:103], 0
    v_mfma_f32_16x16x32_bf16 v[8:11], v[20:23], v[104:107], v[8:11]
    v_mfma_f32_16x16x32_bf16 v[12:15], v[20:23], v[108:111], v[12:15]
    v_mfma_f32_16x16x32_bf16 v[8:11], v[24:27], v[112:115], v[8:11]
    v_mfma_f32_16x16x32_bf16 v[12:15], v[24:27], v[116:119], v[12:15]
    v_mfma_f32_16x16x32_bf16 v[8:11], v[28:31], v[120:123], v[8:11]
    v_mfma_f32_16x16x32_bf16 v[12:15], v[28:31], v[124:127], v[12:15]
    v_mfma_f32_16x16x32_bf16 v[8:11], v[32:35], v[128:131], v[8:11]
    v_mfma_f32_16x16x32_bf16 v[12:15], v[32:35], v[132:135], v[12:15]
    v_mfma_f32_16x16x32_bf16 v[8:11], v[36:39], v[136:139], v[8:11]
    v_mfma_f32_16x16x32_bf16 v[12:15], v[36:39], v[140:143], v[12:15]
    v_mfma_f32_16x16x32_bf16 v[8:11], v[40:43], v[144:147], v[8:11]
    v_mfma_f32_16x16x32_bf16 v[12:15], v[40:43], v[148:151], v[12:15]
    v_mfma_f32_16x16x32_bf16 v[8:11], v[44:47], v[152:155], v[8:11]
    v_mfma_f32_16x16x32_bf16 v[12:15], v[44:47], v[156:159], v[12:15]
    v_mfma_f32_16x16x32_bf16 v[8:11], v[48:51], v[160:163], v[8:11]
    v_mfma_f32_16x16x32_bf16 v[12:15], v[48:51], v[164:167], v[12:15]
    v_mfma_f32_16x16x32_bf16 v[8:11], v[52:55], v[168:171], v[8:11]
    v_mfma_f32_16x16x32_bf16 v[12:15], v[52:55], v[172:175], v[12:15]
    v_mfma_f32_16x16x32_bf16 v[8:11], v[56:59], v[176:179], v[8:11]
    v_mfma_f32_16x16x32_bf16 v[12:15], v[56:59], v[180:183], v[12:15]
    v_mfma_f32_16x16x32_bf16 v[8:11], v[60:63], v[184:187], v[8:11]
    v_mfma_f32_16x16x32_bf16 v[12:15], v[60:63], v[188:191], v[12:15]
    v_mfma_f32_16x16x32_bf16 v[8:11], v[64:67], v[192:195], v[8:11]
    v_mfma_f32_16x16x32_bf16 v[12:15], v[64:67], v[196:199], v[12:15]
    v_mfma_f32_16x16x32_bf16 v[8:11], v[68:71], v[200:203], v[8:11]
    v_mfma_f32_16x16x32_bf16 v[12:15], v[68:71], v[204:207], v[12:15]
    v_mfma_f32_16x16x32_bf16 v[8:11], v[72:75], v[208:211], v[8:11]
    v_mfma_f32_16x16x32_bf16 v[12:15], v[72:75], v[212:215], v[12:15]
    v_mfma_f32_16x16x32_bf16 v[8:11], v[76:79], v[216:219], v[8:11]
    v_mfma_f32_16x16x32_bf16 v[12:15], v[76:79], v[220:223], v[12:15]
    v_mfma_f32_16x16x32_bf16 v[8:11], v[80:83], v[224:227], v[8:11]
    v_mfma_f32_16x16x32_bf16 v[12:15], v[80:83], v[228:231], v[12:15]
    v_mfma_f32_16x16x32_bf16 v[8:11], v[84:87], v[232:235], v[8:11]
    v_mfma_f32_16x16x32_bf16 v[12:15], v[84:87], v[236:239], v[12:15]
    v_mfma_f32_16x16x32_bf16 v[8:11], v[88:91], v[240:243], v[8:11]
    v_mfma_f32_16x16x32_bf16 v[12:15], v[88:91], v[244:247], v[12:15]
    v_mfma_f32_16x16x32_bf16 v[8:11], v[92:95], v[248:251], v[8:11]
    v_mfma_f32_16x16x32_bf16 v[12:15], v[92:95], v[252:255], v[12:15]
    s_nop 7
    v_cvt_pk_bf16_f32 v16, v8, v9
    v_cvt_pk_bf16_f32 v17, v10, v11
    v_cvt_pk_bf16_f32 v18, v12, v13
    v_cvt_pk_bf16_f32 v19, v14, v15
    buffer_store_dwordx2 v[16:17], v3, s[4:7], s26 offen sc1
    buffer_store_dwordx2 v[18:19], v3, s[4:7], s26 offen offset:256 sc1
    s_waitcnt vmcnt(0)
    s_barrier
    s_cmp_lg_u32 s14, 0
    s_cbranch_scc1 GF_129
    v_mov_b32 v7, 1
    v_mov_b32 v8, 0
    s_mov_b64 exec, 1
    buffer_store_dword v7, v8, s[4:7], s27 offen sc1
    s_mov_b64 exec, -1
GF_129:
    s_add_u32 s25, s25, 0x10000
    s_add_u32 s30, s30, 0x10000
    s_add_u32 s26, s26, 0x20000
    s_add_u32 s27, s27, 256
    s_add_u32 s28, s28, 512
    s_add_u32 s24, s24, 1
    s_cmp_lt_u32 s24, 32
    s_cbranch_scc1 MKN_LOOP
    s_cmp_ge_u32 s88, 60
    s_cbranch_scc1 M_EXIT
    s_branch H_EXTRA
H_OUT:
    s_lshl_b32 s64, s3, 5
    s_add_u32 s64, s64, s13
    s_cmp_ge_u32 s64, 60
    s_cbranch_scc1 M_EXIT
    s_mul_hi_u32 s12, s64, 0xccccccd
    s_mul_i32 s65, s12, 20
    s_sub_u32 s13, s64, s65
    s_load_dwordx2 s[44:45], s[0:1], 40
    s_mov_b32 s46, 0x500000
    s_mov_b32 s47, 0x00020000
    s_load_dwordx2 s[48:49], s[0:1], 0
    s_mov_b32 s50, 0x280000
    s_mov_b32 s51, 0x00020000
    s_load_dwordx2 s[52:53], s[0:1], 96
    s_mov_b32 s54, 0x280000
    s_mov_b32 s55, 0x00020000
    s_mov_b32 s36, -1
    s_mov_b32 s37, 0
    s_waitcnt lgkmcnt(0)
    s_mul_i32 s21, s14, 36864
    v_lshrrev_b32 v7, 2, v0
    v_mul_u32_u24 v4, 1280, v7
    v_bfe_u32 v7, v0, 4, 1
    v_lshlrev_b32 v7, 1, v7
    v_and_b32 v8, 3, v0
    v_xor_b32 v7, v7, v8
    v_lshl_add_u32 v4, v7, 4, v4
    v_lshrrev_b32 v7, 4, v0
    v_lshlrev_b32 v2, 8, v7
    v_bfe_u32 v7, v0, 2, 2
    v_lshl_add_u32 v2, v7, 6, v2
    v_and_b32 v7, 3, v0
    v_lshl_add_u32 v2, v7, 3, v2
    v_add_u32 v2, s21, v2
    v_bfe_u32 v7, v0, 4, 1
    v_lshlrev_b32 v7, 5, v7
    v_sub_u32 v3, 32, v7
    v_add_u32 v3, v3, v2
    v_add_u32 v2, v2, v7
    s_mul_i32 s65, s14, 1310720
    s_lshl_b32 s66, s13, 6
    s_add_u32 s65, s65, s66
    s_add_u32 m0, s21, 0
    s_add_u32 s64, s65, 0x0
    buffer_load_dwordx4 v4, s[44:47], s64 offen lds
    s_add_u32 m0, s21, 1024
    s_add_u32 s64, s65, 0x5000
    buffer_load_dwordx4 v4, s[44:47], s64 offen lds
    s_add_u32 m0, s21, 2048
    s_add_u32 s64, s65, 0xa000
    buffer_load_dwordx4 v4, s[44:47], s64 offen lds
    s_add_u32 m0, s21, 3072
    s_add_u32 s64, s65, 0xf000
    buffer_load_dwordx4 v4, s[44:47], s64 offen lds
    s_add_u32 m0, s21, 4096
    s_add_u32 s64, s65, 0x14000
    buffer_load_dwordx4 v4, s[44:47], s64 offen lds
    s_add_u32 m0, s21, 5120
    s_add_u32 s64, s65, 0x19000
    buffer_load_dwordx4 v4, s[44:47], s64 offen lds
    s_add_u32 m0, s21, 6144
    s_add_u32 s64, s65, 0x1e000
    buffer_load_dwordx4 v4, s[44:47], s64 offen lds
    s_add_u32 m0, s21, 7168
    s_add_u32 s64, s65, 0x23000
    buffer_load_dwordx4 v4, s[44:47], s64 offen lds
    s_add_u32 m0, s21, 8192
    s_add_u32 s64, s65, 0x28000
    buffer_load_dwordx4 v4, s[44:47], s64 offen lds
    s_add_u32 m0, s21, 9216
    s_add_u32 s64, s65, 0x2d000
    buffer_load_dwordx4 v4, s[44:47], s64 offen lds
    s_add_u32 m0, s21, 10240
    s_add_u32 s64, s65, 0x32000
    buffer_load_dwordx4 v4, s[44:47], s64 offen lds
    s_add_u32 m0, s21, 11264
    s_add_u32 s64, s65, 0x37000
    buffer_load_dwordx4 v4, s[44:47], s64 offen lds
    s_add_u32 m0, s21, 12288
    s_add_u32 s64, s65, 0x3c000
    buffer_load_dwordx4 v4, s[44:47], s64 offen lds
    s_add_u32 m0, s21, 13312
    s_add_u32 s64, s65, 0x41000
    buffer_load_dwordx4 v4, s[44:47], s64 offen lds
    s_add_u32 m0, s21, 14336
    s_add_u32 s64, s65, 0x46000
    buffer_load_dwordx4 v4, s[44:47], s64 offen lds
    s_add_u32 m0, s21, 15360
    s_add_u32 s64, s65, 0x4b000
    buffer_load_dwordx4 v4, s[44:47], s64 offen lds
    s_add_u32 m0, s21, 16384
    s_add_u32 s64, s65, 0x50000
    buffer_load_dwordx4 v4, s[44:47], s64 offen lds
    s_add_u32 m0, s21, 17408
    s_add_u32 s64, s65, 0x55000
    buffer_load_dwordx4 v4, s[44:47], s64 offen lds
    s_add_u32 m0, s21, 18432
    s_add_u32 s64, s65, 0x5a000
    buffer_load_dwordx4 v4, s[44:47], s64 offen lds
    s_add_u32 m0, s21, 19456
    s_add_u32 s64, s65, 0x5f000
    buffer_load_dwordx4 v4, s[44:47], s64 offen lds
    s_add_u32 m0, s21, 20480
    s_add_u32 s64, s65, 0x64000
    buffer_load_dwordx4 v4, s[44:47], s64 offen lds
    s_add_u32 m0, s21, 21504
    s_add_u32 s64, s65, 0x69000
    buffer_load_dwordx4 v4, s[44:47], s64 offen lds
    s_add_u32 m0, s21, 22528
    s_add_u32 s64, s65, 0x6e000
    buffer_load_dwordx4 v4, s[44:47], s64 offen lds
    s_add_u32 m0, s21, 23552
    s_add_u32 s64, s65, 0x73000
    buffer_load_dwordx4 v4, s[44:47], s64 offen lds
    s_add_u32 m0, s21, 24576
    s_add_u32 s64, s65, 0x78000
    buffer_load_dwordx4 v4, s[44:47], s64 offen lds
    s_add_u32 m0, s21, 25600
    s_add_u32 s64, s65, 0x7d000
    buffer_load_dwordx4 v4, s[44:47], s64 offen lds
    s_add_u32 m0, s21, 26624
    s_add_u32 s64, s65, 0x82000
    buffer_load_dwordx4 v4, s[44:47], s64 offen lds
    s_add_u32 m0, s21, 27648
    s_add_u32 s64, s65, 0x87000
    buffer_load_dwordx4 v4, s[44:47], s64 offen lds
    s_add_u32 m0, s21, 28672
    s_add_u32 s64, s65, 0x8c000
    buffer_load_dwordx4 v4, s[44:47], s64 offen lds
    s_add_u32 m0, s21, 29696
    s_add_u32 s64, s65, 0x91000
    buffer_load_dwordx4 v4, s[44:47], s64 offen lds
    s_add_u32 m0, s21, 30720
    s_add_u32 s64, s65, 0x96000
    buffer_load_dwordx4 v4, s[44:47], s64 offen lds
    s_add_u32 m0, s21, 31744
    s_add_u32 s64, s65, 0x9b000
    buffer_load_dwordx4 v4, s[44:47], s64 offen lds
    s_add_u32 m0, s21, 32768
    s_add_u32 s64, s65, 0xa0000
    buffer_load_dwordx4 v4, s[44:47], s64 offen lds
    s_add_u32 m0, s21, 33792
    s_add_u32 s64, s65, 0xa5000
    buffer_load_dwordx4 v4, s[44:47], s64 offen lds
    s_add_u32 m0, s21, 34816
    s_add_u32 s64, s65, 0xaa000
    buffer_load_dwordx4 v4, s[44:47], s64 offen lds
    s_add_u32 m0, s21, 35840
    s_add_u32 s64, s65, 0xaf000
    buffer_load_dwordx4 v4, s[44:47], s64 offen lds
    s_waitcnt vmcnt(32)
    ds_read_b64_tr_b16 a[0:1], v2 offset:0
    ds_read_b64_tr_b16 a[2:3], v2 offset:1024
    ds_read_b64_tr_b16 a[4:5], v3 offset:0
    ds_read_b64_tr_b16 a[6:7], v3 offset:1024
    ds_read_b64_tr_b16 a[8:9], v2 offset:2048
    ds_read_b64_tr_b16 a[10:11], v2 offset:3072
    ds_read_b64_tr_b16 a[12:13], v3 offset:2048
    ds_read_b64_tr_b16 a[14:15], v3 offset:3072
    s_waitcnt lgkmcnt(0)
    s_add_u32 m0, s21, 0
    s_add_u32 s64, s65, 0xb4000
    buffer_load_dwordx4 v4, s[44:47], s64 offen lds
    s_add_u32 m0, s21, 1024
    s_add_u32 s64, s65, 0xb9000
    buffer_load_dwordx4 v4, s[44:47], s64 offen lds
    s_add_u32 m0, s21, 2048
    s_add_u32 s64, s65, 0xbe000
    buffer_load_dwordx4 v4, s[44:47], s64 offen lds
    s_add_u32 m0, s21, 3072
    s_add_u32 s64, s65, 0xc3000
    buffer_load_dwordx4 v4, s[44:47], s64 offen lds
    s_waitcnt vmcnt(32)
    ds_read_b64_tr_b16 a[16:17], v2 offset:4096
    ds_read_b64_tr_b16 a[18:19], v2 offset:5120
    ds_read_b64_tr_b16 a[20:21], v3 offset:4096
    ds_read_b64_tr_b16 a[22:23], v3 offset:5120
    ds_read_b64_tr_b16 a[24:25], v2 offset:6144
    ds_read_b64_tr_b16 a[26:27], v2 offset:7168
    ds_read_b64_tr_b16 a[28:29], v3 offset:6144
    ds_read_b64_tr_b16 a[30:31], v3 offset:7168
    s_waitcnt lgkmcnt(0)
    s_add_u32 m0, s21, 4096
    s_add_u32 s64, s65, 0xc8000
    buffer_load_dwordx4 v4, s[44:47], s64 offen lds
    s_add_u32 m0, s21, 5120
    s_add_u32 s64, s65, 0xcd000
    buffer_load_dwordx4 v4, s[44:47], s64 offen lds
    s_add_u32 m0, s21, 6144
    s_add_u32 s64, s65, 0xd2000
    buffer_load_dwordx4 v4, s[44:47], s64 offen lds
    s_add_u32 m0, s21, 7168
    s_add_u32 s64, s65, 0xd7000
    buffer_load_dwordx4 v4, s[44:47], s64 offen lds
    s_waitcnt vmcnt(32)
    ds_read_b64_tr_b16 a[32:33], v2 offset:8192
    ds_read_b64_tr_b16 a[34:35], v2 offset:9216
    ds_read_b64_tr_b16 a[36:37], v3 offset:8192
    ds_read_b64_tr_b16 a[38:39], v3 offset:9216
    ds_read_b64_tr_b16 a[40:41], v2 offset:10240
    ds_read_b64_tr_b16 a[42:43], v2 offset:11264
    ds_read_b64_tr_b16 a[44:45], v3 offset:10240
    ds_read_b64_tr_b16 a[46:47], v3 offset:11264
    s_waitcnt lgkmcnt(0)
    s_add_u32 m0, s21, 8192
    s_add_u32 s64, s65, 0xdc000
    buffer_load_dwordx4 v4, s[44:47], s64 offen lds
    s_add_u32 m0, s21, 9216
    s_add_u32 s64, s65, 0xe1000
    buffer_load_dwordx4 v4, s[44:47], s64 offen lds
    s_add_u32 m0, s21, 10240
    s_add_u32 s64, s65, 0xe6000
    buffer_load_dwordx4 v4, s[44:47], s64 offen lds
    s_add_u32 m0, s21, 11264
    s_add_u32 s64, s65, 0xeb000
    buffer_load_dwordx4 v4, s[44:47], s64 offen lds
    s_waitcnt vmcnt(32)
    ds_read_b64_tr_b16 a[48:49], v2 offset:12288
    ds_read_b64_tr_b16 a[50:51], v2 offset:13312
    ds_read_b64_tr_b16 a[52:53], v3 offset:12288
    ds_read_b64_tr_b16 a[54:55], v3 offset:13312
    ds_read_b64_tr_b16 a[56:57], v2 offset:14336
    ds_read_b64_tr_b16 a[58:59], v2 offset:15360
    ds_read_b64_tr_b16 a[60:61], v3 offset:14336
    ds_read_b64_tr_b16 a[62:63], v3 offset:15360
    s_waitcnt lgkmcnt(0)
    s_add_u32 m0, s21, 12288
    s_add_u32 s64, s65, 0xf0000
    buffer_load_dwordx4 v4, s[44:47], s64 offen lds
    s_add_u32 m0, s21, 13312
    s_add_u32 s64, s65, 0xf5000
    buffer_load_dwordx4 v4, s[44:47], s64 offen lds
    s_add_u32 m0, s21, 14336
    s_add_u32 s64, s65, 0xfa000
    buffer_load_dwordx4 v4, s[44:47], s64 offen lds
    s_add_u32 m0, s21, 15360
    s_add_u32 s64, s65, 0xff000
    buffer_load_dwordx4 v4, s[44:47], s64 offen lds
    s_waitcnt vmcnt(32)
    ds_read_b64_tr_b16 a[64:65], v2 offset:16384
    ds_read_b64_tr_b16 a[66:67], v2 offset:17408
    ds_read_b64_tr_b16 a[68:69], v3 offset:16384
    ds_read_b64_tr_b16 a[70:71], v3 offset:17408
    ds_read_b64_tr_b16 a[72:73], v2 offset:18432
    ds_read_b64_tr_b16 a[74:75], v2 offset:19456
    ds_read_b64_tr_b16 a[76:77], v3 offset:18432
    ds_read_b64_tr_b16 a[78:79], v3 offset:19456
    s_waitcnt lgkmcnt(0)
    s_add_u32 m0, s21, 16384
    s_add_u32 s64, s65, 0x104000
    buffer_load_dwordx4 v4, s[44:47], s64 offen lds
    s_add_u32 m0, s21, 17408
    s_add_u32 s64, s65, 0x109000
    buffer_load_dwordx4 v4, s[44:47], s64 offen lds
    s_add_u32 m0, s21, 18432
    s_add_u32 s64, s65, 0x10e000
    buffer_load_dwordx4 v4, s[44:47], s64 offen lds
    s_add_u32 m0, s21, 19456
    s_add_u32 s64, s65, 0x113000
    buffer_load_dwordx4 v4, s[44:47], s64 offen lds
    s_waitcnt vmcnt(32)
    ds_read_b64_tr_b16 a[80:81], v2 offset:20480
    ds_read_b64_tr_b16 a[82:83], v2 offset:21504
    ds_read_b64_tr_b16 a[84:85], v3 offset:20480
    ds_read_b64_tr_b16 a[86:87], v3 offset:21504
    ds_read_b64_tr_b16 a[88:89], v2 offset:22528
    ds_read_b64_tr_b16 a[90:91], v2 offset:23552
    ds_read_b64_tr_b16 a[92:93], v3 offset:22528
    ds_read_b64_tr_b16 a[94:95], v3 offset:23552
    s_waitcnt lgkmcnt(0)
    s_add_u32 m0, s21, 20480
    s_add_u32 s64, s65, 0x118000
    buffer_load_dwordx4 v4, s[44:47], s64 offen lds
    s_add_u32 m0, s21, 21504
    s_add_u32 s64, s65, 0x11d000
    buffer_load_dwordx4 v4, s[44:47], s64 offen lds
    s_add_u32 m0, s21, 22528
    s_add_u32 s64, s65, 0x122000
    buffer_load_dwordx4 v4, s[44:47], s64 offen lds
    s_add_u32 m0, s21, 23552
    s_add_u32 s64, s65, 0x127000
    buffer_load_dwordx4 v4, s[44:47], s64 offen lds
    s_waitcnt vmcnt(32)
    ds_read_b64_tr_b16 a[96:97], v2 offset:24576
    ds_read_b64_tr_b16 a[98:99], v2 offset:25600
    ds_read_b64_tr_b16 a[100:101], v3 offset:24576
    ds_read_b64_tr_b16 a[102:103], v3 offset:25600
    ds_read_b64_tr_b16 a[104:105], v2 offset:26624
    ds_read_b64_tr_b16 a[106:107], v2 offset:27648
    ds_read_b64_tr_b16 a[108:109], v3 offset:26624
    ds_read_b64_tr_b16 a[110:111], v3 offset:27648
    s_waitcnt lgkmcnt(0)
    s_add_u32 m0, s21, 24576
    s_add_u32 s64, s65, 0x12c000
    buffer_load_dwordx4 v4, s[44:47], s64 offen lds
    s_add_u32 m0, s21, 25600
    s_add_u32 s64, s65, 0x131000
    buffer_load_dwordx4 v4, s[44:47], s64 offen lds
    s_add_u32 m0, s21, 26624
    s_add_u32 s64, s65, 0x136000
    buffer_load_dwordx4 v4, s[44:47], s64 offen lds
    s_add_u32 m0, s21, 27648
    s_add_u32 s64, s65, 0x13b000
    buffer_load_dwordx4 v4, s[44:47], s64 offen lds
    s_waitcnt vmcnt(32)
    ds_read_b64_tr_b16 a[112:113], v2 offset:28672
    ds_read_b64_tr_b16 a[114:115], v2 offset:29696
    ds_read_b64_tr_b16 a[116:117], v3 offset:28672
    ds_read_b64_tr_b16 a[118:119], v3 offset:29696
    ds_read_b64_tr_b16 a[120:121], v2 offset:30720
    ds_read_b64_tr_b16 a[122:123], v2 offset:31744
    ds_read_b64_tr_b16 a[124:125], v3 offset:30720
    ds_read_b64_tr_b16 a[126:127], v3 offset:31744
    s_waitcnt lgkmcnt(0)
    s_waitcnt vmcnt(28)
    ds_read_b64_tr_b16 a[128:129], v2 offset:32768
    ds_read_b64_tr_b16 a[130:131], v2 offset:33792
    ds_read_b64_tr_b16 a[132:133], v3 offset:32768
    ds_read_b64_tr_b16 a[134:135], v3 offset:33792
    ds_read_b64_tr_b16 a[136:137], v2 offset:34816
    ds_read_b64_tr_b16 a[138:139], v2 offset:35840
    ds_read_b64_tr_b16 a[140:141], v3 offset:34816
    ds_read_b64_tr_b16 a[142:143], v3 offset:35840
    s_waitcnt lgkmcnt(0)
    s_waitcnt vmcnt(24)
    ds_read_b64_tr_b16 a[144:145], v2 offset:0
    ds_read_b64_tr_b16 a[146:147], v2 offset:1024
    ds_read_b64_tr_b16 a[148:149], v3 offset:0
    ds_read_b64_tr_b16 a[150:151], v3 offset:1024
    ds_read_b64_tr_b16 a[152:153], v2 offset:2048
    ds_read_b64_tr_b16 a[154:155], v2 offset:3072
    ds_read_b64_tr_b16 a[156:157], v3 offset:2048
    ds_read_b64_tr_b16 a[158:159], v3 offset:3072
    s_waitcnt lgkmcnt(0)
    s_waitcnt vmcnt(20)
    ds_read_b64_tr_b16 a[160:161], v2 offset:4096
    ds_read_b64_tr_b16 a[162:163], v2 offset:5120
    ds_read_b64_tr_b16 a[164:165], v3 offset:4096
    ds_read_b64_tr_b16 a[166:167], v3 offset:5120
    ds_read_b64_tr_b16 a[168:169], v2 offset:6144
    ds_read_b64_tr_b16 a[170:171], v2 offset:7168
    ds_read_b64_tr_b16 a[172:173], v3 offset:6144
    ds_read_b64_tr_b16 a[174:175], v3 offset:7168
    s_waitcnt lgkmcnt(0)
    s_waitcnt vmcnt(16)
    ds_read_b64_tr_b16 a[176:177], v2 offset:8192
    ds_read_b64_tr_b16 a[178:179], v2 offset:9216
    ds_read_b64_tr_b16 a[180:181], v3 offset:8192
    ds_read_b64_tr_b16 a[182:183], v3 offset:9216
    ds_read_b64_tr_b16 a[184:185], v2 offset:10240
    ds_read_b64_tr_b16 a[186:187], v2 offset:11264
    ds_read_b64_tr_b16 a[188:189], v3 offset:10240
    ds_read_b64_tr_b16 a[190:191], v3 offset:11264
    s_waitcnt lgkmcnt(0)
    s_waitcnt vmcnt(12)
    ds_read_b64_tr_b16 a[192:193], v2 offset:12288
    ds_read_b64_tr_b16 a[194:195], v2 offset:13312
    ds_read_b64_tr_b16 a[196:197], v3 offset:12288
    ds_read_b64_tr_b16 a[198:199], v3 offset:13312
    ds_read_b64_tr_b16 a[200:201], v2 offset:14336
    ds_read_b64_tr_b16 a[202:203], v2 offset:15360
    ds_read_b64_tr_b16 a[204:205], v3 offset:14336
    ds_read_b64_tr_b16 a[206:207], v3 offset:15360
    s_waitcnt lgkmcnt(0)
    s_waitcnt vmcnt(8)
    ds_read_b64_tr_b16 a[208:209], v2 offset:16384
    ds_read_b64_tr_b16 a[210:211], v2 offset:17408
    ds_read_b64_tr_b16 a[212:213], v3 offset:16384
    ds_read_b64_tr_b16 a[214:215], v3 offset:17408
    ds_read_b64_tr_b16 a[216:217], v2 offset:18432
    ds_read_b64_tr_b16 a[218:219], v2 offset:19456
    ds_read_b64_tr_b16 a[220:221], v3 offset:18432
    ds_read_b64_tr_b16 a[222:223], v3 offset:19456
    s_waitcnt lgkmcnt(0)
    s_waitcnt vmcnt(4)
    ds_read_b64_tr_b16 a[224:225], v2 offset:20480
    ds_read_b64_tr_b16 a[226:227], v2 offset:21504
    ds_read_b64_tr_b16 a[228:229], v3 offset:20480
    ds_read_b64_tr_b16 a[230:231], v3 offset:21504
    ds_read_b64_tr_b16 a[232:233], v2 offset:22528
    ds_read_b64_tr_b16 a[234:235], v2 offset:23552
    ds_read_b64_tr_b16 a[236:237], v3 offset:22528
    ds_read_b64_tr_b16 a[238:239], v3 offset:23552
    s_waitcnt lgkmcnt(0)
    s_waitcnt vmcnt(0)
    ds_read_b64_tr_b16 a[240:241], v2 offset:24576
    ds_read_b64_tr_b16 a[242:243], v2 offset:25600
    ds_read_b64_tr_b16 a[244:245], v3 offset:24576
    ds_read_b64_tr_b16 a[246:247], v3 offset:25600
    ds_read_b64_tr_b16 a[248:249], v2 offset:26624
    ds_read_b64_tr_b16 a[250:251], v2 offset:27648
    ds_read_b64_tr_b16 a[252:253], v3 offset:26624
    ds_read_b64_tr_b16 a[254:255], v3 offset:27648
    s_waitcnt lgkmcnt(0)
    s_barrier
    s_mov_b32 s29, 0
    v_lshlrev_b32 v1, 4, v0
    v_mov_b32 v8, 0
    s_mov_b32 s64, 0x298000
OUS_130:
    buffer_load_dword v7, v8, s[4:7], s64 offen sc1
    s_add_u32 s29, s29, 1
    s_waitcnt vmcnt(0)
    v_cmp_gt_u32 vcc, 1, v7
    s_cbranch_vccz OUSD_131
    s_cmp_gt_u32 s29, 262144
    s_cbranch_scc1 OUSD_131
    s_sleep 8
    s_branch OUS_130
OUSD_131:
    v_lshlrev_b32 v6, 2, v0
    s_mov_b32 s64, 0x5400000
    buffer_load_dword v7, v6, s[4:7], s64 offen sc1
    s_waitcnt vmcnt(0)
    v_readlane_b32 s72, v7, 0
    v_readlane_b32 s73, v7, 1
    v_readlane_b32 s74, v7, 2
    v_readlane_b32 s75, v7, 3
    v_readlane_b32 s76, v7, 4
    v_readlane_b32 s77, v7, 5
    v_readlane_b32 s78, v7, 6
    v_readlane_b32 s79, v7, 7
    s_and_b32 s64, s14, 1
    s_lshl_b32 s64, s64, 4
    v_and_b32 v6, 15, v0
    v_add_u32 v6, s64, v6
    v_mov_b32 v9, v6
    v_mul_u32_u24 v5, 1280, v6
    v_lshrrev_b32 v6, 4, v0
    v_lshl_add_u32 v5, v6, 3, v5
    s_lshr_b32 s64, s14, 1
    s_lshl_b32 s64, s64, 5
    s_lshl_b32 s65, s13, 6
    s_add_u32 s64, s64, s65
    v_add_u32 v5, s64, v5
    v_lshlrev_b32 v6, 2, v0
    s_mov_b32 s80, 0x49249249
    s_mov_b32 s81, 0x92492492
    s_lshl_b64 s[80:81], s[80:81], s12
    s_bitset0_b64 s[80:81], 63
    s_bitset0_b64 s[80:81], 62
    s_mov_b64 s[82:83], 0
    s_lshr_b32 s64, s72, 5
    s_bitset1_b64 s[82:83], s64
    s_lshr_b32 s64, s73, 5
    s_bitset1_b64 s[82:83], s64
    s_lshr_b32 s64, s74, 5
    s_bitset1_b64 s[82:83], s64
    s_lshr_b32 s64, s75, 5
    s_bitset1_b64 s[82:83], s64
    s_lshr_b32 s64, s76, 5
    s_bitset1_b64 s[82:83], s64
    s_lshr_b32 s64, s77, 5
    s_bitset1_b64 s[82:83], s64
    s_lshr_b32 s64, s78, 5
    s_bitset1_b64 s[82:83], s64
    s_lshr_b32 s64, s79, 5
    s_bitset1_b64 s[82:83], s64
OU_LOOP:
    s_cmp_eq_u64 s[80:81], 0
    s_cbranch_scc1 OU_END
    s_andn2_b64 s[84:85], s[80:81], s[82:83]
    s_cbranch_scc0 OU_WM
    s_ff1_i32_b64 s24, s[84:85]
    s_branch OU_GO
OU_WM:
    v_mov_b32 v8, 0
    s_mov_b32 s64, 0x298100
OUW_132:
    buffer_load_dword v7, v8, s[4:7], s64 offen sc1
    s_add_u32 s29, s29, 1
    s_waitcnt vmcnt(0)
    v_cmp_gt_u32 vcc, 40, v7
    s_cbranch_vccz OUWD_133
    s_cmp_gt_u32 s29, 262144
    s_cbranch_scc1 OUWD_133
    s_sleep 8
    s_branch OUW_132
OUWD_133:
    s_mov_b64 s[82:83], 0
    s_branch OU_LOOP
OU_GO:
    s_bitset0_b64 s[80:81], s24
    s_lshr_b32 s86, s14, 1
    s_mul_i32 s67, s24, 40960
    buffer_load_dwordx2 v[160:161], v5, s[48:51], s67 offen
    s_add_u32 s64, s67, 0x0
    buffer_load_dwordx2 v[162:163], v5, s[4:7], s64 offen
    s_mov_b32 s64, 0x298100
    buffer_load_dword v12, off, s[4:7], s64 sc1
    s_lshl_b32 s64, s24, 7
    s_add_u32 s64, s64, 0x296000
    s_mov_b64 exec, s[36:37]
OU_F_134:
    buffer_load_dword v7, v6, s[4:7], s64 offen sc1
    s_add_u32 s29, s29, 1
    s_waitcnt vmcnt(0)
    v_cmp_eq_u32 vcc, 0, v7
    s_cbranch_vccz OU_FD_135
    s_cmp_gt_u32 s29, 262144
    s_cbranch_scc1 OU_FD_135
    s_sleep 1
    s_branch OU_F_134
OU_FD_135:
    s_mov_b64 exec, -1
    s_lshl_b32 s25, s24, 18
    s_lshl_b32 s64, s14, 15
    s_add_u32 s25, s25, s64
    s_add_u32 s25, s25, 0x4400000
    s_add_u32 s64, s25, 0x0
    buffer_load_dwordx4 v[16:19], v1, s[4:7], s64 offen
    s_add_u32 s64, s25, 0x20000
    buffer_load_dwordx4 v[20:23], v1, s[4:7], s64 offen
    s_add_u32 s64, s25, 0x400
    buffer_load_dwordx4 v[24:27], v1, s[4:7], s64 offen
    s_add_u32 s64, s25, 0x20400
    buffer_load_dwordx4 v[28:31], v1, s[4:7], s64 offen
    s_add_u32 s64, s25, 0x800
    buffer_load_dwordx4 v[32:35], v1, s[4:7], s64 offen
    s_add_u32 s64, s25, 0x20800
    buffer_load_dwordx4 v[36:39], v1, s[4:7], s64 offen
    s_add_u32 s64, s25, 0xc00
    buffer_load_dwordx4 v[40:43], v1, s[4:7], s64 offen
    s_add_u32 s64, s25, 0x20c00
    buffer_load_dwordx4 v[44:47], v1, s[4:7], s64 offen
    s_add_u32 s64, s25, 0x1000
    buffer_load_dwordx4 v[48:51], v1, s[4:7], s64 offen
    s_add_u32 s64, s25, 0x21000
    buffer_load_dwordx4 v[52:55], v1, s[4:7], s64 offen
    s_add_u32 s64, s25, 0x1400
    buffer_load_dwordx4 v[56:59], v1, s[4:7], s64 offen
    s_add_u32 s64, s25, 0x21400
    buffer_load_dwordx4 v[60:63], v1, s[4:7], s64 offen
    s_add_u32 s64, s25, 0x1800
    buffer_load_dwordx4 v[64:67], v1, s[4:7], s64 offen
    s_add_u32 s64, s25, 0x21800
    buffer_load_dwordx4 v[68:71], v1, s[4:7], s64 offen
    s_add_u32 s64, s25, 0x1c00
    buffer_load_dwordx4 v[72:75], v1, s[4:7], s64 offen
    s_add_u32 s64, s25, 0x21c00
    buffer_load_dwordx4 v[76:79], v1, s[4:7], s64 offen
    s_add_u32 s64, s25, 0x2000
    buffer_load_dwordx4 v[80:83], v1, s[4:7], s64 offen
    s_add_u32 s64, s25, 0x22000
    buffer_load_dwordx4 v[84:87], v1, s[4:7], s64 offen
    s_add_u32 s64, s25, 0x2400
    buffer_load_dwordx4 v[88:91], v1, s[4:7], s64 offen
    s_add_u32 s64, s25, 0x22400
    buffer_load_dwordx4 v[92:95], v1, s[4:7], s64 offen
    s_add_u32 s64, s25, 0x2800
    buffer_load_dwordx4 v[96:99], v1, s[4:7], s64 offen
    s_add_u32 s64, s25, 0x22800
    buffer_load_dwordx4 v[100:103], v1, s[4:7], s64 offen
    s_add_u32 s64, s25, 0x2c00
    buffer_load_dwordx4 v[104:107], v1, s[4:7], s64 offen
    s_add_u32 s64, s25, 0x22c00
    buffer_load_dwordx4 v[108:111], v1, s[4:7], s64 offen
    s_add_u32 s64, s25, 0x3000
    buffer_load_dwordx4 v[112:115], v1, s[4:7], s64 offen
    s_add_u32 s64, s25, 0x23000
    buffer_load_dwordx4 v[116:119], v1, s[4:7], s64 offen
    s_add_u32 s64, s25, 0x3400
    buffer_load_dwordx4 v[120:123], v1, s[4:7], s64 offen
    s_add_u32 s64, s25, 0x23400
    buffer_load_dwordx4 v[124:127], v1, s[4:7], s64 offen
    s_add_u32 s64, s25, 0x3800
    buffer_load_dwordx4 v[128:131], v1, s[4:7], s64 offen
    s_add_u32 s64, s25, 0x23800
    buffer_load_dwordx4 v[132:135], v1, s[4:7], s64 offen
    s_add_u32 s64, s25, 0x3c00
    buffer_load_dwordx4 v[136:139], v1, s[4:7], s64 offen
    s_add_u32 s64, s25, 0x23c00
    buffer_load_dwordx4 v[140:143], v1, s[4:7], s64 offen
    s_waitcnt vmcnt(30)
    v_mfma_f32_16x16x32_bf16 v[144:147], a[0:3], v[16:19], 0
    v_mfma_f32_16x16x32_bf16 v[148:151], a[0:3], v[20:23], 0
    v_mfma_f32_16x16x32_bf16 v[152:155], a[4:7], v[16:19], 0
    v_mfma_f32_16x16x32_bf16 v[156:159], a[4:7], v[20:23], 0
    s_add_u32 s64, s25, 0x4000
    buffer_load_dwordx4 v[16:19], v1, s[4:7], s64 offen
    s_add_u32 s64, s25, 0x24000
    buffer_load_dwordx4 v[20:23], v1, s[4:7], s64 offen
    s_waitcnt vmcnt(30)
    v_mfma_f32_16x16x32_bf16 v[144:147], a[8:11], v[24:27], v[144:147]
    v_mfma_f32_16x16x32_bf16 v[148:151], a[8:11], v[28:31], v[148:151]
    v_mfma_f32_16x16x32_bf16 v[152:155], a[12:15], v[24:27], v[152:155]
    v_mfma_f32_16x16x32_bf16 v[156:159], a[12:15], v[28:31], v[156:159]
    s_add_u32 s64, s25, 0x4400
    buffer_load_dwordx4 v[24:27], v1, s[4:7], s64 offen
    s_add_u32 s64, s25, 0x24400
    buffer_load_dwordx4 v[28:31], v1, s[4:7], s64 offen
    s_waitcnt vmcnt(30)
    v_mfma_f32_16x16x32_bf16 v[144:147], a[16:19], v[32:35], v[144:147]
    v_mfma_f32_16x16x32_bf16 v[148:151], a[16:19], v[36:39], v[148:151]
    v_mfma_f32_16x16x32_bf16 v[152:155], a[20:23], v[32:35], v[152:155]
    v_mfma_f32_16x16x32_bf16 v[156:159], a[20:23], v[36:39], v[156:159]
    s_add_u32 s64, s25, 0x4800
    buffer_load_dwordx4 v[32:35], v1, s[4:7], s64 offen
    s_add_u32 s64, s25, 0x24800
    buffer_load_dwordx4 v[36:39], v1, s[4:7], s64 offen
    s_waitcnt vmcnt(30)
    v_mfma_f32_16x16x32_bf16 v[144:147], a[24:27], v[40:43], v[144:147]
    v_mfma_f32_16x16x32_bf16 v[148:151], a[24:27], v[44:47], v[148:151]
    v_mfma_f32_16x16x32_bf16 v[152:155], a[28:31], v[40:43], v[152:155]
    v_mfma_f32_16x16x32_bf16 v[156:159], a[28:31], v[44:47], v[156:159]
    s_add_u32 s64, s25, 0x4c00
    buffer_load_dwordx4 v[40:43], v1, s[4:7], s64 offen
    s_add_u32 s64, s25, 0x24c00
    buffer_load_dwordx4 v[44:47], v1, s[4:7], s64 offen
    s_waitcnt vmcnt(30)
    v_mfma_f32_16x16x32_bf16 v[144:147], a[32:35], v[48:51], v[144:147]
    v_mfma_f32_16x16x32_bf16 v[148:151], a[32:35], v[52:55], v[148:151]
    v_mfma_f32_16x16x32_bf16 v[152:155], a[36:39], v[48:51], v[152:155]
    v_mfma_f32_16x16x32_bf16 v[156:159], a[36:39], v[52:55], v[156:159]
    s_add_u32 s64, s25, 0x5000
    buffer_load_dwordx4 v[48:51], v1, s[4:7], s64 offen
    s_add_u32 s64, s25, 0x25000
    buffer_load_dwordx4 v[52:55], v1, s[4:7], s64 offen
    s_waitcnt vmcnt(30)
    v_mfma_f32_16x16x32_bf16 v[144:147], a[40:43], v[56:59], v[144:147]
    v_mfma_f32_16x16x32_bf16 v[148:151], a[40:43], v[60:63], v[148:151]
    v_mfma_f32_16x16x32_bf16 v[152:155], a[44:47], v[56:59], v[152:155]
    v_mfma_f32_16x16x32_bf16 v[156:159], a[44:47], v[60:63], v[156:159]
    s_add_u32 s64, s25, 0x5400
    buffer_load_dwordx4 v[56:59], v1, s[4:7], s64 offen
    s_add_u32 s64, s25, 0x25400
    buffer_load_dwordx4 v[60:63], v1, s[4:7], s64 offen
    s_waitcnt vmcnt(30)
    v_mfma_f32_16x16x32_bf16 v[144:147], a[48:51], v[64:67], v[144:147]
    v_mfma_f32_16x16x32_bf16 v[148:151], a[48:51], v[68:71], v[148:151]
    v_mfma_f32_16x16x32_bf16 v[152:155], a[52:55], v[64:67], v[152:155]
    v_mfma_f32_16x16x32_bf16 v[156:159], a[52:55], v[68:71], v[156:159]
    s_add_u32 s64, s25, 0x5800
    buffer_load_dwordx4 v[64:67], v1, s[4:7], s64 offen
    s_add_u32 s64, s25, 0x25800
    buffer_load_dwordx4 v[68:71], v1, s[4:7], s64 offen
    s_waitcnt vmcnt(30)
    v_mfma_f32_16x16x32_bf16 v[144:147], a[56:59], v[72:75], v[144:147]
    v_mfma_f32_16x16x32_bf16 v[148:151], a[56:59], v[76:79], v[148:151]
    v_mfma_f32_16x16x32_bf16 v[152:155], a[60:63], v[72:75], v[152:155]
    v_mfma_f32_16x16x32_bf16 v[156:159], a[60:63], v[76:79], v[156:159]
    s_add_u32 s64, s25, 0x5c00
    buffer_load_dwordx4 v[72:75], v1, s[4:7], s64 offen
    s_add_u32 s64, s25, 0x25c00
    buffer_load_dwordx4 v[76:79], v1, s[4:7], s64 offen
    s_waitcnt vmcnt(30)
    v_mfma_f32_16x16x32_bf16 v[144:147], a[64:67], v[80:83], v[144:147]
    v_mfma_f32_16x16x32_bf16 v[148:151], a[64:67], v[84:87], v[148:151]
    v_mfma_f32_16x16x32_bf16 v[152:155], a[68:71], v[80:83], v[152:155]
    v_mfma_f32_16x16x32_bf16 v[156:159], a[68:71], v[84:87], v[156:159]
    s_add_u32 s64, s25, 0x6000
    buffer_load_dwordx4 v[80:83], v1, s[4:7], s64 offen
    s_add_u32 s64, s25, 0x26000
    buffer_load_dwordx4 v[84:87], v1, s[4:7], s64 offen
    s_waitcnt vmcnt(30)
    v_mfma_f32_16x16x32_bf16 v[144:147], a[72:75], v[88:91], v[144:147]
    v_mfma_f32_16x16x32_bf16 v[148:151], a[72:75], v[92:95], v[148:151]
    v_mfma_f32_16x16x32_bf16 v[152:155], a[76:79], v[88:91], v[152:155]
    v_mfma_f32_16x16x32_bf16 v[156:159], a[76:79], v[92:95], v[156:159]
    s_add_u32 s64, s25, 0x6400
    buffer_load_dwordx4 v[88:91], v1, s[4:7], s64 offen
    s_add_u32 s64, s25, 0x26400
    buffer_load_dwordx4 v[92:95], v1, s[4:7], s64 offen
    s_waitcnt vmcnt(30)
    v_mfma_f32_16x16x32_bf16 v[144:147], a[80:83], v[96:99], v[144:147]
    v_mfma_f32_16x16x32_bf16 v[148:151], a[80:83], v[100:103], v[148:151]
    v_mfma_f32_16x16x32_bf16 v[152:155], a[84:87], v[96:99], v[152:155]
    v_mfma_f32_16x16x32_bf16 v[156:159], a[84:87], v[100:103], v[156:159]
    s_add_u32 s64, s25, 0x6800
    buffer_load_dwordx4 v[96:99], v1, s[4:7], s64 offen
    s_add_u32 s64, s25, 0x26800
    buffer_load_dwordx4 v[100:103], v1, s[4:7], s64 offen
    s_waitcnt vmcnt(30)
    v_mfma_f32_16x16x32_bf16 v[144:147], a[88:91], v[104:107], v[144:147]
    v_mfma_f32_16x16x32_bf16 v[148:151], a[88:91], v[108:111], v[148:151]
    v_mfma_f32_16x16x32_bf16 v[152:155], a[92:95], v[104:107], v[152:155]
    v_mfma_f32_16x16x32_bf16 v[156:159], a[92:95], v[108:111], v[156:159]
    s_add_u32 s64, s25, 0x6c00
    buffer_load_dwordx4 v[104:107], v1, s[4:7], s64 offen
    s_add_u32 s64, s25, 0x26c00
    buffer_load_dwordx4 v[108:111], v1, s[4:7], s64 offen
    s_waitcnt vmcnt(30)
    v_mfma_f32_16x16x32_bf16 v[144:147], a[96:99], v[112:115], v[144:147]
    v_mfma_f32_16x16x32_bf16 v[148:151], a[96:99], v[116:119], v[148:151]
    v_mfma_f32_16x16x32_bf16 v[152:155], a[100:103], v[112:115], v[152:155]
    v_mfma_f32_16x16x32_bf16 v[156:159], a[100:103], v[116:119], v[156:159]
    s_add_u32 s64, s25, 0x7000
    buffer_load_dwordx4 v[112:115], v1, s[4:7], s64 offen
    s_add_u32 s64, s25, 0x27000
    buffer_load_dwordx4 v[116:119], v1, s[4:7], s64 offen
    s_waitcnt vmcnt(30)
    v_mfma_f32_16x16x32_bf16 v[144:147], a[104:107], v[120:123], v[144:147]
    v_mfma_f32_16x16x32_bf16 v[148:151], a[104:107], v[124:127], v[148:151]
    v_mfma_f32_16x16x32_bf16 v[152:155], a[108:111], v[120:123], v[152:155]
    v_mfma_f32_16x16x32_bf16 v[156:159], a[108:111], v[124:127], v[156:159]
    s_add_u32 s64, s25, 0x7400
    buffer_load_dwordx4 v[120:123], v1, s[4:7], s64 offen
    s_add_u32 s64, s25, 0x27400
    buffer_load_dwordx4 v[124:127], v1, s[4:7], s64 offen
    s_waitcnt vmcnt(30)
    v_mfma_f32_16x16x32_bf16 v[144:147], a[112:115], v[128:131], v[144:147]
    v_mfma_f32_16x16x32_bf16 v[148:151], a[112:115], v[132:135], v[148:151]
    v_mfma_f32_16x16x32_bf16 v[152:155], a[116:119], v[128:131], v[152:155]
    v_mfma_f32_16x16x32_bf16 v[156:159], a[116:119], v[132:135], v[156:159]
    s_add_u32 s64, s25, 0x7800
    buffer_load_dwordx4 v[128:131], v1, s[4:7], s64 offen
    s_add_u32 s64, s25, 0x27800
    buffer_load_dwordx4 v[132:135], v1, s[4:7], s64 offen
    s_waitcnt vmcnt(30)
    v_mfma_f32_16x16x32_bf16 v[144:147], a[120:123], v[136:139], v[144:147]
    v_mfma_f32_16x16x32_bf16 v[148:151], a[120:123], v[140:143], v[148:151]
    v_mfma_f32_16x16x32_bf16 v[152:155], a[124:127], v[136:139], v[152:155]
    v_mfma_f32_16x16x32_bf16 v[156:159], a[124:127], v[140:143], v[156:159]
    s_add_u32 s64, s25, 0x7c00
    buffer_load_dwordx4 v[136:139], v1, s[4:7], s64 offen
    s_add_u32 s64, s25, 0x27c00
    buffer_load_dwordx4 v[140:143], v1, s[4:7], s64 offen
    s_waitcnt vmcnt(30)
    v_mfma_f32_16x16x32_bf16 v[144:147], a[128:131], v[16:19], v[144:147]
    v_mfma_f32_16x16x32_bf16 v[148:151], a[128:131], v[20:23], v[148:151]
    v_mfma_f32_16x16x32_bf16 v[152:155], a[132:135], v[16:19], v[152:155]
    v_mfma_f32_16x16x32_bf16 v[156:159], a[132:135], v[20:23], v[156:159]
    s_waitcnt vmcnt(28)
    v_mfma_f32_16x16x32_bf16 v[144:147], a[136:139], v[24:27], v[144:147]
    v_mfma_f32_16x16x32_bf16 v[148:151], a[136:139], v[28:31], v[148:151]
    v_mfma_f32_16x16x32_bf16 v[152:155], a[140:143], v[24:27], v[152:155]
    v_mfma_f32_16x16x32_bf16 v[156:159], a[140:143], v[28:31], v[156:159]
    s_waitcnt vmcnt(26)
    v_mfma_f32_16x16x32_bf16 v[144:147], a[144:147], v[32:35], v[144:147]
    v_mfma_f32_16x16x32_bf16 v[148:151], a[144:147], v[36:39], v[148:151]
    v_mfma_f32_16x16x32_bf16 v[152:155], a[148:151], v[32:35], v[152:155]
    v_mfma_f32_16x16x32_bf16 v[156:159], a[148:151], v[36:39], v[156:159]
    s_waitcnt vmcnt(24)
    v_mfma_f32_16x16x32_bf16 v[144:147], a[152:155], v[40:43], v[144:147]
    v_mfma_f32_16x16x32_bf16 v[148:151], a[152:155], v[44:47], v[148:151]
    v_mfma_f32_16x16x32_bf16 v[152:155], a[156:159], v[40:43], v[152:155]
    v_mfma_f32_16x16x32_bf16 v[156:159], a[156:159], v[44:47], v[156:159]
    s_waitcnt vmcnt(22)
    v_mfma_f32_16x16x32_bf16 v[144:147], a[160:163], v[48:51], v[144:147]
    v_mfma_f32_16x16x32_bf16 v[148:151], a[160:163], v[52:55], v[148:151]
    v_mfma_f32_16x16x32_bf16 v[152:155], a[164:167], v[48:51], v[152:155]
    v_mfma_f32_16x16x32_bf16 v[156:159], a[164:167], v[52:55], v[156:159]
    s_waitcnt vmcnt(20)
    v_mfma_f32_16x16x32_bf16 v[144:147], a[168:171], v[56:59], v[144:147]
    v_mfma_f32_16x16x32_bf16 v[148:151], a[168:171], v[60:63], v[148:151]
    v_mfma_f32_16x16x32_bf16 v[152:155], a[172:175], v[56:59], v[152:155]
    v_mfma_f32_16x16x32_bf16 v[156:159], a[172:175], v[60:63], v[156:159]
    s_waitcnt vmcnt(18)
    v_mfma_f32_16x16x32_bf16 v[144:147], a[176:179], v[64:67], v[144:147]
    v_mfma_f32_16x16x32_bf16 v[148:151], a[176:179], v[68:71], v[148:151]
    v_mfma_f32_16x16x32_bf16 v[152:155], a[180:183], v[64:67], v[152:155]
    v_mfma_f32_16x16x32_bf16 v[156:159], a[180:183], v[68:71], v[156:159]
    s_waitcnt vmcnt(16)
    v_mfma_f32_16x16x32_bf16 v[144:147], a[184:187], v[72:75], v[144:147]
    v_mfma_f32_16x16x32_bf16 v[148:151], a[184:187], v[76:79], v[148:151]
    v_mfma_f32_16x16x32_bf16 v[152:155], a[188:191], v[72:75], v[152:155]
    v_mfma_f32_16x16x32_bf16 v[156:159], a[188:191], v[76:79], v[156:159]
    s_waitcnt vmcnt(14)
    v_mfma_f32_16x16x32_bf16 v[144:147], a[192:195], v[80:83], v[144:147]
    v_mfma_f32_16x16x32_bf16 v[148:151], a[192:195], v[84:87], v[148:151]
    v_mfma_f32_16x16x32_bf16 v[152:155], a[196:199], v[80:83], v[152:155]
    v_mfma_f32_16x16x32_bf16 v[156:159], a[196:199], v[84:87], v[156:159]
    s_waitcnt vmcnt(12)
    v_mfma_f32_16x16x32_bf16 v[144:147], a[200:203], v[88:91], v[144:147]
    v_mfma_f32_16x16x32_bf16 v[148:151], a[200:203], v[92:95], v[148:151]
    v_mfma_f32_16x16x32_bf16 v[152:155], a[204:207], v[88:91], v[152:155]
    v_mfma_f32_16x16x32_bf16 v[156:159], a[204:207], v[92:95], v[156:159]
    s_waitcnt vmcnt(10)
    v_mfma_f32_16x16x32_bf16 v[144:147], a[208:211], v[96:99], v[144:147]
    v_mfma_f32_16x16x32_bf16 v[148:151], a[208:211], v[100:103], v[148:151]
    v_mfma_f32_16x16x32_bf16 v[152:155], a[212:215], v[96:99], v[152:155]
    v_mfma_f32_16x16x32_bf16 v[156:159], a[212:215], v[100:103], v[156:159]
    s_waitcnt vmcnt(8)
    v_mfma_f32_16x16x32_bf16 v[144:147], a[216:219], v[104:107], v[144:147]
    v_mfma_f32_16x16x32_bf16 v[148:151], a[216:219], v[108:111], v[148:151]
    v_mfma_f32_16x16x32_bf16 v[152:155], a[220:223], v[104:107], v[152:155]
    v_mfma_f32_16x16x32_bf16 v[156:159], a[220:223], v[108:111], v[156:159]
    s_waitcnt vmcnt(6)
    v_mfma_f32_16x16x32_bf16 v[144:147], a[224:227], v[112:115], v[144:147]
    v_mfma_f32_16x16x32_bf16 v[148:151], a[224:227], v[116:119], v[148:151]
    v_mfma_f32_16x16x32_bf16 v[152:155], a[228:231], v[112:115], v[152:155]
    v_mfma_f32_16x16x32_bf16 v[156:159], a[228:231], v[116:119], v[156:159]
    s_waitcnt vmcnt(4)
    v_mfma_f32_16x16x32_bf16 v[144:147], a[232:235], v[120:123], v[144:147]
    v_mfma_f32_16x16x32_bf16 v[148:151], a[232:235], v[124:127], v[148:151]
    v_mfma_f32_16x16x32_bf16 v[152:155], a[236:239], v[120:123], v[152:155]
    v_mfma_f32_16x16x32_bf16 v[156:159], a[236:239], v[124:127], v[156:159]
    s_waitcnt vmcnt(2)
    v_mfma_f32_16x16x32_bf16 v[144:147], a[240:243], v[128:131], v[144:147]
    v_mfma_f32_16x16x32_bf16 v[148:151], a[240:243], v[132:135], v[148:151]
    v_mfma_f32_16x16x32_bf16 v[152:155], a[244:247], v[128:131], v[152:155]
    v_mfma_f32_16x16x32_bf16 v[156:159], a[244:247], v[132:135], v[156:159]
    s_waitcnt vmcnt(0)
    v_mfma_f32_16x16x32_bf16 v[144:147], a[248:251], v[136:139], v[144:147]
    v_mfma_f32_16x16x32_bf16 v[148:151], a[248:251], v[140:143], v[148:151]
    v_mfma_f32_16x16x32_bf16 v[152:155], a[252:255], v[136:139], v[152:155]
    v_mfma_f32_16x16x32_bf16 v[156:159], a[252:255], v[140:143], v[156:159]
    s_lshl_b32 s64, s14, 12
    v_add_u32 v7, s64, v1
    s_barrier
    s_nop 3
    ds_write_b128 v7, v[144:147] offset:0
    ds_write_b128 v7, v[148:151] offset:1024
    ds_write_b128 v7, v[152:155] offset:2048
    ds_write_b128 v7, v[156:159] offset:3072
    v_mov_b32 v13, 16384
    s_cmp_lg_u32 s14, 0
    s_cbranch_scc1 OW0_136
    ds_write_b32 v13, v12
OW0_136:
    s_waitcnt lgkmcnt(0)
    s_barrier
    ds_read_b32 v12, v13
    s_waitcnt lgkmcnt(0)
    v_readfirstlane_b32 s64, v12
    s_cmp_lt_u32 s64, 40
    s_cselect_b64 s[82:83], s[82:83], 0
    s_lshl_b32 s64, s14, 10
    v_add_u32 v7, s64, v1
    ds_read_b128 v[16:19], v7 offset:0
    ds_read_b128 v[20:23], v7 offset:4096
    ds_read_b128 v[24:27], v7 offset:8192
    ds_read_b128 v[28:31], v7 offset:12288
    s_waitcnt lgkmcnt(0)
    v_add_f32 v16, v16, v20
    v_add_f32 v24, v24, v28
    v_add_f32 v16, v16, v24
    v_add_f32 v17, v17, v21
    v_add_f32 v25, v25, v29
    v_add_f32 v17, v17, v25
    v_add_f32 v18, v18, v22
    v_add_f32 v26, v26, v30
    v_add_f32 v18, v18, v26
    v_add_f32 v19, v19, v23
    v_add_f32 v27, v27, v31
    v_add_f32 v19, v19, v27
    v_cvt_pk_bf16_f32 v16, v16, v16
    v_lshlrev_b32 v16, 16, v16
    v_cvt_pk_bf16_f32 v17, v17, v17
    v_lshlrev_b32 v17, 16, v17
    v_cvt_pk_bf16_f32 v18, v18, v18
    v_lshlrev_b32 v18, 16, v18
    v_cvt_pk_bf16_f32 v19, v19, v19
    v_lshlrev_b32 v19, 16, v19
    v_lshlrev_b32 v20, 16, v162
    v_and_b32 v21, 0xffff0000, v162
    v_lshlrev_b32 v24, 16, v160
    v_and_b32 v25, 0xffff0000, v160
    v_lshlrev_b32 v22, 16, v163
    v_and_b32 v23, 0xffff0000, v163
    v_lshlrev_b32 v26, 16, v161
    v_and_b32 v27, 0xffff0000, v161
    s_lshl_b32 s64, s24, 5
    v_add_u32 v8, s64, v9
    v_mov_b32 v10, -1
    v_cmp_eq_u32 vcc, s72, v8
    s_nop 1
    v_cndmask_b32 v10, v10, 0, vcc
    v_cmp_eq_u32 vcc, s73, v8
    s_nop 1
    v_cndmask_b32 v10, v10, 1, vcc
    v_cmp_eq_u32 vcc, s74, v8
    s_nop 1
    v_cndmask_b32 v10, v10, 2, vcc
    v_cmp_eq_u32 vcc, s75, v8
    s_nop 1
    v_cndmask_b32 v10, v10, 3, vcc
    v_cmp_eq_u32 vcc, s76, v8
    s_nop 1
    v_cndmask_b32 v10, v10, 4, vcc
    v_cmp_eq_u32 vcc, s77, v8
    s_nop 1
    v_cndmask_b32 v10, v10, 5, vcc
    v_cmp_eq_u32 vcc, s78, v8
    s_nop 1
    v_cndmask_b32 v10, v10, 6, vcc
    v_cmp_eq_u32 vcc, s79, v8
    s_nop 1
    v_cndmask_b32 v10, v10, 7, vcc
    v_cmp_le_i32 vcc, 0, v10
    s_and_saveexec_b64 s[68:69], vcc
    s_cbranch_execz NOUPD_138
    v_mul_u32_u24 v10, 2560, v10
    v_lshrrev_b32 v11, 4, v0
    v_lshl_add_u32 v10, v11, 4, v10
    s_lshl_b32 s64, s86, 6
    s_lshl_b32 s65, s13, 7
    s_add_u32 s64, s64, s65
    s_add_u32 s64, s64, 0x5410000
    buffer_load_dwordx4 v[164:167], v10, s[4:7], s64 offen sc1
    s_waitcnt vmcnt(0)
    v_add_f32 v20, v20, v164
    v_cvt_pk_bf16_f32 v20, v20, v20
    v_lshlrev_b32 v20, 16, v20
    v_add_f32 v21, v21, v165
    v_cvt_pk_bf16_f32 v21, v21, v21
    v_lshlrev_b32 v21, 16, v21
    v_add_f32 v22, v22, v166
    v_cvt_pk_bf16_f32 v22, v22, v22
    v_lshlrev_b32 v22, 16, v22
    v_add_f32 v23, v23, v167
    v_cvt_pk_bf16_f32 v23, v23, v23
    v_lshlrev_b32 v23, 16, v23
NOUPD_138:
    s_mov_b64 exec, -1
    v_mul_f32 v28, 0xbfb8aa3b, v20
    v_exp_f32 v28, v28
    s_nop 0
    v_add_f32 v28, 1.0, v28
    v_rcp_f32 v28, v28
    s_nop 0
    v_mul_f32 v28, v28, v20
    v_cvt_pk_bf16_f32 v28, v28, v28
    v_lshlrev_b32 v28, 16, v28
    v_mul_f32 v28, v28, v16
    v_cvt_pk_bf16_f32 v28, v28, v28
    v_lshlrev_b32 v28, 16, v28
    v_add_f32 v28, v28, v24
    v_mul_f32 v29, 0xbfb8aa3b, v21
    v_exp_f32 v29, v29
    s_nop 0
    v_add_f32 v29, 1.0, v29
    v_rcp_f32 v29, v29
    s_nop 0
    v_mul_f32 v29, v29, v21
    v_cvt_pk_bf16_f32 v29, v29, v29
    v_lshlrev_b32 v29, 16, v29
    v_mul_f32 v29, v29, v17
    v_cvt_pk_bf16_f32 v29, v29, v29
    v_lshlrev_b32 v29, 16, v29
    v_add_f32 v29, v29, v25
    v_mul_f32 v30, 0xbfb8aa3b, v22
    v_exp_f32 v30, v30
    s_nop 0
    v_add_f32 v30, 1.0, v30
    v_rcp_f32 v30, v30
    s_nop 0
    v_mul_f32 v30, v30, v22
    v_cvt_pk_bf16_f32 v30, v30, v30
    v_lshlrev_b32 v30, 16, v30
    v_mul_f32 v30, v30, v18
    v_cvt_pk_bf16_f32 v30, v30, v30
    v_lshlrev_b32 v30, 16, v30
    v_add_f32 v30, v30, v26
    v_mul_f32 v31, 0xbfb8aa3b, v23
    v_exp_f32 v31, v31
    s_nop 0
    v_add_f32 v31, 1.0, v31
    v_rcp_f32 v31, v31
    s_nop 0
    v_mul_f32 v31, v31, v23
    v_cvt_pk_bf16_f32 v31, v31, v31
    v_lshlrev_b32 v31, 16, v31
    v_mul_f32 v31, v31, v19
    v_cvt_pk_bf16_f32 v31, v31, v31
    v_lshlrev_b32 v31, 16, v31
    v_add_f32 v31, v31, v27
    v_cvt_pk_bf16_f32 v164, v28, v29
    v_cvt_pk_bf16_f32 v165, v30, v31
    buffer_store_dwordx2 v[164:165], v5, s[52:55], s67 offen
OTD_137:
    s_branch OU_LOOP
OU_END:
    s_cmp_lg_u32 s12, 2
    s_cbranch_scc1 OU_X
    v_mov_b32 v8, 0
    s_mov_b32 s64, 0x298100
OUW_139:
    buffer_load_dword v7, v8, s[4:7], s64 offen sc1
    s_add_u32 s29, s29, 1
    s_waitcnt vmcnt(0)
    v_cmp_gt_u32 vcc, 40, v7
    s_cbranch_vccz OUWD_140
    s_cmp_gt_u32 s29, 262144
    s_cbranch_scc1 OUWD_140
    s_sleep 8
    s_branch OUW_139
OUWD_140:
    s_mov_b32 s24, 62
    s_mov_b32 s87, 0
    s_and_b32 s86, s14, 1
    s_lshl_b32 s64, s87, 4
    v_and_b32 v6, 15, v0
    v_add_u32 v6, s64, v6
    v_mov_b32 v9, v6
    v_mul_u32_u24 v5, 1280, v6
    v_lshrrev_b32 v6, 4, v0
    v_lshl_add_u32 v5, v6, 3, v5
    s_and_b32 s64, s14, 1
    s_lshl_b32 s64, s64, 5
    s_lshl_b32 s65, s13, 6
    s_add_u32 s64, s64, s65
    v_add_u32 v5, s64, v5
    s_mul_i32 s67, s24, 40960
    buffer_load_dwordx2 v[160:161], v5, s[48:51], s67 offen
    s_add_u32 s64, s67, 0x0
    buffer_load_dwordx2 v[162:163], v5, s[4:7], s64 offen
    s_lshl_b32 s64, s24, 7
    s_add_u32 s64, s64, 0x296000
    s_mov_b64 exec, s[36:37]
OUH_F_141:
    buffer_load_dword v7, v6, s[4:7], s64 offen sc1
    s_add_u32 s29, s29, 1
    s_waitcnt vmcnt(0)
    v_cmp_eq_u32 vcc, 0, v7
    s_cbranch_vccz OUH_FD_142
    s_cmp_gt_u32 s29, 262144
    s_cbranch_scc1 OUH_FD_142
    s_sleep 1
    s_branch OUH_F_141
OUH_FD_142:
    s_mov_b64 exec, -1
    s_lshl_b32 s25, s24, 18
    s_lshl_b32 s64, s14, 15
    s_add_u32 s25, s25, s64
    s_add_u32 s25, s25, 0x4400000
    s_lshl_b32 s64, s87, 17
    s_add_u32 s25, s25, s64
    s_add_u32 s64, s25, 0x0
    buffer_load_dwordx4 v[16:19], v1, s[4:7], s64 offen
    s_add_u32 s64, s25, 0x400
    buffer_load_dwordx4 v[20:23], v1, s[4:7], s64 offen
    s_add_u32 s64, s25, 0x800
    buffer_load_dwordx4 v[24:27], v1, s[4:7], s64 offen
    s_add_u32 s64, s25, 0xc00
    buffer_load_dwordx4 v[28:31], v1, s[4:7], s64 offen
    s_add_u32 s64, s25, 0x1000
    buffer_load_dwordx4 v[32:35], v1, s[4:7], s64 offen
    s_add_u32 s64, s25, 0x1400
    buffer_load_dwordx4 v[36:39], v1, s[4:7], s64 offen
    s_add_u32 s64, s25, 0x1800
    buffer_load_dwordx4 v[40:43], v1, s[4:7], s64 offen
    s_add_u32 s64, s25, 0x1c00
    buffer_load_dwordx4 v[44:47], v1, s[4:7], s64 offen
    s_add_u32 s64, s25, 0x2000
    buffer_load_dwordx4 v[48:51], v1, s[4:7], s64 offen
    s_add_u32 s64, s25, 0x2400
    buffer_load_dwordx4 v[52:55], v1, s[4:7], s64 offen
    s_add_u32 s64, s25, 0x2800
    buffer_load_dwordx4 v[56:59], v1, s[4:7], s64 offen
    s_add_u32 s64, s25, 0x2c00
    buffer_load_dwordx4 v[60:63], v1, s[4:7], s64 offen
    s_add_u32 s64, s25, 0x3000
    buffer_load_dwordx4 v[64:67], v1, s[4:7], s64 offen
    s_add_u32 s64, s25, 0x3400
    buffer_load_dwordx4 v[68:71], v1, s[4:7], s64 offen
    s_add_u32 s64, s25, 0x3800
    buffer_load_dwordx4 v[72:75], v1, s[4:7], s64 offen
    s_add_u32 s64, s25, 0x3c00
    buffer_load_dwordx4 v[76:79], v1, s[4:7], s64 offen
    s_add_u32 s64, s25, 0x4000
    buffer_load_dwordx4 v[80:83], v1, s[4:7], s64 offen
    s_add_u32 s64, s25, 0x4400
    buffer_load_dwordx4 v[84:87], v1, s[4:7], s64 offen
    s_add_u32 s64, s25, 0x4800
    buffer_load_dwordx4 v[88:91], v1, s[4:7], s64 offen
    s_add_u32 s64, s25, 0x4c00
    buffer_load_dwordx4 v[92:95], v1, s[4:7], s64 offen
    s_add_u32 s64, s25, 0x5000
    buffer_load_dwordx4 v[96:99], v1, s[4:7], s64 offen
    s_add_u32 s64, s25, 0x5400
    buffer_load_dwordx4 v[100:103], v1, s[4:7], s64 offen
    s_add_u32 s64, s25, 0x5800
    buffer_load_dwordx4 v[104:107], v1, s[4:7], s64 offen
    s_add_u32 s64, s25, 0x5c00
    buffer_load_dwordx4 v[108:111], v1, s[4:7], s64 offen
    s_add_u32 s64, s25, 0x6000
    buffer_load_dwordx4 v[112:115], v1, s[4:7], s64 offen
    s_add_u32 s64, s25, 0x6400
    buffer_load_dwordx4 v[116:119], v1, s[4:7], s64 offen
    s_add_u32 s64, s25, 0x6800
    buffer_load_dwordx4 v[120:123], v1, s[4:7], s64 offen
    s_add_u32 s64, s25, 0x6c00
    buffer_load_dwordx4 v[124:127], v1, s[4:7], s64 offen
    s_add_u32 s64, s25, 0x7000
    buffer_load_dwordx4 v[128:131], v1, s[4:7], s64 offen
    s_add_u32 s64, s25, 0x7400
    buffer_load_dwordx4 v[132:135], v1, s[4:7], s64 offen
    s_add_u32 s64, s25, 0x7800
    buffer_load_dwordx4 v[136:139], v1, s[4:7], s64 offen
    s_add_u32 s64, s25, 0x7c00
    buffer_load_dwordx4 v[140:143], v1, s[4:7], s64 offen
    s_waitcnt vmcnt(31)
    v_mfma_f32_16x16x32_bf16 v[144:147], a[0:3], v[16:19], 0
    v_mfma_f32_16x16x32_bf16 v[148:151], a[4:7], v[16:19], 0
    s_waitcnt vmcnt(30)
    v_mfma_f32_16x16x32_bf16 v[144:147], a[8:11], v[20:23], v[144:147]
    v_mfma_f32_16x16x32_bf16 v[148:151], a[12:15], v[20:23], v[148:151]
    s_waitcnt vmcnt(29)
    v_mfma_f32_16x16x32_bf16 v[144:147], a[16:19], v[24:27], v[144:147]
    v_mfma_f32_16x16x32_bf16 v[148:151], a[20:23], v[24:27], v[148:151]
    s_waitcnt vmcnt(28)
    v_mfma_f32_16x16x32_bf16 v[144:147], a[24:27], v[28:31], v[144:147]
    v_mfma_f32_16x16x32_bf16 v[148:151], a[28:31], v[28:31], v[148:151]
    s_waitcnt vmcnt(27)
    v_mfma_f32_16x16x32_bf16 v[144:147], a[32:35], v[32:35], v[144:147]
    v_mfma_f32_16x16x32_bf16 v[148:151], a[36:39], v[32:35], v[148:151]
    s_waitcnt vmcnt(26)
    v_mfma_f32_16x16x32_bf16 v[144:147], a[40:43], v[36:39], v[144:147]
    v_mfma_f32_16x16x32_bf16 v[148:151], a[44:47], v[36:39], v[148:151]
    s_waitcnt vmcnt(25)
    v_mfma_f32_16x16x32_bf16 v[144:147], a[48:51], v[40:43], v[144:147]
    v_mfma_f32_16x16x32_bf16 v[148:151], a[52:55], v[40:43], v[148:151]
    s_waitcnt vmcnt(24)
    v_mfma_f32_16x16x32_bf16 v[144:147], a[56:59], v[44:47], v[144:147]
    v_mfma_f32_16x16x32_bf16 v[148:151], a[60:63], v[44:47], v[148:151]
    s_waitcnt vmcnt(23)
    v_mfma_f32_16x16x32_bf16 v[144:147], a[64:67], v[48:51], v[144:147]
    v_mfma_f32_16x16x32_bf16 v[148:151], a[68:71], v[48:51], v[148:151]
    s_waitcnt vmcnt(22)
    v_mfma_f32_16x16x32_bf16 v[144:147], a[72:75], v[52:55], v[144:147]
    v_mfma_f32_16x16x32_bf16 v[148:151], a[76:79], v[52:55], v[148:151]
    s_waitcnt vmcnt(21)
    v_mfma_f32_16x16x32_bf16 v[144:147], a[80:83], v[56:59], v[144:147]
    v_mfma_f32_16x16x32_bf16 v[148:151], a[84:87], v[56:59], v[148:151]
    s_waitcnt vmcnt(20)
    v_mfma_f32_16x16x32_bf16 v[144:147], a[88:91], v[60:63], v[144:147]
    v_mfma_f32_16x16x32_bf16 v[148:151], a[92:95], v[60:63], v[148:151]
    s_waitcnt vmcnt(19)
    v_mfma_f32_16x16x32_bf16 v[144:147], a[96:99], v[64:67], v[144:147]
    v_mfma_f32_16x16x32_bf16 v[148:151], a[100:103], v[64:67], v[148:151]
    s_waitcnt vmcnt(18)
    v_mfma_f32_16x16x32_bf16 v[144:147], a[104:107], v[68:71], v[144:147]
    v_mfma_f32_16x16x32_bf16 v[148:151], a[108:111], v[68:71], v[148:151]
    s_waitcnt vmcnt(17)
    v_mfma_f32_16x16x32_bf16 v[144:147], a[112:115], v[72:75], v[144:147]
    v_mfma_f32_16x16x32_bf16 v[148:151], a[116:119], v[72:75], v[148:151]
    s_waitcnt vmcnt(16)
    v_mfma_f32_16x16x32_bf16 v[144:147], a[120:123], v[76:79], v[144:147]
    v_mfma_f32_16x16x32_bf16 v[148:151], a[124:127], v[76:79], v[148:151]
    s_waitcnt vmcnt(15)
    v_mfma_f32_16x16x32_bf16 v[144:147], a[128:131], v[80:83], v[144:147]
    v_mfma_f32_16x16x32_bf16 v[148:151], a[132:135], v[80:83], v[148:151]
    s_waitcnt vmcnt(14)
    v_mfma_f32_16x16x32_bf16 v[144:147], a[136:139], v[84:87], v[144:147]
    v_mfma_f32_16x16x32_bf16 v[148:151], a[140:143], v[84:87], v[148:151]
    s_waitcnt vmcnt(13)
    v_mfma_f32_16x16x32_bf16 v[144:147], a[144:147], v[88:91], v[144:147]
    v_mfma_f32_16x16x32_bf16 v[148:151], a[148:151], v[88:91], v[148:151]
    s_waitcnt vmcnt(12)
    v_mfma_f32_16x16x32_bf16 v[144:147], a[152:155], v[92:95], v[144:147]
    v_mfma_f32_16x16x32_bf16 v[148:151], a[156:159], v[92:95], v[148:151]
    s_waitcnt vmcnt(11)
    v_mfma_f32_16x16x32_bf16 v[144:147], a[160:163], v[96:99], v[144:147]
    v_mfma_f32_16x16x32_bf16 v[148:151], a[164:167], v[96:99], v[148:151]
    s_waitcnt vmcnt(10)
    v_mfma_f32_16x16x32_bf16 v[144:147], a[168:171], v[100:103], v[144:147]
    v_mfma_f32_16x16x32_bf16 v[148:151], a[172:175], v[100:103], v[148:151]
    s_waitcnt vmcnt(9)
    v_mfma_f32_16x16x32_bf16 v[144:147], a[176:179], v[104:107], v[144:147]
    v_mfma_f32_16x16x32_bf16 v[148:151], a[180:183], v[104:107], v[148:151]
    s_waitcnt vmcnt(8)
    v_mfma_f32_16x16x32_bf16 v[144:147], a[184:187], v[108:111], v[144:147]
    v_mfma_f32_16x16x32_bf16 v[148:151], a[188:191], v[108:111], v[148:151]
    s_waitcnt vmcnt(7)
    v_mfma_f32_16x16x32_bf16 v[144:147], a[192:195], v[112:115], v[144:147]
    v_mfma_f32_16x16x32_bf16 v[148:151], a[196:199], v[112:115], v[148:151]
    s_waitcnt vmcnt(6)
    v_mfma_f32_16x16x32_bf16 v[144:147], a[200:203], v[116:119], v[144:147]
    v_mfma_f32_16x16x32_bf16 v[148:151], a[204:207], v[116:119], v[148:151]
    s_waitcnt vmcnt(5)
    v_mfma_f32_16x16x32_bf16 v[144:147], a[208:211], v[120:123], v[144:147]
    v_mfma_f32_16x16x32_bf16 v[148:151], a[212:215], v[120:123], v[148:151]
    s_waitcnt vmcnt(4)
    v_mfma_f32_16x16x32_bf16 v[144:147], a[216:219], v[124:127], v[144:147]
    v_mfma_f32_16x16x32_bf16 v[148:151], a[220:223], v[124:127], v[148:151]
    s_waitcnt vmcnt(3)
    v_mfma_f32_16x16x32_bf16 v[144:147], a[224:227], v[128:131], v[144:147]
    v_mfma_f32_16x16x32_bf16 v[148:151], a[228:231], v[128:131], v[148:151]
    s_waitcnt vmcnt(2)
    v_mfma_f32_16x16x32_bf16 v[144:147], a[232:235], v[132:135], v[144:147]
    v_mfma_f32_16x16x32_bf16 v[148:151], a[236:239], v[132:135], v[148:151]
    s_waitcnt vmcnt(1)
    v_mfma_f32_16x16x32_bf16 v[144:147], a[240:243], v[136:139], v[144:147]
    v_mfma_f32_16x16x32_bf16 v[148:151], a[244:247], v[136:139], v[148:151]
    s_waitcnt vmcnt(0)
    v_mfma_f32_16x16x32_bf16 v[144:147], a[248:251], v[140:143], v[144:147]
    v_mfma_f32_16x16x32_bf16 v[148:151], a[252:255], v[140:143], v[148:151]
    s_lshl_b32 s64, s14, 12
    v_add_u32 v7, s64, v1
    s_barrier
    s_nop 3
    ds_write_b128 v7, v[144:147] offset:0
    ds_write_b128 v7, v[148:151] offset:1024
    s_waitcnt lgkmcnt(0)
    s_barrier
    s_cmp_ge_u32 s14, 2
    s_cbranch_scc1 OTD_143
    s_lshl_b32 s64, s14, 10
    v_add_u32 v7, s64, v1
    ds_read_b128 v[16:19], v7 offset:0
    ds_read_b128 v[20:23], v7 offset:4096
    ds_read_b128 v[24:27], v7 offset:8192
    ds_read_b128 v[28:31], v7 offset:12288
    s_waitcnt lgkmcnt(0)
    v_add_f32 v16, v16, v20
    v_add_f32 v24, v24, v28
    v_add_f32 v16, v16, v24
    v_add_f32 v17, v17, v21
    v_add_f32 v25, v25, v29
    v_add_f32 v17, v17, v25
    v_add_f32 v18, v18, v22
    v_add_f32 v26, v26, v30
    v_add_f32 v18, v18, v26
    v_add_f32 v19, v19, v23
    v_add_f32 v27, v27, v31
    v_add_f32 v19, v19, v27
    v_cvt_pk_bf16_f32 v16, v16, v16
    v_lshlrev_b32 v16, 16, v16
    v_cvt_pk_bf16_f32 v17, v17, v17
    v_lshlrev_b32 v17, 16, v17
    v_cvt_pk_bf16_f32 v18, v18, v18
    v_lshlrev_b32 v18, 16, v18
    v_cvt_pk_bf16_f32 v19, v19, v19
    v_lshlrev_b32 v19, 16, v19
    v_lshlrev_b32 v20, 16, v162
    v_and_b32 v21, 0xffff0000, v162
    v_lshlrev_b32 v24, 16, v160
    v_and_b32 v25, 0xffff0000, v160
    v_lshlrev_b32 v22, 16, v163
    v_and_b32 v23, 0xffff0000, v163
    v_lshlrev_b32 v26, 16, v161
    v_and_b32 v27, 0xffff0000, v161
    s_lshl_b32 s64, s24, 5
    v_add_u32 v8, s64, v9
    v_mov_b32 v10, -1
    v_cmp_eq_u32 vcc, s72, v8
    s_nop 1
    v_cndmask_b32 v10, v10, 0, vcc
    v_cmp_eq_u32 vcc, s73, v8
    s_nop 1
    v_cndmask_b32 v10, v10, 1, vcc
    v_cmp_eq_u32 vcc, s74, v8
    s_nop 1
    v_cndmask_b32 v10, v10, 2, vcc
    v_cmp_eq_u32 vcc, s75, v8
    s_nop 1
    v_cndmask_b32 v10, v10, 3, vcc
    v_cmp_eq_u32 vcc, s76, v8
    s_nop 1
    v_cndmask_b32 v10, v10, 4, vcc
    v_cmp_eq_u32 vcc, s77, v8
    s_nop 1
    v_cndmask_b32 v10, v10, 5, vcc
    v_cmp_eq_u32 vcc, s78, v8
    s_nop 1
    v_cndmask_b32 v10, v10, 6, vcc
    v_cmp_eq_u32 vcc, s79, v8
    s_nop 1
    v_cndmask_b32 v10, v10, 7, vcc
    v_cmp_le_i32 vcc, 0, v10
    s_and_saveexec_b64 s[68:69], vcc
    s_cbranch_execz NOUPD_144
    v_mul_u32_u24 v10, 2560, v10
    v_lshrrev_b32 v11, 4, v0
    v_lshl_add_u32 v10, v11, 4, v10
    s_lshl_b32 s64, s86, 6
    s_lshl_b32 s65, s13, 7
    s_add_u32 s64, s64, s65
    s_add_u32 s64, s64, 0x5410000
    buffer_load_dwordx4 v[164:167], v10, s[4:7], s64 offen sc1
    s_waitcnt vmcnt(0)
    v_add_f32 v20, v20, v164
    v_cvt_pk_bf16_f32 v20, v20, v20
    v_lshlrev_b32 v20, 16, v20
    v_add_f32 v21, v21, v165
    v_cvt_pk_bf16_f32 v21, v21, v21
    v_lshlrev_b32 v21, 16, v21
    v_add_f32 v22, v22, v166
    v_cvt_pk_bf16_f32 v22, v22, v22
    v_lshlrev_b32 v22, 16, v22
    v_add_f32 v23, v23, v167
    v_cvt_pk_bf16_f32 v23, v23, v23
    v_lshlrev_b32 v23, 16, v23
NOUPD_144:
    s_mov_b64 exec, -1
    v_mul_f32 v28, 0xbfb8aa3b, v20
    v_exp_f32 v28, v28
    s_nop 0
    v_add_f32 v28, 1.0, v28
    v_rcp_f32 v28, v28
    s_nop 0
    v_mul_f32 v28, v28, v20
    v_cvt_pk_bf16_f32 v28, v28, v28
    v_lshlrev_b32 v28, 16, v28
    v_mul_f32 v28, v28, v16
    v_cvt_pk_bf16_f32 v28, v28, v28
    v_lshlrev_b32 v28, 16, v28
    v_add_f32 v28, v28, v24
    v_mul_f32 v29, 0xbfb8aa3b, v21
    v_exp_f32 v29, v29
    s_nop 0
    v_add_f32 v29, 1.0, v29
    v_rcp_f32 v29, v29
    s_nop 0
    v_mul_f32 v29, v29, v21
    v_cvt_pk_bf16_f32 v29, v29, v29
    v_lshlrev_b32 v29, 16, v29
    v_mul_f32 v29, v29, v17
    v_cvt_pk_bf16_f32 v29, v29, v29
    v_lshlrev_b32 v29, 16, v29
    v_add_f32 v29, v29, v25
    v_mul_f32 v30, 0xbfb8aa3b, v22
    v_exp_f32 v30, v30
    s_nop 0
    v_add_f32 v30, 1.0, v30
    v_rcp_f32 v30, v30
    s_nop 0
    v_mul_f32 v30, v30, v22
    v_cvt_pk_bf16_f32 v30, v30, v30
    v_lshlrev_b32 v30, 16, v30
    v_mul_f32 v30, v30, v18
    v_cvt_pk_bf16_f32 v30, v30, v30
    v_lshlrev_b32 v30, 16, v30
    v_add_f32 v30, v30, v26
    v_mul_f32 v31, 0xbfb8aa3b, v23
    v_exp_f32 v31, v31
    s_nop 0
    v_add_f32 v31, 1.0, v31
    v_rcp_f32 v31, v31
    s_nop 0
    v_mul_f32 v31, v31, v23
    v_cvt_pk_bf16_f32 v31, v31, v31
    v_lshlrev_b32 v31, 16, v31
    v_mul_f32 v31, v31, v19
    v_cvt_pk_bf16_f32 v31, v31, v31
    v_lshlrev_b32 v31, 16, v31
    v_add_f32 v31, v31, v27
    v_cvt_pk_bf16_f32 v164, v28, v29
    v_cvt_pk_bf16_f32 v165, v30, v31
    buffer_store_dwordx2 v[164:165], v5, s[52:55], s67 offen
OTD_143:
OU_X:
    s_branch M_EXIT
H_EXTRA:
    s_mul_hi_u32 s12, s88, 0xccccccd
    s_mul_i32 s65, s12, 20
    s_sub_u32 s13, s88, s65
    s_add_u32 s12, s12, 3
    s_load_dwordx2 s[48:49], s[0:1], 0
    s_mov_b32 s50, 0x280000
    s_mov_b32 s51, 0x00020000
    s_load_dwordx2 s[52:53], s[0:1], 96
    s_mov_b32 s54, 0x280000
    s_mov_b32 s55, 0x00020000
    s_mov_b32 s36, -1
    s_mov_b32 s37, 0
    s_waitcnt lgkmcnt(0)
    v_mbcnt_lo_u32_b32 v0, -1, 0
    v_mbcnt_hi_u32_b32 v0, -1, v0
    s_mov_b32 s29, 0
    v_lshlrev_b32 v1, 4, v0
    v_lshlrev_b32 v6, 2, v0
    v_mov_b32 v8, 0
    s_mov_b32 s64, 0x298100
OXW_145:
    buffer_load_dword v7, v8, s[4:7], s64 offen sc1
    s_add_u32 s29, s29, 1
    s_waitcnt vmcnt(0)
    v_cmp_gt_u32 vcc, 40, v7
    s_cbranch_vccz OXWD_146
    s_cmp_gt_u32 s29, 262144
    s_cbranch_scc1 OXWD_146
    s_sleep 8
    s_branch OXW_145
OXWD_146:
    v_lshlrev_b32 v6, 2, v0
    s_mov_b32 s64, 0x5400000
    buffer_load_dword v7, v6, s[4:7], s64 offen sc1
    s_waitcnt vmcnt(0)
    v_readlane_b32 s72, v7, 0
    v_readlane_b32 s73, v7, 1
    v_readlane_b32 s74, v7, 2
    v_readlane_b32 s75, v7, 3
    v_readlane_b32 s76, v7, 4
    v_readlane_b32 s77, v7, 5
    v_readlane_b32 s78, v7, 6
    v_readlane_b32 s79, v7, 7
    s_cmp_eq_u32 s12, 3
    s_cselect_b32 s24, 62, 63
    s_cmp_eq_u32 s12, 4
    s_cselect_b32 s87, 0, 1
    s_and_b32 s86, s14, 1
    s_lshl_b32 s64, s87, 4
    v_and_b32 v6, 15, v0
    v_add_u32 v6, s64, v6
    v_mov_b32 v9, v6
    v_mul_u32_u24 v5, 1280, v6
    v_lshrrev_b32 v6, 4, v0
    v_lshl_add_u32 v5, v6, 3, v5
    s_and_b32 s64, s14, 1
    s_lshl_b32 s64, s64, 5
    s_lshl_b32 s65, s13, 6
    s_add_u32 s64, s64, s65
    v_add_u32 v5, s64, v5
    s_mul_i32 s67, s24, 40960
    buffer_load_dwordx2 v[160:161], v5, s[48:51], s67 offen
    s_add_u32 s64, s67, 0x0
    buffer_load_dwordx2 v[162:163], v5, s[4:7], s64 offen
    s_lshl_b32 s64, s24, 7
    s_add_u32 s64, s64, 0x296000
    s_mov_b64 exec, s[36:37]
OX_F_147:
    buffer_load_dword v7, v6, s[4:7], s64 offen sc1
    s_add_u32 s29, s29, 1
    s_waitcnt vmcnt(0)
    v_cmp_eq_u32 vcc, 0, v7
    s_cbranch_vccz OX_FD_148
    s_cmp_gt_u32 s29, 262144
    s_cbranch_scc1 OX_FD_148
    s_sleep 1
    s_branch OX_F_147
OX_FD_148:
    s_mov_b64 exec, -1
    s_lshl_b32 s25, s24, 18
    s_lshl_b32 s64, s14, 15
    s_add_u32 s25, s25, s64
    s_add_u32 s25, s25, 0x4400000
    s_lshl_b32 s64, s87, 17
    s_add_u32 s25, s25, s64
    s_add_u32 s64, s25, 0x0
    buffer_load_dwordx4 v[16:19], v1, s[4:7], s64 offen
    s_add_u32 s64, s25, 0x400
    buffer_load_dwordx4 v[20:23], v1, s[4:7], s64 offen
    s_add_u32 s64, s25, 0x800
    buffer_load_dwordx4 v[24:27], v1, s[4:7], s64 offen
    s_add_u32 s64, s25, 0xc00
    buffer_load_dwordx4 v[28:31], v1, s[4:7], s64 offen
    s_add_u32 s64, s25, 0x1000
    buffer_load_dwordx4 v[32:35], v1, s[4:7], s64 offen
    s_add_u32 s64, s25, 0x1400
    buffer_load_dwordx4 v[36:39], v1, s[4:7], s64 offen
    s_add_u32 s64, s25, 0x1800
    buffer_load_dwordx4 v[40:43], v1, s[4:7], s64 offen
    s_add_u32 s64, s25, 0x1c00
    buffer_load_dwordx4 v[44:47], v1, s[4:7], s64 offen
    s_add_u32 s64, s25, 0x2000
    buffer_load_dwordx4 v[48:51], v1, s[4:7], s64 offen
    s_add_u32 s64, s25, 0x2400
    buffer_load_dwordx4 v[52:55], v1, s[4:7], s64 offen
    s_add_u32 s64, s25, 0x2800
    buffer_load_dwordx4 v[56:59], v1, s[4:7], s64 offen
    s_add_u32 s64, s25, 0x2c00
    buffer_load_dwordx4 v[60:63], v1, s[4:7], s64 offen
    s_add_u32 s64, s25, 0x3000
    buffer_load_dwordx4 v[64:67], v1, s[4:7], s64 offen
    s_add_u32 s64, s25, 0x3400
    buffer_load_dwordx4 v[68:71], v1, s[4:7], s64 offen
    s_add_u32 s64, s25, 0x3800
    buffer_load_dwordx4 v[72:75], v1, s[4:7], s64 offen
    s_add_u32 s64, s25, 0x3c00
    buffer_load_dwordx4 v[76:79], v1, s[4:7], s64 offen
    s_add_u32 s64, s25, 0x4000
    buffer_load_dwordx4 v[80:83], v1, s[4:7], s64 offen
    s_add_u32 s64, s25, 0x4400
    buffer_load_dwordx4 v[84:87], v1, s[4:7], s64 offen
    s_add_u32 s64, s25, 0x4800
    buffer_load_dwordx4 v[88:91], v1, s[4:7], s64 offen
    s_add_u32 s64, s25, 0x4c00
    buffer_load_dwordx4 v[92:95], v1, s[4:7], s64 offen
    s_add_u32 s64, s25, 0x5000
    buffer_load_dwordx4 v[96:99], v1, s[4:7], s64 offen
    s_add_u32 s64, s25, 0x5400
    buffer_load_dwordx4 v[100:103], v1, s[4:7], s64 offen
    s_add_u32 s64, s25, 0x5800
    buffer_load_dwordx4 v[104:107], v1, s[4:7], s64 offen
    s_add_u32 s64, s25, 0x5c00
    buffer_load_dwordx4 v[108:111], v1, s[4:7], s64 offen
    s_add_u32 s64, s25, 0x6000
    buffer_load_dwordx4 v[112:115], v1, s[4:7], s64 offen
    s_add_u32 s64, s25, 0x6400
    buffer_load_dwordx4 v[116:119], v1, s[4:7], s64 offen
    s_add_u32 s64, s25, 0x6800
    buffer_load_dwordx4 v[120:123], v1, s[4:7], s64 offen
    s_add_u32 s64, s25, 0x6c00
    buffer_load_dwordx4 v[124:127], v1, s[4:7], s64 offen
    s_add_u32 s64, s25, 0x7000
    buffer_load_dwordx4 v[128:131], v1, s[4:7], s64 offen
    s_add_u32 s64, s25, 0x7400
    buffer_load_dwordx4 v[132:135], v1, s[4:7], s64 offen
    s_add_u32 s64, s25, 0x7800
    buffer_load_dwordx4 v[136:139], v1, s[4:7], s64 offen
    s_add_u32 s64, s25, 0x7c00
    buffer_load_dwordx4 v[140:143], v1, s[4:7], s64 offen
    s_waitcnt vmcnt(31)
    v_mfma_f32_16x16x32_bf16 v[144:147], a[0:3], v[16:19], 0
    v_mfma_f32_16x16x32_bf16 v[148:151], a[4:7], v[16:19], 0
    s_waitcnt vmcnt(30)
    v_mfma_f32_16x16x32_bf16 v[144:147], a[8:11], v[20:23], v[144:147]
    v_mfma_f32_16x16x32_bf16 v[148:151], a[12:15], v[20:23], v[148:151]
    s_waitcnt vmcnt(29)
    v_mfma_f32_16x16x32_bf16 v[144:147], a[16:19], v[24:27], v[144:147]
    v_mfma_f32_16x16x32_bf16 v[148:151], a[20:23], v[24:27], v[148:151]
    s_waitcnt vmcnt(28)
    v_mfma_f32_16x16x32_bf16 v[144:147], a[24:27], v[28:31], v[144:147]
    v_mfma_f32_16x16x32_bf16 v[148:151], a[28:31], v[28:31], v[148:151]
    s_waitcnt vmcnt(27)
    v_mfma_f32_16x16x32_bf16 v[144:147], a[32:35], v[32:35], v[144:147]
    v_mfma_f32_16x16x32_bf16 v[148:151], a[36:39], v[32:35], v[148:151]
    s_waitcnt vmcnt(26)
    v_mfma_f32_16x16x32_bf16 v[144:147], a[40:43], v[36:39], v[144:147]
    v_mfma_f32_16x16x32_bf16 v[148:151], a[44:47], v[36:39], v[148:151]
    s_waitcnt vmcnt(25)
    v_mfma_f32_16x16x32_bf16 v[144:147], a[48:51], v[40:43], v[144:147]
    v_mfma_f32_16x16x32_bf16 v[148:151], a[52:55], v[40:43], v[148:151]
    s_waitcnt vmcnt(24)
    v_mfma_f32_16x16x32_bf16 v[144:147], a[56:59], v[44:47], v[144:147]
    v_mfma_f32_16x16x32_bf16 v[148:151], a[60:63], v[44:47], v[148:151]
    s_waitcnt vmcnt(23)
    v_mfma_f32_16x16x32_bf16 v[144:147], a[64:67], v[48:51], v[144:147]
    v_mfma_f32_16x16x32_bf16 v[148:151], a[68:71], v[48:51], v[148:151]
    s_waitcnt vmcnt(22)
    v_mfma_f32_16x16x32_bf16 v[144:147], a[72:75], v[52:55], v[144:147]
    v_mfma_f32_16x16x32_bf16 v[148:151], a[76:79], v[52:55], v[148:151]
    s_waitcnt vmcnt(21)
    v_mfma_f32_16x16x32_bf16 v[144:147], a[80:83], v[56:59], v[144:147]
    v_mfma_f32_16x16x32_bf16 v[148:151], a[84:87], v[56:59], v[148:151]
    s_waitcnt vmcnt(20)
    v_mfma_f32_16x16x32_bf16 v[144:147], a[88:91], v[60:63], v[144:147]
    v_mfma_f32_16x16x32_bf16 v[148:151], a[92:95], v[60:63], v[148:151]
    s_waitcnt vmcnt(19)
    v_mfma_f32_16x16x32_bf16 v[144:147], a[96:99], v[64:67], v[144:147]
    v_mfma_f32_16x16x32_bf16 v[148:151], a[100:103], v[64:67], v[148:151]
    s_waitcnt vmcnt(18)
    v_mfma_f32_16x16x32_bf16 v[144:147], a[104:107], v[68:71], v[144:147]
    v_mfma_f32_16x16x32_bf16 v[148:151], a[108:111], v[68:71], v[148:151]
    s_waitcnt vmcnt(17)
    v_mfma_f32_16x16x32_bf16 v[144:147], a[112:115], v[72:75], v[144:147]
    v_mfma_f32_16x16x32_bf16 v[148:151], a[116:119], v[72:75], v[148:151]
    s_waitcnt vmcnt(16)
    v_mfma_f32_16x16x32_bf16 v[144:147], a[120:123], v[76:79], v[144:147]
    v_mfma_f32_16x16x32_bf16 v[148:151], a[124:127], v[76:79], v[148:151]
    s_waitcnt vmcnt(15)
    v_mfma_f32_16x16x32_bf16 v[144:147], a[128:131], v[80:83], v[144:147]
    v_mfma_f32_16x16x32_bf16 v[148:151], a[132:135], v[80:83], v[148:151]
    s_waitcnt vmcnt(14)
    v_mfma_f32_16x16x32_bf16 v[144:147], a[136:139], v[84:87], v[144:147]
    v_mfma_f32_16x16x32_bf16 v[148:151], a[140:143], v[84:87], v[148:151]
    s_waitcnt vmcnt(13)
    v_mfma_f32_16x16x32_bf16 v[144:147], a[144:147], v[88:91], v[144:147]
    v_mfma_f32_16x16x32_bf16 v[148:151], a[148:151], v[88:91], v[148:151]
    s_waitcnt vmcnt(12)
    v_mfma_f32_16x16x32_bf16 v[144:147], a[152:155], v[92:95], v[144:147]
    v_mfma_f32_16x16x32_bf16 v[148:151], a[156:159], v[92:95], v[148:151]
    s_waitcnt vmcnt(11)
    v_mfma_f32_16x16x32_bf16 v[144:147], a[160:163], v[96:99], v[144:147]
    v_mfma_f32_16x16x32_bf16 v[148:151], a[164:167], v[96:99], v[148:151]
    s_waitcnt vmcnt(10)
    v_mfma_f32_16x16x32_bf16 v[144:147], a[168:171], v[100:103], v[144:147]
    v_mfma_f32_16x16x32_bf16 v[148:151], a[172:175], v[100:103], v[148:151]
    s_waitcnt vmcnt(9)
    v_mfma_f32_16x16x32_bf16 v[144:147], a[176:179], v[104:107], v[144:147]
    v_mfma_f32_16x16x32_bf16 v[148:151], a[180:183], v[104:107], v[148:151]
    s_waitcnt vmcnt(8)
    v_mfma_f32_16x16x32_bf16 v[144:147], a[184:187], v[108:111], v[144:147]
    v_mfma_f32_16x16x32_bf16 v[148:151], a[188:191], v[108:111], v[148:151]
    s_waitcnt vmcnt(7)
    v_mfma_f32_16x16x32_bf16 v[144:147], a[192:195], v[112:115], v[144:147]
    v_mfma_f32_16x16x32_bf16 v[148:151], a[196:199], v[112:115], v[148:151]
    s_waitcnt vmcnt(6)
    v_mfma_f32_16x16x32_bf16 v[144:147], a[200:203], v[116:119], v[144:147]
    v_mfma_f32_16x16x32_bf16 v[148:151], a[204:207], v[116:119], v[148:151]
    s_waitcnt vmcnt(5)
    v_mfma_f32_16x16x32_bf16 v[144:147], a[208:211], v[120:123], v[144:147]
    v_mfma_f32_16x16x32_bf16 v[148:151], a[212:215], v[120:123], v[148:151]
    s_waitcnt vmcnt(4)
    v_mfma_f32_16x16x32_bf16 v[144:147], a[216:219], v[124:127], v[144:147]
    v_mfma_f32_16x16x32_bf16 v[148:151], a[220:223], v[124:127], v[148:151]
    s_waitcnt vmcnt(3)
    v_mfma_f32_16x16x32_bf16 v[144:147], a[224:227], v[128:131], v[144:147]
    v_mfma_f32_16x16x32_bf16 v[148:151], a[228:231], v[128:131], v[148:151]
    s_waitcnt vmcnt(2)
    v_mfma_f32_16x16x32_bf16 v[144:147], a[232:235], v[132:135], v[144:147]
    v_mfma_f32_16x16x32_bf16 v[148:151], a[236:239], v[132:135], v[148:151]
    s_waitcnt vmcnt(1)
    v_mfma_f32_16x16x32_bf16 v[144:147], a[240:243], v[136:139], v[144:147]
    v_mfma_f32_16x16x32_bf16 v[148:151], a[244:247], v[136:139], v[148:151]
    s_waitcnt vmcnt(0)
    v_mfma_f32_16x16x32_bf16 v[144:147], a[248:251], v[140:143], v[144:147]
    v_mfma_f32_16x16x32_bf16 v[148:151], a[252:255], v[140:143], v[148:151]
    s_lshl_b32 s64, s14, 12
    v_add_u32 v7, s64, v1
    s_barrier
    s_nop 3
    ds_write_b128 v7, v[144:147] offset:0
    ds_write_b128 v7, v[148:151] offset:1024
    s_waitcnt lgkmcnt(0)
    s_barrier
    s_cmp_ge_u32 s14, 2
    s_cbranch_scc1 OTD_149
    s_lshl_b32 s64, s14, 10
    v_add_u32 v7, s64, v1
    ds_read_b128 v[16:19], v7 offset:0
    ds_read_b128 v[20:23], v7 offset:4096
    ds_read_b128 v[24:27], v7 offset:8192
    ds_read_b128 v[28:31], v7 offset:12288
    s_waitcnt lgkmcnt(0)
    v_add_f32 v16, v16, v20
    v_add_f32 v24, v24, v28
    v_add_f32 v16, v16, v24
    v_add_f32 v17, v17, v21
    v_add_f32 v25, v25, v29
    v_add_f32 v17, v17, v25
    v_add_f32 v18, v18, v22
    v_add_f32 v26, v26, v30
    v_add_f32 v18, v18, v26
    v_add_f32 v19, v19, v23
    v_add_f32 v27, v27, v31
    v_add_f32 v19, v19, v27
    v_cvt_pk_bf16_f32 v16, v16, v16
    v_lshlrev_b32 v16, 16, v16
    v_cvt_pk_bf16_f32 v17, v17, v17
    v_lshlrev_b32 v17, 16, v17
    v_cvt_pk_bf16_f32 v18, v18, v18
    v_lshlrev_b32 v18, 16, v18
    v_cvt_pk_bf16_f32 v19, v19, v19
    v_lshlrev_b32 v19, 16, v19
    v_lshlrev_b32 v20, 16, v162
    v_and_b32 v21, 0xffff0000, v162
    v_lshlrev_b32 v24, 16, v160
    v_and_b32 v25, 0xffff0000, v160
    v_lshlrev_b32 v22, 16, v163
    v_and_b32 v23, 0xffff0000, v163
    v_lshlrev_b32 v26, 16, v161
    v_and_b32 v27, 0xffff0000, v161
    s_lshl_b32 s64, s24, 5
    v_add_u32 v8, s64, v9
    v_mov_b32 v10, -1
    v_cmp_eq_u32 vcc, s72, v8
    s_nop 1
    v_cndmask_b32 v10, v10, 0, vcc
    v_cmp_eq_u32 vcc, s73, v8
    s_nop 1
    v_cndmask_b32 v10, v10, 1, vcc
    v_cmp_eq_u32 vcc, s74, v8
    s_nop 1
    v_cndmask_b32 v10, v10, 2, vcc
    v_cmp_eq_u32 vcc, s75, v8
    s_nop 1
    v_cndmask_b32 v10, v10, 3, vcc
    v_cmp_eq_u32 vcc, s76, v8
    s_nop 1
    v_cndmask_b32 v10, v10, 4, vcc
    v_cmp_eq_u32 vcc, s77, v8
    s_nop 1
    v_cndmask_b32 v10, v10, 5, vcc
    v_cmp_eq_u32 vcc, s78, v8
    s_nop 1
    v_cndmask_b32 v10, v10, 6, vcc
    v_cmp_eq_u32 vcc, s79, v8
    s_nop 1
    v_cndmask_b32 v10, v10, 7, vcc
    v_cmp_le_i32 vcc, 0, v10
    s_and_saveexec_b64 s[68:69], vcc
    s_cbranch_execz NOUPD_150
    v_mul_u32_u24 v10, 2560, v10
    v_lshrrev_b32 v11, 4, v0
    v_lshl_add_u32 v10, v11, 4, v10
    s_lshl_b32 s64, s86, 6
    s_lshl_b32 s65, s13, 7
    s_add_u32 s64, s64, s65
    s_add_u32 s64, s64, 0x5410000
    buffer_load_dwordx4 v[164:167], v10, s[4:7], s64 offen sc1
    s_waitcnt vmcnt(0)
    v_add_f32 v20, v20, v164
    v_cvt_pk_bf16_f32 v20, v20, v20
    v_lshlrev_b32 v20, 16, v20
    v_add_f32 v21, v21, v165
    v_cvt_pk_bf16_f32 v21, v21, v21
    v_lshlrev_b32 v21, 16, v21
    v_add_f32 v22, v22, v166
    v_cvt_pk_bf16_f32 v22, v22, v22
    v_lshlrev_b32 v22, 16, v22
    v_add_f32 v23, v23, v167
    v_cvt_pk_bf16_f32 v23, v23, v23
    v_lshlrev_b32 v23, 16, v23
NOUPD_150:
    s_mov_b64 exec, -1
    v_mul_f32 v28, 0xbfb8aa3b, v20
    v_exp_f32 v28, v28
    s_nop 0
    v_add_f32 v28, 1.0, v28
    v_rcp_f32 v28, v28
    s_nop 0
    v_mul_f32 v28, v28, v20
    v_cvt_pk_bf16_f32 v28, v28, v28
    v_lshlrev_b32 v28, 16, v28
    v_mul_f32 v28, v28, v16
    v_cvt_pk_bf16_f32 v28, v28, v28
    v_lshlrev_b32 v28, 16, v28
    v_add_f32 v28, v28, v24
    v_mul_f32 v29, 0xbfb8aa3b, v21
    v_exp_f32 v29, v29
    s_nop 0
    v_add_f32 v29, 1.0, v29
    v_rcp_f32 v29, v29
    s_nop 0
    v_mul_f32 v29, v29, v21
    v_cvt_pk_bf16_f32 v29, v29, v29
    v_lshlrev_b32 v29, 16, v29
    v_mul_f32 v29, v29, v17
    v_cvt_pk_bf16_f32 v29, v29, v29
    v_lshlrev_b32 v29, 16, v29
    v_add_f32 v29, v29, v25
    v_mul_f32 v30, 0xbfb8aa3b, v22
    v_exp_f32 v30, v30
    s_nop 0
    v_add_f32 v30, 1.0, v30
    v_rcp_f32 v30, v30
    s_nop 0
    v_mul_f32 v30, v30, v22
    v_cvt_pk_bf16_f32 v30, v30, v30
    v_lshlrev_b32 v30, 16, v30
    v_mul_f32 v30, v30, v18
    v_cvt_pk_bf16_f32 v30, v30, v30
    v_lshlrev_b32 v30, 16, v30
    v_add_f32 v30, v30, v26
    v_mul_f32 v31, 0xbfb8aa3b, v23
    v_exp_f32 v31, v31
    s_nop 0
    v_add_f32 v31, 1.0, v31
    v_rcp_f32 v31, v31
    s_nop 0
    v_mul_f32 v31, v31, v23
    v_cvt_pk_bf16_f32 v31, v31, v31
    v_lshlrev_b32 v31, 16, v31
    v_mul_f32 v31, v31, v19
    v_cvt_pk_bf16_f32 v31, v31, v31
    v_lshlrev_b32 v31, 16, v31
    v_add_f32 v31, v31, v27
    v_cvt_pk_bf16_f32 v164, v28, v29
    v_cvt_pk_bf16_f32 v165, v30, v31
    buffer_store_dwordx2 v[164:165], v5, s[52:55], s67 offen
OTD_149:
    s_branch M_EXIT
H_Q:
    s_mov_b32 s29, 0
    v_lshlrev_b32 v1, 4, v0
    v_lshrrev_b32 v5, 4, v0
    v_lshlrev_b32 v2, 7, v5
    v_and_b32 v5, 7, v0
    v_lshl_add_u32 v2, v5, 4, v2
    v_bfe_u32 v5, v0, 4, 1
    v_lshlrev_b32 v3, 7, v5
    v_and_b32 v5, 15, v0
    v_lshl_add_u32 v3, v5, 3, v3
    s_mov_b32 s34, 0x3e0293ee
    s_mov_b32 s35, 0x3e0293ee
    s_mov_b32 s36, -1
    s_mov_b32 s37, 0
    v_lshrrev_b32 v5, 4, v0
    v_lshlrev_b32 v5, 2, v5
    v_and_b32 v6, 15, v0
    v_add_u32 v7, 0, v5
    v_cmp_le_u32 s[38:39], v7, v6
    v_add_u32 v7, 1, v5
    v_cmp_le_u32 s[40:41], v7, v6
    v_add_u32 v7, 2, v5
    v_cmp_le_u32 s[42:43], v7, v6
    v_add_u32 v7, 3, v5
    v_cmp_le_u32 s[44:45], v7, v6
    v_mov_b32 v248, 0x3f803f80
    v_mov_b32 v249, 0x3f803f80
    v_mov_b32 v250, 0x3f803f80
    v_mov_b32 v251, 0x3f803f80
    s_lshl_b32 s24, s12, 2
    s_add_u32 s24, s24, s14
    s_mov_b32 s25, 0
AT0_LOOP:
    s_lshl_b32 s64, s24, 5
    s_add_u32 s64, s64, s13
    s_lshl_b32 s26, s64, 13
    s_add_u32 s26, s26, 0x3400000
    s_lshl_b32 s27, s64, 14
    s_add_u32 s27, s27, 0x1400000
    s_lshl_b32 s65, s64, 11
    s_add_u32 s30, s65, 0x640000
    s_add_u32 s31, s65, 0xa40000
    s_lshl_b32 s33, s64, 2
    s_add_u32 s33, s33, 0x296000
    s_lshl_b32 s32, s24, 18
    s_lshl_b32 s65, s13, 12
    s_add_u32 s32, s32, s65
    s_add_u32 s32, s32, 0x4400000
    s_lshr_b32 s65, s24, 2
    s_lshl_b32 s65, s65, 9
    s_lshl_b32 s66, s13, 4
    s_add_u32 s65, s65, s66
    s_add_u32 s65, s65, 0x291000
    s_lshr_b32 s66, s24, 1
    s_lshl_b32 s66, s66, 8
    s_lshl_b32 s64, s13, 3
    s_add_u32 s66, s66, s64
    s_add_u32 s66, s66, 0x293ff4
    v_lshlrev_b32 v5, 2, v0
    v_mov_b32 v6, s65
    v_mov_b32 v7, s66
    v_cmp_gt_u32 vcc, 3, v0
    s_nop 1
    v_cndmask_b32 v6, v7, v6, vcc
    v_add_u32 v4, v5, v6
    s_mov_b32 s64, 0
    s_mov_b64 exec, 7
AT0_F_151:
    buffer_load_dword v5, v4, s[4:7], s64 offen sc1
    s_add_u32 s29, s29, 1
    s_waitcnt vmcnt(0)
    v_cmp_eq_u32 vcc, 0, v5
    s_cbranch_vccz AT0_FD_152
    s_cmp_gt_u32 s29, 262144
    s_cbranch_scc1 AT0_FD_152
    s_sleep 1
    s_branch AT0_F_151
AT0_FD_152:
    s_mov_b64 exec, -1
    buffer_load_dwordx4 v[16:19], v1, s[4:7], s26 offen offset:0
    buffer_load_dwordx4 v[20:23], v1, s[4:7], s26 offen offset:1024
    buffer_load_dwordx4 v[24:27], v1, s[4:7], s26 offen offset:2048
    buffer_load_dwordx4 v[28:31], v1, s[4:7], s26 offen offset:3072
    s_add_u32 s26, s26, 4096
    buffer_load_dwordx4 v[32:35], v1, s[4:7], s26 offen offset:0
    buffer_load_dwordx4 v[36:39], v1, s[4:7], s26 offen offset:1024
    buffer_load_dwordx4 v[40:43], v1, s[4:7], s26 offen offset:2048
    buffer_load_dwordx4 v[44:47], v1, s[4:7], s26 offen offset:3072
    buffer_load_dwordx4 v[48:51], v1, s[4:7], s27 offen offset:0
    buffer_load_dwordx4 v[52:55], v1, s[4:7], s27 offen offset:1024
    buffer_load_dwordx4 v[56:59], v1, s[4:7], s27 offen offset:2048
    buffer_load_dwordx4 v[60:63], v1, s[4:7], s27 offen offset:3072
    s_add_u32 s27, s27, 4096
    buffer_load_dwordx4 v[64:67], v1, s[4:7], s27 offen offset:0
    buffer_load_dwordx4 v[68:71], v1, s[4:7], s27 offen offset:1024
    buffer_load_dwordx4 v[72:75], v1, s[4:7], s27 offen offset:2048
    buffer_load_dwordx4 v[76:79], v1, s[4:7], s27 offen offset:3072
    s_add_u32 s27, s27, 4096
    buffer_load_dwordx4 v[80:83], v1, s[4:7], s27 offen offset:0
    buffer_load_dwordx4 v[84:87], v1, s[4:7], s27 offen offset:1024
    buffer_load_dwordx4 v[88:91], v1, s[4:7], s27 offen offset:2048
    buffer_load_dwordx4 v[92:95], v1, s[4:7], s27 offen offset:3072
    s_add_u32 s27, s27, 4096
    buffer_load_dwordx4 v[96:99], v1, s[4:7], s27 offen offset:0
    buffer_load_dwordx4 v[100:103], v1, s[4:7], s27 offen offset:1024
    buffer_load_dwordx4 v[104:107], v1, s[4:7], s27 offen offset:2048
    buffer_load_dwordx4 v[108:111], v1, s[4:7], s27 offen offset:3072
    s_mov_b64 exec, 0x18
AT0_G_153:
    buffer_load_dword v5, v4, s[4:7], s64 offen sc1
    s_add_u32 s29, s29, 1
    s_waitcnt vmcnt(0)
    v_cmp_eq_u32 vcc, 0, v5
    s_cbranch_vccz AT0_GD_154
    s_cmp_gt_u32 s29, 262144
    s_cbranch_scc1 AT0_GD_154
    s_sleep 1
    s_branch AT0_G_153
AT0_GD_154:
    s_mov_b64 exec, -1
    buffer_load_dwordx4 v[112:115], v2, s[4:7], s30 offen offset:0
    buffer_load_dwordx4 v[116:119], v2, s[4:7], s30 offen offset:512
    buffer_load_dwordx4 v[120:123], v2, s[4:7], s30 offen offset:1024
    buffer_load_dwordx4 v[124:127], v2, s[4:7], s30 offen offset:1536
    buffer_load_dwordx2 v[128:129], v3, s[4:7], s31 offen offset:0
    buffer_load_dwordx2 v[130:131], v3, s[4:7], s31 offen offset:256
    buffer_load_dwordx2 v[132:133], v3, s[4:7], s31 offen offset:512
    buffer_load_dwordx2 v[134:135], v3, s[4:7], s31 offen offset:768
    buffer_load_dwordx2 v[136:137], v3, s[4:7], s31 offen offset:1024
    buffer_load_dwordx2 v[138:139], v3, s[4:7], s31 offen offset:1280
    buffer_load_dwordx2 v[140:141], v3, s[4:7], s31 offen offset:1536
    buffer_load_dwordx2 v[142:143], v3, s[4:7], s31 offen offset:1792
    v_mfma_f32_16x16x32_bf16 v[148:151], v[48:51], v[16:19], 0
    v_mfma_f32_16x16x32_bf16 v[156:159], v[48:51], v[32:35], 0
    v_mfma_f32_16x16x32_bf16 v[160:163], v[64:67], v[32:35], 0
    v_mfma_f32_16x16x32_bf16 v[148:151], v[52:55], v[20:23], v[148:151]
    v_mfma_f32_16x16x32_bf16 v[156:159], v[52:55], v[36:39], v[156:159]
    v_mfma_f32_16x16x32_bf16 v[160:163], v[68:71], v[36:39], v[160:163]
    v_mfma_f32_16x16x32_bf16 v[148:151], v[56:59], v[24:27], v[148:151]
    v_mfma_f32_16x16x32_bf16 v[156:159], v[56:59], v[40:43], v[156:159]
    v_mfma_f32_16x16x32_bf16 v[160:163], v[72:75], v[40:43], v[160:163]
    v_mfma_f32_16x16x32_bf16 v[148:151], v[60:63], v[28:31], v[148:151]
    v_mfma_f32_16x16x32_bf16 v[156:159], v[60:63], v[44:47], v[156:159]
    v_mfma_f32_16x16x32_bf16 v[160:163], v[76:79], v[44:47], v[160:163]
    s_waitcnt vmcnt(8)
    v_mfma_f32_16x16x32_bf16 v[144:147], v[112:115], v[16:19], 0
    v_mfma_f32_16x16x32_bf16 v[152:155], v[112:115], v[32:35], 0
    v_mfma_f32_16x16x32_bf16 v[144:147], v[116:119], v[20:23], v[144:147]
    v_mfma_f32_16x16x32_bf16 v[152:155], v[116:119], v[36:39], v[152:155]
    v_mfma_f32_16x16x32_bf16 v[144:147], v[120:123], v[24:27], v[144:147]
    v_mfma_f32_16x16x32_bf16 v[152:155], v[120:123], v[40:43], v[152:155]
    v_mfma_f32_16x16x32_bf16 v[144:147], v[124:127], v[28:31], v[144:147]
    v_mfma_f32_16x16x32_bf16 v[152:155], v[124:127], v[44:47], v[152:155]
    v_mov_b32 v11, 0xff800000
    s_nop 7
    v_cndmask_b32 v148, v11, v148, s[38:39]
    v_cndmask_b32 v160, v11, v160, s[38:39]
    v_cndmask_b32 v144, v11, v144, s[36:37]
    v_cndmask_b32 v152, v11, v152, s[36:37]
    v_cndmask_b32 v149, v11, v149, s[40:41]
    v_cndmask_b32 v161, v11, v161, s[40:41]
    v_cndmask_b32 v145, v11, v145, s[36:37]
    v_cndmask_b32 v153, v11, v153, s[36:37]
    v_cndmask_b32 v150, v11, v150, s[42:43]
    v_cndmask_b32 v162, v11, v162, s[42:43]
    v_cndmask_b32 v146, v11, v146, s[36:37]
    v_cndmask_b32 v154, v11, v154, s[36:37]
    v_cndmask_b32 v151, v11, v151, s[44:45]
    v_cndmask_b32 v163, v11, v163, s[44:45]
    v_cndmask_b32 v147, v11, v147, s[36:37]
    v_cndmask_b32 v155, v11, v155, s[36:37]
    v_max3_f32 v8, v144, v145, v146
    v_max3_f32 v8, v8, v147, v148
    v_max3_f32 v8, v8, v149, v150
    v_max_f32 v8, v8, v151
    v_mov_b32 v9, v8
    s_nop 1
    v_permlane16_swap_b32 v8, v9
    v_max_f32 v8, v8, v9
    v_mov_b32 v9, v8
    s_nop 1
    v_permlane32_swap_b32 v8, v9
    v_max_f32 v8, v8, v9
    v_mul_f32 v8, s34, v8
    v_fma_f32 v144, v144, s34, -v8
    v_fma_f32 v145, v145, s34, -v8
    v_fma_f32 v146, v146, s34, -v8
    v_fma_f32 v147, v147, s34, -v8
    v_fma_f32 v148, v148, s34, -v8
    v_fma_f32 v149, v149, s34, -v8
    v_fma_f32 v150, v150, s34, -v8
    v_fma_f32 v151, v151, s34, -v8
    v_exp_f32 v144, v144
    v_exp_f32 v145, v145
    v_exp_f32 v146, v146
    v_exp_f32 v147, v147
    v_exp_f32 v148, v148
    v_exp_f32 v149, v149
    v_exp_f32 v150, v150
    v_exp_f32 v151, v151
    s_nop 0
    v_cvt_pk_bf16_f32 v164, v148, v149
    v_cvt_pk_bf16_f32 v165, v150, v151
    v_mov_b32 v166, 0
    v_mov_b32 v167, 0
    v_cvt_pk_bf16_f32 v168, v144, v145
    v_cvt_pk_bf16_f32 v169, v146, v147
    v_max3_f32 v8, v152, v153, v154
    v_max3_f32 v8, v8, v155, v156
    v_max3_f32 v8, v8, v157, v158
    v_max3_f32 v8, v8, v159, v160
    v_max3_f32 v8, v8, v161, v162
    v_max_f32 v8, v8, v163
    v_mov_b32 v9, v8
    s_nop 1
    v_permlane16_swap_b32 v8, v9
    v_max_f32 v8, v8, v9
    v_mov_b32 v9, v8
    s_nop 1
    v_permlane32_swap_b32 v8, v9
    v_max_f32 v8, v8, v9
    v_mul_f32 v8, s34, v8
    v_fma_f32 v152, v152, s34, -v8
    v_fma_f32 v153, v153, s34, -v8
    v_fma_f32 v154, v154, s34, -v8
    v_fma_f32 v155, v155, s34, -v8
    v_fma_f32 v156, v156, s34, -v8
    v_fma_f32 v157, v157, s34, -v8
    v_fma_f32 v158, v158, s34, -v8
    v_fma_f32 v159, v159, s34, -v8
    v_fma_f32 v160, v160, s34, -v8
    v_fma_f32 v161, v161, s34, -v8
    v_fma_f32 v162, v162, s34, -v8
    v_fma_f32 v163, v163, s34, -v8
    v_exp_f32 v152, v152
    v_exp_f32 v153, v153
    v_exp_f32 v154, v154
    v_exp_f32 v155, v155
    v_exp_f32 v156, v156
    v_exp_f32 v157, v157
    v_exp_f32 v158, v158
    v_exp_f32 v159, v159
    v_exp_f32 v160, v160
    v_exp_f32 v161, v161
    v_exp_f32 v162, v162
    v_exp_f32 v163, v163
    s_nop 0
    v_cvt_pk_bf16_f32 v170, v156, v157
    v_cvt_pk_bf16_f32 v171, v158, v159
    v_cvt_pk_bf16_f32 v172, v160, v161
    v_cvt_pk_bf16_f32 v173, v162, v163
    v_cvt_pk_bf16_f32 v174, v152, v153
    v_cvt_pk_bf16_f32 v175, v154, v155
    s_waitcnt vmcnt(0)
    v_mfma_f32_16x16x32_bf16 v[240:243], v[248:251], v[164:167], 0
    v_mfma_f32_16x16x32_bf16 v[244:247], v[248:251], v[170:173], 0
    v_mfma_f32_16x16x32_bf16 v[176:179], v[80:83], v[164:167], 0
    v_mfma_f32_16x16x32_bf16 v[180:183], v[80:83], v[170:173], 0
    v_mfma_f32_16x16x32_bf16 v[184:187], v[84:87], v[164:167], 0
    v_mfma_f32_16x16x32_bf16 v[188:191], v[84:87], v[170:173], 0
    v_mfma_f32_16x16x32_bf16 v[192:195], v[88:91], v[164:167], 0
    v_mfma_f32_16x16x32_bf16 v[196:199], v[88:91], v[170:173], 0
    v_mfma_f32_16x16x32_bf16 v[200:203], v[92:95], v[164:167], 0
    v_mfma_f32_16x16x32_bf16 v[204:207], v[92:95], v[170:173], 0
    v_mfma_f32_16x16x32_bf16 v[208:211], v[96:99], v[164:167], 0
    v_mfma_f32_16x16x32_bf16 v[212:215], v[96:99], v[170:173], 0
    v_mfma_f32_16x16x32_bf16 v[216:219], v[100:103], v[164:167], 0
    v_mfma_f32_16x16x32_bf16 v[220:223], v[100:103], v[170:173], 0
    v_mfma_f32_16x16x32_bf16 v[224:227], v[104:107], v[164:167], 0
    v_mfma_f32_16x16x32_bf16 v[228:231], v[104:107], v[170:173], 0
    v_mfma_f32_16x16x32_bf16 v[232:235], v[108:111], v[164:167], 0
    v_mfma_f32_16x16x32_bf16 v[236:239], v[108:111], v[170:173], 0
    v_mfma_f32_16x16x16_bf16 v[240:243], v[248:249], v[168:169], v[240:243]
    v_mfma_f32_16x16x16_bf16 v[244:247], v[248:249], v[174:175], v[244:247]
    v_mfma_f32_16x16x16_bf16 v[176:179], v[128:129], v[168:169], v[176:179]
    v_mfma_f32_16x16x16_bf16 v[180:183], v[128:129], v[174:175], v[180:183]
    v_mfma_f32_16x16x16_bf16 v[184:187], v[130:131], v[168:169], v[184:187]
    v_mfma_f32_16x16x16_bf16 v[188:191], v[130:131], v[174:175], v[188:191]
    v_mfma_f32_16x16x16_bf16 v[192:195], v[132:133], v[168:169], v[192:195]
    v_mfma_f32_16x16x16_bf16 v[196:199], v[132:133], v[174:175], v[196:199]
    v_mfma_f32_16x16x16_bf16 v[200:203], v[134:135], v[168:169], v[200:203]
    v_mfma_f32_16x16x16_bf16 v[204:207], v[134:135], v[174:175], v[204:207]
    v_mfma_f32_16x16x16_bf16 v[208:211], v[136:137], v[168:169], v[208:211]
    v_mfma_f32_16x16x16_bf16 v[212:215], v[136:137], v[174:175], v[212:215]
    v_mfma_f32_16x16x16_bf16 v[216:219], v[138:139], v[168:169], v[216:219]
    v_mfma_f32_16x16x16_bf16 v[220:223], v[138:139], v[174:175], v[220:223]
    v_mfma_f32_16x16x16_bf16 v[224:227], v[140:141], v[168:169], v[224:227]
    v_mfma_f32_16x16x16_bf16 v[228:231], v[140:141], v[174:175], v[228:231]
    v_mfma_f32_16x16x16_bf16 v[232:235], v[142:143], v[168:169], v[232:235]
    v_mfma_f32_16x16x16_bf16 v[236:239], v[142:143], v[174:175], v[236:239]
    v_rcp_f32 v8, v240
    v_rcp_f32 v9, v244
    s_nop 7
    v_mul_f32 v176, v176, v8
    v_mul_f32 v177, v177, v8
    v_mul_f32 v178, v178, v8
    v_mul_f32 v179, v179, v8
    v_cvt_pk_bf16_f32 v16, v176, v177
    v_cvt_pk_bf16_f32 v17, v178, v179
    v_mul_f32 v184, v184, v8
    v_mul_f32 v185, v185, v8
    v_mul_f32 v186, v186, v8
    v_mul_f32 v187, v187, v8
    v_cvt_pk_bf16_f32 v18, v184, v185
    v_cvt_pk_bf16_f32 v19, v186, v187
    s_add_u32 s64, s32, 0x0
    buffer_store_dwordx4 v[16:19], v1, s[4:7], s64 offen offset:0 sc1
    v_mul_f32 v192, v192, v8
    v_mul_f32 v193, v193, v8
    v_mul_f32 v194, v194, v8
    v_mul_f32 v195, v195, v8
    v_cvt_pk_bf16_f32 v20, v192, v193
    v_cvt_pk_bf16_f32 v21, v194, v195
    v_mul_f32 v200, v200, v8
    v_mul_f32 v201, v201, v8
    v_mul_f32 v202, v202, v8
    v_mul_f32 v203, v203, v8
    v_cvt_pk_bf16_f32 v22, v200, v201
    v_cvt_pk_bf16_f32 v23, v202, v203
    s_add_u32 s64, s32, 0x0
    buffer_store_dwordx4 v[20:23], v1, s[4:7], s64 offen offset:1024 sc1
    v_mul_f32 v208, v208, v8
    v_mul_f32 v209, v209, v8
    v_mul_f32 v210, v210, v8
    v_mul_f32 v211, v211, v8
    v_cvt_pk_bf16_f32 v24, v208, v209
    v_cvt_pk_bf16_f32 v25, v210, v211
    v_mul_f32 v216, v216, v8
    v_mul_f32 v217, v217, v8
    v_mul_f32 v218, v218, v8
    v_mul_f32 v219, v219, v8
    v_cvt_pk_bf16_f32 v26, v216, v217
    v_cvt_pk_bf16_f32 v27, v218, v219
    s_add_u32 s64, s32, 0x0
    buffer_store_dwordx4 v[24:27], v1, s[4:7], s64 offen offset:2048 sc1
    v_mul_f32 v224, v224, v8
    v_mul_f32 v225, v225, v8
    v_mul_f32 v226, v226, v8
    v_mul_f32 v227, v227, v8
    v_cvt_pk_bf16_f32 v28, v224, v225
    v_cvt_pk_bf16_f32 v29, v226, v227
    v_mul_f32 v232, v232, v8
    v_mul_f32 v233, v233, v8
    v_mul_f32 v234, v234, v8
    v_mul_f32 v235, v235, v8
    v_cvt_pk_bf16_f32 v30, v232, v233
    v_cvt_pk_bf16_f32 v31, v234, v235
    s_add_u32 s64, s32, 0x0
    buffer_store_dwordx4 v[28:31], v1, s[4:7], s64 offen offset:3072 sc1
    v_mul_f32 v180, v180, v9
    v_mul_f32 v181, v181, v9
    v_mul_f32 v182, v182, v9
    v_mul_f32 v183, v183, v9
    v_cvt_pk_bf16_f32 v32, v180, v181
    v_cvt_pk_bf16_f32 v33, v182, v183
    v_mul_f32 v188, v188, v9
    v_mul_f32 v189, v189, v9
    v_mul_f32 v190, v190, v9
    v_mul_f32 v191, v191, v9
    v_cvt_pk_bf16_f32 v34, v188, v189
    v_cvt_pk_bf16_f32 v35, v190, v191
    s_add_u32 s64, s32, 0x20000
    buffer_store_dwordx4 v[32:35], v1, s[4:7], s64 offen offset:0 sc1
    v_mul_f32 v196, v196, v9
    v_mul_f32 v197, v197, v9
    v_mul_f32 v198, v198, v9
    v_mul_f32 v199, v199, v9
    v_cvt_pk_bf16_f32 v36, v196, v197
    v_cvt_pk_bf16_f32 v37, v198, v199
    v_mul_f32 v204, v204, v9
    v_mul_f32 v205, v205, v9
    v_mul_f32 v206, v206, v9
    v_mul_f32 v207, v207, v9
    v_cvt_pk_bf16_f32 v38, v204, v205
    v_cvt_pk_bf16_f32 v39, v206, v207
    s_add_u32 s64, s32, 0x20000
    buffer_store_dwordx4 v[36:39], v1, s[4:7], s64 offen offset:1024 sc1
    v_mul_f32 v212, v212, v9
    v_mul_f32 v213, v213, v9
    v_mul_f32 v214, v214, v9
    v_mul_f32 v215, v215, v9
    v_cvt_pk_bf16_f32 v40, v212, v213
    v_cvt_pk_bf16_f32 v41, v214, v215
    v_mul_f32 v220, v220, v9
    v_mul_f32 v221, v221, v9
    v_mul_f32 v222, v222, v9
    v_mul_f32 v223, v223, v9
    v_cvt_pk_bf16_f32 v42, v220, v221
    v_cvt_pk_bf16_f32 v43, v222, v223
    s_add_u32 s64, s32, 0x20000
    buffer_store_dwordx4 v[40:43], v1, s[4:7], s64 offen offset:2048 sc1
    v_mul_f32 v228, v228, v9
    v_mul_f32 v229, v229, v9
    v_mul_f32 v230, v230, v9
    v_mul_f32 v231, v231, v9
    v_cvt_pk_bf16_f32 v44, v228, v229
    v_cvt_pk_bf16_f32 v45, v230, v231
    v_mul_f32 v236, v236, v9
    v_mul_f32 v237, v237, v9
    v_mul_f32 v238, v238, v9
    v_mul_f32 v239, v239, v9
    v_cvt_pk_bf16_f32 v46, v236, v237
    v_cvt_pk_bf16_f32 v47, v238, v239
    s_add_u32 s64, s32, 0x20000
    buffer_store_dwordx4 v[44:47], v1, s[4:7], s64 offen offset:3072 sc1
    s_waitcnt vmcnt(0)
    v_mov_b32 v7, 1
    v_mov_b32 v8, 0
    s_mov_b64 exec, 1
    buffer_store_dword v7, v8, s[4:7], s33 offen sc1
    s_mov_b64 exec, -1
    s_add_u32 s24, s24, 8
    s_add_u32 s25, s25, 1
    s_cmp_lt_u32 s25, 1
    s_cbranch_scc1 AT0_LOOP
    s_lshl_b32 s70, s13, 1
    s_add_u32 s70, s70, s12
    s_load_dwordx2 s[44:45], s[0:1], 72
    s_mov_b32 s46, 0x21c000
    s_mov_b32 s47, 0x00020000
    s_load_dwordx2 s[48:49], s[0:1], 80
    s_mov_b32 s50, 0x21c000
    s_mov_b32 s51, 0x00020000
    s_load_dwordx2 s[52:53], s[0:1], 88
    s_mov_b32 s54, 0x21c000
    s_mov_b32 s55, 0x00020000
    s_mov_b32 s29, 0
    s_waitcnt lgkmcnt(0)
    v_mbcnt_lo_u32_b32 v0, -1, 0
    v_mbcnt_hi_u32_b32 v0, -1, v0
    s_lshl_b32 s24, s70, 2
    s_add_u32 s24, s24, s14
    s_cmp_ge_u32 s24, 108
    s_cbranch_scc1 H_A1
    v_mov_b32 v8, 0
    s_mov_b32 s64, 0x298000
F1W_155:
    buffer_load_dword v7, v8, s[4:7], s64 offen sc1
    s_add_u32 s29, s29, 1
    s_waitcnt vmcnt(0)
    v_cmp_gt_u32 vcc, 1, v7
    s_cbranch_vccz F1WD_156
    s_cmp_gt_u32 s29, 262144
    s_cbranch_scc1 F1WD_156
    s_sleep 8
    s_branch F1W_155
F1WD_156:
    s_mul_i32 s25, s14, 40960
    v_lshrrev_b32 v7, 1, v0
    v_mul_u32_u24 v2, 3456, v7
    v_and_b32 v7, 1, v0
    v_lshl_add_u32 v2, v7, 4, v2
    v_lshrrev_b32 v7, 4, v0
    v_lshlrev_b32 v3, 8, v7
    v_bfe_u32 v7, v0, 2, 2
    v_lshl_add_u32 v3, v7, 5, v3
    v_and_b32 v7, 3, v0
    v_lshl_add_u32 v3, v7, 3, v3
    v_add_u32 v3, s25, v3
    v_and_b32 v7, 7, v0
    v_lshlrev_b32 v7, 2, v7
    s_mov_b32 s64, 0x5400000
    buffer_load_dword v4, v7, s[4:7], s64 offen sc1
    s_waitcnt vmcnt(0)
    v_mul_u32_u24 v4, 1280, v4
    v_lshrrev_b32 v7, 4, v0
    v_lshl_add_u32 v4, v7, 4, v4
    s_mov_b32 s65, 0x0
    buffer_load_dwordx4 v[16:19], v4, s[4:7], s65 offen offset:0 sc1
    buffer_load_dwordx4 v[20:23], v4, s[4:7], s65 offen offset:64 sc1
    buffer_load_dwordx4 v[24:27], v4, s[4:7], s65 offen offset:128 sc1
    buffer_load_dwordx4 v[28:31], v4, s[4:7], s65 offen offset:192 sc1
    buffer_load_dwordx4 v[32:35], v4, s[4:7], s65 offen offset:256 sc1
    buffer_load_dwordx4 v[36:39], v4, s[4:7], s65 offen offset:320 sc1
    buffer_load_dwordx4 v[40:43], v4, s[4:7], s65 offen offset:384 sc1
    buffer_load_dwordx4 v[44:47], v4, s[4:7], s65 offen offset:448 sc1
    buffer_load_dwordx4 v[48:51], v4, s[4:7], s65 offen offset:512 sc1
    buffer_load_dwordx4 v[52:55], v4, s[4:7], s65 offen offset:576 sc1
    buffer_load_dwordx4 v[56:59], v4, s[4:7], s65 offen offset:640 sc1
    buffer_load_dwordx4 v[60:63], v4, s[4:7], s65 offen offset:704 sc1
    buffer_load_dwordx4 v[64:67], v4, s[4:7], s65 offen offset:768 sc1
    buffer_load_dwordx4 v[68:71], v4, s[4:7], s65 offen offset:832 sc1
    buffer_load_dwordx4 v[72:75], v4, s[4:7], s65 offen offset:896 sc1
    buffer_load_dwordx4 v[76:79], v4, s[4:7], s65 offen offset:960 sc1
    buffer_load_dwordx4 v[80:83], v4, s[4:7], s65 offen offset:1024 sc1
    buffer_load_dwordx4 v[84:87], v4, s[4:7], s65 offen offset:1088 sc1
    buffer_load_dwordx4 v[88:91], v4, s[4:7], s65 offen offset:1152 sc1
    buffer_load_dwordx4 v[92:95], v4, s[4:7], s65 offen offset:1216 sc1
    s_lshl_b32 s26, s24, 5
    s_add_u32 m0, s25, 0
    s_add_u32 s64, s26, 0x0
    buffer_load_dwordx4 v2, s[44:47], s64 offen lds
    s_add_u32 m0, s25, 1024
    s_add_u32 s64, s26, 0x1b000
    buffer_load_dwordx4 v2, s[44:47], s64 offen lds
    s_add_u32 m0, s25, 2048
    s_add_u32 s64, s26, 0x36000
    buffer_load_dwordx4 v2, s[44:47], s64 offen lds
    s_add_u32 m0, s25, 3072
    s_add_u32 s64, s26, 0x51000
    buffer_load_dwordx4 v2, s[44:47], s64 offen lds
    s_add_u32 m0, s25, 4096
    s_add_u32 s64, s26, 0x6c000
    buffer_load_dwordx4 v2, s[44:47], s64 offen lds
    s_add_u32 m0, s25, 5120
    s_add_u32 s64, s26, 0x87000
    buffer_load_dwordx4 v2, s[44:47], s64 offen lds
    s_add_u32 m0, s25, 6144
    s_add_u32 s64, s26, 0xa2000
    buffer_load_dwordx4 v2, s[44:47], s64 offen lds
    s_add_u32 m0, s25, 7168
    s_add_u32 s64, s26, 0xbd000
    buffer_load_dwordx4 v2, s[44:47], s64 offen lds
    s_add_u32 m0, s25, 8192
    s_add_u32 s64, s26, 0xd8000
    buffer_load_dwordx4 v2, s[44:47], s64 offen lds
    s_add_u32 m0, s25, 9216
    s_add_u32 s64, s26, 0xf3000
    buffer_load_dwordx4 v2, s[44:47], s64 offen lds
    s_add_u32 m0, s25, 10240
    s_add_u32 s64, s26, 0x10e000
    buffer_load_dwordx4 v2, s[44:47], s64 offen lds
    s_add_u32 m0, s25, 11264
    s_add_u32 s64, s26, 0x129000
    buffer_load_dwordx4 v2, s[44:47], s64 offen lds
    s_add_u32 m0, s25, 12288
    s_add_u32 s64, s26, 0x144000
    buffer_load_dwordx4 v2, s[44:47], s64 offen lds
    s_add_u32 m0, s25, 13312
    s_add_u32 s64, s26, 0x15f000
    buffer_load_dwordx4 v2, s[44:47], s64 offen lds
    s_add_u32 m0, s25, 14336
    s_add_u32 s64, s26, 0x17a000
    buffer_load_dwordx4 v2, s[44:47], s64 offen lds
    s_add_u32 m0, s25, 15360
    s_add_u32 s64, s26, 0x195000
    buffer_load_dwordx4 v2, s[44:47], s64 offen lds
    s_add_u32 m0, s25, 16384
    s_add_u32 s64, s26, 0x1b0000
    buffer_load_dwordx4 v2, s[44:47], s64 offen lds
    s_add_u32 m0, s25, 17408
    s_add_u32 s64, s26, 0x1cb000
    buffer_load_dwordx4 v2, s[44:47], s64 offen lds
    s_add_u32 m0, s25, 18432
    s_add_u32 s64, s26, 0x1e6000
    buffer_load_dwordx4 v2, s[44:47], s64 offen lds
    s_add_u32 m0, s25, 19456
    s_add_u32 s64, s26, 0x201000
    buffer_load_dwordx4 v2, s[44:47], s64 offen lds
    s_waitcnt vmcnt(0)
    ds_read_b64_tr_b16 v[96:97], v3 offset:0
    ds_read_b64_tr_b16 v[98:99], v3 offset:128
    ds_read_b64_tr_b16 v[100:101], v3 offset:1024
    ds_read_b64_tr_b16 v[102:103], v3 offset:1152
    ds_read_b64_tr_b16 v[104:105], v3 offset:2048
    ds_read_b64_tr_b16 v[106:107], v3 offset:2176
    ds_read_b64_tr_b16 v[108:109], v3 offset:3072
    ds_read_b64_tr_b16 v[110:111], v3 offset:3200
    ds_read_b64_tr_b16 v[112:113], v3 offset:4096
    ds_read_b64_tr_b16 v[114:115], v3 offset:4224
    ds_read_b64_tr_b16 v[116:117], v3 offset:5120
    ds_read_b64_tr_b16 v[118:119], v3 offset:5248
    s_waitcnt lgkmcnt(4)
    ds_read_b64_tr_b16 v[120:121], v3 offset:6144
    ds_read_b64_tr_b16 v[122:123], v3 offset:6272
    ds_read_b64_tr_b16 v[124:125], v3 offset:7168
    ds_read_b64_tr_b16 v[126:127], v3 offset:7296
    ds_read_b64_tr_b16 v[128:129], v3 offset:8192
    ds_read_b64_tr_b16 v[130:131], v3 offset:8320
    ds_read_b64_tr_b16 v[132:133], v3 offset:9216
    ds_read_b64_tr_b16 v[134:135], v3 offset:9344
    ds_read_b64_tr_b16 v[136:137], v3 offset:10240
    ds_read_b64_tr_b16 v[138:139], v3 offset:10368
    ds_read_b64_tr_b16 v[140:141], v3 offset:11264
    ds_read_b64_tr_b16 v[142:143], v3 offset:11392
    s_waitcnt lgkmcnt(4)
    ds_read_b64_tr_b16 v[144:145], v3 offset:12288
    ds_read_b64_tr_b16 v[146:147], v3 offset:12416
    ds_read_b64_tr_b16 v[148:149], v3 offset:13312
    ds_read_b64_tr_b16 v[150:151], v3 offset:13440
    ds_read_b64_tr_b16 v[152:153], v3 offset:14336
    ds_read_b64_tr_b16 v[154:155], v3 offset:14464
    ds_read_b64_tr_b16 v[156:157], v3 offset:15360
    ds_read_b64_tr_b16 v[158:159], v3 offset:15488
    ds_read_b64_tr_b16 v[160:161], v3 offset:16384
    ds_read_b64_tr_b16 v[162:163], v3 offset:16512
    ds_read_b64_tr_b16 v[164:165], v3 offset:17408
    ds_read_b64_tr_b16 v[166:167], v3 offset:17536
    s_waitcnt lgkmcnt(4)
    ds_read_b64_tr_b16 v[168:169], v3 offset:18432
    ds_read_b64_tr_b16 v[170:171], v3 offset:18560
    ds_read_b64_tr_b16 v[172:173], v3 offset:19456
    ds_read_b64_tr_b16 v[174:175], v3 offset:19584
    s_waitcnt lgkmcnt(0)
    s_add_u32 s25, s25, 20480
    v_add_u32 v3, 20480, v3
    s_add_u32 m0, s25, 0
    s_add_u32 s64, s26, 0x0
    buffer_load_dwordx4 v2, s[48:51], s64 offen lds
    s_add_u32 m0, s25, 1024
    s_add_u32 s64, s26, 0x1b000
    buffer_load_dwordx4 v2, s[48:51], s64 offen lds
    s_add_u32 m0, s25, 2048
    s_add_u32 s64, s26, 0x36000
    buffer_load_dwordx4 v2, s[48:51], s64 offen lds
    s_add_u32 m0, s25, 3072
    s_add_u32 s64, s26, 0x51000
    buffer_load_dwordx4 v2, s[48:51], s64 offen lds
    s_add_u32 m0, s25, 4096
    s_add_u32 s64, s26, 0x6c000
    buffer_load_dwordx4 v2, s[48:51], s64 offen lds
    s_add_u32 m0, s25, 5120
    s_add_u32 s64, s26, 0x87000
    buffer_load_dwordx4 v2, s[48:51], s64 offen lds
    s_add_u32 m0, s25, 6144
    s_add_u32 s64, s26, 0xa2000
    buffer_load_dwordx4 v2, s[48:51], s64 offen lds
    s_add_u32 m0, s25, 7168
    s_add_u32 s64, s26, 0xbd000
    buffer_load_dwordx4 v2, s[48:51], s64 offen lds
    s_add_u32 m0, s25, 8192
    s_add_u32 s64, s26, 0xd8000
    buffer_load_dwordx4 v2, s[48:51], s64 offen lds
    s_add_u32 m0, s25, 9216
    s_add_u32 s64, s26, 0xf3000
    buffer_load_dwordx4 v2, s[48:51], s64 offen lds
    s_add_u32 m0, s25, 10240
    s_add_u32 s64, s26, 0x10e000
    buffer_load_dwordx4 v2, s[48:51], s64 offen lds
    s_add_u32 m0, s25, 11264
    s_add_u32 s64, s26, 0x129000
    buffer_load_dwordx4 v2, s[48:51], s64 offen lds
    s_add_u32 m0, s25, 12288
    s_add_u32 s64, s26, 0x144000
    buffer_load_dwordx4 v2, s[48:51], s64 offen lds
    s_add_u32 m0, s25, 13312
    s_add_u32 s64, s26, 0x15f000
    buffer_load_dwordx4 v2, s[48:51], s64 offen lds
    s_add_u32 m0, s25, 14336
    s_add_u32 s64, s26, 0x17a000
    buffer_load_dwordx4 v2, s[48:51], s64 offen lds
    s_add_u32 m0, s25, 15360
    s_add_u32 s64, s26, 0x195000
    buffer_load_dwordx4 v2, s[48:51], s64 offen lds
    s_add_u32 m0, s25, 16384
    s_add_u32 s64, s26, 0x1b0000
    buffer_load_dwordx4 v2, s[48:51], s64 offen lds
    s_add_u32 m0, s25, 17408
    s_add_u32 s64, s26, 0x1cb000
    buffer_load_dwordx4 v2, s[48:51], s64 offen lds
    s_add_u32 m0, s25, 18432
    s_add_u32 s64, s26, 0x1e6000
    buffer_load_dwordx4 v2, s[48:51], s64 offen lds
    s_add_u32 m0, s25, 19456
    s_add_u32 s64, s26, 0x201000
    buffer_load_dwordx4 v2, s[48:51], s64 offen lds
    s_waitcnt vmcnt(0)
    ds_read_b64_tr_b16 v[176:177], v3 offset:0
    ds_read_b64_tr_b16 v[178:179], v3 offset:128
    ds_read_b64_tr_b16 v[180:181], v3 offset:1024
    ds_read_b64_tr_b16 v[182:183], v3 offset:1152
    ds_read_b64_tr_b16 v[184:185], v3 offset:2048
    ds_read_b64_tr_b16 v[186:187], v3 offset:2176
    ds_read_b64_tr_b16 v[188:189], v3 offset:3072
    ds_read_b64_tr_b16 v[190:191], v3 offset:3200
    ds_read_b64_tr_b16 v[192:193], v3 offset:4096
    ds_read_b64_tr_b16 v[194:195], v3 offset:4224
    ds_read_b64_tr_b16 v[196:197], v3 offset:5120
    ds_read_b64_tr_b16 v[198:199], v3 offset:5248
    s_waitcnt lgkmcnt(4)
    ds_read_b64_tr_b16 v[200:201], v3 offset:6144
    ds_read_b64_tr_b16 v[202:203], v3 offset:6272
    ds_read_b64_tr_b16 v[204:205], v3 offset:7168
    ds_read_b64_tr_b16 v[206:207], v3 offset:7296
    ds_read_b64_tr_b16 v[208:209], v3 offset:8192
    ds_read_b64_tr_b16 v[210:211], v3 offset:8320
    ds_read_b64_tr_b16 v[212:213], v3 offset:9216
    ds_read_b64_tr_b16 v[214:215], v3 offset:9344
    ds_read_b64_tr_b16 v[216:217], v3 offset:10240
    ds_read_b64_tr_b16 v[218:219], v3 offset:10368
    ds_read_b64_tr_b16 v[220:221], v3 offset:11264
    ds_read_b64_tr_b16 v[222:223], v3 offset:11392
    s_waitcnt lgkmcnt(4)
    ds_read_b64_tr_b16 v[224:225], v3 offset:12288
    ds_read_b64_tr_b16 v[226:227], v3 offset:12416
    ds_read_b64_tr_b16 v[228:229], v3 offset:13312
    ds_read_b64_tr_b16 v[230:231], v3 offset:13440
    ds_read_b64_tr_b16 v[232:233], v3 offset:14336
    ds_read_b64_tr_b16 v[234:235], v3 offset:14464
    ds_read_b64_tr_b16 v[236:237], v3 offset:15360
    ds_read_b64_tr_b16 v[238:239], v3 offset:15488
    ds_read_b64_tr_b16 v[240:241], v3 offset:16384
    ds_read_b64_tr_b16 v[242:243], v3 offset:16512
    ds_read_b64_tr_b16 v[244:245], v3 offset:17408
    ds_read_b64_tr_b16 v[246:247], v3 offset:17536
    s_waitcnt lgkmcnt(4)
    ds_read_b64_tr_b16 v[248:249], v3 offset:18432
    ds_read_b64_tr_b16 v[250:251], v3 offset:18560
    ds_read_b64_tr_b16 v[252:253], v3 offset:19456
    ds_read_b64_tr_b16 v[254:255], v3 offset:19584
    s_waitcnt lgkmcnt(0)
    v_mfma_f32_16x16x32_bf16 v[8:11], v[96:99], v[16:19], 0
    v_mfma_f32_16x16x32_bf16 v[12:15], v[176:179], v[16:19], 0
    v_mfma_f32_16x16x32_bf16 v[8:11], v[100:103], v[20:23], v[8:11]
    v_mfma_f32_16x16x32_bf16 v[12:15], v[180:183], v[20:23], v[12:15]
    v_mfma_f32_16x16x32_bf16 v[8:11], v[104:107], v[24:27], v[8:11]
    v_mfma_f32_16x16x32_bf16 v[12:15], v[184:187], v[24:27], v[12:15]
    v_mfma_f32_16x16x32_bf16 v[8:11], v[108:111], v[28:31], v[8:11]
    v_mfma_f32_16x16x32_bf16 v[12:15], v[188:191], v[28:31], v[12:15]
    v_mfma_f32_16x16x32_bf16 v[8:11], v[112:115], v[32:35], v[8:11]
    v_mfma_f32_16x16x32_bf16 v[12:15], v[192:195], v[32:35], v[12:15]
    v_mfma_f32_16x16x32_bf16 v[8:11], v[116:119], v[36:39], v[8:11]
    v_mfma_f32_16x16x32_bf16 v[12:15], v[196:199], v[36:39], v[12:15]
    v_mfma_f32_16x16x32_bf16 v[8:11], v[120:123], v[40:43], v[8:11]
    v_mfma_f32_16x16x32_bf16 v[12:15], v[200:203], v[40:43], v[12:15]
    v_mfma_f32_16x16x32_bf16 v[8:11], v[124:127], v[44:47], v[8:11]
    v_mfma_f32_16x16x32_bf16 v[12:15], v[204:207], v[44:47], v[12:15]
    v_mfma_f32_16x16x32_bf16 v[8:11], v[128:131], v[48:51], v[8:11]
    v_mfma_f32_16x16x32_bf16 v[12:15], v[208:211], v[48:51], v[12:15]
    v_mfma_f32_16x16x32_bf16 v[8:11], v[132:135], v[52:55], v[8:11]
    v_mfma_f32_16x16x32_bf16 v[12:15], v[212:215], v[52:55], v[12:15]
    v_mfma_f32_16x16x32_bf16 v[8:11], v[136:139], v[56:59], v[8:11]
    v_mfma_f32_16x16x32_bf16 v[12:15], v[216:219], v[56:59], v[12:15]
    v_mfma_f32_16x16x32_bf16 v[8:11], v[140:143], v[60:63], v[8:11]
    v_mfma_f32_16x16x32_bf16 v[12:15], v[220:223], v[60:63], v[12:15]
    v_mfma_f32_16x16x32_bf16 v[8:11], v[144:147], v[64:67], v[8:11]
    v_mfma_f32_16x16x32_bf16 v[12:15], v[224:227], v[64:67], v[12:15]
    v_mfma_f32_16x16x32_bf16 v[8:11], v[148:151], v[68:71], v[8:11]
    v_mfma_f32_16x16x32_bf16 v[12:15], v[228:231], v[68:71], v[12:15]
    v_mfma_f32_16x16x32_bf16 v[8:11], v[152:155], v[72:75], v[8:11]
    v_mfma_f32_16x16x32_bf16 v[12:15], v[232:235], v[72:75], v[12:15]
    v_mfma_f32_16x16x32_bf16 v[8:11], v[156:159], v[76:79], v[8:11]
    v_mfma_f32_16x16x32_bf16 v[12:15], v[236:239], v[76:79], v[12:15]
    v_mfma_f32_16x16x32_bf16 v[8:11], v[160:163], v[80:83], v[8:11]
    v_mfma_f32_16x16x32_bf16 v[12:15], v[240:243], v[80:83], v[12:15]
    v_mfma_f32_16x16x32_bf16 v[8:11], v[164:167], v[84:87], v[8:11]
    v_mfma_f32_16x16x32_bf16 v[12:15], v[244:247], v[84:87], v[12:15]
    v_mfma_f32_16x16x32_bf16 v[8:11], v[168:171], v[88:91], v[8:11]
    v_mfma_f32_16x16x32_bf16 v[12:15], v[248:251], v[88:91], v[12:15]
    v_mfma_f32_16x16x32_bf16 v[8:11], v[172:175], v[92:95], v[8:11]
    v_mfma_f32_16x16x32_bf16 v[12:15], v[252:255], v[92:95], v[12:15]
    s_nop 7
    v_cvt_pk_bf16_f32 v8, v8, v8
    v_lshlrev_b32 v8, 16, v8
    v_cvt_pk_bf16_f32 v12, v12, v12
    v_lshlrev_b32 v12, 16, v12
    v_mul_f32 v16, 0xbfb8aa3b, v8
    v_exp_f32 v16, v16
    s_nop 0
    v_add_f32 v16, 1.0, v16
    v_rcp_f32 v16, v16
    s_nop 0
    v_mul_f32 v8, v8, v16
    v_cvt_pk_bf16_f32 v8, v8, v8
    v_lshlrev_b32 v8, 16, v8
    v_mul_f32 v8, v8, v12
    v_cvt_pk_bf16_f32 v9, v9, v9
    v_lshlrev_b32 v9, 16, v9
    v_cvt_pk_bf16_f32 v13, v13, v13
    v_lshlrev_b32 v13, 16, v13
    v_mul_f32 v17, 0xbfb8aa3b, v9
    v_exp_f32 v17, v17
    s_nop 0
    v_add_f32 v17, 1.0, v17
    v_rcp_f32 v17, v17
    s_nop 0
    v_mul_f32 v9, v9, v17
    v_cvt_pk_bf16_f32 v9, v9, v9
    v_lshlrev_b32 v9, 16, v9
    v_mul_f32 v9, v9, v13
    v_cvt_pk_bf16_f32 v10, v10, v10
    v_lshlrev_b32 v10, 16, v10
    v_cvt_pk_bf16_f32 v14, v14, v14
    v_lshlrev_b32 v14, 16, v14
    v_mul_f32 v18, 0xbfb8aa3b, v10
    v_exp_f32 v18, v18
    s_nop 0
    v_add_f32 v18, 1.0, v18
    v_rcp_f32 v18, v18
    s_nop 0
    v_mul_f32 v10, v10, v18
    v_cvt_pk_bf16_f32 v10, v10, v10
    v_lshlrev_b32 v10, 16, v10
    v_mul_f32 v10, v10, v14
    v_cvt_pk_bf16_f32 v11, v11, v11
    v_lshlrev_b32 v11, 16, v11
    v_cvt_pk_bf16_f32 v15, v15, v15
    v_lshlrev_b32 v15, 16, v15
    v_mul_f32 v19, 0xbfb8aa3b, v11
    v_exp_f32 v19, v19
    s_nop 0
    v_add_f32 v19, 1.0, v19
    v_rcp_f32 v19, v19
    s_nop 0
    v_mul_f32 v11, v11, v19
    v_cvt_pk_bf16_f32 v11, v11, v11
    v_lshlrev_b32 v11, 16, v11
    v_mul_f32 v11, v11, v15
    v_cvt_pk_bf16_f32 v16, v8, v9
    v_cvt_pk_bf16_f32 v17, v10, v11
    s_lshr_b32 s65, s24, 1
    s_lshl_b32 s65, s65, 10
    s_and_b32 s66, s24, 1
    s_lshl_b32 s66, s66, 3
    s_add_u32 s65, s65, s66
    s_add_u32 s65, s65, 0x5401000
    v_lshlrev_b32 v4, 4, v0
    buffer_store_dwordx2 v[16:17], v4, s[4:7], s65 offen sc1
    s_waitcnt vmcnt(0)
    v_mov_b32 v7, 1
    v_mov_b32 v8, 0
    s_mov_b32 s64, 0x298080
    s_mov_b64 exec, 1
    buffer_atomic_add v7, v8, s[4:7], s64 offen sc1
    s_mov_b64 exec, -1
H_A1:
    v_mbcnt_lo_u32_b32 v0, -1, 0
    v_mbcnt_hi_u32_b32 v0, -1, v0
    s_mov_b32 s29, 0
    v_lshlrev_b32 v1, 4, v0
    v_lshrrev_b32 v5, 4, v0
    v_lshlrev_b32 v2, 7, v5
    v_and_b32 v5, 7, v0
    v_lshl_add_u32 v2, v5, 4, v2
    v_bfe_u32 v5, v0, 4, 1
    v_lshlrev_b32 v3, 7, v5
    v_and_b32 v5, 15, v0
    v_lshl_add_u32 v3, v5, 3, v3
    s_mov_b32 s34, 0x3e0293ee
    s_mov_b32 s35, 0x3e0293ee
    s_mov_b32 s36, -1
    s_mov_b32 s37, 0
    v_lshrrev_b32 v5, 4, v0
    v_lshlrev_b32 v5, 2, v5
    v_and_b32 v6, 15, v0
    v_add_u32 v7, 0, v5
    v_cmp_le_u32 s[38:39], v7, v6
    v_add_u32 v7, 1, v5
    v_cmp_le_u32 s[40:41], v7, v6
    v_add_u32 v7, 2, v5
    v_cmp_le_u32 s[42:43], v7, v6
    v_add_u32 v7, 3, v5
    v_cmp_le_u32 s[44:45], v7, v6
    v_mov_b32 v248, 0x3f803f80
    v_mov_b32 v249, 0x3f803f80
    v_mov_b32 v250, 0x3f803f80
    v_mov_b32 v251, 0x3f803f80
    s_lshl_b32 s24, s12, 2
    s_add_u32 s24, s24, s14
    s_add_u32 s24, s24, 8
    s_mov_b32 s25, 1
AT1_LOOP:
    s_lshl_b32 s64, s24, 5
    s_add_u32 s64, s64, s13
    s_lshl_b32 s26, s64, 13
    s_add_u32 s26, s26, 0x3400000
    s_lshl_b32 s27, s64, 14
    s_add_u32 s27, s27, 0x1400000
    s_lshl_b32 s65, s64, 11
    s_add_u32 s30, s65, 0x640000
    s_add_u32 s31, s65, 0xa40000
    s_lshl_b32 s33, s64, 2
    s_add_u32 s33, s33, 0x296000
    s_lshl_b32 s32, s24, 18
    s_lshl_b32 s65, s13, 12
    s_add_u32 s32, s32, s65
    s_add_u32 s32, s32, 0x4400000
    s_lshr_b32 s65, s24, 2
    s_lshl_b32 s65, s65, 9
    s_lshl_b32 s66, s13, 4
    s_add_u32 s65, s65, s66
    s_add_u32 s65, s65, 0x291000
    s_lshr_b32 s66, s24, 1
    s_lshl_b32 s66, s66, 8
    s_lshl_b32 s64, s13, 3
    s_add_u32 s66, s66, s64
    s_add_u32 s66, s66, 0x293ff4
    v_lshlrev_b32 v5, 2, v0
    v_mov_b32 v6, s65
    v_mov_b32 v7, s66
    v_cmp_gt_u32 vcc, 3, v0
    s_nop 1
    v_cndmask_b32 v6, v7, v6, vcc
    v_add_u32 v4, v5, v6
    s_mov_b32 s64, 0
    s_mov_b64 exec, 7
AT1_F_157:
    buffer_load_dword v5, v4, s[4:7], s64 offen sc1
    s_add_u32 s29, s29, 1
    s_waitcnt vmcnt(0)
    v_cmp_eq_u32 vcc, 0, v5
    s_cbranch_vccz AT1_FD_158
    s_cmp_gt_u32 s29, 262144
    s_cbranch_scc1 AT1_FD_158
    s_sleep 1
    s_branch AT1_F_157
AT1_FD_158:
    s_mov_b64 exec, -1
    buffer_load_dwordx4 v[16:19], v1, s[4:7], s26 offen offset:0
    buffer_load_dwordx4 v[20:23], v1, s[4:7], s26 offen offset:1024
    buffer_load_dwordx4 v[24:27], v1, s[4:7], s26 offen offset:2048
    buffer_load_dwordx4 v[28:31], v1, s[4:7], s26 offen offset:3072
    s_add_u32 s26, s26, 4096
    buffer_load_dwordx4 v[32:35], v1, s[4:7], s26 offen offset:0
    buffer_load_dwordx4 v[36:39], v1, s[4:7], s26 offen offset:1024
    buffer_load_dwordx4 v[40:43], v1, s[4:7], s26 offen offset:2048
    buffer_load_dwordx4 v[44:47], v1, s[4:7], s26 offen offset:3072
    buffer_load_dwordx4 v[48:51], v1, s[4:7], s27 offen offset:0
    buffer_load_dwordx4 v[52:55], v1, s[4:7], s27 offen offset:1024
    buffer_load_dwordx4 v[56:59], v1, s[4:7], s27 offen offset:2048
    buffer_load_dwordx4 v[60:63], v1, s[4:7], s27 offen offset:3072
    s_add_u32 s27, s27, 4096
    buffer_load_dwordx4 v[64:67], v1, s[4:7], s27 offen offset:0
    buffer_load_dwordx4 v[68:71], v1, s[4:7], s27 offen offset:1024
    buffer_load_dwordx4 v[72:75], v1, s[4:7], s27 offen offset:2048
    buffer_load_dwordx4 v[76:79], v1, s[4:7], s27 offen offset:3072
    s_add_u32 s27, s27, 4096
    buffer_load_dwordx4 v[80:83], v1, s[4:7], s27 offen offset:0
    buffer_load_dwordx4 v[84:87], v1, s[4:7], s27 offen offset:1024
    buffer_load_dwordx4 v[88:91], v1, s[4:7], s27 offen offset:2048
    buffer_load_dwordx4 v[92:95], v1, s[4:7], s27 offen offset:3072
    s_add_u32 s27, s27, 4096
    buffer_load_dwordx4 v[96:99], v1, s[4:7], s27 offen offset:0
    buffer_load_dwordx4 v[100:103], v1, s[4:7], s27 offen offset:1024
    buffer_load_dwordx4 v[104:107], v1, s[4:7], s27 offen offset:2048
    buffer_load_dwordx4 v[108:111], v1, s[4:7], s27 offen offset:3072
    s_mov_b64 exec, 0x18
AT1_G_159:
    buffer_load_dword v5, v4, s[4:7], s64 offen sc1
    s_add_u32 s29, s29, 1
    s_waitcnt vmcnt(0)
    v_cmp_eq_u32 vcc, 0, v5
    s_cbranch_vccz AT1_GD_160
    s_cmp_gt_u32 s29, 262144
    s_cbranch_scc1 AT1_GD_160
    s_sleep 1
    s_branch AT1_G_159
AT1_GD_160:
    s_mov_b64 exec, -1
    buffer_load_dwordx4 v[112:115], v2, s[4:7], s30 offen offset:0
    buffer_load_dwordx4 v[116:119], v2, s[4:7], s30 offen offset:512
    buffer_load_dwordx4 v[120:123], v2, s[4:7], s30 offen offset:1024
    buffer_load_dwordx4 v[124:127], v2, s[4:7], s30 offen offset:1536
    buffer_load_dwordx2 v[128:129], v3, s[4:7], s31 offen offset:0
    buffer_load_dwordx2 v[130:131], v3, s[4:7], s31 offen offset:256
    buffer_load_dwordx2 v[132:133], v3, s[4:7], s31 offen offset:512
    buffer_load_dwordx2 v[134:135], v3, s[4:7], s31 offen offset:768
    buffer_load_dwordx2 v[136:137], v3, s[4:7], s31 offen offset:1024
    buffer_load_dwordx2 v[138:139], v3, s[4:7], s31 offen offset:1280
    buffer_load_dwordx2 v[140:141], v3, s[4:7], s31 offen offset:1536
    buffer_load_dwordx2 v[142:143], v3, s[4:7], s31 offen offset:1792
    v_mfma_f32_16x16x32_bf16 v[148:151], v[48:51], v[16:19], 0
    v_mfma_f32_16x16x32_bf16 v[156:159], v[48:51], v[32:35], 0
    v_mfma_f32_16x16x32_bf16 v[160:163], v[64:67], v[32:35], 0
    v_mfma_f32_16x16x32_bf16 v[148:151], v[52:55], v[20:23], v[148:151]
    v_mfma_f32_16x16x32_bf16 v[156:159], v[52:55], v[36:39], v[156:159]
    v_mfma_f32_16x16x32_bf16 v[160:163], v[68:71], v[36:39], v[160:163]
    v_mfma_f32_16x16x32_bf16 v[148:151], v[56:59], v[24:27], v[148:151]
    v_mfma_f32_16x16x32_bf16 v[156:159], v[56:59], v[40:43], v[156:159]
    v_mfma_f32_16x16x32_bf16 v[160:163], v[72:75], v[40:43], v[160:163]
    v_mfma_f32_16x16x32_bf16 v[148:151], v[60:63], v[28:31], v[148:151]
    v_mfma_f32_16x16x32_bf16 v[156:159], v[60:63], v[44:47], v[156:159]
    v_mfma_f32_16x16x32_bf16 v[160:163], v[76:79], v[44:47], v[160:163]
    s_waitcnt vmcnt(8)
    v_mfma_f32_16x16x32_bf16 v[144:147], v[112:115], v[16:19], 0
    v_mfma_f32_16x16x32_bf16 v[152:155], v[112:115], v[32:35], 0
    v_mfma_f32_16x16x32_bf16 v[144:147], v[116:119], v[20:23], v[144:147]
    v_mfma_f32_16x16x32_bf16 v[152:155], v[116:119], v[36:39], v[152:155]
    v_mfma_f32_16x16x32_bf16 v[144:147], v[120:123], v[24:27], v[144:147]
    v_mfma_f32_16x16x32_bf16 v[152:155], v[120:123], v[40:43], v[152:155]
    v_mfma_f32_16x16x32_bf16 v[144:147], v[124:127], v[28:31], v[144:147]
    v_mfma_f32_16x16x32_bf16 v[152:155], v[124:127], v[44:47], v[152:155]
    v_mov_b32 v11, 0xff800000
    s_nop 7
    v_cndmask_b32 v148, v11, v148, s[38:39]
    v_cndmask_b32 v160, v11, v160, s[38:39]
    v_cndmask_b32 v144, v11, v144, s[36:37]
    v_cndmask_b32 v152, v11, v152, s[36:37]
    v_cndmask_b32 v149, v11, v149, s[40:41]
    v_cndmask_b32 v161, v11, v161, s[40:41]
    v_cndmask_b32 v145, v11, v145, s[36:37]
    v_cndmask_b32 v153, v11, v153, s[36:37]
    v_cndmask_b32 v150, v11, v150, s[42:43]
    v_cndmask_b32 v162, v11, v162, s[42:43]
    v_cndmask_b32 v146, v11, v146, s[36:37]
    v_cndmask_b32 v154, v11, v154, s[36:37]
    v_cndmask_b32 v151, v11, v151, s[44:45]
    v_cndmask_b32 v163, v11, v163, s[44:45]
    v_cndmask_b32 v147, v11, v147, s[36:37]
    v_cndmask_b32 v155, v11, v155, s[36:37]
    v_max3_f32 v8, v144, v145, v146
    v_max3_f32 v8, v8, v147, v148
    v_max3_f32 v8, v8, v149, v150
    v_max_f32 v8, v8, v151
    v_mov_b32 v9, v8
    s_nop 1
    v_permlane16_swap_b32 v8, v9
    v_max_f32 v8, v8, v9
    v_mov_b32 v9, v8
    s_nop 1
    v_permlane32_swap_b32 v8, v9
    v_max_f32 v8, v8, v9
    v_mul_f32 v8, s34, v8
    v_fma_f32 v144, v144, s34, -v8
    v_fma_f32 v145, v145, s34, -v8
    v_fma_f32 v146, v146, s34, -v8
    v_fma_f32 v147, v147, s34, -v8
    v_fma_f32 v148, v148, s34, -v8
    v_fma_f32 v149, v149, s34, -v8
    v_fma_f32 v150, v150, s34, -v8
    v_fma_f32 v151, v151, s34, -v8
    v_exp_f32 v144, v144
    v_exp_f32 v145, v145
    v_exp_f32 v146, v146
    v_exp_f32 v147, v147
    v_exp_f32 v148, v148
    v_exp_f32 v149, v149
    v_exp_f32 v150, v150
    v_exp_f32 v151, v151
    s_nop 0
    v_cvt_pk_bf16_f32 v164, v148, v149
    v_cvt_pk_bf16_f32 v165, v150, v151
    v_mov_b32 v166, 0
    v_mov_b32 v167, 0
    v_cvt_pk_bf16_f32 v168, v144, v145
    v_cvt_pk_bf16_f32 v169, v146, v147
    v_max3_f32 v8, v152, v153, v154
    v_max3_f32 v8, v8, v155, v156
    v_max3_f32 v8, v8, v157, v158
    v_max3_f32 v8, v8, v159, v160
    v_max3_f32 v8, v8, v161, v162
    v_max_f32 v8, v8, v163
    v_mov_b32 v9, v8
    s_nop 1
    v_permlane16_swap_b32 v8, v9
    v_max_f32 v8, v8, v9
    v_mov_b32 v9, v8
    s_nop 1
    v_permlane32_swap_b32 v8, v9
    v_max_f32 v8, v8, v9
    v_mul_f32 v8, s34, v8
    v_fma_f32 v152, v152, s34, -v8
    v_fma_f32 v153, v153, s34, -v8
    v_fma_f32 v154, v154, s34, -v8
    v_fma_f32 v155, v155, s34, -v8
    v_fma_f32 v156, v156, s34, -v8
    v_fma_f32 v157, v157, s34, -v8
    v_fma_f32 v158, v158, s34, -v8
    v_fma_f32 v159, v159, s34, -v8
    v_fma_f32 v160, v160, s34, -v8
    v_fma_f32 v161, v161, s34, -v8
    v_fma_f32 v162, v162, s34, -v8
    v_fma_f32 v163, v163, s34, -v8
    v_exp_f32 v152, v152
    v_exp_f32 v153, v153
    v_exp_f32 v154, v154
    v_exp_f32 v155, v155
    v_exp_f32 v156, v156
    v_exp_f32 v157, v157
    v_exp_f32 v158, v158
    v_exp_f32 v159, v159
    v_exp_f32 v160, v160
    v_exp_f32 v161, v161
    v_exp_f32 v162, v162
    v_exp_f32 v163, v163
    s_nop 0
    v_cvt_pk_bf16_f32 v170, v156, v157
    v_cvt_pk_bf16_f32 v171, v158, v159
    v_cvt_pk_bf16_f32 v172, v160, v161
    v_cvt_pk_bf16_f32 v173, v162, v163
    v_cvt_pk_bf16_f32 v174, v152, v153
    v_cvt_pk_bf16_f32 v175, v154, v155
    s_waitcnt vmcnt(0)
    v_mfma_f32_16x16x32_bf16 v[240:243], v[248:251], v[164:167], 0
    v_mfma_f32_16x16x32_bf16 v[244:247], v[248:251], v[170:173], 0
    v_mfma_f32_16x16x32_bf16 v[176:179], v[80:83], v[164:167], 0
    v_mfma_f32_16x16x32_bf16 v[180:183], v[80:83], v[170:173], 0
    v_mfma_f32_16x16x32_bf16 v[184:187], v[84:87], v[164:167], 0
    v_mfma_f32_16x16x32_bf16 v[188:191], v[84:87], v[170:173], 0
    v_mfma_f32_16x16x32_bf16 v[192:195], v[88:91], v[164:167], 0
    v_mfma_f32_16x16x32_bf16 v[196:199], v[88:91], v[170:173], 0
    v_mfma_f32_16x16x32_bf16 v[200:203], v[92:95], v[164:167], 0
    v_mfma_f32_16x16x32_bf16 v[204:207], v[92:95], v[170:173], 0
    v_mfma_f32_16x16x32_bf16 v[208:211], v[96:99], v[164:167], 0
    v_mfma_f32_16x16x32_bf16 v[212:215], v[96:99], v[170:173], 0
    v_mfma_f32_16x16x32_bf16 v[216:219], v[100:103], v[164:167], 0
    v_mfma_f32_16x16x32_bf16 v[220:223], v[100:103], v[170:173], 0
    v_mfma_f32_16x16x32_bf16 v[224:227], v[104:107], v[164:167], 0
    v_mfma_f32_16x16x32_bf16 v[228:231], v[104:107], v[170:173], 0
    v_mfma_f32_16x16x32_bf16 v[232:235], v[108:111], v[164:167], 0
    v_mfma_f32_16x16x32_bf16 v[236:239], v[108:111], v[170:173], 0
    v_mfma_f32_16x16x16_bf16 v[240:243], v[248:249], v[168:169], v[240:243]
    v_mfma_f32_16x16x16_bf16 v[244:247], v[248:249], v[174:175], v[244:247]
    v_mfma_f32_16x16x16_bf16 v[176:179], v[128:129], v[168:169], v[176:179]
    v_mfma_f32_16x16x16_bf16 v[180:183], v[128:129], v[174:175], v[180:183]
    v_mfma_f32_16x16x16_bf16 v[184:187], v[130:131], v[168:169], v[184:187]
    v_mfma_f32_16x16x16_bf16 v[188:191], v[130:131], v[174:175], v[188:191]
    v_mfma_f32_16x16x16_bf16 v[192:195], v[132:133], v[168:169], v[192:195]
    v_mfma_f32_16x16x16_bf16 v[196:199], v[132:133], v[174:175], v[196:199]
    v_mfma_f32_16x16x16_bf16 v[200:203], v[134:135], v[168:169], v[200:203]
    v_mfma_f32_16x16x16_bf16 v[204:207], v[134:135], v[174:175], v[204:207]
    v_mfma_f32_16x16x16_bf16 v[208:211], v[136:137], v[168:169], v[208:211]
    v_mfma_f32_16x16x16_bf16 v[212:215], v[136:137], v[174:175], v[212:215]
    v_mfma_f32_16x16x16_bf16 v[216:219], v[138:139], v[168:169], v[216:219]
    v_mfma_f32_16x16x16_bf16 v[220:223], v[138:139], v[174:175], v[220:223]
    v_mfma_f32_16x16x16_bf16 v[224:227], v[140:141], v[168:169], v[224:227]
    v_mfma_f32_16x16x16_bf16 v[228:231], v[140:141], v[174:175], v[228:231]
    v_mfma_f32_16x16x16_bf16 v[232:235], v[142:143], v[168:169], v[232:235]
    v_mfma_f32_16x16x16_bf16 v[236:239], v[142:143], v[174:175], v[236:239]
    v_rcp_f32 v8, v240
    v_rcp_f32 v9, v244
    s_nop 7
    v_mul_f32 v176, v176, v8
    v_mul_f32 v177, v177, v8
    v_mul_f32 v178, v178, v8
    v_mul_f32 v179, v179, v8
    v_cvt_pk_bf16_f32 v16, v176, v177
    v_cvt_pk_bf16_f32 v17, v178, v179
    v_mul_f32 v184, v184, v8
    v_mul_f32 v185, v185, v8
    v_mul_f32 v186, v186, v8
    v_mul_f32 v187, v187, v8
    v_cvt_pk_bf16_f32 v18, v184, v185
    v_cvt_pk_bf16_f32 v19, v186, v187
    s_add_u32 s64, s32, 0x0
    buffer_store_dwordx4 v[16:19], v1, s[4:7], s64 offen offset:0 sc1
    v_mul_f32 v192, v192, v8
    v_mul_f32 v193, v193, v8
    v_mul_f32 v194, v194, v8
    v_mul_f32 v195, v195, v8
    v_cvt_pk_bf16_f32 v20, v192, v193
    v_cvt_pk_bf16_f32 v21, v194, v195
    v_mul_f32 v200, v200, v8
    v_mul_f32 v201, v201, v8
    v_mul_f32 v202, v202, v8
    v_mul_f32 v203, v203, v8
    v_cvt_pk_bf16_f32 v22, v200, v201
    v_cvt_pk_bf16_f32 v23, v202, v203
    s_add_u32 s64, s32, 0x0
    buffer_store_dwordx4 v[20:23], v1, s[4:7], s64 offen offset:1024 sc1
    v_mul_f32 v208, v208, v8
    v_mul_f32 v209, v209, v8
    v_mul_f32 v210, v210, v8
    v_mul_f32 v211, v211, v8
    v_cvt_pk_bf16_f32 v24, v208, v209
    v_cvt_pk_bf16_f32 v25, v210, v211
    v_mul_f32 v216, v216, v8
    v_mul_f32 v217, v217, v8
    v_mul_f32 v218, v218, v8
    v_mul_f32 v219, v219, v8
    v_cvt_pk_bf16_f32 v26, v216, v217
    v_cvt_pk_bf16_f32 v27, v218, v219
    s_add_u32 s64, s32, 0x0
    buffer_store_dwordx4 v[24:27], v1, s[4:7], s64 offen offset:2048 sc1
    v_mul_f32 v224, v224, v8
    v_mul_f32 v225, v225, v8
    v_mul_f32 v226, v226, v8
    v_mul_f32 v227, v227, v8
    v_cvt_pk_bf16_f32 v28, v224, v225
    v_cvt_pk_bf16_f32 v29, v226, v227
    v_mul_f32 v232, v232, v8
    v_mul_f32 v233, v233, v8
    v_mul_f32 v234, v234, v8
    v_mul_f32 v235, v235, v8
    v_cvt_pk_bf16_f32 v30, v232, v233
    v_cvt_pk_bf16_f32 v31, v234, v235
    s_add_u32 s64, s32, 0x0
    buffer_store_dwordx4 v[28:31], v1, s[4:7], s64 offen offset:3072 sc1
    v_mul_f32 v180, v180, v9
    v_mul_f32 v181, v181, v9
    v_mul_f32 v182, v182, v9
    v_mul_f32 v183, v183, v9
    v_cvt_pk_bf16_f32 v32, v180, v181
    v_cvt_pk_bf16_f32 v33, v182, v183
    v_mul_f32 v188, v188, v9
    v_mul_f32 v189, v189, v9
    v_mul_f32 v190, v190, v9
    v_mul_f32 v191, v191, v9
    v_cvt_pk_bf16_f32 v34, v188, v189
    v_cvt_pk_bf16_f32 v35, v190, v191
    s_add_u32 s64, s32, 0x20000
    buffer_store_dwordx4 v[32:35], v1, s[4:7], s64 offen offset:0 sc1
    v_mul_f32 v196, v196, v9
    v_mul_f32 v197, v197, v9
    v_mul_f32 v198, v198, v9
    v_mul_f32 v199, v199, v9
    v_cvt_pk_bf16_f32 v36, v196, v197
    v_cvt_pk_bf16_f32 v37, v198, v199
    v_mul_f32 v204, v204, v9
    v_mul_f32 v205, v205, v9
    v_mul_f32 v206, v206, v9
    v_mul_f32 v207, v207, v9
    v_cvt_pk_bf16_f32 v38, v204, v205
    v_cvt_pk_bf16_f32 v39, v206, v207
    s_add_u32 s64, s32, 0x20000
    buffer_store_dwordx4 v[36:39], v1, s[4:7], s64 offen offset:1024 sc1
    v_mul_f32 v212, v212, v9
    v_mul_f32 v213, v213, v9
    v_mul_f32 v214, v214, v9
    v_mul_f32 v215, v215, v9
    v_cvt_pk_bf16_f32 v40, v212, v213
    v_cvt_pk_bf16_f32 v41, v214, v215
    v_mul_f32 v220, v220, v9
    v_mul_f32 v221, v221, v9
    v_mul_f32 v222, v222, v9
    v_mul_f32 v223, v223, v9
    v_cvt_pk_bf16_f32 v42, v220, v221
    v_cvt_pk_bf16_f32 v43, v222, v223
    s_add_u32 s64, s32, 0x20000
    buffer_store_dwordx4 v[40:43], v1, s[4:7], s64 offen offset:2048 sc1
    v_mul_f32 v228, v228, v9
    v_mul_f32 v229, v229, v9
    v_mul_f32 v230, v230, v9
    v_mul_f32 v231, v231, v9
    v_cvt_pk_bf16_f32 v44, v228, v229
    v_cvt_pk_bf16_f32 v45, v230, v231
    v_mul_f32 v236, v236, v9
    v_mul_f32 v237, v237, v9
    v_mul_f32 v238, v238, v9
    v_mul_f32 v239, v239, v9
    v_cvt_pk_bf16_f32 v46, v236, v237
    v_cvt_pk_bf16_f32 v47, v238, v239
    s_add_u32 s64, s32, 0x20000
    buffer_store_dwordx4 v[44:47], v1, s[4:7], s64 offen offset:3072 sc1
    s_waitcnt vmcnt(0)
    v_mov_b32 v7, 1
    v_mov_b32 v8, 0
    s_mov_b64 exec, 1
    buffer_store_dword v7, v8, s[4:7], s33 offen sc1
    s_mov_b64 exec, -1
    s_add_u32 s24, s24, 8
    s_add_u32 s25, s25, 1
    s_cmp_lt_u32 s25, 2
    s_cbranch_scc1 AT1_LOOP
    s_lshl_b32 s70, s13, 1
    s_add_u32 s70, s70, s12
    s_load_dwordx2 s[44:45], s[0:1], 72
    s_mov_b32 s46, 0x21c000
    s_mov_b32 s47, 0x00020000
    s_load_dwordx2 s[48:49], s[0:1], 80
    s_mov_b32 s50, 0x21c000
    s_mov_b32 s51, 0x00020000
    s_load_dwordx2 s[52:53], s[0:1], 88
    s_mov_b32 s54, 0x21c000
    s_mov_b32 s55, 0x00020000
    s_mov_b32 s29, 0
    s_waitcnt lgkmcnt(0)
    v_mbcnt_lo_u32_b32 v0, -1, 0
    v_mbcnt_hi_u32_b32 v0, -1, v0
    s_cmp_lg_u32 s14, 0
    s_cbranch_scc1 H_ATT
    s_cmp_ge_u32 s70, 40
    s_cbranch_scc1 H_ATT
    s_mov_b32 s24, s70
    v_mov_b32 v8, 0
    s_mov_b32 s64, 0x298080
F2W_161:
    buffer_load_dword v7, v8, s[4:7], s64 offen sc1
    s_add_u32 s29, s29, 1
    s_waitcnt vmcnt(0)
    v_mov_b32 v9, 108
    v_cmp_gt_u32 vcc, v9, v7
    s_cbranch_vccz F2WD_162
    s_cmp_gt_u32 s29, 262144
    s_cbranch_scc1 F2WD_162
    s_sleep 8
    s_branch F2W_161
F2WD_162:
    s_mov_b32 s25, 0
    v_lshrrev_b32 v7, 1, v0
    v_mul_u32_u24 v2, 1280, v7
    v_and_b32 v7, 1, v0
    v_lshl_add_u32 v2, v7, 4, v2
    v_lshrrev_b32 v7, 4, v0
    v_lshlrev_b32 v3, 7, v7
    v_bfe_u32 v7, v0, 2, 2
    v_lshl_add_u32 v3, v7, 5, v3
    v_and_b32 v7, 3, v0
    v_lshl_add_u32 v3, v7, 3, v3
    v_add_u32 v3, s25, v3
    v_lshlrev_b32 v4, 4, v0
    s_mov_b32 s65, 0x5401000
    buffer_load_dwordx4 v[16:19], v4, s[4:7], s65 offen offset:0 sc1
    buffer_load_dwordx4 v[20:23], v4, s[4:7], s65 offen offset:1024 sc1
    buffer_load_dwordx4 v[24:27], v4, s[4:7], s65 offen offset:2048 sc1
    buffer_load_dwordx4 v[28:31], v4, s[4:7], s65 offen offset:3072 sc1
    s_add_u32 s65, s65, 4096
    buffer_load_dwordx4 v[32:35], v4, s[4:7], s65 offen offset:0 sc1
    buffer_load_dwordx4 v[36:39], v4, s[4:7], s65 offen offset:1024 sc1
    buffer_load_dwordx4 v[40:43], v4, s[4:7], s65 offen offset:2048 sc1
    buffer_load_dwordx4 v[44:47], v4, s[4:7], s65 offen offset:3072 sc1
    s_add_u32 s65, s65, 4096
    buffer_load_dwordx4 v[48:51], v4, s[4:7], s65 offen offset:0 sc1
    buffer_load_dwordx4 v[52:55], v4, s[4:7], s65 offen offset:1024 sc1
    buffer_load_dwordx4 v[56:59], v4, s[4:7], s65 offen offset:2048 sc1
    buffer_load_dwordx4 v[60:63], v4, s[4:7], s65 offen offset:3072 sc1
    s_add_u32 s65, s65, 4096
    buffer_load_dwordx4 v[64:67], v4, s[4:7], s65 offen offset:0 sc1
    buffer_load_dwordx4 v[68:71], v4, s[4:7], s65 offen offset:1024 sc1
    buffer_load_dwordx4 v[72:75], v4, s[4:7], s65 offen offset:2048 sc1
    buffer_load_dwordx4 v[76:79], v4, s[4:7], s65 offen offset:3072 sc1
    s_add_u32 s65, s65, 4096
    buffer_load_dwordx4 v[80:83], v4, s[4:7], s65 offen offset:0 sc1
    buffer_load_dwordx4 v[84:87], v4, s[4:7], s65 offen offset:1024 sc1
    buffer_load_dwordx4 v[88:91], v4, s[4:7], s65 offen offset:2048 sc1
    buffer_load_dwordx4 v[92:95], v4, s[4:7], s65 offen offset:3072 sc1
    s_add_u32 s65, s65, 4096
    buffer_load_dwordx4 v[96:99], v4, s[4:7], s65 offen offset:0 sc1
    buffer_load_dwordx4 v[100:103], v4, s[4:7], s65 offen offset:1024 sc1
    buffer_load_dwordx4 v[104:107], v4, s[4:7], s65 offen offset:2048 sc1
    buffer_load_dwordx4 v[108:111], v4, s[4:7], s65 offen offset:3072 sc1
    s_add_u32 s65, s65, 4096
    buffer_load_dwordx4 v[112:115], v4, s[4:7], s65 offen offset:0 sc1
    buffer_load_dwordx4 v[116:119], v4, s[4:7], s65 offen offset:1024 sc1
    buffer_load_dwordx4 v[120:123], v4, s[4:7], s65 offen offset:2048 sc1
    buffer_load_dwordx4 v[124:127], v4, s[4:7], s65 offen offset:3072 sc1
    s_add_u32 s65, s65, 4096
    buffer_load_dwordx4 v[128:131], v4, s[4:7], s65 offen offset:0 sc1
    buffer_load_dwordx4 v[132:135], v4, s[4:7], s65 offen offset:1024 sc1
    buffer_load_dwordx4 v[136:139], v4, s[4:7], s65 offen offset:2048 sc1
    buffer_load_dwordx4 v[140:143], v4, s[4:7], s65 offen offset:3072 sc1
    s_add_u32 s65, s65, 4096
    buffer_load_dwordx4 v[144:147], v4, s[4:7], s65 offen offset:0 sc1
    buffer_load_dwordx4 v[148:151], v4, s[4:7], s65 offen offset:1024 sc1
    buffer_load_dwordx4 v[152:155], v4, s[4:7], s65 offen offset:2048 sc1
    buffer_load_dwordx4 v[156:159], v4, s[4:7], s65 offen offset:3072 sc1
    s_add_u32 s65, s65, 4096
    buffer_load_dwordx4 v[160:163], v4, s[4:7], s65 offen offset:0 sc1
    buffer_load_dwordx4 v[164:167], v4, s[4:7], s65 offen offset:1024 sc1
    buffer_load_dwordx4 v[168:171], v4, s[4:7], s65 offen offset:2048 sc1
    buffer_load_dwordx4 v[172:175], v4, s[4:7], s65 offen offset:3072 sc1
    s_add_u32 s65, s65, 4096
    buffer_load_dwordx4 v[176:179], v4, s[4:7], s65 offen offset:0 sc1
    s_waitcnt vmcnt(20)
    buffer_load_dwordx4 v[180:183], v4, s[4:7], s65 offen offset:1024 sc1
    buffer_load_dwordx4 v[184:187], v4, s[4:7], s65 offen offset:2048 sc1
    buffer_load_dwordx4 v[188:191], v4, s[4:7], s65 offen offset:3072 sc1
    s_add_u32 s65, s65, 4096
    buffer_load_dwordx4 v[192:195], v4, s[4:7], s65 offen offset:0 sc1
    buffer_load_dwordx4 v[196:199], v4, s[4:7], s65 offen offset:1024 sc1
    buffer_load_dwordx4 v[200:203], v4, s[4:7], s65 offen offset:2048 sc1
    buffer_load_dwordx4 v[204:207], v4, s[4:7], s65 offen offset:3072 sc1
    s_add_u32 s65, s65, 4096
    buffer_load_dwordx4 v[208:211], v4, s[4:7], s65 offen offset:0 sc1
    buffer_load_dwordx4 v[212:215], v4, s[4:7], s65 offen offset:1024 sc1
    buffer_load_dwordx4 v[216:219], v4, s[4:7], s65 offen offset:2048 sc1
    buffer_load_dwordx4 v[220:223], v4, s[4:7], s65 offen offset:3072 sc1
    s_add_u32 s65, s65, 4096
    buffer_load_dwordx4 v[224:227], v4, s[4:7], s65 offen offset:0 sc1
    buffer_load_dwordx4 v[228:231], v4, s[4:7], s65 offen offset:1024 sc1
    s_waitcnt vmcnt(0)
    s_lshl_b32 s26, s24, 5
    s_add_u32 m0, s25, 0
    s_add_u32 s64, s26, 0x0
    buffer_load_dwordx4 v2, s[52:55], s64 offen lds
    s_add_u32 m0, s25, 1024
    s_add_u32 s64, s26, 0xa000
    buffer_load_dwordx4 v2, s[52:55], s64 offen lds
    s_add_u32 m0, s25, 2048
    s_add_u32 s64, s26, 0x14000
    buffer_load_dwordx4 v2, s[52:55], s64 offen lds
    s_add_u32 m0, s25, 3072
    s_add_u32 s64, s26, 0x1e000
    buffer_load_dwordx4 v2, s[52:55], s64 offen lds
    s_add_u32 m0, s25, 4096
    s_add_u32 s64, s26, 0x28000
    buffer_load_dwordx4 v2, s[52:55], s64 offen lds
    s_add_u32 m0, s25, 5120
    s_add_u32 s64, s26, 0x32000
    buffer_load_dwordx4 v2, s[52:55], s64 offen lds
    s_add_u32 m0, s25, 6144
    s_add_u32 s64, s26, 0x3c000
    buffer_load_dwordx4 v2, s[52:55], s64 offen lds
    s_add_u32 m0, s25, 7168
    s_add_u32 s64, s26, 0x46000
    buffer_load_dwordx4 v2, s[52:55], s64 offen lds
    s_add_u32 m0, s25, 8192
    s_add_u32 s64, s26, 0x50000
    buffer_load_dwordx4 v2, s[52:55], s64 offen lds
    s_add_u32 m0, s25, 9216
    s_add_u32 s64, s26, 0x5a000
    buffer_load_dwordx4 v2, s[52:55], s64 offen lds
    s_add_u32 m0, s25, 10240
    s_add_u32 s64, s26, 0x64000
    buffer_load_dwordx4 v2, s[52:55], s64 offen lds
    s_add_u32 m0, s25, 11264
    s_add_u32 s64, s26, 0x6e000
    buffer_load_dwordx4 v2, s[52:55], s64 offen lds
    s_add_u32 m0, s25, 12288
    s_add_u32 s64, s26, 0x78000
    buffer_load_dwordx4 v2, s[52:55], s64 offen lds
    s_add_u32 m0, s25, 13312
    s_add_u32 s64, s26, 0x82000
    buffer_load_dwordx4 v2, s[52:55], s64 offen lds
    s_add_u32 m0, s25, 14336
    s_add_u32 s64, s26, 0x8c000
    buffer_load_dwordx4 v2, s[52:55], s64 offen lds
    s_add_u32 m0, s25, 15360
    s_add_u32 s64, s26, 0x96000
    buffer_load_dwordx4 v2, s[52:55], s64 offen lds
    s_add_u32 m0, s25, 16384
    s_add_u32 s64, s26, 0xa0000
    buffer_load_dwordx4 v2, s[52:55], s64 offen lds
    s_add_u32 m0, s25, 17408
    s_add_u32 s64, s26, 0xaa000
    buffer_load_dwordx4 v2, s[52:55], s64 offen lds
    s_add_u32 m0, s25, 18432
    s_add_u32 s64, s26, 0xb4000
    buffer_load_dwordx4 v2, s[52:55], s64 offen lds
    s_add_u32 m0, s25, 19456
    s_add_u32 s64, s26, 0xbe000
    buffer_load_dwordx4 v2, s[52:55], s64 offen lds
    s_add_u32 m0, s25, 20480
    s_add_u32 s64, s26, 0xc8000
    buffer_load_dwordx4 v2, s[52:55], s64 offen lds
    s_add_u32 m0, s25, 21504
    s_add_u32 s64, s26, 0xd2000
    buffer_load_dwordx4 v2, s[52:55], s64 offen lds
    s_add_u32 m0, s25, 22528
    s_add_u32 s64, s26, 0xdc000
    buffer_load_dwordx4 v2, s[52:55], s64 offen lds
    s_add_u32 m0, s25, 23552
    s_add_u32 s64, s26, 0xe6000
    buffer_load_dwordx4 v2, s[52:55], s64 offen lds
    s_add_u32 m0, s25, 24576
    s_add_u32 s64, s26, 0xf0000
    buffer_load_dwordx4 v2, s[52:55], s64 offen lds
    s_add_u32 m0, s25, 25600
    s_add_u32 s64, s26, 0xfa000
    buffer_load_dwordx4 v2, s[52:55], s64 offen lds
    s_add_u32 m0, s25, 26624
    s_add_u32 s64, s26, 0x104000
    buffer_load_dwordx4 v2, s[52:55], s64 offen lds
    s_add_u32 m0, s25, 27648
    s_add_u32 s64, s26, 0x10e000
    buffer_load_dwordx4 v2, s[52:55], s64 offen lds
    s_add_u32 m0, s25, 28672
    s_add_u32 s64, s26, 0x118000
    buffer_load_dwordx4 v2, s[52:55], s64 offen lds
    s_add_u32 m0, s25, 29696
    s_add_u32 s64, s26, 0x122000
    buffer_load_dwordx4 v2, s[52:55], s64 offen lds
    s_add_u32 m0, s25, 30720
    s_add_u32 s64, s26, 0x12c000
    buffer_load_dwordx4 v2, s[52:55], s64 offen lds
    s_add_u32 m0, s25, 31744
    s_add_u32 s64, s26, 0x136000
    buffer_load_dwordx4 v2, s[52:55], s64 offen lds
    s_add_u32 m0, s25, 32768
    s_add_u32 s64, s26, 0x140000
    buffer_load_dwordx4 v2, s[52:55], s64 offen lds
    s_add_u32 m0, s25, 33792
    s_add_u32 s64, s26, 0x14a000
    buffer_load_dwordx4 v2, s[52:55], s64 offen lds
    s_add_u32 m0, s25, 34816
    s_add_u32 s64, s26, 0x154000
    buffer_load_dwordx4 v2, s[52:55], s64 offen lds
    s_add_u32 m0, s25, 35840
    s_add_u32 s64, s26, 0x15e000
    buffer_load_dwordx4 v2, s[52:55], s64 offen lds
    s_add_u32 m0, s25, 36864
    s_add_u32 s64, s26, 0x168000
    buffer_load_dwordx4 v2, s[52:55], s64 offen lds
    s_add_u32 m0, s25, 37888
    s_add_u32 s64, s26, 0x172000
    buffer_load_dwordx4 v2, s[52:55], s64 offen lds
    s_add_u32 m0, s25, 38912
    s_add_u32 s64, s26, 0x17c000
    buffer_load_dwordx4 v2, s[52:55], s64 offen lds
    s_add_u32 m0, s25, 39936
    s_add_u32 s64, s26, 0x186000
    buffer_load_dwordx4 v2, s[52:55], s64 offen lds
    s_add_u32 m0, s25, 40960
    s_add_u32 s64, s26, 0x190000
    buffer_load_dwordx4 v2, s[52:55], s64 offen lds
    s_waitcnt vmcnt(20)
    s_add_u32 m0, s25, 41984
    s_add_u32 s64, s26, 0x19a000
    buffer_load_dwordx4 v2, s[52:55], s64 offen lds
    s_add_u32 m0, s25, 43008
    s_add_u32 s64, s26, 0x1a4000
    buffer_load_dwordx4 v2, s[52:55], s64 offen lds
    s_add_u32 m0, s25, 44032
    s_add_u32 s64, s26, 0x1ae000
    buffer_load_dwordx4 v2, s[52:55], s64 offen lds
    s_add_u32 m0, s25, 45056
    s_add_u32 s64, s26, 0x1b8000
    buffer_load_dwordx4 v2, s[52:55], s64 offen lds
    s_add_u32 m0, s25, 46080
    s_add_u32 s64, s26, 0x1c2000
    buffer_load_dwordx4 v2, s[52:55], s64 offen lds
    s_add_u32 m0, s25, 47104
    s_add_u32 s64, s26, 0x1cc000
    buffer_load_dwordx4 v2, s[52:55], s64 offen lds
    s_add_u32 m0, s25, 48128
    s_add_u32 s64, s26, 0x1d6000
    buffer_load_dwordx4 v2, s[52:55], s64 offen lds
    s_add_u32 m0, s25, 49152
    s_add_u32 s64, s26, 0x1e0000
    buffer_load_dwordx4 v2, s[52:55], s64 offen lds
    s_add_u32 m0, s25, 50176
    s_add_u32 s64, s26, 0x1ea000
    buffer_load_dwordx4 v2, s[52:55], s64 offen lds
    s_add_u32 m0, s25, 51200
    s_add_u32 s64, s26, 0x1f4000
    buffer_load_dwordx4 v2, s[52:55], s64 offen lds
    s_add_u32 m0, s25, 52224
    s_add_u32 s64, s26, 0x1fe000
    buffer_load_dwordx4 v2, s[52:55], s64 offen lds
    s_add_u32 m0, s25, 53248
    s_add_u32 s64, s26, 0x208000
    buffer_load_dwordx4 v2, s[52:55], s64 offen lds
    s_add_u32 m0, s25, 54272
    s_add_u32 s64, s26, 0x212000
    buffer_load_dwordx4 v2, s[52:55], s64 offen lds
    s_waitcnt vmcnt(0)
    ds_read_b64_tr_b16 v[232:233], v3 offset:0
    ds_read_b64_tr_b16 v[234:235], v3 offset:512
    s_waitcnt lgkmcnt(0)
    v_mfma_f32_16x16x32_bf16 v[8:11], v[232:235], v[16:19], 0
    ds_read_b64_tr_b16 v[236:237], v3 offset:1024
    ds_read_b64_tr_b16 v[238:239], v3 offset:1536
    s_waitcnt lgkmcnt(0)
    v_mfma_f32_16x16x32_bf16 v[8:11], v[236:239], v[20:23], v[8:11]
    ds_read_b64_tr_b16 v[240:241], v3 offset:2048
    ds_read_b64_tr_b16 v[242:243], v3 offset:2560
    s_waitcnt lgkmcnt(0)
    v_mfma_f32_16x16x32_bf16 v[8:11], v[240:243], v[24:27], v[8:11]
    ds_read_b64_tr_b16 v[244:245], v3 offset:3072
    ds_read_b64_tr_b16 v[246:247], v3 offset:3584
    s_waitcnt lgkmcnt(0)
    v_mfma_f32_16x16x32_bf16 v[8:11], v[244:247], v[28:31], v[8:11]
    ds_read_b64_tr_b16 v[232:233], v3 offset:4096
    ds_read_b64_tr_b16 v[234:235], v3 offset:4608
    s_waitcnt lgkmcnt(0)
    v_mfma_f32_16x16x32_bf16 v[8:11], v[232:235], v[32:35], v[8:11]
    ds_read_b64_tr_b16 v[236:237], v3 offset:5120
    ds_read_b64_tr_b16 v[238:239], v3 offset:5632
    s_waitcnt lgkmcnt(0)
    v_mfma_f32_16x16x32_bf16 v[8:11], v[236:239], v[36:39], v[8:11]
    ds_read_b64_tr_b16 v[240:241], v3 offset:6144
    ds_read_b64_tr_b16 v[242:243], v3 offset:6656
    s_waitcnt lgkmcnt(0)
    v_mfma_f32_16x16x32_bf16 v[8:11], v[240:243], v[40:43], v[8:11]
    ds_read_b64_tr_b16 v[244:245], v3 offset:7168
    ds_read_b64_tr_b16 v[246:247], v3 offset:7680
    s_waitcnt lgkmcnt(0)
    v_mfma_f32_16x16x32_bf16 v[8:11], v[244:247], v[44:47], v[8:11]
    ds_read_b64_tr_b16 v[232:233], v3 offset:8192
    ds_read_b64_tr_b16 v[234:235], v3 offset:8704
    s_waitcnt lgkmcnt(0)
    v_mfma_f32_16x16x32_bf16 v[8:11], v[232:235], v[48:51], v[8:11]
    ds_read_b64_tr_b16 v[236:237], v3 offset:9216
    ds_read_b64_tr_b16 v[238:239], v3 offset:9728
    s_waitcnt lgkmcnt(0)
    v_mfma_f32_16x16x32_bf16 v[8:11], v[236:239], v[52:55], v[8:11]
    ds_read_b64_tr_b16 v[240:241], v3 offset:10240
    ds_read_b64_tr_b16 v[242:243], v3 offset:10752
    s_waitcnt lgkmcnt(0)
    v_mfma_f32_16x16x32_bf16 v[8:11], v[240:243], v[56:59], v[8:11]
    ds_read_b64_tr_b16 v[244:245], v3 offset:11264
    ds_read_b64_tr_b16 v[246:247], v3 offset:11776
    s_waitcnt lgkmcnt(0)
    v_mfma_f32_16x16x32_bf16 v[8:11], v[244:247], v[60:63], v[8:11]
    ds_read_b64_tr_b16 v[232:233], v3 offset:12288
    ds_read_b64_tr_b16 v[234:235], v3 offset:12800
    s_waitcnt lgkmcnt(0)
    v_mfma_f32_16x16x32_bf16 v[8:11], v[232:235], v[64:67], v[8:11]
    ds_read_b64_tr_b16 v[236:237], v3 offset:13312
    ds_read_b64_tr_b16 v[238:239], v3 offset:13824
    s_waitcnt lgkmcnt(0)
    v_mfma_f32_16x16x32_bf16 v[8:11], v[236:239], v[68:71], v[8:11]
    ds_read_b64_tr_b16 v[240:241], v3 offset:14336
    ds_read_b64_tr_b16 v[242:243], v3 offset:14848
    s_waitcnt lgkmcnt(0)
    v_mfma_f32_16x16x32_bf16 v[8:11], v[240:243], v[72:75], v[8:11]
    ds_read_b64_tr_b16 v[244:245], v3 offset:15360
    ds_read_b64_tr_b16 v[246:247], v3 offset:15872
    s_waitcnt lgkmcnt(0)
    v_mfma_f32_16x16x32_bf16 v[8:11], v[244:247], v[76:79], v[8:11]
    ds_read_b64_tr_b16 v[232:233], v3 offset:16384
    ds_read_b64_tr_b16 v[234:235], v3 offset:16896
    s_waitcnt lgkmcnt(0)
    v_mfma_f32_16x16x32_bf16 v[8:11], v[232:235], v[80:83], v[8:11]
    ds_read_b64_tr_b16 v[236:237], v3 offset:17408
    ds_read_b64_tr_b16 v[238:239], v3 offset:17920
    s_waitcnt lgkmcnt(0)
    v_mfma_f32_16x16x32_bf16 v[8:11], v[236:239], v[84:87], v[8:11]
    ds_read_b64_tr_b16 v[240:241], v3 offset:18432
    ds_read_b64_tr_b16 v[242:243], v3 offset:18944
    s_waitcnt lgkmcnt(0)
    v_mfma_f32_16x16x32_bf16 v[8:11], v[240:243], v[88:91], v[8:11]
    ds_read_b64_tr_b16 v[244:245], v3 offset:19456
    ds_read_b64_tr_b16 v[246:247], v3 offset:19968
    s_waitcnt lgkmcnt(0)
    v_mfma_f32_16x16x32_bf16 v[8:11], v[244:247], v[92:95], v[8:11]
    ds_read_b64_tr_b16 v[232:233], v3 offset:20480
    ds_read_b64_tr_b16 v[234:235], v3 offset:20992
    s_waitcnt lgkmcnt(0)
    v_mfma_f32_16x16x32_bf16 v[8:11], v[232:235], v[96:99], v[8:11]
    ds_read_b64_tr_b16 v[236:237], v3 offset:21504
    ds_read_b64_tr_b16 v[238:239], v3 offset:22016
    s_waitcnt lgkmcnt(0)
    v_mfma_f32_16x16x32_bf16 v[8:11], v[236:239], v[100:103], v[8:11]
    ds_read_b64_tr_b16 v[240:241], v3 offset:22528
    ds_read_b64_tr_b16 v[242:243], v3 offset:23040
    s_waitcnt lgkmcnt(0)
    v_mfma_f32_16x16x32_bf16 v[8:11], v[240:243], v[104:107], v[8:11]
    ds_read_b64_tr_b16 v[244:245], v3 offset:23552
    ds_read_b64_tr_b16 v[246:247], v3 offset:24064
    s_waitcnt lgkmcnt(0)
    v_mfma_f32_16x16x32_bf16 v[8:11], v[244:247], v[108:111], v[8:11]
    ds_read_b64_tr_b16 v[232:233], v3 offset:24576
    ds_read_b64_tr_b16 v[234:235], v3 offset:25088
    s_waitcnt lgkmcnt(0)
    v_mfma_f32_16x16x32_bf16 v[8:11], v[232:235], v[112:115], v[8:11]
    ds_read_b64_tr_b16 v[236:237], v3 offset:25600
    ds_read_b64_tr_b16 v[238:239], v3 offset:26112
    s_waitcnt lgkmcnt(0)
    v_mfma_f32_16x16x32_bf16 v[8:11], v[236:239], v[116:119], v[8:11]
    ds_read_b64_tr_b16 v[240:241], v3 offset:26624
    ds_read_b64_tr_b16 v[242:243], v3 offset:27136
    s_waitcnt lgkmcnt(0)
    v_mfma_f32_16x16x32_bf16 v[8:11], v[240:243], v[120:123], v[8:11]
    ds_read_b64_tr_b16 v[244:245], v3 offset:27648
    ds_read_b64_tr_b16 v[246:247], v3 offset:28160
    s_waitcnt lgkmcnt(0)
    v_mfma_f32_16x16x32_bf16 v[8:11], v[244:247], v[124:127], v[8:11]
    ds_read_b64_tr_b16 v[232:233], v3 offset:28672
    ds_read_b64_tr_b16 v[234:235], v3 offset:29184
    s_waitcnt lgkmcnt(0)
    v_mfma_f32_16x16x32_bf16 v[8:11], v[232:235], v[128:131], v[8:11]
    ds_read_b64_tr_b16 v[236:237], v3 offset:29696
    ds_read_b64_tr_b16 v[238:239], v3 offset:30208
    s_waitcnt lgkmcnt(0)
    v_mfma_f32_16x16x32_bf16 v[8:11], v[236:239], v[132:135], v[8:11]
    ds_read_b64_tr_b16 v[240:241], v3 offset:30720
    ds_read_b64_tr_b16 v[242:243], v3 offset:31232
    s_waitcnt lgkmcnt(0)
    v_mfma_f32_16x16x32_bf16 v[8:11], v[240:243], v[136:139], v[8:11]
    ds_read_b64_tr_b16 v[244:245], v3 offset:31744
    ds_read_b64_tr_b16 v[246:247], v3 offset:32256
    s_waitcnt lgkmcnt(0)
    v_mfma_f32_16x16x32_bf16 v[8:11], v[244:247], v[140:143], v[8:11]
    ds_read_b64_tr_b16 v[232:233], v3 offset:32768
    ds_read_b64_tr_b16 v[234:235], v3 offset:33280
    s_waitcnt lgkmcnt(0)
    v_mfma_f32_16x16x32_bf16 v[8:11], v[232:235], v[144:147], v[8:11]
    ds_read_b64_tr_b16 v[236:237], v3 offset:33792
    ds_read_b64_tr_b16 v[238:239], v3 offset:34304
    s_waitcnt lgkmcnt(0)
    v_mfma_f32_16x16x32_bf16 v[8:11], v[236:239], v[148:151], v[8:11]
    ds_read_b64_tr_b16 v[240:241], v3 offset:34816
    ds_read_b64_tr_b16 v[242:243], v3 offset:35328
    s_waitcnt lgkmcnt(0)
    v_mfma_f32_16x16x32_bf16 v[8:11], v[240:243], v[152:155], v[8:11]
    ds_read_b64_tr_b16 v[244:245], v3 offset:35840
    ds_read_b64_tr_b16 v[246:247], v3 offset:36352
    s_waitcnt lgkmcnt(0)
    v_mfma_f32_16x16x32_bf16 v[8:11], v[244:247], v[156:159], v[8:11]
    ds_read_b64_tr_b16 v[232:233], v3 offset:36864
    ds_read_b64_tr_b16 v[234:235], v3 offset:37376
    s_waitcnt lgkmcnt(0)
    v_mfma_f32_16x16x32_bf16 v[8:11], v[232:235], v[160:163], v[8:11]
    ds_read_b64_tr_b16 v[236:237], v3 offset:37888
    ds_read_b64_tr_b16 v[238:239], v3 offset:38400
    s_waitcnt lgkmcnt(0)
    v_mfma_f32_16x16x32_bf16 v[8:11], v[236:239], v[164:167], v[8:11]
    ds_read_b64_tr_b16 v[240:241], v3 offset:38912
    ds_read_b64_tr_b16 v[242:243], v3 offset:39424
    s_waitcnt lgkmcnt(0)
    v_mfma_f32_16x16x32_bf16 v[8:11], v[240:243], v[168:171], v[8:11]
    ds_read_b64_tr_b16 v[244:245], v3 offset:39936
    ds_read_b64_tr_b16 v[246:247], v3 offset:40448
    s_waitcnt lgkmcnt(0)
    v_mfma_f32_16x16x32_bf16 v[8:11], v[244:247], v[172:175], v[8:11]
    ds_read_b64_tr_b16 v[232:233], v3 offset:40960
    ds_read_b64_tr_b16 v[234:235], v3 offset:41472
    s_waitcnt lgkmcnt(0)
    v_mfma_f32_16x16x32_bf16 v[8:11], v[232:235], v[176:179], v[8:11]
    ds_read_b64_tr_b16 v[236:237], v3 offset:41984
    ds_read_b64_tr_b16 v[238:239], v3 offset:42496
    s_waitcnt lgkmcnt(0)
    v_mfma_f32_16x16x32_bf16 v[8:11], v[236:239], v[180:183], v[8:11]
    ds_read_b64_tr_b16 v[240:241], v3 offset:43008
    ds_read_b64_tr_b16 v[242:243], v3 offset:43520
    s_waitcnt lgkmcnt(0)
    v_mfma_f32_16x16x32_bf16 v[8:11], v[240:243], v[184:187], v[8:11]
    ds_read_b64_tr_b16 v[244:245], v3 offset:44032
    ds_read_b64_tr_b16 v[246:247], v3 offset:44544
    s_waitcnt lgkmcnt(0)
    v_mfma_f32_16x16x32_bf16 v[8:11], v[244:247], v[188:191], v[8:11]
    ds_read_b64_tr_b16 v[232:233], v3 offset:45056
    ds_read_b64_tr_b16 v[234:235], v3 offset:45568
    s_waitcnt lgkmcnt(0)
    v_mfma_f32_16x16x32_bf16 v[8:11], v[232:235], v[192:195], v[8:11]
    ds_read_b64_tr_b16 v[236:237], v3 offset:46080
    ds_read_b64_tr_b16 v[238:239], v3 offset:46592
    s_waitcnt lgkmcnt(0)
    v_mfma_f32_16x16x32_bf16 v[8:11], v[236:239], v[196:199], v[8:11]
    ds_read_b64_tr_b16 v[240:241], v3 offset:47104
    ds_read_b64_tr_b16 v[242:243], v3 offset:47616
    s_waitcnt lgkmcnt(0)
    v_mfma_f32_16x16x32_bf16 v[8:11], v[240:243], v[200:203], v[8:11]
    ds_read_b64_tr_b16 v[244:245], v3 offset:48128
    ds_read_b64_tr_b16 v[246:247], v3 offset:48640
    s_waitcnt lgkmcnt(0)
    v_mfma_f32_16x16x32_bf16 v[8:11], v[244:247], v[204:207], v[8:11]
    ds_read_b64_tr_b16 v[232:233], v3 offset:49152
    ds_read_b64_tr_b16 v[234:235], v3 offset:49664
    s_waitcnt lgkmcnt(0)
    v_mfma_f32_16x16x32_bf16 v[8:11], v[232:235], v[208:211], v[8:11]
    ds_read_b64_tr_b16 v[236:237], v3 offset:50176
    ds_read_b64_tr_b16 v[238:239], v3 offset:50688
    s_waitcnt lgkmcnt(0)
    v_mfma_f32_16x16x32_bf16 v[8:11], v[236:239], v[212:215], v[8:11]
    ds_read_b64_tr_b16 v[240:241], v3 offset:51200
    ds_read_b64_tr_b16 v[242:243], v3 offset:51712
    s_waitcnt lgkmcnt(0)
    v_mfma_f32_16x16x32_bf16 v[8:11], v[240:243], v[216:219], v[8:11]
    ds_read_b64_tr_b16 v[244:245], v3 offset:52224
    ds_read_b64_tr_b16 v[246:247], v3 offset:52736
    s_waitcnt lgkmcnt(0)
    v_mfma_f32_16x16x32_bf16 v[8:11], v[244:247], v[220:223], v[8:11]
    ds_read_b64_tr_b16 v[232:233], v3 offset:53248
    ds_read_b64_tr_b16 v[234:235], v3 offset:53760
    s_waitcnt lgkmcnt(0)
    v_mfma_f32_16x16x32_bf16 v[8:11], v[232:235], v[224:227], v[8:11]
    ds_read_b64_tr_b16 v[236:237], v3 offset:54272
    ds_read_b64_tr_b16 v[238:239], v3 offset:54784
    s_waitcnt lgkmcnt(0)
    v_mfma_f32_16x16x32_bf16 v[8:11], v[236:239], v[228:231], v[8:11]
    v_and_b32 v7, 7, v0
    v_lshlrev_b32 v7, 2, v7
    s_mov_b32 s64, 0x5400020
    buffer_load_dword v12, v7, s[4:7], s64 offen sc1
    s_waitcnt vmcnt(0)
    s_nop 7
    v_cvt_pk_bf16_f32 v8, v8, v8
    v_lshlrev_b32 v8, 16, v8
    v_mul_f32 v8, v8, v12
    v_cvt_pk_bf16_f32 v8, v8, v8
    v_lshlrev_b32 v8, 16, v8
    v_cvt_pk_bf16_f32 v9, v9, v9
    v_lshlrev_b32 v9, 16, v9
    v_mul_f32 v9, v9, v12
    v_cvt_pk_bf16_f32 v9, v9, v9
    v_lshlrev_b32 v9, 16, v9
    v_cvt_pk_bf16_f32 v10, v10, v10
    v_lshlrev_b32 v10, 16, v10
    v_mul_f32 v10, v10, v12
    v_cvt_pk_bf16_f32 v10, v10, v10
    v_lshlrev_b32 v10, 16, v10
    v_cvt_pk_bf16_f32 v11, v11, v11
    v_lshlrev_b32 v11, 16, v11
    v_mul_f32 v11, v11, v12
    v_cvt_pk_bf16_f32 v11, v11, v11
    v_lshlrev_b32 v11, 16, v11
    v_and_b32 v7, 7, v0
    v_mul_u32_u24 v7, 2560, v7
    v_lshrrev_b32 v13, 4, v0
    v_lshl_add_u32 v7, v13, 4, v7
    s_lshl_b32 s64, s24, 6
    s_add_u32 s64, s64, 0x5410000
    s_mov_b32 s68, 0x00ff00ff
    s_mov_b32 s69, 0x00ff00ff
    s_mov_b64 exec, s[68:69]
    buffer_store_dwordx4 v[8:11], v7, s[4:7], s64 offen sc1
    s_mov_b64 exec, -1
    s_waitcnt vmcnt(0)
    v_mov_b32 v7, 1
    v_mov_b32 v8, 0
    s_mov_b32 s64, 0x298100
    s_mov_b64 exec, 1
    buffer_atomic_add v7, v8, s[4:7], s64 offen sc1
    s_mov_b64 exec, -1
H_ATT:
    v_mbcnt_lo_u32_b32 v0, -1, 0
    v_mbcnt_hi_u32_b32 v0, -1, v0
    s_mov_b32 s29, 0
    v_lshlrev_b32 v1, 4, v0
    v_lshrrev_b32 v5, 4, v0
    v_lshlrev_b32 v2, 7, v5
    v_and_b32 v5, 7, v0
    v_lshl_add_u32 v2, v5, 4, v2
    v_bfe_u32 v5, v0, 4, 1
    v_lshlrev_b32 v3, 7, v5
    v_and_b32 v5, 15, v0
    v_lshl_add_u32 v3, v5, 3, v3
    s_mov_b32 s34, 0x3e0293ee
    s_mov_b32 s35, 0x3e0293ee
    s_mov_b32 s36, -1
    s_mov_b32 s37, 0
    v_lshrrev_b32 v5, 4, v0
    v_lshlrev_b32 v5, 2, v5
    v_and_b32 v6, 15, v0
    v_add_u32 v7, 0, v5
    v_cmp_le_u32 s[38:39], v7, v6
    v_add_u32 v7, 1, v5
    v_cmp_le_u32 s[40:41], v7, v6
    v_add_u32 v7, 2, v5
    v_cmp_le_u32 s[42:43], v7, v6
    v_add_u32 v7, 3, v5
    v_cmp_le_u32 s[44:45], v7, v6
    v_mov_b32 v248, 0x3f803f80
    v_mov_b32 v249, 0x3f803f80
    v_mov_b32 v250, 0x3f803f80
    v_mov_b32 v251, 0x3f803f80
    s_lshl_b32 s24, s12, 2
    s_add_u32 s24, s24, s14
    s_add_u32 s24, s24, 16
    s_mov_b32 s25, 2
AT2_LOOP:
    s_lshl_b32 s64, s24, 5
    s_add_u32 s64, s64, s13
    s_lshl_b32 s26, s64, 13
    s_add_u32 s26, s26, 0x3400000
    s_lshl_b32 s27, s64, 14
    s_add_u32 s27, s27, 0x1400000
    s_lshl_b32 s65, s64, 11
    s_add_u32 s30, s65, 0x640000
    s_add_u32 s31, s65, 0xa40000
    s_lshl_b32 s33, s64, 2
    s_add_u32 s33, s33, 0x296000
    s_lshl_b32 s32, s24, 18
    s_lshl_b32 s65, s13, 12
    s_add_u32 s32, s32, s65
    s_add_u32 s32, s32, 0x4400000
    s_lshr_b32 s65, s24, 2
    s_lshl_b32 s65, s65, 9
    s_lshl_b32 s66, s13, 4
    s_add_u32 s65, s65, s66
    s_add_u32 s65, s65, 0x291000
    s_lshr_b32 s66, s24, 1
    s_lshl_b32 s66, s66, 8
    s_lshl_b32 s64, s13, 3
    s_add_u32 s66, s66, s64
    s_add_u32 s66, s66, 0x293ff4
    v_lshlrev_b32 v5, 2, v0
    v_mov_b32 v6, s65
    v_mov_b32 v7, s66
    v_cmp_gt_u32 vcc, 3, v0
    s_nop 1
    v_cndmask_b32 v6, v7, v6, vcc
    v_add_u32 v4, v5, v6
    s_mov_b32 s64, 0
    s_mov_b64 exec, 7
AT2_F_163:
    buffer_load_dword v5, v4, s[4:7], s64 offen sc1
    s_add_u32 s29, s29, 1
    s_waitcnt vmcnt(0)
    v_cmp_eq_u32 vcc, 0, v5
    s_cbranch_vccz AT2_FD_164
    s_cmp_gt_u32 s29, 262144
    s_cbranch_scc1 AT2_FD_164
    s_sleep 1
    s_branch AT2_F_163
AT2_FD_164:
    s_mov_b64 exec, -1
    buffer_load_dwordx4 v[16:19], v1, s[4:7], s26 offen offset:0
    buffer_load_dwordx4 v[20:23], v1, s[4:7], s26 offen offset:1024
    buffer_load_dwordx4 v[24:27], v1, s[4:7], s26 offen offset:2048
    buffer_load_dwordx4 v[28:31], v1, s[4:7], s26 offen offset:3072
    s_add_u32 s26, s26, 4096
    buffer_load_dwordx4 v[32:35], v1, s[4:7], s26 offen offset:0
    buffer_load_dwordx4 v[36:39], v1, s[4:7], s26 offen offset:1024
    buffer_load_dwordx4 v[40:43], v1, s[4:7], s26 offen offset:2048
    buffer_load_dwordx4 v[44:47], v1, s[4:7], s26 offen offset:3072
    buffer_load_dwordx4 v[48:51], v1, s[4:7], s27 offen offset:0
    buffer_load_dwordx4 v[52:55], v1, s[4:7], s27 offen offset:1024
    buffer_load_dwordx4 v[56:59], v1, s[4:7], s27 offen offset:2048
    buffer_load_dwordx4 v[60:63], v1, s[4:7], s27 offen offset:3072
    s_add_u32 s27, s27, 4096
    buffer_load_dwordx4 v[64:67], v1, s[4:7], s27 offen offset:0
    buffer_load_dwordx4 v[68:71], v1, s[4:7], s27 offen offset:1024
    buffer_load_dwordx4 v[72:75], v1, s[4:7], s27 offen offset:2048
    buffer_load_dwordx4 v[76:79], v1, s[4:7], s27 offen offset:3072
    s_add_u32 s27, s27, 4096
    buffer_load_dwordx4 v[80:83], v1, s[4:7], s27 offen offset:0
    buffer_load_dwordx4 v[84:87], v1, s[4:7], s27 offen offset:1024
    buffer_load_dwordx4 v[88:91], v1, s[4:7], s27 offen offset:2048
    buffer_load_dwordx4 v[92:95], v1, s[4:7], s27 offen offset:3072
    s_add_u32 s27, s27, 4096
    buffer_load_dwordx4 v[96:99], v1, s[4:7], s27 offen offset:0
    buffer_load_dwordx4 v[100:103], v1, s[4:7], s27 offen offset:1024
    buffer_load_dwordx4 v[104:107], v1, s[4:7], s27 offen offset:2048
    buffer_load_dwordx4 v[108:111], v1, s[4:7], s27 offen offset:3072
    s_mov_b64 exec, 0x18
AT2_G_165:
    buffer_load_dword v5, v4, s[4:7], s64 offen sc1
    s_add_u32 s29, s29, 1
    s_waitcnt vmcnt(0)
    v_cmp_eq_u32 vcc, 0, v5
    s_cbranch_vccz AT2_GD_166
    s_cmp_gt_u32 s29, 262144
    s_cbranch_scc1 AT2_GD_166
    s_sleep 1
    s_branch AT2_G_165
AT2_GD_166:
    s_mov_b64 exec, -1
    buffer_load_dwordx4 v[112:115], v2, s[4:7], s30 offen offset:0
    buffer_load_dwordx4 v[116:119], v2, s[4:7], s30 offen offset:512
    buffer_load_dwordx4 v[120:123], v2, s[4:7], s30 offen offset:1024
    buffer_load_dwordx4 v[124:127], v2, s[4:7], s30 offen offset:1536
    buffer_load_dwordx2 v[128:129], v3, s[4:7], s31 offen offset:0
    buffer_load_dwordx2 v[130:131], v3, s[4:7], s31 offen offset:256
    buffer_load_dwordx2 v[132:133], v3, s[4:7], s31 offen offset:512
    buffer_load_dwordx2 v[134:135], v3, s[4:7], s31 offen offset:768
    buffer_load_dwordx2 v[136:137], v3, s[4:7], s31 offen offset:1024
    buffer_load_dwordx2 v[138:139], v3, s[4:7], s31 offen offset:1280
    buffer_load_dwordx2 v[140:141], v3, s[4:7], s31 offen offset:1536
    buffer_load_dwordx2 v[142:143], v3, s[4:7], s31 offen offset:1792
    v_mfma_f32_16x16x32_bf16 v[148:151], v[48:51], v[16:19], 0
    v_mfma_f32_16x16x32_bf16 v[156:159], v[48:51], v[32:35], 0
    v_mfma_f32_16x16x32_bf16 v[160:163], v[64:67], v[32:35], 0
    v_mfma_f32_16x16x32_bf16 v[148:151], v[52:55], v[20:23], v[148:151]
    v_mfma_f32_16x16x32_bf16 v[156:159], v[52:55], v[36:39], v[156:159]
    v_mfma_f32_16x16x32_bf16 v[160:163], v[68:71], v[36:39], v[160:163]
    v_mfma_f32_16x16x32_bf16 v[148:151], v[56:59], v[24:27], v[148:151]
    v_mfma_f32_16x16x32_bf16 v[156:159], v[56:59], v[40:43], v[156:159]
    v_mfma_f32_16x16x32_bf16 v[160:163], v[72:75], v[40:43], v[160:163]
    v_mfma_f32_16x16x32_bf16 v[148:151], v[60:63], v[28:31], v[148:151]
    v_mfma_f32_16x16x32_bf16 v[156:159], v[60:63], v[44:47], v[156:159]
    v_mfma_f32_16x16x32_bf16 v[160:163], v[76:79], v[44:47], v[160:163]
    s_waitcnt vmcnt(8)
    v_mfma_f32_16x16x32_bf16 v[144:147], v[112:115], v[16:19], 0
    v_mfma_f32_16x16x32_bf16 v[152:155], v[112:115], v[32:35], 0
    v_mfma_f32_16x16x32_bf16 v[144:147], v[116:119], v[20:23], v[144:147]
    v_mfma_f32_16x16x32_bf16 v[152:155], v[116:119], v[36:39], v[152:155]
    v_mfma_f32_16x16x32_bf16 v[144:147], v[120:123], v[24:27], v[144:147]
    v_mfma_f32_16x16x32_bf16 v[152:155], v[120:123], v[40:43], v[152:155]
    v_mfma_f32_16x16x32_bf16 v[144:147], v[124:127], v[28:31], v[144:147]
    v_mfma_f32_16x16x32_bf16 v[152:155], v[124:127], v[44:47], v[152:155]
    v_mov_b32 v11, 0xff800000
    s_nop 7
    v_cndmask_b32 v148, v11, v148, s[38:39]
    v_cndmask_b32 v160, v11, v160, s[38:39]
    v_cndmask_b32 v144, v11, v144, s[36:37]
    v_cndmask_b32 v152, v11, v152, s[36:37]
    v_cndmask_b32 v149, v11, v149, s[40:41]
    v_cndmask_b32 v161, v11, v161, s[40:41]
    v_cndmask_b32 v145, v11, v145, s[36:37]
    v_cndmask_b32 v153, v11, v153, s[36:37]
    v_cndmask_b32 v150, v11, v150, s[42:43]
    v_cndmask_b32 v162, v11, v162, s[42:43]
    v_cndmask_b32 v146, v11, v146, s[36:37]
    v_cndmask_b32 v154, v11, v154, s[36:37]
    v_cndmask_b32 v151, v11, v151, s[44:45]
    v_cndmask_b32 v163, v11, v163, s[44:45]
    v_cndmask_b32 v147, v11, v147, s[36:37]
    v_cndmask_b32 v155, v11, v155, s[36:37]
    v_max3_f32 v8, v144, v145, v146
    v_max3_f32 v8, v8, v147, v148
    v_max3_f32 v8, v8, v149, v150
    v_max_f32 v8, v8, v151
    v_mov_b32 v9, v8
    s_nop 1
    v_permlane16_swap_b32 v8, v9
    v_max_f32 v8, v8, v9
    v_mov_b32 v9, v8
    s_nop 1
    v_permlane32_swap_b32 v8, v9
    v_max_f32 v8, v8, v9
    v_mul_f32 v8, s34, v8
    v_fma_f32 v144, v144, s34, -v8
    v_fma_f32 v145, v145, s34, -v8
    v_fma_f32 v146, v146, s34, -v8
    v_fma_f32 v147, v147, s34, -v8
    v_fma_f32 v148, v148, s34, -v8
    v_fma_f32 v149, v149, s34, -v8
    v_fma_f32 v150, v150, s34, -v8
    v_fma_f32 v151, v151, s34, -v8
    v_exp_f32 v144, v144
    v_exp_f32 v145, v145
    v_exp_f32 v146, v146
    v_exp_f32 v147, v147
    v_exp_f32 v148, v148
    v_exp_f32 v149, v149
    v_exp_f32 v150, v150
    v_exp_f32 v151, v151
    s_nop 0
    v_cvt_pk_bf16_f32 v164, v148, v149
    v_cvt_pk_bf16_f32 v165, v150, v151
    v_mov_b32 v166, 0
    v_mov_b32 v167, 0
    v_cvt_pk_bf16_f32 v168, v144, v145
    v_cvt_pk_bf16_f32 v169, v146, v147
    v_max3_f32 v8, v152, v153, v154
    v_max3_f32 v8, v8, v155, v156
    v_max3_f32 v8, v8, v157, v158
    v_max3_f32 v8, v8, v159, v160
    v_max3_f32 v8, v8, v161, v162
    v_max_f32 v8, v8, v163
    v_mov_b32 v9, v8
    s_nop 1
    v_permlane16_swap_b32 v8, v9
    v_max_f32 v8, v8, v9
    v_mov_b32 v9, v8
    s_nop 1
    v_permlane32_swap_b32 v8, v9
    v_max_f32 v8, v8, v9
    v_mul_f32 v8, s34, v8
    v_fma_f32 v152, v152, s34, -v8
    v_fma_f32 v153, v153, s34, -v8
    v_fma_f32 v154, v154, s34, -v8
    v_fma_f32 v155, v155, s34, -v8
    v_fma_f32 v156, v156, s34, -v8
    v_fma_f32 v157, v157, s34, -v8
    v_fma_f32 v158, v158, s34, -v8
    v_fma_f32 v159, v159, s34, -v8
    v_fma_f32 v160, v160, s34, -v8
    v_fma_f32 v161, v161, s34, -v8
    v_fma_f32 v162, v162, s34, -v8
    v_fma_f32 v163, v163, s34, -v8
    v_exp_f32 v152, v152
    v_exp_f32 v153, v153
    v_exp_f32 v154, v154
    v_exp_f32 v155, v155
    v_exp_f32 v156, v156
    v_exp_f32 v157, v157
    v_exp_f32 v158, v158
    v_exp_f32 v159, v159
    v_exp_f32 v160, v160
    v_exp_f32 v161, v161
    v_exp_f32 v162, v162
    v_exp_f32 v163, v163
    s_nop 0
    v_cvt_pk_bf16_f32 v170, v156, v157
    v_cvt_pk_bf16_f32 v171, v158, v159
    v_cvt_pk_bf16_f32 v172, v160, v161
    v_cvt_pk_bf16_f32 v173, v162, v163
    v_cvt_pk_bf16_f32 v174, v152, v153
    v_cvt_pk_bf16_f32 v175, v154, v155
    s_waitcnt vmcnt(0)
    v_mfma_f32_16x16x32_bf16 v[240:243], v[248:251], v[164:167], 0
    v_mfma_f32_16x16x32_bf16 v[244:247], v[248:251], v[170:173], 0
    v_mfma_f32_16x16x32_bf16 v[176:179], v[80:83], v[164:167], 0
    v_mfma_f32_16x16x32_bf16 v[180:183], v[80:83], v[170:173], 0
    v_mfma_f32_16x16x32_bf16 v[184:187], v[84:87], v[164:167], 0
    v_mfma_f32_16x16x32_bf16 v[188:191], v[84:87], v[170:173], 0
    v_mfma_f32_16x16x32_bf16 v[192:195], v[88:91], v[164:167], 0
    v_mfma_f32_16x16x32_bf16 v[196:199], v[88:91], v[170:173], 0
    v_mfma_f32_16x16x32_bf16 v[200:203], v[92:95], v[164:167], 0
    v_mfma_f32_16x16x32_bf16 v[204:207], v[92:95], v[170:173], 0
    v_mfma_f32_16x16x32_bf16 v[208:211], v[96:99], v[164:167], 0
    v_mfma_f32_16x16x32_bf16 v[212:215], v[96:99], v[170:173], 0
    v_mfma_f32_16x16x32_bf16 v[216:219], v[100:103], v[164:167], 0
    v_mfma_f32_16x16x32_bf16 v[220:223], v[100:103], v[170:173], 0
    v_mfma_f32_16x16x32_bf16 v[224:227], v[104:107], v[164:167], 0
    v_mfma_f32_16x16x32_bf16 v[228:231], v[104:107], v[170:173], 0
    v_mfma_f32_16x16x32_bf16 v[232:235], v[108:111], v[164:167], 0
    v_mfma_f32_16x16x32_bf16 v[236:239], v[108:111], v[170:173], 0
    v_mfma_f32_16x16x16_bf16 v[240:243], v[248:249], v[168:169], v[240:243]
    v_mfma_f32_16x16x16_bf16 v[244:247], v[248:249], v[174:175], v[244:247]
    v_mfma_f32_16x16x16_bf16 v[176:179], v[128:129], v[168:169], v[176:179]
    v_mfma_f32_16x16x16_bf16 v[180:183], v[128:129], v[174:175], v[180:183]
    v_mfma_f32_16x16x16_bf16 v[184:187], v[130:131], v[168:169], v[184:187]
    v_mfma_f32_16x16x16_bf16 v[188:191], v[130:131], v[174:175], v[188:191]
    v_mfma_f32_16x16x16_bf16 v[192:195], v[132:133], v[168:169], v[192:195]
    v_mfma_f32_16x16x16_bf16 v[196:199], v[132:133], v[174:175], v[196:199]
    v_mfma_f32_16x16x16_bf16 v[200:203], v[134:135], v[168:169], v[200:203]
    v_mfma_f32_16x16x16_bf16 v[204:207], v[134:135], v[174:175], v[204:207]
    v_mfma_f32_16x16x16_bf16 v[208:211], v[136:137], v[168:169], v[208:211]
    v_mfma_f32_16x16x16_bf16 v[212:215], v[136:137], v[174:175], v[212:215]
    v_mfma_f32_16x16x16_bf16 v[216:219], v[138:139], v[168:169], v[216:219]
    v_mfma_f32_16x16x16_bf16 v[220:223], v[138:139], v[174:175], v[220:223]
    v_mfma_f32_16x16x16_bf16 v[224:227], v[140:141], v[168:169], v[224:227]
    v_mfma_f32_16x16x16_bf16 v[228:231], v[140:141], v[174:175], v[228:231]
    v_mfma_f32_16x16x16_bf16 v[232:235], v[142:143], v[168:169], v[232:235]
    v_mfma_f32_16x16x16_bf16 v[236:239], v[142:143], v[174:175], v[236:239]
    v_rcp_f32 v8, v240
    v_rcp_f32 v9, v244
    s_nop 7
    v_mul_f32 v176, v176, v8
    v_mul_f32 v177, v177, v8
    v_mul_f32 v178, v178, v8
    v_mul_f32 v179, v179, v8
    v_cvt_pk_bf16_f32 v16, v176, v177
    v_cvt_pk_bf16_f32 v17, v178, v179
    v_mul_f32 v184, v184, v8
    v_mul_f32 v185, v185, v8
    v_mul_f32 v186, v186, v8
    v_mul_f32 v187, v187, v8
    v_cvt_pk_bf16_f32 v18, v184, v185
    v_cvt_pk_bf16_f32 v19, v186, v187
    s_add_u32 s64, s32, 0x0
    buffer_store_dwordx4 v[16:19], v1, s[4:7], s64 offen offset:0 sc1
    v_mul_f32 v192, v192, v8
    v_mul_f32 v193, v193, v8
    v_mul_f32 v194, v194, v8
    v_mul_f32 v195, v195, v8
    v_cvt_pk_bf16_f32 v20, v192, v193
    v_cvt_pk_bf16_f32 v21, v194, v195
    v_mul_f32 v200, v200, v8
    v_mul_f32 v201, v201, v8
    v_mul_f32 v202, v202, v8
    v_mul_f32 v203, v203, v8
    v_cvt_pk_bf16_f32 v22, v200, v201
    v_cvt_pk_bf16_f32 v23, v202, v203
    s_add_u32 s64, s32, 0x0
    buffer_store_dwordx4 v[20:23], v1, s[4:7], s64 offen offset:1024 sc1
    v_mul_f32 v208, v208, v8
    v_mul_f32 v209, v209, v8
    v_mul_f32 v210, v210, v8
    v_mul_f32 v211, v211, v8
    v_cvt_pk_bf16_f32 v24, v208, v209
    v_cvt_pk_bf16_f32 v25, v210, v211
    v_mul_f32 v216, v216, v8
    v_mul_f32 v217, v217, v8
    v_mul_f32 v218, v218, v8
    v_mul_f32 v219, v219, v8
    v_cvt_pk_bf16_f32 v26, v216, v217
    v_cvt_pk_bf16_f32 v27, v218, v219
    s_add_u32 s64, s32, 0x0
    buffer_store_dwordx4 v[24:27], v1, s[4:7], s64 offen offset:2048 sc1
    v_mul_f32 v224, v224, v8
    v_mul_f32 v225, v225, v8
    v_mul_f32 v226, v226, v8
    v_mul_f32 v227, v227, v8
    v_cvt_pk_bf16_f32 v28, v224, v225
    v_cvt_pk_bf16_f32 v29, v226, v227
    v_mul_f32 v232, v232, v8
    v_mul_f32 v233, v233, v8
    v_mul_f32 v234, v234, v8
    v_mul_f32 v235, v235, v8
    v_cvt_pk_bf16_f32 v30, v232, v233
    v_cvt_pk_bf16_f32 v31, v234, v235
    s_add_u32 s64, s32, 0x0
    buffer_store_dwordx4 v[28:31], v1, s[4:7], s64 offen offset:3072 sc1
    v_mul_f32 v180, v180, v9
    v_mul_f32 v181, v181, v9
    v_mul_f32 v182, v182, v9
    v_mul_f32 v183, v183, v9
    v_cvt_pk_bf16_f32 v32, v180, v181
    v_cvt_pk_bf16_f32 v33, v182, v183
    v_mul_f32 v188, v188, v9
    v_mul_f32 v189, v189, v9
    v_mul_f32 v190, v190, v9
    v_mul_f32 v191, v191, v9
    v_cvt_pk_bf16_f32 v34, v188, v189
    v_cvt_pk_bf16_f32 v35, v190, v191
    s_add_u32 s64, s32, 0x20000
    buffer_store_dwordx4 v[32:35], v1, s[4:7], s64 offen offset:0 sc1
    v_mul_f32 v196, v196, v9
    v_mul_f32 v197, v197, v9
    v_mul_f32 v198, v198, v9
    v_mul_f32 v199, v199, v9
    v_cvt_pk_bf16_f32 v36, v196, v197
    v_cvt_pk_bf16_f32 v37, v198, v199
    v_mul_f32 v204, v204, v9
    v_mul_f32 v205, v205, v9
    v_mul_f32 v206, v206, v9
    v_mul_f32 v207, v207, v9
    v_cvt_pk_bf16_f32 v38, v204, v205
    v_cvt_pk_bf16_f32 v39, v206, v207
    s_add_u32 s64, s32, 0x20000
    buffer_store_dwordx4 v[36:39], v1, s[4:7], s64 offen offset:1024 sc1
    v_mul_f32 v212, v212, v9
    v_mul_f32 v213, v213, v9
    v_mul_f32 v214, v214, v9
    v_mul_f32 v215, v215, v9
    v_cvt_pk_bf16_f32 v40, v212, v213
    v_cvt_pk_bf16_f32 v41, v214, v215
    v_mul_f32 v220, v220, v9
    v_mul_f32 v221, v221, v9
    v_mul_f32 v222, v222, v9
    v_mul_f32 v223, v223, v9
    v_cvt_pk_bf16_f32 v42, v220, v221
    v_cvt_pk_bf16_f32 v43, v222, v223
    s_add_u32 s64, s32, 0x20000
    buffer_store_dwordx4 v[40:43], v1, s[4:7], s64 offen offset:2048 sc1
    v_mul_f32 v228, v228, v9
    v_mul_f32 v229, v229, v9
    v_mul_f32 v230, v230, v9
    v_mul_f32 v231, v231, v9
    v_cvt_pk_bf16_f32 v44, v228, v229
    v_cvt_pk_bf16_f32 v45, v230, v231
    v_mul_f32 v236, v236, v9
    v_mul_f32 v237, v237, v9
    v_mul_f32 v238, v238, v9
    v_mul_f32 v239, v239, v9
    v_cvt_pk_bf16_f32 v46, v236, v237
    v_cvt_pk_bf16_f32 v47, v238, v239
    s_add_u32 s64, s32, 0x20000
    buffer_store_dwordx4 v[44:47], v1, s[4:7], s64 offen offset:3072 sc1
    s_waitcnt vmcnt(0)
    v_mov_b32 v7, 1
    v_mov_b32 v8, 0
    s_mov_b64 exec, 1
    buffer_store_dword v7, v8, s[4:7], s33 offen sc1
    s_mov_b64 exec, -1
    s_add_u32 s24, s24, 8
    s_add_u32 s25, s25, 1
    s_cmp_lt_u32 s25, 8
    s_cbranch_scc1 AT2_LOOP
M_EXIT:
    s_endpgm
.section .rodata,"a"
.p2align 6
.amdhsa_kernel main_kernel
  .amdhsa_next_free_vgpr 512
  .amdhsa_next_free_sgpr 102
  .amdhsa_accum_offset 256
  .amdhsa_group_segment_fixed_size 0
  .amdhsa_kernarg_size 120
  .amdhsa_user_sgpr_count 2
  .amdhsa_user_sgpr_kernarg_segment_ptr 1
  .amdhsa_system_sgpr_workgroup_id_x 1
.end_amdhsa_kernel
```

```asm
; @launch kernel=main_kernel grid=(256,1,1) block=(256,1,1) lds=163840
.amdgcn_target "amdgcn-amd-amdhsa--gfx950"
.text
.globl main_kernel
.p2align 8
.type main_kernel,@function
main_kernel:
    s_cmp_ge_u32 s2, 256
    s_cbranch_scc1 M_EXIT
    s_load_dwordx2 s[4:5], s[0:1], 112
    s_mov_b32 s6, 0x10000000
    s_mov_b32 s7, 0x00020000
    s_load_dwordx2 s[60:61], s[0:1], 104
    s_mov_b32 s62, 256
    s_mov_b32 s63, 0x00020000
    v_lshrrev_b32 v1, 6, v0
    v_and_b32 v0, 63, v0
    s_nop 0
    v_readfirstlane_b32 s14, v1
    s_getreg_b32 s98, hwreg(HW_REG_XCC_ID)
    s_and_b32 s98, s98, 7
    s_mov_b32 s97, 0
    s_mov_b32 s95, 4
    s_waitcnt lgkmcnt(0)
    s_cmp_lg_u32 s14, 0
    s_cbranch_scc1 NOMEAS_1
    s_and_b32 s64, s2, 0xfffffffd
    s_cmp_lg_u32 s64, 1
    s_cbranch_scc1 NOMEAS_1
    s_lshr_b32 s70, s2, 1
    s_mov_b32 s72, s60
    s_mov_b32 s73, s61
    s_mov_b32 s74, s62
    s_mov_b32 s75, s63
    s_lshl_b32 s60, s70, 21
    s_add_u32 s60, s60, 0x6001800
    v_mov_b32 v60, 0
    v_mov_b32 v61, -1
    s_mov_b32 s66, 0x7fffffff
    s_mov_b32 s67, 0x7fffffff
    s_mov_b32 s68, 0x7fffffff
    s_mov_b32 s69, 0x7fffffff
    s_mov_b64 exec, 1
    s_add_u32 s61, s60, 0
    s_memtime s[62:63]
    s_waitcnt lgkmcnt(0)
    buffer_store_dword v61, v60, s[4:7], s61 offen offset:0 sc1
    s_waitcnt vmcnt(0)
    s_memtime s[64:65]
    s_waitcnt lgkmcnt(0)
    s_sub_u32 s62, s64, s62
    s_min_u32 s66, s66, s62
    s_add_u32 s61, s60, 8192
    s_memtime s[62:63]
    s_waitcnt lgkmcnt(0)
    buffer_store_dword v61, v60, s[4:7], s61 offen offset:0 sc1
    s_waitcnt vmcnt(0)
    s_memtime s[64:65]
    s_waitcnt lgkmcnt(0)
    s_sub_u32 s62, s64, s62
    s_min_u32 s67, s67, s62
    s_add_u32 s61, s60, 16384
    s_memtime s[62:63]
    s_waitcnt lgkmcnt(0)
    buffer_store_dword v61, v60, s[4:7], s61 offen offset:0 sc1
    s_waitcnt vmcnt(0)
    s_memtime s[64:65]
    s_waitcnt lgkmcnt(0)
    s_sub_u32 s62, s64, s62
    s_min_u32 s68, s68, s62
    s_add_u32 s61, s60, 24576
    s_memtime s[62:63]
    s_waitcnt lgkmcnt(0)
    buffer_store_dword v61, v60, s[4:7], s61 offen offset:0 sc1
    s_waitcnt vmcnt(0)
    s_memtime s[64:65]
    s_waitcnt lgkmcnt(0)
    s_sub_u32 s62, s64, s62
    s_min_u32 s69, s69, s62
    s_add_u32 s61, s60, 0
    s_memtime s[62:63]
    s_waitcnt lgkmcnt(0)
    buffer_store_dword v61, v60, s[4:7], s61 offen offset:128 sc1
    s_waitcnt vmcnt(0)
    s_memtime s[64:65]
    s_waitcnt lgkmcnt(0)
    s_sub_u32 s62, s64, s62
    s_min_u32 s66, s66, s62
    s_add_u32 s61, s60, 8192
    s_memtime s[62:63]
    s_waitcnt lgkmcnt(0)
    buffer_store_dword v61, v60, s[4:7], s61 offen offset:128 sc1
    s_waitcnt vmcnt(0)
    s_memtime s[64:65]
    s_waitcnt lgkmcnt(0)
    s_sub_u32 s62, s64, s62
    s_min_u32 s67, s67, s62
    s_add_u32 s61, s60, 16384
    s_memtime s[62:63]
    s_waitcnt lgkmcnt(0)
    buffer_store_dword v61, v60, s[4:7], s61 offen offset:128 sc1
    s_waitcnt vmcnt(0)
    s_memtime s[64:65]
    s_waitcnt lgkmcnt(0)
    s_sub_u32 s62, s64, s62
    s_min_u32 s68, s68, s62
    s_add_u32 s61, s60, 24576
    s_memtime s[62:63]
    s_waitcnt lgkmcnt(0)
    buffer_store_dword v61, v60, s[4:7], s61 offen offset:128 sc1
    s_waitcnt vmcnt(0)
    s_memtime s[64:65]
    s_waitcnt lgkmcnt(0)
    s_sub_u32 s62, s64, s62
    s_min_u32 s69, s69, s62
    s_mov_b64 exec, -1
    s_mov_b32 s60, 0
    s_mov_b32 s61, s66
    s_cmp_lt_u32 s67, s61
    s_cselect_b32 s60, 1, s60
    s_min_u32 s61, s61, s67
    s_cmp_lt_u32 s68, s61
    s_cselect_b32 s60, 2, s60
    s_min_u32 s61, s61, s68
    s_cmp_lt_u32 s69, s61
    s_cselect_b32 s60, 3, s60
    s_min_u32 s61, s61, s69
    s_and_b32 s61, s98, 1
    s_lshl_b32 s61, s61, 1
    s_lshr_b32 s62, s98, 2
    s_add_u32 s61, s61, s62
    s_xor_b32 s60, s60, s61
    s_add_u32 s71, s60, 1
    s_mov_b32 s60, s72
    s_mov_b32 s61, s73
    s_mov_b32 s62, s74
    s_mov_b32 s63, s75
    s_lshl_b32 s70, s70, 2
    s_add_u32 s70, s70, 132
    v_mov_b32 v61, s71
    s_mov_b64 exec, 1
    buffer_store_dword v61, off, s[60:63], s70 sc1
    s_mov_b64 exec, -1
NOMEAS_1:
    s_cmp_lg_u32 s14, 0
    s_cbranch_scc1 M_TICKW
    s_mul_i32 s64, s98, 32
    s_add_u32 s64, s64, 0x0
    v_mov_b32 v1, 0
    v_mov_b32 v2, 1
    s_mov_b64 exec, 1
    buffer_atomic_add v2, v1, s[60:63], s64 offen sc0
    s_waitcnt vmcnt(0)
    ds_write_b32 v1, v2
    s_waitcnt lgkmcnt(0)
    s_mov_b64 exec, -1
M_TICKW:
    s_barrier
    v_mov_b32 v1, 0
    ds_read_b32 v2, v1
    s_waitcnt lgkmcnt(0)
    v_readfirstlane_b32 s99, v2
    s_barrier
    s_cmp_ge_u32 s99, 32
    s_cbranch_scc1 M_SLOW0
    s_mov_b32 s12, s98
    s_cmp_eq_u32 s12, 0
    s_cbranch_scc1 XOK_2
    s_cmp_eq_u32 s12, 2
    s_cbranch_scc0 M_FH
    s_mov_b32 s12, 1
XOK_2:
    s_mov_b32 s13, s99
    s_branch M_REC
M_FH:
    s_sub_u32 s96, s98, 1
    s_cmp_gt_u32 s98, 2
    s_cselect_b32 s64, 1, 0
    s_sub_u32 s96, s96, s64
    s_lshl_b32 s96, s96, 5
    s_add_u32 s96, s96, s99
    s_branch M_HELP
M_SLOW0:
    v_mbcnt_lo_u32_b32 v0, -1, 0
    v_mbcnt_hi_u32_b32 v0, -1, v0
    v_mul_u32_u24 v8, 32, v0
    s_mov_b32 s64, 0x0
    s_mov_b32 s65, 0
    s_mov_b64 exec, 0xff
TK_3:
    buffer_load_dword v9, v8, s[60:63], s64 offen sc1
    s_add_u32 s65, s65, 1
    s_waitcnt vmcnt(0)
    s_mov_b32 s66, 0
    v_readlane_b32 s67, v9, 0
    s_add_u32 s66, s66, s67
    v_readlane_b32 s67, v9, 1
    s_add_u32 s66, s66, s67
    v_readlane_b32 s67, v9, 2
    s_add_u32 s66, s66, s67
    v_readlane_b32 s67, v9, 3
    s_add_u32 s66, s66, s67
    v_readlane_b32 s67, v9, 4
    s_add_u32 s66, s66, s67
    v_readlane_b32 s67, v9, 5
    s_add_u32 s66, s66, s67
    v_readlane_b32 s67, v9, 6
    s_add_u32 s66, s66, s67
    v_readlane_b32 s67, v9, 7
    s_add_u32 s66, s66, s67
    s_cmp_ge_u32 s66, 256
    s_cbranch_scc1 TKD_4
    s_cmp_gt_u32 s65, 262144
    s_cbranch_scc0 TK_3
TKD_4:
    v_cmp_ne_u32 vcc, 32, v9
    s_mov_b64 exec, -1
M_SLOW:
    s_waitcnt vmcnt(0) lgkmcnt(0)
    s_barrier
    s_cmp_lg_u32 s14, 0
    s_cbranch_scc1 M_SLOWB
    v_mov_b32 v8, 1
    s_mov_b64 exec, 1
    buffer_atomic_add v8, off, s[60:63], 12 sc1
    s_mov_b64 exec, -1
M_SLOWB:
    s_mov_b32 s95, 12
    s_mov_b32 s65, 0
SB_5:
    buffer_load_dword v8, off, s[60:63], s95 sc1
    s_add_u32 s65, s65, 1
    s_waitcnt vmcnt(0)
    v_readfirstlane_b32 s64, v8
    s_cmp_ge_u32 s64, 256
    s_cbranch_scc1 SBD_6
    s_cmp_gt_u32 s65, 65536
    s_cbranch_scc1 SBD_6
    s_sleep 4
    s_branch SB_5
SBD_6:
    s_mov_b32 s95, 8
    s_mov_b32 s97, 1
    s_cmp_lt_u32 s2, 64
    s_cbranch_scc0 M_SH
    s_lshr_b32 s12, s2, 5
    s_and_b32 s13, s2, 31
    s_branch M_REC
M_SH:
    s_sub_u32 s96, s2, 64
    s_branch M_HELP
M_REC:
    v_mbcnt_lo_u32_b32 v0, -1, 0
    v_mbcnt_hi_u32_b32 v0, -1, v0
    s_load_dwordx2 s[44:45], s[0:1], 16
    s_mov_b32 s46, 0x500000
    s_mov_b32 s47, 0x00020000
    s_load_dwordx2 s[48:49], s[0:1], 24
    s_mov_b32 s50, 0x500000
    s_mov_b32 s51, 0x00020000
    s_load_dwordx2 s[52:53], s[0:1], 32
    s_mov_b32 s54, 0x500000
    s_mov_b32 s55, 0x00020000
    s_load_dwordx2 s[56:57], s[0:1], 40
    s_mov_b32 s58, 0x500000
    s_mov_b32 s59, 0x00020000
    s_waitcnt lgkmcnt(0)
    v_and_b32 v0, 63, v0
    s_mul_i32 s40, s14, 36864
    s_add_u32 s40, s40, 16384
    v_bfe_u32 v95, v0, 2, 2
    v_lshlrev_b32 v88, 15, v95
    v_lshrrev_b32 v95, 5, v0
    v_lshl_add_u32 v88, v95, 14, v88
    v_bfe_u32 v95, v0, 4, 1
    v_lshl_add_u32 v88, v95, 13, v88
    v_lshlrev_b32 v95, 1, v95
    v_and_b32 v8, 3, v0
    v_xor_b32 v95, v95, v8
    v_lshl_add_u32 v88, v95, 4, v88
    v_bfe_u32 v95, v0, 2, 1
    v_mov_b32 v8, v95
    v_bfe_u32 v95, v0, 3, 1
    v_lshl_add_u32 v8, v95, 2, v8
    v_bfe_u32 v95, v0, 4, 1
    v_lshl_add_u32 v8, v95, 1, v8
    v_bfe_u32 v95, v0, 5, 1
    v_lshl_add_u32 v8, v95, 3, v8
    v_mul_u32_u24 v8, 1280, v8
    v_and_b32 v95, 3, v0
    v_lshl_add_u32 v89, v95, 4, v8
    v_lshrrev_b32 v95, 1, v0
    v_mul_u32_u24 v8, 1280, v95
    v_and_b32 v95, 1, v0
    v_lshl_add_u32 v90, v95, 4, v8
    v_lshrrev_b32 v95, 5, v0
    v_lshlrev_b32 v91, 10, v95
    v_bfe_u32 v95, v0, 2, 1
    v_lshl_add_u32 v91, v95, 8, v91
    v_bfe_u32 v95, v0, 4, 1
    v_lshl_add_u32 v91, v95, 6, v91
    v_bfe_u32 v95, v0, 3, 1
    v_lshl_add_u32 v91, v95, 7, v91
    v_and_b32 v95, 1, v0
    v_lshl_add_u32 v91, v95, 3, v91
    v_bfe_u32 v95, v0, 1, 1
    v_lshl_add_u32 v91, v95, 4, v91
    v_add_u32 v91, s40, v91
    v_bfe_u32 v95, v0, 2, 1
    v_lshlrev_b32 v95, 5, v95
    v_sub_u32 v92, 32, v95
    v_add_u32 v92, v92, v91
    v_add_u32 v91, v91, v95
    v_lshrrev_b32 v95, 5, v0
    v_lshlrev_b32 v93, 9, v95
    v_bfe_u32 v95, v0, 4, 1
    v_lshl_add_u32 v93, v95, 7, v93
    v_bfe_u32 v95, v0, 2, 1
    v_lshl_add_u32 v93, v95, 6, v93
    v_bfe_u32 v95, v0, 3, 1
    v_lshl_add_u32 v93, v95, 5, v93
    v_and_b32 v95, 3, v0
    v_lshl_add_u32 v93, v95, 3, v93
    v_add_u32 v93, s40, v93
    v_lshrrev_b32 v95, 4, v0
    v_lshlrev_b32 v94, 8, v95
    v_bfe_u32 v95, v0, 2, 2
    v_lshl_add_u32 v94, v95, 5, v94
    v_and_b32 v95, 3, v0
    v_lshl_add_u32 v94, v95, 3, v94
    v_add_u32 v94, s40, v94
    v_lshrrev_b32 v95, 4, v0
    v_lshlrev_b32 v8, 13, v95
    v_and_b32 v95, 1, v95
    v_lshlrev_b32 v95, 1, v95
    v_and_b32 v9, 15, v0
    v_xor_b32 v9, v9, v95
    v_xor_b32 v95, 0, v9
    v_lshl_add_u32 v76, v95, 4, v8
    v_xor_b32 v95, 4, v9
    v_lshl_add_u32 v77, v95, 4, v8
    v_xor_b32 v95, 8, v9
    v_lshl_add_u32 v78, v95, 4, v8
    v_xor_b32 v95, 12, v9
    v_lshl_add_u32 v79, v95, 4, v8
    v_lshrrev_b32 v95, 5, v0
    v_mul_u32_u24 v8, 36864, v95
    v_bfe_u32 v95, v0, 3, 1
    v_lshl_add_u32 v8, v95, 11, v8
    v_lshlrev_b32 v9, 3, v95
    v_bfe_u32 v95, v0, 4, 1
    v_lshl_add_u32 v8, v95, 10, v8
    v_lshl_add_u32 v9, v95, 2, v9
    v_bfe_u32 v95, v0, 2, 1
    v_lshl_add_u32 v8, v95, 8, v8
    v_lshl_add_u32 v9, v95, 1, v9
    v_and_b32 v95, 1, v0
    v_lshl_add_u32 v8, v95, 3, v8
    v_add_u32 v8, 16384, v8
    v_bfe_u32 v95, v0, 1, 1
    s_lshl_b32 s64, s14, 2
    v_add_u32 v10, s64, v95
    v_add_u32 v95, 0, v10
    v_xor_b32 v95, v95, v9
    v_lshl_add_u32 v72, v95, 4, v8
    v_add_u32 v73, 73728, v72
    v_add_u32 v95, 2, v10
    v_xor_b32 v95, v95, v9
    v_lshl_add_u32 v74, v95, 4, v8
    v_add_u32 v75, 73728, v74
    s_lshl_b32 s64, s13, 8
    s_lshl_b32 s65, s14, 17
    s_add_u32 s64, s64, s65
    s_mul_i32 s65, s12, 2621440
    s_add_u32 s71, s64, s65
    s_sub_u32 s65, 2621440, s65
    s_add_u32 s72, s64, s65
    s_mul_i32 s39, s13, 163840
    s_mul_i32 s64, s12, 640
    s_add_u32 s39, s39, s64
    s_lshl_b32 s64, s14, 5
    s_add_u32 s41, s39, s64
    s_add_u32 s41, s41, 0x200
    s_lshl_b32 s64, s14, 6
    s_add_u32 s39, s39, s64
    v_lshlrev_b32 v87, 6, v0
    s_add_u32 m0, s40, 0
    s_add_u32 s64, s71, 0x0
    buffer_load_dwordx4 v76, s[44:47], s64 offen lds
    s_add_u32 m0, s40, 1024
    s_add_u32 s64, s71, 0x8000
    buffer_load_dwordx4 v77, s[44:47], s64 offen lds
    s_add_u32 m0, s40, 2048
    s_add_u32 s64, s71, 0x10000
    buffer_load_dwordx4 v78, s[44:47], s64 offen lds
    s_add_u32 m0, s40, 3072
    s_add_u32 s64, s71, 0x18000
    buffer_load_dwordx4 v79, s[44:47], s64 offen lds
    s_add_u32 m0, s40, 4096
    s_add_u32 s64, s71, 0x80000
    buffer_load_dwordx4 v76, s[44:47], s64 offen lds
    s_add_u32 m0, s40, 5120
    s_add_u32 s64, s71, 0x88000
    buffer_load_dwordx4 v77, s[44:47], s64 offen lds
    s_add_u32 m0, s40, 6144
    s_add_u32 s64, s71, 0x90000
    buffer_load_dwordx4 v78, s[44:47], s64 offen lds
    s_add_u32 m0, s40, 7168
    s_add_u32 s64, s71, 0x98000
    buffer_load_dwordx4 v79, s[44:47], s64 offen lds
    s_add_u32 m0, s40, 8192
    s_add_u32 s64, s71, 0x100000
    buffer_load_dwordx4 v76, s[44:47], s64 offen lds
    s_add_u32 m0, s40, 9216
    s_add_u32 s64, s71, 0x108000
    buffer_load_dwordx4 v77, s[44:47], s64 offen lds
    s_add_u32 m0, s40, 10240
    s_add_u32 s64, s71, 0x110000
    buffer_load_dwordx4 v78, s[44:47], s64 offen lds
    s_add_u32 m0, s40, 11264
    s_add_u32 s64, s71, 0x118000
    buffer_load_dwordx4 v79, s[44:47], s64 offen lds
    s_add_u32 m0, s40, 12288
    s_add_u32 s64, s71, 0x180000
    buffer_load_dwordx4 v76, s[44:47], s64 offen lds
    s_add_u32 m0, s40, 13312
    s_add_u32 s64, s71, 0x188000
    buffer_load_dwordx4 v77, s[44:47], s64 offen lds
    s_add_u32 m0, s40, 14336
    s_add_u32 s64, s71, 0x190000
    buffer_load_dwordx4 v78, s[44:47], s64 offen lds
    s_add_u32 m0, s40, 15360
    s_add_u32 s64, s71, 0x198000
    buffer_load_dwordx4 v79, s[44:47], s64 offen lds
    s_add_u32 m0, s40, 16384
    s_add_u32 s64, s71, 0x200000
    buffer_load_dwordx4 v76, s[44:47], s64 offen lds
    s_add_u32 m0, s40, 17408
    s_add_u32 s64, s71, 0x208000
    buffer_load_dwordx4 v77, s[44:47], s64 offen lds
    s_add_u32 m0, s40, 18432
    s_add_u32 s64, s71, 0x210000
    buffer_load_dwordx4 v78, s[44:47], s64 offen lds
    s_add_u32 m0, s40, 19456
    s_add_u32 s64, s71, 0x218000
    buffer_load_dwordx4 v79, s[44:47], s64 offen lds
    s_add_u32 m0, s40, 20480
    s_add_u32 s64, s72, 0x0
    buffer_load_dwordx4 v76, s[44:47], s64 offen lds
    s_add_u32 m0, s40, 21504
    s_add_u32 s64, s72, 0x8000
    buffer_load_dwordx4 v77, s[44:47], s64 offen lds
    s_add_u32 m0, s40, 22528
    s_add_u32 s64, s72, 0x10000
    buffer_load_dwordx4 v78, s[44:47], s64 offen lds
    s_add_u32 m0, s40, 23552
    s_add_u32 s64, s72, 0x18000
    buffer_load_dwordx4 v79, s[44:47], s64 offen lds
    s_add_u32 m0, s40, 24576
    s_add_u32 s64, s72, 0x80000
    buffer_load_dwordx4 v76, s[44:47], s64 offen lds
    s_add_u32 m0, s40, 25600
    s_add_u32 s64, s72, 0x88000
    buffer_load_dwordx4 v77, s[44:47], s64 offen lds
    s_add_u32 m0, s40, 26624
    s_add_u32 s64, s72, 0x90000
    buffer_load_dwordx4 v78, s[44:47], s64 offen lds
    s_add_u32 m0, s40, 27648
    s_add_u32 s64, s72, 0x98000
    buffer_load_dwordx4 v79, s[44:47], s64 offen lds
    s_add_u32 m0, s40, 28672
    s_add_u32 s64, s72, 0x100000
    buffer_load_dwordx4 v76, s[44:47], s64 offen lds
    s_add_u32 m0, s40, 29696
    s_add_u32 s64, s72, 0x108000
    buffer_load_dwordx4 v77, s[44:47], s64 offen lds
    s_add_u32 m0, s40, 30720
    s_add_u32 s64, s72, 0x110000
    buffer_load_dwordx4 v78, s[44:47], s64 offen lds
    s_add_u32 m0, s40, 31744
    s_add_u32 s64, s72, 0x118000
    buffer_load_dwordx4 v79, s[44:47], s64 offen lds
    v_and_b32 v0, 63, v0
    v_lshlrev_b32 v1, 4, v0
    s_mul_i32 s64, s14, 36864
    s_add_u32 s64, s64, 16384
    v_add_u32 v2, s64, v1
    v_bfe_u32 v8, v0, 4, 1
    v_mul_u32_u24 v8, 1152, v8
    v_lshrrev_b32 v9, 5, v0
    v_lshlrev_b32 v9, 4, v9
    v_and_b32 v10, 15, v0
    v_add_u32 v9, v9, v10
    s_lshl_b32 s64, s14, 5
    v_add_u32 v9, s64, v9
    v_lshl_add_u32 v8, v9, 3, v8
    v_add_u32 v3, 8192, v8
    v_and_b32 v8, 1, v0
    v_mul_u32_u24 v8, 1152, v8
    v_lshrrev_b32 v9, 4, v0
    v_lshlrev_b32 v9, 2, v9
    v_bfe_u32 v10, v0, 2, 2
    v_add_u32 v9, v9, v10
    v_lshl_add_u32 v8, v9, 3, v8
    v_add_u32 v4, 8192, v8
    v_and_b32 v8, 7, v0
    v_mul_u32_u24 v8, 288, v8
    v_bfe_u32 v9, v0, 3, 1
    v_lshl_add_u32 v8, v9, 5, v8
    v_lshrrev_b32 v9, 4, v0
    v_lshl_add_u32 v8, v9, 3, v8
    s_lshl_b32 s64, s14, 6
    s_add_u32 s64, s64, 12800
    v_add_u32 v5, s64, v8
    s_mov_b32 s32, 0x00ff00ff
    s_mov_b32 s33, 0x00ff00ff
    s_mov_b32 s34, -1
    s_mov_b32 s35, 0
    s_mov_b32 s36, 0x00010001
    s_mov_b32 s37, 0x00010001
    v_mov_b32 v8, 0xeeee
    v_mov_b32 v9, 0x4444
    v_cndmask_b32 v6, v8, v9, s[32:33]
    v_lshrrev_b32 v8, 5, v0
    v_lshlrev_b32 v8, 13, v8
    v_bfe_u32 v9, v0, 3, 1
    v_lshl_add_u32 v8, v9, 12, v8
    v_and_b32 v9, 7, v0
    v_lshl_add_u32 v8, v9, 4, v8
    v_bfe_u32 v9, v0, 4, 1
    v_lshl_add_u32 v7, v9, 3, v8
    s_mov_b32 s10, 0x3e0293ee
    s_mov_b32 s11, 0x3e0293ee
    s_cmp_eq_u32 s14, 0
    s_cselect_b32 s42, 1, 0
    s_cmp_ge_u32 s13, 24
    s_cselect_b32 s65, 1, 0
    s_cmp_eq_u32 s14, 1
    s_cselect_b32 s65, s65, 0
    s_or_b32 s42, s42, s65
    s_lshl_b32 s65, s65, 3
    s_add_u32 s64, s13, s65
    s_cmp_eq_u32 s64, 39
    s_cselect_b32 s22, s42, 0
    s_mul_i32 s24, s12, 163840
    s_add_u32 s24, s24, 0x300000
    s_lshl_b32 s67, s13, 7
    s_add_u32 s26, s24, s67
    s_lshl_b32 s67, s14, 14
    s_add_u32 s23, s26, s67
    s_add_u32 s25, s23, 0x10000
    s_lshl_b32 s67, s14, 13
    s_add_u32 s26, s26, s67
    s_add_u32 s26, s26, 0x20000
    s_lshl_b32 s67, s64, 12
    s_add_u32 s24, s24, s67
    s_lshl_b32 s64, s64, 7
    s_lshl_b32 s65, s12, 13
    s_add_u32 s17, s65, 0x5900000
    s_add_u32 s18, s17, s64
    s_lshl_b32 s65, s12, 21
    s_add_u32 s66, s65, 0x6000000
    s_add_u32 s21, s66, s64
    s_xor_b32 s65, s65, 0x200000
    s_add_u32 s20, s65, 0x5ff8000
    s_and_b32 s64, s13, 1
    s_cmp_eq_u32 s64, s12
    s_cselect_b32 s43, 1, 0
    s_mov_b32 s43, 0
    s_lshl_b32 s64, s13, 4
    s_add_u32 s69, s64, 0x291000
    s_lshl_b32 s64, s13, 2
    s_add_u32 s70, s64, 0x294000
    s_lshl_b32 s64, s13, 14
    s_lshl_b32 s73, s14, 11
    s_lshl_b32 s65, s14, 12
    s_add_u32 s65, s65, s64
    s_add_u32 s3, s65, 0x1500000
    s_add_u32 s64, s64, s73
    s_add_u32 s28, s64, 0x1400000
    s_add_u32 s29, s64, 0x1402000
    s_lshl_b32 s64, s13, 11
    s_add_u32 s30, s64, 0x640000
    s_lshl_b32 s64, s13, 12
    s_lshl_b32 s65, s14, 10
    s_add_u32 s64, s64, s65
    s_add_u32 s31, s64, 0xa40000
    s_waitcnt vmcnt(28)
    s_barrier
    s_add_u32 m0, s40, 32768
    s_add_u32 s64, s72, 0x180000
    buffer_load_dwordx4 v76, s[44:47], s64 offen lds
    s_add_u32 m0, s40, 33792
    s_add_u32 s64, s72, 0x188000
    buffer_load_dwordx4 v77, s[44:47], s64 offen lds
    s_add_u32 m0, s40, 34816
    s_add_u32 s64, s72, 0x190000
    buffer_load_dwordx4 v78, s[44:47], s64 offen lds
    s_add_u32 m0, s40, 35840
    s_add_u32 s64, s72, 0x198000
    buffer_load_dwordx4 v79, s[44:47], s64 offen lds
    ds_read_b64_tr_b16 v[96:97], v72 offset:0
    ds_read_b64_tr_b16 v[98:99], v72 offset:512
    ds_read_b64_tr_b16 v[100:101], v73 offset:0
    ds_read_b64_tr_b16 v[102:103], v73 offset:512
    ds_read_b64_tr_b16 v[104:105], v74 offset:0
    ds_read_b64_tr_b16 v[106:107], v74 offset:512
    ds_read_b64_tr_b16 v[108:109], v75 offset:0
    ds_read_b64_tr_b16 v[110:111], v75 offset:512
    s_waitcnt lgkmcnt(0)
    s_waitcnt vmcnt(28)
    s_barrier
    s_add_u32 m0, s40, 0
    s_add_u32 s64, s72, 0x200000
    buffer_load_dwordx4 v76, s[44:47], s64 offen lds
    s_add_u32 m0, s40, 1024
    s_add_u32 s64, s72, 0x208000
    buffer_load_dwordx4 v77, s[44:47], s64 offen lds
    s_add_u32 m0, s40, 2048
    s_add_u32 s64, s72, 0x210000
    buffer_load_dwordx4 v78, s[44:47], s64 offen lds
    s_add_u32 m0, s40, 3072
    s_add_u32 s64, s72, 0x218000
    buffer_load_dwordx4 v79, s[44:47], s64 offen lds
    ds_read_b64_tr_b16 v[112:113], v72 offset:4096
    ds_read_b64_tr_b16 v[114:115], v72 offset:4608
    ds_read_b64_tr_b16 v[116:117], v73 offset:4096
    ds_read_b64_tr_b16 v[118:119], v73 offset:4608
    ds_read_b64_tr_b16 v[120:121], v74 offset:4096
    ds_read_b64_tr_b16 v[122:123], v74 offset:4608
    ds_read_b64_tr_b16 v[124:125], v75 offset:4096
    ds_read_b64_tr_b16 v[126:127], v75 offset:4608
    s_waitcnt lgkmcnt(0)
    s_waitcnt vmcnt(28)
    s_barrier
    s_add_u32 m0, s40, 4096
    s_add_u32 s64, s72, 0x200000
    buffer_load_dwordx4 v76, s[48:51], s64 offen lds
    s_add_u32 m0, s40, 5120
    s_add_u32 s64, s72, 0x208000
    buffer_load_dwordx4 v77, s[48:51], s64 offen lds
    s_add_u32 m0, s40, 6144
    s_add_u32 s64, s72, 0x210000
    buffer_load_dwordx4 v78, s[48:51], s64 offen lds
    s_add_u32 m0, s40, 7168
    s_add_u32 s64, s72, 0x218000
    buffer_load_dwordx4 v79, s[48:51], s64 offen lds
    ds_read_b64_tr_b16 v[128:129], v72 offset:8192
    ds_read_b64_tr_b16 v[130:131], v72 offset:8704
    ds_read_b64_tr_b16 v[132:133], v73 offset:8192
    ds_read_b64_tr_b16 v[134:135], v73 offset:8704
    ds_read_b64_tr_b16 v[136:137], v74 offset:8192
    ds_read_b64_tr_b16 v[138:139], v74 offset:8704
    ds_read_b64_tr_b16 v[140:141], v75 offset:8192
    ds_read_b64_tr_b16 v[142:143], v75 offset:8704
    s_waitcnt lgkmcnt(0)
    s_waitcnt vmcnt(28)
    s_barrier
    s_add_u32 m0, s40, 8192
    s_add_u32 s64, s71, 0x0
    buffer_load_dwordx4 v76, s[52:55], s64 offen lds
    s_add_u32 m0, s40, 9216
    s_add_u32 s64, s71, 0x8000
    buffer_load_dwordx4 v77, s[52:55], s64 offen lds
    s_add_u32 m0, s40, 10240
    s_add_u32 s64, s71, 0x10000
    buffer_load_dwordx4 v78, s[52:55], s64 offen lds
    s_add_u32 m0, s40, 11264
    s_add_u32 s64, s71, 0x18000
    buffer_load_dwordx4 v79, s[52:55], s64 offen lds
    ds_read_b64_tr_b16 v[144:145], v72 offset:12288
    ds_read_b64_tr_b16 v[146:147], v72 offset:12800
    ds_read_b64_tr_b16 v[148:149], v73 offset:12288
    ds_read_b64_tr_b16 v[150:151], v73 offset:12800
    ds_read_b64_tr_b16 v[152:153], v74 offset:12288
    ds_read_b64_tr_b16 v[154:155], v74 offset:12800
    ds_read_b64_tr_b16 v[156:157], v75 offset:12288
    ds_read_b64_tr_b16 v[158:159], v75 offset:12800
    s_waitcnt lgkmcnt(0)
    s_waitcnt vmcnt(28)
    s_barrier
    s_add_u32 m0, s40, 12288
    s_add_u32 s64, s71, 0x80000
    buffer_load_dwordx4 v76, s[52:55], s64 offen lds
    s_add_u32 m0, s40, 13312
    s_add_u32 s64, s71, 0x88000
    buffer_load_dwordx4 v77, s[52:55], s64 offen lds
    s_add_u32 m0, s40, 14336
    s_add_u32 s64, s71, 0x90000
    buffer_load_dwordx4 v78, s[52:55], s64 offen lds
    s_add_u32 m0, s40, 15360
    s_add_u32 s64, s71, 0x98000
    buffer_load_dwordx4 v79, s[52:55], s64 offen lds
    ds_read_b64_tr_b16 v[160:161], v72 offset:16384
    ds_read_b64_tr_b16 v[162:163], v72 offset:16896
    ds_read_b64_tr_b16 v[164:165], v73 offset:16384
    ds_read_b64_tr_b16 v[166:167], v73 offset:16896
    ds_read_b64_tr_b16 v[168:169], v74 offset:16384
    ds_read_b64_tr_b16 v[170:171], v74 offset:16896
    ds_read_b64_tr_b16 v[172:173], v75 offset:16384
    ds_read_b64_tr_b16 v[174:175], v75 offset:16896
    s_waitcnt lgkmcnt(0)
    s_waitcnt vmcnt(28)
    s_barrier
    s_add_u32 m0, s40, 16384
    s_add_u32 s64, s71, 0x100000
    buffer_load_dwordx4 v76, s[52:55], s64 offen lds
    s_add_u32 m0, s40, 17408
    s_add_u32 s64, s71, 0x108000
    buffer_load_dwordx4 v77, s[52:55], s64 offen lds
    s_add_u32 m0, s40, 18432
    s_add_u32 s64, s71, 0x110000
    buffer_load_dwordx4 v78, s[52:55], s64 offen lds
    s_add_u32 m0, s40, 19456
    s_add_u32 s64, s71, 0x118000
    buffer_load_dwordx4 v79, s[52:55], s64 offen lds
    ds_read_b64_tr_b16 v[176:177], v72 offset:20480
    ds_read_b64_tr_b16 v[178:179], v72 offset:20992
    ds_read_b64_tr_b16 v[180:181], v73 offset:20480
    ds_read_b64_tr_b16 v[182:183], v73 offset:20992
    ds_read_b64_tr_b16 v[184:185], v74 offset:20480
    ds_read_b64_tr_b16 v[186:187], v74 offset:20992
    ds_read_b64_tr_b16 v[188:189], v75 offset:20480
    ds_read_b64_tr_b16 v[190:191], v75 offset:20992
    s_waitcnt lgkmcnt(0)
    s_waitcnt vmcnt(28)
    s_barrier
    s_add_u32 m0, s40, 20480
    s_add_u32 s64, s71, 0x180000
    buffer_load_dwordx4 v76, s[52:55], s64 offen lds
    s_add_u32 m0, s40, 21504
    s_add_u32 s64, s71, 0x188000
    buffer_load_dwordx4 v77, s[52:55], s64 offen lds
    s_add_u32 m0, s40, 22528
    s_add_u32 s64, s71, 0x190000
    buffer_load_dwordx4 v78, s[52:55], s64 offen lds
    s_add_u32 m0, s40, 23552
    s_add_u32 s64, s71, 0x198000
    buffer_load_dwordx4 v79, s[52:55], s64 offen lds
    ds_read_b64_tr_b16 v[192:193], v72 offset:24576
    ds_read_b64_tr_b16 v[194:195], v72 offset:25088
    ds_read_b64_tr_b16 v[196:197], v73 offset:24576
    ds_read_b64_tr_b16 v[198:199], v73 offset:25088
    ds_read_b64_tr_b16 v[200:201], v74 offset:24576
    ds_read_b64_tr_b16 v[202:203], v74 offset:25088
    ds_read_b64_tr_b16 v[204:205], v75 offset:24576
    ds_read_b64_tr_b16 v[206:207], v75 offset:25088
    s_waitcnt lgkmcnt(0)
    s_waitcnt vmcnt(28)
    s_barrier
    s_add_u32 m0, s40, 24576
    s_add_u32 s64, s71, 0x200000
    buffer_load_dwordx4 v76, s[52:55], s64 offen lds
    s_add_u32 m0, s40, 25600
    s_add_u32 s64, s71, 0x208000
    buffer_load_dwordx4 v77, s[52:55], s64 offen lds
    s_add_u32 m0, s40, 26624
    s_add_u32 s64, s71, 0x210000
    buffer_load_dwordx4 v78, s[52:55], s64 offen lds
    s_add_u32 m0, s40, 27648
    s_add_u32 s64, s71, 0x218000
    buffer_load_dwordx4 v79, s[52:55], s64 offen lds
    ds_read_b64_tr_b16 v[208:209], v72 offset:28672
    ds_read_b64_tr_b16 v[210:211], v72 offset:29184
    ds_read_b64_tr_b16 v[212:213], v73 offset:28672
    ds_read_b64_tr_b16 v[214:215], v73 offset:29184
    ds_read_b64_tr_b16 v[216:217], v74 offset:28672
    ds_read_b64_tr_b16 v[218:219], v74 offset:29184
    ds_read_b64_tr_b16 v[220:221], v75 offset:28672
    ds_read_b64_tr_b16 v[222:223], v75 offset:29184
    s_waitcnt lgkmcnt(0)
    s_waitcnt vmcnt(28)
    s_barrier
    s_add_u32 m0, s40, 28672
    s_add_u32 s64, s72, 0x0
    buffer_load_dwordx4 v76, s[52:55], s64 offen lds
    s_add_u32 m0, s40, 29696
    s_add_u32 s64, s72, 0x8000
    buffer_load_dwordx4 v77, s[52:55], s64 offen lds
    s_add_u32 m0, s40, 30720
    s_add_u32 s64, s72, 0x10000
    buffer_load_dwordx4 v78, s[52:55], s64 offen lds
    s_add_u32 m0, s40, 31744
    s_add_u32 s64, s72, 0x18000
    buffer_load_dwordx4 v79, s[52:55], s64 offen lds
    ds_read_b64_tr_b16 v[224:225], v72 offset:32768
    ds_read_b64_tr_b16 v[226:227], v72 offset:33280
    ds_read_b64_tr_b16 v[228:229], v73 offset:32768
    ds_read_b64_tr_b16 v[230:231], v73 offset:33280
    ds_read_b64_tr_b16 v[232:233], v74 offset:32768
    ds_read_b64_tr_b16 v[234:235], v74 offset:33280
    ds_read_b64_tr_b16 v[236:237], v75 offset:32768
    ds_read_b64_tr_b16 v[238:239], v75 offset:33280
    s_waitcnt lgkmcnt(0)
    s_waitcnt vmcnt(28)
    s_barrier
    s_add_u32 m0, s40, 32768
    s_add_u32 s64, s72, 0x80000
    buffer_load_dwordx4 v76, s[52:55], s64 offen lds
    s_add_u32 m0, s40, 33792
    s_add_u32 s64, s72, 0x88000
    buffer_load_dwordx4 v77, s[52:55], s64 offen lds
    s_add_u32 m0, s40, 34816
    s_add_u32 s64, s72, 0x90000
    buffer_load_dwordx4 v78, s[52:55], s64 offen lds
    s_add_u32 m0, s40, 35840
    s_add_u32 s64, s72, 0x98000
    buffer_load_dwordx4 v79, s[52:55], s64 offen lds
    ds_read_b64_tr_b16 v[240:241], v72 offset:0
    ds_read_b64_tr_b16 v[242:243], v72 offset:512
    ds_read_b64_tr_b16 v[244:245], v73 offset:0
    ds_read_b64_tr_b16 v[246:247], v73 offset:512
    ds_read_b64_tr_b16 v[248:249], v74 offset:0
    ds_read_b64_tr_b16 v[250:251], v74 offset:512
    ds_read_b64_tr_b16 v[252:253], v75 offset:0
    ds_read_b64_tr_b16 v[254:255], v75 offset:512
    s_waitcnt lgkmcnt(0)
    s_waitcnt vmcnt(28)
    s_barrier
    s_add_u32 m0, s40, 0
    s_add_u32 s64, s72, 0x100000
    buffer_load_dwordx4 v76, s[52:55], s64 offen lds
    s_add_u32 m0, s40, 1024
    s_add_u32 s64, s72, 0x108000
    buffer_load_dwordx4 v77, s[52:55], s64 offen lds
    s_add_u32 m0, s40, 2048
    s_add_u32 s64, s72, 0x110000
    buffer_load_dwordx4 v78, s[52:55], s64 offen lds
    s_add_u32 m0, s40, 3072
    s_add_u32 s64, s72, 0x118000
    buffer_load_dwordx4 v79, s[52:55], s64 offen lds
    ds_read_b64_tr_b16 a[240:241], v72 offset:4096
    ds_read_b64_tr_b16 a[242:243], v72 offset:4608
    ds_read_b64_tr_b16 a[244:245], v73 offset:4096
    ds_read_b64_tr_b16 a[246:247], v73 offset:4608
    ds_read_b64_tr_b16 a[248:249], v74 offset:4096
    ds_read_b64_tr_b16 a[250:251], v74 offset:4608
    ds_read_b64_tr_b16 a[252:253], v75 offset:4096
    ds_read_b64_tr_b16 a[254:255], v75 offset:4608
    s_waitcnt lgkmcnt(0)
    s_waitcnt vmcnt(28)
    s_barrier
    s_add_u32 m0, s40, 4096
    s_add_u32 s64, s72, 0x180000
    buffer_load_dwordx4 v76, s[52:55], s64 offen lds
    s_add_u32 m0, s40, 5120
    s_add_u32 s64, s72, 0x188000
    buffer_load_dwordx4 v77, s[52:55], s64 offen lds
    s_add_u32 m0, s40, 6144
    s_add_u32 s64, s72, 0x190000
    buffer_load_dwordx4 v78, s[52:55], s64 offen lds
    s_add_u32 m0, s40, 7168
    s_add_u32 s64, s72, 0x198000
    buffer_load_dwordx4 v79, s[52:55], s64 offen lds
    ds_read_b64_tr_b16 a[0:1], v72 offset:8192
    ds_read_b64_tr_b16 a[2:3], v72 offset:8704
    ds_read_b64_tr_b16 a[4:5], v73 offset:8192
    ds_read_b64_tr_b16 a[6:7], v73 offset:8704
    ds_read_b64_tr_b16 a[8:9], v74 offset:8192
    ds_read_b64_tr_b16 a[10:11], v74 offset:8704
    ds_read_b64_tr_b16 a[12:13], v75 offset:8192
    ds_read_b64_tr_b16 a[14:15], v75 offset:8704
    s_waitcnt lgkmcnt(0)
    s_waitcnt vmcnt(28)
    s_barrier
    s_add_u32 m0, s40, 8192
    s_add_u32 s64, s72, 0x200000
    buffer_load_dwordx4 v76, s[52:55], s64 offen lds
    s_add_u32 m0, s40, 9216
    s_add_u32 s64, s72, 0x208000
    buffer_load_dwordx4 v77, s[52:55], s64 offen lds
    s_add_u32 m0, s40, 10240
    s_add_u32 s64, s72, 0x210000
    buffer_load_dwordx4 v78, s[52:55], s64 offen lds
    s_add_u32 m0, s40, 11264
    s_add_u32 s64, s72, 0x218000
    buffer_load_dwordx4 v79, s[52:55], s64 offen lds
    ds_read_b64_tr_b16 a[16:17], v72 offset:12288
    ds_read_b64_tr_b16 a[18:19], v72 offset:12800
    ds_read_b64_tr_b16 a[20:21], v73 offset:12288
    ds_read_b64_tr_b16 a[22:23], v73 offset:12800
    ds_read_b64_tr_b16 a[24:25], v74 offset:12288
    ds_read_b64_tr_b16 a[26:27], v74 offset:12800
    ds_read_b64_tr_b16 a[28:29], v75 offset:12288
    ds_read_b64_tr_b16 a[30:31], v75 offset:12800
    s_waitcnt lgkmcnt(0)
    s_waitcnt vmcnt(28)
    s_barrier
    s_add_u32 m0, s40, 12288
    s_add_u32 s64, s39, 0x0
    buffer_load_dwordx4 v89, s[56:59], s64 offen lds
    s_add_u32 m0, s40, 13312
    s_add_u32 s64, s39, 0x5000
    buffer_load_dwordx4 v89, s[56:59], s64 offen lds
    s_add_u32 m0, s40, 14336
    s_add_u32 s64, s39, 0xa000
    buffer_load_dwordx4 v89, s[56:59], s64 offen lds
    s_add_u32 m0, s40, 15360
    s_add_u32 s64, s39, 0xf000
    buffer_load_dwordx4 v89, s[56:59], s64 offen lds
    ds_read_b64_tr_b16 a[32:33], v72 offset:16384
    ds_read_b64_tr_b16 a[34:35], v72 offset:16896
    ds_read_b64_tr_b16 a[36:37], v73 offset:16384
    ds_read_b64_tr_b16 a[38:39], v73 offset:16896
    ds_read_b64_tr_b16 a[40:41], v74 offset:16384
    ds_read_b64_tr_b16 a[42:43], v74 offset:16896
    ds_read_b64_tr_b16 a[44:45], v75 offset:16384
    ds_read_b64_tr_b16 a[46:47], v75 offset:16896
    s_waitcnt lgkmcnt(0)
    s_waitcnt vmcnt(28)
    s_barrier
    s_add_u32 m0, s40, 16384
    s_add_u32 s64, s39, 0x14000
    buffer_load_dwordx4 v89, s[56:59], s64 offen lds
    s_add_u32 m0, s40, 17408
    s_add_u32 s64, s39, 0x19000
    buffer_load_dwordx4 v89, s[56:59], s64 offen lds
    s_add_u32 m0, s40, 18432
    s_add_u32 s64, s39, 0x1e000
    buffer_load_dwordx4 v89, s[56:59], s64 offen lds
    s_add_u32 m0, s40, 19456
    s_add_u32 s64, s39, 0x23000
    buffer_load_dwordx4 v89, s[56:59], s64 offen lds
    ds_read_b64_tr_b16 a[48:49], v72 offset:20480
    ds_read_b64_tr_b16 a[50:51], v72 offset:20992
    ds_read_b64_tr_b16 a[52:53], v73 offset:20480
    ds_read_b64_tr_b16 a[54:55], v73 offset:20992
    ds_read_b64_tr_b16 a[56:57], v74 offset:20480
    ds_read_b64_tr_b16 a[58:59], v74 offset:20992
    ds_read_b64_tr_b16 a[60:61], v75 offset:20480
    ds_read_b64_tr_b16 a[62:63], v75 offset:20992
    s_waitcnt lgkmcnt(0)
    s_waitcnt vmcnt(28)
    s_barrier
    s_add_u32 m0, s40, 20480
    s_add_u32 s64, s39, 0x100
    buffer_load_dwordx4 v89, s[56:59], s64 offen lds
    s_add_u32 m0, s40, 21504
    s_add_u32 s64, s39, 0x5100
    buffer_load_dwordx4 v89, s[56:59], s64 offen lds
    s_add_u32 m0, s40, 22528
    s_add_u32 s64, s39, 0xa100
    buffer_load_dwordx4 v89, s[56:59], s64 offen lds
    s_add_u32 m0, s40, 23552
    s_add_u32 s64, s39, 0xf100
    buffer_load_dwordx4 v89, s[56:59], s64 offen lds
    ds_read_b64_tr_b16 a[64:65], v72 offset:24576
    ds_read_b64_tr_b16 a[66:67], v72 offset:25088
    ds_read_b64_tr_b16 a[68:69], v73 offset:24576
    ds_read_b64_tr_b16 a[70:71], v73 offset:25088
    ds_read_b64_tr_b16 a[72:73], v74 offset:24576
    ds_read_b64_tr_b16 a[74:75], v74 offset:25088
    ds_read_b64_tr_b16 a[76:77], v75 offset:24576
    ds_read_b64_tr_b16 a[78:79], v75 offset:25088
    s_waitcnt lgkmcnt(0)
    s_waitcnt vmcnt(28)
    s_barrier
    s_add_u32 m0, s40, 24576
    s_add_u32 s64, s39, 0x14100
    buffer_load_dwordx4 v89, s[56:59], s64 offen lds
    s_add_u32 m0, s40, 25600
    s_add_u32 s64, s39, 0x19100
    buffer_load_dwordx4 v89, s[56:59], s64 offen lds
    s_add_u32 m0, s40, 26624
    s_add_u32 s64, s39, 0x1e100
    buffer_load_dwordx4 v89, s[56:59], s64 offen lds
    s_add_u32 m0, s40, 27648
    s_add_u32 s64, s39, 0x23100
    buffer_load_dwordx4 v89, s[56:59], s64 offen lds
    ds_read_b64_tr_b16 a[80:81], v72 offset:28672
    ds_read_b64_tr_b16 a[82:83], v72 offset:29184
    ds_read_b64_tr_b16 a[84:85], v73 offset:28672
    ds_read_b64_tr_b16 a[86:87], v73 offset:29184
    ds_read_b64_tr_b16 a[88:89], v74 offset:28672
    ds_read_b64_tr_b16 a[90:91], v74 offset:29184
    ds_read_b64_tr_b16 a[92:93], v75 offset:28672
    ds_read_b64_tr_b16 a[94:95], v75 offset:29184
    s_waitcnt lgkmcnt(0)
    s_waitcnt vmcnt(28)
    s_barrier
    s_add_u32 m0, s40, 28672
    s_add_u32 s64, s41, 0x0
    buffer_load_dwordx4 v90, s[56:59], s64 offen lds
    s_add_u32 m0, s40, 29696
    s_add_u32 s64, s41, 0xa000
    buffer_load_dwordx4 v90, s[56:59], s64 offen lds
    s_add_u32 m0, s40, 30720
    s_add_u32 s64, s41, 0x14000
    buffer_load_dwordx4 v90, s[56:59], s64 offen lds
    s_add_u32 m0, s40, 31744
    s_add_u32 s64, s41, 0x1e000
    buffer_load_dwordx4 v90, s[56:59], s64 offen lds
    ds_read_b64_tr_b16 a[96:97], v72 offset:32768
    ds_read_b64_tr_b16 a[98:99], v72 offset:33280
    ds_read_b64_tr_b16 a[100:101], v73 offset:32768
    ds_read_b64_tr_b16 a[102:103], v73 offset:33280
    ds_read_b64_tr_b16 a[104:105], v74 offset:32768
    ds_read_b64_tr_b16 a[106:107], v74 offset:33280
    ds_read_b64_tr_b16 a[108:109], v75 offset:32768
    ds_read_b64_tr_b16 a[110:111], v75 offset:33280
    s_waitcnt lgkmcnt(0)
    s_waitcnt vmcnt(28)
    s_barrier
    s_add_u32 m0, s40, 32768
    s_add_u32 s64, s72, 0x180000
    buffer_load_dwordx4 v76, s[48:51], s64 offen lds
    s_add_u32 m0, s40, 33792
    s_add_u32 s64, s72, 0x188000
    buffer_load_dwordx4 v77, s[48:51], s64 offen lds
    s_add_u32 m0, s40, 34816
    s_add_u32 s64, s72, 0x190000
    buffer_load_dwordx4 v78, s[48:51], s64 offen lds
    s_add_u32 m0, s40, 35840
    s_add_u32 s64, s72, 0x198000
    buffer_load_dwordx4 v79, s[48:51], s64 offen lds
    v_lshlrev_b32 v80, 2, v0
    buffer_load_dword v81, v80, s[60:63], 0 offen sc1
    ds_read_b64_tr_b16 a[112:113], v72 offset:0
    ds_read_b64_tr_b16 a[114:115], v72 offset:512
    ds_read_b64_tr_b16 a[116:117], v73 offset:0
    ds_read_b64_tr_b16 a[118:119], v73 offset:512
    ds_read_b64_tr_b16 a[120:121], v74 offset:0
    ds_read_b64_tr_b16 a[122:123], v74 offset:512
    ds_read_b64_tr_b16 a[124:125], v75 offset:0
    ds_read_b64_tr_b16 a[126:127], v75 offset:512
    s_waitcnt lgkmcnt(0)
    s_waitcnt vmcnt(29)
    s_barrier
    s_add_u32 m0, s40, 0
    s_add_u32 s64, s71, 0x0
    buffer_load_dwordx4 v76, s[48:51], s64 offen lds
    s_add_u32 m0, s40, 1024
    s_add_u32 s64, s71, 0x8000
    buffer_load_dwordx4 v77, s[48:51], s64 offen lds
    s_add_u32 m0, s40, 2048
    s_add_u32 s64, s71, 0x10000
    buffer_load_dwordx4 v78, s[48:51], s64 offen lds
    s_add_u32 m0, s40, 3072
    s_add_u32 s64, s71, 0x18000
    buffer_load_dwordx4 v79, s[48:51], s64 offen lds
    ds_read_b64_tr_b16 a[128:129], v72 offset:4096
    ds_read_b64_tr_b16 a[130:131], v72 offset:4608
    ds_read_b64_tr_b16 a[132:133], v73 offset:4096
    ds_read_b64_tr_b16 a[134:135], v73 offset:4608
    ds_read_b64_tr_b16 a[136:137], v74 offset:4096
    ds_read_b64_tr_b16 a[138:139], v74 offset:4608
    ds_read_b64_tr_b16 a[140:141], v75 offset:4096
    ds_read_b64_tr_b16 a[142:143], v75 offset:4608
    s_waitcnt lgkmcnt(0)
    s_waitcnt vmcnt(29)
    s_barrier
    s_add_u32 m0, s40, 4096
    s_add_u32 s64, s71, 0x80000
    buffer_load_dwordx4 v76, s[48:51], s64 offen lds
    s_add_u32 m0, s40, 5120
    s_add_u32 s64, s71, 0x88000
    buffer_load_dwordx4 v77, s[48:51], s64 offen lds
    s_add_u32 m0, s40, 6144
    s_add_u32 s64, s71, 0x90000
    buffer_load_dwordx4 v78, s[48:51], s64 offen lds
    s_add_u32 m0, s40, 7168
    s_add_u32 s64, s71, 0x98000
    buffer_load_dwordx4 v79, s[48:51], s64 offen lds
    ds_read_b64_tr_b16 a[144:145], v72 offset:8192
    ds_read_b64_tr_b16 a[146:147], v72 offset:8704
    ds_read_b64_tr_b16 a[148:149], v73 offset:8192
    ds_read_b64_tr_b16 a[150:151], v73 offset:8704
    ds_read_b64_tr_b16 a[152:153], v74 offset:8192
    ds_read_b64_tr_b16 a[154:155], v74 offset:8704
    ds_read_b64_tr_b16 a[156:157], v75 offset:8192
    ds_read_b64_tr_b16 a[158:159], v75 offset:8704
    s_waitcnt lgkmcnt(0)
    s_waitcnt vmcnt(29)
    s_barrier
    s_add_u32 m0, s40, 8192
    s_add_u32 s64, s71, 0x100000
    buffer_load_dwordx4 v76, s[48:51], s64 offen lds
    s_add_u32 m0, s40, 9216
    s_add_u32 s64, s71, 0x108000
    buffer_load_dwordx4 v77, s[48:51], s64 offen lds
    s_add_u32 m0, s40, 10240
    s_add_u32 s64, s71, 0x110000
    buffer_load_dwordx4 v78, s[48:51], s64 offen lds
    s_add_u32 m0, s40, 11264
    s_add_u32 s64, s71, 0x118000
    buffer_load_dwordx4 v79, s[48:51], s64 offen lds
    ds_read_b64_tr_b16 a[160:161], v93 offset:12288
    ds_read_b64_tr_b16 a[162:163], v93 offset:12544
    ds_read_b64_tr_b16 a[164:165], v93 offset:13312
    ds_read_b64_tr_b16 a[166:167], v93 offset:13568
    ds_read_b64_tr_b16 a[168:169], v93 offset:14336
    ds_read_b64_tr_b16 a[170:171], v93 offset:14592
    ds_read_b64_tr_b16 a[172:173], v93 offset:15360
    ds_read_b64_tr_b16 a[174:175], v93 offset:15616
    s_waitcnt lgkmcnt(0)
    s_waitcnt vmcnt(29)
    s_barrier
    s_add_u32 m0, s40, 12288
    s_add_u32 s64, s71, 0x180000
    buffer_load_dwordx4 v76, s[48:51], s64 offen lds
    s_add_u32 m0, s40, 13312
    s_add_u32 s64, s71, 0x188000
    buffer_load_dwordx4 v77, s[48:51], s64 offen lds
    s_add_u32 m0, s40, 14336
    s_add_u32 s64, s71, 0x190000
    buffer_load_dwordx4 v78, s[48:51], s64 offen lds
    s_add_u32 m0, s40, 15360
    s_add_u32 s64, s71, 0x198000
    buffer_load_dwordx4 v79, s[48:51], s64 offen lds
    ds_read_b64_tr_b16 a[176:177], v93 offset:16384
    ds_read_b64_tr_b16 a[178:179], v93 offset:16640
    ds_read_b64_tr_b16 a[180:181], v93 offset:17408
    ds_read_b64_tr_b16 a[182:183], v93 offset:17664
    ds_read_b64_tr_b16 a[184:185], v93 offset:18432
    ds_read_b64_tr_b16 a[186:187], v93 offset:18688
    ds_read_b64_tr_b16 a[188:189], v93 offset:19456
    ds_read_b64_tr_b16 a[190:191], v93 offset:19712
    s_waitcnt lgkmcnt(0)
    s_waitcnt vmcnt(29)
    s_barrier
    s_add_u32 m0, s40, 16384
    s_add_u32 s64, s71, 0x200000
    buffer_load_dwordx4 v76, s[48:51], s64 offen lds
    s_add_u32 m0, s40, 17408
    s_add_u32 s64, s71, 0x208000
    buffer_load_dwordx4 v77, s[48:51], s64 offen lds
    s_add_u32 m0, s40, 18432
    s_add_u32 s64, s71, 0x210000
    buffer_load_dwordx4 v78, s[48:51], s64 offen lds
    s_add_u32 m0, s40, 19456
    s_add_u32 s64, s71, 0x218000
    buffer_load_dwordx4 v79, s[48:51], s64 offen lds
    ds_read_b64_tr_b16 a[192:193], v93 offset:20480
    ds_read_b64_tr_b16 a[194:195], v93 offset:20736
    ds_read_b64_tr_b16 a[196:197], v93 offset:21504
    ds_read_b64_tr_b16 a[198:199], v93 offset:21760
    ds_read_b64_tr_b16 a[200:201], v93 offset:22528
    ds_read_b64_tr_b16 a[202:203], v93 offset:22784
    ds_read_b64_tr_b16 a[204:205], v93 offset:23552
    ds_read_b64_tr_b16 a[206:207], v93 offset:23808
    s_waitcnt lgkmcnt(0)
    s_waitcnt vmcnt(29)
    s_barrier
    s_add_u32 m0, s40, 20480
    s_add_u32 s64, s72, 0x0
    buffer_load_dwordx4 v76, s[48:51], s64 offen lds
    s_add_u32 m0, s40, 21504
    s_add_u32 s64, s72, 0x8000
    buffer_load_dwordx4 v77, s[48:51], s64 offen lds
    s_add_u32 m0, s40, 22528
    s_add_u32 s64, s72, 0x10000
    buffer_load_dwordx4 v78, s[48:51], s64 offen lds
    s_add_u32 m0, s40, 23552
    s_add_u32 s64, s72, 0x18000
    buffer_load_dwordx4 v79, s[48:51], s64 offen lds
    ds_read_b64_tr_b16 a[208:209], v93 offset:24576
    ds_read_b64_tr_b16 a[210:211], v93 offset:24832
    ds_read_b64_tr_b16 a[212:213], v93 offset:25600
    ds_read_b64_tr_b16 a[214:215], v93 offset:25856
    ds_read_b64_tr_b16 a[216:217], v93 offset:26624
    ds_read_b64_tr_b16 a[218:219], v93 offset:26880
    ds_read_b64_tr_b16 a[220:221], v93 offset:27648
    ds_read_b64_tr_b16 a[222:223], v93 offset:27904
    s_waitcnt lgkmcnt(0)
    s_waitcnt vmcnt(29)
    s_barrier
    s_add_u32 m0, s40, 24576
    s_add_u32 s64, s72, 0x80000
    buffer_load_dwordx4 v76, s[48:51], s64 offen lds
    s_add_u32 m0, s40, 25600
    s_add_u32 s64, s72, 0x88000
    buffer_load_dwordx4 v77, s[48:51], s64 offen lds
    s_add_u32 m0, s40, 26624
    s_add_u32 s64, s72, 0x90000
    buffer_load_dwordx4 v78, s[48:51], s64 offen lds
    s_add_u32 m0, s40, 27648
    s_add_u32 s64, s72, 0x98000
    buffer_load_dwordx4 v79, s[48:51], s64 offen lds
    ds_read_b64_tr_b16 a[224:225], v94 offset:28672
    ds_read_b64_tr_b16 a[226:227], v94 offset:28800
    ds_read_b64_tr_b16 a[228:229], v94 offset:29696
    ds_read_b64_tr_b16 a[230:231], v94 offset:29824
    ds_read_b64_tr_b16 a[232:233], v94 offset:30720
    ds_read_b64_tr_b16 a[234:235], v94 offset:30848
    ds_read_b64_tr_b16 a[236:237], v94 offset:31744
    ds_read_b64_tr_b16 a[238:239], v94 offset:31872
    s_waitcnt lgkmcnt(0)
    s_waitcnt vmcnt(29)
    s_barrier
    s_add_u32 m0, s40, 28672
    s_add_u32 s64, s72, 0x100000
    buffer_load_dwordx4 v76, s[48:51], s64 offen lds
    s_add_u32 m0, s40, 29696
    s_add_u32 s64, s72, 0x108000
    buffer_load_dwordx4 v77, s[48:51], s64 offen lds
    s_add_u32 m0, s40, 30720
    s_add_u32 s64, s72, 0x110000
    buffer_load_dwordx4 v78, s[48:51], s64 offen lds
    s_add_u32 m0, s40, 31744
    s_add_u32 s64, s72, 0x118000
    buffer_load_dwordx4 v79, s[48:51], s64 offen lds
    buffer_load_dwordx2 v[82:83], off, s[4:7], s69 sc1
    ds_read_b64_tr_b16 v[12:13], v72 offset:32768
    ds_read_b64_tr_b16 v[14:15], v72 offset:33280
    ds_read_b64_tr_b16 v[16:17], v73 offset:32768
    ds_read_b64_tr_b16 v[18:19], v73 offset:33280
    ds_read_b64_tr_b16 v[20:21], v74 offset:32768
    ds_read_b64_tr_b16 v[22:23], v74 offset:33280
    ds_read_b64_tr_b16 v[24:25], v75 offset:32768
    ds_read_b64_tr_b16 v[26:27], v75 offset:33280
    s_waitcnt lgkmcnt(0)
    s_barrier
    ds_write_b128 v2, v[12:15] offset:32768
    ds_write_b128 v2, v[16:19] offset:33792
    ds_write_b128 v2, v[20:23] offset:34816
    ds_write_b128 v2, v[24:27] offset:35840
    s_waitcnt lgkmcnt(0)
    s_waitcnt vmcnt(29)
    s_barrier
    ds_read_b64_tr_b16 v[12:13], v72 offset:0
    ds_read_b64_tr_b16 v[14:15], v72 offset:512
    ds_read_b64_tr_b16 v[16:17], v73 offset:0
    ds_read_b64_tr_b16 v[18:19], v73 offset:512
    ds_read_b64_tr_b16 v[20:21], v74 offset:0
    ds_read_b64_tr_b16 v[22:23], v74 offset:512
    ds_read_b64_tr_b16 v[24:25], v75 offset:0
    ds_read_b64_tr_b16 v[26:27], v75 offset:512
    s_waitcnt lgkmcnt(0)
    s_barrier
    ds_write_b128 v2, v[12:15] offset:0
    ds_write_b128 v2, v[16:19] offset:1024
    ds_write_b128 v2, v[20:23] offset:2048
    ds_write_b128 v2, v[24:27] offset:3072
    s_waitcnt lgkmcnt(0)
    s_waitcnt vmcnt(25)
    s_barrier
    ds_read_b64_tr_b16 v[12:13], v72 offset:4096
    ds_read_b64_tr_b16 v[14:15], v72 offset:4608
    ds_read_b64_tr_b16 v[16:17], v73 offset:4096
    ds_read_b64_tr_b16 v[18:19], v73 offset:4608
    ds_read_b64_tr_b16 v[20:21], v74 offset:4096
    ds_read_b64_tr_b16 v[22:23], v74 offset:4608
    ds_read_b64_tr_b16 v[24:25], v75 offset:4096
    ds_read_b64_tr_b16 v[26:27], v75 offset:4608
    s_waitcnt lgkmcnt(0)
    s_barrier
    ds_write_b128 v2, v[12:15] offset:4096
    ds_write_b128 v2, v[16:19] offset:5120
    ds_write_b128 v2, v[20:23] offset:6144
    ds_write_b128 v2, v[24:27] offset:7168
    s_waitcnt lgkmcnt(0)
    s_waitcnt vmcnt(21)
    s_barrier
    ds_read_b64_tr_b16 v[12:13], v72 offset:8192
    ds_read_b64_tr_b16 v[14:15], v72 offset:8704
    ds_read_b64_tr_b16 v[16:17], v73 offset:8192
    ds_read_b64_tr_b16 v[18:19], v73 offset:8704
    ds_read_b64_tr_b16 v[20:21], v74 offset:8192
    ds_read_b64_tr_b16 v[22:23], v74 offset:8704
    ds_read_b64_tr_b16 v[24:25], v75 offset:8192
    ds_read_b64_tr_b16 v[26:27], v75 offset:8704
    s_waitcnt lgkmcnt(0)
    s_barrier
    ds_write_b128 v2, v[12:15] offset:8192
    ds_write_b128 v2, v[16:19] offset:9216
    ds_write_b128 v2, v[20:23] offset:10240
    ds_write_b128 v2, v[24:27] offset:11264
    s_waitcnt lgkmcnt(0)
    s_waitcnt vmcnt(17)
    s_barrier
    ds_read_b64_tr_b16 v[12:13], v72 offset:12288
    ds_read_b64_tr_b16 v[14:15], v72 offset:12800
    ds_read_b64_tr_b16 v[16:17], v73 offset:12288
    ds_read_b64_tr_b16 v[18:19], v73 offset:12800
    ds_read_b64_tr_b16 v[20:21], v74 offset:12288
    ds_read_b64_tr_b16 v[22:23], v74 offset:12800
    ds_read_b64_tr_b16 v[24:25], v75 offset:12288
    ds_read_b64_tr_b16 v[26:27], v75 offset:12800
    s_waitcnt lgkmcnt(0)
    s_barrier
    ds_write_b128 v2, v[12:15] offset:12288
    ds_write_b128 v2, v[16:19] offset:13312
    ds_write_b128 v2, v[20:23] offset:14336
    ds_write_b128 v2, v[24:27] offset:15360
    s_waitcnt lgkmcnt(0)
    s_waitcnt vmcnt(13)
    s_barrier
    ds_read_b64_tr_b16 v[12:13], v72 offset:16384
    ds_read_b64_tr_b16 v[14:15], v72 offset:16896
    ds_read_b64_tr_b16 v[16:17], v73 offset:16384
    ds_read_b64_tr_b16 v[18:19], v73 offset:16896
    ds_read_b64_tr_b16 v[20:21], v74 offset:16384
    ds_read_b64_tr_b16 v[22:23], v74 offset:16896
    ds_read_b64_tr_b16 v[24:25], v75 offset:16384
    ds_read_b64_tr_b16 v[26:27], v75 offset:16896
    s_waitcnt lgkmcnt(0)
    s_barrier
    ds_write_b128 v2, v[12:15] offset:16384
    ds_write_b128 v2, v[16:19] offset:17408
    ds_write_b128 v2, v[20:23] offset:18432
    ds_write_b128 v2, v[24:27] offset:19456
    s_waitcnt lgkmcnt(0)
    s_waitcnt vmcnt(9)
    s_barrier
    ds_read_b64_tr_b16 v[12:13], v72 offset:20480
    ds_read_b64_tr_b16 v[14:15], v72 offset:20992
    ds_read_b64_tr_b16 v[16:17], v73 offset:20480
    ds_read_b64_tr_b16 v[18:19], v73 offset:20992
    ds_read_b64_tr_b16 v[20:21], v74 offset:20480
    ds_read_b64_tr_b16 v[22:23], v74 offset:20992
    ds_read_b64_tr_b16 v[24:25], v75 offset:20480
    ds_read_b64_tr_b16 v[26:27], v75 offset:20992
    s_waitcnt lgkmcnt(0)
    s_barrier
    ds_write_b128 v2, v[12:15] offset:20480
    ds_write_b128 v2, v[16:19] offset:21504
    ds_write_b128 v2, v[20:23] offset:22528
    ds_write_b128 v2, v[24:27] offset:23552
    s_waitcnt lgkmcnt(0)
    s_waitcnt vmcnt(5)
    s_barrier
    ds_read_b64_tr_b16 v[12:13], v72 offset:24576
    ds_read_b64_tr_b16 v[14:15], v72 offset:25088
    ds_read_b64_tr_b16 v[16:17], v73 offset:24576
    ds_read_b64_tr_b16 v[18:19], v73 offset:25088
    ds_read_b64_tr_b16 v[20:21], v74 offset:24576
    ds_read_b64_tr_b16 v[22:23], v74 offset:25088
    ds_read_b64_tr_b16 v[24:25], v75 offset:24576
    ds_read_b64_tr_b16 v[26:27], v75 offset:25088
    s_waitcnt lgkmcnt(0)
    s_barrier
    ds_write_b128 v2, v[12:15] offset:24576
    ds_write_b128 v2, v[16:19] offset:25600
    ds_write_b128 v2, v[20:23] offset:26624
    ds_write_b128 v2, v[24:27] offset:27648
    s_waitcnt lgkmcnt(0)
    s_waitcnt vmcnt(1)
    s_barrier
    ds_read_b64_tr_b16 v[12:13], v72 offset:28672
    ds_read_b64_tr_b16 v[14:15], v72 offset:29184
    ds_read_b64_tr_b16 v[16:17], v73 offset:28672
    ds_read_b64_tr_b16 v[18:19], v73 offset:29184
    ds_read_b64_tr_b16 v[20:21], v74 offset:28672
    ds_read_b64_tr_b16 v[22:23], v74 offset:29184
    ds_read_b64_tr_b16 v[24:25], v75 offset:28672
    ds_read_b64_tr_b16 v[26:27], v75 offset:29184
    s_waitcnt lgkmcnt(0)
    s_barrier
    ds_write_b128 v2, v[12:15] offset:28672
    ds_write_b128 v2, v[16:19] offset:29696
    ds_write_b128 v2, v[20:23] offset:30720
    ds_write_b128 v2, v[24:27] offset:31744
    s_waitcnt lgkmcnt(0)
    s_waitcnt vmcnt(0)
    s_cmp_lg_u32 s97, 0
    s_cbranch_scc1 NOTEARLY_8
    v_cmp_ne_u32 vcc, 32, v81
    v_readlane_b32 s64, v81, 1
    v_readlane_b32 s66, v81, 33
    v_readlane_b32 s67, v81, 34
    s_and_b32 s65, vcc_lo, 0x01010101
    s_cbranch_scc1 NOTEARLY_8
    s_and_b32 s65, vcc_hi, 0x01010101
    s_cbranch_scc1 NOTEARLY_8
    s_cmp_lt_u32 s64, 192
    s_cbranch_scc1 NOTEARLY_8
    s_min_u32 s65, s66, s67
    s_cmp_eq_u32 s65, 0
    s_cbranch_scc1 NOTEARLY_8
    s_sub_u32 s66, s66, 1
    s_sub_u32 s67, s67, 1
    s_branch EARLY_7
NOTEARLY_8:
    s_cmp_lg_u32 s97, 0
    s_cbranch_scc1 CM_9
    v_mbcnt_lo_u32_b32 v0, -1, 0
    v_mbcnt_hi_u32_b32 v0, -1, v0
    v_mul_u32_u24 v8, 32, v0
    s_mov_b32 s64, 0x0
    s_mov_b32 s65, 0
    s_mov_b64 exec, 0xff
TK_10:
    buffer_load_dword v9, v8, s[60:63], s64 offen sc1
    s_add_u32 s65, s65, 1
    s_waitcnt vmcnt(0)
    s_mov_b32 s66, 0
    v_readlane_b32 s67, v9, 0
    s_add_u32 s66, s66, s67
    v_readlane_b32 s67, v9, 1
    s_add_u32 s66, s66, s67
    v_readlane_b32 s67, v9, 2
    s_add_u32 s66, s66, s67
    v_readlane_b32 s67, v9, 3
    s_add_u32 s66, s66, s67
    v_readlane_b32 s67, v9, 4
    s_add_u32 s66, s66, s67
    v_readlane_b32 s67, v9, 5
    s_add_u32 s66, s66, s67
    v_readlane_b32 s67, v9, 6
    s_add_u32 s66, s66, s67
    v_readlane_b32 s67, v9, 7
    s_add_u32 s66, s66, s67
    s_cmp_ge_u32 s66, 256
    s_cbranch_scc1 TKD_11
    s_cmp_gt_u32 s65, 262144
    s_cbranch_scc0 TK_10
TKD_11:
    v_cmp_ne_u32 vcc, 32, v9
    s_mov_b64 exec, -1
    s_cbranch_vccnz M_SLOW
CM_9:
    s_mov_b32 s65, 0
RI_12:
    buffer_load_dword v8, off, s[60:63], s95 sc1
    s_add_u32 s65, s65, 1
    s_waitcnt vmcnt(0)
    v_readfirstlane_b32 s64, v8
    s_cmp_ge_u32 s64, 192
    s_cbranch_scc1 RID_13
    s_cmp_gt_u32 s65, 65536
    s_cbranch_scc1 RID_13
    s_sleep 4
    s_branch RI_12
RID_13:
    s_mov_b32 s65, 0
CW_14:
    buffer_load_dwordx2 v[8:9], off, s[60:63], 0 offset:132 sc1
    s_add_u32 s65, s65, 1
    s_waitcnt vmcnt(0)
    v_readfirstlane_b32 s66, v8
    v_readfirstlane_b32 s67, v9
    s_min_u32 s64, s66, s67
    s_cmp_lg_u32 s64, 0
    s_cbranch_scc1 CWD_15
    s_cmp_gt_u32 s65, 65536
    s_cbranch_scc1 CWD_15
    s_sleep 4
    s_branch CW_14
CWD_15:
    s_sub_u32 s66, s66, 1
    s_and_b32 s66, s66, 3
    s_sub_u32 s67, s67, 1
    s_and_b32 s67, s67, 3
EARLY_7:
    s_mov_b32 s54, s66
    s_mov_b32 s55, s67
    s_mov_b32 s38, 0x3f80
    s_mov_b32 s53, 0
    s_cmp_eq_u32 s14, 2
    s_cselect_b32 s52, 1024, 0
    s_mov_b32 s44, 0x3030303
    s_mov_b32 s45, 0x3030303
    s_mov_b32 s46, 0xc0c0c0c
    s_mov_b32 s47, 0xc0c0c0c
    s_mov_b32 s48, 0x30303030
    s_mov_b32 s49, 0x30303030
    s_mov_b32 s50, 0xc0c0c0c0
    s_mov_b32 s51, 0xc0c0c0c0
    v_and_b32 v8, 7, v0
    v_mul_u32_u24 v8, 288, v8
    v_lshrrev_b32 v9, 4, v0
    v_lshl_add_u32 v8, v9, 4, v8
    v_add_u32 v0, 12800, v8
    s_mov_b32 s68, 0
    s_mov_b32 s40, 0
    s_mov_b32 s64, s54
    s_mov_b32 s65, s55
    s_cmp_eq_u32 s12, 0
    s_cselect_b32 s66, s65, s64
    s_cselect_b32 s64, s64, s65
    s_and_b32 s64, s64, 3
    s_lshl_b32 s64, s64, 13
    s_and_b32 s66, s66, 3
    s_lshl_b32 s66, s66, 13
    s_add_u32 s21, s21, s64
    s_add_u32 s20, s20, s66
    s_cmp_eq_u32 s42, 0
    s_cselect_b32 s18, 0x40000000, s18
    s_cselect_b32 s21, 0x40000000, s21
    s_lshl_b32 s65, s12, 7
    s_add_u32 s65, s65, 0x29a000
    s_cmp_eq_u32 s22, 0
    s_cselect_b32 s22, 0x40000000, s65
    s_lshl_b32 s64, s13, 2
    s_add_u32 s64, s64, s14
    s_cmp_ge_u32 s64, 40
    s_cselect_b32 s65, 40, 0
    s_sub_u32 s64, s64, s65
    s_cmp_ge_u32 s64, 40
    s_cselect_b32 s65, 40, 0
    s_sub_u32 s64, s64, s65
    s_cmp_ge_u32 s64, 40
    s_cselect_b32 s65, 40, 0
    s_sub_u32 s64, s64, s65
    s_lshl_b32 s27, s64, 7
    s_add_u32 s19, s27, 0x4000
    v_and_b32 v82, v82, v83
    v_cmp_eq_u32 vcc, 0, v82
    s_cmp_lg_u32 s97, 0
    s_cselect_b64 vcc, -1, vcc
    s_cbranch_vccz KVOK_16
    v_mov_b32 v29, 0
FSPIN_17:
    buffer_load_dwordx2 v[12:13], v29, s[4:7], s69 offen sc1
    s_add_u32 s68, s68, 1
    s_waitcnt vmcnt(0)
    v_and_b32 v12, v12, v13
    v_cmp_eq_u32 vcc, 0, v12
    s_cbranch_vccz FDONE_18
    s_cmp_gt_u32 s68, 262144
    s_cbranch_scc0 FSPIN_17
FDONE_18:
KVOK_16:
    s_barrier
    s_mov_b32 m0, s73
    s_nop 0
    buffer_load_dwordx4 v1, s[4:7], s28 offen lds
    buffer_load_dwordx4 v1, s[4:7], s28 offen offset:1024 lds
    s_mov_b32 m0, 16128
    v_lshlrev_b32 v12, 2, v1
    s_add_u32 s65, s3, 0xfff80000
    buffer_load_dword v12, s[4:7], s65 offen lds
    s_mov_b32 s15, 0
    s_mov_b32 s16, 0
    s_add_u32 s66, s17, s52
    buffer_load_dwordx4 v[12:15], v1, s[4:7], s66 offen sc1
    buffer_load_dwordx4 v[16:19], v1, s[4:7], s17 offen offset:2048 sc1
    v_add_u32 v29, s52, v1
    s_waitcnt vmcnt(0)
    ds_write_b128 v29, v[12:15] offset:12800
    ds_write_b128 v1, v[16:19] offset:15104
    s_waitcnt lgkmcnt(0)
    v_mov_b64 v[32:33], 0
    v_mov_b64 v[34:35], 0
    v_mov_b64 v[36:37], 0
    v_mov_b64 v[38:39], 0
    v_mov_b64 v[40:41], 0
    v_mov_b64 v[42:43], 0
    v_mov_b64 v[44:45], 0
    v_mov_b64 v[46:47], 0
    v_mov_b64 v[48:49], 0
    v_mov_b64 v[50:51], 0
    v_mov_b64 v[52:53], 0
    v_mov_b64 v[54:55], 0
    v_mov_b32 v9, 0x40000000
    ds_read_b128 v[56:59], v2 offset:0
    ds_read_b128 v[60:63], v2 offset:1024
    ds_read_b128 v[64:67], v2 offset:2048
    ds_read_b128 v[68:71], v2 offset:3072
    s_cmp_eq_u32 s97, 0
    s_cbranch_scc1 REC_LOOP
    s_branch REC_LOOP_S
REC_POLL_S:
    s_cmp_lg_u32 s14, 3
    s_cbranch_scc1 NOFLG_19
    s_add_u32 s64, s15, 2
    s_and_b32 s65, s64, 0x43
    s_cmp_lg_u32 s65, 0
    s_cbranch_scc1 NOFLG_19
    s_lshl_b32 s64, s64, 7
    s_add_u32 s64, s64, s69
    v_mov_b32 v29, 0
FSPIN_20:
    buffer_load_dwordx2 v[12:13], v29, s[4:7], s64 offen sc1
    s_add_u32 s68, s68, 1
    s_waitcnt vmcnt(0)
    v_and_b32 v12, v12, v13
    v_cmp_eq_u32 vcc, 0, v12
    s_cbranch_vccz FDONE_21
    s_cmp_gt_u32 s68, 262144
    s_cbranch_scc0 FSPIN_20
FDONE_21:
NOFLG_19:
    s_add_u32 s66, s17, s52
    v_add_u32 v10, s52, v1
    s_xor_b32 s16, s16, 1
    v_mov_b64 v[32:33], 0
    v_mov_b64 v[34:35], 0
    v_mov_b64 v[36:37], 0
    v_mov_b64 v[38:39], 0
    v_mov_b64 v[40:41], 0
    v_mov_b64 v[42:43], 0
    v_mov_b64 v[44:45], 0
    v_mov_b64 v[46:47], 0
    v_mov_b64 v[48:49], 0
    v_mov_b64 v[50:51], 0
    v_mov_b64 v[52:53], 0
    v_mov_b64 v[54:55], 0
    ds_read_b128 v[56:59], v2 offset:0
    ds_read_b128 v[60:63], v2 offset:1024
    ds_read_b128 v[64:67], v2 offset:2048
    ds_read_b128 v[68:71], v2 offset:3072
    s_barrier
    s_cmp_lt_u32 s15, 63
    s_cbranch_scc0 REC_END
    s_nop 14
    buffer_load_dwordx4 v[20:23], v1, s[4:7], s66 offen offset:0 sc1
    s_nop 7
    buffer_load_dwordx4 v[24:27], v1, s[4:7], s66 offen offset:0 sc1
    s_nop 7
    buffer_load_dwordx4 v[28:31], v1, s[4:7], s66 offen offset:0 sc1
IPOLL_23:
    s_waitcnt vmcnt(2)
    ds_write_b128 v10, v[20:23] offset:12800
    v_max3_u32 v11, v20, v21, v22
    v_max_u32 v11, v11, v23
    v_cmp_eq_u32 vcc, -1, v11
    s_cbranch_vccz IOK_22
    buffer_load_dwordx4 v[20:23], v1, s[4:7], s66 offen offset:0 sc1
    s_waitcnt vmcnt(2)
    ds_write_b128 v10, v[24:27] offset:12800
    v_max3_u32 v11, v24, v25, v26
    v_max_u32 v11, v11, v27
    v_cmp_eq_u32 vcc, -1, v11
    s_cbranch_vccz IOK_22
    buffer_load_dwordx4 v[24:27], v1, s[4:7], s66 offen offset:0 sc1
    s_waitcnt vmcnt(2)
    ds_write_b128 v10, v[28:31] offset:12800
    v_max3_u32 v11, v28, v29, v30
    v_max_u32 v11, v11, v31
    v_cmp_eq_u32 vcc, -1, v11
    s_add_u32 s68, s68, 1
    s_add_u32 s53, s53, 1
    s_cmp_gt_u32 s68, 262144
    s_cbranch_scc1 IOK_22
    s_cbranch_vccz IOK_22
    buffer_load_dwordx4 v[28:31], v1, s[4:7], s66 offen offset:0 sc1
    s_branch IPOLL_23
IOK_22:
    s_waitcnt lgkmcnt(0)
REC_LOOP_S:
    s_barrier
    ds_read_b128 v[12:15], v1 offset:12800
    ds_read_b128 v[16:19], v1 offset:13824
    buffer_load_dwordx4 v[20:23], v1, s[4:7], s17 offen offset:2048
    ds_read_b128 v[72:75], v2 offset:4096
    ds_read_b128 v[76:79], v2 offset:5120
    ds_read_b128 v[80:83], v2 offset:6144
    ds_read_b128 v[84:87], v2 offset:7168
    s_add_u32 s74, s17, 0x1000
    s_add_u32 s20, s20, 0x8000
    s_add_u32 s75, s20, 0x1000
    s_mov_b32 m0, 16128
    s_add_u32 s65, s20, s27
    s_waitcnt lgkmcnt(5)
    v_smfmac_f32_16x16x64_bf16 v[32:35], v[12:15], v[96:103], v6
    buffer_load_dwordx4 v[24:27], v1, s[4:7], s17 offen offset:3072
    v_smfmac_f32_16x16x64_bf16 v[36:39], v[12:15], v[104:111], v6
    v_smfmac_f32_16x16x64_bf16 v[40:43], v[12:15], v[56:63], v6
    buffer_load_dwordx4 v[28:31], v1, s[4:7], s74 offen offset:0
    ds_read_b128 v[56:59], v2 offset:8192
    ds_read_b128 v[60:63], v2 offset:9216
    v_smfmac_f32_16x16x64_bf16 v[44:47], v[12:15], v[64:71], v6
    ds_read_b128 v[64:67], v2 offset:10240
    ds_read_b128 v[68:71], v2 offset:11264
    s_waitcnt lgkmcnt(8)
    v_smfmac_f32_16x16x64_bf16 v[48:51], v[12:15], a[0:7], v6
    v_smfmac_f32_16x16x64_bf16 v[52:55], v[12:15], a[8:15], v6
    buffer_load_dwordx4 v[12:15], v1, s[4:7], s20 offen offset:0
    buffer_load_dword off, s[4:7], s65 lds
    v_smfmac_f32_16x16x64_bf16 v[32:35], v[16:19], v[112:119], v6
    v_smfmac_f32_16x16x64_bf16 v[36:39], v[16:19], v[120:127], v6
    s_waitcnt lgkmcnt(4)
    v_smfmac_f32_16x16x64_bf16 v[40:43], v[16:19], v[72:79], v6
    ds_read_b128 v[72:75], v2 offset:12288
    ds_read_b128 v[76:79], v2 offset:13312
    v_smfmac_f32_16x16x64_bf16 v[44:47], v[16:19], v[80:87], v6
    ds_read_b128 v[80:83], v2 offset:14336
    ds_read_b128 v[84:87], v2 offset:15360
    s_waitcnt vmcnt(4)
    v_cmp_eq_u32 vcc, -1, v23
    v_smfmac_f32_16x16x64_bf16 v[48:51], v[16:19], a[16:23], v6
    v_smfmac_f32_16x16x64_bf16 v[52:55], v[16:19], a[24:31], v6
    s_cbranch_vccnz RETRY_24
BACK_25:
    buffer_load_dwordx4 v[16:19], v1, s[4:7], s20 offen offset:1024
    v_smfmac_f32_16x16x64_bf16 v[32:35], v[20:23], v[128:135], v6
    v_smfmac_f32_16x16x64_bf16 v[36:39], v[20:23], v[136:143], v6
    s_waitcnt lgkmcnt(4)
    v_smfmac_f32_16x16x64_bf16 v[40:43], v[20:23], v[56:63], v6
    ds_read_b128 v[56:59], v2 offset:16384
    ds_read_b128 v[60:63], v2 offset:17408
    v_smfmac_f32_16x16x64_bf16 v[44:47], v[20:23], v[64:71], v6
    ds_read_b128 v[64:67], v2 offset:18432
    ds_read_b128 v[68:71], v2 offset:19456
    s_waitcnt vmcnt(4)
    v_cmp_eq_u32 vcc, -1, v27
    v_smfmac_f32_16x16x64_bf16 v[48:51], v[20:23], a[32:39], v6
    v_smfmac_f32_16x16x64_bf16 v[52:55], v[20:23], a[40:47], v6
    s_cbranch_vccnz RETRY_26
BACK_27:
    buffer_load_dwordx4 v[20:23], v1, s[4:7], s20 offen offset:2048
    v_smfmac_f32_16x16x64_bf16 v[32:35], v[24:27], v[144:151], v6
    v_smfmac_f32_16x16x64_bf16 v[36:39], v[24:27], v[152:159], v6
    s_waitcnt lgkmcnt(4)
    v_smfmac_f32_16x16x64_bf16 v[40:43], v[24:27], v[72:79], v6
    ds_read_b128 v[72:75], v2 offset:20480
    ds_read_b128 v[76:79], v2 offset:21504
    v_smfmac_f32_16x16x64_bf16 v[44:47], v[24:27], v[80:87], v6
    ds_read_b128 v[80:83], v2 offset:22528
    ds_read_b128 v[84:87], v2 offset:23552
    s_waitcnt vmcnt(4)
    v_cmp_eq_u32 vcc, -1, v31
    v_smfmac_f32_16x16x64_bf16 v[48:51], v[24:27], a[48:55], v6
    v_smfmac_f32_16x16x64_bf16 v[52:55], v[24:27], a[56:63], v6
    s_cbranch_vccnz RETRY_28
BACK_29:
    buffer_load_dwordx4 v[24:27], v1, s[4:7], s20 offen offset:3072
    v_smfmac_f32_16x16x64_bf16 v[32:35], v[28:31], v[160:167], v6
    v_smfmac_f32_16x16x64_bf16 v[36:39], v[28:31], v[168:175], v6
    s_waitcnt lgkmcnt(4)
    v_smfmac_f32_16x16x64_bf16 v[40:43], v[28:31], v[56:63], v6
    ds_read_b128 v[56:59], v2 offset:24576
    ds_read_b128 v[60:63], v2 offset:25600
    v_smfmac_f32_16x16x64_bf16 v[44:47], v[28:31], v[64:71], v6
    ds_read_b128 v[64:67], v2 offset:26624
    ds_read_b128 v[68:71], v2 offset:27648
    s_waitcnt vmcnt(4)
    v_cmp_eq_u32 vcc, -1, v15
    v_smfmac_f32_16x16x64_bf16 v[48:51], v[28:31], a[64:71], v6
    v_smfmac_f32_16x16x64_bf16 v[52:55], v[28:31], a[72:79], v6
    s_cbranch_vccnz RETRY_30
BACK_31:
    buffer_load_dwordx4 v[28:31], v1, s[4:7], s75 offen offset:0
    v_smfmac_f32_16x16x64_bf16 v[32:35], v[12:15], v[176:183], v6
    s_waitcnt vmcnt(3)
    v_cmp_eq_u32 vcc, -1, v19
    v_smfmac_f32_16x16x64_bf16 v[36:39], v[12:15], v[184:191], v6
    s_waitcnt lgkmcnt(4)
    v_smfmac_f32_16x16x64_bf16 v[40:43], v[12:15], v[72:79], v6
    ds_read_b128 v[72:75], v2 offset:28672
    ds_read_b128 v[76:79], v2 offset:29696
    v_smfmac_f32_16x16x64_bf16 v[44:47], v[12:15], v[80:87], v6
    ds_read_b128 v[80:83], v2 offset:30720
    ds_read_b128 v[84:87], v2 offset:31744
    buffer_load_dwordx4 v[88:91], v1, s[4:7], s29 offen offset:0
    s_cbranch_vccnz RETRY_32
BACK_33:
    v_smfmac_f32_16x16x64_bf16 v[32:35], v[16:19], v[192:199], v6
    s_waitcnt vmcnt(3)
    v_cmp_eq_u32 vcc, -1, v23
    v_smfmac_f32_16x16x64_bf16 v[36:39], v[16:19], v[200:207], v6
    s_waitcnt lgkmcnt(4)
    v_smfmac_f32_16x16x64_bf16 v[40:43], v[16:19], v[56:63], v6
    ds_read_b128 v[56:59], v2 offset:32768
    ds_read_b128 v[60:63], v2 offset:33792
    v_smfmac_f32_16x16x64_bf16 v[44:47], v[16:19], v[64:71], v6
    ds_read_b128 v[64:67], v2 offset:34816
    ds_read_b128 v[68:71], v2 offset:35840
    s_cbranch_vccnz RETRY_34
BACK_35:
    v_smfmac_f32_16x16x64_bf16 v[32:35], v[20:23], v[208:215], v6
    s_waitcnt vmcnt(2)
    v_cmp_eq_u32 vcc, -1, v27
    v_smfmac_f32_16x16x64_bf16 v[36:39], v[20:23], v[216:223], v6
    s_waitcnt lgkmcnt(4)
    v_smfmac_f32_16x16x64_bf16 v[40:43], v[20:23], v[72:79], v6
    ds_read_b128 v[72:75], v1 offset:0
    ds_read_b128 v[76:79], v1 offset:4096
    v_smfmac_f32_16x16x64_bf16 v[44:47], v[20:23], v[80:87], v6
    ds_read_b128 v[80:83], v1 offset:1024
    ds_read_b128 v[84:87], v1 offset:5120
    buffer_load_dwordx4 v[92:95], v1, s[4:7], s29 offen offset:1024
    s_cbranch_vccnz RETRY_36
BACK_37:
    v_smfmac_f32_16x16x64_bf16 v[32:35], v[24:27], v[224:231], v6
    s_waitcnt vmcnt(2)
    v_cmp_eq_u32 vcc, -1, v31
    v_smfmac_f32_16x16x64_bf16 v[36:39], v[24:27], v[232:239], v6
    s_waitcnt lgkmcnt(4)
    v_smfmac_f32_16x16x64_bf16 v[40:43], v[24:27], v[56:63], v6
    ds_read_b128 v[56:59], v1 offset:2048
    ds_read_b128 v[60:63], v1 offset:6144
    v_smfmac_f32_16x16x64_bf16 v[44:47], v[24:27], v[64:71], v6
    ds_read_b128 v[64:67], v1 offset:3072
    ds_read_b128 v[68:71], v1 offset:7168
    s_cbranch_vccnz RETRY_38
BACK_39:
    v_smfmac_f32_16x16x64_bf16 v[32:35], v[28:31], v[240:247], v6
    v_smfmac_f32_16x16x64_bf16 v[36:39], v[28:31], v[248:255], v6
    v_smfmac_f32_16x16x64_bf16 v[40:43], v[28:31], a[240:247], v6
    v_smfmac_f32_16x16x64_bf16 v[44:47], v[28:31], a[248:255], v6
    v_lshlrev_b32 v8, 2, v1
    s_add_u32 s65, s17, s19
    buffer_load_dword v8, s[4:7], s3 offen lds
    buffer_load_dword off, s[4:7], s65 sc1 lds
    buffer_store_dword v6, off, s[4:7], s22 sc1
    s_add_u32 s22, s22, 256
    v_permlane32_swap_b32 v32, v36
    v_permlane32_swap_b32 v33, v37
    v_permlane32_swap_b32 v34, v38
    v_permlane32_swap_b32 v35, v39
    v_pk_add_f32 v[32:33], v[32:33], v[36:37]
    v_pk_add_f32 v[34:35], v[34:35], v[38:39]
    v_cvt_pk_bf16_f32 v36, v32, v33
    v_cvt_pk_bf16_f32 v37, v34, v35
    ds_write_b64 v3, v[36:37] offset:0
    v_permlane32_swap_b32 v40, v44
    v_permlane32_swap_b32 v41, v45
    v_permlane32_swap_b32 v42, v46
    v_permlane32_swap_b32 v43, v47
    v_pk_add_f32 v[40:41], v[40:41], v[44:45]
    v_pk_add_f32 v[42:43], v[42:43], v[46:47]
    v_cvt_pk_bf16_f32 v44, v40, v41
    v_cvt_pk_bf16_f32 v45, v42, v43
    ds_write_b64 v3, v[44:45] offset:2304
    v_smfmac_f32_16x16x64_bf16 v[48:51], v[12:15], a[80:87], v6
    v_smfmac_f32_16x16x64_bf16 v[52:55], v[12:15], a[88:95], v6
    v_smfmac_f32_16x16x64_bf16 v[48:51], v[16:19], a[96:103], v6
    v_smfmac_f32_16x16x64_bf16 v[52:55], v[16:19], a[104:111], v6
    s_waitcnt lgkmcnt(0)
    s_barrier
    ds_read_b64_tr_b16 v[32:33], v4 offset:0
    ds_read_b64_tr_b16 v[34:35], v4 offset:128
    ds_read_b64_tr_b16 v[36:37], v4 offset:256
    ds_read_b64_tr_b16 v[38:39], v4 offset:384
    v_smfmac_f32_16x16x64_bf16 v[48:51], v[20:23], a[112:119], v6
    v_smfmac_f32_16x16x64_bf16 v[52:55], v[20:23], a[120:127], v6
    ds_read_b64_tr_b16 v[40:41], v4 offset:512
    ds_read_b64_tr_b16 v[42:43], v4 offset:640
    ds_read_b64_tr_b16 v[44:45], v4 offset:768
    ds_read_b64_tr_b16 v[46:47], v4 offset:896
    v_smfmac_f32_16x16x64_bf16 v[48:51], v[24:27], a[128:135], v6
    v_smfmac_f32_16x16x64_bf16 v[52:55], v[24:27], a[136:143], v6
    s_waitcnt lgkmcnt(4)
    v_mfma_f32_16x16x32_bf16 v[8:11], v[72:75], v[32:35], 0
    ds_read_b64_tr_b16 v[12:13], v4 offset:2304
    ds_read_b64_tr_b16 v[14:15], v4 offset:2432
    v_mfma_f32_16x16x32_bf16 v[8:11], v[80:83], v[36:39], v[8:11]
    ds_read_b64_tr_b16 v[16:17], v4 offset:2560
    ds_read_b64_tr_b16 v[18:19], v4 offset:2688
    s_waitcnt lgkmcnt(4)
    v_mfma_f32_16x16x32_bf16 v[8:11], v[56:59], v[40:43], v[8:11]
    ds_read_b64_tr_b16 v[56:57], v4 offset:2816
    ds_read_b64_tr_b16 v[58:59], v4 offset:2944
    v_mfma_f32_16x16x32_bf16 v[8:11], v[64:67], v[44:47], v[8:11]
    ds_read_b64_tr_b16 v[64:65], v4 offset:3072
    ds_read_b64_tr_b16 v[66:67], v4 offset:3200
    v_mfma_f32_16x16x32_bf16 v[72:75], v[76:79], v[32:35], 0
    v_mfma_f32_16x16x32_bf16 v[72:75], v[84:87], v[36:39], v[72:75]
    v_mfma_f32_16x16x32_bf16 v[72:75], v[60:63], v[40:43], v[72:75]
    v_mfma_f32_16x16x32_bf16 v[72:75], v[68:71], v[44:47], v[72:75]
    s_waitcnt lgkmcnt(4)
    v_mfma_f32_16x16x32_bf16 v[80:83], v[12:15], v[32:35], 0
    v_mfma_f32_16x16x32_bf16 v[80:83], v[16:19], v[36:39], v[80:83]
    s_waitcnt lgkmcnt(0)
    v_mfma_f32_16x16x32_bf16 v[80:83], v[56:59], v[40:43], v[80:83]
    v_mfma_f32_16x16x32_bf16 v[80:83], v[64:67], v[44:47], v[80:83]
    v_smfmac_f32_16x16x64_bf16 v[48:51], v[28:31], a[144:151], v6
    v_smfmac_f32_16x16x64_bf16 v[52:55], v[28:31], a[152:159], v6
    v_mov_b32 v24, 0x3f803f80
    v_mov_b32 v25, 0x3f803f80
    v_mov_b32 v26, 0x3f803f80
    v_mov_b32 v27, 0x3f803f80
    v_max3_f32 v20, v8, v9, v10
    v_max3_f32 v21, v11, v72, v73
    v_max3_f32 v20, v20, v21, v74
    v_max3_f32 v21, v80, v81, v82
    v_max3_f32 v20, v20, v75, v83
    v_max_f32 v20, v20, v21
    v_mov_b32 v21, v20
    v_cvt_pk_bf16_f32 v48, v48, v49
    v_cvt_pk_bf16_f32 v49, v50, v51
    v_permlane16_swap_b32 v20, v21
    v_max_f32 v20, v20, v21
    v_mov_b32 v21, v20
    v_cvt_pk_bf16_f32 v50, v52, v53
    v_cvt_pk_bf16_f32 v51, v54, v55
    v_permlane32_swap_b32 v20, v21
    v_max_f32 v20, v20, v21
    v_mul_f32 v22, s10, v20
    v_pk_fma_f32 v[8:9], v[8:9], s[10:11], v[22:23] op_sel_hi:[1,1,0] neg_lo:[0,0,1] neg_hi:[0,0,1]
    v_pk_fma_f32 v[10:11], v[10:11], s[10:11], v[22:23] op_sel_hi:[1,1,0] neg_lo:[0,0,1] neg_hi:[0,0,1]
    v_pk_fma_f32 v[72:73], v[72:73], s[10:11], v[22:23] op_sel_hi:[1,1,0] neg_lo:[0,0,1] neg_hi:[0,0,1]
    v_pk_fma_f32 v[74:75], v[74:75], s[10:11], v[22:23] op_sel_hi:[1,1,0] neg_lo:[0,0,1] neg_hi:[0,0,1]
    v_pk_fma_f32 v[80:81], v[80:81], s[10:11], v[22:23] op_sel_hi:[1,1,0] neg_lo:[0,0,1] neg_hi:[0,0,1]
    v_pk_fma_f32 v[82:83], v[82:83], s[10:11], v[22:23] op_sel_hi:[1,1,0] neg_lo:[0,0,1] neg_hi:[0,0,1]
    v_exp_f32 v8, v8
    v_exp_f32 v9, v9
    v_exp_f32 v10, v10
    v_exp_f32 v11, v11
    v_exp_f32 v72, v72
    v_exp_f32 v73, v73
    v_exp_f32 v74, v74
    v_exp_f32 v75, v75
    v_cvt_pk_bf16_f32 v32, v8, v9
    v_cvt_pk_bf16_f32 v33, v10, v11
    v_exp_f32 v80, v80
    v_exp_f32 v81, v81
    v_exp_f32 v82, v82
    v_exp_f32 v83, v83
    v_cvt_pk_bf16_f32 v34, v72, v73
    v_cvt_pk_bf16_f32 v35, v74, v75
    v_cndmask_b32 v12, 0, v24, s[34:35]
    v_cndmask_b32 v13, 0, v24, s[34:35]
    s_waitcnt vmcnt(3)
    v_mfma_f32_16x16x32_bf16 v[8:11], v[24:27], v[32:35], 0
    v_cvt_pk_bf16_f32 v36, v80, v81
    v_mfma_f32_16x16x32_bf16 v[40:43], v[88:91], v[32:35], 0
    v_cvt_pk_bf16_f32 v37, v82, v83
    v_mfma_f32_16x16x32_bf16 v[44:47], v[92:95], v[32:35], 0
    v_mfma_f32_16x16x16_bf16 v[8:11], v[12:13], v[36:37], v[8:11]
    v_mov_b64 v[72:73], 0
    v_mfma_f32_16x16x16_bf16 v[40:43], v[48:49], v[36:37], v[40:43]
    v_mov_b64 v[74:75], 0
    v_mfma_f32_16x16x16_bf16 v[44:47], v[50:51], v[36:37], v[44:47]
    v_mov_b64 v[76:77], 0
    v_mov_b64 v[78:79], 0
    v_mov_b64 v[80:81], 0
    v_mov_b64 v[82:83], 0
    v_rcp_f32 v22, v8
    s_nop 2
    v_cndmask_b32 v40, v44, v40, s[32:33]
    v_cndmask_b32 v41, v45, v41, s[32:33]
    v_cndmask_b32 v42, v46, v42, s[32:33]
    v_cndmask_b32 v43, v47, v43, s[32:33]
    v_pk_mul_f32 v[40:41], v[40:41], v[22:23] op_sel_hi:[1,0]
    v_pk_mul_f32 v[42:43], v[42:43], v[22:23] op_sel_hi:[1,0]
    v_cvt_pk_bf16_f32 v44, v40, v41
    v_cvt_pk_bf16_f32 v45, v42, v43
    ds_write_b64 v5, v[44:45]
    s_mov_b32 m0, s73
    s_add_u32 s28, s28, 0x80000
    buffer_load_dwordx4 v1, s[4:7], s28 offen lds
    buffer_load_dwordx4 v1, s[4:7], s28 offen offset:1024 lds
    v_and_b32 v9, 0x70, v1
    v_bfe_u32 v29, v1, 8, 1
    v_lshl_add_u32 v9, v29, 3, v9
    v_bfe_u32 v29, v1, 9, 1
    v_lshl_add_u32 v9, v29, 2, v9
    v_mov_b32 v29, 0x40000000
    s_waitcnt lgkmcnt(0)
    s_barrier
    ds_read_b128 v[12:15], v0 offset:0
    ds_read_b128 v[16:19], v0 offset:64
    ds_read_b128 v[20:23], v0 offset:128
    ds_read_b128 v[24:27], v0 offset:192
    v_cndmask_b32 v9, v29, v9, s[32:33]
    v_and_b32 v29, 16, v1
    v_lshlrev_b32 v29, v29, s38
    v_cndmask_b32 v88, 0, v29, s[44:45]
    v_cndmask_b32 v89, 0, v29, s[46:47]
    v_cndmask_b32 v90, 0, v29, s[48:49]
    v_cndmask_b32 v91, 0, v29, s[50:51]
    s_waitcnt lgkmcnt(3)
    v_smfmac_f32_16x16x64_bf16 v[72:75], v[12:15], a[160:167], v6
    s_waitcnt lgkmcnt(2)
    v_smfmac_f32_16x16x64_bf16 v[72:75], v[16:19], a[168:175], v6
    s_waitcnt lgkmcnt(1)
    v_smfmac_f32_16x16x64_bf16 v[72:75], v[20:23], a[176:183], v6
    s_waitcnt lgkmcnt(0)
    v_smfmac_f32_16x16x64_bf16 v[72:75], v[24:27], a[184:191], v6
    v_smfmac_f32_16x16x64_bf16 v[76:79], v[12:15], a[192:199], v6
    v_smfmac_f32_16x16x64_bf16 v[76:79], v[16:19], a[200:207], v6
    v_cvt_pk_bf16_f32 v72, v72, v73
    v_smfmac_f32_16x16x64_bf16 v[76:79], v[20:23], a[208:215], v6
    v_cvt_pk_bf16_f32 v73, v74, v75
    v_smfmac_f32_16x16x64_bf16 v[76:79], v[24:27], a[216:223], v6
    v_and_or_b32 v72, v72, -2, s16
    v_mfma_f32_16x16x32_bf16 v[80:83], v[12:15], a[224:227], 0
    buffer_store_dwordx2 v[72:73], v7, s[4:7], s23 offen sc1
    v_mfma_f32_16x16x32_bf16 v[80:83], v[16:19], a[228:231], v[80:83]
    v_mfma_f32_16x16x32_bf16 v[80:83], v[20:23], a[232:235], v[80:83]
    v_cvt_pk_bf16_f32 v76, v76, v77
    v_cvt_pk_bf16_f32 v77, v78, v79
    v_mfma_f32_16x16x32_bf16 v[80:83], v[24:27], a[236:239], v[80:83]
    v_and_or_b32 v76, v76, -2, s16
    buffer_store_dwordx2 v[76:77], v7, s[4:7], s25 offen sc1
    s_add_u32 s17, s17, 0x4000
    s_add_u32 s3, s3, 0x80000
    s_add_u32 s29, s29, 0x80000
    s_add_u32 s18, s18, 0x4000
    s_add_u32 s21, s21, 0x8000
    s_add_u32 s15, s15, 1
    s_nop 0
    v_cvt_pk_bf16_f32 v80, v80, v81
    v_cvt_pk_bf16_f32 v81, v82, v83
    v_and_or_b32 v80, v80, -2, s16
    s_mov_b64 exec, s[34:35]
    buffer_store_dwordx2 v[80:81], v7, s[4:7], s26 offen sc1
    s_mov_b64 exec, -1
    s_cmp_lg_u32 s42, 0
    s_cbranch_scc1 OWN_41
    s_cmp_lt_u32 s14, 2
    s_cbranch_scc1 IDLE_40
    s_branch REC_POLL_S
OWN_41:
    s_nop 15
    s_nop 13
    buffer_load_dwordx4 v[12:15], v1, s[4:7], s24 offen offset:0 sc1
    buffer_load_dwordx4 v[16:19], v1, s[4:7], s24 offen offset:1024 sc1
    buffer_load_dwordx4 v[20:23], v1, s[4:7], s24 offen offset:2048 sc1
    buffer_load_dwordx4 v[24:27], v1, s[4:7], s24 offen offset:3072 sc1
    ds_read_b128 v[56:59], v2 offset:0
    ds_read_b128 v[60:63], v2 offset:1024
    ds_read_b128 v[64:67], v2 offset:2048
    ds_read_b128 v[68:71], v2 offset:3072
    v_mov_b64 v[32:33], 0
    v_mov_b64 v[34:35], 0
    v_mov_b64 v[36:37], 0
    v_mov_b64 v[38:39], 0
    v_mov_b64 v[40:41], 0
    v_mov_b64 v[42:43], 0
    v_mov_b64 v[44:45], 0
    v_mov_b64 v[46:47], 0
    buffer_load_dwordx4 v[72:75], v1, s[4:7], s24 offen offset:0 sc1
    buffer_load_dwordx4 v[76:79], v1, s[4:7], s24 offen offset:1024 sc1
    buffer_load_dwordx4 v[80:83], v1, s[4:7], s24 offen offset:2048 sc1
    buffer_load_dwordx4 v[84:87], v1, s[4:7], s24 offen offset:3072 sc1
    v_mov_b64 v[48:49], 0
    v_mov_b64 v[50:51], 0
    v_mov_b64 v[52:53], 0
    v_mov_b64 v[54:55], 0
OPOLL_43:
    s_waitcnt vmcnt(7)
    v_mfma_f32_16x16x32_bf16 v[92:95], v[12:15], v[88:91], 0
    v_bitop3_b32 v10, v12, v14, s16 bitop3:0x7e
    s_waitcnt vmcnt(6)
    v_mfma_f32_16x16x32_bf16 v[92:95], v[16:19], v[88:91], v[92:95]
    v_bitop3_b32 v11, v16, v18, s16 bitop3:0x7e
    s_waitcnt vmcnt(5)
    v_mfma_f32_16x16x32_bf16 v[92:95], v[20:23], v[88:91], v[92:95]
    v_bitop3_b32 v30, v20, v22, s16 bitop3:0x7e
    s_waitcnt vmcnt(4)
    v_mfma_f32_16x16x32_bf16 v[92:95], v[24:27], v[88:91], v[92:95]
    v_bitop3_b32 v31, v24, v26, s16 bitop3:0x7e
    v_or3_b32 v10, v10, v11, v30
    v_bitop3_b32 v10, v10, v31, 1 bitop3:0xa8
    v_cmp_ne_u32 vcc, 0, v10
    s_nop 3
    s_cbranch_vccz ODONE_42
    s_add_u32 s40, s40, 1
    buffer_load_dwordx4 v[12:15], v1, s[4:7], s24 offen offset:0 sc1
    buffer_load_dwordx4 v[16:19], v1, s[4:7], s24 offen offset:1024 sc1
    buffer_load_dwordx4 v[20:23], v1, s[4:7], s24 offen offset:2048 sc1
    buffer_load_dwordx4 v[24:27], v1, s[4:7], s24 offen offset:3072 sc1
    s_waitcnt vmcnt(7)
    v_mfma_f32_16x16x32_bf16 v[92:95], v[72:75], v[88:91], 0
    v_bitop3_b32 v10, v72, v74, s16 bitop3:0x7e
    s_waitcnt vmcnt(6)
    v_mfma_f32_16x16x32_bf16 v[92:95], v[76:79], v[88:91], v[92:95]
    v_bitop3_b32 v11, v76, v78, s16 bitop3:0x7e
    s_waitcnt vmcnt(5)
    v_mfma_f32_16x16x32_bf16 v[92:95], v[80:83], v[88:91], v[92:95]
    v_bitop3_b32 v30, v80, v82, s16 bitop3:0x7e
    s_waitcnt vmcnt(4)
    v_mfma_f32_16x16x32_bf16 v[92:95], v[84:87], v[88:91], v[92:95]
    v_bitop3_b32 v31, v84, v86, s16 bitop3:0x7e
    v_or3_b32 v10, v10, v11, v30
    v_bitop3_b32 v10, v10, v31, 1 bitop3:0xa8
    v_cmp_ne_u32 vcc, 0, v10
    s_add_u32 s68, s68, 1
    s_cmp_gt_u32 s68, 262144
    s_cbranch_scc1 ODONE_42
    s_nop 0
    s_cbranch_vccz ODONE_42
    s_add_u32 s40, s40, 1
    buffer_load_dwordx4 v[72:75], v1, s[4:7], s24 offen offset:0 sc1
    buffer_load_dwordx4 v[76:79], v1, s[4:7], s24 offen offset:1024 sc1
    buffer_load_dwordx4 v[80:83], v1, s[4:7], s24 offen offset:2048 sc1
    buffer_load_dwordx4 v[84:87], v1, s[4:7], s24 offen offset:3072 sc1
    s_branch OPOLL_43
ODONE_42:
    v_permlane32_swap_b32 v92, v94
    v_permlane32_swap_b32 v93, v95
    v_add_f32 v92, v92, v94
    v_add_f32 v93, v93, v95
    v_cvt_pk_bf16_f32 v8, v92, v93
    buffer_store_dword v8, v9, s[4:7], s18 offen sc1
    s_barrier
    s_nop 15
    s_nop 15
    s_nop 12
    buffer_store_dword v8, v9, s[4:7], s21 offen sc1
    s_cmp_lt_u32 s15, 61
    s_cbranch_scc1 EFLG_44
    buffer_store_dword v6, off, s[4:7], s22 sc1
EFLG_44:
    s_xor_b32 s16, s16, 1
    s_waitcnt vmcnt(2) lgkmcnt(0)
    s_cmp_lt_u32 s15, 63
    s_cbranch_scc1 REC_LOOP_S
    s_branch REC_END
IDLE_40:
    s_barrier
    v_mov_b64 v[32:33], 0
    v_mov_b64 v[34:35], 0
    v_mov_b64 v[36:37], 0
    v_mov_b64 v[38:39], 0
    v_mov_b64 v[40:41], 0
    v_mov_b64 v[42:43], 0
    v_mov_b64 v[44:45], 0
    v_mov_b64 v[46:47], 0
    v_mov_b64 v[48:49], 0
    v_mov_b64 v[50:51], 0
    v_mov_b64 v[52:53], 0
    v_mov_b64 v[54:55], 0
    ds_read_b128 v[56:59], v2 offset:0
    ds_read_b128 v[60:63], v2 offset:1024
    ds_read_b128 v[64:67], v2 offset:2048
    ds_read_b128 v[68:71], v2 offset:3072
    s_xor_b32 s16, s16, 1
    s_waitcnt vmcnt(0)
    s_cmp_lt_u32 s15, 63
    s_cbranch_scc1 REC_LOOP_S
    s_branch REC_END
REC_TAIL_S:
RETRY_24:
SPIN_45:
    buffer_load_dwordx4 v[20:23], v1, s[4:7], s17 offen offset:2048 sc1
    buffer_load_dwordx4 v[24:27], v1, s[4:7], s17 offen offset:3072 sc1
    buffer_load_dwordx4 v[28:31], v1, s[4:7], s74 offen offset:0 sc1
    s_add_u32 s68, s68, 1
    s_add_u32 s40, s40, 1024
    s_cmp_gt_u32 s68, 262144
    s_waitcnt vmcnt(0)
    s_cbranch_scc1 BACK_25
    v_cmp_eq_u32 vcc, -1, v23
    s_cbranch_vccnz SPIN_45
    s_branch BACK_25
RETRY_26:
SPIN_46:
    buffer_load_dwordx4 v[24:27], v1, s[4:7], s17 offen offset:3072 sc1
    buffer_load_dwordx4 v[28:31], v1, s[4:7], s74 offen offset:0 sc1
    s_add_u32 s68, s68, 1
    s_add_u32 s40, s40, 1024
    s_cmp_gt_u32 s68, 262144
    s_waitcnt vmcnt(0)
    s_cbranch_scc1 BACK_27
    v_cmp_eq_u32 vcc, -1, v27
    s_cbranch_vccnz SPIN_46
    s_branch BACK_27
RETRY_28:
SPIN_47:
    buffer_load_dwordx4 v[28:31], v1, s[4:7], s74 offen offset:0 sc1
    s_add_u32 s68, s68, 1
    s_add_u32 s40, s40, 1024
    s_cmp_gt_u32 s68, 262144
    s_waitcnt vmcnt(0)
    s_cbranch_scc1 BACK_29
    v_cmp_eq_u32 vcc, -1, v31
    s_cbranch_vccnz SPIN_47
    s_branch BACK_29
RETRY_30:
SPIN_48:
    buffer_load_dwordx4 v[12:15], v1, s[4:7], s20 offen offset:0 sc1
    buffer_load_dwordx4 v[16:19], v1, s[4:7], s20 offen offset:1024 sc1
    buffer_load_dwordx4 v[20:23], v1, s[4:7], s20 offen offset:2048 sc1
    buffer_load_dwordx4 v[24:27], v1, s[4:7], s20 offen offset:3072 sc1
    s_add_u32 s68, s68, 1
    s_add_u32 s40, s40, 1048576
    s_cmp_gt_u32 s68, 262144
    s_waitcnt vmcnt(0)
    s_cbranch_scc1 BACK_31
    v_cmp_eq_u32 vcc, -1, v15
    s_cbranch_vccnz SPIN_48
    s_branch BACK_31
RETRY_32:
SPIN_49:
    buffer_load_dwordx4 v[16:19], v1, s[4:7], s20 offen offset:1024 sc1
    buffer_load_dwordx4 v[20:23], v1, s[4:7], s20 offen offset:2048 sc1
    buffer_load_dwordx4 v[24:27], v1, s[4:7], s20 offen offset:3072 sc1
    buffer_load_dwordx4 v[28:31], v1, s[4:7], s75 offen offset:0 sc1
    s_add_u32 s68, s68, 1
    s_add_u32 s40, s40, 1048576
    s_cmp_gt_u32 s68, 262144
    s_waitcnt vmcnt(0)
    s_cbranch_scc1 BACK_33
    v_cmp_eq_u32 vcc, -1, v19
    s_cbranch_vccnz SPIN_49
    s_branch BACK_33
RETRY_34:
SPIN_50:
    buffer_load_dwordx4 v[20:23], v1, s[4:7], s20 offen offset:2048 sc1
    buffer_load_dwordx4 v[24:27], v1, s[4:7], s20 offen offset:3072 sc1
    buffer_load_dwordx4 v[28:31], v1, s[4:7], s75 offen offset:0 sc1
    s_add_u32 s68, s68, 1
    s_add_u32 s40, s40, 1048576
    s_cmp_gt_u32 s68, 262144
    s_waitcnt vmcnt(0)
    s_cbranch_scc1 BACK_35
    v_cmp_eq_u32 vcc, -1, v23
    s_cbranch_vccnz SPIN_50
    s_branch BACK_35
RETRY_36:
SPIN_51:
    buffer_load_dwordx4 v[24:27], v1, s[4:7], s20 offen offset:3072 sc1
    buffer_load_dwordx4 v[28:31], v1, s[4:7], s75 offen offset:0 sc1
    s_add_u32 s68, s68, 1
    s_add_u32 s40, s40, 1048576
    s_cmp_gt_u32 s68, 262144
    s_waitcnt vmcnt(0)
    s_cbranch_scc1 BACK_37
    v_cmp_eq_u32 vcc, -1, v27
    s_cbranch_vccnz SPIN_51
    s_branch BACK_37
RETRY_38:
SPIN_52:
    buffer_load_dwordx4 v[28:31], v1, s[4:7], s75 offen offset:0 sc1
    s_add_u32 s68, s68, 1
    s_add_u32 s40, s40, 1048576
    s_cmp_gt_u32 s68, 262144
    s_waitcnt vmcnt(0)
    s_cbranch_scc1 BACK_39
    v_cmp_eq_u32 vcc, -1, v31
    s_cbranch_vccnz SPIN_52
    s_branch BACK_39
REC_POLL:
    s_cmp_lg_u32 s14, 3
    s_cbranch_scc1 NOFLG_53
    s_add_u32 s64, s15, 2
    s_and_b32 s65, s64, 0x43
    s_cmp_lg_u32 s65, 0
    s_cbranch_scc1 NOFLG_53
    s_lshl_b32 s64, s64, 7
    s_add_u32 s64, s64, s69
    v_mov_b32 v29, 0
FSPIN_54:
    buffer_load_dwordx2 v[12:13], v29, s[4:7], s64 offen sc1
    s_add_u32 s68, s68, 1
    s_waitcnt vmcnt(0)
    v_and_b32 v12, v12, v13
    v_cmp_eq_u32 vcc, 0, v12
    s_cbranch_vccz FDONE_55
    s_cmp_gt_u32 s68, 262144
    s_cbranch_scc0 FSPIN_54
FDONE_55:
NOFLG_53:
    s_add_u32 s66, s17, s52
    v_add_u32 v10, s52, v1
    s_xor_b32 s16, s16, 1
    v_mov_b64 v[32:33], 0
    v_mov_b64 v[34:35], 0
    v_mov_b64 v[36:37], 0
    v_mov_b64 v[38:39], 0
    v_mov_b64 v[40:41], 0
    v_mov_b64 v[42:43], 0
    v_mov_b64 v[44:45], 0
    v_mov_b64 v[46:47], 0
    v_mov_b64 v[48:49], 0
    v_mov_b64 v[50:51], 0
    v_mov_b64 v[52:53], 0
    v_mov_b64 v[54:55], 0
    ds_read_b128 v[56:59], v2 offset:0
    ds_read_b128 v[60:63], v2 offset:1024
    ds_read_b128 v[64:67], v2 offset:2048
    ds_read_b128 v[68:71], v2 offset:3072
    s_barrier
    s_cmp_lt_u32 s15, 63
    s_cbranch_scc0 REC_END
    s_nop 14
    buffer_load_dwordx4 v[20:23], v1, s[4:7], s66 offen offset:0 sc1
    s_nop 7
    buffer_load_dwordx4 v[24:27], v1, s[4:7], s66 offen offset:0 sc1
    s_nop 7
    buffer_load_dwordx4 v[28:31], v1, s[4:7], s66 offen offset:0 sc1
IPOLL_57:
    s_waitcnt vmcnt(2)
    ds_write_b128 v10, v[20:23] offset:12800
    v_max3_u32 v11, v20, v21, v22
    v_max_u32 v11, v11, v23
    v_cmp_eq_u32 vcc, -1, v11
    s_cbranch_vccz IOK_56
    buffer_load_dwordx4 v[20:23], v1, s[4:7], s66 offen offset:0 sc1
    s_waitcnt vmcnt(2)
    ds_write_b128 v10, v[24:27] offset:12800
    v_max3_u32 v11, v24, v25, v26
    v_max_u32 v11, v11, v27
    v_cmp_eq_u32 vcc, -1, v11
    s_cbranch_vccz IOK_56
    buffer_load_dwordx4 v[24:27], v1, s[4:7], s66 offen offset:0 sc1
    s_waitcnt vmcnt(2)
    ds_write_b128 v10, v[28:31] offset:12800
    v_max3_u32 v11, v28, v29, v30
    v_max_u32 v11, v11, v31
    v_cmp_eq_u32 vcc, -1, v11
    s_add_u32 s68, s68, 1
    s_add_u32 s53, s53, 1
    s_cmp_gt_u32 s68, 262144
    s_cbranch_scc1 IOK_56
    s_cbranch_vccz IOK_56
    buffer_load_dwordx4 v[28:31], v1, s[4:7], s66 offen offset:0 sc1
    s_branch IPOLL_57
IOK_56:
    s_waitcnt lgkmcnt(0)
REC_LOOP:
    s_barrier
    ds_read_b128 v[12:15], v1 offset:12800
    ds_read_b128 v[16:19], v1 offset:13824
    buffer_load_dwordx4 v[20:23], v1, s[4:7], s17 offen offset:2048
    ds_read_b128 v[72:75], v2 offset:4096
    ds_read_b128 v[76:79], v2 offset:5120
    ds_read_b128 v[80:83], v2 offset:6144
    ds_read_b128 v[84:87], v2 offset:7168
    s_add_u32 s74, s17, 0x1000
    s_add_u32 s20, s20, 0x8000
    s_add_u32 s75, s20, 0x1000
    s_mov_b32 m0, 16128
    s_add_u32 s65, s20, s27
    s_waitcnt lgkmcnt(5)
    v_smfmac_f32_16x16x64_bf16 v[32:35], v[12:15], v[96:103], v6
    buffer_load_dwordx4 v[24:27], v1, s[4:7], s17 offen offset:3072
    v_smfmac_f32_16x16x64_bf16 v[36:39], v[12:15], v[104:111], v6
    v_smfmac_f32_16x16x64_bf16 v[40:43], v[12:15], v[56:63], v6
    buffer_load_dwordx4 v[28:31], v1, s[4:7], s74 offen offset:0
    ds_read_b128 v[56:59], v2 offset:8192
    ds_read_b128 v[60:63], v2 offset:9216
    v_smfmac_f32_16x16x64_bf16 v[44:47], v[12:15], v[64:71], v6
    ds_read_b128 v[64:67], v2 offset:10240
    ds_read_b128 v[68:71], v2 offset:11264
    s_waitcnt lgkmcnt(8)
    v_smfmac_f32_16x16x64_bf16 v[48:51], v[12:15], a[0:7], v6
    v_smfmac_f32_16x16x64_bf16 v[52:55], v[12:15], a[8:15], v6
    buffer_load_dwordx4 v[12:15], v1, s[4:7], s20 offen offset:0
    buffer_load_dword off, s[4:7], s65 lds
    v_smfmac_f32_16x16x64_bf16 v[32:35], v[16:19], v[112:119], v6
    v_smfmac_f32_16x16x64_bf16 v[36:39], v[16:19], v[120:127], v6
    s_waitcnt lgkmcnt(4)
    v_smfmac_f32_16x16x64_bf16 v[40:43], v[16:19], v[72:79], v6
    ds_read_b128 v[72:75], v2 offset:12288
    ds_read_b128 v[76:79], v2 offset:13312
    v_smfmac_f32_16x16x64_bf16 v[44:47], v[16:19], v[80:87], v6
    ds_read_b128 v[80:83], v2 offset:14336
    ds_read_b128 v[84:87], v2 offset:15360
    s_waitcnt vmcnt(4)
    v_cmp_eq_u32 vcc, -1, v23
    v_smfmac_f32_16x16x64_bf16 v[48:51], v[16:19], a[16:23], v6
    v_smfmac_f32_16x16x64_bf16 v[52:55], v[16:19], a[24:31], v6
    s_cbranch_vccnz RETRY_58
BACK_59:
    buffer_load_dwordx4 v[16:19], v1, s[4:7], s20 offen offset:1024
    v_smfmac_f32_16x16x64_bf16 v[32:35], v[20:23], v[128:135], v6
    v_smfmac_f32_16x16x64_bf16 v[36:39], v[20:23], v[136:143], v6
    s_waitcnt lgkmcnt(4)
    v_smfmac_f32_16x16x64_bf16 v[40:43], v[20:23], v[56:63], v6
    ds_read_b128 v[56:59], v2 offset:16384
    ds_read_b128 v[60:63], v2 offset:17408
    v_smfmac_f32_16x16x64_bf16 v[44:47], v[20:23], v[64:71], v6
    ds_read_b128 v[64:67], v2 offset:18432
    ds_read_b128 v[68:71], v2 offset:19456
    s_waitcnt vmcnt(4)
    v_cmp_eq_u32 vcc, -1, v27
    v_smfmac_f32_16x16x64_bf16 v[48:51], v[20:23], a[32:39], v6
    v_smfmac_f32_16x16x64_bf16 v[52:55], v[20:23], a[40:47], v6
    s_cbranch_vccnz RETRY_60
BACK_61:
    buffer_load_dwordx4 v[20:23], v1, s[4:7], s20 offen offset:2048
    v_smfmac_f32_16x16x64_bf16 v[32:35], v[24:27], v[144:151], v6
    v_smfmac_f32_16x16x64_bf16 v[36:39], v[24:27], v[152:159], v6
    s_waitcnt lgkmcnt(4)
    v_smfmac_f32_16x16x64_bf16 v[40:43], v[24:27], v[72:79], v6
    ds_read_b128 v[72:75], v2 offset:20480
    ds_read_b128 v[76:79], v2 offset:21504
    v_smfmac_f32_16x16x64_bf16 v[44:47], v[24:27], v[80:87], v6
    ds_read_b128 v[80:83], v2 offset:22528
    ds_read_b128 v[84:87], v2 offset:23552
    s_waitcnt vmcnt(4)
    v_cmp_eq_u32 vcc, -1, v31
    v_smfmac_f32_16x16x64_bf16 v[48:51], v[24:27], a[48:55], v6
    v_smfmac_f32_16x16x64_bf16 v[52:55], v[24:27], a[56:63], v6
    s_cbranch_vccnz RETRY_62
BACK_63:
    buffer_load_dwordx4 v[24:27], v1, s[4:7], s20 offen offset:3072
    v_smfmac_f32_16x16x64_bf16 v[32:35], v[28:31], v[160:167], v6
    v_smfmac_f32_16x16x64_bf16 v[36:39], v[28:31], v[168:175], v6
    s_waitcnt lgkmcnt(4)
    v_smfmac_f32_16x16x64_bf16 v[40:43], v[28:31], v[56:63], v6
    ds_read_b128 v[56:59], v2 offset:24576
    ds_read_b128 v[60:63], v2 offset:25600
    v_smfmac_f32_16x16x64_bf16 v[44:47], v[28:31], v[64:71], v6
    ds_read_b128 v[64:67], v2 offset:26624
    ds_read_b128 v[68:71], v2 offset:27648
    s_waitcnt vmcnt(4)
    v_cmp_eq_u32 vcc, -1, v15
    v_smfmac_f32_16x16x64_bf16 v[48:51], v[28:31], a[64:71], v6
    v_smfmac_f32_16x16x64_bf16 v[52:55], v[28:31], a[72:79], v6
    s_cbranch_vccnz RETRY_64
BACK_65:
    buffer_load_dwordx4 v[28:31], v1, s[4:7], s75 offen offset:0
    v_smfmac_f32_16x16x64_bf16 v[32:35], v[12:15], v[176:183], v6
    s_waitcnt vmcnt(3)
    v_cmp_eq_u32 vcc, -1, v19
    v_smfmac_f32_16x16x64_bf16 v[36:39], v[12:15], v[184:191], v6
    s_waitcnt lgkmcnt(4)
    v_smfmac_f32_16x16x64_bf16 v[40:43], v[12:15], v[72:79], v6
    ds_read_b128 v[72:75], v2 offset:28672
    ds_read_b128 v[76:79], v2 offset:29696
    v_smfmac_f32_16x16x64_bf16 v[44:47], v[12:15], v[80:87], v6
    ds_read_b128 v[80:83], v2 offset:30720
    ds_read_b128 v[84:87], v2 offset:31744
    buffer_load_dwordx4 v[88:91], v1, s[4:7], s29 offen offset:0
    s_cbranch_vccnz RETRY_66
BACK_67:
    v_smfmac_f32_16x16x64_bf16 v[32:35], v[16:19], v[192:199], v6
    s_waitcnt vmcnt(3)
    v_cmp_eq_u32 vcc, -1, v23
    v_smfmac_f32_16x16x64_bf16 v[36:39], v[16:19], v[200:207], v6
    s_waitcnt lgkmcnt(4)
    v_smfmac_f32_16x16x64_bf16 v[40:43], v[16:19], v[56:63], v6
    ds_read_b128 v[56:59], v2 offset:32768
    ds_read_b128 v[60:63], v2 offset:33792
    v_smfmac_f32_16x16x64_bf16 v[44:47], v[16:19], v[64:71], v6
    ds_read_b128 v[64:67], v2 offset:34816
    ds_read_b128 v[68:71], v2 offset:35840
    s_cbranch_vccnz RETRY_68
BACK_69:
    v_smfmac_f32_16x16x64_bf16 v[32:35], v[20:23], v[208:215], v6
    s_waitcnt vmcnt(2)
    v_cmp_eq_u32 vcc, -1, v27
    v_smfmac_f32_16x16x64_bf16 v[36:39], v[20:23], v[216:223], v6
    s_waitcnt lgkmcnt(4)
    v_smfmac_f32_16x16x64_bf16 v[40:43], v[20:23], v[72:79], v6
    ds_read_b128 v[72:75], v1 offset:0
    ds_read_b128 v[76:79], v1 offset:4096
    v_smfmac_f32_16x16x64_bf16 v[44:47], v[20:23], v[80:87], v6
    ds_read_b128 v[80:83], v1 offset:1024
    ds_read_b128 v[84:87], v1 offset:5120
    buffer_load_dwordx4 v[92:95], v1, s[4:7], s29 offen offset:1024
    s_cbranch_vccnz RETRY_70
BACK_71:
    v_smfmac_f32_16x16x64_bf16 v[32:35], v[24:27], v[224:231], v6
    s_waitcnt vmcnt(2)
    v_cmp_eq_u32 vcc, -1, v31
    v_smfmac_f32_16x16x64_bf16 v[36:39], v[24:27], v[232:239], v6
    s_waitcnt lgkmcnt(4)
    v_smfmac_f32_16x16x64_bf16 v[40:43], v[24:27], v[56:63], v6
    ds_read_b128 v[56:59], v1 offset:2048
    ds_read_b128 v[60:63], v1 offset:6144
    v_smfmac_f32_16x16x64_bf16 v[44:47], v[24:27], v[64:71], v6
    ds_read_b128 v[64:67], v1 offset:3072
    ds_read_b128 v[68:71], v1 offset:7168
    s_cbranch_vccnz RETRY_72
BACK_73:
    v_smfmac_f32_16x16x64_bf16 v[32:35], v[28:31], v[240:247], v6
    v_smfmac_f32_16x16x64_bf16 v[36:39], v[28:31], v[248:255], v6
    v_smfmac_f32_16x16x64_bf16 v[40:43], v[28:31], a[240:247], v6
    v_smfmac_f32_16x16x64_bf16 v[44:47], v[28:31], a[248:255], v6
    v_lshlrev_b32 v8, 2, v1
    s_add_u32 s65, s17, s19
    buffer_load_dword v8, s[4:7], s3 offen lds
    buffer_load_dword off, s[4:7], s65 sc1 lds
    buffer_store_dword v6, off, s[4:7], s22 sc1
    s_add_u32 s22, s22, 256
    v_permlane32_swap_b32 v32, v36
    v_permlane32_swap_b32 v33, v37
    v_permlane32_swap_b32 v34, v38
    v_permlane32_swap_b32 v35, v39
    v_pk_add_f32 v[32:33], v[32:33], v[36:37]
    v_pk_add_f32 v[34:35], v[34:35], v[38:39]
    v_cvt_pk_bf16_f32 v36, v32, v33
    v_cvt_pk_bf16_f32 v37, v34, v35
    ds_write_b64 v3, v[36:37] offset:0
    v_permlane32_swap_b32 v40, v44
    v_permlane32_swap_b32 v41, v45
    v_permlane32_swap_b32 v42, v46
    v_permlane32_swap_b32 v43, v47
    v_pk_add_f32 v[40:41], v[40:41], v[44:45]
    v_pk_add_f32 v[42:43], v[42:43], v[46:47]
    v_cvt_pk_bf16_f32 v44, v40, v41
    v_cvt_pk_bf16_f32 v45, v42, v43
    ds_write_b64 v3, v[44:45] offset:2304
    v_smfmac_f32_16x16x64_bf16 v[48:51], v[12:15], a[80:87], v6
    v_smfmac_f32_16x16x64_bf16 v[52:55], v[12:15], a[88:95], v6
    v_smfmac_f32_16x16x64_bf16 v[48:51], v[16:19], a[96:103], v6
    v_smfmac_f32_16x16x64_bf16 v[52:55], v[16:19], a[104:111], v6
    s_waitcnt lgkmcnt(0)
    s_barrier
    ds_read_b64_tr_b16 v[32:33], v4 offset:0
    ds_read_b64_tr_b16 v[34:35], v4 offset:128
    ds_read_b64_tr_b16 v[36:37], v4 offset:256
    ds_read_b64_tr_b16 v[38:39], v4 offset:384
    v_smfmac_f32_16x16x64_bf16 v[48:51], v[20:23], a[112:119], v6
    v_smfmac_f32_16x16x64_bf16 v[52:55], v[20:23], a[120:127], v6
    ds_read_b64_tr_b16 v[40:41], v4 offset:512
    ds_read_b64_tr_b16 v[42:43], v4 offset:640
    ds_read_b64_tr_b16 v[44:45], v4 offset:768
    ds_read_b64_tr_b16 v[46:47], v4 offset:896
    v_smfmac_f32_16x16x64_bf16 v[48:51], v[24:27], a[128:135], v6
    v_smfmac_f32_16x16x64_bf16 v[52:55], v[24:27], a[136:143], v6
    s_waitcnt lgkmcnt(4)
    v_mfma_f32_16x16x32_bf16 v[8:11], v[72:75], v[32:35], 0
    ds_read_b64_tr_b16 v[12:13], v4 offset:2304
    ds_read_b64_tr_b16 v[14:15], v4 offset:2432
    v_mfma_f32_16x16x32_bf16 v[8:11], v[80:83], v[36:39], v[8:11]
    ds_read_b64_tr_b16 v[16:17], v4 offset:2560
    ds_read_b64_tr_b16 v[18:19], v4 offset:2688
    s_waitcnt lgkmcnt(4)
    v_mfma_f32_16x16x32_bf16 v[8:11], v[56:59], v[40:43], v[8:11]
    ds_read_b64_tr_b16 v[56:57], v4 offset:2816
    ds_read_b64_tr_b16 v[58:59], v4 offset:2944
    v_mfma_f32_16x16x32_bf16 v[8:11], v[64:67], v[44:47], v[8:11]
    ds_read_b64_tr_b16 v[64:65], v4 offset:3072
    ds_read_b64_tr_b16 v[66:67], v4 offset:3200
    v_mfma_f32_16x16x32_bf16 v[72:75], v[76:79], v[32:35], 0
    v_mfma_f32_16x16x32_bf16 v[72:75], v[84:87], v[36:39], v[72:75]
    v_mfma_f32_16x16x32_bf16 v[72:75], v[60:63], v[40:43], v[72:75]
    v_mfma_f32_16x16x32_bf16 v[72:75], v[68:71], v[44:47], v[72:75]
    s_waitcnt lgkmcnt(4)
    v_mfma_f32_16x16x32_bf16 v[80:83], v[12:15], v[32:35], 0
    v_mfma_f32_16x16x32_bf16 v[80:83], v[16:19], v[36:39], v[80:83]
    s_waitcnt lgkmcnt(0)
    v_mfma_f32_16x16x32_bf16 v[80:83], v[56:59], v[40:43], v[80:83]
    v_mfma_f32_16x16x32_bf16 v[80:83], v[64:67], v[44:47], v[80:83]
    v_smfmac_f32_16x16x64_bf16 v[48:51], v[28:31], a[144:151], v6
    v_smfmac_f32_16x16x64_bf16 v[52:55], v[28:31], a[152:159], v6
    v_mov_b32 v24, 0x3f803f80
    v_mov_b32 v25, 0x3f803f80
    v_mov_b32 v26, 0x3f803f80
    v_mov_b32 v27, 0x3f803f80
    v_max3_f32 v20, v8, v9, v10
    v_max3_f32 v21, v11, v72, v73
    v_max3_f32 v20, v20, v21, v74
    v_max3_f32 v21, v80, v81, v82
    v_max3_f32 v20, v20, v75, v83
    v_max_f32 v20, v20, v21
    v_mov_b32 v21, v20
    v_cvt_pk_bf16_f32 v48, v48, v49
    v_cvt_pk_bf16_f32 v49, v50, v51
    v_permlane16_swap_b32 v20, v21
    v_max_f32 v20, v20, v21
    v_mov_b32 v21, v20
    v_cvt_pk_bf16_f32 v50, v52, v53
    v_cvt_pk_bf16_f32 v51, v54, v55
    v_permlane32_swap_b32 v20, v21
    v_max_f32 v20, v20, v21
    v_mul_f32 v22, s10, v20
    v_pk_fma_f32 v[8:9], v[8:9], s[10:11], v[22:23] op_sel_hi:[1,1,0] neg_lo:[0,0,1] neg_hi:[0,0,1]
    v_pk_fma_f32 v[10:11], v[10:11], s[10:11], v[22:23] op_sel_hi:[1,1,0] neg_lo:[0,0,1] neg_hi:[0,0,1]
    v_pk_fma_f32 v[72:73], v[72:73], s[10:11], v[22:23] op_sel_hi:[1,1,0] neg_lo:[0,0,1] neg_hi:[0,0,1]
    v_pk_fma_f32 v[74:75], v[74:75], s[10:11], v[22:23] op_sel_hi:[1,1,0] neg_lo:[0,0,1] neg_hi:[0,0,1]
    v_pk_fma_f32 v[80:81], v[80:81], s[10:11], v[22:23] op_sel_hi:[1,1,0] neg_lo:[0,0,1] neg_hi:[0,0,1]
    v_pk_fma_f32 v[82:83], v[82:83], s[10:11], v[22:23] op_sel_hi:[1,1,0] neg_lo:[0,0,1] neg_hi:[0,0,1]
    v_exp_f32 v8, v8
    v_exp_f32 v9, v9
    v_exp_f32 v10, v10
    v_exp_f32 v11, v11
    v_exp_f32 v72, v72
    v_exp_f32 v73, v73
    v_exp_f32 v74, v74
    v_exp_f32 v75, v75
    v_cvt_pk_bf16_f32 v32, v8, v9
    v_cvt_pk_bf16_f32 v33, v10, v11
    v_exp_f32 v80, v80
    v_exp_f32 v81, v81
    v_exp_f32 v82, v82
    v_exp_f32 v83, v83
    v_cvt_pk_bf16_f32 v34, v72, v73
    v_cvt_pk_bf16_f32 v35, v74, v75
    v_cndmask_b32 v12, 0, v24, s[34:35]
    v_cndmask_b32 v13, 0, v24, s[34:35]
    s_waitcnt vmcnt(3)
    v_mfma_f32_16x16x32_bf16 v[8:11], v[24:27], v[32:35], 0
    v_cvt_pk_bf16_f32 v36, v80, v81
    v_mfma_f32_16x16x32_bf16 v[40:43], v[88:91], v[32:35], 0
    v_cvt_pk_bf16_f32 v37, v82, v83
    v_mfma_f32_16x16x32_bf16 v[44:47], v[92:95], v[32:35], 0
    v_mfma_f32_16x16x16_bf16 v[8:11], v[12:13], v[36:37], v[8:11]
    v_mov_b64 v[72:73], 0
    v_mfma_f32_16x16x16_bf16 v[40:43], v[48:49], v[36:37], v[40:43]
    v_mov_b64 v[74:75], 0
    v_mfma_f32_16x16x16_bf16 v[44:47], v[50:51], v[36:37], v[44:47]
    v_mov_b64 v[76:77], 0
    v_mov_b64 v[78:79], 0
    v_mov_b64 v[80:81], 0
    v_mov_b64 v[82:83], 0
    v_rcp_f32 v22, v8
    s_nop 2
    v_cndmask_b32 v40, v44, v40, s[32:33]
    v_cndmask_b32 v41, v45, v41, s[32:33]
    v_cndmask_b32 v42, v46, v42, s[32:33]
    v_cndmask_b32 v43, v47, v43, s[32:33]
    v_pk_mul_f32 v[40:41], v[40:41], v[22:23] op_sel_hi:[1,0]
    v_pk_mul_f32 v[42:43], v[42:43], v[22:23] op_sel_hi:[1,0]
    v_cvt_pk_bf16_f32 v44, v40, v41
    v_cvt_pk_bf16_f32 v45, v42, v43
    ds_write_b64 v5, v[44:45]
    s_mov_b32 m0, s73
    s_add_u32 s28, s28, 0x80000
    buffer_load_dwordx4 v1, s[4:7], s28 offen lds
    buffer_load_dwordx4 v1, s[4:7], s28 offen offset:1024 lds
    v_and_b32 v9, 0x70, v1
    v_bfe_u32 v29, v1, 8, 1
    v_lshl_add_u32 v9, v29, 3, v9
    v_bfe_u32 v29, v1, 9, 1
    v_lshl_add_u32 v9, v29, 2, v9
    v_mov_b32 v29, 0x40000000
    s_waitcnt lgkmcnt(0)
    s_barrier
    ds_read_b128 v[12:15], v0 offset:0
    ds_read_b128 v[16:19], v0 offset:64
    ds_read_b128 v[20:23], v0 offset:128
    ds_read_b128 v[24:27], v0 offset:192
    v_cndmask_b32 v9, v29, v9, s[32:33]
    v_and_b32 v29, 16, v1
    v_lshlrev_b32 v29, v29, s38
    v_cndmask_b32 v88, 0, v29, s[44:45]
    v_cndmask_b32 v89, 0, v29, s[46:47]
    v_cndmask_b32 v90, 0, v29, s[48:49]
    v_cndmask_b32 v91, 0, v29, s[50:51]
    s_waitcnt lgkmcnt(3)
    v_smfmac_f32_16x16x64_bf16 v[72:75], v[12:15], a[160:167], v6
    s_waitcnt lgkmcnt(2)
    v_smfmac_f32_16x16x64_bf16 v[72:75], v[16:19], a[168:175], v6
    s_waitcnt lgkmcnt(1)
    v_smfmac_f32_16x16x64_bf16 v[72:75], v[20:23], a[176:183], v6
    s_waitcnt lgkmcnt(0)
    v_smfmac_f32_16x16x64_bf16 v[72:75], v[24:27], a[184:191], v6
    v_smfmac_f32_16x16x64_bf16 v[76:79], v[12:15], a[192:199], v6
    v_smfmac_f32_16x16x64_bf16 v[76:79], v[16:19], a[200:207], v6
    v_cvt_pk_bf16_f32 v72, v72, v73
    v_smfmac_f32_16x16x64_bf16 v[76:79], v[20:23], a[208:215], v6
    v_cvt_pk_bf16_f32 v73, v74, v75
    v_smfmac_f32_16x16x64_bf16 v[76:79], v[24:27], a[216:223], v6
    v_and_or_b32 v72, v72, -2, s16
    v_mfma_f32_16x16x32_bf16 v[80:83], v[12:15], a[224:227], 0
    buffer_store_dwordx2 v[72:73], v7, s[4:7], s23 offen
    v_mfma_f32_16x16x32_bf16 v[80:83], v[16:19], a[228:231], v[80:83]
    v_mfma_f32_16x16x32_bf16 v[80:83], v[20:23], a[232:235], v[80:83]
    v_cvt_pk_bf16_f32 v76, v76, v77
    v_cvt_pk_bf16_f32 v77, v78, v79
    v_mfma_f32_16x16x32_bf16 v[80:83], v[24:27], a[236:239], v[80:83]
    v_and_or_b32 v76, v76, -2, s16
    buffer_store_dwordx2 v[76:77], v7, s[4:7], s25 offen
    s_add_u32 s17, s17, 0x4000
    s_add_u32 s3, s3, 0x80000
    s_add_u32 s29, s29, 0x80000
    s_add_u32 s18, s18, 0x4000
    s_add_u32 s21, s21, 0x8000
    s_add_u32 s15, s15, 1
    s_nop 0
    v_cvt_pk_bf16_f32 v80, v80, v81
    v_cvt_pk_bf16_f32 v81, v82, v83
    v_and_or_b32 v80, v80, -2, s16
    s_mov_b64 exec, s[34:35]
    buffer_store_dwordx2 v[80:81], v7, s[4:7], s26 offen
    s_mov_b64 exec, -1
    s_cmp_lg_u32 s42, 0
    s_cbranch_scc1 OWN_75
    s_cmp_lt_u32 s14, 2
    s_cbranch_scc1 IDLE_74
    s_branch REC_POLL
OWN_75:
    s_nop 15
    s_nop 13
    buffer_load_dwordx4 v[12:15], v1, s[4:7], s24 offen offset:0 sc1
    buffer_load_dwordx4 v[16:19], v1, s[4:7], s24 offen offset:1024 sc1
    buffer_load_dwordx4 v[20:23], v1, s[4:7], s24 offen offset:2048 sc1
    buffer_load_dwordx4 v[24:27], v1, s[4:7], s24 offen offset:3072 sc1
    ds_read_b128 v[56:59], v2 offset:0
    ds_read_b128 v[60:63], v2 offset:1024
    ds_read_b128 v[64:67], v2 offset:2048
    ds_read_b128 v[68:71], v2 offset:3072
    v_mov_b64 v[32:33], 0
    v_mov_b64 v[34:35], 0
    v_mov_b64 v[36:37], 0
    v_mov_b64 v[38:39], 0
    v_mov_b64 v[40:41], 0
    v_mov_b64 v[42:43], 0
    v_mov_b64 v[44:45], 0
    v_mov_b64 v[46:47], 0
    buffer_load_dwordx4 v[72:75], v1, s[4:7], s24 offen offset:0 sc1
    buffer_load_dwordx4 v[76:79], v1, s[4:7], s24 offen offset:1024 sc1
    buffer_load_dwordx4 v[80:83], v1, s[4:7], s24 offen offset:2048 sc1
    buffer_load_dwordx4 v[84:87], v1, s[4:7], s24 offen offset:3072 sc1
    v_mov_b64 v[48:49], 0
    v_mov_b64 v[50:51], 0
    v_mov_b64 v[52:53], 0
    v_mov_b64 v[54:55], 0
OPOLL_77:
    s_waitcnt vmcnt(7)
    v_mfma_f32_16x16x32_bf16 v[92:95], v[12:15], v[88:91], 0
    v_bitop3_b32 v10, v12, v14, s16 bitop3:0x7e
    s_waitcnt vmcnt(6)
    v_mfma_f32_16x16x32_bf16 v[92:95], v[16:19], v[88:91], v[92:95]
    v_bitop3_b32 v11, v16, v18, s16 bitop3:0x7e
    s_waitcnt vmcnt(5)
    v_mfma_f32_16x16x32_bf16 v[92:95], v[20:23], v[88:91], v[92:95]
    v_bitop3_b32 v30, v20, v22, s16 bitop3:0x7e
    s_waitcnt vmcnt(4)
    v_mfma_f32_16x16x32_bf16 v[92:95], v[24:27], v[88:91], v[92:95]
    v_bitop3_b32 v31, v24, v26, s16 bitop3:0x7e
    v_or3_b32 v10, v10, v11, v30
    v_bitop3_b32 v10, v10, v31, 1 bitop3:0xa8
    v_cmp_ne_u32 vcc, 0, v10
    s_nop 3
    s_cbranch_vccz ODONE_76
    s_add_u32 s40, s40, 1
    buffer_load_dwordx4 v[12:15], v1, s[4:7], s24 offen offset:0 sc1
    buffer_load_dwordx4 v[16:19], v1, s[4:7], s24 offen offset:1024 sc1
    buffer_load_dwordx4 v[20:23], v1, s[4:7], s24 offen offset:2048 sc1
    buffer_load_dwordx4 v[24:27], v1, s[4:7], s24 offen offset:3072 sc1
    s_waitcnt vmcnt(7)
    v_mfma_f32_16x16x32_bf16 v[92:95], v[72:75], v[88:91], 0
    v_bitop3_b32 v10, v72, v74, s16 bitop3:0x7e
    s_waitcnt vmcnt(6)
    v_mfma_f32_16x16x32_bf16 v[92:95], v[76:79], v[88:91], v[92:95]
    v_bitop3_b32 v11, v76, v78, s16 bitop3:0x7e
    s_waitcnt vmcnt(5)
    v_mfma_f32_16x16x32_bf16 v[92:95], v[80:83], v[88:91], v[92:95]
    v_bitop3_b32 v30, v80, v82, s16 bitop3:0x7e
    s_waitcnt vmcnt(4)
    v_mfma_f32_16x16x32_bf16 v[92:95], v[84:87], v[88:91], v[92:95]
    v_bitop3_b32 v31, v84, v86, s16 bitop3:0x7e
    v_or3_b32 v10, v10, v11, v30
    v_bitop3_b32 v10, v10, v31, 1 bitop3:0xa8
    v_cmp_ne_u32 vcc, 0, v10
    s_add_u32 s68, s68, 1
    s_cmp_gt_u32 s68, 262144
    s_cbranch_scc1 ODONE_76
    s_nop 0
    s_cbranch_vccz ODONE_76
    s_add_u32 s40, s40, 1
    buffer_load_dwordx4 v[72:75], v1, s[4:7], s24 offen offset:0 sc1
    buffer_load_dwordx4 v[76:79], v1, s[4:7], s24 offen offset:1024 sc1
    buffer_load_dwordx4 v[80:83], v1, s[4:7], s24 offen offset:2048 sc1
    buffer_load_dwordx4 v[84:87], v1, s[4:7], s24 offen offset:3072 sc1
    s_branch OPOLL_77
ODONE_76:
    v_permlane32_swap_b32 v92, v94
    v_permlane32_swap_b32 v93, v95
    v_add_f32 v92, v92, v94
    v_add_f32 v93, v93, v95
    v_cvt_pk_bf16_f32 v8, v92, v93
    buffer_store_dword v8, v9, s[4:7], s18 offen
    s_barrier
    s_nop 15
    s_nop 15
    s_nop 12
    buffer_store_dword v8, v9, s[4:7], s21 offen sc1
    s_cmp_lt_u32 s15, 61
    s_cbranch_scc1 EFLG_78
    buffer_store_dword v6, off, s[4:7], s22 sc1
EFLG_78:
    s_xor_b32 s16, s16, 1
    s_waitcnt vmcnt(2) lgkmcnt(0)
    s_cmp_lt_u32 s15, 63
    s_cbranch_scc1 REC_LOOP
    s_branch REC_END
IDLE_74:
    s_barrier
    v_mov_b64 v[32:33], 0
    v_mov_b64 v[34:35], 0
    v_mov_b64 v[36:37], 0
    v_mov_b64 v[38:39], 0
    v_mov_b64 v[40:41], 0
    v_mov_b64 v[42:43], 0
    v_mov_b64 v[44:45], 0
    v_mov_b64 v[46:47], 0
    v_mov_b64 v[48:49], 0
    v_mov_b64 v[50:51], 0
    v_mov_b64 v[52:53], 0
    v_mov_b64 v[54:55], 0
    ds_read_b128 v[56:59], v2 offset:0
    ds_read_b128 v[60:63], v2 offset:1024
    ds_read_b128 v[64:67], v2 offset:2048
    ds_read_b128 v[68:71], v2 offset:3072
    s_xor_b32 s16, s16, 1
    s_waitcnt vmcnt(0)
    s_cmp_lt_u32 s15, 63
    s_cbranch_scc1 REC_LOOP
    s_branch REC_END
REC_TAIL:
RETRY_58:
SPIN_79:
    buffer_load_dwordx4 v[20:23], v1, s[4:7], s17 offen offset:2048 sc1
    buffer_load_dwordx4 v[24:27], v1, s[4:7], s17 offen offset:3072 sc1
    buffer_load_dwordx4 v[28:31], v1, s[4:7], s74 offen offset:0 sc1
    s_add_u32 s68, s68, 1
    s_add_u32 s40, s40, 1024
    s_cmp_gt_u32 s68, 262144
    s_waitcnt vmcnt(0)
    s_cbranch_scc1 BACK_59
    v_cmp_eq_u32 vcc, -1, v23
    s_cbranch_vccnz SPIN_79
    s_branch BACK_59
RETRY_60:
SPIN_80:
    buffer_load_dwordx4 v[24:27], v1, s[4:7], s17 offen offset:3072 sc1
    buffer_load_dwordx4 v[28:31], v1, s[4:7], s74 offen offset:0 sc1
    s_add_u32 s68, s68, 1
    s_add_u32 s40, s40, 1024
    s_cmp_gt_u32 s68, 262144
    s_waitcnt vmcnt(0)
    s_cbranch_scc1 BACK_61
    v_cmp_eq_u32 vcc, -1, v27
    s_cbranch_vccnz SPIN_80
    s_branch BACK_61
RETRY_62:
SPIN_81:
    buffer_load_dwordx4 v[28:31], v1, s[4:7], s74 offen offset:0 sc1
    s_add_u32 s68, s68, 1
    s_add_u32 s40, s40, 1024
    s_cmp_gt_u32 s68, 262144
    s_waitcnt vmcnt(0)
    s_cbranch_scc1 BACK_63
    v_cmp_eq_u32 vcc, -1, v31
    s_cbranch_vccnz SPIN_81
    s_branch BACK_63
RETRY_64:
SPIN_82:
    buffer_load_dwordx4 v[12:15], v1, s[4:7], s20 offen offset:0 sc1
    buffer_load_dwordx4 v[16:19], v1, s[4:7], s20 offen offset:1024 sc1
    buffer_load_dwordx4 v[20:23], v1, s[4:7], s20 offen offset:2048 sc1
    buffer_load_dwordx4 v[24:27], v1, s[4:7], s20 offen offset:3072 sc1
    s_add_u32 s68, s68, 1
    s_add_u32 s40, s40, 1048576
    s_cmp_gt_u32 s68, 262144
    s_waitcnt vmcnt(0)
    s_cbranch_scc1 BACK_65
    v_cmp_eq_u32 vcc, -1, v15
    s_cbranch_vccnz SPIN_82
    s_branch BACK_65
RETRY_66:
SPIN_83:
    buffer_load_dwordx4 v[16:19], v1, s[4:7], s20 offen offset:1024 sc1
    buffer_load_dwordx4 v[20:23], v1, s[4:7], s20 offen offset:2048 sc1
    buffer_load_dwordx4 v[24:27], v1, s[4:7], s20 offen offset:3072 sc1
    buffer_load_dwordx4 v[28:31], v1, s[4:7], s75 offen offset:0 sc1
    s_add_u32 s68, s68, 1
    s_add_u32 s40, s40, 1048576
    s_cmp_gt_u32 s68, 262144
    s_waitcnt vmcnt(0)
    s_cbranch_scc1 BACK_67
    v_cmp_eq_u32 vcc, -1, v19
    s_cbranch_vccnz SPIN_83
    s_branch BACK_67
RETRY_68:
SPIN_84:
    buffer_load_dwordx4 v[20:23], v1, s[4:7], s20 offen offset:2048 sc1
    buffer_load_dwordx4 v[24:27], v1, s[4:7], s20 offen offset:3072 sc1
    buffer_load_dwordx4 v[28:31], v1, s[4:7], s75 offen offset:0 sc1
    s_add_u32 s68, s68, 1
    s_add_u32 s40, s40, 1048576
    s_cmp_gt_u32 s68, 262144
    s_waitcnt vmcnt(0)
    s_cbranch_scc1 BACK_69
    v_cmp_eq_u32 vcc, -1, v23
    s_cbranch_vccnz SPIN_84
    s_branch BACK_69
RETRY_70:
SPIN_85:
    buffer_load_dwordx4 v[24:27], v1, s[4:7], s20 offen offset:3072 sc1
    buffer_load_dwordx4 v[28:31], v1, s[4:7], s75 offen offset:0 sc1
    s_add_u32 s68, s68, 1
    s_add_u32 s40, s40, 1048576
    s_cmp_gt_u32 s68, 262144
    s_waitcnt vmcnt(0)
    s_cbranch_scc1 BACK_71
    v_cmp_eq_u32 vcc, -1, v27
    s_cbranch_vccnz SPIN_85
    s_branch BACK_71
RETRY_72:
SPIN_86:
    buffer_load_dwordx4 v[28:31], v1, s[4:7], s75 offen offset:0 sc1
    s_add_u32 s68, s68, 1
    s_add_u32 s40, s40, 1048576
    s_cmp_gt_u32 s68, 262144
    s_waitcnt vmcnt(0)
    s_cbranch_scc1 BACK_73
    v_cmp_eq_u32 vcc, -1, v31
    s_cbranch_vccnz SPIN_86
    s_branch BACK_73
REC_END:
    s_branch M_EXIT
M_HELP:
    v_mbcnt_lo_u32_b32 v0, -1, 0
    v_mbcnt_hi_u32_b32 v0, -1, v0
    s_load_dwordx2 s[16:17], s[0:1], 0
    s_mov_b32 s18, 2621440
    s_mov_b32 s19, 0x00020000
    s_load_dwordx2 s[20:21], s[0:1], 64
    s_mov_b32 s22, 1280
    s_mov_b32 s23, 0x00020000
    s_load_dwordx2 s[24:25], s[0:1], 8
    s_mov_b32 s26, 10240
    s_mov_b32 s27, 0x00020000
    s_lshl_b32 s28, s96, 2
    s_add_u32 s28, s28, s14
    s_mul_i32 s28, s28, 3
    v_lshlrev_b32 v3, 4, v0
    v_lshlrev_b32 v4, 2, v0
    s_waitcnt lgkmcnt(0)
    s_add_u32 s29, s28, 0
    s_mul_i32 s33, s29, 1280
    buffer_load_dwordx4 v[10:13], v3, s[16:19], s33 offen
    buffer_load_dword v14, v4, s[16:19], s33 offen offset:1024
    s_add_u32 s29, s28, 1
    s_mul_i32 s34, s29, 1280
    buffer_load_dwordx4 v[16:19], v3, s[16:19], s34 offen
    buffer_load_dword v20, v4, s[16:19], s34 offen offset:1024
    s_add_u32 s29, s28, 2
    s_mul_i32 s35, s29, 1280
    buffer_load_dwordx4 v[22:25], v3, s[16:19], s35 offen
    buffer_load_dword v26, v4, s[16:19], s35 offen offset:1024
    buffer_load_dwordx4 v[28:31], v3, s[20:23], 0 offen
    buffer_load_dword v32, v4, s[20:23], 0 offen offset:1024
    s_cmp_ge_u32 s96, 10
    s_cbranch_scc1 INM0_87
    v_and_b32 v5, 7, v0
    v_mul_u32_u24 v5, 1280, v5
    v_lshrrev_b32 v6, 4, v0
    v_lshl_add_u32 v5, v6, 5, v5
    v_bfe_u32 v6, v0, 3, 1
    v_lshl_add_u32 v5, v6, 4, v5
    s_lshl_b32 s29, s96, 7
    buffer_load_dwordx4 v[34:37], v5, s[24:27], s29 offen
INM0_87:
    s_waitcnt vmcnt(0)
    s_add_u32 s29, s28, 0
    s_cmp_ge_u32 s29, 2048
    s_cbranch_scc1 INR_88
    v_lshlrev_b32 v50, 16, v10
    v_and_b32 v60, 0xffff0000, v10
    v_lshlrev_b32 v51, 16, v11
    v_and_b32 v61, 0xffff0000, v11
    v_lshlrev_b32 v52, 16, v12
    v_and_b32 v62, 0xffff0000, v12
    v_lshlrev_b32 v53, 16, v13
    v_and_b32 v63, 0xffff0000, v13
    v_lshlrev_b32 v54, 16, v14
    v_and_b32 v64, 0xffff0000, v14
    v_add_f32 v70, v50, v60
    v_add_f32 v70, v70, v51
    v_add_f32 v70, v70, v61
    v_add_f32 v70, v70, v52
    v_add_f32 v70, v70, v62
    v_add_f32 v70, v70, v53
    v_add_f32 v70, v70, v63
    v_add_f32 v70, v70, v54
    v_add_f32 v70, v70, v64
    s_nop 1
    v_add_f32_dpp v70, v70, v70 quad_perm:[1,0,3,2] row_mask:0xf bank_mask:0xf
    s_nop 1
    v_add_f32_dpp v70, v70, v70 quad_perm:[2,3,0,1] row_mask:0xf bank_mask:0xf
    s_nop 1
    v_add_f32_dpp v70, v70, v70 row_half_mirror row_mask:0xf bank_mask:0xf
    s_nop 1
    v_add_f32_dpp v70, v70, v70 row_mirror row_mask:0xf bank_mask:0xf
    v_mov_b32 v71, v70
    s_nop 1
    v_permlane16_swap_b32 v70, v71
    v_add_f32 v70, v70, v71
    v_mov_b32 v71, v70
    s_nop 1
    v_permlane32_swap_b32 v70, v71
    v_add_f32 v70, v70, v71
    v_mul_f32 v72, 0x3acccccd, v70
    v_mov_b32 v73, 0
    v_sub_f32 v74, v50, v72
    v_fmac_f32 v73, v74, v74
    v_sub_f32 v74, v60, v72
    v_fmac_f32 v73, v74, v74
    v_sub_f32 v74, v51, v72
    v_fmac_f32 v73, v74, v74
    v_sub_f32 v74, v61, v72
    v_fmac_f32 v73, v74, v74
    v_sub_f32 v74, v52, v72
    v_fmac_f32 v73, v74, v74
    v_sub_f32 v74, v62, v72
    v_fmac_f32 v73, v74, v74
    v_sub_f32 v74, v53, v72
    v_fmac_f32 v73, v74, v74
    v_sub_f32 v74, v63, v72
    v_fmac_f32 v73, v74, v74
    v_sub_f32 v74, v54, v72
    v_fmac_f32 v73, v74, v74
    v_sub_f32 v74, v64, v72
    v_fmac_f32 v73, v74, v74
    s_nop 1
    v_add_f32_dpp v73, v73, v73 quad_perm:[1,0,3,2] row_mask:0xf bank_mask:0xf
    s_nop 1
    v_add_f32_dpp v73, v73, v73 quad_perm:[2,3,0,1] row_mask:0xf bank_mask:0xf
    s_nop 1
    v_add_f32_dpp v73, v73, v73 row_half_mirror row_mask:0xf bank_mask:0xf
    s_nop 1
    v_add_f32_dpp v73, v73, v73 row_mirror row_mask:0xf bank_mask:0xf
    v_mov_b32 v71, v73
    s_nop 1
    v_permlane16_swap_b32 v73, v71
    v_add_f32 v73, v73, v71
    v_mov_b32 v71, v73
    s_nop 1
    v_permlane32_swap_b32 v73, v71
    v_add_f32 v73, v73, v71
    v_mul_f32 v73, 0x3acccccd, v73
    v_cvt_pk_bf16_f32 v72, v72, v72
    v_lshlrev_b32 v72, 16, v72
    v_cvt_pk_bf16_f32 v73, v73, v73
    v_lshlrev_b32 v73, 16, v73
    v_add_f32 v73, 0x3727c5ac, v73
    v_cvt_pk_bf16_f32 v73, v73, v73
    v_lshlrev_b32 v73, 16, v73
    v_sqrt_f32 v73, v73
    s_nop 0
    v_cvt_pk_bf16_f32 v73, v73, v73
    v_lshlrev_b32 v73, 16, v73
    v_rcp_f32 v75, v73
    s_nop 0
    v_mov_b32 v76, 0
    v_sub_f32 v50, v50, v72
    v_cvt_pk_bf16_f32 v50, v50, v50
    v_lshlrev_b32 v50, 16, v50
    v_mul_f32 v74, v50, v75
    v_fma_f32 v77, -v74, v73, v50
    v_fma_f32 v50, v77, v75, v74
    v_sub_f32 v60, v60, v72
    v_cvt_pk_bf16_f32 v60, v60, v60
    v_lshlrev_b32 v60, 16, v60
    v_mul_f32 v74, v60, v75
    v_fma_f32 v77, -v74, v73, v60
    v_fma_f32 v60, v77, v75, v74
    v_cvt_pk_bf16_f32 v10, v50, v60
    v_lshlrev_b32 v74, 16, v10
    v_lshlrev_b32 v77, 16, v28
    v_fmac_f32 v76, v74, v77
    v_and_b32 v74, 0xffff0000, v10
    v_and_b32 v77, 0xffff0000, v28
    v_fmac_f32 v76, v74, v77
    v_sub_f32 v51, v51, v72
    v_cvt_pk_bf16_f32 v51, v51, v51
    v_lshlrev_b32 v51, 16, v51
    v_mul_f32 v74, v51, v75
    v_fma_f32 v77, -v74, v73, v51
    v_fma_f32 v51, v77, v75, v74
    v_sub_f32 v61, v61, v72
    v_cvt_pk_bf16_f32 v61, v61, v61
    v_lshlrev_b32 v61, 16, v61
    v_mul_f32 v74, v61, v75
    v_fma_f32 v77, -v74, v73, v61
    v_fma_f32 v61, v77, v75, v74
    v_cvt_pk_bf16_f32 v11, v51, v61
    v_lshlrev_b32 v74, 16, v11
    v_lshlrev_b32 v77, 16, v29
    v_fmac_f32 v76, v74, v77
    v_and_b32 v74, 0xffff0000, v11
    v_and_b32 v77, 0xffff0000, v29
    v_fmac_f32 v76, v74, v77
    v_sub_f32 v52, v52, v72
    v_cvt_pk_bf16_f32 v52, v52, v52
    v_lshlrev_b32 v52, 16, v52
    v_mul_f32 v74, v52, v75
    v_fma_f32 v77, -v74, v73, v52
    v_fma_f32 v52, v77, v75, v74
    v_sub_f32 v62, v62, v72
    v_cvt_pk_bf16_f32 v62, v62, v62
    v_lshlrev_b32 v62, 16, v62
    v_mul_f32 v74, v62, v75
    v_fma_f32 v77, -v74, v73, v62
    v_fma_f32 v62, v77, v75, v74
    v_cvt_pk_bf16_f32 v12, v52, v62
    v_lshlrev_b32 v74, 16, v12
    v_lshlrev_b32 v77, 16, v30
    v_fmac_f32 v76, v74, v77
    v_and_b32 v74, 0xffff0000, v12
    v_and_b32 v77, 0xffff0000, v30
    v_fmac_f32 v76, v74, v77
    v_sub_f32 v53, v53, v72
    v_cvt_pk_bf16_f32 v53, v53, v53
    v_lshlrev_b32 v53, 16, v53
    v_mul_f32 v74, v53, v75
    v_fma_f32 v77, -v74, v73, v53
    v_fma_f32 v53, v77, v75, v74
    v_sub_f32 v63, v63, v72
    v_cvt_pk_bf16_f32 v63, v63, v63
    v_lshlrev_b32 v63, 16, v63
    v_mul_f32 v74, v63, v75
    v_fma_f32 v77, -v74, v73, v63
    v_fma_f32 v63, v77, v75, v74
    v_cvt_pk_bf16_f32 v13, v53, v63
    v_lshlrev_b32 v74, 16, v13
    v_lshlrev_b32 v77, 16, v31
    v_fmac_f32 v76, v74, v77
    v_and_b32 v74, 0xffff0000, v13
    v_and_b32 v77, 0xffff0000, v31
    v_fmac_f32 v76, v74, v77
    v_sub_f32 v54, v54, v72
    v_cvt_pk_bf16_f32 v54, v54, v54
    v_lshlrev_b32 v54, 16, v54
    v_mul_f32 v74, v54, v75
    v_fma_f32 v77, -v74, v73, v54
    v_fma_f32 v54, v77, v75, v74
    v_sub_f32 v64, v64, v72
    v_cvt_pk_bf16_f32 v64, v64, v64
    v_lshlrev_b32 v64, 16, v64
    v_mul_f32 v74, v64, v75
    v_fma_f32 v77, -v74, v73, v64
    v_fma_f32 v64, v77, v75, v74
    v_cvt_pk_bf16_f32 v14, v54, v64
    v_lshlrev_b32 v74, 16, v14
    v_lshlrev_b32 v77, 16, v32
    v_fmac_f32 v76, v74, v77
    v_and_b32 v74, 0xffff0000, v14
    v_and_b32 v77, 0xffff0000, v32
    v_fmac_f32 v76, v74, v77
    s_add_u32 s30, s33, 0x0
    buffer_store_dwordx4 v[10:13], v3, s[4:7], s30 offen sc1
    buffer_store_dword v14, v4, s[4:7], s30 offen offset:1024 sc1
    s_nop 1
    v_add_f32_dpp v76, v76, v76 quad_perm:[1,0,3,2] row_mask:0xf bank_mask:0xf
    s_nop 1
    v_add_f32_dpp v76, v76, v76 quad_perm:[2,3,0,1] row_mask:0xf bank_mask:0xf
    s_nop 1
    v_add_f32_dpp v76, v76, v76 row_half_mirror row_mask:0xf bank_mask:0xf
    s_nop 1
    v_add_f32_dpp v76, v76, v76 row_mirror row_mask:0xf bank_mask:0xf
    v_mov_b32 v71, v76
    s_nop 1
    v_permlane16_swap_b32 v76, v71
    v_add_f32 v76, v76, v71
    v_mov_b32 v71, v76
    s_nop 1
    v_permlane32_swap_b32 v76, v71
    v_add_f32 v76, v76, v71
    v_cvt_pk_bf16_f32 v76, v76, v76
    v_lshlrev_b32 v76, 16, v76
    s_lshl_b32 s30, s29, 2
    s_add_u32 s30, s30, 0x280000
    s_mov_b64 exec, 1
    buffer_store_dword v76, off, s[4:7], s30 sc1
    s_mov_b64 exec, -1
INR_88:
    s_add_u32 s29, s28, 1
    s_cmp_ge_u32 s29, 2048
    s_cbranch_scc1 INR_89
    v_lshlrev_b32 v50, 16, v16
    v_and_b32 v60, 0xffff0000, v16
    v_lshlrev_b32 v51, 16, v17
    v_and_b32 v61, 0xffff0000, v17
    v_lshlrev_b32 v52, 16, v18
    v_and_b32 v62, 0xffff0000, v18
    v_lshlrev_b32 v53, 16, v19
    v_and_b32 v63, 0xffff0000, v19
    v_lshlrev_b32 v54, 16, v20
    v_and_b32 v64, 0xffff0000, v20
    v_add_f32 v70, v50, v60
    v_add_f32 v70, v70, v51
    v_add_f32 v70, v70, v61
    v_add_f32 v70, v70, v52
    v_add_f32 v70, v70, v62
    v_add_f32 v70, v70, v53
    v_add_f32 v70, v70, v63
    v_add_f32 v70, v70, v54
    v_add_f32 v70, v70, v64
    s_nop 1
    v_add_f32_dpp v70, v70, v70 quad_perm:[1,0,3,2] row_mask:0xf bank_mask:0xf
    s_nop 1
    v_add_f32_dpp v70, v70, v70 quad_perm:[2,3,0,1] row_mask:0xf bank_mask:0xf
    s_nop 1
    v_add_f32_dpp v70, v70, v70 row_half_mirror row_mask:0xf bank_mask:0xf
    s_nop 1
    v_add_f32_dpp v70, v70, v70 row_mirror row_mask:0xf bank_mask:0xf
    v_mov_b32 v71, v70
    s_nop 1
    v_permlane16_swap_b32 v70, v71
    v_add_f32 v70, v70, v71
    v_mov_b32 v71, v70
    s_nop 1
    v_permlane32_swap_b32 v70, v71
    v_add_f32 v70, v70, v71
    v_mul_f32 v72, 0x3acccccd, v70
    v_mov_b32 v73, 0
    v_sub_f32 v74, v50, v72
    v_fmac_f32 v73, v74, v74
    v_sub_f32 v74, v60, v72
    v_fmac_f32 v73, v74, v74
    v_sub_f32 v74, v51, v72
    v_fmac_f32 v73, v74, v74
    v_sub_f32 v74, v61, v72
    v_fmac_f32 v73, v74, v74
    v_sub_f32 v74, v52, v72
    v_fmac_f32 v73, v74, v74
    v_sub_f32 v74, v62, v72
    v_fmac_f32 v73, v74, v74
    v_sub_f32 v74, v53, v72
    v_fmac_f32 v73, v74, v74
    v_sub_f32 v74, v63, v72
    v_fmac_f32 v73, v74, v74
    v_sub_f32 v74, v54, v72
    v_fmac_f32 v73, v74, v74
    v_sub_f32 v74, v64, v72
    v_fmac_f32 v73, v74, v74
    s_nop 1
    v_add_f32_dpp v73, v73, v73 quad_perm:[1,0,3,2] row_mask:0xf bank_mask:0xf
    s_nop 1
    v_add_f32_dpp v73, v73, v73 quad_perm:[2,3,0,1] row_mask:0xf bank_mask:0xf
    s_nop 1
    v_add_f32_dpp v73, v73, v73 row_half_mirror row_mask:0xf bank_mask:0xf
    s_nop 1
    v_add_f32_dpp v73, v73, v73 row_mirror row_mask:0xf bank_mask:0xf
    v_mov_b32 v71, v73
    s_nop 1
    v_permlane16_swap_b32 v73, v71
    v_add_f32 v73, v73, v71
    v_mov_b32 v71, v73
    s_nop 1
    v_permlane32_swap_b32 v73, v71
    v_add_f32 v73, v73, v71
    v_mul_f32 v73, 0x3acccccd, v73
    v_cvt_pk_bf16_f32 v72, v72, v72
    v_lshlrev_b32 v72, 16, v72
    v_cvt_pk_bf16_f32 v73, v73, v73
    v_lshlrev_b32 v73, 16, v73
    v_add_f32 v73, 0x3727c5ac, v73
    v_cvt_pk_bf16_f32 v73, v73, v73
    v_lshlrev_b32 v73, 16, v73
    v_sqrt_f32 v73, v73
    s_nop 0
    v_cvt_pk_bf16_f32 v73, v73, v73
    v_lshlrev_b32 v73, 16, v73
    v_rcp_f32 v75, v73
    s_nop 0
    v_mov_b32 v76, 0
    v_sub_f32 v50, v50, v72
    v_cvt_pk_bf16_f32 v50, v50, v50
    v_lshlrev_b32 v50, 16, v50
    v_mul_f32 v74, v50, v75
    v_fma_f32 v77, -v74, v73, v50
    v_fma_f32 v50, v77, v75, v74
    v_sub_f32 v60, v60, v72
    v_cvt_pk_bf16_f32 v60, v60, v60
    v_lshlrev_b32 v60, 16, v60
    v_mul_f32 v74, v60, v75
    v_fma_f32 v77, -v74, v73, v60
    v_fma_f32 v60, v77, v75, v74
    v_cvt_pk_bf16_f32 v16, v50, v60
    v_lshlrev_b32 v74, 16, v16
    v_lshlrev_b32 v77, 16, v28
    v_fmac_f32 v76, v74, v77
    v_and_b32 v74, 0xffff0000, v16
    v_and_b32 v77, 0xffff0000, v28
    v_fmac_f32 v76, v74, v77
    v_sub_f32 v51, v51, v72
    v_cvt_pk_bf16_f32 v51, v51, v51
    v_lshlrev_b32 v51, 16, v51
    v_mul_f32 v74, v51, v75
    v_fma_f32 v77, -v74, v73, v51
    v_fma_f32 v51, v77, v75, v74
    v_sub_f32 v61, v61, v72
    v_cvt_pk_bf16_f32 v61, v61, v61
    v_lshlrev_b32 v61, 16, v61
    v_mul_f32 v74, v61, v75
    v_fma_f32 v77, -v74, v73, v61
    v_fma_f32 v61, v77, v75, v74
    v_cvt_pk_bf16_f32 v17, v51, v61
    v_lshlrev_b32 v74, 16, v17
    v_lshlrev_b32 v77, 16, v29
    v_fmac_f32 v76, v74, v77
    v_and_b32 v74, 0xffff0000, v17
    v_and_b32 v77, 0xffff0000, v29
    v_fmac_f32 v76, v74, v77
    v_sub_f32 v52, v52, v72
    v_cvt_pk_bf16_f32 v52, v52, v52
    v_lshlrev_b32 v52, 16, v52
    v_mul_f32 v74, v52, v75
    v_fma_f32 v77, -v74, v73, v52
    v_fma_f32 v52, v77, v75, v74
    v_sub_f32 v62, v62, v72
    v_cvt_pk_bf16_f32 v62, v62, v62
    v_lshlrev_b32 v62, 16, v62
    v_mul_f32 v74, v62, v75
    v_fma_f32 v77, -v74, v73, v62
    v_fma_f32 v62, v77, v75, v74
    v_cvt_pk_bf16_f32 v18, v52, v62
    v_lshlrev_b32 v74, 16, v18
    v_lshlrev_b32 v77, 16, v30
    v_fmac_f32 v76, v74, v77
    v_and_b32 v74, 0xffff0000, v18
    v_and_b32 v77, 0xffff0000, v30
    v_fmac_f32 v76, v74, v77
    v_sub_f32 v53, v53, v72
    v_cvt_pk_bf16_f32 v53, v53, v53
    v_lshlrev_b32 v53, 16, v53
    v_mul_f32 v74, v53, v75
    v_fma_f32 v77, -v74, v73, v53
    v_fma_f32 v53, v77, v75, v74
    v_sub_f32 v63, v63, v72
    v_cvt_pk_bf16_f32 v63, v63, v63
    v_lshlrev_b32 v63, 16, v63
    v_mul_f32 v74, v63, v75
    v_fma_f32 v77, -v74, v73, v63
    v_fma_f32 v63, v77, v75, v74
    v_cvt_pk_bf16_f32 v19, v53, v63
    v_lshlrev_b32 v74, 16, v19
    v_lshlrev_b32 v77, 16, v31
    v_fmac_f32 v76, v74, v77
    v_and_b32 v74, 0xffff0000, v19
    v_and_b32 v77, 0xffff0000, v31
    v_fmac_f32 v76, v74, v77
    v_sub_f32 v54, v54, v72
    v_cvt_pk_bf16_f32 v54, v54, v54
    v_lshlrev_b32 v54, 16, v54
    v_mul_f32 v74, v54, v75
    v_fma_f32 v77, -v74, v73, v54
    v_fma_f32 v54, v77, v75, v74
    v_sub_f32 v64, v64, v72
    v_cvt_pk_bf16_f32 v64, v64, v64
    v_lshlrev_b32 v64, 16, v64
    v_mul_f32 v74, v64, v75
    v_fma_f32 v77, -v74, v73, v64
    v_fma_f32 v64, v77, v75, v74
    v_cvt_pk_bf16_f32 v20, v54, v64
    v_lshlrev_b32 v74, 16, v20
    v_lshlrev_b32 v77, 16, v32
    v_fmac_f32 v76, v74, v77
    v_and_b32 v74, 0xffff0000, v20
    v_and_b32 v77, 0xffff0000, v32
    v_fmac_f32 v76, v74, v77
    s_add_u32 s30, s34, 0x0
    buffer_store_dwordx4 v[16:19], v3, s[4:7], s30 offen sc1
    buffer_store_dword v20, v4, s[4:7], s30 offen offset:1024 sc1
    s_nop 1
    v_add_f32_dpp v76, v76, v76 quad_perm:[1,0,3,2] row_mask:0xf bank_mask:0xf
    s_nop 1
    v_add_f32_dpp v76, v76, v76 quad_perm:[2,3,0,1] row_mask:0xf bank_mask:0xf
    s_nop 1
    v_add_f32_dpp v76, v76, v76 row_half_mirror row_mask:0xf bank_mask:0xf
    s_nop 1
    v_add_f32_dpp v76, v76, v76 row_mirror row_mask:0xf bank_mask:0xf
    v_mov_b32 v71, v76
    s_nop 1
    v_permlane16_swap_b32 v76, v71
    v_add_f32 v76, v76, v71
    v_mov_b32 v71, v76
    s_nop 1
    v_permlane32_swap_b32 v76, v71
    v_add_f32 v76, v76, v71
    v_cvt_pk_bf16_f32 v76, v76, v76
    v_lshlrev_b32 v76, 16, v76
    s_lshl_b32 s30, s29, 2
    s_add_u32 s30, s30, 0x280000
    s_mov_b64 exec, 1
    buffer_store_dword v76, off, s[4:7], s30 sc1
    s_mov_b64 exec, -1
INR_89:
    s_add_u32 s29, s28, 2
    s_cmp_ge_u32 s29, 2048
    s_cbranch_scc1 INR_90
    v_lshlrev_b32 v50, 16, v22
    v_and_b32 v60, 0xffff0000, v22
    v_lshlrev_b32 v51, 16, v23
    v_and_b32 v61, 0xffff0000, v23
    v_lshlrev_b32 v52, 16, v24
    v_and_b32 v62, 0xffff0000, v24
    v_lshlrev_b32 v53, 16, v25
    v_and_b32 v63, 0xffff0000, v25
    v_lshlrev_b32 v54, 16, v26
    v_and_b32 v64, 0xffff0000, v26
    v_add_f32 v70, v50, v60
    v_add_f32 v70, v70, v51
    v_add_f32 v70, v70, v61
    v_add_f32 v70, v70, v52
    v_add_f32 v70, v70, v62
    v_add_f32 v70, v70, v53
    v_add_f32 v70, v70, v63
    v_add_f32 v70, v70, v54
    v_add_f32 v70, v70, v64
    s_nop 1
    v_add_f32_dpp v70, v70, v70 quad_perm:[1,0,3,2] row_mask:0xf bank_mask:0xf
    s_nop 1
    v_add_f32_dpp v70, v70, v70 quad_perm:[2,3,0,1] row_mask:0xf bank_mask:0xf
    s_nop 1
    v_add_f32_dpp v70, v70, v70 row_half_mirror row_mask:0xf bank_mask:0xf
    s_nop 1
    v_add_f32_dpp v70, v70, v70 row_mirror row_mask:0xf bank_mask:0xf
    v_mov_b32 v71, v70
    s_nop 1
    v_permlane16_swap_b32 v70, v71
    v_add_f32 v70, v70, v71
    v_mov_b32 v71, v70
    s_nop 1
    v_permlane32_swap_b32 v70, v71
    v_add_f32 v70, v70, v71
    v_mul_f32 v72, 0x3acccccd, v70
    v_mov_b32 v73, 0
    v_sub_f32 v74, v50, v72
    v_fmac_f32 v73, v74, v74
    v_sub_f32 v74, v60, v72
    v_fmac_f32 v73, v74, v74
    v_sub_f32 v74, v51, v72
    v_fmac_f32 v73, v74, v74
    v_sub_f32 v74, v61, v72
    v_fmac_f32 v73, v74, v74
    v_sub_f32 v74, v52, v72
    v_fmac_f32 v73, v74, v74
    v_sub_f32 v74, v62, v72
    v_fmac_f32 v73, v74, v74
    v_sub_f32 v74, v53, v72
    v_fmac_f32 v73, v74, v74
    v_sub_f32 v74, v63, v72
    v_fmac_f32 v73, v74, v74
    v_sub_f32 v74, v54, v72
    v_fmac_f32 v73, v74, v74
    v_sub_f32 v74, v64, v72
    v_fmac_f32 v73, v74, v74
    s_nop 1
    v_add_f32_dpp v73, v73, v73 quad_perm:[1,0,3,2] row_mask:0xf bank_mask:0xf
    s_nop 1
    v_add_f32_dpp v73, v73, v73 quad_perm:[2,3,0,1] row_mask:0xf bank_mask:0xf
    s_nop 1
    v_add_f32_dpp v73, v73, v73 row_half_mirror row_mask:0xf bank_mask:0xf
    s_nop 1
    v_add_f32_dpp v73, v73, v73 row_mirror row_mask:0xf bank_mask:0xf
    v_mov_b32 v71, v73
    s_nop 1
    v_permlane16_swap_b32 v73, v71
    v_add_f32 v73, v73, v71
    v_mov_b32 v71, v73
    s_nop 1
    v_permlane32_swap_b32 v73, v71
    v_add_f32 v73, v73, v71
    v_mul_f32 v73, 0x3acccccd, v73
    v_cvt_pk_bf16_f32 v72, v72, v72
    v_lshlrev_b32 v72, 16, v72
    v_cvt_pk_bf16_f32 v73, v73, v73
    v_lshlrev_b32 v73, 16, v73
    v_add_f32 v73, 0x3727c5ac, v73
    v_cvt_pk_bf16_f32 v73, v73, v73
    v_lshlrev_b32 v73, 16, v73
    v_sqrt_f32 v73, v73
    s_nop 0
    v_cvt_pk_bf16_f32 v73, v73, v73
    v_lshlrev_b32 v73, 16, v73
    v_rcp_f32 v75, v73
    s_nop 0
    v_mov_b32 v76, 0
    v_sub_f32 v50, v50, v72
    v_cvt_pk_bf16_f32 v50, v50, v50
    v_lshlrev_b32 v50, 16, v50
    v_mul_f32 v74, v50, v75
    v_fma_f32 v77, -v74, v73, v50
    v_fma_f32 v50, v77, v75, v74
    v_sub_f32 v60, v60, v72
    v_cvt_pk_bf16_f32 v60, v60, v60
    v_lshlrev_b32 v60, 16, v60
    v_mul_f32 v74, v60, v75
    v_fma_f32 v77, -v74, v73, v60
    v_fma_f32 v60, v77, v75, v74
    v_cvt_pk_bf16_f32 v22, v50, v60
    v_lshlrev_b32 v74, 16, v22
    v_lshlrev_b32 v77, 16, v28
    v_fmac_f32 v76, v74, v77
    v_and_b32 v74, 0xffff0000, v22
    v_and_b32 v77, 0xffff0000, v28
    v_fmac_f32 v76, v74, v77
    v_sub_f32 v51, v51, v72
    v_cvt_pk_bf16_f32 v51, v51, v51
    v_lshlrev_b32 v51, 16, v51
    v_mul_f32 v74, v51, v75
    v_fma_f32 v77, -v74, v73, v51
    v_fma_f32 v51, v77, v75, v74
    v_sub_f32 v61, v61, v72
    v_cvt_pk_bf16_f32 v61, v61, v61
    v_lshlrev_b32 v61, 16, v61
    v_mul_f32 v74, v61, v75
    v_fma_f32 v77, -v74, v73, v61
    v_fma_f32 v61, v77, v75, v74
    v_cvt_pk_bf16_f32 v23, v51, v61
    v_lshlrev_b32 v74, 16, v23
    v_lshlrev_b32 v77, 16, v29
    v_fmac_f32 v76, v74, v77
    v_and_b32 v74, 0xffff0000, v23
    v_and_b32 v77, 0xffff0000, v29
    v_fmac_f32 v76, v74, v77
    v_sub_f32 v52, v52, v72
    v_cvt_pk_bf16_f32 v52, v52, v52
    v_lshlrev_b32 v52, 16, v52
    v_mul_f32 v74, v52, v75
    v_fma_f32 v77, -v74, v73, v52
    v_fma_f32 v52, v77, v75, v74
    v_sub_f32 v62, v62, v72
    v_cvt_pk_bf16_f32 v62, v62, v62
    v_lshlrev_b32 v62, 16, v62
    v_mul_f32 v74, v62, v75
    v_fma_f32 v77, -v74, v73, v62
    v_fma_f32 v62, v77, v75, v74
    v_cvt_pk_bf16_f32 v24, v52, v62
    v_lshlrev_b32 v74, 16, v24
    v_lshlrev_b32 v77, 16, v30
    v_fmac_f32 v76, v74, v77
    v_and_b32 v74, 0xffff0000, v24
    v_and_b32 v77, 0xffff0000, v30
    v_fmac_f32 v76, v74, v77
    v_sub_f32 v53, v53, v72
    v_cvt_pk_bf16_f32 v53, v53, v53
    v_lshlrev_b32 v53, 16, v53
    v_mul_f32 v74, v53, v75
    v_fma_f32 v77, -v74, v73, v53
    v_fma_f32 v53, v77, v75, v74
    v_sub_f32 v63, v63, v72
    v_cvt_pk_bf16_f32 v63, v63, v63
    v_lshlrev_b32 v63, 16, v63
    v_mul_f32 v74, v63, v75
    v_fma_f32 v77, -v74, v73, v63
    v_fma_f32 v63, v77, v75, v74
    v_cvt_pk_bf16_f32 v25, v53, v63
    v_lshlrev_b32 v74, 16, v25
    v_lshlrev_b32 v77, 16, v31
    v_fmac_f32 v76, v74, v77
    v_and_b32 v74, 0xffff0000, v25
    v_and_b32 v77, 0xffff0000, v31
    v_fmac_f32 v76, v74, v77
    v_sub_f32 v54, v54, v72
    v_cvt_pk_bf16_f32 v54, v54, v54
    v_lshlrev_b32 v54, 16, v54
    v_mul_f32 v74, v54, v75
    v_fma_f32 v77, -v74, v73, v54
    v_fma_f32 v54, v77, v75, v74
    v_sub_f32 v64, v64, v72
    v_cvt_pk_bf16_f32 v64, v64, v64
    v_lshlrev_b32 v64, 16, v64
    v_mul_f32 v74, v64, v75
    v_fma_f32 v77, -v74, v73, v64
    v_fma_f32 v64, v77, v75, v74
    v_cvt_pk_bf16_f32 v26, v54, v64
    v_lshlrev_b32 v74, 16, v26
    v_lshlrev_b32 v77, 16, v32
    v_fmac_f32 v76, v74, v77
    v_and_b32 v74, 0xffff0000, v26
    v_and_b32 v77, 0xffff0000, v32
    v_fmac_f32 v76, v74, v77
    s_add_u32 s30, s35, 0x0
    buffer_store_dwordx4 v[22:25], v3, s[4:7], s30 offen sc1
    buffer_store_dword v26, v4, s[4:7], s30 offen offset:1024 sc1
    s_nop 1
    v_add_f32_dpp v76, v76, v76 quad_perm:[1,0,3,2] row_mask:0xf bank_mask:0xf
    s_nop 1
    v_add_f32_dpp v76, v76, v76 quad_perm:[2,3,0,1] row_mask:0xf bank_mask:0xf
    s_nop 1
    v_add_f32_dpp v76, v76, v76 row_half_mirror row_mask:0xf bank_mask:0xf
    s_nop 1
    v_add_f32_dpp v76, v76, v76 row_mirror row_mask:0xf bank_mask:0xf
    v_mov_b32 v71, v76
    s_nop 1
    v_permlane16_swap_b32 v76, v71
    v_add_f32 v76, v76, v71
    v_mov_b32 v71, v76
    s_nop 1
    v_permlane32_swap_b32 v76, v71
    v_add_f32 v76, v76, v71
    v_cvt_pk_bf16_f32 v76, v76, v76
    v_lshlrev_b32 v76, 16, v76
    s_lshl_b32 s30, s29, 2
    s_add_u32 s30, s30, 0x280000
    s_mov_b64 exec, 1
    buffer_store_dword v76, off, s[4:7], s30 sc1
    s_mov_b64 exec, -1
INR_90:
    s_lshl_b32 s29, s96, 2
    s_add_u32 s29, s29, s14
    s_lshl_b32 s29, s29, 6
    v_add_u32 v5, s29, v0
    v_lshlrev_b32 v6, 4, v5
    v_mov_b32 v40, -1
    v_mov_b32 v44, 0
    v_mov_b32 v41, -1
    v_mov_b32 v45, 0
    v_mov_b32 v42, -1
    v_mov_b32 v46, 0
    v_mov_b32 v43, -1
    v_mov_b32 v47, 0
    v_cmp_gt_u32 vcc, 0x1000, v5
    s_nop 0
    s_and_saveexec_b64 s[38:39], vcc
    s_cbranch_execz INF_91
    s_mov_b32 s30, 0x290000
    buffer_store_dwordx4 v[44:47], v6, s[4:7], s30 offen sc1
INF_91:
    s_mov_b64 exec, s[38:39]
    v_cmp_gt_u32 vcc, 0x5000, v5
    s_nop 0
    s_and_saveexec_b64 s[38:39], vcc
    s_cbranch_execz INF_92
    s_mov_b32 s30, 0x300000
    buffer_store_dwordx4 v[40:43], v6, s[4:7], s30 offen sc1
INF_92:
    s_mov_b64 exec, s[38:39]
    v_lshrrev_b32 v7, 6, v5
    v_mul_u32_u24 v7, 52429, v7
    v_lshrrev_b32 v7, 18, v7
    v_mul_u32_u24 v8, 320, v7
    v_sub_u32 v8, v5, v8
    v_lshlrev_b32 v48, 4, v8
    v_lshl_add_u32 v49, v7, 13, v48
    v_cmp_gt_u32 vcc, 0xa000, v5
    s_nop 0
    s_and_saveexec_b64 s[38:39], vcc
    s_cbranch_execz INF_93
    s_mov_b32 s30, 0x5904000
    buffer_store_dwordx4 v[40:43], v49, s[4:7], s30 offen sc1
INF_93:
    s_mov_b64 exec, s[38:39]
    s_mov_b32 s65, 0
CW_94:
    buffer_load_dwordx2 v[8:9], off, s[60:63], 0 offset:132 sc1
    s_add_u32 s65, s65, 1
    s_waitcnt vmcnt(0)
    v_readfirstlane_b32 s31, v8
    v_readfirstlane_b32 s32, v9
    s_min_u32 s64, s31, s32
    s_cmp_lg_u32 s64, 0
    s_cbranch_scc1 CWD_95
    s_cmp_gt_u32 s65, 65536
    s_cbranch_scc1 CWD_95
    s_sleep 4
    s_branch CW_94
CWD_95:
    s_sub_u32 s31, s31, 1
    s_and_b32 s31, s31, 3
    s_sub_u32 s32, s32, 1
    s_and_b32 s32, s32, 3
    s_lshl_b32 s31, s31, 13
    s_lshl_b32 s32, s32, 13
    s_add_u32 s32, s32, 0x200000
    v_and_b32 v8, 1, v7
    v_cmp_eq_u32 vcc, 1, v8
    v_mov_b32 v8, s31
    v_mov_b32 v9, s32
    v_cndmask_b32 v8, v8, v9, vcc
    v_lshrrev_b32 v9, 1, v7
    v_lshl_add_u32 v8, v9, 15, v8
    v_add_u32 v49, v8, v48
    v_cmp_le_u32 vcc, 640, v5
    v_mov_b32 v9, 0x40000000
    s_nop 0
    v_cndmask_b32 v49, v9, v49, vcc
    v_cmp_gt_u32 vcc, 0xa000, v5
    s_nop 0
    s_and_saveexec_b64 s[38:39], vcc
    s_cbranch_execz INF_96
    s_mov_b32 s30, 0x6000000
    buffer_store_dwordx4 v[40:43], v49, s[4:7], s30 offen sc1
INF_96:
    s_mov_b64 exec, s[38:39]
    s_cmp_ge_u32 s96, 10
    s_cbranch_scc1 INM1_97
    s_cmp_ge_u32 s14, 2
    s_cbranch_scc1 INM1_97
    s_cmp_ge_u32 s96, 5
    s_cselect_b32 s36, 1, 0
    s_mul_i32 s29, s36, 5
    s_sub_u32 s29, s96, s29
    s_lshl_b32 s29, s29, 10
    s_lshl_b32 s30, s36, 13
    s_add_u32 s30, s30, 0x5900000
    s_cmp_eq_u32 s36, 0
    s_cselect_b32 s37, s31, s32
    s_add_u32 s37, s37, 0x6000000
    s_cmp_eq_u32 s14, 0
    s_cselect_b32 s30, s30, s37
    s_add_u32 s30, s30, s29
    buffer_store_dwordx4 v[34:37], v3, s[4:7], s30 offen sc1
INM1_97:
    s_waitcnt vmcnt(0)
    s_barrier
    s_cmp_lg_u32 s14, 0
    s_cbranch_scc1 INE_98
    s_cmp_lg_u32 s96, 10
    s_cbranch_scc1 ING_99
    v_mov_b32 v44, 1
    v_lshlrev_b32 v6, 7, v0
    s_mov_b32 s30, 0x29a000
    s_mov_b64 exec, 3
    buffer_store_dword v44, v6, s[4:7], s30 offen sc1
    s_mov_b64 exec, -1
    s_waitcnt vmcnt(0)
ING_99:
    v_mov_b32 v8, 1
    s_mov_b64 exec, 1
    buffer_atomic_add v8, off, s[60:63], s95 sc1
    s_mov_b64 exec, -1
INE_98:
    v_mbcnt_lo_u32_b32 v0, -1, 0
    v_mbcnt_hi_u32_b32 v0, -1, v0
    s_and_b32 s12, s96, 1
    s_lshr_b32 s3, s96, 1
    s_and_b32 s13, s3, 31
    s_lshr_b32 s3, s3, 5
    s_load_dwordx4 s[48:51], s[0:1], 16
    s_load_dwordx2 s[52:53], s[0:1], 32
    s_waitcnt lgkmcnt(0)
    s_mov_b32 s46, 5242880
    s_mov_b32 s47, 0x00020000
    s_cmp_eq_u32 s3, 0
    s_cbranch_scc1 H_E0
    s_cmp_eq_u32 s3, 1
    s_cbranch_scc1 H_E1
    s_cmp_eq_u32 s3, 2
    s_cbranch_scc1 H_E2
    s_branch M_EXIT
H_E0:
    s_mov_b32 s44, s50
    s_mov_b32 s45, s51
    s_lshl_b32 s16, s13, 14
    s_mov_b32 s17, 0x80000
    s_lshl_b32 s64, s14, 10
    s_add_u32 s16, s16, 0x1400000
    s_add_u32 s16, s16, s64
    s_mul_i32 s64, s12, s17
    s_lshl_b32 s64, s64, 2
    s_add_u32 s16, s16, s64
    s_lshl_b32 s18, s13, 4
    s_add_u32 s18, s18, 0x291000
    s_branch G_T
H_E1:
    s_mov_b32 s44, s52
    s_mov_b32 s45, s53
    s_lshl_b32 s16, s13, 14
    s_mov_b32 s17, 0x80000
    s_lshl_b32 s64, s14, 11
    s_add_u32 s16, s16, 0x1402000
    s_add_u32 s16, s16, s64
    s_mul_i32 s64, s12, s17
    s_lshl_b32 s64, s64, 2
    s_add_u32 s16, s16, s64
    s_lshl_b32 s18, s13, 4
    s_add_u32 s18, s18, 0x291004
    s_branch G_N
H_E2:
    s_mov_b32 s44, s48
    s_mov_b32 s45, s49
    s_lshl_b32 s16, s13, 13
    s_mov_b32 s17, 0x40000
    s_lshl_b32 s64, s14, 10
    s_add_u32 s16, s16, 0x3400000
    s_add_u32 s16, s16, s64
    s_mul_i32 s64, s12, s17
    s_lshl_b32 s64, s64, 2
    s_add_u32 s16, s16, s64
    s_lshl_b32 s18, s13, 4
    s_add_u32 s18, s18, 0x291008
    s_branch G_T
G_T:
    s_lshl_b32 s65, s13, 8
    s_lshl_b32 s66, s14, 6
    s_add_u32 s20, s65, s66
    s_mul_i32 s21, s14, 36864
    v_lshrrev_b32 v6, 2, v0
    v_mul_u32_u24 v5, 8192, v6
    v_lshrrev_b32 v6, 5, v0
    v_lshlrev_b32 v6, 1, v6
    v_and_b32 v7, 3, v0
    v_xor_b32 v6, v6, v7
    v_lshl_add_u32 v5, v6, 4, v5
    v_lshrrev_b32 v6, 5, v0
    v_lshlrev_b32 v3, 10, v6
    v_bfe_u32 v6, v0, 2, 2
    v_lshl_add_u32 v3, v6, 6, v3
    v_and_b32 v6, 3, v0
    v_lshl_add_u32 v3, v6, 3, v3
    v_bfe_u32 v6, v0, 4, 1
    v_lshl_add_u32 v3, v6, 9, v3
    v_add_u32 v3, s21, v3
    v_lshlrev_b32 v6, 5, v6
    v_sub_u32 v4, 32, v6
    v_add_u32 v4, v4, v3
    v_add_u32 v3, v3, v6
    s_add_u32 m0, s21, 0
    s_add_u32 s64, s20, 0x0
    buffer_load_dwordx4 v5, s[44:47], s64 offen lds
    s_add_u32 m0, s21, 1024
    s_add_u32 s64, s20, 0x20000
    buffer_load_dwordx4 v5, s[44:47], s64 offen lds
    s_add_u32 m0, s21, 2048
    s_add_u32 s64, s20, 0x40000
    buffer_load_dwordx4 v5, s[44:47], s64 offen lds
    s_add_u32 m0, s21, 3072
    s_add_u32 s64, s20, 0x60000
    buffer_load_dwordx4 v5, s[44:47], s64 offen lds
    s_add_u32 m0, s21, 4096
    s_add_u32 s64, s20, 0x80000
    buffer_load_dwordx4 v5, s[44:47], s64 offen lds
    s_add_u32 m0, s21, 5120
    s_add_u32 s64, s20, 0xa0000
    buffer_load_dwordx4 v5, s[44:47], s64 offen lds
    s_add_u32 m0, s21, 6144
    s_add_u32 s64, s20, 0xc0000
    buffer_load_dwordx4 v5, s[44:47], s64 offen lds
    s_add_u32 m0, s21, 7168
    s_add_u32 s64, s20, 0xe0000
    buffer_load_dwordx4 v5, s[44:47], s64 offen lds
    s_add_u32 m0, s21, 8192
    s_add_u32 s64, s20, 0x100000
    buffer_load_dwordx4 v5, s[44:47], s64 offen lds
    s_add_u32 m0, s21, 9216
    s_add_u32 s64, s20, 0x120000
    buffer_load_dwordx4 v5, s[44:47], s64 offen lds
    s_add_u32 m0, s21, 10240
    s_add_u32 s64, s20, 0x140000
    buffer_load_dwordx4 v5, s[44:47], s64 offen lds
    s_add_u32 m0, s21, 11264
    s_add_u32 s64, s20, 0x160000
    buffer_load_dwordx4 v5, s[44:47], s64 offen lds
    s_add_u32 m0, s21, 12288
    s_add_u32 s64, s20, 0x180000
    buffer_load_dwordx4 v5, s[44:47], s64 offen lds
    s_add_u32 m0, s21, 13312
    s_add_u32 s64, s20, 0x1a0000
    buffer_load_dwordx4 v5, s[44:47], s64 offen lds
    s_add_u32 m0, s21, 14336
    s_add_u32 s64, s20, 0x1c0000
    buffer_load_dwordx4 v5, s[44:47], s64 offen lds
    s_add_u32 m0, s21, 15360
    s_add_u32 s64, s20, 0x1e0000
    buffer_load_dwordx4 v5, s[44:47], s64 offen lds
    s_add_u32 m0, s21, 16384
    s_add_u32 s64, s20, 0x200000
    buffer_load_dwordx4 v5, s[44:47], s64 offen lds
    s_add_u32 m0, s21, 17408
    s_add_u32 s64, s20, 0x220000
    buffer_load_dwordx4 v5, s[44:47], s64 offen lds
    s_add_u32 m0, s21, 18432
    s_add_u32 s64, s20, 0x240000
    buffer_load_dwordx4 v5, s[44:47], s64 offen lds
    s_add_u32 m0, s21, 19456
    s_add_u32 s64, s20, 0x260000
    buffer_load_dwordx4 v5, s[44:47], s64 offen lds
    s_add_u32 m0, s21, 20480
    s_add_u32 s64, s20, 0x280000
    buffer_load_dwordx4 v5, s[44:47], s64 offen lds
    s_add_u32 m0, s21, 21504
    s_add_u32 s64, s20, 0x2a0000
    buffer_load_dwordx4 v5, s[44:47], s64 offen lds
    s_add_u32 m0, s21, 22528
    s_add_u32 s64, s20, 0x2c0000
    buffer_load_dwordx4 v5, s[44:47], s64 offen lds
    s_add_u32 m0, s21, 23552
    s_add_u32 s64, s20, 0x2e0000
    buffer_load_dwordx4 v5, s[44:47], s64 offen lds
    s_add_u32 m0, s21, 24576
    s_add_u32 s64, s20, 0x300000
    buffer_load_dwordx4 v5, s[44:47], s64 offen lds
    s_add_u32 m0, s21, 25600
    s_add_u32 s64, s20, 0x320000
    buffer_load_dwordx4 v5, s[44:47], s64 offen lds
    s_add_u32 m0, s21, 26624
    s_add_u32 s64, s20, 0x340000
    buffer_load_dwordx4 v5, s[44:47], s64 offen lds
    s_add_u32 m0, s21, 27648
    s_add_u32 s64, s20, 0x360000
    buffer_load_dwordx4 v5, s[44:47], s64 offen lds
    s_add_u32 m0, s21, 28672
    s_add_u32 s64, s20, 0x380000
    buffer_load_dwordx4 v5, s[44:47], s64 offen lds
    s_add_u32 m0, s21, 29696
    s_add_u32 s64, s20, 0x3a0000
    buffer_load_dwordx4 v5, s[44:47], s64 offen lds
    s_add_u32 m0, s21, 30720
    s_add_u32 s64, s20, 0x3c0000
    buffer_load_dwordx4 v5, s[44:47], s64 offen lds
    s_add_u32 m0, s21, 31744
    s_add_u32 s64, s20, 0x3e0000
    buffer_load_dwordx4 v5, s[44:47], s64 offen lds
    s_add_u32 m0, s21, 32768
    s_add_u32 s64, s20, 0x400000
    buffer_load_dwordx4 v5, s[44:47], s64 offen lds
    s_add_u32 m0, s21, 33792
    s_add_u32 s64, s20, 0x420000
    buffer_load_dwordx4 v5, s[44:47], s64 offen lds
    s_add_u32 m0, s21, 34816
    s_add_u32 s64, s20, 0x440000
    buffer_load_dwordx4 v5, s[44:47], s64 offen lds
    s_add_u32 m0, s21, 35840
    s_add_u32 s64, s20, 0x460000
    buffer_load_dwordx4 v5, s[44:47], s64 offen lds
    s_waitcnt vmcnt(32)
    ds_read_b64_tr_b16 v[96:97], v3 offset:0
    ds_read_b64_tr_b16 v[98:99], v3 offset:256
    ds_read_b64_tr_b16 v[100:101], v4 offset:0
    ds_read_b64_tr_b16 v[102:103], v4 offset:256
    ds_read_b64_tr_b16 v[104:105], v3 offset:2048
    ds_read_b64_tr_b16 v[106:107], v3 offset:2304
    ds_read_b64_tr_b16 v[108:109], v4 offset:2048
    ds_read_b64_tr_b16 v[110:111], v4 offset:2304
    s_waitcnt lgkmcnt(0)
    s_add_u32 m0, s21, 0
    s_add_u32 s64, s20, 0x480000
    buffer_load_dwordx4 v5, s[44:47], s64 offen lds
    s_add_u32 m0, s21, 1024
    s_add_u32 s64, s20, 0x4a0000
    buffer_load_dwordx4 v5, s[44:47], s64 offen lds
    s_add_u32 m0, s21, 2048
    s_add_u32 s64, s20, 0x4c0000
    buffer_load_dwordx4 v5, s[44:47], s64 offen lds
    s_add_u32 m0, s21, 3072
    s_add_u32 s64, s20, 0x4e0000
    buffer_load_dwordx4 v5, s[44:47], s64 offen lds
    s_waitcnt vmcnt(32)
    ds_read_b64_tr_b16 v[112:113], v3 offset:4096
    ds_read_b64_tr_b16 v[114:115], v3 offset:4352
    ds_read_b64_tr_b16 v[116:117], v4 offset:4096
    ds_read_b64_tr_b16 v[118:119], v4 offset:4352
    ds_read_b64_tr_b16 v[120:121], v3 offset:6144
    ds_read_b64_tr_b16 v[122:123], v3 offset:6400
    ds_read_b64_tr_b16 v[124:125], v4 offset:6144
    ds_read_b64_tr_b16 v[126:127], v4 offset:6400
    s_waitcnt lgkmcnt(0)
    s_waitcnt vmcnt(28)
    ds_read_b64_tr_b16 v[128:129], v3 offset:8192
    ds_read_b64_tr_b16 v[130:131], v3 offset:8448
    ds_read_b64_tr_b16 v[132:133], v4 offset:8192
    ds_read_b64_tr_b16 v[134:135], v4 offset:8448
    ds_read_b64_tr_b16 v[136:137], v3 offset:10240
    ds_read_b64_tr_b16 v[138:139], v3 offset:10496
    ds_read_b64_tr_b16 v[140:141], v4 offset:10240
    ds_read_b64_tr_b16 v[142:143], v4 offset:10496
    s_waitcnt lgkmcnt(0)
    s_waitcnt vmcnt(24)
    ds_read_b64_tr_b16 v[144:145], v3 offset:12288
    ds_read_b64_tr_b16 v[146:147], v3 offset:12544
    ds_read_b64_tr_b16 v[148:149], v4 offset:12288
    ds_read_b64_tr_b16 v[150:151], v4 offset:12544
    ds_read_b64_tr_b16 v[152:153], v3 offset:14336
    ds_read_b64_tr_b16 v[154:155], v3 offset:14592
    ds_read_b64_tr_b16 v[156:157], v4 offset:14336
    ds_read_b64_tr_b16 v[158:159], v4 offset:14592
    s_waitcnt lgkmcnt(0)
    s_waitcnt vmcnt(20)
    ds_read_b64_tr_b16 v[160:161], v3 offset:16384
    ds_read_b64_tr_b16 v[162:163], v3 offset:16640
    ds_read_b64_tr_b16 v[164:165], v4 offset:16384
    ds_read_b64_tr_b16 v[166:167], v4 offset:16640
    ds_read_b64_tr_b16 v[168:169], v3 offset:18432
    ds_read_b64_tr_b16 v[170:171], v3 offset:18688
    ds_read_b64_tr_b16 v[172:173], v4 offset:18432
    ds_read_b64_tr_b16 v[174:175], v4 offset:18688
    s_waitcnt lgkmcnt(0)
    s_waitcnt vmcnt(16)
    ds_read_b64_tr_b16 v[176:177], v3 offset:20480
    ds_read_b64_tr_b16 v[178:179], v3 offset:20736
    ds_read_b64_tr_b16 v[180:181], v4 offset:20480
    ds_read_b64_tr_b16 v[182:183], v4 offset:20736
    ds_read_b64_tr_b16 v[184:185], v3 offset:22528
    ds_read_b64_tr_b16 v[186:187], v3 offset:22784
    ds_read_b64_tr_b16 v[188:189], v4 offset:22528
    ds_read_b64_tr_b16 v[190:191], v4 offset:22784
    s_waitcnt lgkmcnt(0)
    s_waitcnt vmcnt(12)
    ds_read_b64_tr_b16 v[192:193], v3 offset:24576
    ds_read_b64_tr_b16 v[194:195], v3 offset:24832
    ds_read_b64_tr_b16 v[196:197], v4 offset:24576
    ds_read_b64_tr_b16 v[198:199], v4 offset:24832
    ds_read_b64_tr_b16 v[200:201], v3 offset:26624
    ds_read_b64_tr_b16 v[202:203], v3 offset:26880
    ds_read_b64_tr_b16 v[204:205], v4 offset:26624
    ds_read_b64_tr_b16 v[206:207], v4 offset:26880
    s_waitcnt lgkmcnt(0)
    s_waitcnt vmcnt(8)
    ds_read_b64_tr_b16 v[208:209], v3 offset:28672
    ds_read_b64_tr_b16 v[210:211], v3 offset:28928
    ds_read_b64_tr_b16 v[212:213], v4 offset:28672
    ds_read_b64_tr_b16 v[214:215], v4 offset:28928
    ds_read_b64_tr_b16 v[216:217], v3 offset:30720
    ds_read_b64_tr_b16 v[218:219], v3 offset:30976
    ds_read_b64_tr_b16 v[220:221], v4 offset:30720
    ds_read_b64_tr_b16 v[222:223], v4 offset:30976
    s_waitcnt lgkmcnt(0)
    s_waitcnt vmcnt(4)
    ds_read_b64_tr_b16 v[224:225], v3 offset:32768
    ds_read_b64_tr_b16 v[226:227], v3 offset:33024
    ds_read_b64_tr_b16 v[228:229], v4 offset:32768
    ds_read_b64_tr_b16 v[230:231], v4 offset:33024
    ds_read_b64_tr_b16 v[232:233], v3 offset:34816
    ds_read_b64_tr_b16 v[234:235], v3 offset:35072
    ds_read_b64_tr_b16 v[236:237], v4 offset:34816
    ds_read_b64_tr_b16 v[238:239], v4 offset:35072
    s_waitcnt lgkmcnt(0)
    s_waitcnt vmcnt(0)
    ds_read_b64_tr_b16 v[240:241], v3 offset:0
    ds_read_b64_tr_b16 v[242:243], v3 offset:256
    ds_read_b64_tr_b16 v[244:245], v4 offset:0
    ds_read_b64_tr_b16 v[246:247], v4 offset:256
    ds_read_b64_tr_b16 v[248:249], v3 offset:2048
    ds_read_b64_tr_b16 v[250:251], v3 offset:2304
    ds_read_b64_tr_b16 v[252:253], v4 offset:2048
    ds_read_b64_tr_b16 v[254:255], v4 offset:2304
    s_waitcnt lgkmcnt(0)
    s_cmp_lg_u32 s97, 0
    s_cbranch_scc1 CM_100
    v_mbcnt_lo_u32_b32 v0, -1, 0
    v_mbcnt_hi_u32_b32 v0, -1, v0
    v_mul_u32_u24 v8, 32, v0
    s_mov_b32 s64, 0x0
    s_mov_b32 s65, 0
    s_mov_b64 exec, 0xff
TK_101:
    buffer_load_dword v9, v8, s[60:63], s64 offen sc1
    s_add_u32 s65, s65, 1
    s_waitcnt vmcnt(0)
    s_mov_b32 s66, 0
    v_readlane_b32 s67, v9, 0
    s_add_u32 s66, s66, s67
    v_readlane_b32 s67, v9, 1
    s_add_u32 s66, s66, s67
    v_readlane_b32 s67, v9, 2
    s_add_u32 s66, s66, s67
    v_readlane_b32 s67, v9, 3
    s_add_u32 s66, s66, s67
    v_readlane_b32 s67, v9, 4
    s_add_u32 s66, s66, s67
    v_readlane_b32 s67, v9, 5
    s_add_u32 s66, s66, s67
    v_readlane_b32 s67, v9, 6
    s_add_u32 s66, s66, s67
    v_readlane_b32 s67, v9, 7
    s_add_u32 s66, s66, s67
    s_cmp_ge_u32 s66, 256
    s_cbranch_scc1 TKD_102
    s_cmp_gt_u32 s65, 262144
    s_cbranch_scc0 TK_101
TKD_102:
    v_cmp_ne_u32 vcc, 32, v9
    s_mov_b64 exec, -1
    s_cbranch_vccnz M_SLOW
CM_100:
    s_mov_b32 s65, 0
GI_103:
    buffer_load_dword v8, off, s[60:63], s95 sc1
    s_add_u32 s65, s65, 1
    s_waitcnt vmcnt(0)
    v_readfirstlane_b32 s64, v8
    s_cmp_ge_u32 s64, 192
    s_cbranch_scc1 GID_104
    s_cmp_gt_u32 s65, 65536
    s_cbranch_scc1 GID_104
    s_sleep 4
    s_branch GI_103
GID_104:
    v_mbcnt_lo_u32_b32 v0, -1, 0
    v_mbcnt_hi_u32_b32 v0, -1, v0
    s_cmp_lg_u32 s3, 2
    s_cbranch_scc1 NOSEL_105
    s_or_b32 s64, s13, s12
    s_or_b32 s64, s64, s14
    s_cmp_lg_u32 s64, 0
    s_cbranch_scc1 NOSEL_105
    s_mov_b32 s29, 0
    v_lshlrev_b32 v1, 4, v0
    s_mov_b32 s64, 0x280000
    buffer_load_dwordx4 v[16:19], v1, s[4:7], s64 offen offset:0 sc1
    buffer_load_dwordx4 v[20:23], v1, s[4:7], s64 offen offset:1024 sc1
    buffer_load_dwordx4 v[24:27], v1, s[4:7], s64 offen offset:2048 sc1
    buffer_load_dwordx4 v[28:31], v1, s[4:7], s64 offen offset:3072 sc1
    s_add_u32 s64, s64, 4096
    buffer_load_dwordx4 v[32:35], v1, s[4:7], s64 offen offset:0 sc1
    buffer_load_dwordx4 v[36:39], v1, s[4:7], s64 offen offset:1024 sc1
    buffer_load_dwordx4 v[40:43], v1, s[4:7], s64 offen offset:2048 sc1
    buffer_load_dwordx4 v[44:47], v1, s[4:7], s64 offen offset:3072 sc1
    s_waitcnt vmcnt(0)
    v_lshlrev_b32 v2, 2, v0
    v_ashrrev_i32 v3, 31, v16
    v_or_b32 v3, 0x80000000, v3
    v_xor_b32 v16, v16, v3
    v_and_b32 v16, 0xffff0000, v16
    v_sub_u32 v3, 65535, v2
    v_or_b32 v16, v16, v3
    v_ashrrev_i32 v3, 31, v17
    v_or_b32 v3, 0x80000000, v3
    v_xor_b32 v17, v17, v3
    v_and_b32 v17, 0xffff0000, v17
    v_sub_u32 v3, 65534, v2
    v_or_b32 v17, v17, v3
    v_ashrrev_i32 v3, 31, v18
    v_or_b32 v3, 0x80000000, v3
    v_xor_b32 v18, v18, v3
    v_and_b32 v18, 0xffff0000, v18
    v_sub_u32 v3, 65533, v2
    v_or_b32 v18, v18, v3
    v_ashrrev_i32 v3, 31, v19
    v_or_b32 v3, 0x80000000, v3
    v_xor_b32 v19, v19, v3
    v_and_b32 v19, 0xffff0000, v19
    v_sub_u32 v3, 65532, v2
    v_or_b32 v19, v19, v3
    v_ashrrev_i32 v3, 31, v20
    v_or_b32 v3, 0x80000000, v3
    v_xor_b32 v20, v20, v3
    v_and_b32 v20, 0xffff0000, v20
    v_sub_u32 v3, 65279, v2
    v_or_b32 v20, v20, v3
    v_ashrrev_i32 v3, 31, v21
    v_or_b32 v3, 0x80000000, v3
    v_xor_b32 v21, v21, v3
    v_and_b32 v21, 0xffff0000, v21
    v_sub_u32 v3, 65278, v2
    v_or_b32 v21, v21, v3
    v_ashrrev_i32 v3, 31, v22
    v_or_b32 v3, 0x80000000, v3
    v_xor_b32 v22, v22, v3
    v_and_b32 v22, 0xffff0000, v22
    v_sub_u32 v3, 65277, v2
    v_or_b32 v22, v22, v3
    v_ashrrev_i32 v3, 31, v23
    v_or_b32 v3, 0x80000000, v3
    v_xor_b32 v23, v23, v3
    v_and_b32 v23, 0xffff0000, v23
    v_sub_u32 v3, 65276, v2
    v_or_b32 v23, v23, v3
    v_ashrrev_i32 v3, 31, v24
    v_or_b32 v3, 0x80000000, v3
    v_xor_b32 v24, v24, v3
    v_and_b32 v24, 0xffff0000, v24
    v_sub_u32 v3, 65023, v2
    v_or_b32 v24, v24, v3
    v_ashrrev_i32 v3, 31, v25
    v_or_b32 v3, 0x80000000, v3
    v_xor_b32 v25, v25, v3
    v_and_b32 v25, 0xffff0000, v25
    v_sub_u32 v3, 65022, v2
    v_or_b32 v25, v25, v3
    v_ashrrev_i32 v3, 31, v26
    v_or_b32 v3, 0x80000000, v3
    v_xor_b32 v26, v26, v3
    v_and_b32 v26, 0xffff0000, v26
    v_sub_u32 v3, 65021, v2
    v_or_b32 v26, v26, v3
    v_ashrrev_i32 v3, 31, v27
    v_or_b32 v3, 0x80000000, v3
    v_xor_b32 v27, v27, v3
    v_and_b32 v27, 0xffff0000, v27
    v_sub_u32 v3, 65020, v2
    v_or_b32 v27, v27, v3
    v_ashrrev_i32 v3, 31, v28
    v_or_b32 v3, 0x80000000, v3
    v_xor_b32 v28, v28, v3
    v_and_b32 v28, 0xffff0000, v28
    v_sub_u32 v3, 64767, v2
    v_or_b32 v28, v28, v3
    v_ashrrev_i32 v3, 31, v29
    v_or_b32 v3, 0x80000000, v3
    v_xor_b32 v29, v29, v3
    v_and_b32 v29, 0xffff0000, v29
    v_sub_u32 v3, 64766, v2
    v_or_b32 v29, v29, v3
    v_ashrrev_i32 v3, 31, v30
    v_or_b32 v3, 0x80000000, v3
    v_xor_b32 v30, v30, v3
    v_and_b32 v30, 0xffff0000, v30
    v_sub_u32 v3, 64765, v2
    v_or_b32 v30, v30, v3
    v_ashrrev_i32 v3, 31, v31
    v_or_b32 v3, 0x80000000, v3
    v_xor_b32 v31, v31, v3
    v_and_b32 v31, 0xffff0000, v31
    v_sub_u32 v3, 64764, v2
    v_or_b32 v31, v31, v3
    v_ashrrev_i32 v3, 31, v32
    v_or_b32 v3, 0x80000000, v3
    v_xor_b32 v32, v32, v3
    v_and_b32 v32, 0xffff0000, v32
    v_sub_u32 v3, 64511, v2
    v_or_b32 v32, v32, v3
    v_ashrrev_i32 v3, 31, v33
    v_or_b32 v3, 0x80000000, v3
    v_xor_b32 v33, v33, v3
    v_and_b32 v33, 0xffff0000, v33
    v_sub_u32 v3, 64510, v2
    v_or_b32 v33, v33, v3
    v_ashrrev_i32 v3, 31, v34
    v_or_b32 v3, 0x80000000, v3
    v_xor_b32 v34, v34, v3
    v_and_b32 v34, 0xffff0000, v34
    v_sub_u32 v3, 64509, v2
    v_or_b32 v34, v34, v3
    v_ashrrev_i32 v3, 31, v35
    v_or_b32 v3, 0x80000000, v3
    v_xor_b32 v35, v35, v3
    v_and_b32 v35, 0xffff0000, v35
    v_sub_u32 v3, 64508, v2
    v_or_b32 v35, v35, v3
    v_ashrrev_i32 v3, 31, v36
    v_or_b32 v3, 0x80000000, v3
    v_xor_b32 v36, v36, v3
    v_and_b32 v36, 0xffff0000, v36
    v_sub_u32 v3, 64255, v2
    v_or_b32 v36, v36, v3
    v_ashrrev_i32 v3, 31, v37
    v_or_b32 v3, 0x80000000, v3
    v_xor_b32 v37, v37, v3
    v_and_b32 v37, 0xffff0000, v37
    v_sub_u32 v3, 64254, v2
    v_or_b32 v37, v37, v3
    v_ashrrev_i32 v3, 31, v38
    v_or_b32 v3, 0x80000000, v3
    v_xor_b32 v38, v38, v3
    v_and_b32 v38, 0xffff0000, v38
    v_sub_u32 v3, 64253, v2
    v_or_b32 v38, v38, v3
    v_ashrrev_i32 v3, 31, v39
    v_or_b32 v3, 0x80000000, v3
    v_xor_b32 v39, v39, v3
    v_and_b32 v39, 0xffff0000, v39
    v_sub_u32 v3, 64252, v2
    v_or_b32 v39, v39, v3
    v_ashrrev_i32 v3, 31, v40
    v_or_b32 v3, 0x80000000, v3
    v_xor_b32 v40, v40, v3
    v_and_b32 v40, 0xffff0000, v40
    v_sub_u32 v3, 63999, v2
    v_or_b32 v40, v40, v3
    v_ashrrev_i32 v3, 31, v41
    v_or_b32 v3, 0x80000000, v3
    v_xor_b32 v41, v41, v3
    v_and_b32 v41, 0xffff0000, v41
    v_sub_u32 v3, 63998, v2
    v_or_b32 v41, v41, v3
    v_ashrrev_i32 v3, 31, v42
    v_or_b32 v3, 0x80000000, v3
    v_xor_b32 v42, v42, v3
    v_and_b32 v42, 0xffff0000, v42
    v_sub_u32 v3, 63997, v2
    v_or_b32 v42, v42, v3
    v_ashrrev_i32 v3, 31, v43
    v_or_b32 v3, 0x80000000, v3
    v_xor_b32 v43, v43, v3
    v_and_b32 v43, 0xffff0000, v43
    v_sub_u32 v3, 63996, v2
    v_or_b32 v43, v43, v3
    v_ashrrev_i32 v3, 31, v44
    v_or_b32 v3, 0x80000000, v3
    v_xor_b32 v44, v44, v3
    v_and_b32 v44, 0xffff0000, v44
    v_sub_u32 v3, 63743, v2
    v_or_b32 v44, v44, v3
    v_ashrrev_i32 v3, 31, v45
    v_or_b32 v3, 0x80000000, v3
    v_xor_b32 v45, v45, v3
    v_and_b32 v45, 0xffff0000, v45
    v_sub_u32 v3, 63742, v2
    v_or_b32 v45, v45, v3
    v_ashrrev_i32 v3, 31, v46
    v_or_b32 v3, 0x80000000, v3
    v_xor_b32 v46, v46, v3
    v_and_b32 v46, 0xffff0000, v46
    v_sub_u32 v3, 63741, v2
    v_or_b32 v46, v46, v3
    v_ashrrev_i32 v3, 31, v47
    v_or_b32 v3, 0x80000000, v3
    v_xor_b32 v47, v47, v3
    v_and_b32 v47, 0xffff0000, v47
    v_sub_u32 v3, 63740, v2
    v_or_b32 v47, v47, v3
    v_max3_u32 v4, v16, v17, v18
    v_max3_u32 v4, v4, v19, v20
    v_max3_u32 v4, v4, v21, v22
    v_max3_u32 v4, v4, v23, v24
    v_max3_u32 v4, v4, v25, v26
    v_max3_u32 v4, v4, v27, v28
    v_max3_u32 v4, v4, v29, v30
    v_max3_u32 v4, v4, v31, v32
    v_max3_u32 v4, v4, v33, v34
    v_max3_u32 v4, v4, v35, v36
    v_max3_u32 v4, v4, v37, v38
    v_max3_u32 v4, v4, v39, v40
    v_max3_u32 v4, v4, v41, v42
    v_max3_u32 v4, v4, v43, v44
    v_max3_u32 v4, v4, v45, v46
    v_max_u32 v4, v4, v47
    s_nop 1
    v_max_u32_dpp v4, v4, v4 quad_perm:[1,0,3,2] row_mask:0xf bank_mask:0xf
    s_nop 1
    v_max_u32_dpp v4, v4, v4 quad_perm:[2,3,0,1] row_mask:0xf bank_mask:0xf
    s_nop 1
    v_max_u32_dpp v4, v4, v4 row_half_mirror row_mask:0xf bank_mask:0xf
    s_nop 1
    v_max_u32_dpp v4, v4, v4 row_mirror row_mask:0xf bank_mask:0xf
    v_mov_b32 v5, v4
    s_nop 1
    v_permlane16_swap_b32 v4, v5
    v_max_u32 v4, v4, v5
    v_mov_b32 v5, v4
    s_nop 1
    v_permlane32_swap_b32 v4, v5
    v_max_u32 v4, v4, v5
    v_mov_b32 v56, v4
    v_cmp_eq_u32 vcc, v4, v16
    s_nop 1
    v_cndmask_b32 v16, v16, 0, vcc
    v_cmp_eq_u32 vcc, v4, v17
    s_nop 1
    v_cndmask_b32 v17, v17, 0, vcc
    v_cmp_eq_u32 vcc, v4, v18
    s_nop 1
    v_cndmask_b32 v18, v18, 0, vcc
    v_cmp_eq_u32 vcc, v4, v19
    s_nop 1
    v_cndmask_b32 v19, v19, 0, vcc
    v_cmp_eq_u32 vcc, v4, v20
    s_nop 1
    v_cndmask_b32 v20, v20, 0, vcc
    v_cmp_eq_u32 vcc, v4, v21
    s_nop 1
    v_cndmask_b32 v21, v21, 0, vcc
    v_cmp_eq_u32 vcc, v4, v22
    s_nop 1
    v_cndmask_b32 v22, v22, 0, vcc
    v_cmp_eq_u32 vcc, v4, v23
    s_nop 1
    v_cndmask_b32 v23, v23, 0, vcc
    v_cmp_eq_u32 vcc, v4, v24
    s_nop 1
    v_cndmask_b32 v24, v24, 0, vcc
    v_cmp_eq_u32 vcc, v4, v25
    s_nop 1
    v_cndmask_b32 v25, v25, 0, vcc
    v_cmp_eq_u32 vcc, v4, v26
    s_nop 1
    v_cndmask_b32 v26, v26, 0, vcc
    v_cmp_eq_u32 vcc, v4, v27
    s_nop 1
    v_cndmask_b32 v27, v27, 0, vcc
    v_cmp_eq_u32 vcc, v4, v28
    s_nop 1
    v_cndmask_b32 v28, v28, 0, vcc
    v_cmp_eq_u32 vcc, v4, v29
    s_nop 1
    v_cndmask_b32 v29, v29, 0, vcc
    v_cmp_eq_u32 vcc, v4, v30
    s_nop 1
    v_cndmask_b32 v30, v30, 0, vcc
    v_cmp_eq_u32 vcc, v4, v31
    s_nop 1
    v_cndmask_b32 v31, v31, 0, vcc
    v_cmp_eq_u32 vcc, v4, v32
    s_nop 1
    v_cndmask_b32 v32, v32, 0, vcc
    v_cmp_eq_u32 vcc, v4, v33
    s_nop 1
    v_cndmask_b32 v33, v33, 0, vcc
    v_cmp_eq_u32 vcc, v4, v34
    s_nop 1
    v_cndmask_b32 v34, v34, 0, vcc
    v_cmp_eq_u32 vcc, v4, v35
    s_nop 1
    v_cndmask_b32 v35, v35, 0, vcc
    v_cmp_eq_u32 vcc, v4, v36
    s_nop 1
    v_cndmask_b32 v36, v36, 0, vcc
    v_cmp_eq_u32 vcc, v4, v37
    s_nop 1
    v_cndmask_b32 v37, v37, 0, vcc
    v_cmp_eq_u32 vcc, v4, v38
    s_nop 1
    v_cndmask_b32 v38, v38, 0, vcc
    v_cmp_eq_u32 vcc, v4, v39
    s_nop 1
    v_cndmask_b32 v39, v39, 0, vcc
    v_cmp_eq_u32 vcc, v4, v40
    s_nop 1
    v_cndmask_b32 v40, v40, 0, vcc
    v_cmp_eq_u32 vcc, v4, v41
    s_nop 1
    v_cndmask_b32 v41, v41, 0, vcc
    v_cmp_eq_u32 vcc, v4, v42
    s_nop 1
    v_cndmask_b32 v42, v42, 0, vcc
    v_cmp_eq_u32 vcc, v4, v43
    s_nop 1
    v_cndmask_b32 v43, v43, 0, vcc
    v_cmp_eq_u32 vcc, v4, v44
    s_nop 1
    v_cndmask_b32 v44, v44, 0, vcc
    v_cmp_eq_u32 vcc, v4, v45
    s_nop 1
    v_cndmask_b32 v45, v45, 0, vcc
    v_cmp_eq_u32 vcc, v4, v46
    s_nop 1
    v_cndmask_b32 v46, v46, 0, vcc
    v_cmp_eq_u32 vcc, v4, v47
    s_nop 1
    v_cndmask_b32 v47, v47, 0, vcc
    v_max3_u32 v4, v16, v17, v18
    v_max3_u32 v4, v4, v19, v20
    v_max3_u32 v4, v4, v21, v22
    v_max3_u32 v4, v4, v23, v24
    v_max3_u32 v4, v4, v25, v26
    v_max3_u32 v4, v4, v27, v28
    v_max3_u32 v4, v4, v29, v30
    v_max3_u32 v4, v4, v31, v32
    v_max3_u32 v4, v4, v33, v34
    v_max3_u32 v4, v4, v35, v36
    v_max3_u32 v4, v4, v37, v38
    v_max3_u32 v4, v4, v39, v40
    v_max3_u32 v4, v4, v41, v42
    v_max3_u32 v4, v4, v43, v44
    v_max3_u32 v4, v4, v45, v46
    v_max_u32 v4, v4, v47
    s_nop 1
    v_max_u32_dpp v4, v4, v4 quad_perm:[1,0,3,2] row_mask:0xf bank_mask:0xf
    s_nop 1
    v_max_u32_dpp v4, v4, v4 quad_perm:[2,3,0,1] row_mask:0xf bank_mask:0xf
    s_nop 1
    v_max_u32_dpp v4, v4, v4 row_half_mirror row_mask:0xf bank_mask:0xf
    s_nop 1
    v_max_u32_dpp v4, v4, v4 row_mirror row_mask:0xf bank_mask:0xf
    v_mov_b32 v5, v4
    s_nop 1
    v_permlane16_swap_b32 v4, v5
    v_max_u32 v4, v4, v5
    v_mov_b32 v5, v4
    s_nop 1
    v_permlane32_swap_b32 v4, v5
    v_max_u32 v4, v4, v5
    v_mov_b32 v57, v4
    v_cmp_eq_u32 vcc, v4, v16
    s_nop 1
    v_cndmask_b32 v16, v16, 0, vcc
    v_cmp_eq_u32 vcc, v4, v17
    s_nop 1
    v_cndmask_b32 v17, v17, 0, vcc
    v_cmp_eq_u32 vcc, v4, v18
    s_nop 1
    v_cndmask_b32 v18, v18, 0, vcc
    v_cmp_eq_u32 vcc, v4, v19
    s_nop 1
    v_cndmask_b32 v19, v19, 0, vcc
    v_cmp_eq_u32 vcc, v4, v20
    s_nop 1
    v_cndmask_b32 v20, v20, 0, vcc
    v_cmp_eq_u32 vcc, v4, v21
    s_nop 1
    v_cndmask_b32 v21, v21, 0, vcc
    v_cmp_eq_u32 vcc, v4, v22
    s_nop 1
    v_cndmask_b32 v22, v22, 0, vcc
    v_cmp_eq_u32 vcc, v4, v23
    s_nop 1
    v_cndmask_b32 v23, v23, 0, vcc
    v_cmp_eq_u32 vcc, v4, v24
    s_nop 1
    v_cndmask_b32 v24, v24, 0, vcc
    v_cmp_eq_u32 vcc, v4, v25
    s_nop 1
    v_cndmask_b32 v25, v25, 0, vcc
    v_cmp_eq_u32 vcc, v4, v26
    s_nop 1
    v_cndmask_b32 v26, v26, 0, vcc
    v_cmp_eq_u32 vcc, v4, v27
    s_nop 1
    v_cndmask_b32 v27, v27, 0, vcc
    v_cmp_eq_u32 vcc, v4, v28
    s_nop 1
    v_cndmask_b32 v28, v28, 0, vcc
    v_cmp_eq_u32 vcc, v4, v29
    s_nop 1
    v_cndmask_b32 v29, v29, 0, vcc
    v_cmp_eq_u32 vcc, v4, v30
    s_nop 1
    v_cndmask_b32 v30, v30, 0, vcc
    v_cmp_eq_u32 vcc, v4, v31
    s_nop 1
    v_cndmask_b32 v31, v31, 0, vcc
    v_cmp_eq_u32 vcc, v4, v32
    s_nop 1
    v_cndmask_b32 v32, v32, 0, vcc
    v_cmp_eq_u32 vcc, v4, v33
    s_nop 1
    v_cndmask_b32 v33, v33, 0, vcc
    v_cmp_eq_u32 vcc, v4, v34
    s_nop 1
    v_cndmask_b32 v34, v34, 0, vcc
    v_cmp_eq_u32 vcc, v4, v35
    s_nop 1
    v_cndmask_b32 v35, v35, 0, vcc
    v_cmp_eq_u32 vcc, v4, v36
    s_nop 1
    v_cndmask_b32 v36, v36, 0, vcc
    v_cmp_eq_u32 vcc, v4, v37
    s_nop 1
    v_cndmask_b32 v37, v37, 0, vcc
    v_cmp_eq_u32 vcc, v4, v38
    s_nop 1
    v_cndmask_b32 v38, v38, 0, vcc
    v_cmp_eq_u32 vcc, v4, v39
    s_nop 1
    v_cndmask_b32 v39, v39, 0, vcc
    v_cmp_eq_u32 vcc, v4, v40
    s_nop 1
    v_cndmask_b32 v40, v40, 0, vcc
    v_cmp_eq_u32 vcc, v4, v41
    s_nop 1
    v_cndmask_b32 v41, v41, 0, vcc
    v_cmp_eq_u32 vcc, v4, v42
    s_nop 1
    v_cndmask_b32 v42, v42, 0, vcc
    v_cmp_eq_u32 vcc, v4, v43
    s_nop 1
    v_cndmask_b32 v43, v43, 0, vcc
    v_cmp_eq_u32 vcc, v4, v44
    s_nop 1
    v_cndmask_b32 v44, v44, 0, vcc
    v_cmp_eq_u32 vcc, v4, v45
    s_nop 1
    v_cndmask_b32 v45, v45, 0, vcc
    v_cmp_eq_u32 vcc, v4, v46
    s_nop 1
    v_cndmask_b32 v46, v46, 0, vcc
    v_cmp_eq_u32 vcc, v4, v47
    s_nop 1
    v_cndmask_b32 v47, v47, 0, vcc
    v_max3_u32 v4, v16, v17, v18
    v_max3_u32 v4, v4, v19, v20
    v_max3_u32 v4, v4, v21, v22
    v_max3_u32 v4, v4, v23, v24
    v_max3_u32 v4, v4, v25, v26
    v_max3_u32 v4, v4, v27, v28
    v_max3_u32 v4, v4, v29, v30
    v_max3_u32 v4, v4, v31, v32
    v_max3_u32 v4, v4, v33, v34
    v_max3_u32 v4, v4, v35, v36
    v_max3_u32 v4, v4, v37, v38
    v_max3_u32 v4, v4, v39, v40
    v_max3_u32 v4, v4, v41, v42
    v_max3_u32 v4, v4, v43, v44
    v_max3_u32 v4, v4, v45, v46
    v_max_u32 v4, v4, v47
    s_nop 1
    v_max_u32_dpp v4, v4, v4 quad_perm:[1,0,3,2] row_mask:0xf bank_mask:0xf
    s_nop 1
    v_max_u32_dpp v4, v4, v4 quad_perm:[2,3,0,1] row_mask:0xf bank_mask:0xf
    s_nop 1
    v_max_u32_dpp v4, v4, v4 row_half_mirror row_mask:0xf bank_mask:0xf
    s_nop 1
    v_max_u32_dpp v4, v4, v4 row_mirror row_mask:0xf bank_mask:0xf
    v_mov_b32 v5, v4
    s_nop 1
    v_permlane16_swap_b32 v4, v5
    v_max_u32 v4, v4, v5
    v_mov_b32 v5, v4
    s_nop 1
    v_permlane32_swap_b32 v4, v5
    v_max_u32 v4, v4, v5
    v_mov_b32 v58, v4
    v_cmp_eq_u32 vcc, v4, v16
    s_nop 1
    v_cndmask_b32 v16, v16, 0, vcc
    v_cmp_eq_u32 vcc, v4, v17
    s_nop 1
    v_cndmask_b32 v17, v17, 0, vcc
    v_cmp_eq_u32 vcc, v4, v18
    s_nop 1
    v_cndmask_b32 v18, v18, 0, vcc
    v_cmp_eq_u32 vcc, v4, v19
    s_nop 1
    v_cndmask_b32 v19, v19, 0, vcc
    v_cmp_eq_u32 vcc, v4, v20
    s_nop 1
    v_cndmask_b32 v20, v20, 0, vcc
    v_cmp_eq_u32 vcc, v4, v21
    s_nop 1
    v_cndmask_b32 v21, v21, 0, vcc
    v_cmp_eq_u32 vcc, v4, v22
    s_nop 1
    v_cndmask_b32 v22, v22, 0, vcc
    v_cmp_eq_u32 vcc, v4, v23
    s_nop 1
    v_cndmask_b32 v23, v23, 0, vcc
    v_cmp_eq_u32 vcc, v4, v24
    s_nop 1
    v_cndmask_b32 v24, v24, 0, vcc
    v_cmp_eq_u32 vcc, v4, v25
    s_nop 1
    v_cndmask_b32 v25, v25, 0, vcc
    v_cmp_eq_u32 vcc, v4, v26
    s_nop 1
    v_cndmask_b32 v26, v26, 0, vcc
    v_cmp_eq_u32 vcc, v4, v27
    s_nop 1
    v_cndmask_b32 v27, v27, 0, vcc
    v_cmp_eq_u32 vcc, v4, v28
    s_nop 1
    v_cndmask_b32 v28, v28, 0, vcc
    v_cmp_eq_u32 vcc, v4, v29
    s_nop 1
    v_cndmask_b32 v29, v29, 0, vcc
    v_cmp_eq_u32 vcc, v4, v30
    s_nop 1
    v_cndmask_b32 v30, v30, 0, vcc
    v_cmp_eq_u32 vcc, v4, v31
    s_nop 1
    v_cndmask_b32 v31, v31, 0, vcc
    v_cmp_eq_u32 vcc, v4, v32
    s_nop 1
    v_cndmask_b32 v32, v32, 0, vcc
    v_cmp_eq_u32 vcc, v4, v33
    s_nop 1
    v_cndmask_b32 v33, v33, 0, vcc
    v_cmp_eq_u32 vcc, v4, v34
    s_nop 1
    v_cndmask_b32 v34, v34, 0, vcc
    v_cmp_eq_u32 vcc, v4, v35
    s_nop 1
    v_cndmask_b32 v35, v35, 0, vcc
    v_cmp_eq_u32 vcc, v4, v36
    s_nop 1
    v_cndmask_b32 v36, v36, 0, vcc
    v_cmp_eq_u32 vcc, v4, v37
    s_nop 1
    v_cndmask_b32 v37, v37, 0, vcc
    v_cmp_eq_u32 vcc, v4, v38
    s_nop 1
    v_cndmask_b32 v38, v38, 0, vcc
    v_cmp_eq_u32 vcc, v4, v39
    s_nop 1
    v_cndmask_b32 v39, v39, 0, vcc
    v_cmp_eq_u32 vcc, v4, v40
    s_nop 1
    v_cndmask_b32 v40, v40, 0, vcc
    v_cmp_eq_u32 vcc, v4, v41
    s_nop 1
    v_cndmask_b32 v41, v41, 0, vcc
    v_cmp_eq_u32 vcc, v4, v42
    s_nop 1
    v_cndmask_b32 v42, v42, 0, vcc
    v_cmp_eq_u32 vcc, v4, v43
    s_nop 1
    v_cndmask_b32 v43, v43, 0, vcc
    v_cmp_eq_u32 vcc, v4, v44
    s_nop 1
    v_cndmask_b32 v44, v44, 0, vcc
    v_cmp_eq_u32 vcc, v4, v45
    s_nop 1
    v_cndmask_b32 v45, v45, 0, vcc
    v_cmp_eq_u32 vcc, v4, v46
    s_nop 1
    v_cndmask_b32 v46, v46, 0, vcc
    v_cmp_eq_u32 vcc, v4, v47
    s_nop 1
    v_cndmask_b32 v47, v47, 0, vcc
    v_max3_u32 v4, v16, v17, v18
    v_max3_u32 v4, v4, v19, v20
    v_max3_u32 v4, v4, v21, v22
    v_max3_u32 v4, v4, v23, v24
    v_max3_u32 v4, v4, v25, v26
    v_max3_u32 v4, v4, v27, v28
    v_max3_u32 v4, v4, v29, v30
    v_max3_u32 v4, v4, v31, v32
    v_max3_u32 v4, v4, v33, v34
    v_max3_u32 v4, v4, v35, v36
    v_max3_u32 v4, v4, v37, v38
    v_max3_u32 v4, v4, v39, v40
    v_max3_u32 v4, v4, v41, v42
    v_max3_u32 v4, v4, v43, v44
    v_max3_u32 v4, v4, v45, v46
    v_max_u32 v4, v4, v47
    s_nop 1
    v_max_u32_dpp v4, v4, v4 quad_perm:[1,0,3,2] row_mask:0xf bank_mask:0xf
    s_nop 1
    v_max_u32_dpp v4, v4, v4 quad_perm:[2,3,0,1] row_mask:0xf bank_mask:0xf
    s_nop 1
    v_max_u32_dpp v4, v4, v4 row_half_mirror row_mask:0xf bank_mask:0xf
    s_nop 1
    v_max_u32_dpp v4, v4, v4 row_mirror row_mask:0xf bank_mask:0xf
    v_mov_b32 v5, v4
    s_nop 1
    v_permlane16_swap_b32 v4, v5
    v_max_u32 v4, v4, v5
    v_mov_b32 v5, v4
    s_nop 1
    v_permlane32_swap_b32 v4, v5
    v_max_u32 v4, v4, v5
    v_mov_b32 v59, v4
    v_cmp_eq_u32 vcc, v4, v16
    s_nop 1
    v_cndmask_b32 v16, v16, 0, vcc
    v_cmp_eq_u32 vcc, v4, v17
    s_nop 1
    v_cndmask_b32 v17, v17, 0, vcc
    v_cmp_eq_u32 vcc, v4, v18
    s_nop 1
    v_cndmask_b32 v18, v18, 0, vcc
    v_cmp_eq_u32 vcc, v4, v19
    s_nop 1
    v_cndmask_b32 v19, v19, 0, vcc
    v_cmp_eq_u32 vcc, v4, v20
    s_nop 1
    v_cndmask_b32 v20, v20, 0, vcc
    v_cmp_eq_u32 vcc, v4, v21
    s_nop 1
    v_cndmask_b32 v21, v21, 0, vcc
    v_cmp_eq_u32 vcc, v4, v22
    s_nop 1
    v_cndmask_b32 v22, v22, 0, vcc
    v_cmp_eq_u32 vcc, v4, v23
    s_nop 1
    v_cndmask_b32 v23, v23, 0, vcc
    v_cmp_eq_u32 vcc, v4, v24
    s_nop 1
    v_cndmask_b32 v24, v24, 0, vcc
    v_cmp_eq_u32 vcc, v4, v25
    s_nop 1
    v_cndmask_b32 v25, v25, 0, vcc
    v_cmp_eq_u32 vcc, v4, v26
    s_nop 1
    v_cndmask_b32 v26, v26, 0, vcc
    v_cmp_eq_u32 vcc, v4, v27
    s_nop 1
    v_cndmask_b32 v27, v27, 0, vcc
    v_cmp_eq_u32 vcc, v4, v28
    s_nop 1
    v_cndmask_b32 v28, v28, 0, vcc
    v_cmp_eq_u32 vcc, v4, v29
    s_nop 1
    v_cndmask_b32 v29, v29, 0, vcc
    v_cmp_eq_u32 vcc, v4, v30
    s_nop 1
    v_cndmask_b32 v30, v30, 0, vcc
    v_cmp_eq_u32 vcc, v4, v31
    s_nop 1
    v_cndmask_b32 v31, v31, 0, vcc
    v_cmp_eq_u32 vcc, v4, v32
    s_nop 1
    v_cndmask_b32 v32, v32, 0, vcc
    v_cmp_eq_u32 vcc, v4, v33
    s_nop 1
    v_cndmask_b32 v33, v33, 0, vcc
    v_cmp_eq_u32 vcc, v4, v34
    s_nop 1
    v_cndmask_b32 v34, v34, 0, vcc
    v_cmp_eq_u32 vcc, v4, v35
    s_nop 1
    v_cndmask_b32 v35, v35, 0, vcc
    v_cmp_eq_u32 vcc, v4, v36
    s_nop 1
    v_cndmask_b32 v36, v36, 0, vcc
    v_cmp_eq_u32 vcc, v4, v37
    s_nop 1
    v_cndmask_b32 v37, v37, 0, vcc
    v_cmp_eq_u32 vcc, v4, v38
    s_nop 1
    v_cndmask_b32 v38, v38, 0, vcc
    v_cmp_eq_u32 vcc, v4, v39
    s_nop 1
    v_cndmask_b32 v39, v39, 0, vcc
    v_cmp_eq_u32 vcc, v4, v40
    s_nop 1
    v_cndmask_b32 v40, v40, 0, vcc
    v_cmp_eq_u32 vcc, v4, v41
    s_nop 1
    v_cndmask_b32 v41, v41, 0, vcc
    v_cmp_eq_u32 vcc, v4, v42
    s_nop 1
    v_cndmask_b32 v42, v42, 0, vcc
    v_cmp_eq_u32 vcc, v4, v43
    s_nop 1
    v_cndmask_b32 v43, v43, 0, vcc
    v_cmp_eq_u32 vcc, v4, v44
    s_nop 1
    v_cndmask_b32 v44, v44, 0, vcc
    v_cmp_eq_u32 vcc, v4, v45
    s_nop 1
    v_cndmask_b32 v45, v45, 0, vcc
    v_cmp_eq_u32 vcc, v4, v46
    s_nop 1
    v_cndmask_b32 v46, v46, 0, vcc
    v_cmp_eq_u32 vcc, v4, v47
    s_nop 1
    v_cndmask_b32 v47, v47, 0, vcc
    v_max3_u32 v4, v16, v17, v18
    v_max3_u32 v4, v4, v19, v20
    v_max3_u32 v4, v4, v21, v22
    v_max3_u32 v4, v4, v23, v24
    v_max3_u32 v4, v4, v25, v26
    v_max3_u32 v4, v4, v27, v28
    v_max3_u32 v4, v4, v29, v30
    v_max3_u32 v4, v4, v31, v32
    v_max3_u32 v4, v4, v33, v34
    v_max3_u32 v4, v4, v35, v36
    v_max3_u32 v4, v4, v37, v38
    v_max3_u32 v4, v4, v39, v40
    v_max3_u32 v4, v4, v41, v42
    v_max3_u32 v4, v4, v43, v44
    v_max3_u32 v4, v4, v45, v46
    v_max_u32 v4, v4, v47
    s_nop 1
    v_max_u32_dpp v4, v4, v4 quad_perm:[1,0,3,2] row_mask:0xf bank_mask:0xf
    s_nop 1
    v_max_u32_dpp v4, v4, v4 quad_perm:[2,3,0,1] row_mask:0xf bank_mask:0xf
    s_nop 1
    v_max_u32_dpp v4, v4, v4 row_half_mirror row_mask:0xf bank_mask:0xf
    s_nop 1
    v_max_u32_dpp v4, v4, v4 row_mirror row_mask:0xf bank_mask:0xf
    v_mov_b32 v5, v4
    s_nop 1
    v_permlane16_swap_b32 v4, v5
    v_max_u32 v4, v4, v5
    v_mov_b32 v5, v4
    s_nop 1
    v_permlane32_swap_b32 v4, v5
    v_max_u32 v4, v4, v5
    v_mov_b32 v60, v4
    v_cmp_eq_u32 vcc, v4, v16
    s_nop 1
    v_cndmask_b32 v16, v16, 0, vcc
    v_cmp_eq_u32 vcc, v4, v17
    s_nop 1
    v_cndmask_b32 v17, v17, 0, vcc
    v_cmp_eq_u32 vcc, v4, v18
    s_nop 1
    v_cndmask_b32 v18, v18, 0, vcc
    v_cmp_eq_u32 vcc, v4, v19
    s_nop 1
    v_cndmask_b32 v19, v19, 0, vcc
    v_cmp_eq_u32 vcc, v4, v20
    s_nop 1
    v_cndmask_b32 v20, v20, 0, vcc
    v_cmp_eq_u32 vcc, v4, v21
    s_nop 1
    v_cndmask_b32 v21, v21, 0, vcc
    v_cmp_eq_u32 vcc, v4, v22
    s_nop 1
    v_cndmask_b32 v22, v22, 0, vcc
    v_cmp_eq_u32 vcc, v4, v23
    s_nop 1
    v_cndmask_b32 v23, v23, 0, vcc
    v_cmp_eq_u32 vcc, v4, v24
    s_nop 1
    v_cndmask_b32 v24, v24, 0, vcc
    v_cmp_eq_u32 vcc, v4, v25
    s_nop 1
    v_cndmask_b32 v25, v25, 0, vcc
    v_cmp_eq_u32 vcc, v4, v26
    s_nop 1
    v_cndmask_b32 v26, v26, 0, vcc
    v_cmp_eq_u32 vcc, v4, v27
    s_nop 1
    v_cndmask_b32 v27, v27, 0, vcc
    v_cmp_eq_u32 vcc, v4, v28
    s_nop 1
    v_cndmask_b32 v28, v28, 0, vcc
    v_cmp_eq_u32 vcc, v4, v29
    s_nop 1
    v_cndmask_b32 v29, v29, 0, vcc
    v_cmp_eq_u32 vcc, v4, v30
    s_nop 1
    v_cndmask_b32 v30, v30, 0, vcc
    v_cmp_eq_u32 vcc, v4, v31
    s_nop 1
    v_cndmask_b32 v31, v31, 0, vcc
    v_cmp_eq_u32 vcc, v4, v32
    s_nop 1
    v_cndmask_b32 v32, v32, 0, vcc
    v_cmp_eq_u32 vcc, v4, v33
    s_nop 1
    v_cndmask_b32 v33, v33, 0, vcc
    v_cmp_eq_u32 vcc, v4, v34
    s_nop 1
    v_cndmask_b32 v34, v34, 0, vcc
    v_cmp_eq_u32 vcc, v4, v35
    s_nop 1
    v_cndmask_b32 v35, v35, 0, vcc
    v_cmp_eq_u32 vcc, v4, v36
    s_nop 1
    v_cndmask_b32 v36, v36, 0, vcc
    v_cmp_eq_u32 vcc, v4, v37
    s_nop 1
    v_cndmask_b32 v37, v37, 0, vcc
    v_cmp_eq_u32 vcc, v4, v38
    s_nop 1
    v_cndmask_b32 v38, v38, 0, vcc
    v_cmp_eq_u32 vcc, v4, v39
    s_nop 1
    v_cndmask_b32 v39, v39, 0, vcc
    v_cmp_eq_u32 vcc, v4, v40
    s_nop 1
    v_cndmask_b32 v40, v40, 0, vcc
    v_cmp_eq_u32 vcc, v4, v41
    s_nop 1
    v_cndmask_b32 v41, v41, 0, vcc
    v_cmp_eq_u32 vcc, v4, v42
    s_nop 1
    v_cndmask_b32 v42, v42, 0, vcc
    v_cmp_eq_u32 vcc, v4, v43
    s_nop 1
    v_cndmask_b32 v43, v43, 0, vcc
    v_cmp_eq_u32 vcc, v4, v44
    s_nop 1
    v_cndmask_b32 v44, v44, 0, vcc
    v_cmp_eq_u32 vcc, v4, v45
    s_nop 1
    v_cndmask_b32 v45, v45, 0, vcc
    v_cmp_eq_u32 vcc, v4, v46
    s_nop 1
    v_cndmask_b32 v46, v46, 0, vcc
    v_cmp_eq_u32 vcc, v4, v47
    s_nop 1
    v_cndmask_b32 v47, v47, 0, vcc
    v_max3_u32 v4, v16, v17, v18
    v_max3_u32 v4, v4, v19, v20
    v_max3_u32 v4, v4, v21, v22
    v_max3_u32 v4, v4, v23, v24
    v_max3_u32 v4, v4, v25, v26
    v_max3_u32 v4, v4, v27, v28
    v_max3_u32 v4, v4, v29, v30
    v_max3_u32 v4, v4, v31, v32
    v_max3_u32 v4, v4, v33, v34
    v_max3_u32 v4, v4, v35, v36
    v_max3_u32 v4, v4, v37, v38
    v_max3_u32 v4, v4, v39, v40
    v_max3_u32 v4, v4, v41, v42
    v_max3_u32 v4, v4, v43, v44
    v_max3_u32 v4, v4, v45, v46
    v_max_u32 v4, v4, v47
    s_nop 1
    v_max_u32_dpp v4, v4, v4 quad_perm:[1,0,3,2] row_mask:0xf bank_mask:0xf
    s_nop 1
    v_max_u32_dpp v4, v4, v4 quad_perm:[2,3,0,1] row_mask:0xf bank_mask:0xf
    s_nop 1
    v_max_u32_dpp v4, v4, v4 row_half_mirror row_mask:0xf bank_mask:0xf
    s_nop 1
    v_max_u32_dpp v4, v4, v4 row_mirror row_mask:0xf bank_mask:0xf
    v_mov_b32 v5, v4
    s_nop 1
    v_permlane16_swap_b32 v4, v5
    v_max_u32 v4, v4, v5
    v_mov_b32 v5, v4
    s_nop 1
    v_permlane32_swap_b32 v4, v5
    v_max_u32 v4, v4, v5
    v_mov_b32 v61, v4
    v_cmp_eq_u32 vcc, v4, v16
    s_nop 1
    v_cndmask_b32 v16, v16, 0, vcc
    v_cmp_eq_u32 vcc, v4, v17
    s_nop 1
    v_cndmask_b32 v17, v17, 0, vcc
    v_cmp_eq_u32 vcc, v4, v18
    s_nop 1
    v_cndmask_b32 v18, v18, 0, vcc
    v_cmp_eq_u32 vcc, v4, v19
    s_nop 1
    v_cndmask_b32 v19, v19, 0, vcc
    v_cmp_eq_u32 vcc, v4, v20
    s_nop 1
    v_cndmask_b32 v20, v20, 0, vcc
    v_cmp_eq_u32 vcc, v4, v21
    s_nop 1
    v_cndmask_b32 v21, v21, 0, vcc
    v_cmp_eq_u32 vcc, v4, v22
    s_nop 1
    v_cndmask_b32 v22, v22, 0, vcc
    v_cmp_eq_u32 vcc, v4, v23
    s_nop 1
    v_cndmask_b32 v23, v23, 0, vcc
    v_cmp_eq_u32 vcc, v4, v24
    s_nop 1
    v_cndmask_b32 v24, v24, 0, vcc
    v_cmp_eq_u32 vcc, v4, v25
    s_nop 1
    v_cndmask_b32 v25, v25, 0, vcc
    v_cmp_eq_u32 vcc, v4, v26
    s_nop 1
    v_cndmask_b32 v26, v26, 0, vcc
    v_cmp_eq_u32 vcc, v4, v27
    s_nop 1
    v_cndmask_b32 v27, v27, 0, vcc
    v_cmp_eq_u32 vcc, v4, v28
    s_nop 1
    v_cndmask_b32 v28, v28, 0, vcc
    v_cmp_eq_u32 vcc, v4, v29
    s_nop 1
    v_cndmask_b32 v29, v29, 0, vcc
    v_cmp_eq_u32 vcc, v4, v30
    s_nop 1
    v_cndmask_b32 v30, v30, 0, vcc
    v_cmp_eq_u32 vcc, v4, v31
    s_nop 1
    v_cndmask_b32 v31, v31, 0, vcc
    v_cmp_eq_u32 vcc, v4, v32
    s_nop 1
    v_cndmask_b32 v32, v32, 0, vcc
    v_cmp_eq_u32 vcc, v4, v33
    s_nop 1
    v_cndmask_b32 v33, v33, 0, vcc
    v_cmp_eq_u32 vcc, v4, v34
    s_nop 1
    v_cndmask_b32 v34, v34, 0, vcc
    v_cmp_eq_u32 vcc, v4, v35
    s_nop 1
    v_cndmask_b32 v35, v35, 0, vcc
    v_cmp_eq_u32 vcc, v4, v36
    s_nop 1
    v_cndmask_b32 v36, v36, 0, vcc
    v_cmp_eq_u32 vcc, v4, v37
    s_nop 1
    v_cndmask_b32 v37, v37, 0, vcc
    v_cmp_eq_u32 vcc, v4, v38
    s_nop 1
    v_cndmask_b32 v38, v38, 0, vcc
    v_cmp_eq_u32 vcc, v4, v39
    s_nop 1
    v_cndmask_b32 v39, v39, 0, vcc
    v_cmp_eq_u32 vcc, v4, v40
    s_nop 1
    v_cndmask_b32 v40, v40, 0, vcc
    v_cmp_eq_u32 vcc, v4, v41
    s_nop 1
    v_cndmask_b32 v41, v41, 0, vcc
    v_cmp_eq_u32 vcc, v4, v42
    s_nop 1
    v_cndmask_b32 v42, v42, 0, vcc
    v_cmp_eq_u32 vcc, v4, v43
    s_nop 1
    v_cndmask_b32 v43, v43, 0, vcc
    v_cmp_eq_u32 vcc, v4, v44
    s_nop 1
    v_cndmask_b32 v44, v44, 0, vcc
    v_cmp_eq_u32 vcc, v4, v45
    s_nop 1
    v_cndmask_b32 v45, v45, 0, vcc
    v_cmp_eq_u32 vcc, v4, v46
    s_nop 1
    v_cndmask_b32 v46, v46, 0, vcc
    v_cmp_eq_u32 vcc, v4, v47
    s_nop 1
    v_cndmask_b32 v47, v47, 0, vcc
    v_max3_u32 v4, v16, v17, v18
    v_max3_u32 v4, v4, v19, v20
    v_max3_u32 v4, v4, v21, v22
    v_max3_u32 v4, v4, v23, v24
    v_max3_u32 v4, v4, v25, v26
    v_max3_u32 v4, v4, v27, v28
    v_max3_u32 v4, v4, v29, v30
    v_max3_u32 v4, v4, v31, v32
    v_max3_u32 v4, v4, v33, v34
    v_max3_u32 v4, v4, v35, v36
    v_max3_u32 v4, v4, v37, v38
    v_max3_u32 v4, v4, v39, v40
    v_max3_u32 v4, v4, v41, v42
    v_max3_u32 v4, v4, v43, v44
    v_max3_u32 v4, v4, v45, v46
    v_max_u32 v4, v4, v47
    s_nop 1
    v_max_u32_dpp v4, v4, v4 quad_perm:[1,0,3,2] row_mask:0xf bank_mask:0xf
    s_nop 1
    v_max_u32_dpp v4, v4, v4 quad_perm:[2,3,0,1] row_mask:0xf bank_mask:0xf
    s_nop 1
    v_max_u32_dpp v4, v4, v4 row_half_mirror row_mask:0xf bank_mask:0xf
    s_nop 1
    v_max_u32_dpp v4, v4, v4 row_mirror row_mask:0xf bank_mask:0xf
    v_mov_b32 v5, v4
    s_nop 1
    v_permlane16_swap_b32 v4, v5
    v_max_u32 v4, v4, v5
    v_mov_b32 v5, v4
    s_nop 1
    v_permlane32_swap_b32 v4, v5
    v_max_u32 v4, v4, v5
    v_mov_b32 v62, v4
    v_cmp_eq_u32 vcc, v4, v16
    s_nop 1
    v_cndmask_b32 v16, v16, 0, vcc
    v_cmp_eq_u32 vcc, v4, v17
    s_nop 1
    v_cndmask_b32 v17, v17, 0, vcc
    v_cmp_eq_u32 vcc, v4, v18
    s_nop 1
    v_cndmask_b32 v18, v18, 0, vcc
    v_cmp_eq_u32 vcc, v4, v19
    s_nop 1
    v_cndmask_b32 v19, v19, 0, vcc
    v_cmp_eq_u32 vcc, v4, v20
    s_nop 1
    v_cndmask_b32 v20, v20, 0, vcc
    v_cmp_eq_u32 vcc, v4, v21
    s_nop 1
    v_cndmask_b32 v21, v21, 0, vcc
    v_cmp_eq_u32 vcc, v4, v22
    s_nop 1
    v_cndmask_b32 v22, v22, 0, vcc
    v_cmp_eq_u32 vcc, v4, v23
    s_nop 1
    v_cndmask_b32 v23, v23, 0, vcc
    v_cmp_eq_u32 vcc, v4, v24
    s_nop 1
    v_cndmask_b32 v24, v24, 0, vcc
    v_cmp_eq_u32 vcc, v4, v25
    s_nop 1
    v_cndmask_b32 v25, v25, 0, vcc
    v_cmp_eq_u32 vcc, v4, v26
    s_nop 1
    v_cndmask_b32 v26, v26, 0, vcc
    v_cmp_eq_u32 vcc, v4, v27
    s_nop 1
    v_cndmask_b32 v27, v27, 0, vcc
    v_cmp_eq_u32 vcc, v4, v28
    s_nop 1
    v_cndmask_b32 v28, v28, 0, vcc
    v_cmp_eq_u32 vcc, v4, v29
    s_nop 1
    v_cndmask_b32 v29, v29, 0, vcc
    v_cmp_eq_u32 vcc, v4, v30
    s_nop 1
    v_cndmask_b32 v30, v30, 0, vcc
    v_cmp_eq_u32 vcc, v4, v31
    s_nop 1
    v_cndmask_b32 v31, v31, 0, vcc
    v_cmp_eq_u32 vcc, v4, v32
    s_nop 1
    v_cndmask_b32 v32, v32, 0, vcc
    v_cmp_eq_u32 vcc, v4, v33
    s_nop 1
    v_cndmask_b32 v33, v33, 0, vcc
    v_cmp_eq_u32 vcc, v4, v34
    s_nop 1
    v_cndmask_b32 v34, v34, 0, vcc
    v_cmp_eq_u32 vcc, v4, v35
    s_nop 1
    v_cndmask_b32 v35, v35, 0, vcc
    v_cmp_eq_u32 vcc, v4, v36
    s_nop 1
    v_cndmask_b32 v36, v36, 0, vcc
    v_cmp_eq_u32 vcc, v4, v37
    s_nop 1
    v_cndmask_b32 v37, v37, 0, vcc
    v_cmp_eq_u32 vcc, v4, v38
    s_nop 1
    v_cndmask_b32 v38, v38, 0, vcc
    v_cmp_eq_u32 vcc, v4, v39
    s_nop 1
    v_cndmask_b32 v39, v39, 0, vcc
    v_cmp_eq_u32 vcc, v4, v40
    s_nop 1
    v_cndmask_b32 v40, v40, 0, vcc
    v_cmp_eq_u32 vcc, v4, v41
    s_nop 1
    v_cndmask_b32 v41, v41, 0, vcc
    v_cmp_eq_u32 vcc, v4, v42
    s_nop 1
    v_cndmask_b32 v42, v42, 0, vcc
    v_cmp_eq_u32 vcc, v4, v43
    s_nop 1
    v_cndmask_b32 v43, v43, 0, vcc
    v_cmp_eq_u32 vcc, v4, v44
    s_nop 1
    v_cndmask_b32 v44, v44, 0, vcc
    v_cmp_eq_u32 vcc, v4, v45
    s_nop 1
    v_cndmask_b32 v45, v45, 0, vcc
    v_cmp_eq_u32 vcc, v4, v46
    s_nop 1
    v_cndmask_b32 v46, v46, 0, vcc
    v_cmp_eq_u32 vcc, v4, v47
    s_nop 1
    v_cndmask_b32 v47, v47, 0, vcc
    v_max3_u32 v4, v16, v17, v18
    v_max3_u32 v4, v4, v19, v20
    v_max3_u32 v4, v4, v21, v22
    v_max3_u32 v4, v4, v23, v24
    v_max3_u32 v4, v4, v25, v26
    v_max3_u32 v4, v4, v27, v28
    v_max3_u32 v4, v4, v29, v30
    v_max3_u32 v4, v4, v31, v32
    v_max3_u32 v4, v4, v33, v34
    v_max3_u32 v4, v4, v35, v36
    v_max3_u32 v4, v4, v37, v38
    v_max3_u32 v4, v4, v39, v40
    v_max3_u32 v4, v4, v41, v42
    v_max3_u32 v4, v4, v43, v44
    v_max3_u32 v4, v4, v45, v46
    v_max_u32 v4, v4, v47
    s_nop 1
    v_max_u32_dpp v4, v4, v4 quad_perm:[1,0,3,2] row_mask:0xf bank_mask:0xf
    s_nop 1
    v_max_u32_dpp v4, v4, v4 quad_perm:[2,3,0,1] row_mask:0xf bank_mask:0xf
    s_nop 1
    v_max_u32_dpp v4, v4, v4 row_half_mirror row_mask:0xf bank_mask:0xf
    s_nop 1
    v_max_u32_dpp v4, v4, v4 row_mirror row_mask:0xf bank_mask:0xf
    v_mov_b32 v5, v4
    s_nop 1
    v_permlane16_swap_b32 v4, v5
    v_max_u32 v4, v4, v5
    v_mov_b32 v5, v4
    s_nop 1
    v_permlane32_swap_b32 v4, v5
    v_max_u32 v4, v4, v5
    v_mov_b32 v63, v4
    v_mov_b32 v4, v56
    v_cmp_eq_u32 vcc, 1, v0
    s_nop 1
    v_cndmask_b32 v4, v4, v57, vcc
    v_cmp_eq_u32 vcc, 2, v0
    s_nop 1
    v_cndmask_b32 v4, v4, v58, vcc
    v_cmp_eq_u32 vcc, 3, v0
    s_nop 1
    v_cndmask_b32 v4, v4, v59, vcc
    v_cmp_eq_u32 vcc, 4, v0
    s_nop 1
    v_cndmask_b32 v4, v4, v60, vcc
    v_cmp_eq_u32 vcc, 5, v0
    s_nop 1
    v_cndmask_b32 v4, v4, v61, vcc
    v_cmp_eq_u32 vcc, 6, v0
    s_nop 1
    v_cndmask_b32 v4, v4, v62, vcc
    v_cmp_eq_u32 vcc, 7, v0
    s_nop 1
    v_cndmask_b32 v4, v4, v63, vcc
    v_and_b32 v5, 0xffff, v4
    v_sub_u32 v5, 0xffff, v5
    v_and_b32 v4, 0xffff0000, v4
    v_ashrrev_i32 v3, 31, v4
    v_not_b32 v3, v3
    v_or_b32 v3, 0x80000000, v3
    v_xor_b32 v4, v4, v3
    v_and_b32 v4, 0xffff0000, v4
    v_mul_f32 v4, 0xbfb8aa3b, v4
    v_exp_f32 v4, v4
    s_nop 0
    v_add_f32 v4, 1.0, v4
    v_rcp_f32 v4, v4
    s_nop 0
    v_cvt_pk_bf16_f32 v4, v4, v4
    v_lshlrev_b32 v4, 16, v4
    v_lshlrev_b32 v6, 2, v0
    s_mov_b32 s64, 0x5400000
    s_mov_b64 exec, 0xff
    buffer_store_dword v5, v6, s[4:7], s64 offen sc1
    buffer_store_dword v4, v6, s[4:7], s64 offen offset:32 sc1
    s_mov_b64 exec, -1
    s_waitcnt vmcnt(0)
    v_mov_b32 v7, 1
    v_mov_b32 v8, 0
    s_mov_b32 s64, 0x298000
    s_mov_b64 exec, 1
    buffer_atomic_add v7, v8, s[4:7], s64 offen sc1
    s_mov_b64 exec, -1
    v_mbcnt_lo_u32_b32 v0, -1, 0
    v_mbcnt_hi_u32_b32 v0, -1, v0
NOSEL_105:
    v_lshlrev_b32 v1, 4, v0
    v_lshrrev_b32 v6, 3, v0
    v_mul_u32_u24 v2, 1280, v6
    v_and_b32 v7, 7, v0
    v_xor_b32 v7, v7, v6
    v_lshl_add_u32 v2, v7, 4, v2
    v_bfe_u32 v6, v0, 3, 1
    v_lshlrev_b32 v9, 10, v6
    v_and_b32 v6, 7, v0
    v_lshl_add_u32 v9, v6, 7, v9
    v_lshrrev_b32 v7, 4, v0
    v_xor_b32 v7, v7, v6
    v_lshl_add_u32 v3, v7, 4, v9
    v_xor_b32 v7, 4, v7
    v_lshl_add_u32 v4, v7, 4, v9
    v_add_u32 v6, 0x10000, v3
    v_add_u32 v9, 0x10000, v4
    s_barrier
    s_mul_i32 s20, s12, 163840
    s_mul_i32 s64, s14, 40960
    s_add_u32 s20, s20, s64
    s_add_u32 s20, s20, 0x0
    s_lshl_b32 s21, s14, 12
    s_add_u32 m0, s21, 0
    s_add_u32 s64, s20, 0x0
    buffer_load_dwordx4 v2, s[4:7], s64 offen lds
    s_add_u32 m0, s21, 1024
    s_add_u32 s64, s20, 0x2800
    buffer_load_dwordx4 v2, s[4:7], s64 offen lds
    s_add_u32 m0, s21, 2048
    s_add_u32 s64, s20, 0x5000
    buffer_load_dwordx4 v2, s[4:7], s64 offen lds
    s_add_u32 m0, s21, 3072
    s_add_u32 s64, s20, 0x7800
    buffer_load_dwordx4 v2, s[4:7], s64 offen lds
    s_add_u32 m0, s21, 16384
    s_add_u32 s64, s20, 0x80
    buffer_load_dwordx4 v2, s[4:7], s64 offen lds
    s_add_u32 m0, s21, 17408
    s_add_u32 s64, s20, 0x2880
    buffer_load_dwordx4 v2, s[4:7], s64 offen lds
    s_add_u32 m0, s21, 18432
    s_add_u32 s64, s20, 0x5080
    buffer_load_dwordx4 v2, s[4:7], s64 offen lds
    s_add_u32 m0, s21, 19456
    s_add_u32 s64, s20, 0x7880
    buffer_load_dwordx4 v2, s[4:7], s64 offen lds
    s_add_u32 m0, s21, 32768
    s_add_u32 s64, s20, 0x100
    buffer_load_dwordx4 v2, s[4:7], s64 offen lds
    s_add_u32 m0, s21, 33792
    s_add_u32 s64, s20, 0x2900
    buffer_load_dwordx4 v2, s[4:7], s64 offen lds
    s_add_u32 m0, s21, 34816
    s_add_u32 s64, s20, 0x5100
    buffer_load_dwordx4 v2, s[4:7], s64 offen lds
    s_add_u32 m0, s21, 35840
    s_add_u32 s64, s20, 0x7900
    buffer_load_dwordx4 v2, s[4:7], s64 offen lds
    s_add_u32 m0, s21, 49152
    s_add_u32 s64, s20, 0x180
    buffer_load_dwordx4 v2, s[4:7], s64 offen lds
    s_add_u32 m0, s21, 50176
    s_add_u32 s64, s20, 0x2980
    buffer_load_dwordx4 v2, s[4:7], s64 offen lds
    s_add_u32 m0, s21, 51200
    s_add_u32 s64, s20, 0x5180
    buffer_load_dwordx4 v2, s[4:7], s64 offen lds
    s_add_u32 m0, s21, 52224
    s_add_u32 s64, s20, 0x7980
    buffer_load_dwordx4 v2, s[4:7], s64 offen lds
    s_mov_b32 s64, 0x40000000
    buffer_store_dword v7, v1, s[4:7], s64 offen
    buffer_store_dword v7, v1, s[4:7], s64 offen
    buffer_store_dword v7, v1, s[4:7], s64 offen
    buffer_store_dword v7, v1, s[4:7], s64 offen
    buffer_store_dword v7, v1, s[4:7], s64 offen
    buffer_store_dword v7, v1, s[4:7], s64 offen
    buffer_store_dword v7, v1, s[4:7], s64 offen
    buffer_store_dword v7, v1, s[4:7], s64 offen
    s_waitcnt vmcnt(20)
    s_barrier
    ds_read_b128 a[0:3], v3 offset:0
    ds_read_b128 a[4:7], v3 offset:2048
    ds_read_b128 a[8:11], v3 offset:4096
    ds_read_b128 a[12:15], v3 offset:6144
    ds_read_b128 a[16:19], v3 offset:8192
    ds_read_b128 a[20:23], v3 offset:10240
    ds_read_b128 a[24:27], v3 offset:12288
    ds_read_b128 a[28:31], v3 offset:14336
    s_mov_b32 s19, 0
    s_mov_b32 s22, s16
    s_mov_b32 s23, 0x40000000
G_T_LOOP:
    s_waitcnt lgkmcnt(4)
    v_mfma_f32_16x16x32_bf16 v[16:19], v[96:99], a[0:3], 0
    v_mfma_f32_16x16x32_bf16 v[20:23], v[100:103], a[0:3], 0
    ds_read_b128 a[32:35], v4 offset:0
    v_mfma_f32_16x16x32_bf16 v[24:27], v[96:99], a[4:7], 0
    v_mfma_f32_16x16x32_bf16 v[28:31], v[100:103], a[4:7], 0
    ds_read_b128 a[36:39], v4 offset:2048
    v_mfma_f32_16x16x32_bf16 v[32:35], v[96:99], a[8:11], 0
    v_mfma_f32_16x16x32_bf16 v[36:39], v[100:103], a[8:11], 0
    ds_read_b128 a[40:43], v4 offset:4096
    v_mfma_f32_16x16x32_bf16 v[40:43], v[96:99], a[12:15], 0
    v_mfma_f32_16x16x32_bf16 v[44:47], v[100:103], a[12:15], 0
    ds_read_b128 a[44:47], v4 offset:6144
    s_waitcnt lgkmcnt(4)
    v_mfma_f32_16x16x32_bf16 v[48:51], v[96:99], a[16:19], 0
    v_mfma_f32_16x16x32_bf16 v[52:55], v[100:103], a[16:19], 0
    ds_read_b128 a[48:51], v4 offset:8192
    v_mfma_f32_16x16x32_bf16 v[56:59], v[96:99], a[20:23], 0
    v_mfma_f32_16x16x32_bf16 v[60:63], v[100:103], a[20:23], 0
    ds_read_b128 a[52:55], v4 offset:10240
    v_mfma_f32_16x16x32_bf16 v[64:67], v[96:99], a[24:27], 0
    v_mfma_f32_16x16x32_bf16 v[68:71], v[100:103], a[24:27], 0
    ds_read_b128 a[56:59], v4 offset:12288
    v_mfma_f32_16x16x32_bf16 v[72:75], v[96:99], a[28:31], 0
    v_mfma_f32_16x16x32_bf16 v[76:79], v[100:103], a[28:31], 0
    ds_read_b128 a[60:63], v4 offset:14336
    s_waitcnt vmcnt(16)
    s_barrier
    s_waitcnt lgkmcnt(4)
    v_mfma_f32_16x16x32_bf16 v[16:19], v[104:107], a[32:35], v[16:19]
    v_mfma_f32_16x16x32_bf16 v[20:23], v[108:111], a[32:35], v[20:23]
    ds_read_b128 a[0:3], v3 offset:16384
    s_add_u32 m0, s21, 65536
    v_mfma_f32_16x16x32_bf16 v[24:27], v[104:107], a[36:39], v[24:27]
    v_mfma_f32_16x16x32_bf16 v[28:31], v[108:111], a[36:39], v[28:31]
    ds_read_b128 a[4:7], v3 offset:18432
    s_add_u32 s64, s20, 0x200
    buffer_load_dwordx4 v2, s[4:7], s64 offen lds
    v_mfma_f32_16x16x32_bf16 v[32:35], v[104:107], a[40:43], v[32:35]
    v_mfma_f32_16x16x32_bf16 v[36:39], v[108:111], a[40:43], v[36:39]
    ds_read_b128 a[8:11], v3 offset:20480
    s_add_u32 m0, s21, 66560
    v_mfma_f32_16x16x32_bf16 v[40:43], v[104:107], a[44:47], v[40:43]
    v_mfma_f32_16x16x32_bf16 v[44:47], v[108:111], a[44:47], v[44:47]
    ds_read_b128 a[12:15], v3 offset:22528
    s_add_u32 s64, s20, 0x2a00
    buffer_load_dwordx4 v2, s[4:7], s64 offen lds
    s_waitcnt lgkmcnt(4)
    v_mfma_f32_16x16x32_bf16 v[48:51], v[104:107], a[48:51], v[48:51]
    v_mfma_f32_16x16x32_bf16 v[52:55], v[108:111], a[48:51], v[52:55]
    ds_read_b128 a[16:19], v3 offset:24576
    s_add_u32 m0, s21, 67584
    v_mfma_f32_16x16x32_bf16 v[56:59], v[104:107], a[52:55], v[56:59]
    v_mfma_f32_16x16x32_bf16 v[60:63], v[108:111], a[52:55], v[60:63]
    ds_read_b128 a[20:23], v3 offset:26624
    s_add_u32 s64, s20, 0x5200
    buffer_load_dwordx4 v2, s[4:7], s64 offen lds
    v_mfma_f32_16x16x32_bf16 v[64:67], v[104:107], a[56:59], v[64:67]
    v_mfma_f32_16x16x32_bf16 v[68:71], v[108:111], a[56:59], v[68:71]
    ds_read_b128 a[24:27], v3 offset:28672
    s_add_u32 m0, s21, 68608
    v_mfma_f32_16x16x32_bf16 v[72:75], v[104:107], a[60:63], v[72:75]
    v_mfma_f32_16x16x32_bf16 v[76:79], v[108:111], a[60:63], v[76:79]
    ds_read_b128 a[28:31], v3 offset:30720
    s_add_u32 s64, s20, 0x7a00
    buffer_load_dwordx4 v2, s[4:7], s64 offen lds
    s_waitcnt lgkmcnt(4)
    v_mfma_f32_16x16x32_bf16 v[16:19], v[112:115], a[0:3], v[16:19]
    v_mfma_f32_16x16x32_bf16 v[20:23], v[116:119], a[0:3], v[20:23]
    ds_read_b128 a[32:35], v4 offset:16384
    v_mfma_f32_16x16x32_bf16 v[24:27], v[112:115], a[4:7], v[24:27]
    v_mfma_f32_16x16x32_bf16 v[28:31], v[116:119], a[4:7], v[28:31]
    ds_read_b128 a[36:39], v4 offset:18432
    v_mfma_f32_16x16x32_bf16 v[32:35], v[112:115], a[8:11], v[32:35]
    v_mfma_f32_16x16x32_bf16 v[36:39], v[116:119], a[8:11], v[36:39]
    ds_read_b128 a[40:43], v4 offset:20480
    v_mfma_f32_16x16x32_bf16 v[40:43], v[112:115], a[12:15], v[40:43]
    v_mfma_f32_16x16x32_bf16 v[44:47], v[116:119], a[12:15], v[44:47]
    ds_read_b128 a[44:47], v4 offset:22528
    s_waitcnt lgkmcnt(4)
    v_mfma_f32_16x16x32_bf16 v[48:51], v[112:115], a[16:19], v[48:51]
    v_mfma_f32_16x16x32_bf16 v[52:55], v[116:119], a[16:19], v[52:55]
    ds_read_b128 a[48:51], v4 offset:24576
    v_mfma_f32_16x16x32_bf16 v[56:59], v[112:115], a[20:23], v[56:59]
    v_mfma_f32_16x16x32_bf16 v[60:63], v[116:119], a[20:23], v[60:63]
    ds_read_b128 a[52:55], v4 offset:26624
    v_mfma_f32_16x16x32_bf16 v[64:67], v[112:115], a[24:27], v[64:67]
    v_mfma_f32_16x16x32_bf16 v[68:71], v[116:119], a[24:27], v[68:71]
    ds_read_b128 a[56:59], v4 offset:28672
    v_mfma_f32_16x16x32_bf16 v[72:75], v[112:115], a[28:31], v[72:75]
    v_mfma_f32_16x16x32_bf16 v[76:79], v[116:119], a[28:31], v[76:79]
    ds_read_b128 a[60:63], v4 offset:30720
    s_waitcnt vmcnt(16)
    s_barrier
    s_waitcnt lgkmcnt(4)
    v_mfma_f32_16x16x32_bf16 v[16:19], v[120:123], a[32:35], v[16:19]
    v_mfma_f32_16x16x32_bf16 v[20:23], v[124:127], a[32:35], v[20:23]
    ds_read_b128 a[0:3], v3 offset:32768
    s_add_u32 m0, s21, 0
    v_mfma_f32_16x16x32_bf16 v[24:27], v[120:123], a[36:39], v[24:27]
    v_mfma_f32_16x16x32_bf16 v[28:31], v[124:127], a[36:39], v[28:31]
    ds_read_b128 a[4:7], v3 offset:34816
    s_add_u32 s64, s20, 0x280
    buffer_load_dwordx4 v2, s[4:7], s64 offen lds
    v_mfma_f32_16x16x32_bf16 v[32:35], v[120:123], a[40:43], v[32:35]
    v_mfma_f32_16x16x32_bf16 v[36:39], v[124:127], a[40:43], v[36:39]
    ds_read_b128 a[8:11], v3 offset:36864
    s_add_u32 m0, s21, 1024
    v_mfma_f32_16x16x32_bf16 v[40:43], v[120:123], a[44:47], v[40:43]
    v_mfma_f32_16x16x32_bf16 v[44:47], v[124:127], a[44:47], v[44:47]
    ds_read_b128 a[12:15], v3 offset:38912
    s_add_u32 s64, s20, 0x2a80
    buffer_load_dwordx4 v2, s[4:7], s64 offen lds
    s_waitcnt lgkmcnt(4)
    v_mfma_f32_16x16x32_bf16 v[48:51], v[120:123], a[48:51], v[48:51]
    v_mfma_f32_16x16x32_bf16 v[52:55], v[124:127], a[48:51], v[52:55]
    ds_read_b128 a[16:19], v3 offset:40960
    s_add_u32 m0, s21, 2048
    v_mfma_f32_16x16x32_bf16 v[56:59], v[120:123], a[52:55], v[56:59]
    v_mfma_f32_16x16x32_bf16 v[60:63], v[124:127], a[52:55], v[60:63]
    ds_read_b128 a[20:23], v3 offset:43008
    s_add_u32 s64, s20, 0x5280
    buffer_load_dwordx4 v2, s[4:7], s64 offen lds
    v_mfma_f32_16x16x32_bf16 v[64:67], v[120:123], a[56:59], v[64:67]
    v_mfma_f32_16x16x32_bf16 v[68:71], v[124:127], a[56:59], v[68:71]
    ds_read_b128 a[24:27], v3 offset:45056
    s_add_u32 m0, s21, 3072
    v_mfma_f32_16x16x32_bf16 v[72:75], v[120:123], a[60:63], v[72:75]
    v_mfma_f32_16x16x32_bf16 v[76:79], v[124:127], a[60:63], v[76:79]
    ds_read_b128 a[28:31], v3 offset:47104
    s_add_u32 s64, s20, 0x7a80
    buffer_load_dwordx4 v2, s[4:7], s64 offen lds
    s_waitcnt lgkmcnt(4)
    v_mfma_f32_16x16x32_bf16 v[16:19], v[128:131], a[0:3], v[16:19]
    v_mfma_f32_16x16x32_bf16 v[20:23], v[132:135], a[0:3], v[20:23]
    ds_read_b128 a[32:35], v4 offset:32768
    v_mfma_f32_16x16x32_bf16 v[24:27], v[128:131], a[4:7], v[24:27]
    v_mfma_f32_16x16x32_bf16 v[28:31], v[132:135], a[4:7], v[28:31]
    ds_read_b128 a[36:39], v4 offset:34816
    v_mfma_f32_16x16x32_bf16 v[32:35], v[128:131], a[8:11], v[32:35]
    v_mfma_f32_16x16x32_bf16 v[36:39], v[132:135], a[8:11], v[36:39]
    ds_read_b128 a[40:43], v4 offset:36864
    v_mfma_f32_16x16x32_bf16 v[40:43], v[128:131], a[12:15], v[40:43]
    v_mfma_f32_16x16x32_bf16 v[44:47], v[132:135], a[12:15], v[44:47]
    ds_read_b128 a[44:47], v4 offset:38912
    s_waitcnt lgkmcnt(4)
    v_mfma_f32_16x16x32_bf16 v[48:51], v[128:131], a[16:19], v[48:51]
    v_mfma_f32_16x16x32_bf16 v[52:55], v[132:135], a[16:19], v[52:55]
    ds_read_b128 a[48:51], v4 offset:40960
    v_mfma_f32_16x16x32_bf16 v[56:59], v[128:131], a[20:23], v[56:59]
    v_mfma_f32_16x16x32_bf16 v[60:63], v[132:135], a[20:23], v[60:63]
    ds_read_b128 a[52:55], v4 offset:43008
    v_mfma_f32_16x16x32_bf16 v[64:67], v[128:131], a[24:27], v[64:67]
    v_mfma_f32_16x16x32_bf16 v[68:71], v[132:135], a[24:27], v[68:71]
    ds_read_b128 a[56:59], v4 offset:45056
    v_mfma_f32_16x16x32_bf16 v[72:75], v[128:131], a[28:31], v[72:75]
    v_mfma_f32_16x16x32_bf16 v[76:79], v[132:135], a[28:31], v[76:79]
    ds_read_b128 a[60:63], v4 offset:47104
    s_waitcnt vmcnt(16)
    s_barrier
    s_waitcnt lgkmcnt(4)
    v_mfma_f32_16x16x32_bf16 v[16:19], v[136:139], a[32:35], v[16:19]
    v_mfma_f32_16x16x32_bf16 v[20:23], v[140:143], a[32:35], v[20:23]
    ds_read_b128 a[0:3], v3 offset:49152
    s_add_u32 m0, s21, 16384
    v_mfma_f32_16x16x32_bf16 v[24:27], v[136:139], a[36:39], v[24:27]
    v_mfma_f32_16x16x32_bf16 v[28:31], v[140:143], a[36:39], v[28:31]
    ds_read_b128 a[4:7], v3 offset:51200
    s_add_u32 s64, s20, 0x300
    buffer_load_dwordx4 v2, s[4:7], s64 offen lds
    v_mfma_f32_16x16x32_bf16 v[32:35], v[136:139], a[40:43], v[32:35]
    v_mfma_f32_16x16x32_bf16 v[36:39], v[140:143], a[40:43], v[36:39]
    ds_read_b128 a[8:11], v3 offset:53248
    s_add_u32 m0, s21, 17408
    v_mfma_f32_16x16x32_bf16 v[40:43], v[136:139], a[44:47], v[40:43]
    v_mfma_f32_16x16x32_bf16 v[44:47], v[140:143], a[44:47], v[44:47]
    ds_read_b128 a[12:15], v3 offset:55296
    s_add_u32 s64, s20, 0x2b00
    buffer_load_dwordx4 v2, s[4:7], s64 offen lds
    s_waitcnt lgkmcnt(4)
    v_mfma_f32_16x16x32_bf16 v[48:51], v[136:139], a[48:51], v[48:51]
    v_mfma_f32_16x16x32_bf16 v[52:55], v[140:143], a[48:51], v[52:55]
    ds_read_b128 a[16:19], v3 offset:57344
    s_add_u32 m0, s21, 18432
    v_mfma_f32_16x16x32_bf16 v[56:59], v[136:139], a[52:55], v[56:59]
    v_mfma_f32_16x16x32_bf16 v[60:63], v[140:143], a[52:55], v[60:63]
    ds_read_b128 a[20:23], v3 offset:59392
    s_add_u32 s64, s20, 0x5300
    buffer_load_dwordx4 v2, s[4:7], s64 offen lds
    v_mfma_f32_16x16x32_bf16 v[64:67], v[136:139], a[56:59], v[64:67]
    v_mfma_f32_16x16x32_bf16 v[68:71], v[140:143], a[56:59], v[68:71]
    ds_read_b128 a[24:27], v3 offset:61440
    s_add_u32 m0, s21, 19456
    v_mfma_f32_16x16x32_bf16 v[72:75], v[136:139], a[60:63], v[72:75]
    v_mfma_f32_16x16x32_bf16 v[76:79], v[140:143], a[60:63], v[76:79]
    ds_read_b128 a[28:31], v3 offset:63488
    s_add_u32 s64, s20, 0x7b00
    buffer_load_dwordx4 v2, s[4:7], s64 offen lds
    s_waitcnt lgkmcnt(4)
    v_mfma_f32_16x16x32_bf16 v[16:19], v[144:147], a[0:3], v[16:19]
    v_mfma_f32_16x16x32_bf16 v[20:23], v[148:151], a[0:3], v[20:23]
    ds_read_b128 a[32:35], v4 offset:49152
    v_mfma_f32_16x16x32_bf16 v[24:27], v[144:147], a[4:7], v[24:27]
    v_mfma_f32_16x16x32_bf16 v[28:31], v[148:151], a[4:7], v[28:31]
    ds_read_b128 a[36:39], v4 offset:51200
    v_mfma_f32_16x16x32_bf16 v[32:35], v[144:147], a[8:11], v[32:35]
    v_mfma_f32_16x16x32_bf16 v[36:39], v[148:151], a[8:11], v[36:39]
    ds_read_b128 a[40:43], v4 offset:53248
    v_mfma_f32_16x16x32_bf16 v[40:43], v[144:147], a[12:15], v[40:43]
    v_mfma_f32_16x16x32_bf16 v[44:47], v[148:151], a[12:15], v[44:47]
    ds_read_b128 a[44:47], v4 offset:55296
    s_waitcnt lgkmcnt(4)
    v_mfma_f32_16x16x32_bf16 v[48:51], v[144:147], a[16:19], v[48:51]
    v_mfma_f32_16x16x32_bf16 v[52:55], v[148:151], a[16:19], v[52:55]
    ds_read_b128 a[48:51], v4 offset:57344
    v_mfma_f32_16x16x32_bf16 v[56:59], v[144:147], a[20:23], v[56:59]
    v_mfma_f32_16x16x32_bf16 v[60:63], v[148:151], a[20:23], v[60:63]
    ds_read_b128 a[52:55], v4 offset:59392
    v_mfma_f32_16x16x32_bf16 v[64:67], v[144:147], a[24:27], v[64:67]
    v_mfma_f32_16x16x32_bf16 v[68:71], v[148:151], a[24:27], v[68:71]
    ds_read_b128 a[56:59], v4 offset:61440
    v_mfma_f32_16x16x32_bf16 v[72:75], v[144:147], a[28:31], v[72:75]
    v_mfma_f32_16x16x32_bf16 v[76:79], v[148:151], a[28:31], v[76:79]
    ds_read_b128 a[60:63], v4 offset:63488
    s_waitcnt vmcnt(8)
    s_barrier
    s_cmp_lg_u32 s14, 0
    s_cbranch_scc1 GF_106
    v_mov_b32 v7, 1
    v_mov_b32 v8, 0
    s_mov_b64 exec, 1
    buffer_store_dword v7, v8, s[4:7], s23 offen sc1
    s_mov_b64 exec, -1
GF_106:
    s_waitcnt lgkmcnt(4)
    v_mfma_f32_16x16x32_bf16 v[16:19], v[152:155], a[32:35], v[16:19]
    v_mfma_f32_16x16x32_bf16 v[20:23], v[156:159], a[32:35], v[20:23]
    ds_read_b128 a[0:3], v6 offset:0
    s_add_u32 m0, s21, 32768
    v_mfma_f32_16x16x32_bf16 v[24:27], v[152:155], a[36:39], v[24:27]
    v_mfma_f32_16x16x32_bf16 v[28:31], v[156:159], a[36:39], v[28:31]
    ds_read_b128 a[4:7], v6 offset:2048
    s_add_u32 s64, s20, 0x380
    buffer_load_dwordx4 v2, s[4:7], s64 offen lds
    v_mfma_f32_16x16x32_bf16 v[32:35], v[152:155], a[40:43], v[32:35]
    v_mfma_f32_16x16x32_bf16 v[36:39], v[156:159], a[40:43], v[36:39]
    ds_read_b128 a[8:11], v6 offset:4096
    s_add_u32 m0, s21, 33792
    v_mfma_f32_16x16x32_bf16 v[40:43], v[152:155], a[44:47], v[40:43]
    v_mfma_f32_16x16x32_bf16 v[44:47], v[156:159], a[44:47], v[44:47]
    ds_read_b128 a[12:15], v6 offset:6144
    s_add_u32 s64, s20, 0x2b80
    buffer_load_dwordx4 v2, s[4:7], s64 offen lds
    s_waitcnt lgkmcnt(4)
    v_mfma_f32_16x16x32_bf16 v[48:51], v[152:155], a[48:51], v[48:51]
    v_mfma_f32_16x16x32_bf16 v[52:55], v[156:159], a[48:51], v[52:55]
    ds_read_b128 a[16:19], v6 offset:8192
    s_add_u32 m0, s21, 34816
    v_mfma_f32_16x16x32_bf16 v[56:59], v[152:155], a[52:55], v[56:59]
    v_mfma_f32_16x16x32_bf16 v[60:63], v[156:159], a[52:55], v[60:63]
    ds_read_b128 a[20:23], v6 offset:10240
    s_add_u32 s64, s20, 0x5380
    buffer_load_dwordx4 v2, s[4:7], s64 offen lds
    v_mfma_f32_16x16x32_bf16 v[64:67], v[152:155], a[56:59], v[64:67]
    v_mfma_f32_16x16x32_bf16 v[68:71], v[156:159], a[56:59], v[68:71]
    ds_read_b128 a[24:27], v6 offset:12288
    s_add_u32 m0, s21, 35840
    v_mfma_f32_16x16x32_bf16 v[72:75], v[152:155], a[60:63], v[72:75]
    v_mfma_f32_16x16x32_bf16 v[76:79], v[156:159], a[60:63], v[76:79]
    ds_read_b128 a[28:31], v6 offset:14336
    s_add_u32 s64, s20, 0x7b80
    buffer_load_dwordx4 v2, s[4:7], s64 offen lds
    s_waitcnt lgkmcnt(4)
    v_mfma_f32_16x16x32_bf16 v[16:19], v[160:163], a[0:3], v[16:19]
    v_mfma_f32_16x16x32_bf16 v[20:23], v[164:167], a[0:3], v[20:23]
    ds_read_b128 a[32:35], v9 offset:0
    v_mfma_f32_16x16x32_bf16 v[24:27], v[160:163], a[4:7], v[24:27]
    v_mfma_f32_16x16x32_bf16 v[28:31], v[164:167], a[4:7], v[28:31]
    ds_read_b128 a[36:39], v9 offset:2048
    v_mfma_f32_16x16x32_bf16 v[32:35], v[160:163], a[8:11], v[32:35]
    v_mfma_f32_16x16x32_bf16 v[36:39], v[164:167], a[8:11], v[36:39]
    ds_read_b128 a[40:43], v9 offset:4096
    v_mfma_f32_16x16x32_bf16 v[40:43], v[160:163], a[12:15], v[40:43]
    v_mfma_f32_16x16x32_bf16 v[44:47], v[164:167], a[12:15], v[44:47]
    ds_read_b128 a[44:47], v9 offset:6144
    s_waitcnt lgkmcnt(4)
    v_mfma_f32_16x16x32_bf16 v[48:51], v[160:163], a[16:19], v[48:51]
    v_mfma_f32_16x16x32_bf16 v[52:55], v[164:167], a[16:19], v[52:55]
    ds_read_b128 a[48:51], v9 offset:8192
    v_mfma_f32_16x16x32_bf16 v[56:59], v[160:163], a[20:23], v[56:59]
    v_mfma_f32_16x16x32_bf16 v[60:63], v[164:167], a[20:23], v[60:63]
    ds_read_b128 a[52:55], v9 offset:10240
    v_mfma_f32_16x16x32_bf16 v[64:67], v[160:163], a[24:27], v[64:67]
    v_mfma_f32_16x16x32_bf16 v[68:71], v[164:167], a[24:27], v[68:71]
    ds_read_b128 a[56:59], v9 offset:12288
    v_mfma_f32_16x16x32_bf16 v[72:75], v[160:163], a[28:31], v[72:75]
    v_mfma_f32_16x16x32_bf16 v[76:79], v[164:167], a[28:31], v[76:79]
    ds_read_b128 a[60:63], v9 offset:14336
    s_waitcnt vmcnt(8)
    s_barrier
    s_waitcnt lgkmcnt(4)
    v_mfma_f32_16x16x32_bf16 v[16:19], v[168:171], a[32:35], v[16:19]
    v_mfma_f32_16x16x32_bf16 v[20:23], v[172:175], a[32:35], v[20:23]
    ds_read_b128 a[0:3], v3 offset:0
    s_add_u32 m0, s21, 49152
    v_mfma_f32_16x16x32_bf16 v[24:27], v[168:171], a[36:39], v[24:27]
    v_mfma_f32_16x16x32_bf16 v[28:31], v[172:175], a[36:39], v[28:31]
    ds_read_b128 a[4:7], v3 offset:2048
    s_add_u32 s64, s20, 0x400
    buffer_load_dwordx4 v2, s[4:7], s64 offen lds
    v_mfma_f32_16x16x32_bf16 v[32:35], v[168:171], a[40:43], v[32:35]
    v_mfma_f32_16x16x32_bf16 v[36:39], v[172:175], a[40:43], v[36:39]
    ds_read_b128 a[8:11], v3 offset:4096
    s_add_u32 m0, s21, 50176
    v_mfma_f32_16x16x32_bf16 v[40:43], v[168:171], a[44:47], v[40:43]
    v_mfma_f32_16x16x32_bf16 v[44:47], v[172:175], a[44:47], v[44:47]
    ds_read_b128 a[12:15], v3 offset:6144
    s_add_u32 s64, s20, 0x2c00
    buffer_load_dwordx4 v2, s[4:7], s64 offen lds
    s_waitcnt lgkmcnt(4)
    v_mfma_f32_16x16x32_bf16 v[48:51], v[168:171], a[48:51], v[48:51]
    v_mfma_f32_16x16x32_bf16 v[52:55], v[172:175], a[48:51], v[52:55]
    ds_read_b128 a[16:19], v3 offset:8192
    s_add_u32 m0, s21, 51200
    v_mfma_f32_16x16x32_bf16 v[56:59], v[168:171], a[52:55], v[56:59]
    v_mfma_f32_16x16x32_bf16 v[60:63], v[172:175], a[52:55], v[60:63]
    ds_read_b128 a[20:23], v3 offset:10240
    s_add_u32 s64, s20, 0x5400
    buffer_load_dwordx4 v2, s[4:7], s64 offen lds
    v_mfma_f32_16x16x32_bf16 v[64:67], v[168:171], a[56:59], v[64:67]
    v_mfma_f32_16x16x32_bf16 v[68:71], v[172:175], a[56:59], v[68:71]
    ds_read_b128 a[24:27], v3 offset:12288
    s_add_u32 m0, s21, 52224
    v_mfma_f32_16x16x32_bf16 v[72:75], v[168:171], a[60:63], v[72:75]
    v_mfma_f32_16x16x32_bf16 v[76:79], v[172:175], a[60:63], v[76:79]
    ds_read_b128 a[28:31], v3 offset:14336
    s_add_u32 s64, s20, 0x7c00
    buffer_load_dwordx4 v2, s[4:7], s64 offen lds
    s_waitcnt lgkmcnt(4)
    v_mfma_f32_16x16x32_bf16 v[16:19], v[176:179], a[0:3], v[16:19]
    v_mfma_f32_16x16x32_bf16 v[20:23], v[180:183], a[0:3], v[20:23]
    ds_read_b128 a[32:35], v4 offset:0
    v_mfma_f32_16x16x32_bf16 v[24:27], v[176:179], a[4:7], v[24:27]
    v_mfma_f32_16x16x32_bf16 v[28:31], v[180:183], a[4:7], v[28:31]
    ds_read_b128 a[36:39], v4 offset:2048
    v_mfma_f32_16x16x32_bf16 v[32:35], v[176:179], a[8:11], v[32:35]
    v_mfma_f32_16x16x32_bf16 v[36:39], v[180:183], a[8:11], v[36:39]
    ds_read_b128 a[40:43], v4 offset:4096
    v_mfma_f32_16x16x32_bf16 v[40:43], v[176:179], a[12:15], v[40:43]
    v_mfma_f32_16x16x32_bf16 v[44:47], v[180:183], a[12:15], v[44:47]
    ds_read_b128 a[44:47], v4 offset:6144
    s_waitcnt lgkmcnt(4)
    v_mfma_f32_16x16x32_bf16 v[48:51], v[176:179], a[16:19], v[48:51]
    v_mfma_f32_16x16x32_bf16 v[52:55], v[180:183], a[16:19], v[52:55]
    ds_read_b128 a[48:51], v4 offset:8192
    v_mfma_f32_16x16x32_bf16 v[56:59], v[176:179], a[20:23], v[56:59]
    v_mfma_f32_16x16x32_bf16 v[60:63], v[180:183], a[20:23], v[60:63]
    ds_read_b128 a[52:55], v4 offset:10240
    v_mfma_f32_16x16x32_bf16 v[64:67], v[176:179], a[24:27], v[64:67]
    v_mfma_f32_16x16x32_bf16 v[68:71], v[180:183], a[24:27], v[68:71]
    ds_read_b128 a[56:59], v4 offset:12288
    v_mfma_f32_16x16x32_bf16 v[72:75], v[176:179], a[28:31], v[72:75]
    v_mfma_f32_16x16x32_bf16 v[76:79], v[180:183], a[28:31], v[76:79]
    ds_read_b128 a[60:63], v4 offset:14336
    s_waitcnt vmcnt(8)
    s_barrier
    s_waitcnt lgkmcnt(4)
    v_mfma_f32_16x16x32_bf16 v[16:19], v[184:187], a[32:35], v[16:19]
    v_mfma_f32_16x16x32_bf16 v[20:23], v[188:191], a[32:35], v[20:23]
    ds_read_b128 a[0:3], v3 offset:16384
    s_add_u32 m0, s21, 65536
    v_mfma_f32_16x16x32_bf16 v[24:27], v[184:187], a[36:39], v[24:27]
    v_mfma_f32_16x16x32_bf16 v[28:31], v[188:191], a[36:39], v[28:31]
    ds_read_b128 a[4:7], v3 offset:18432
    s_add_u32 s64, s20, 0x480
    buffer_load_dwordx4 v2, s[4:7], s64 offen lds
    v_mfma_f32_16x16x32_bf16 v[32:35], v[184:187], a[40:43], v[32:35]
    v_mfma_f32_16x16x32_bf16 v[36:39], v[188:191], a[40:43], v[36:39]
    ds_read_b128 a[8:11], v3 offset:20480
    s_add_u32 m0, s21, 66560
    v_mfma_f32_16x16x32_bf16 v[40:43], v[184:187], a[44:47], v[40:43]
    v_mfma_f32_16x16x32_bf16 v[44:47], v[188:191], a[44:47], v[44:47]
    ds_read_b128 a[12:15], v3 offset:22528
    s_add_u32 s64, s20, 0x2c80
    buffer_load_dwordx4 v2, s[4:7], s64 offen lds
    s_waitcnt lgkmcnt(4)
    v_mfma_f32_16x16x32_bf16 v[48:51], v[184:187], a[48:51], v[48:51]
    v_mfma_f32_16x16x32_bf16 v[52:55], v[188:191], a[48:51], v[52:55]
    ds_read_b128 a[16:19], v3 offset:24576
    s_add_u32 m0, s21, 67584
    v_mfma_f32_16x16x32_bf16 v[56:59], v[184:187], a[52:55], v[56:59]
    v_mfma_f32_16x16x32_bf16 v[60:63], v[188:191], a[52:55], v[60:63]
    ds_read_b128 a[20:23], v3 offset:26624
    s_add_u32 s64, s20, 0x5480
    buffer_load_dwordx4 v2, s[4:7], s64 offen lds
    v_mfma_f32_16x16x32_bf16 v[64:67], v[184:187], a[56:59], v[64:67]
    v_mfma_f32_16x16x32_bf16 v[68:71], v[188:191], a[56:59], v[68:71]
    ds_read_b128 a[24:27], v3 offset:28672
    s_add_u32 m0, s21, 68608
    v_mfma_f32_16x16x32_bf16 v[72:75], v[184:187], a[60:63], v[72:75]
    v_mfma_f32_16x16x32_bf16 v[76:79], v[188:191], a[60:63], v[76:79]
    ds_read_b128 a[28:31], v3 offset:30720
    s_add_u32 s64, s20, 0x7c80
    buffer_load_dwordx4 v2, s[4:7], s64 offen lds
    s_waitcnt lgkmcnt(4)
    v_mfma_f32_16x16x32_bf16 v[16:19], v[192:195], a[0:3], v[16:19]
    v_mfma_f32_16x16x32_bf16 v[20:23], v[196:199], a[0:3], v[20:23]
    ds_read_b128 a[32:35], v4 offset:16384
    v_mfma_f32_16x16x32_bf16 v[24:27], v[192:195], a[4:7], v[24:27]
    v_mfma_f32_16x16x32_bf16 v[28:31], v[196:199], a[4:7], v[28:31]
    ds_read_b128 a[36:39], v4 offset:18432
    v_mfma_f32_16x16x32_bf16 v[32:35], v[192:195], a[8:11], v[32:35]
    v_mfma_f32_16x16x32_bf16 v[36:39], v[196:199], a[8:11], v[36:39]
    ds_read_b128 a[40:43], v4 offset:20480
    v_mfma_f32_16x16x32_bf16 v[40:43], v[192:195], a[12:15], v[40:43]
    v_mfma_f32_16x16x32_bf16 v[44:47], v[196:199], a[12:15], v[44:47]
    ds_read_b128 a[44:47], v4 offset:22528
    s_waitcnt lgkmcnt(4)
    v_mfma_f32_16x16x32_bf16 v[48:51], v[192:195], a[16:19], v[48:51]
    v_mfma_f32_16x16x32_bf16 v[52:55], v[196:199], a[16:19], v[52:55]
    ds_read_b128 a[48:51], v4 offset:24576
    v_mfma_f32_16x16x32_bf16 v[56:59], v[192:195], a[20:23], v[56:59]
    v_mfma_f32_16x16x32_bf16 v[60:63], v[196:199], a[20:23], v[60:63]
    ds_read_b128 a[52:55], v4 offset:26624
    v_mfma_f32_16x16x32_bf16 v[64:67], v[192:195], a[24:27], v[64:67]
    v_mfma_f32_16x16x32_bf16 v[68:71], v[196:199], a[24:27], v[68:71]
    ds_read_b128 a[56:59], v4 offset:28672
    v_mfma_f32_16x16x32_bf16 v[72:75], v[192:195], a[28:31], v[72:75]
    v_mfma_f32_16x16x32_bf16 v[76:79], v[196:199], a[28:31], v[76:79]
    ds_read_b128 a[60:63], v4 offset:30720
    s_waitcnt vmcnt(8)
    s_barrier
    s_waitcnt lgkmcnt(4)
    v_mfma_f32_16x16x32_bf16 v[16:19], v[200:203], a[32:35], v[16:19]
    v_mfma_f32_16x16x32_bf16 v[20:23], v[204:207], a[32:35], v[20:23]
    ds_read_b128 a[0:3], v3 offset:32768
    s_add_u32 m0, s21, 0
    v_mfma_f32_16x16x32_bf16 v[24:27], v[200:203], a[36:39], v[24:27]
    v_mfma_f32_16x16x32_bf16 v[28:31], v[204:207], a[36:39], v[28:31]
    ds_read_b128 a[4:7], v3 offset:34816
    s_add_u32 s64, s20, 0x50000
    buffer_load_dwordx4 v2, s[4:7], s64 offen lds
    v_mfma_f32_16x16x32_bf16 v[32:35], v[200:203], a[40:43], v[32:35]
    v_mfma_f32_16x16x32_bf16 v[36:39], v[204:207], a[40:43], v[36:39]
    ds_read_b128 a[8:11], v3 offset:36864
    s_add_u32 m0, s21, 1024
    v_mfma_f32_16x16x32_bf16 v[40:43], v[200:203], a[44:47], v[40:43]
    v_mfma_f32_16x16x32_bf16 v[44:47], v[204:207], a[44:47], v[44:47]
    ds_read_b128 a[12:15], v3 offset:38912
    s_add_u32 s64, s20, 0x52800
    buffer_load_dwordx4 v2, s[4:7], s64 offen lds
    s_waitcnt lgkmcnt(4)
    v_mfma_f32_16x16x32_bf16 v[48:51], v[200:203], a[48:51], v[48:51]
    v_mfma_f32_16x16x32_bf16 v[52:55], v[204:207], a[48:51], v[52:55]
    ds_read_b128 a[16:19], v3 offset:40960
    s_add_u32 m0, s21, 2048
    v_mfma_f32_16x16x32_bf16 v[56:59], v[200:203], a[52:55], v[56:59]
    v_mfma_f32_16x16x32_bf16 v[60:63], v[204:207], a[52:55], v[60:63]
    ds_read_b128 a[20:23], v3 offset:43008
    s_add_u32 s64, s20, 0x55000
    buffer_load_dwordx4 v2, s[4:7], s64 offen lds
    v_mfma_f32_16x16x32_bf16 v[64:67], v[200:203], a[56:59], v[64:67]
    v_mfma_f32_16x16x32_bf16 v[68:71], v[204:207], a[56:59], v[68:71]
    ds_read_b128 a[24:27], v3 offset:45056
    s_add_u32 m0, s21, 3072
    v_mfma_f32_16x16x32_bf16 v[72:75], v[200:203], a[60:63], v[72:75]
    v_mfma_f32_16x16x32_bf16 v[76:79], v[204:207], a[60:63], v[76:79]
    ds_read_b128 a[28:31], v3 offset:47104
    s_add_u32 s64, s20, 0x57800
    buffer_load_dwordx4 v2, s[4:7], s64 offen lds
    s_waitcnt lgkmcnt(4)
    v_mfma_f32_16x16x32_bf16 v[16:19], v[208:211], a[0:3], v[16:19]
    v_mfma_f32_16x16x32_bf16 v[20:23], v[212:215], a[0:3], v[20:23]
    ds_read_b128 a[32:35], v4 offset:32768
    v_mfma_f32_16x16x32_bf16 v[24:27], v[208:211], a[4:7], v[24:27]
    v_mfma_f32_16x16x32_bf16 v[28:31], v[212:215], a[4:7], v[28:31]
    ds_read_b128 a[36:39], v4 offset:34816
    v_mfma_f32_16x16x32_bf16 v[32:35], v[208:211], a[8:11], v[32:35]
    v_mfma_f32_16x16x32_bf16 v[36:39], v[212:215], a[8:11], v[36:39]
    ds_read_b128 a[40:43], v4 offset:36864
    v_mfma_f32_16x16x32_bf16 v[40:43], v[208:211], a[12:15], v[40:43]
    v_mfma_f32_16x16x32_bf16 v[44:47], v[212:215], a[12:15], v[44:47]
    ds_read_b128 a[44:47], v4 offset:38912
    s_waitcnt lgkmcnt(4)
    v_mfma_f32_16x16x32_bf16 v[48:51], v[208:211], a[16:19], v[48:51]
    v_mfma_f32_16x16x32_bf16 v[52:55], v[212:215], a[16:19], v[52:55]
    ds_read_b128 a[48:51], v4 offset:40960
    v_mfma_f32_16x16x32_bf16 v[56:59], v[208:211], a[20:23], v[56:59]
    v_mfma_f32_16x16x32_bf16 v[60:63], v[212:215], a[20:23], v[60:63]
    ds_read_b128 a[52:55], v4 offset:43008
    v_mfma_f32_16x16x32_bf16 v[64:67], v[208:211], a[24:27], v[64:67]
    v_mfma_f32_16x16x32_bf16 v[68:71], v[212:215], a[24:27], v[68:71]
    ds_read_b128 a[56:59], v4 offset:45056
    v_mfma_f32_16x16x32_bf16 v[72:75], v[208:211], a[28:31], v[72:75]
    v_mfma_f32_16x16x32_bf16 v[76:79], v[212:215], a[28:31], v[76:79]
    ds_read_b128 a[60:63], v4 offset:47104
    s_waitcnt vmcnt(8)
    s_barrier
    s_waitcnt lgkmcnt(4)
    v_mfma_f32_16x16x32_bf16 v[16:19], v[216:219], a[32:35], v[16:19]
    v_mfma_f32_16x16x32_bf16 v[20:23], v[220:223], a[32:35], v[20:23]
    ds_read_b128 a[0:3], v3 offset:49152
    s_add_u32 m0, s21, 16384
    v_mfma_f32_16x16x32_bf16 v[24:27], v[216:219], a[36:39], v[24:27]
    v_mfma_f32_16x16x32_bf16 v[28:31], v[220:223], a[36:39], v[28:31]
    ds_read_b128 a[4:7], v3 offset:51200
    s_add_u32 s64, s20, 0x50080
    buffer_load_dwordx4 v2, s[4:7], s64 offen lds
    v_mfma_f32_16x16x32_bf16 v[32:35], v[216:219], a[40:43], v[32:35]
    v_mfma_f32_16x16x32_bf16 v[36:39], v[220:223], a[40:43], v[36:39]
    ds_read_b128 a[8:11], v3 offset:53248
    s_add_u32 m0, s21, 17408
    v_mfma_f32_16x16x32_bf16 v[40:43], v[216:219], a[44:47], v[40:43]
    v_mfma_f32_16x16x32_bf16 v[44:47], v[220:223], a[44:47], v[44:47]
    ds_read_b128 a[12:15], v3 offset:55296
    s_add_u32 s64, s20, 0x52880
    buffer_load_dwordx4 v2, s[4:7], s64 offen lds
    s_waitcnt lgkmcnt(4)
    v_mfma_f32_16x16x32_bf16 v[48:51], v[216:219], a[48:51], v[48:51]
    v_mfma_f32_16x16x32_bf16 v[52:55], v[220:223], a[48:51], v[52:55]
    ds_read_b128 a[16:19], v3 offset:57344
    s_add_u32 m0, s21, 18432
    v_mfma_f32_16x16x32_bf16 v[56:59], v[216:219], a[52:55], v[56:59]
    v_mfma_f32_16x16x32_bf16 v[60:63], v[220:223], a[52:55], v[60:63]
    ds_read_b128 a[20:23], v3 offset:59392
    s_add_u32 s64, s20, 0x55080
    buffer_load_dwordx4 v2, s[4:7], s64 offen lds
    v_mfma_f32_16x16x32_bf16 v[64:67], v[216:219], a[56:59], v[64:67]
    v_mfma_f32_16x16x32_bf16 v[68:71], v[220:223], a[56:59], v[68:71]
    ds_read_b128 a[24:27], v3 offset:61440
    s_add_u32 m0, s21, 19456
    v_mfma_f32_16x16x32_bf16 v[72:75], v[216:219], a[60:63], v[72:75]
    v_mfma_f32_16x16x32_bf16 v[76:79], v[220:223], a[60:63], v[76:79]
    ds_read_b128 a[28:31], v3 offset:63488
    s_add_u32 s64, s20, 0x57880
    buffer_load_dwordx4 v2, s[4:7], s64 offen lds
    s_waitcnt lgkmcnt(4)
    v_mfma_f32_16x16x32_bf16 v[16:19], v[224:227], a[0:3], v[16:19]
    v_mfma_f32_16x16x32_bf16 v[20:23], v[228:231], a[0:3], v[20:23]
    ds_read_b128 a[32:35], v4 offset:49152
    v_mfma_f32_16x16x32_bf16 v[24:27], v[224:227], a[4:7], v[24:27]
    v_mfma_f32_16x16x32_bf16 v[28:31], v[228:231], a[4:7], v[28:31]
    ds_read_b128 a[36:39], v4 offset:51200
    v_mfma_f32_16x16x32_bf16 v[32:35], v[224:227], a[8:11], v[32:35]
    v_mfma_f32_16x16x32_bf16 v[36:39], v[228:231], a[8:11], v[36:39]
    ds_read_b128 a[40:43], v4 offset:53248
    v_mfma_f32_16x16x32_bf16 v[40:43], v[224:227], a[12:15], v[40:43]
    v_mfma_f32_16x16x32_bf16 v[44:47], v[228:231], a[12:15], v[44:47]
    ds_read_b128 a[44:47], v4 offset:55296
    s_waitcnt lgkmcnt(4)
    v_mfma_f32_16x16x32_bf16 v[48:51], v[224:227], a[16:19], v[48:51]
    v_mfma_f32_16x16x32_bf16 v[52:55], v[228:231], a[16:19], v[52:55]
    ds_read_b128 a[48:51], v4 offset:57344
    v_mfma_f32_16x16x32_bf16 v[56:59], v[224:227], a[20:23], v[56:59]
    v_mfma_f32_16x16x32_bf16 v[60:63], v[228:231], a[20:23], v[60:63]
    ds_read_b128 a[52:55], v4 offset:59392
    v_mfma_f32_16x16x32_bf16 v[64:67], v[224:227], a[24:27], v[64:67]
    v_mfma_f32_16x16x32_bf16 v[68:71], v[228:231], a[24:27], v[68:71]
    ds_read_b128 a[56:59], v4 offset:61440
    v_mfma_f32_16x16x32_bf16 v[72:75], v[224:227], a[28:31], v[72:75]
    v_mfma_f32_16x16x32_bf16 v[76:79], v[228:231], a[28:31], v[76:79]
    ds_read_b128 a[60:63], v4 offset:63488
    s_waitcnt vmcnt(8)
    s_barrier
    s_waitcnt lgkmcnt(4)
    v_mfma_f32_16x16x32_bf16 v[16:19], v[232:235], a[32:35], v[16:19]
    v_mfma_f32_16x16x32_bf16 v[20:23], v[236:239], a[32:35], v[20:23]
    ds_read_b128 a[0:3], v6 offset:0
    s_add_u32 m0, s21, 32768
    v_mfma_f32_16x16x32_bf16 v[24:27], v[232:235], a[36:39], v[24:27]
    v_mfma_f32_16x16x32_bf16 v[28:31], v[236:239], a[36:39], v[28:31]
    ds_read_b128 a[4:7], v6 offset:2048
    s_add_u32 s64, s20, 0x50100
    buffer_load_dwordx4 v2, s[4:7], s64 offen lds
    v_mfma_f32_16x16x32_bf16 v[32:35], v[232:235], a[40:43], v[32:35]
    v_mfma_f32_16x16x32_bf16 v[36:39], v[236:239], a[40:43], v[36:39]
    ds_read_b128 a[8:11], v6 offset:4096
    s_add_u32 m0, s21, 33792
    v_mfma_f32_16x16x32_bf16 v[40:43], v[232:235], a[44:47], v[40:43]
    v_mfma_f32_16x16x32_bf16 v[44:47], v[236:239], a[44:47], v[44:47]
    ds_read_b128 a[12:15], v6 offset:6144
    s_add_u32 s64, s20, 0x52900
    buffer_load_dwordx4 v2, s[4:7], s64 offen lds
    s_waitcnt lgkmcnt(4)
    v_mfma_f32_16x16x32_bf16 v[48:51], v[232:235], a[48:51], v[48:51]
    v_mfma_f32_16x16x32_bf16 v[52:55], v[236:239], a[48:51], v[52:55]
    ds_read_b128 a[16:19], v6 offset:8192
    s_add_u32 m0, s21, 34816
    v_mfma_f32_16x16x32_bf16 v[56:59], v[232:235], a[52:55], v[56:59]
    v_mfma_f32_16x16x32_bf16 v[60:63], v[236:239], a[52:55], v[60:63]
    ds_read_b128 a[20:23], v6 offset:10240
    s_add_u32 s64, s20, 0x55100
    buffer_load_dwordx4 v2, s[4:7], s64 offen lds
    v_mfma_f32_16x16x32_bf16 v[64:67], v[232:235], a[56:59], v[64:67]
    v_mfma_f32_16x16x32_bf16 v[68:71], v[236:239], a[56:59], v[68:71]
    ds_read_b128 a[24:27], v6 offset:12288
    s_add_u32 m0, s21, 35840
    v_mfma_f32_16x16x32_bf16 v[72:75], v[232:235], a[60:63], v[72:75]
    v_mfma_f32_16x16x32_bf16 v[76:79], v[236:239], a[60:63], v[76:79]
    ds_read_b128 a[28:31], v6 offset:14336
    s_add_u32 s64, s20, 0x57900
    buffer_load_dwordx4 v2, s[4:7], s64 offen lds
    s_waitcnt lgkmcnt(4)
    v_mfma_f32_16x16x32_bf16 v[16:19], v[240:243], a[0:3], v[16:19]
    v_mfma_f32_16x16x32_bf16 v[20:23], v[244:247], a[0:3], v[20:23]
    ds_read_b128 a[32:35], v9 offset:0
    v_mfma_f32_16x16x32_bf16 v[24:27], v[240:243], a[4:7], v[24:27]
    v_mfma_f32_16x16x32_bf16 v[28:31], v[244:247], a[4:7], v[28:31]
    ds_read_b128 a[36:39], v9 offset:2048
    v_mfma_f32_16x16x32_bf16 v[32:35], v[240:243], a[8:11], v[32:35]
    v_mfma_f32_16x16x32_bf16 v[36:39], v[244:247], a[8:11], v[36:39]
    ds_read_b128 a[40:43], v9 offset:4096
    v_mfma_f32_16x16x32_bf16 v[40:43], v[240:243], a[12:15], v[40:43]
    v_mfma_f32_16x16x32_bf16 v[44:47], v[244:247], a[12:15], v[44:47]
    ds_read_b128 a[44:47], v9 offset:6144
    s_waitcnt lgkmcnt(4)
    v_mfma_f32_16x16x32_bf16 v[48:51], v[240:243], a[16:19], v[48:51]
    v_mfma_f32_16x16x32_bf16 v[52:55], v[244:247], a[16:19], v[52:55]
    ds_read_b128 a[48:51], v9 offset:8192
    v_mfma_f32_16x16x32_bf16 v[56:59], v[240:243], a[20:23], v[56:59]
    v_mfma_f32_16x16x32_bf16 v[60:63], v[244:247], a[20:23], v[60:63]
    ds_read_b128 a[52:55], v9 offset:10240
    v_mfma_f32_16x16x32_bf16 v[64:67], v[240:243], a[24:27], v[64:67]
    v_mfma_f32_16x16x32_bf16 v[68:71], v[244:247], a[24:27], v[68:71]
    ds_read_b128 a[56:59], v9 offset:12288
    v_mfma_f32_16x16x32_bf16 v[72:75], v[240:243], a[28:31], v[72:75]
    v_mfma_f32_16x16x32_bf16 v[76:79], v[244:247], a[28:31], v[76:79]
    ds_read_b128 a[60:63], v9 offset:14336
    s_waitcnt vmcnt(8)
    s_barrier
    s_waitcnt lgkmcnt(4)
    v_mfma_f32_16x16x32_bf16 v[16:19], v[248:251], a[32:35], v[16:19]
    v_mfma_f32_16x16x32_bf16 v[20:23], v[252:255], a[32:35], v[20:23]
    ds_read_b128 a[0:3], v3 offset:0
    s_add_u32 m0, s21, 49152
    v_mfma_f32_16x16x32_bf16 v[24:27], v[248:251], a[36:39], v[24:27]
    v_mfma_f32_16x16x32_bf16 v[28:31], v[252:255], a[36:39], v[28:31]
    ds_read_b128 a[4:7], v3 offset:2048
    s_add_u32 s64, s20, 0x50180
    buffer_load_dwordx4 v2, s[4:7], s64 offen lds
    v_mfma_f32_16x16x32_bf16 v[32:35], v[248:251], a[40:43], v[32:35]
    v_mfma_f32_16x16x32_bf16 v[36:39], v[252:255], a[40:43], v[36:39]
    ds_read_b128 a[8:11], v3 offset:4096
    s_add_u32 m0, s21, 50176
    v_mfma_f32_16x16x32_bf16 v[40:43], v[248:251], a[44:47], v[40:43]
    v_mfma_f32_16x16x32_bf16 v[44:47], v[252:255], a[44:47], v[44:47]
    ds_read_b128 a[12:15], v3 offset:6144
    s_add_u32 s64, s20, 0x52980
    buffer_load_dwordx4 v2, s[4:7], s64 offen lds
    s_waitcnt lgkmcnt(4)
    v_mfma_f32_16x16x32_bf16 v[48:51], v[248:251], a[48:51], v[48:51]
    v_mfma_f32_16x16x32_bf16 v[52:55], v[252:255], a[48:51], v[52:55]
    ds_read_b128 a[16:19], v3 offset:8192
    s_add_u32 m0, s21, 51200
    v_mfma_f32_16x16x32_bf16 v[56:59], v[248:251], a[52:55], v[56:59]
    v_mfma_f32_16x16x32_bf16 v[60:63], v[252:255], a[52:55], v[60:63]
    ds_read_b128 a[20:23], v3 offset:10240
    s_add_u32 s64, s20, 0x55180
    buffer_load_dwordx4 v2, s[4:7], s64 offen lds
    v_mfma_f32_16x16x32_bf16 v[64:67], v[248:251], a[56:59], v[64:67]
    v_mfma_f32_16x16x32_bf16 v[68:71], v[252:255], a[56:59], v[68:71]
    ds_read_b128 a[24:27], v3 offset:12288
    s_add_u32 m0, s21, 52224
    v_mfma_f32_16x16x32_bf16 v[72:75], v[248:251], a[60:63], v[72:75]
    v_mfma_f32_16x16x32_bf16 v[76:79], v[252:255], a[60:63], v[76:79]
    ds_read_b128 a[28:31], v3 offset:14336
    s_add_u32 s64, s20, 0x57980
    buffer_load_dwordx4 v2, s[4:7], s64 offen lds
    s_nop 5
    s_mul_i32 s65, s17, 0
    s_add_u32 s65, s65, s22
    s_add_u32 s64, s65, 0
    v_cvt_pk_bf16_f32 v80, v16, v17
    v_cvt_pk_bf16_f32 v81, v18, v19
    v_cvt_pk_bf16_f32 v82, v20, v21
    v_cvt_pk_bf16_f32 v83, v22, v23
    buffer_store_dwordx4 v[80:83], v1, s[4:7], s64 offen sc1
    s_add_u32 s64, s65, 4096
    v_cvt_pk_bf16_f32 v84, v24, v25
    v_cvt_pk_bf16_f32 v85, v26, v27
    v_cvt_pk_bf16_f32 v86, v28, v29
    v_cvt_pk_bf16_f32 v87, v30, v31
    buffer_store_dwordx4 v[84:87], v1, s[4:7], s64 offen sc1
    s_mul_i32 s65, s17, 1
    s_add_u32 s65, s65, s22
    s_add_u32 s64, s65, 0
    v_cvt_pk_bf16_f32 v88, v32, v33
    v_cvt_pk_bf16_f32 v89, v34, v35
    v_cvt_pk_bf16_f32 v90, v36, v37
    v_cvt_pk_bf16_f32 v91, v38, v39
    buffer_store_dwordx4 v[88:91], v1, s[4:7], s64 offen sc1
    s_add_u32 s64, s65, 4096
    v_cvt_pk_bf16_f32 v92, v40, v41
    v_cvt_pk_bf16_f32 v93, v42, v43
    v_cvt_pk_bf16_f32 v94, v44, v45
    v_cvt_pk_bf16_f32 v95, v46, v47
    buffer_store_dwordx4 v[92:95], v1, s[4:7], s64 offen sc1
    s_mul_i32 s65, s17, 2
    s_add_u32 s65, s65, s22
    s_add_u32 s64, s65, 0
    v_cvt_pk_bf16_f32 v80, v48, v49
    v_cvt_pk_bf16_f32 v81, v50, v51
    v_cvt_pk_bf16_f32 v82, v52, v53
    v_cvt_pk_bf16_f32 v83, v54, v55
    buffer_store_dwordx4 v[80:83], v1, s[4:7], s64 offen sc1
    s_add_u32 s64, s65, 4096
    v_cvt_pk_bf16_f32 v84, v56, v57
    v_cvt_pk_bf16_f32 v85, v58, v59
    v_cvt_pk_bf16_f32 v86, v60, v61
    v_cvt_pk_bf16_f32 v87, v62, v63
    buffer_store_dwordx4 v[84:87], v1, s[4:7], s64 offen sc1
    s_mul_i32 s65, s17, 3
    s_add_u32 s65, s65, s22
    s_add_u32 s64, s65, 0
    v_cvt_pk_bf16_f32 v88, v64, v65
    v_cvt_pk_bf16_f32 v89, v66, v67
    v_cvt_pk_bf16_f32 v90, v68, v69
    v_cvt_pk_bf16_f32 v91, v70, v71
    buffer_store_dwordx4 v[88:91], v1, s[4:7], s64 offen sc1
    s_add_u32 s64, s65, 4096
    v_cvt_pk_bf16_f32 v92, v72, v73
    v_cvt_pk_bf16_f32 v93, v74, v75
    v_cvt_pk_bf16_f32 v94, v76, v77
    v_cvt_pk_bf16_f32 v95, v78, v79
    buffer_store_dwordx4 v[92:95], v1, s[4:7], s64 offen sc1
    s_lshl_b32 s64, s19, 1
    s_add_u32 s64, s64, s12
    s_lshl_b32 s64, s64, 9
    s_add_u32 s23, s18, s64
    s_lshl_b32 s64, s17, 3
    s_add_u32 s22, s22, s64
    s_add_u32 s19, s19, 1
    s_add_u32 s20, s20, 0x50000
    s_cmp_lt_u32 s19, 8
    s_cbranch_scc1 G_T_LOOP
    s_waitcnt vmcnt(0) lgkmcnt(0)
    s_barrier
    s_cmp_lg_u32 s14, 0
    s_cbranch_scc1 GF_107
    v_mov_b32 v7, 1
    v_mov_b32 v8, 0
    s_mov_b64 exec, 1
    buffer_store_dword v7, v8, s[4:7], s23 offen sc1
    s_mov_b64 exec, -1
GF_107:
    s_cmp_eq_u32 s3, 2
    s_cbranch_scc1 H_Q
    s_cmp_eq_u32 s12, 1
    s_cbranch_scc1 H_OUT
    s_lshl_b32 s88, s3, 5
    s_add_u32 s88, s88, s13
    s_mov_b32 s29, 0
    v_lshlrev_b32 v1, 4, v0
    s_mov_b32 s65, 0
CW_108:
    buffer_load_dwordx2 v[8:9], off, s[60:63], 0 offset:132 sc1
    s_add_u32 s65, s65, 1
    s_waitcnt vmcnt(0)
    v_readfirstlane_b32 s66, v8
    v_readfirstlane_b32 s67, v9
    s_min_u32 s64, s66, s67
    s_cmp_lg_u32 s64, 0
    s_cbranch_scc1 CWD_109
    s_cmp_gt_u32 s65, 65536
    s_cbranch_scc1 CWD_109
    s_sleep 4
    s_branch CW_108
CWD_109:
    s_sub_u32 s66, s66, 1
    s_and_b32 s66, s66, 3
    s_sub_u32 s67, s67, 1
    s_and_b32 s67, s67, 3
    s_mov_b32 s64, s66
    s_mov_b32 s65, s67
    s_and_b32 s64, s64, 3
    s_lshl_b32 s64, s64, 13
    s_and_b32 s65, s65, 3
    s_lshl_b32 s65, s65, 13
    s_add_u32 s25, s64, 0x6000000
    s_add_u32 s30, s65, 0x6200000
    v_bfe_u32 v4, v0, 3, 1
    v_mul_u32_u24 v2, 0x8000, v4
    v_lshrrev_b32 v4, 5, v0
    v_lshl_add_u32 v2, v4, 8, v2
    v_bfe_u32 v4, v0, 4, 1
    v_lshl_add_u32 v2, v4, 7, v2
    v_and_b32 v4, 7, v0
    v_lshl_add_u32 v2, v4, 4, v2
    v_bfe_u32 v4, v0, 3, 1
    v_lshlrev_b32 v3, 16, v4
    v_lshrrev_b32 v4, 4, v0
    v_lshl_add_u32 v3, v4, 7, v3
    v_and_b32 v4, 7, v0
    v_lshl_add_u32 v3, v4, 4, v3
    s_lshl_b32 s26, s13, 11
    s_lshl_b32 s64, s14, 9
    s_add_u32 s26, s26, s64
    s_add_u32 s26, s26, 0x640000
    s_lshl_b32 s27, s13, 3
    s_add_u32 s27, s27, 0x294000
    s_mov_b32 s28, 0x29a000
    s_mov_b32 s24, 0
    v_lshlrev_b32 v6, 7, v0
MKT_LOOP:
    s_cmp_lg_u32 s24, 10
    s_cbranch_scc1 MKH_110
    v_mov_b32 v10, v2
    v_mov_b32 v11, v3
    s_cmp_ge_u32 s88, 60
    s_cbranch_scc1 NOWO_111
    s_mov_b32 s89, s13
    s_mul_hi_u32 s65, s88, 0xccccccd
    s_mul_i32 s65, s65, 20
    s_sub_u32 s13, s88, s65
    s_load_dwordx2 s[44:45], s[0:1], 40
    s_mov_b32 s46, 0x500000
    s_mov_b32 s47, 0x00020000
    s_waitcnt lgkmcnt(0)
    s_mul_i32 s21, s14, 36864
    v_lshrrev_b32 v7, 2, v0
    v_mul_u32_u24 v4, 1280, v7
    v_bfe_u32 v7, v0, 4, 1
    v_lshlrev_b32 v7, 1, v7
    v_and_b32 v8, 3, v0
    v_xor_b32 v7, v7, v8
    v_lshl_add_u32 v4, v7, 4, v4
    v_lshrrev_b32 v7, 4, v0
    v_lshlrev_b32 v2, 8, v7
    v_bfe_u32 v7, v0, 2, 2
    v_lshl_add_u32 v2, v7, 6, v2
    v_and_b32 v7, 3, v0
    v_lshl_add_u32 v2, v7, 3, v2
    v_add_u32 v2, s21, v2
    v_bfe_u32 v7, v0, 4, 1
    v_lshlrev_b32 v7, 5, v7
    v_sub_u32 v3, 32, v7
    v_add_u32 v3, v3, v2
    v_add_u32 v2, v2, v7
    s_mul_i32 s65, s14, 1310720
    s_lshl_b32 s66, s13, 6
    s_add_u32 s65, s65, s66
    s_add_u32 m0, s21, 0
    s_add_u32 s64, s65, 0x0
    buffer_load_dwordx4 v4, s[44:47], s64 offen lds
    s_add_u32 m0, s21, 1024
    s_add_u32 s64, s65, 0x5000
    buffer_load_dwordx4 v4, s[44:47], s64 offen lds
    s_add_u32 m0, s21, 2048
    s_add_u32 s64, s65, 0xa000
    buffer_load_dwordx4 v4, s[44:47], s64 offen lds
    s_add_u32 m0, s21, 3072
    s_add_u32 s64, s65, 0xf000
    buffer_load_dwordx4 v4, s[44:47], s64 offen lds
    s_add_u32 m0, s21, 4096
    s_add_u32 s64, s65, 0x14000
    buffer_load_dwordx4 v4, s[44:47], s64 offen lds
    s_add_u32 m0, s21, 5120
    s_add_u32 s64, s65, 0x19000
    buffer_load_dwordx4 v4, s[44:47], s64 offen lds
    s_add_u32 m0, s21, 6144
    s_add_u32 s64, s65, 0x1e000
    buffer_load_dwordx4 v4, s[44:47], s64 offen lds
    s_add_u32 m0, s21, 7168
    s_add_u32 s64, s65, 0x23000
    buffer_load_dwordx4 v4, s[44:47], s64 offen lds
    s_add_u32 m0, s21, 8192
    s_add_u32 s64, s65, 0x28000
    buffer_load_dwordx4 v4, s[44:47], s64 offen lds
    s_add_u32 m0, s21, 9216
    s_add_u32 s64, s65, 0x2d000
    buffer_load_dwordx4 v4, s[44:47], s64 offen lds
    s_add_u32 m0, s21, 10240
    s_add_u32 s64, s65, 0x32000
    buffer_load_dwordx4 v4, s[44:47], s64 offen lds
    s_add_u32 m0, s21, 11264
    s_add_u32 s64, s65, 0x37000
    buffer_load_dwordx4 v4, s[44:47], s64 offen lds
    s_add_u32 m0, s21, 12288
    s_add_u32 s64, s65, 0x3c000
    buffer_load_dwordx4 v4, s[44:47], s64 offen lds
    s_add_u32 m0, s21, 13312
    s_add_u32 s64, s65, 0x41000
    buffer_load_dwordx4 v4, s[44:47], s64 offen lds
    s_add_u32 m0, s21, 14336
    s_add_u32 s64, s65, 0x46000
    buffer_load_dwordx4 v4, s[44:47], s64 offen lds
    s_add_u32 m0, s21, 15360
    s_add_u32 s64, s65, 0x4b000
    buffer_load_dwordx4 v4, s[44:47], s64 offen lds
    s_add_u32 m0, s21, 16384
    s_add_u32 s64, s65, 0x50000
    buffer_load_dwordx4 v4, s[44:47], s64 offen lds
    s_add_u32 m0, s21, 17408
    s_add_u32 s64, s65, 0x55000
    buffer_load_dwordx4 v4, s[44:47], s64 offen lds
    s_add_u32 m0, s21, 18432
    s_add_u32 s64, s65, 0x5a000
    buffer_load_dwordx4 v4, s[44:47], s64 offen lds
    s_add_u32 m0, s21, 19456
    s_add_u32 s64, s65, 0x5f000
    buffer_load_dwordx4 v4, s[44:47], s64 offen lds
    s_add_u32 m0, s21, 20480
    s_add_u32 s64, s65, 0x64000
    buffer_load_dwordx4 v4, s[44:47], s64 offen lds
    s_add_u32 m0, s21, 21504
    s_add_u32 s64, s65, 0x69000
    buffer_load_dwordx4 v4, s[44:47], s64 offen lds
    s_add_u32 m0, s21, 22528
    s_add_u32 s64, s65, 0x6e000
    buffer_load_dwordx4 v4, s[44:47], s64 offen lds
    s_add_u32 m0, s21, 23552
    s_add_u32 s64, s65, 0x73000
    buffer_load_dwordx4 v4, s[44:47], s64 offen lds
    s_add_u32 m0, s21, 24576
    s_add_u32 s64, s65, 0x78000
    buffer_load_dwordx4 v4, s[44:47], s64 offen lds
    s_add_u32 m0, s21, 25600
    s_add_u32 s64, s65, 0x7d000
    buffer_load_dwordx4 v4, s[44:47], s64 offen lds
    s_add_u32 m0, s21, 26624
    s_add_u32 s64, s65, 0x82000
    buffer_load_dwordx4 v4, s[44:47], s64 offen lds
    s_add_u32 m0, s21, 27648
    s_add_u32 s64, s65, 0x87000
    buffer_load_dwordx4 v4, s[44:47], s64 offen lds
    s_add_u32 m0, s21, 28672
    s_add_u32 s64, s65, 0x8c000
    buffer_load_dwordx4 v4, s[44:47], s64 offen lds
    s_add_u32 m0, s21, 29696
    s_add_u32 s64, s65, 0x91000
    buffer_load_dwordx4 v4, s[44:47], s64 offen lds
    s_add_u32 m0, s21, 30720
    s_add_u32 s64, s65, 0x96000
    buffer_load_dwordx4 v4, s[44:47], s64 offen lds
    s_add_u32 m0, s21, 31744
    s_add_u32 s64, s65, 0x9b000
    buffer_load_dwordx4 v4, s[44:47], s64 offen lds
    s_add_u32 m0, s21, 32768
    s_add_u32 s64, s65, 0xa0000
    buffer_load_dwordx4 v4, s[44:47], s64 offen lds
    s_add_u32 m0, s21, 33792
    s_add_u32 s64, s65, 0xa5000
    buffer_load_dwordx4 v4, s[44:47], s64 offen lds
    s_add_u32 m0, s21, 34816
    s_add_u32 s64, s65, 0xaa000
    buffer_load_dwordx4 v4, s[44:47], s64 offen lds
    s_add_u32 m0, s21, 35840
    s_add_u32 s64, s65, 0xaf000
    buffer_load_dwordx4 v4, s[44:47], s64 offen lds
    s_waitcnt vmcnt(32)
    ds_read_b64_tr_b16 a[0:1], v2 offset:0
    ds_read_b64_tr_b16 a[2:3], v2 offset:1024
    ds_read_b64_tr_b16 a[4:5], v3 offset:0
    ds_read_b64_tr_b16 a[6:7], v3 offset:1024
    ds_read_b64_tr_b16 a[8:9], v2 offset:2048
    ds_read_b64_tr_b16 a[10:11], v2 offset:3072
    ds_read_b64_tr_b16 a[12:13], v3 offset:2048
    ds_read_b64_tr_b16 a[14:15], v3 offset:3072
    s_waitcnt lgkmcnt(0)
    s_add_u32 m0, s21, 0
    s_add_u32 s64, s65, 0xb4000
    buffer_load_dwordx4 v4, s[44:47], s64 offen lds
    s_add_u32 m0, s21, 1024
    s_add_u32 s64, s65, 0xb9000
    buffer_load_dwordx4 v4, s[44:47], s64 offen lds
    s_add_u32 m0, s21, 2048
    s_add_u32 s64, s65, 0xbe000
    buffer_load_dwordx4 v4, s[44:47], s64 offen lds
    s_add_u32 m0, s21, 3072
    s_add_u32 s64, s65, 0xc3000
    buffer_load_dwordx4 v4, s[44:47], s64 offen lds
    s_waitcnt vmcnt(32)
    ds_read_b64_tr_b16 a[16:17], v2 offset:4096
    ds_read_b64_tr_b16 a[18:19], v2 offset:5120
    ds_read_b64_tr_b16 a[20:21], v3 offset:4096
    ds_read_b64_tr_b16 a[22:23], v3 offset:5120
    ds_read_b64_tr_b16 a[24:25], v2 offset:6144
    ds_read_b64_tr_b16 a[26:27], v2 offset:7168
    ds_read_b64_tr_b16 a[28:29], v3 offset:6144
    ds_read_b64_tr_b16 a[30:31], v3 offset:7168
    s_waitcnt lgkmcnt(0)
    s_add_u32 m0, s21, 4096
    s_add_u32 s64, s65, 0xc8000
    buffer_load_dwordx4 v4, s[44:47], s64 offen lds
    s_add_u32 m0, s21, 5120
    s_add_u32 s64, s65, 0xcd000
    buffer_load_dwordx4 v4, s[44:47], s64 offen lds
    s_add_u32 m0, s21, 6144
    s_add_u32 s64, s65, 0xd2000
    buffer_load_dwordx4 v4, s[44:47], s64 offen lds
    s_add_u32 m0, s21, 7168
    s_add_u32 s64, s65, 0xd7000
    buffer_load_dwordx4 v4, s[44:47], s64 offen lds
    s_waitcnt vmcnt(32)
    ds_read_b64_tr_b16 a[32:33], v2 offset:8192
    ds_read_b64_tr_b16 a[34:35], v2 offset:9216
    ds_read_b64_tr_b16 a[36:37], v3 offset:8192
    ds_read_b64_tr_b16 a[38:39], v3 offset:9216
    ds_read_b64_tr_b16 a[40:41], v2 offset:10240
    ds_read_b64_tr_b16 a[42:43], v2 offset:11264
    ds_read_b64_tr_b16 a[44:45], v3 offset:10240
    ds_read_b64_tr_b16 a[46:47], v3 offset:11264
    s_waitcnt lgkmcnt(0)
    s_add_u32 m0, s21, 8192
    s_add_u32 s64, s65, 0xdc000
    buffer_load_dwordx4 v4, s[44:47], s64 offen lds
    s_add_u32 m0, s21, 9216
    s_add_u32 s64, s65, 0xe1000
    buffer_load_dwordx4 v4, s[44:47], s64 offen lds
    s_add_u32 m0, s21, 10240
    s_add_u32 s64, s65, 0xe6000
    buffer_load_dwordx4 v4, s[44:47], s64 offen lds
    s_add_u32 m0, s21, 11264
    s_add_u32 s64, s65, 0xeb000
    buffer_load_dwordx4 v4, s[44:47], s64 offen lds
    s_waitcnt vmcnt(32)
    ds_read_b64_tr_b16 a[48:49], v2 offset:12288
    ds_read_b64_tr_b16 a[50:51], v2 offset:13312
    ds_read_b64_tr_b16 a[52:53], v3 offset:12288
    ds_read_b64_tr_b16 a[54:55], v3 offset:13312
    ds_read_b64_tr_b16 a[56:57], v2 offset:14336
    ds_read_b64_tr_b16 a[58:59], v2 offset:15360
    ds_read_b64_tr_b16 a[60:61], v3 offset:14336
    ds_read_b64_tr_b16 a[62:63], v3 offset:15360
    s_waitcnt lgkmcnt(0)
    s_add_u32 m0, s21, 12288
    s_add_u32 s64, s65, 0xf0000
    buffer_load_dwordx4 v4, s[44:47], s64 offen lds
    s_add_u32 m0, s21, 13312
    s_add_u32 s64, s65, 0xf5000
    buffer_load_dwordx4 v4, s[44:47], s64 offen lds
    s_add_u32 m0, s21, 14336
    s_add_u32 s64, s65, 0xfa000
    buffer_load_dwordx4 v4, s[44:47], s64 offen lds
    s_add_u32 m0, s21, 15360
    s_add_u32 s64, s65, 0xff000
    buffer_load_dwordx4 v4, s[44:47], s64 offen lds
    s_waitcnt vmcnt(32)
    ds_read_b64_tr_b16 a[64:65], v2 offset:16384
    ds_read_b64_tr_b16 a[66:67], v2 offset:17408
    ds_read_b64_tr_b16 a[68:69], v3 offset:16384
    ds_read_b64_tr_b16 a[70:71], v3 offset:17408
    ds_read_b64_tr_b16 a[72:73], v2 offset:18432
    ds_read_b64_tr_b16 a[74:75], v2 offset:19456
    ds_read_b64_tr_b16 a[76:77], v3 offset:18432
    ds_read_b64_tr_b16 a[78:79], v3 offset:19456
    s_waitcnt lgkmcnt(0)
    s_add_u32 m0, s21, 16384
    s_add_u32 s64, s65, 0x104000
    buffer_load_dwordx4 v4, s[44:47], s64 offen lds
    s_add_u32 m0, s21, 17408
    s_add_u32 s64, s65, 0x109000
    buffer_load_dwordx4 v4, s[44:47], s64 offen lds
    s_add_u32 m0, s21, 18432
    s_add_u32 s64, s65, 0x10e000
    buffer_load_dwordx4 v4, s[44:47], s64 offen lds
    s_add_u32 m0, s21, 19456
    s_add_u32 s64, s65, 0x113000
    buffer_load_dwordx4 v4, s[44:47], s64 offen lds
    s_waitcnt vmcnt(32)
    ds_read_b64_tr_b16 a[80:81], v2 offset:20480
    ds_read_b64_tr_b16 a[82:83], v2 offset:21504
    ds_read_b64_tr_b16 a[84:85], v3 offset:20480
    ds_read_b64_tr_b16 a[86:87], v3 offset:21504
    ds_read_b64_tr_b16 a[88:89], v2 offset:22528
    ds_read_b64_tr_b16 a[90:91], v2 offset:23552
    ds_read_b64_tr_b16 a[92:93], v3 offset:22528
    ds_read_b64_tr_b16 a[94:95], v3 offset:23552
    s_waitcnt lgkmcnt(0)
    s_add_u32 m0, s21, 20480
    s_add_u32 s64, s65, 0x118000
    buffer_load_dwordx4 v4, s[44:47], s64 offen lds
    s_add_u32 m0, s21, 21504
    s_add_u32 s64, s65, 0x11d000
    buffer_load_dwordx4 v4, s[44:47], s64 offen lds
    s_add_u32 m0, s21, 22528
    s_add_u32 s64, s65, 0x122000
    buffer_load_dwordx4 v4, s[44:47], s64 offen lds
    s_add_u32 m0, s21, 23552
    s_add_u32 s64, s65, 0x127000
    buffer_load_dwordx4 v4, s[44:47], s64 offen lds
    s_waitcnt vmcnt(32)
    ds_read_b64_tr_b16 a[96:97], v2 offset:24576
    ds_read_b64_tr_b16 a[98:99], v2 offset:25600
    ds_read_b64_tr_b16 a[100:101], v3 offset:24576
    ds_read_b64_tr_b16 a[102:103], v3 offset:25600
    ds_read_b64_tr_b16 a[104:105], v2 offset:26624
    ds_read_b64_tr_b16 a[106:107], v2 offset:27648
    ds_read_b64_tr_b16 a[108:109], v3 offset:26624
    ds_read_b64_tr_b16 a[110:111], v3 offset:27648
    s_waitcnt lgkmcnt(0)
    s_add_u32 m0, s21, 24576
    s_add_u32 s64, s65, 0x12c000
    buffer_load_dwordx4 v4, s[44:47], s64 offen lds
    s_add_u32 m0, s21, 25600
    s_add_u32 s64, s65, 0x131000
    buffer_load_dwordx4 v4, s[44:47], s64 offen lds
    s_add_u32 m0, s21, 26624
    s_add_u32 s64, s65, 0x136000
    buffer_load_dwordx4 v4, s[44:47], s64 offen lds
    s_add_u32 m0, s21, 27648
    s_add_u32 s64, s65, 0x13b000
    buffer_load_dwordx4 v4, s[44:47], s64 offen lds
    s_waitcnt vmcnt(32)
    ds_read_b64_tr_b16 a[112:113], v2 offset:28672
    ds_read_b64_tr_b16 a[114:115], v2 offset:29696
    ds_read_b64_tr_b16 a[116:117], v3 offset:28672
    ds_read_b64_tr_b16 a[118:119], v3 offset:29696
    ds_read_b64_tr_b16 a[120:121], v2 offset:30720
    ds_read_b64_tr_b16 a[122:123], v2 offset:31744
    ds_read_b64_tr_b16 a[124:125], v3 offset:30720
    ds_read_b64_tr_b16 a[126:127], v3 offset:31744
    s_waitcnt lgkmcnt(0)
    s_waitcnt vmcnt(28)
    ds_read_b64_tr_b16 a[128:129], v2 offset:32768
    ds_read_b64_tr_b16 a[130:131], v2 offset:33792
    ds_read_b64_tr_b16 a[132:133], v3 offset:32768
    ds_read_b64_tr_b16 a[134:135], v3 offset:33792
    ds_read_b64_tr_b16 a[136:137], v2 offset:34816
    ds_read_b64_tr_b16 a[138:139], v2 offset:35840
    ds_read_b64_tr_b16 a[140:141], v3 offset:34816
    ds_read_b64_tr_b16 a[142:143], v3 offset:35840
    s_waitcnt lgkmcnt(0)
    s_waitcnt vmcnt(24)
    ds_read_b64_tr_b16 a[144:145], v2 offset:0
    ds_read_b64_tr_b16 a[146:147], v2 offset:1024
    ds_read_b64_tr_b16 a[148:149], v3 offset:0
    ds_read_b64_tr_b16 a[150:151], v3 offset:1024
    ds_read_b64_tr_b16 a[152:153], v2 offset:2048
    ds_read_b64_tr_b16 a[154:155], v2 offset:3072
    ds_read_b64_tr_b16 a[156:157], v3 offset:2048
    ds_read_b64_tr_b16 a[158:159], v3 offset:3072
    s_waitcnt lgkmcnt(0)
    s_waitcnt vmcnt(20)
    ds_read_b64_tr_b16 a[160:161], v2 offset:4096
    ds_read_b64_tr_b16 a[162:163], v2 offset:5120
    ds_read_b64_tr_b16 a[164:165], v3 offset:4096
    ds_read_b64_tr_b16 a[166:167], v3 offset:5120
    ds_read_b64_tr_b16 a[168:169], v2 offset:6144
    ds_read_b64_tr_b16 a[170:171], v2 offset:7168
    ds_read_b64_tr_b16 a[172:173], v3 offset:6144
    ds_read_b64_tr_b16 a[174:175], v3 offset:7168
    s_waitcnt lgkmcnt(0)
    s_waitcnt vmcnt(16)
    ds_read_b64_tr_b16 a[176:177], v2 offset:8192
    ds_read_b64_tr_b16 a[178:179], v2 offset:9216
    ds_read_b64_tr_b16 a[180:181], v3 offset:8192
    ds_read_b64_tr_b16 a[182:183], v3 offset:9216
    ds_read_b64_tr_b16 a[184:185], v2 offset:10240
    ds_read_b64_tr_b16 a[186:187], v2 offset:11264
    ds_read_b64_tr_b16 a[188:189], v3 offset:10240
    ds_read_b64_tr_b16 a[190:191], v3 offset:11264
    s_waitcnt lgkmcnt(0)
    s_waitcnt vmcnt(12)
    ds_read_b64_tr_b16 a[192:193], v2 offset:12288
    ds_read_b64_tr_b16 a[194:195], v2 offset:13312
    ds_read_b64_tr_b16 a[196:197], v3 offset:12288
    ds_read_b64_tr_b16 a[198:199], v3 offset:13312
    ds_read_b64_tr_b16 a[200:201], v2 offset:14336
    ds_read_b64_tr_b16 a[202:203], v2 offset:15360
    ds_read_b64_tr_b16 a[204:205], v3 offset:14336
    ds_read_b64_tr_b16 a[206:207], v3 offset:15360
    s_waitcnt lgkmcnt(0)
    s_waitcnt vmcnt(8)
    ds_read_b64_tr_b16 a[208:209], v2 offset:16384
    ds_read_b64_tr_b16 a[210:211], v2 offset:17408
    ds_read_b64_tr_b16 a[212:213], v3 offset:16384
    ds_read_b64_tr_b16 a[214:215], v3 offset:17408
    ds_read_b64_tr_b16 a[216:217], v2 offset:18432
    ds_read_b64_tr_b16 a[218:219], v2 offset:19456
    ds_read_b64_tr_b16 a[220:221], v3 offset:18432
    ds_read_b64_tr_b16 a[222:223], v3 offset:19456
    s_waitcnt lgkmcnt(0)
    s_waitcnt vmcnt(4)
    ds_read_b64_tr_b16 a[224:225], v2 offset:20480
    ds_read_b64_tr_b16 a[226:227], v2 offset:21504
    ds_read_b64_tr_b16 a[228:229], v3 offset:20480
    ds_read_b64_tr_b16 a[230:231], v3 offset:21504
    ds_read_b64_tr_b16 a[232:233], v2 offset:22528
    ds_read_b64_tr_b16 a[234:235], v2 offset:23552
    ds_read_b64_tr_b16 a[236:237], v3 offset:22528
    ds_read_b64_tr_b16 a[238:239], v3 offset:23552
    s_waitcnt lgkmcnt(0)
    s_waitcnt vmcnt(0)
    ds_read_b64_tr_b16 a[240:241], v2 offset:24576
    ds_read_b64_tr_b16 a[242:243], v2 offset:25600
    ds_read_b64_tr_b16 a[244:245], v3 offset:24576
    ds_read_b64_tr_b16 a[246:247], v3 offset:25600
    ds_read_b64_tr_b16 a[248:249], v2 offset:26624
    ds_read_b64_tr_b16 a[250:251], v2 offset:27648
    ds_read_b64_tr_b16 a[252:253], v3 offset:26624
    ds_read_b64_tr_b16 a[254:255], v3 offset:27648
    s_waitcnt lgkmcnt(0)
    s_mov_b32 s13, s89
NOWO_111:
    v_mov_b32 v2, v10
    v_mov_b32 v3, v11
MKH_110:
    s_mov_b64 exec, 0xf
MKT_M_112:
    buffer_load_dword v5, v6, s[4:7], s28 offen sc1
    s_add_u32 s29, s29, 1
    s_waitcnt vmcnt(0)
    v_cmp_eq_u32 vcc, 0, v5
    s_cbranch_vccz MKT_MD_113
    s_cmp_gt_u32 s29, 262144
    s_cbranch_scc1 MKT_MD_113
    s_sleep 1
    s_branch MKT_M_112
MKT_MD_113:
    s_mov_b64 exec, -1
MKR_114:
    s_add_u32 s64, s25, 0x0
    buffer_load_dwordx4 v[16:19], v2, s[4:7], s64 offen sc1
    s_add_u32 s64, s25, 0x200
    buffer_load_dwordx4 v[20:23], v2, s[4:7], s64 offen sc1
    s_add_u32 s64, s25, 0x400
    buffer_load_dwordx4 v[24:27], v2, s[4:7], s64 offen sc1
    s_add_u32 s64, s25, 0x600
    buffer_load_dwordx4 v[28:31], v2, s[4:7], s64 offen sc1
    s_add_u32 s64, s25, 0x800
    buffer_load_dwordx4 v[32:35], v2, s[4:7], s64 offen sc1
    s_add_u32 s64, s25, 0xa00
    buffer_load_dwordx4 v[36:39], v2, s[4:7], s64 offen sc1
    s_add_u32 s64, s25, 0xc00
    buffer_load_dwordx4 v[40:43], v2, s[4:7], s64 offen sc1
    s_add_u32 s64, s25, 0xe00
    buffer_load_dwordx4 v[44:47], v2, s[4:7], s64 offen sc1
    s_add_u32 s64, s25, 0x1000
    buffer_load_dwordx4 v[48:51], v2, s[4:7], s64 offen sc1
    s_add_u32 s64, s25, 0x1200
    buffer_load_dwordx4 v[52:55], v2, s[4:7], s64 offen sc1
    s_add_u32 s64, s30, 0x0
    buffer_load_dwordx4 v[56:59], v2, s[4:7], s64 offen sc1
    s_add_u32 s64, s30, 0x200
    buffer_load_dwordx4 v[60:63], v2, s[4:7], s64 offen sc1
    s_add_u32 s64, s30, 0x400
    buffer_load_dwordx4 v[64:67], v2, s[4:7], s64 offen sc1
    s_add_u32 s64, s30, 0x600
    buffer_load_dwordx4 v[68:71], v2, s[4:7], s64 offen sc1
    s_add_u32 s64, s30, 0x800
    buffer_load_dwordx4 v[72:75], v2, s[4:7], s64 offen sc1
    s_add_u32 s64, s30, 0xa00
    buffer_load_dwordx4 v[76:79], v2, s[4:7], s64 offen sc1
    s_add_u32 s64, s30, 0xc00
    buffer_load_dwordx4 v[80:83], v2, s[4:7], s64 offen sc1
    s_add_u32 s64, s30, 0xe00
    buffer_load_dwordx4 v[84:87], v2, s[4:7], s64 offen sc1
    s_add_u32 s64, s30, 0x1000
    buffer_load_dwordx4 v[88:91], v2, s[4:7], s64 offen sc1
    s_add_u32 s64, s30, 0x1200
    buffer_load_dwordx4 v[92:95], v2, s[4:7], s64 offen sc1
    s_add_u32 s29, s29, 1
    s_waitcnt vmcnt(0)
    v_max3_u32 v4, v19, v23, v27
    v_max3_u32 v4, v4, v31, v35
    v_max3_u32 v4, v4, v39, v43
    v_max3_u32 v4, v4, v47, v51
    v_max3_u32 v4, v4, v55, v59
    v_max3_u32 v4, v4, v63, v67
    v_max3_u32 v4, v4, v71, v75
    v_max3_u32 v4, v4, v79, v83
    v_max3_u32 v4, v4, v87, v91
    v_max_u32 v4, v4, v95
    v_cmp_eq_u32 vcc, -1, v4
    s_cbranch_vccz MKO_115
    s_cmp_gt_u32 s29, 262144
    s_cbranch_scc0 MKR_114
MKO_115:
    v_mfma_f32_16x16x32_bf16 v[8:11], v[96:99], v[16:19], 0
    v_mfma_f32_16x16x32_bf16 v[12:15], v[100:103], v[16:19], 0
    v_mfma_f32_16x16x32_bf16 v[8:11], v[104:107], v[20:23], v[8:11]
    v_mfma_f32_16x16x32_bf16 v[12:15], v[108:111], v[20:23], v[12:15]
    v_mfma_f32_16x16x32_bf16 v[8:11], v[112:115], v[24:27], v[8:11]
    v_mfma_f32_16x16x32_bf16 v[12:15], v[116:119], v[24:27], v[12:15]
    v_mfma_f32_16x16x32_bf16 v[8:11], v[120:123], v[28:31], v[8:11]
    v_mfma_f32_16x16x32_bf16 v[12:15], v[124:127], v[28:31], v[12:15]
    v_mfma_f32_16x16x32_bf16 v[8:11], v[128:131], v[32:35], v[8:11]
    v_mfma_f32_16x16x32_bf16 v[12:15], v[132:135], v[32:35], v[12:15]
    v_mfma_f32_16x16x32_bf16 v[8:11], v[136:139], v[36:39], v[8:11]
    v_mfma_f32_16x16x32_bf16 v[12:15], v[140:143], v[36:39], v[12:15]
    v_mfma_f32_16x16x32_bf16 v[8:11], v[144:147], v[40:43], v[8:11]
    v_mfma_f32_16x16x32_bf16 v[12:15], v[148:151], v[40:43], v[12:15]
    v_mfma_f32_16x16x32_bf16 v[8:11], v[152:155], v[44:47], v[8:11]
    v_mfma_f32_16x16x32_bf16 v[12:15], v[156:159], v[44:47], v[12:15]
    v_mfma_f32_16x16x32_bf16 v[8:11], v[160:163], v[48:51], v[8:11]
    v_mfma_f32_16x16x32_bf16 v[12:15], v[164:167], v[48:51], v[12:15]
    v_mfma_f32_16x16x32_bf16 v[8:11], v[168:171], v[52:55], v[8:11]
    v_mfma_f32_16x16x32_bf16 v[12:15], v[172:175], v[52:55], v[12:15]
    v_mfma_f32_16x16x32_bf16 v[8:11], v[176:179], v[56:59], v[8:11]
    v_mfma_f32_16x16x32_bf16 v[12:15], v[180:183], v[56:59], v[12:15]
    v_mfma_f32_16x16x32_bf16 v[8:11], v[184:187], v[60:63], v[8:11]
    v_mfma_f32_16x16x32_bf16 v[12:15], v[188:191], v[60:63], v[12:15]
    v_mfma_f32_16x16x32_bf16 v[8:11], v[192:195], v[64:67], v[8:11]
    v_mfma_f32_16x16x32_bf16 v[12:15], v[196:199], v[64:67], v[12:15]
    v_mfma_f32_16x16x32_bf16 v[8:11], v[200:203], v[68:71], v[8:11]
    v_mfma_f32_16x16x32_bf16 v[12:15], v[204:207], v[68:71], v[12:15]
    v_mfma_f32_16x16x32_bf16 v[8:11], v[208:211], v[72:75], v[8:11]
    v_mfma_f32_16x16x32_bf16 v[12:15], v[212:215], v[72:75], v[12:15]
    v_mfma_f32_16x16x32_bf16 v[8:11], v[216:219], v[76:79], v[8:11]
    v_mfma_f32_16x16x32_bf16 v[12:15], v[220:223], v[76:79], v[12:15]
    v_mfma_f32_16x16x32_bf16 v[8:11], v[224:227], v[80:83], v[8:11]
    v_mfma_f32_16x16x32_bf16 v[12:15], v[228:231], v[80:83], v[12:15]
    v_mfma_f32_16x16x32_bf16 v[8:11], v[232:235], v[84:87], v[8:11]
    v_mfma_f32_16x16x32_bf16 v[12:15], v[236:239], v[84:87], v[12:15]
    v_mfma_f32_16x16x32_bf16 v[8:11], v[240:243], v[88:91], v[8:11]
    v_mfma_f32_16x16x32_bf16 v[12:15], v[244:247], v[88:91], v[12:15]
    v_mfma_f32_16x16x32_bf16 v[8:11], v[248:251], v[92:95], v[8:11]
    v_mfma_f32_16x16x32_bf16 v[12:15], v[252:255], v[92:95], v[12:15]
    s_nop 7
    v_cvt_pk_bf16_f32 v16, v8, v9
    v_cvt_pk_bf16_f32 v17, v10, v11
    v_cvt_pk_bf16_f32 v18, v12, v13
    v_cvt_pk_bf16_f32 v19, v14, v15
    buffer_store_dwordx4 v[16:19], v3, s[4:7], s26 offen sc1
    s_waitcnt vmcnt(0)
    s_barrier
    s_cmp_lg_u32 s14, 0
    s_cbranch_scc1 GF_116
    v_mov_b32 v7, 1
    v_mov_b32 v8, 0
    s_mov_b64 exec, 1
    buffer_store_dword v7, v8, s[4:7], s27 offen sc1
    s_mov_b64 exec, -1
GF_116:
    s_add_u32 s25, s25, 0x10000
    s_add_u32 s30, s30, 0x10000
    s_add_u32 s26, s26, 0x20000
    s_add_u32 s27, s27, 256
    s_add_u32 s28, s28, 512
    s_add_u32 s24, s24, 1
    s_cmp_lt_u32 s24, 32
    s_cbranch_scc1 MKT_LOOP
    s_cmp_ge_u32 s88, 60
    s_cbranch_scc1 M_EXIT
    s_branch H_EXTRA
G_N:
    s_lshl_b32 s65, s13, 8
    s_lshl_b32 s66, s14, 6
    s_add_u32 s20, s65, s66
    s_mul_i32 s21, s14, 36864
    v_lshrrev_b32 v6, 2, v0
    v_mul_u32_u24 v5, 8192, v6
    v_lshrrev_b32 v6, 5, v0
    v_lshlrev_b32 v6, 1, v6
    v_and_b32 v7, 3, v0
    v_xor_b32 v6, v6, v7
    v_lshl_add_u32 v5, v6, 4, v5
    v_lshrrev_b32 v6, 5, v0
    v_lshlrev_b32 v3, 10, v6
    v_bfe_u32 v6, v0, 2, 2
    v_lshl_add_u32 v3, v6, 6, v3
    v_and_b32 v6, 3, v0
    v_lshl_add_u32 v3, v6, 3, v3
    v_bfe_u32 v6, v0, 4, 1
    v_lshl_add_u32 v3, v6, 9, v3
    v_add_u32 v3, s21, v3
    v_lshlrev_b32 v6, 5, v6
    v_sub_u32 v4, 32, v6
    v_add_u32 v4, v4, v3
    v_add_u32 v3, v3, v6
    s_add_u32 m0, s21, 0
    s_add_u32 s64, s20, 0x0
    buffer_load_dwordx4 v5, s[44:47], s64 offen lds
    s_add_u32 m0, s21, 1024
    s_add_u32 s64, s20, 0x20000
    buffer_load_dwordx4 v5, s[44:47], s64 offen lds
    s_add_u32 m0, s21, 2048
    s_add_u32 s64, s20, 0x40000
    buffer_load_dwordx4 v5, s[44:47], s64 offen lds
    s_add_u32 m0, s21, 3072
    s_add_u32 s64, s20, 0x60000
    buffer_load_dwordx4 v5, s[44:47], s64 offen lds
    s_add_u32 m0, s21, 4096
    s_add_u32 s64, s20, 0x80000
    buffer_load_dwordx4 v5, s[44:47], s64 offen lds
    s_add_u32 m0, s21, 5120
    s_add_u32 s64, s20, 0xa0000
    buffer_load_dwordx4 v5, s[44:47], s64 offen lds
    s_add_u32 m0, s21, 6144
    s_add_u32 s64, s20, 0xc0000
    buffer_load_dwordx4 v5, s[44:47], s64 offen lds
    s_add_u32 m0, s21, 7168
    s_add_u32 s64, s20, 0xe0000
    buffer_load_dwordx4 v5, s[44:47], s64 offen lds
    s_add_u32 m0, s21, 8192
    s_add_u32 s64, s20, 0x100000
    buffer_load_dwordx4 v5, s[44:47], s64 offen lds
    s_add_u32 m0, s21, 9216
    s_add_u32 s64, s20, 0x120000
    buffer_load_dwordx4 v5, s[44:47], s64 offen lds
    s_add_u32 m0, s21, 10240
    s_add_u32 s64, s20, 0x140000
    buffer_load_dwordx4 v5, s[44:47], s64 offen lds
    s_add_u32 m0, s21, 11264
    s_add_u32 s64, s20, 0x160000
    buffer_load_dwordx4 v5, s[44:47], s64 offen lds
    s_add_u32 m0, s21, 12288
    s_add_u32 s64, s20, 0x180000
    buffer_load_dwordx4 v5, s[44:47], s64 offen lds
    s_add_u32 m0, s21, 13312
    s_add_u32 s64, s20, 0x1a0000
    buffer_load_dwordx4 v5, s[44:47], s64 offen lds
    s_add_u32 m0, s21, 14336
    s_add_u32 s64, s20, 0x1c0000
    buffer_load_dwordx4 v5, s[44:47], s64 offen lds
    s_add_u32 m0, s21, 15360
    s_add_u32 s64, s20, 0x1e0000
    buffer_load_dwordx4 v5, s[44:47], s64 offen lds
    s_add_u32 m0, s21, 16384
    s_add_u32 s64, s20, 0x200000
    buffer_load_dwordx4 v5, s[44:47], s64 offen lds
    s_add_u32 m0, s21, 17408
    s_add_u32 s64, s20, 0x220000
    buffer_load_dwordx4 v5, s[44:47], s64 offen lds
    s_add_u32 m0, s21, 18432
    s_add_u32 s64, s20, 0x240000
    buffer_load_dwordx4 v5, s[44:47], s64 offen lds
    s_add_u32 m0, s21, 19456
    s_add_u32 s64, s20, 0x260000
    buffer_load_dwordx4 v5, s[44:47], s64 offen lds
    s_add_u32 m0, s21, 20480
    s_add_u32 s64, s20, 0x280000
    buffer_load_dwordx4 v5, s[44:47], s64 offen lds
    s_add_u32 m0, s21, 21504
    s_add_u32 s64, s20, 0x2a0000
    buffer_load_dwordx4 v5, s[44:47], s64 offen lds
    s_add_u32 m0, s21, 22528
    s_add_u32 s64, s20, 0x2c0000
    buffer_load_dwordx4 v5, s[44:47], s64 offen lds
    s_add_u32 m0, s21, 23552
    s_add_u32 s64, s20, 0x2e0000
    buffer_load_dwordx4 v5, s[44:47], s64 offen lds
    s_add_u32 m0, s21, 24576
    s_add_u32 s64, s20, 0x300000
    buffer_load_dwordx4 v5, s[44:47], s64 offen lds
    s_add_u32 m0, s21, 25600
    s_add_u32 s64, s20, 0x320000
    buffer_load_dwordx4 v5, s[44:47], s64 offen lds
    s_add_u32 m0, s21, 26624
    s_add_u32 s64, s20, 0x340000
    buffer_load_dwordx4 v5, s[44:47], s64 offen lds
    s_add_u32 m0, s21, 27648
    s_add_u32 s64, s20, 0x360000
    buffer_load_dwordx4 v5, s[44:47], s64 offen lds
    s_add_u32 m0, s21, 28672
    s_add_u32 s64, s20, 0x380000
    buffer_load_dwordx4 v5, s[44:47], s64 offen lds
    s_add_u32 m0, s21, 29696
    s_add_u32 s64, s20, 0x3a0000
    buffer_load_dwordx4 v5, s[44:47], s64 offen lds
    s_add_u32 m0, s21, 30720
    s_add_u32 s64, s20, 0x3c0000
    buffer_load_dwordx4 v5, s[44:47], s64 offen lds
    s_add_u32 m0, s21, 31744
    s_add_u32 s64, s20, 0x3e0000
    buffer_load_dwordx4 v5, s[44:47], s64 offen lds
    s_add_u32 m0, s21, 32768
    s_add_u32 s64, s20, 0x400000
    buffer_load_dwordx4 v5, s[44:47], s64 offen lds
    s_add_u32 m0, s21, 33792
    s_add_u32 s64, s20, 0x420000
    buffer_load_dwordx4 v5, s[44:47], s64 offen lds
    s_add_u32 m0, s21, 34816
    s_add_u32 s64, s20, 0x440000
    buffer_load_dwordx4 v5, s[44:47], s64 offen lds
    s_add_u32 m0, s21, 35840
    s_add_u32 s64, s20, 0x460000
    buffer_load_dwordx4 v5, s[44:47], s64 offen lds
    s_waitcnt vmcnt(32)
    ds_read_b64_tr_b16 v[96:97], v3 offset:0
    ds_read_b64_tr_b16 v[98:99], v3 offset:256
    ds_read_b64_tr_b16 v[100:101], v4 offset:0
    ds_read_b64_tr_b16 v[102:103], v4 offset:256
    ds_read_b64_tr_b16 v[104:105], v3 offset:2048
    ds_read_b64_tr_b16 v[106:107], v3 offset:2304
    ds_read_b64_tr_b16 v[108:109], v4 offset:2048
    ds_read_b64_tr_b16 v[110:111], v4 offset:2304
    s_waitcnt lgkmcnt(0)
    s_add_u32 m0, s21, 0
    s_add_u32 s64, s20, 0x480000
    buffer_load_dwordx4 v5, s[44:47], s64 offen lds
    s_add_u32 m0, s21, 1024
    s_add_u32 s64, s20, 0x4a0000
    buffer_load_dwordx4 v5, s[44:47], s64 offen lds
    s_add_u32 m0, s21, 2048
    s_add_u32 s64, s20, 0x4c0000
    buffer_load_dwordx4 v5, s[44:47], s64 offen lds
    s_add_u32 m0, s21, 3072
    s_add_u32 s64, s20, 0x4e0000
    buffer_load_dwordx4 v5, s[44:47], s64 offen lds
    s_waitcnt vmcnt(32)
    ds_read_b64_tr_b16 v[112:113], v3 offset:4096
    ds_read_b64_tr_b16 v[114:115], v3 offset:4352
    ds_read_b64_tr_b16 v[116:117], v4 offset:4096
    ds_read_b64_tr_b16 v[118:119], v4 offset:4352
    ds_read_b64_tr_b16 v[120:121], v3 offset:6144
    ds_read_b64_tr_b16 v[122:123], v3 offset:6400
    ds_read_b64_tr_b16 v[124:125], v4 offset:6144
    ds_read_b64_tr_b16 v[126:127], v4 offset:6400
    s_waitcnt lgkmcnt(0)
    s_waitcnt vmcnt(28)
    ds_read_b64_tr_b16 v[128:129], v3 offset:8192
    ds_read_b64_tr_b16 v[130:131], v3 offset:8448
    ds_read_b64_tr_b16 v[132:133], v4 offset:8192
    ds_read_b64_tr_b16 v[134:135], v4 offset:8448
    ds_read_b64_tr_b16 v[136:137], v3 offset:10240
    ds_read_b64_tr_b16 v[138:139], v3 offset:10496
    ds_read_b64_tr_b16 v[140:141], v4 offset:10240
    ds_read_b64_tr_b16 v[142:143], v4 offset:10496
    s_waitcnt lgkmcnt(0)
    s_waitcnt vmcnt(24)
    ds_read_b64_tr_b16 v[144:145], v3 offset:12288
    ds_read_b64_tr_b16 v[146:147], v3 offset:12544
    ds_read_b64_tr_b16 v[148:149], v4 offset:12288
    ds_read_b64_tr_b16 v[150:151], v4 offset:12544
    ds_read_b64_tr_b16 v[152:153], v3 offset:14336
    ds_read_b64_tr_b16 v[154:155], v3 offset:14592
    ds_read_b64_tr_b16 v[156:157], v4 offset:14336
    ds_read_b64_tr_b16 v[158:159], v4 offset:14592
    s_waitcnt lgkmcnt(0)
    s_waitcnt vmcnt(20)
    ds_read_b64_tr_b16 v[160:161], v3 offset:16384
    ds_read_b64_tr_b16 v[162:163], v3 offset:16640
    ds_read_b64_tr_b16 v[164:165], v4 offset:16384
    ds_read_b64_tr_b16 v[166:167], v4 offset:16640
    ds_read_b64_tr_b16 v[168:169], v3 offset:18432
    ds_read_b64_tr_b16 v[170:171], v3 offset:18688
    ds_read_b64_tr_b16 v[172:173], v4 offset:18432
    ds_read_b64_tr_b16 v[174:175], v4 offset:18688
    s_waitcnt lgkmcnt(0)
    s_waitcnt vmcnt(16)
    ds_read_b64_tr_b16 v[176:177], v3 offset:20480
    ds_read_b64_tr_b16 v[178:179], v3 offset:20736
    ds_read_b64_tr_b16 v[180:181], v4 offset:20480
    ds_read_b64_tr_b16 v[182:183], v4 offset:20736
    ds_read_b64_tr_b16 v[184:185], v3 offset:22528
    ds_read_b64_tr_b16 v[186:187], v3 offset:22784
    ds_read_b64_tr_b16 v[188:189], v4 offset:22528
    ds_read_b64_tr_b16 v[190:191], v4 offset:22784
    s_waitcnt lgkmcnt(0)
    s_waitcnt vmcnt(12)
    ds_read_b64_tr_b16 v[192:193], v3 offset:24576
    ds_read_b64_tr_b16 v[194:195], v3 offset:24832
    ds_read_b64_tr_b16 v[196:197], v4 offset:24576
    ds_read_b64_tr_b16 v[198:199], v4 offset:24832
    ds_read_b64_tr_b16 v[200:201], v3 offset:26624
    ds_read_b64_tr_b16 v[202:203], v3 offset:26880
    ds_read_b64_tr_b16 v[204:205], v4 offset:26624
    ds_read_b64_tr_b16 v[206:207], v4 offset:26880
    s_waitcnt lgkmcnt(0)
    s_waitcnt vmcnt(8)
    ds_read_b64_tr_b16 v[208:209], v3 offset:28672
    ds_read_b64_tr_b16 v[210:211], v3 offset:28928
    ds_read_b64_tr_b16 v[212:213], v4 offset:28672
    ds_read_b64_tr_b16 v[214:215], v4 offset:28928
    ds_read_b64_tr_b16 v[216:217], v3 offset:30720
    ds_read_b64_tr_b16 v[218:219], v3 offset:30976
    ds_read_b64_tr_b16 v[220:221], v4 offset:30720
    ds_read_b64_tr_b16 v[222:223], v4 offset:30976
    s_waitcnt lgkmcnt(0)
    s_waitcnt vmcnt(4)
    ds_read_b64_tr_b16 v[224:225], v3 offset:32768
    ds_read_b64_tr_b16 v[226:227], v3 offset:33024
    ds_read_b64_tr_b16 v[228:229], v4 offset:32768
    ds_read_b64_tr_b16 v[230:231], v4 offset:33024
    ds_read_b64_tr_b16 v[232:233], v3 offset:34816
    ds_read_b64_tr_b16 v[234:235], v3 offset:35072
    ds_read_b64_tr_b16 v[236:237], v4 offset:34816
    ds_read_b64_tr_b16 v[238:239], v4 offset:35072
    s_waitcnt lgkmcnt(0)
    s_waitcnt vmcnt(0)
    ds_read_b64_tr_b16 v[240:241], v3 offset:0
    ds_read_b64_tr_b16 v[242:243], v3 offset:256
    ds_read_b64_tr_b16 v[244:245], v4 offset:0
    ds_read_b64_tr_b16 v[246:247], v4 offset:256
    ds_read_b64_tr_b16 v[248:249], v3 offset:2048
    ds_read_b64_tr_b16 v[250:251], v3 offset:2304
    ds_read_b64_tr_b16 v[252:253], v4 offset:2048
    ds_read_b64_tr_b16 v[254:255], v4 offset:2304
    s_waitcnt lgkmcnt(0)
    s_cmp_lg_u32 s97, 0
    s_cbranch_scc1 CM_117
    v_mbcnt_lo_u32_b32 v0, -1, 0
    v_mbcnt_hi_u32_b32 v0, -1, v0
    v_mul_u32_u24 v8, 32, v0
    s_mov_b32 s64, 0x0
    s_mov_b32 s65, 0
    s_mov_b64 exec, 0xff
TK_118:
    buffer_load_dword v9, v8, s[60:63], s64 offen sc1
    s_add_u32 s65, s65, 1
    s_waitcnt vmcnt(0)
    s_mov_b32 s66, 0
    v_readlane_b32 s67, v9, 0
    s_add_u32 s66, s66, s67
    v_readlane_b32 s67, v9, 1
    s_add_u32 s66, s66, s67
    v_readlane_b32 s67, v9, 2
    s_add_u32 s66, s66, s67
    v_readlane_b32 s67, v9, 3
    s_add_u32 s66, s66, s67
    v_readlane_b32 s67, v9, 4
    s_add_u32 s66, s66, s67
    v_readlane_b32 s67, v9, 5
    s_add_u32 s66, s66, s67
    v_readlane_b32 s67, v9, 6
    s_add_u32 s66, s66, s67
    v_readlane_b32 s67, v9, 7
    s_add_u32 s66, s66, s67
    s_cmp_ge_u32 s66, 256
    s_cbranch_scc1 TKD_119
    s_cmp_gt_u32 s65, 262144
    s_cbranch_scc0 TK_118
TKD_119:
    v_cmp_ne_u32 vcc, 32, v9
    s_mov_b64 exec, -1
    s_cbranch_vccnz M_SLOW
CM_117:
    s_mov_b32 s65, 0
GI_120:
    buffer_load_dword v8, off, s[60:63], s95 sc1
    s_add_u32 s65, s65, 1
    s_waitcnt vmcnt(0)
    v_readfirstlane_b32 s64, v8
    s_cmp_ge_u32 s64, 192
    s_cbranch_scc1 GID_121
    s_cmp_gt_u32 s65, 65536
    s_cbranch_scc1 GID_121
    s_sleep 4
    s_branch GI_120
GID_121:
    v_mbcnt_lo_u32_b32 v0, -1, 0
    v_mbcnt_hi_u32_b32 v0, -1, v0
    v_lshlrev_b32 v1, 4, v0
    v_lshrrev_b32 v6, 3, v0
    v_mul_u32_u24 v2, 1280, v6
    v_and_b32 v7, 7, v0
    v_xor_b32 v7, v7, v6
    v_lshl_add_u32 v2, v7, 4, v2
    v_bfe_u32 v6, v0, 3, 1
    v_lshlrev_b32 v9, 10, v6
    v_and_b32 v6, 7, v0
    v_lshl_add_u32 v9, v6, 7, v9
    v_lshrrev_b32 v7, 4, v0
    v_xor_b32 v7, v7, v6
    v_lshl_add_u32 v3, v7, 4, v9
    v_xor_b32 v7, 4, v7
    v_lshl_add_u32 v4, v7, 4, v9
    v_add_u32 v6, 0x10000, v3
    v_add_u32 v9, 0x10000, v4
    s_barrier
    s_mul_i32 s20, s12, 163840
    s_mul_i32 s64, s14, 40960
    s_add_u32 s20, s20, s64
    s_add_u32 s20, s20, 0x0
    s_lshl_b32 s21, s14, 12
    s_add_u32 m0, s21, 0
    s_add_u32 s64, s20, 0x0
    buffer_load_dwordx4 v2, s[4:7], s64 offen lds
    s_add_u32 m0, s21, 1024
    s_add_u32 s64, s20, 0x2800
    buffer_load_dwordx4 v2, s[4:7], s64 offen lds
    s_add_u32 m0, s21, 2048
    s_add_u32 s64, s20, 0x5000
    buffer_load_dwordx4 v2, s[4:7], s64 offen lds
    s_add_u32 m0, s21, 3072
    s_add_u32 s64, s20, 0x7800
    buffer_load_dwordx4 v2, s[4:7], s64 offen lds
    s_add_u32 m0, s21, 16384
    s_add_u32 s64, s20, 0x80
    buffer_load_dwordx4 v2, s[4:7], s64 offen lds
    s_add_u32 m0, s21, 17408
    s_add_u32 s64, s20, 0x2880
    buffer_load_dwordx4 v2, s[4:7], s64 offen lds
    s_add_u32 m0, s21, 18432
    s_add_u32 s64, s20, 0x5080
    buffer_load_dwordx4 v2, s[4:7], s64 offen lds
    s_add_u32 m0, s21, 19456
    s_add_u32 s64, s20, 0x7880
    buffer_load_dwordx4 v2, s[4:7], s64 offen lds
    s_add_u32 m0, s21, 32768
    s_add_u32 s64, s20, 0x100
    buffer_load_dwordx4 v2, s[4:7], s64 offen lds
    s_add_u32 m0, s21, 33792
    s_add_u32 s64, s20, 0x2900
    buffer_load_dwordx4 v2, s[4:7], s64 offen lds
    s_add_u32 m0, s21, 34816
    s_add_u32 s64, s20, 0x5100
    buffer_load_dwordx4 v2, s[4:7], s64 offen lds
    s_add_u32 m0, s21, 35840
    s_add_u32 s64, s20, 0x7900
    buffer_load_dwordx4 v2, s[4:7], s64 offen lds
    s_add_u32 m0, s21, 49152
    s_add_u32 s64, s20, 0x180
    buffer_load_dwordx4 v2, s[4:7], s64 offen lds
    s_add_u32 m0, s21, 50176
    s_add_u32 s64, s20, 0x2980
    buffer_load_dwordx4 v2, s[4:7], s64 offen lds
    s_add_u32 m0, s21, 51200
    s_add_u32 s64, s20, 0x5180
    buffer_load_dwordx4 v2, s[4:7], s64 offen lds
    s_add_u32 m0, s21, 52224
    s_add_u32 s64, s20, 0x7980
    buffer_load_dwordx4 v2, s[4:7], s64 offen lds
    s_mov_b32 s64, 0x40000000
    buffer_store_dword v7, v1, s[4:7], s64 offen
    buffer_store_dword v7, v1, s[4:7], s64 offen
    buffer_store_dword v7, v1, s[4:7], s64 offen
    buffer_store_dword v7, v1, s[4:7], s64 offen
    buffer_store_dword v7, v1, s[4:7], s64 offen
    buffer_store_dword v7, v1, s[4:7], s64 offen
    buffer_store_dword v7, v1, s[4:7], s64 offen
    buffer_store_dword v7, v1, s[4:7], s64 offen
    s_waitcnt vmcnt(20)
    s_barrier
    ds_read_b128 a[0:3], v3 offset:0
    ds_read_b128 a[4:7], v3 offset:2048
    ds_read_b128 a[8:11], v3 offset:4096
    ds_read_b128 a[12:15], v3 offset:6144
    ds_read_b128 a[16:19], v3 offset:8192
    ds_read_b128 a[20:23], v3 offset:10240
    ds_read_b128 a[24:27], v3 offset:12288
    ds_read_b128 a[28:31], v3 offset:14336
    s_mov_b32 s19, 0
    s_mov_b32 s22, s16
    s_mov_b32 s23, 0x40000000
G_N_LOOP:
    s_waitcnt lgkmcnt(4)
    v_mfma_f32_16x16x32_bf16 v[16:19], a[0:3], v[96:99], 0
    v_mfma_f32_16x16x32_bf16 v[20:23], a[0:3], v[100:103], 0
    ds_read_b128 a[32:35], v4 offset:0
    v_mfma_f32_16x16x32_bf16 v[24:27], a[4:7], v[96:99], 0
    v_mfma_f32_16x16x32_bf16 v[28:31], a[4:7], v[100:103], 0
    ds_read_b128 a[36:39], v4 offset:2048
    v_mfma_f32_16x16x32_bf16 v[32:35], a[8:11], v[96:99], 0
    v_mfma_f32_16x16x32_bf16 v[36:39], a[8:11], v[100:103], 0
    ds_read_b128 a[40:43], v4 offset:4096
    v_mfma_f32_16x16x32_bf16 v[40:43], a[12:15], v[96:99], 0
    v_mfma_f32_16x16x32_bf16 v[44:47], a[12:15], v[100:103], 0
    ds_read_b128 a[44:47], v4 offset:6144
    s_waitcnt lgkmcnt(4)
    v_mfma_f32_16x16x32_bf16 v[48:51], a[16:19], v[96:99], 0
    v_mfma_f32_16x16x32_bf16 v[52:55], a[16:19], v[100:103], 0
    ds_read_b128 a[48:51], v4 offset:8192
    v_mfma_f32_16x16x32_bf16 v[56:59], a[20:23], v[96:99], 0
    v_mfma_f32_16x16x32_bf16 v[60:63], a[20:23], v[100:103], 0
    ds_read_b128 a[52:55], v4 offset:10240
    v_mfma_f32_16x16x32_bf16 v[64:67], a[24:27], v[96:99], 0
    v_mfma_f32_16x16x32_bf16 v[68:71], a[24:27], v[100:103], 0
    ds_read_b128 a[56:59], v4 offset:12288
    v_mfma_f32_16x16x32_bf16 v[72:75], a[28:31], v[96:99], 0
    v_mfma_f32_16x16x32_bf16 v[76:79], a[28:31], v[100:103], 0
    ds_read_b128 a[60:63], v4 offset:14336
    s_waitcnt vmcnt(16)
    s_barrier
    s_waitcnt lgkmcnt(4)
    v_mfma_f32_16x16x32_bf16 v[16:19], a[32:35], v[104:107], v[16:19]
    v_mfma_f32_16x16x32_bf16 v[20:23], a[32:35], v[108:111], v[20:23]
    ds_read_b128 a[0:3], v3 offset:16384
    s_add_u32 m0, s21, 65536
    v_mfma_f32_16x16x32_bf16 v[24:27], a[36:39], v[104:107], v[24:27]
    v_mfma_f32_16x16x32_bf16 v[28:31], a[36:39], v[108:111], v[28:31]
    ds_read_b128 a[4:7], v3 offset:18432
    s_add_u32 s64, s20, 0x200
    buffer_load_dwordx4 v2, s[4:7], s64 offen lds
    v_mfma_f32_16x16x32_bf16 v[32:35], a[40:43], v[104:107], v[32:35]
    v_mfma_f32_16x16x32_bf16 v[36:39], a[40:43], v[108:111], v[36:39]
    ds_read_b128 a[8:11], v3 offset:20480
    s_add_u32 m0, s21, 66560
    v_mfma_f32_16x16x32_bf16 v[40:43], a[44:47], v[104:107], v[40:43]
    v_mfma_f32_16x16x32_bf16 v[44:47], a[44:47], v[108:111], v[44:47]
    ds_read_b128 a[12:15], v3 offset:22528
    s_add_u32 s64, s20, 0x2a00
    buffer_load_dwordx4 v2, s[4:7], s64 offen lds
    s_waitcnt lgkmcnt(4)
    v_mfma_f32_16x16x32_bf16 v[48:51], a[48:51], v[104:107], v[48:51]
    v_mfma_f32_16x16x32_bf16 v[52:55], a[48:51], v[108:111], v[52:55]
    ds_read_b128 a[16:19], v3 offset:24576
    s_add_u32 m0, s21, 67584
    v_mfma_f32_16x16x32_bf16 v[56:59], a[52:55], v[104:107], v[56:59]
    v_mfma_f32_16x16x32_bf16 v[60:63], a[52:55], v[108:111], v[60:63]
    ds_read_b128 a[20:23], v3 offset:26624
    s_add_u32 s64, s20, 0x5200
    buffer_load_dwordx4 v2, s[4:7], s64 offen lds
    v_mfma_f32_16x16x32_bf16 v[64:67], a[56:59], v[104:107], v[64:67]
    v_mfma_f32_16x16x32_bf16 v[68:71], a[56:59], v[108:111], v[68:71]
    ds_read_b128 a[24:27], v3 offset:28672
    s_add_u32 m0, s21, 68608
    v_mfma_f32_16x16x32_bf16 v[72:75], a[60:63], v[104:107], v[72:75]
    v_mfma_f32_16x16x32_bf16 v[76:79], a[60:63], v[108:111], v[76:79]
    ds_read_b128 a[28:31], v3 offset:30720
    s_add_u32 s64, s20, 0x7a00
    buffer_load_dwordx4 v2, s[4:7], s64 offen lds
    s_waitcnt lgkmcnt(4)
    v_mfma_f32_16x16x32_bf16 v[16:19], a[0:3], v[112:115], v[16:19]
    v_mfma_f32_16x16x32_bf16 v[20:23], a[0:3], v[116:119], v[20:23]
    ds_read_b128 a[32:35], v4 offset:16384
    v_mfma_f32_16x16x32_bf16 v[24:27], a[4:7], v[112:115], v[24:27]
    v_mfma_f32_16x16x32_bf16 v[28:31], a[4:7], v[116:119], v[28:31]
    ds_read_b128 a[36:39], v4 offset:18432
    v_mfma_f32_16x16x32_bf16 v[32:35], a[8:11], v[112:115], v[32:35]
    v_mfma_f32_16x16x32_bf16 v[36:39], a[8:11], v[116:119], v[36:39]
    ds_read_b128 a[40:43], v4 offset:20480
    v_mfma_f32_16x16x32_bf16 v[40:43], a[12:15], v[112:115], v[40:43]
    v_mfma_f32_16x16x32_bf16 v[44:47], a[12:15], v[116:119], v[44:47]
    ds_read_b128 a[44:47], v4 offset:22528
    s_waitcnt lgkmcnt(4)
    v_mfma_f32_16x16x32_bf16 v[48:51], a[16:19], v[112:115], v[48:51]
    v_mfma_f32_16x16x32_bf16 v[52:55], a[16:19], v[116:119], v[52:55]
    ds_read_b128 a[48:51], v4 offset:24576
    v_mfma_f32_16x16x32_bf16 v[56:59], a[20:23], v[112:115], v[56:59]
    v_mfma_f32_16x16x32_bf16 v[60:63], a[20:23], v[116:119], v[60:63]
    ds_read_b128 a[52:55], v4 offset:26624
    v_mfma_f32_16x16x32_bf16 v[64:67], a[24:27], v[112:115], v[64:67]
    v_mfma_f32_16x16x32_bf16 v[68:71], a[24:27], v[116:119], v[68:71]
    ds_read_b128 a[56:59], v4 offset:28672
    v_mfma_f32_16x16x32_bf16 v[72:75], a[28:31], v[112:115], v[72:75]
    v_mfma_f32_16x16x32_bf16 v[76:79], a[28:31], v[116:119], v[76:79]
    ds_read_b128 a[60:63], v4 offset:30720
    s_waitcnt vmcnt(16)
    s_barrier
    s_waitcnt lgkmcnt(4)
    v_mfma_f32_16x16x32_bf16 v[16:19], a[32:35], v[120:123], v[16:19]
    v_mfma_f32_16x16x32_bf16 v[20:23], a[32:35], v[124:127], v[20:23]
    ds_read_b128 a[0:3], v3 offset:32768
    s_add_u32 m0, s21, 0
    v_mfma_f32_16x16x32_bf16 v[24:27], a[36:39], v[120:123], v[24:27]
    v_mfma_f32_16x16x32_bf16 v[28:31], a[36:39], v[124:127], v[28:31]
    ds_read_b128 a[4:7], v3 offset:34816
    s_add_u32 s64, s20, 0x280
    buffer_load_dwordx4 v2, s[4:7], s64 offen lds
    v_mfma_f32_16x16x32_bf16 v[32:35], a[40:43], v[120:123], v[32:35]
    v_mfma_f32_16x16x32_bf16 v[36:39], a[40:43], v[124:127], v[36:39]
    ds_read_b128 a[8:11], v3 offset:36864
    s_add_u32 m0, s21, 1024
    v_mfma_f32_16x16x32_bf16 v[40:43], a[44:47], v[120:123], v[40:43]
    v_mfma_f32_16x16x32_bf16 v[44:47], a[44:47], v[124:127], v[44:47]
    ds_read_b128 a[12:15], v3 offset:38912
    s_add_u32 s64, s20, 0x2a80
    buffer_load_dwordx4 v2, s[4:7], s64 offen lds
    s_waitcnt lgkmcnt(4)
    v_mfma_f32_16x16x32_bf16 v[48:51], a[48:51], v[120:123], v[48:51]
    v_mfma_f32_16x16x32_bf16 v[52:55], a[48:51], v[124:127], v[52:55]
    ds_read_b128 a[16:19], v3 offset:40960
    s_add_u32 m0, s21, 2048
    v_mfma_f32_16x16x32_bf16 v[56:59], a[52:55], v[120:123], v[56:59]
    v_mfma_f32_16x16x32_bf16 v[60:63], a[52:55], v[124:127], v[60:63]
    ds_read_b128 a[20:23], v3 offset:43008
    s_add_u32 s64, s20, 0x5280
    buffer_load_dwordx4 v2, s[4:7], s64 offen lds
    v_mfma_f32_16x16x32_bf16 v[64:67], a[56:59], v[120:123], v[64:67]
    v_mfma_f32_16x16x32_bf16 v[68:71], a[56:59], v[124:127], v[68:71]
    ds_read_b128 a[24:27], v3 offset:45056
    s_add_u32 m0, s21, 3072
    v_mfma_f32_16x16x32_bf16 v[72:75], a[60:63], v[120:123], v[72:75]
    v_mfma_f32_16x16x32_bf16 v[76:79], a[60:63], v[124:127], v[76:79]
    ds_read_b128 a[28:31], v3 offset:47104
    s_add_u32 s64, s20, 0x7a80
    buffer_load_dwordx4 v2, s[4:7], s64 offen lds
    s_waitcnt lgkmcnt(4)
    v_mfma_f32_16x16x32_bf16 v[16:19], a[0:3], v[128:131], v[16:19]
    v_mfma_f32_16x16x32_bf16 v[20:23], a[0:3], v[132:135], v[20:23]
    ds_read_b128 a[32:35], v4 offset:32768
    v_mfma_f32_16x16x32_bf16 v[24:27], a[4:7], v[128:131], v[24:27]
    v_mfma_f32_16x16x32_bf16 v[28:31], a[4:7], v[132:135], v[28:31]
    ds_read_b128 a[36:39], v4 offset:34816
    v_mfma_f32_16x16x32_bf16 v[32:35], a[8:11], v[128:131], v[32:35]
    v_mfma_f32_16x16x32_bf16 v[36:39], a[8:11], v[132:135], v[36:39]
    ds_read_b128 a[40:43], v4 offset:36864
    v_mfma_f32_16x16x32_bf16 v[40:43], a[12:15], v[128:131], v[40:43]
    v_mfma_f32_16x16x32_bf16 v[44:47], a[12:15], v[132:135], v[44:47]
    ds_read_b128 a[44:47], v4 offset:38912
    s_waitcnt lgkmcnt(4)
    v_mfma_f32_16x16x32_bf16 v[48:51], a[16:19], v[128:131], v[48:51]
    v_mfma_f32_16x16x32_bf16 v[52:55], a[16:19], v[132:135], v[52:55]
    ds_read_b128 a[48:51], v4 offset:40960
    v_mfma_f32_16x16x32_bf16 v[56:59], a[20:23], v[128:131], v[56:59]
    v_mfma_f32_16x16x32_bf16 v[60:63], a[20:23], v[132:135], v[60:63]
    ds_read_b128 a[52:55], v4 offset:43008
    v_mfma_f32_16x16x32_bf16 v[64:67], a[24:27], v[128:131], v[64:67]
    v_mfma_f32_16x16x32_bf16 v[68:71], a[24:27], v[132:135], v[68:71]
    ds_read_b128 a[56:59], v4 offset:45056
    v_mfma_f32_16x16x32_bf16 v[72:75], a[28:31], v[128:131], v[72:75]
    v_mfma_f32_16x16x32_bf16 v[76:79], a[28:31], v[132:135], v[76:79]
    ds_read_b128 a[60:63], v4 offset:47104
    s_waitcnt vmcnt(16)
    s_barrier
    s_waitcnt lgkmcnt(4)
    v_mfma_f32_16x16x32_bf16 v[16:19], a[32:35], v[136:139], v[16:19]
    v_mfma_f32_16x16x32_bf16 v[20:23], a[32:35], v[140:143], v[20:23]
    ds_read_b128 a[0:3], v3 offset:49152
    s_add_u32 m0, s21, 16384
    v_mfma_f32_16x16x32_bf16 v[24:27], a[36:39], v[136:139], v[24:27]
    v_mfma_f32_16x16x32_bf16 v[28:31], a[36:39], v[140:143], v[28:31]
    ds_read_b128 a[4:7], v3 offset:51200
    s_add_u32 s64, s20, 0x300
    buffer_load_dwordx4 v2, s[4:7], s64 offen lds
    v_mfma_f32_16x16x32_bf16 v[32:35], a[40:43], v[136:139], v[32:35]
    v_mfma_f32_16x16x32_bf16 v[36:39], a[40:43], v[140:143], v[36:39]
    ds_read_b128 a[8:11], v3 offset:53248
    s_add_u32 m0, s21, 17408
    v_mfma_f32_16x16x32_bf16 v[40:43], a[44:47], v[136:139], v[40:43]
    v_mfma_f32_16x16x32_bf16 v[44:47], a[44:47], v[140:143], v[44:47]
    ds_read_b128 a[12:15], v3 offset:55296
    s_add_u32 s64, s20, 0x2b00
    buffer_load_dwordx4 v2, s[4:7], s64 offen lds
    s_waitcnt lgkmcnt(4)
    v_mfma_f32_16x16x32_bf16 v[48:51], a[48:51], v[136:139], v[48:51]
    v_mfma_f32_16x16x32_bf16 v[52:55], a[48:51], v[140:143], v[52:55]
    ds_read_b128 a[16:19], v3 offset:57344
    s_add_u32 m0, s21, 18432
    v_mfma_f32_16x16x32_bf16 v[56:59], a[52:55], v[136:139], v[56:59]
    v_mfma_f32_16x16x32_bf16 v[60:63], a[52:55], v[140:143], v[60:63]
    ds_read_b128 a[20:23], v3 offset:59392
    s_add_u32 s64, s20, 0x5300
    buffer_load_dwordx4 v2, s[4:7], s64 offen lds
    v_mfma_f32_16x16x32_bf16 v[64:67], a[56:59], v[136:139], v[64:67]
    v_mfma_f32_16x16x32_bf16 v[68:71], a[56:59], v[140:143], v[68:71]
    ds_read_b128 a[24:27], v3 offset:61440
    s_add_u32 m0, s21, 19456
    v_mfma_f32_16x16x32_bf16 v[72:75], a[60:63], v[136:139], v[72:75]
    v_mfma_f32_16x16x32_bf16 v[76:79], a[60:63], v[140:143], v[76:79]
    ds_read_b128 a[28:31], v3 offset:63488
    s_add_u32 s64, s20, 0x7b00
    buffer_load_dwordx4 v2, s[4:7], s64 offen lds
    s_waitcnt lgkmcnt(4)
    v_mfma_f32_16x16x32_bf16 v[16:19], a[0:3], v[144:147], v[16:19]
    v_mfma_f32_16x16x32_bf16 v[20:23], a[0:3], v[148:151], v[20:23]
    ds_read_b128 a[32:35], v4 offset:49152
    v_mfma_f32_16x16x32_bf16 v[24:27], a[4:7], v[144:147], v[24:27]
    v_mfma_f32_16x16x32_bf16 v[28:31], a[4:7], v[148:151], v[28:31]
    ds_read_b128 a[36:39], v4 offset:51200
    v_mfma_f32_16x16x32_bf16 v[32:35], a[8:11], v[144:147], v[32:35]
    v_mfma_f32_16x16x32_bf16 v[36:39], a[8:11], v[148:151], v[36:39]
    ds_read_b128 a[40:43], v4 offset:53248
    v_mfma_f32_16x16x32_bf16 v[40:43], a[12:15], v[144:147], v[40:43]
    v_mfma_f32_16x16x32_bf16 v[44:47], a[12:15], v[148:151], v[44:47]
    ds_read_b128 a[44:47], v4 offset:55296
    s_waitcnt lgkmcnt(4)
    v_mfma_f32_16x16x32_bf16 v[48:51], a[16:19], v[144:147], v[48:51]
    v_mfma_f32_16x16x32_bf16 v[52:55], a[16:19], v[148:151], v[52:55]
    ds_read_b128 a[48:51], v4 offset:57344
    v_mfma_f32_16x16x32_bf16 v[56:59], a[20:23], v[144:147], v[56:59]
    v_mfma_f32_16x16x32_bf16 v[60:63], a[20:23], v[148:151], v[60:63]
    ds_read_b128 a[52:55], v4 offset:59392
    v_mfma_f32_16x16x32_bf16 v[64:67], a[24:27], v[144:147], v[64:67]
    v_mfma_f32_16x16x32_bf16 v[68:71], a[24:27], v[148:151], v[68:71]
    ds_read_b128 a[56:59], v4 offset:61440
    v_mfma_f32_16x16x32_bf16 v[72:75], a[28:31], v[144:147], v[72:75]
    v_mfma_f32_16x16x32_bf16 v[76:79], a[28:31], v[148:151], v[76:79]
    ds_read_b128 a[60:63], v4 offset:63488
    s_waitcnt vmcnt(8)
    s_barrier
    s_cmp_lg_u32 s14, 0
    s_cbranch_scc1 GF_122
    v_mov_b32 v7, 1
    v_mov_b32 v8, 0
    s_mov_b64 exec, 1
    buffer_store_dword v7, v8, s[4:7], s23 offen sc1
    s_mov_b64 exec, -1
GF_122:
    s_waitcnt lgkmcnt(4)
    v_mfma_f32_16x16x32_bf16 v[16:19], a[32:35], v[152:155], v[16:19]
    v_mfma_f32_16x16x32_bf16 v[20:23], a[32:35], v[156:159], v[20:23]
    ds_read_b128 a[0:3], v6 offset:0
    s_add_u32 m0, s21, 32768
    v_mfma_f32_16x16x32_bf16 v[24:27], a[36:39], v[152:155], v[24:27]
    v_mfma_f32_16x16x32_bf16 v[28:31], a[36:39], v[156:159], v[28:31]
    ds_read_b128 a[4:7], v6 offset:2048
    s_add_u32 s64, s20, 0x380
    buffer_load_dwordx4 v2, s[4:7], s64 offen lds
    v_mfma_f32_16x16x32_bf16 v[32:35], a[40:43], v[152:155], v[32:35]
    v_mfma_f32_16x16x32_bf16 v[36:39], a[40:43], v[156:159], v[36:39]
    ds_read_b128 a[8:11], v6 offset:4096
    s_add_u32 m0, s21, 33792
    v_mfma_f32_16x16x32_bf16 v[40:43], a[44:47], v[152:155], v[40:43]
    v_mfma_f32_16x16x32_bf16 v[44:47], a[44:47], v[156:159], v[44:47]
    ds_read_b128 a[12:15], v6 offset:6144
    s_add_u32 s64, s20, 0x2b80
    buffer_load_dwordx4 v2, s[4:7], s64 offen lds
    s_waitcnt lgkmcnt(4)
    v_mfma_f32_16x16x32_bf16 v[48:51], a[48:51], v[152:155], v[48:51]
    v_mfma_f32_16x16x32_bf16 v[52:55], a[48:51], v[156:159], v[52:55]
    ds_read_b128 a[16:19], v6 offset:8192
    s_add_u32 m0, s21, 34816
    v_mfma_f32_16x16x32_bf16 v[56:59], a[52:55], v[152:155], v[56:59]
    v_mfma_f32_16x16x32_bf16 v[60:63], a[52:55], v[156:159], v[60:63]
    ds_read_b128 a[20:23], v6 offset:10240
    s_add_u32 s64, s20, 0x5380
    buffer_load_dwordx4 v2, s[4:7], s64 offen lds
    v_mfma_f32_16x16x32_bf16 v[64:67], a[56:59], v[152:155], v[64:67]
    v_mfma_f32_16x16x32_bf16 v[68:71], a[56:59], v[156:159], v[68:71]
    ds_read_b128 a[24:27], v6 offset:12288
    s_add_u32 m0, s21, 35840
    v_mfma_f32_16x16x32_bf16 v[72:75], a[60:63], v[152:155], v[72:75]
    v_mfma_f32_16x16x32_bf16 v[76:79], a[60:63], v[156:159], v[76:79]
    ds_read_b128 a[28:31], v6 offset:14336
    s_add_u32 s64, s20, 0x7b80
    buffer_load_dwordx4 v2, s[4:7], s64 offen lds
    s_waitcnt lgkmcnt(4)
    v_mfma_f32_16x16x32_bf16 v[16:19], a[0:3], v[160:163], v[16:19]
    v_mfma_f32_16x16x32_bf16 v[20:23], a[0:3], v[164:167], v[20:23]
    ds_read_b128 a[32:35], v9 offset:0
    v_mfma_f32_16x16x32_bf16 v[24:27], a[4:7], v[160:163], v[24:27]
    v_mfma_f32_16x16x32_bf16 v[28:31], a[4:7], v[164:167], v[28:31]
    ds_read_b128 a[36:39], v9 offset:2048
    v_mfma_f32_16x16x32_bf16 v[32:35], a[8:11], v[160:163], v[32:35]
    v_mfma_f32_16x16x32_bf16 v[36:39], a[8:11], v[164:167], v[36:39]
    ds_read_b128 a[40:43], v9 offset:4096
    v_mfma_f32_16x16x32_bf16 v[40:43], a[12:15], v[160:163], v[40:43]
    v_mfma_f32_16x16x32_bf16 v[44:47], a[12:15], v[164:167], v[44:47]
    ds_read_b128 a[44:47], v9 offset:6144
    s_waitcnt lgkmcnt(4)
    v_mfma_f32_16x16x32_bf16 v[48:51], a[16:19], v[160:163], v[48:51]
    v_mfma_f32_16x16x32_bf16 v[52:55], a[16:19], v[164:167], v[52:55]
    ds_read_b128 a[48:51], v9 offset:8192
    v_mfma_f32_16x16x32_bf16 v[56:59], a[20:23], v[160:163], v[56:59]
    v_mfma_f32_16x16x32_bf16 v[60:63], a[20:23], v[164:167], v[60:63]
    ds_read_b128 a[52:55], v9 offset:10240
    v_mfma_f32_16x16x32_bf16 v[64:67], a[24:27], v[160:163], v[64:67]
    v_mfma_f32_16x16x32_bf16 v[68:71], a[24:27], v[164:167], v[68:71]
    ds_read_b128 a[56:59], v9 offset:12288
    v_mfma_f32_16x16x32_bf16 v[72:75], a[28:31], v[160:163], v[72:75]
    v_mfma_f32_16x16x32_bf16 v[76:79], a[28:31], v[164:167], v[76:79]
    ds_read_b128 a[60:63], v9 offset:14336
    s_waitcnt vmcnt(8)
    s_barrier
    s_waitcnt lgkmcnt(4)
    v_mfma_f32_16x16x32_bf16 v[16:19], a[32:35], v[168:171], v[16:19]
    v_mfma_f32_16x16x32_bf16 v[20:23], a[32:35], v[172:175], v[20:23]
    ds_read_b128 a[0:3], v3 offset:0
    s_add_u32 m0, s21, 49152
    v_mfma_f32_16x16x32_bf16 v[24:27], a[36:39], v[168:171], v[24:27]
    v_mfma_f32_16x16x32_bf16 v[28:31], a[36:39], v[172:175], v[28:31]
    ds_read_b128 a[4:7], v3 offset:2048
    s_add_u32 s64, s20, 0x400
    buffer_load_dwordx4 v2, s[4:7], s64 offen lds
    v_mfma_f32_16x16x32_bf16 v[32:35], a[40:43], v[168:171], v[32:35]
    v_mfma_f32_16x16x32_bf16 v[36:39], a[40:43], v[172:175], v[36:39]
    ds_read_b128 a[8:11], v3 offset:4096
    s_add_u32 m0, s21, 50176
    v_mfma_f32_16x16x32_bf16 v[40:43], a[44:47], v[168:171], v[40:43]
    v_mfma_f32_16x16x32_bf16 v[44:47], a[44:47], v[172:175], v[44:47]
    ds_read_b128 a[12:15], v3 offset:6144
    s_add_u32 s64, s20, 0x2c00
    buffer_load_dwordx4 v2, s[4:7], s64 offen lds
    s_waitcnt lgkmcnt(4)
    v_mfma_f32_16x16x32_bf16 v[48:51], a[48:51], v[168:171], v[48:51]
    v_mfma_f32_16x16x32_bf16 v[52:55], a[48:51], v[172:175], v[52:55]
    ds_read_b128 a[16:19], v3 offset:8192
    s_add_u32 m0, s21, 51200
    v_mfma_f32_16x16x32_bf16 v[56:59], a[52:55], v[168:171], v[56:59]
    v_mfma_f32_16x16x32_bf16 v[60:63], a[52:55], v[172:175], v[60:63]
    ds_read_b128 a[20:23], v3 offset:10240
    s_add_u32 s64, s20, 0x5400
    buffer_load_dwordx4 v2, s[4:7], s64 offen lds
    v_mfma_f32_16x16x32_bf16 v[64:67], a[56:59], v[168:171], v[64:67]
    v_mfma_f32_16x16x32_bf16 v[68:71], a[56:59], v[172:175], v[68:71]
    ds_read_b128 a[24:27], v3 offset:12288
    s_add_u32 m0, s21, 52224
    v_mfma_f32_16x16x32_bf16 v[72:75], a[60:63], v[168:171], v[72:75]
    v_mfma_f32_16x16x32_bf16 v[76:79], a[60:63], v[172:175], v[76:79]
    ds_read_b128 a[28:31], v3 offset:14336
    s_add_u32 s64, s20, 0x7c00
    buffer_load_dwordx4 v2, s[4:7], s64 offen lds
    s_waitcnt lgkmcnt(4)
    v_mfma_f32_16x16x32_bf16 v[16:19], a[0:3], v[176:179], v[16:19]
    v_mfma_f32_16x16x32_bf16 v[20:23], a[0:3], v[180:183], v[20:23]
    ds_read_b128 a[32:35], v4 offset:0
    v_mfma_f32_16x16x32_bf16 v[24:27], a[4:7], v[176:179], v[24:27]
    v_mfma_f32_16x16x32_bf16 v[28:31], a[4:7], v[180:183], v[28:31]
    ds_read_b128 a[36:39], v4 offset:2048
    v_mfma_f32_16x16x32_bf16 v[32:35], a[8:11], v[176:179], v[32:35]
    v_mfma_f32_16x16x32_bf16 v[36:39], a[8:11], v[180:183], v[36:39]
    ds_read_b128 a[40:43], v4 offset:4096
    v_mfma_f32_16x16x32_bf16 v[40:43], a[12:15], v[176:179], v[40:43]
    v_mfma_f32_16x16x32_bf16 v[44:47], a[12:15], v[180:183], v[44:47]
    ds_read_b128 a[44:47], v4 offset:6144
    s_waitcnt lgkmcnt(4)
    v_mfma_f32_16x16x32_bf16 v[48:51], a[16:19], v[176:179], v[48:51]
    v_mfma_f32_16x16x32_bf16 v[52:55], a[16:19], v[180:183], v[52:55]
    ds_read_b128 a[48:51], v4 offset:8192
    v_mfma_f32_16x16x32_bf16 v[56:59], a[20:23], v[176:179], v[56:59]
    v_mfma_f32_16x16x32_bf16 v[60:63], a[20:23], v[180:183], v[60:63]
    ds_read_b128 a[52:55], v4 offset:10240
    v_mfma_f32_16x16x32_bf16 v[64:67], a[24:27], v[176:179], v[64:67]
    v_mfma_f32_16x16x32_bf16 v[68:71], a[24:27], v[180:183], v[68:71]
    ds_read_b128 a[56:59], v4 offset:12288
    v_mfma_f32_16x16x32_bf16 v[72:75], a[28:31], v[176:179], v[72:75]
    v_mfma_f32_16x16x32_bf16 v[76:79], a[28:31], v[180:183], v[76:79]
    ds_read_b128 a[60:63], v4 offset:14336
    s_waitcnt vmcnt(8)
    s_barrier
    s_waitcnt lgkmcnt(4)
    v_mfma_f32_16x16x32_bf16 v[16:19], a[32:35], v[184:187], v[16:19]
    v_mfma_f32_16x16x32_bf16 v[20:23], a[32:35], v[188:191], v[20:23]
    ds_read_b128 a[0:3], v3 offset:16384
    s_add_u32 m0, s21, 65536
    v_mfma_f32_16x16x32_bf16 v[24:27], a[36:39], v[184:187], v[24:27]
    v_mfma_f32_16x16x32_bf16 v[28:31], a[36:39], v[188:191], v[28:31]
    ds_read_b128 a[4:7], v3 offset:18432
    s_add_u32 s64, s20, 0x480
    buffer_load_dwordx4 v2, s[4:7], s64 offen lds
    v_mfma_f32_16x16x32_bf16 v[32:35], a[40:43], v[184:187], v[32:35]
    v_mfma_f32_16x16x32_bf16 v[36:39], a[40:43], v[188:191], v[36:39]
    ds_read_b128 a[8:11], v3 offset:20480
    s_add_u32 m0, s21, 66560
    v_mfma_f32_16x16x32_bf16 v[40:43], a[44:47], v[184:187], v[40:43]
    v_mfma_f32_16x16x32_bf16 v[44:47], a[44:47], v[188:191], v[44:47]
    ds_read_b128 a[12:15], v3 offset:22528
    s_add_u32 s64, s20, 0x2c80
    buffer_load_dwordx4 v2, s[4:7], s64 offen lds
    s_waitcnt lgkmcnt(4)
    v_mfma_f32_16x16x32_bf16 v[48:51], a[48:51], v[184:187], v[48:51]
    v_mfma_f32_16x16x32_bf16 v[52:55], a[48:51], v[188:191], v[52:55]
    ds_read_b128 a[16:19], v3 offset:24576
    s_add_u32 m0, s21, 67584
    v_mfma_f32_16x16x32_bf16 v[56:59], a[52:55], v[184:187], v[56:59]
    v_mfma_f32_16x16x32_bf16 v[60:63], a[52:55], v[188:191], v[60:63]
    ds_read_b128 a[20:23], v3 offset:26624
    s_add_u32 s64, s20, 0x5480
    buffer_load_dwordx4 v2, s[4:7], s64 offen lds
    v_mfma_f32_16x16x32_bf16 v[64:67], a[56:59], v[184:187], v[64:67]
    v_mfma_f32_16x16x32_bf16 v[68:71], a[56:59], v[188:191], v[68:71]
    ds_read_b128 a[24:27], v3 offset:28672
    s_add_u32 m0, s21, 68608
    v_mfma_f32_16x16x32_bf16 v[72:75], a[60:63], v[184:187], v[72:75]
    v_mfma_f32_16x16x32_bf16 v[76:79], a[60:63], v[188:191], v[76:79]
    ds_read_b128 a[28:31], v3 offset:30720
    s_add_u32 s64, s20, 0x7c80
    buffer_load_dwordx4 v2, s[4:7], s64 offen lds
    s_waitcnt lgkmcnt(4)
    v_mfma_f32_16x16x32_bf16 v[16:19], a[0:3], v[192:195], v[16:19]
    v_mfma_f32_16x16x32_bf16 v[20:23], a[0:3], v[196:199], v[20:23]
    ds_read_b128 a[32:35], v4 offset:16384
    v_mfma_f32_16x16x32_bf16 v[24:27], a[4:7], v[192:195], v[24:27]
    v_mfma_f32_16x16x32_bf16 v[28:31], a[4:7], v[196:199], v[28:31]
    ds_read_b128 a[36:39], v4 offset:18432
    v_mfma_f32_16x16x32_bf16 v[32:35], a[8:11], v[192:195], v[32:35]
    v_mfma_f32_16x16x32_bf16 v[36:39], a[8:11], v[196:199], v[36:39]
    ds_read_b128 a[40:43], v4 offset:20480
    v_mfma_f32_16x16x32_bf16 v[40:43], a[12:15], v[192:195], v[40:43]
    v_mfma_f32_16x16x32_bf16 v[44:47], a[12:15], v[196:199], v[44:47]
    ds_read_b128 a[44:47], v4 offset:22528
    s_waitcnt lgkmcnt(4)
    v_mfma_f32_16x16x32_bf16 v[48:51], a[16:19], v[192:195], v[48:51]
    v_mfma_f32_16x16x32_bf16 v[52:55], a[16:19], v[196:199], v[52:55]
    ds_read_b128 a[48:51], v4 offset:24576
    v_mfma_f32_16x16x32_bf16 v[56:59], a[20:23], v[192:195], v[56:59]
    v_mfma_f32_16x16x32_bf16 v[60:63], a[20:23], v[196:199], v[60:63]
    ds_read_b128 a[52:55], v4 offset:26624
    v_mfma_f32_16x16x32_bf16 v[64:67], a[24:27], v[192:195], v[64:67]
    v_mfma_f32_16x16x32_bf16 v[68:71], a[24:27], v[196:199], v[68:71]
    ds_read_b128 a[56:59], v4 offset:28672
    v_mfma_f32_16x16x32_bf16 v[72:75], a[28:31], v[192:195], v[72:75]
    v_mfma_f32_16x16x32_bf16 v[76:79], a[28:31], v[196:199], v[76:79]
    ds_read_b128 a[60:63], v4 offset:30720
    s_waitcnt vmcnt(8)
    s_barrier
    s_waitcnt lgkmcnt(4)
    v_mfma_f32_16x16x32_bf16 v[16:19], a[32:35], v[200:203], v[16:19]
    v_mfma_f32_16x16x32_bf16 v[20:23], a[32:35], v[204:207], v[20:23]
    ds_read_b128 a[0:3], v3 offset:32768
    s_add_u32 m0, s21, 0
    v_mfma_f32_16x16x32_bf16 v[24:27], a[36:39], v[200:203], v[24:27]
    v_mfma_f32_16x16x32_bf16 v[28:31], a[36:39], v[204:207], v[28:31]
    ds_read_b128 a[4:7], v3 offset:34816
    s_add_u32 s64, s20, 0x50000
    buffer_load_dwordx4 v2, s[4:7], s64 offen lds
    v_mfma_f32_16x16x32_bf16 v[32:35], a[40:43], v[200:203], v[32:35]
    v_mfma_f32_16x16x32_bf16 v[36:39], a[40:43], v[204:207], v[36:39]
    ds_read_b128 a[8:11], v3 offset:36864
    s_add_u32 m0, s21, 1024
    v_mfma_f32_16x16x32_bf16 v[40:43], a[44:47], v[200:203], v[40:43]
    v_mfma_f32_16x16x32_bf16 v[44:47], a[44:47], v[204:207], v[44:47]
    ds_read_b128 a[12:15], v3 offset:38912
    s_add_u32 s64, s20, 0x52800
    buffer_load_dwordx4 v2, s[4:7], s64 offen lds
    s_waitcnt lgkmcnt(4)
    v_mfma_f32_16x16x32_bf16 v[48:51], a[48:51], v[200:203], v[48:51]
    v_mfma_f32_16x16x32_bf16 v[52:55], a[48:51], v[204:207], v[52:55]
    ds_read_b128 a[16:19], v3 offset:40960
    s_add_u32 m0, s21, 2048
    v_mfma_f32_16x16x32_bf16 v[56:59], a[52:55], v[200:203], v[56:59]
    v_mfma_f32_16x16x32_bf16 v[60:63], a[52:55], v[204:207], v[60:63]
    ds_read_b128 a[20:23], v3 offset:43008
    s_add_u32 s64, s20, 0x55000
    buffer_load_dwordx4 v2, s[4:7], s64 offen lds
    v_mfma_f32_16x16x32_bf16 v[64:67], a[56:59], v[200:203], v[64:67]
    v_mfma_f32_16x16x32_bf16 v[68:71], a[56:59], v[204:207], v[68:71]
    ds_read_b128 a[24:27], v3 offset:45056
    s_add_u32 m0, s21, 3072
    v_mfma_f32_16x16x32_bf16 v[72:75], a[60:63], v[200:203], v[72:75]
    v_mfma_f32_16x16x32_bf16 v[76:79], a[60:63], v[204:207], v[76:79]
    ds_read_b128 a[28:31], v3 offset:47104
    s_add_u32 s64, s20, 0x57800
    buffer_load_dwordx4 v2, s[4:7], s64 offen lds
    s_waitcnt lgkmcnt(4)
    v_mfma_f32_16x16x32_bf16 v[16:19], a[0:3], v[208:211], v[16:19]
    v_mfma_f32_16x16x32_bf16 v[20:23], a[0:3], v[212:215], v[20:23]
    ds_read_b128 a[32:35], v4 offset:32768
    v_mfma_f32_16x16x32_bf16 v[24:27], a[4:7], v[208:211], v[24:27]
    v_mfma_f32_16x16x32_bf16 v[28:31], a[4:7], v[212:215], v[28:31]
    ds_read_b128 a[36:39], v4 offset:34816
    v_mfma_f32_16x16x32_bf16 v[32:35], a[8:11], v[208:211], v[32:35]
    v_mfma_f32_16x16x32_bf16 v[36:39], a[8:11], v[212:215], v[36:39]
    ds_read_b128 a[40:43], v4 offset:36864
    v_mfma_f32_16x16x32_bf16 v[40:43], a[12:15], v[208:211], v[40:43]
    v_mfma_f32_16x16x32_bf16 v[44:47], a[12:15], v[212:215], v[44:47]
    ds_read_b128 a[44:47], v4 offset:38912
    s_waitcnt lgkmcnt(4)
    v_mfma_f32_16x16x32_bf16 v[48:51], a[16:19], v[208:211], v[48:51]
    v_mfma_f32_16x16x32_bf16 v[52:55], a[16:19], v[212:215], v[52:55]
    ds_read_b128 a[48:51], v4 offset:40960
    v_mfma_f32_16x16x32_bf16 v[56:59], a[20:23], v[208:211], v[56:59]
    v_mfma_f32_16x16x32_bf16 v[60:63], a[20:23], v[212:215], v[60:63]
    ds_read_b128 a[52:55], v4 offset:43008
    v_mfma_f32_16x16x32_bf16 v[64:67], a[24:27], v[208:211], v[64:67]
    v_mfma_f32_16x16x32_bf16 v[68:71], a[24:27], v[212:215], v[68:71]
    ds_read_b128 a[56:59], v4 offset:45056
    v_mfma_f32_16x16x32_bf16 v[72:75], a[28:31], v[208:211], v[72:75]
    v_mfma_f32_16x16x32_bf16 v[76:79], a[28:31], v[212:215], v[76:79]
    ds_read_b128 a[60:63], v4 offset:47104
    s_waitcnt vmcnt(8)
    s_barrier
    s_waitcnt lgkmcnt(4)
    v_mfma_f32_16x16x32_bf16 v[16:19], a[32:35], v[216:219], v[16:19]
    v_mfma_f32_16x16x32_bf16 v[20:23], a[32:35], v[220:223], v[20:23]
    ds_read_b128 a[0:3], v3 offset:49152
    s_add_u32 m0, s21, 16384
    v_mfma_f32_16x16x32_bf16 v[24:27], a[36:39], v[216:219], v[24:27]
    v_mfma_f32_16x16x32_bf16 v[28:31], a[36:39], v[220:223], v[28:31]
    ds_read_b128 a[4:7], v3 offset:51200
    s_add_u32 s64, s20, 0x50080
    buffer_load_dwordx4 v2, s[4:7], s64 offen lds
    v_mfma_f32_16x16x32_bf16 v[32:35], a[40:43], v[216:219], v[32:35]
    v_mfma_f32_16x16x32_bf16 v[36:39], a[40:43], v[220:223], v[36:39]
    ds_read_b128 a[8:11], v3 offset:53248
    s_add_u32 m0, s21, 17408
    v_mfma_f32_16x16x32_bf16 v[40:43], a[44:47], v[216:219], v[40:43]
    v_mfma_f32_16x16x32_bf16 v[44:47], a[44:47], v[220:223], v[44:47]
    ds_read_b128 a[12:15], v3 offset:55296
    s_add_u32 s64, s20, 0x52880
    buffer_load_dwordx4 v2, s[4:7], s64 offen lds
    s_waitcnt lgkmcnt(4)
    v_mfma_f32_16x16x32_bf16 v[48:51], a[48:51], v[216:219], v[48:51]
    v_mfma_f32_16x16x32_bf16 v[52:55], a[48:51], v[220:223], v[52:55]
    ds_read_b128 a[16:19], v3 offset:57344
    s_add_u32 m0, s21, 18432
    v_mfma_f32_16x16x32_bf16 v[56:59], a[52:55], v[216:219], v[56:59]
    v_mfma_f32_16x16x32_bf16 v[60:63], a[52:55], v[220:223], v[60:63]
    ds_read_b128 a[20:23], v3 offset:59392
    s_add_u32 s64, s20, 0x55080
    buffer_load_dwordx4 v2, s[4:7], s64 offen lds
    v_mfma_f32_16x16x32_bf16 v[64:67], a[56:59], v[216:219], v[64:67]
    v_mfma_f32_16x16x32_bf16 v[68:71], a[56:59], v[220:223], v[68:71]
    ds_read_b128 a[24:27], v3 offset:61440
    s_add_u32 m0, s21, 19456
    v_mfma_f32_16x16x32_bf16 v[72:75], a[60:63], v[216:219], v[72:75]
    v_mfma_f32_16x16x32_bf16 v[76:79], a[60:63], v[220:223], v[76:79]
    ds_read_b128 a[28:31], v3 offset:63488
    s_add_u32 s64, s20, 0x57880
    buffer_load_dwordx4 v2, s[4:7], s64 offen lds
    s_waitcnt lgkmcnt(4)
    v_mfma_f32_16x16x32_bf16 v[16:19], a[0:3], v[224:227], v[16:19]
    v_mfma_f32_16x16x32_bf16 v[20:23], a[0:3], v[228:231], v[20:23]
    ds_read_b128 a[32:35], v4 offset:49152
    v_mfma_f32_16x16x32_bf16 v[24:27], a[4:7], v[224:227], v[24:27]
    v_mfma_f32_16x16x32_bf16 v[28:31], a[4:7], v[228:231], v[28:31]
    ds_read_b128 a[36:39], v4 offset:51200
    v_mfma_f32_16x16x32_bf16 v[32:35], a[8:11], v[224:227], v[32:35]
    v_mfma_f32_16x16x32_bf16 v[36:39], a[8:11], v[228:231], v[36:39]
    ds_read_b128 a[40:43], v4 offset:53248
    v_mfma_f32_16x16x32_bf16 v[40:43], a[12:15], v[224:227], v[40:43]
    v_mfma_f32_16x16x32_bf16 v[44:47], a[12:15], v[228:231], v[44:47]
    ds_read_b128 a[44:47], v4 offset:55296
    s_waitcnt lgkmcnt(4)
    v_mfma_f32_16x16x32_bf16 v[48:51], a[16:19], v[224:227], v[48:51]
    v_mfma_f32_16x16x32_bf16 v[52:55], a[16:19], v[228:231], v[52:55]
    ds_read_b128 a[48:51], v4 offset:57344
    v_mfma_f32_16x16x32_bf16 v[56:59], a[20:23], v[224:227], v[56:59]
    v_mfma_f32_16x16x32_bf16 v[60:63], a[20:23], v[228:231], v[60:63]
    ds_read_b128 a[52:55], v4 offset:59392
    v_mfma_f32_16x16x32_bf16 v[64:67], a[24:27], v[224:227], v[64:67]
    v_mfma_f32_16x16x32_bf16 v[68:71], a[24:27], v[228:231], v[68:71]
    ds_read_b128 a[56:59], v4 offset:61440
    v_mfma_f32_16x16x32_bf16 v[72:75], a[28:31], v[224:227], v[72:75]
    v_mfma_f32_16x16x32_bf16 v[76:79], a[28:31], v[228:231], v[76:79]
    ds_read_b128 a[60:63], v4 offset:63488
    s_waitcnt vmcnt(8)
    s_barrier
    s_waitcnt lgkmcnt(4)
    v_mfma_f32_16x16x32_bf16 v[16:19], a[32:35], v[232:235], v[16:19]
    v_mfma_f32_16x16x32_bf16 v[20:23], a[32:35], v[236:239], v[20:23]
    ds_read_b128 a[0:3], v6 offset:0
    s_add_u32 m0, s21, 32768
    v_mfma_f32_16x16x32_bf16 v[24:27], a[36:39], v[232:235], v[24:27]
    v_mfma_f32_16x16x32_bf16 v[28:31], a[36:39], v[236:239], v[28:31]
    ds_read_b128 a[4:7], v6 offset:2048
    s_add_u32 s64, s20, 0x50100
    buffer_load_dwordx4 v2, s[4:7], s64 offen lds
    v_mfma_f32_16x16x32_bf16 v[32:35], a[40:43], v[232:235], v[32:35]
    v_mfma_f32_16x16x32_bf16 v[36:39], a[40:43], v[236:239], v[36:39]
    ds_read_b128 a[8:11], v6 offset:4096
    s_add_u32 m0, s21, 33792
    v_mfma_f32_16x16x32_bf16 v[40:43], a[44:47], v[232:235], v[40:43]
    v_mfma_f32_16x16x32_bf16 v[44:47], a[44:47], v[236:239], v[44:47]
    ds_read_b128 a[12:15], v6 offset:6144
    s_add_u32 s64, s20, 0x52900
    buffer_load_dwordx4 v2, s[4:7], s64 offen lds
    s_waitcnt lgkmcnt(4)
    v_mfma_f32_16x16x32_bf16 v[48:51], a[48:51], v[232:235], v[48:51]
    v_mfma_f32_16x16x32_bf16 v[52:55], a[48:51], v[236:239], v[52:55]
    ds_read_b128 a[16:19], v6 offset:8192
    s_add_u32 m0, s21, 34816
    v_mfma_f32_16x16x32_bf16 v[56:59], a[52:55], v[232:235], v[56:59]
    v_mfma_f32_16x16x32_bf16 v[60:63], a[52:55], v[236:239], v[60:63]
    ds_read_b128 a[20:23], v6 offset:10240
    s_add_u32 s64, s20, 0x55100
    buffer_load_dwordx4 v2, s[4:7], s64 offen lds
    v_mfma_f32_16x16x32_bf16 v[64:67], a[56:59], v[232:235], v[64:67]
    v_mfma_f32_16x16x32_bf16 v[68:71], a[56:59], v[236:239], v[68:71]
    ds_read_b128 a[24:27], v6 offset:12288
    s_add_u32 m0, s21, 35840
    v_mfma_f32_16x16x32_bf16 v[72:75], a[60:63], v[232:235], v[72:75]
    v_mfma_f32_16x16x32_bf16 v[76:79], a[60:63], v[236:239], v[76:79]
    ds_read_b128 a[28:31], v6 offset:14336
    s_add_u32 s64, s20, 0x57900
    buffer_load_dwordx4 v2, s[4:7], s64 offen lds
    s_waitcnt lgkmcnt(4)
    v_mfma_f32_16x16x32_bf16 v[16:19], a[0:3], v[240:243], v[16:19]
    v_mfma_f32_16x16x32_bf16 v[20:23], a[0:3], v[244:247], v[20:23]
    ds_read_b128 a[32:35], v9 offset:0
    v_mfma_f32_16x16x32_bf16 v[24:27], a[4:7], v[240:243], v[24:27]
    v_mfma_f32_16x16x32_bf16 v[28:31], a[4:7], v[244:247], v[28:31]
    ds_read_b128 a[36:39], v9 offset:2048
    v_mfma_f32_16x16x32_bf16 v[32:35], a[8:11], v[240:243], v[32:35]
    v_mfma_f32_16x16x32_bf16 v[36:39], a[8:11], v[244:247], v[36:39]
    ds_read_b128 a[40:43], v9 offset:4096
    v_mfma_f32_16x16x32_bf16 v[40:43], a[12:15], v[240:243], v[40:43]
    v_mfma_f32_16x16x32_bf16 v[44:47], a[12:15], v[244:247], v[44:47]
    ds_read_b128 a[44:47], v9 offset:6144
    s_waitcnt lgkmcnt(4)
    v_mfma_f32_16x16x32_bf16 v[48:51], a[16:19], v[240:243], v[48:51]
    v_mfma_f32_16x16x32_bf16 v[52:55], a[16:19], v[244:247], v[52:55]
    ds_read_b128 a[48:51], v9 offset:8192
    v_mfma_f32_16x16x32_bf16 v[56:59], a[20:23], v[240:243], v[56:59]
    v_mfma_f32_16x16x32_bf16 v[60:63], a[20:23], v[244:247], v[60:63]
    ds_read_b128 a[52:55], v9 offset:10240
    v_mfma_f32_16x16x32_bf16 v[64:67], a[24:27], v[240:243], v[64:67]
    v_mfma_f32_16x16x32_bf16 v[68:71], a[24:27], v[244:247], v[68:71]
    ds_read_b128 a[56:59], v9 offset:12288
    v_mfma_f32_16x16x32_bf16 v[72:75], a[28:31], v[240:243], v[72:75]
    v_mfma_f32_16x16x32_bf16 v[76:79], a[28:31], v[244:247], v[76:79]
    ds_read_b128 a[60:63], v9 offset:14336
    s_waitcnt vmcnt(8)
    s_barrier
    s_waitcnt lgkmcnt(4)
    v_mfma_f32_16x16x32_bf16 v[16:19], a[32:35], v[248:251], v[16:19]
    v_mfma_f32_16x16x32_bf16 v[20:23], a[32:35], v[252:255], v[20:23]
    ds_read_b128 a[0:3], v3 offset:0
    s_add_u32 m0, s21, 49152
    v_mfma_f32_16x16x32_bf16 v[24:27], a[36:39], v[248:251], v[24:27]
    v_mfma_f32_16x16x32_bf16 v[28:31], a[36:39], v[252:255], v[28:31]
    ds_read_b128 a[4:7], v3 offset:2048
    s_add_u32 s64, s20, 0x50180
    buffer_load_dwordx4 v2, s[4:7], s64 offen lds
    v_mfma_f32_16x16x32_bf16 v[32:35], a[40:43], v[248:251], v[32:35]
    v_mfma_f32_16x16x32_bf16 v[36:39], a[40:43], v[252:255], v[36:39]
    ds_read_b128 a[8:11], v3 offset:4096
    s_add_u32 m0, s21, 50176
    v_mfma_f32_16x16x32_bf16 v[40:43], a[44:47], v[248:251], v[40:43]
    v_mfma_f32_16x16x32_bf16 v[44:47], a[44:47], v[252:255], v[44:47]
    ds_read_b128 a[12:15], v3 offset:6144
    s_add_u32 s64, s20, 0x52980
    buffer_load_dwordx4 v2, s[4:7], s64 offen lds
    s_waitcnt lgkmcnt(4)
    v_mfma_f32_16x16x32_bf16 v[48:51], a[48:51], v[248:251], v[48:51]
    v_mfma_f32_16x16x32_bf16 v[52:55], a[48:51], v[252:255], v[52:55]
    ds_read_b128 a[16:19], v3 offset:8192
    s_add_u32 m0, s21, 51200
    v_mfma_f32_16x16x32_bf16 v[56:59], a[52:55], v[248:251], v[56:59]
    v_mfma_f32_16x16x32_bf16 v[60:63], a[52:55], v[252:255], v[60:63]
    ds_read_b128 a[20:23], v3 offset:10240
    s_add_u32 s64, s20, 0x55180
    buffer_load_dwordx4 v2, s[4:7], s64 offen lds
    v_mfma_f32_16x16x32_bf16 v[64:67], a[56:59], v[248:251], v[64:67]
    v_mfma_f32_16x16x32_bf16 v[68:71], a[56:59], v[252:255], v[68:71]
    ds_read_b128 a[24:27], v3 offset:12288
    s_add_u32 m0, s21, 52224
    v_mfma_f32_16x16x32_bf16 v[72:75], a[60:63], v[248:251], v[72:75]
    v_mfma_f32_16x16x32_bf16 v[76:79], a[60:63], v[252:255], v[76:79]
    ds_read_b128 a[28:31], v3 offset:14336
    s_add_u32 s64, s20, 0x57980
    buffer_load_dwordx4 v2, s[4:7], s64 offen lds
    s_nop 5
    s_mul_i32 s65, s17, 0
    s_add_u32 s65, s65, s22
    s_add_u32 s64, s65, 0
    v_cvt_pk_bf16_f32 v80, v16, v17
    v_cvt_pk_bf16_f32 v81, v18, v19
    v_cvt_pk_bf16_f32 v82, v24, v25
    v_cvt_pk_bf16_f32 v83, v26, v27
    buffer_store_dwordx4 v[80:83], v1, s[4:7], s64 offen sc1
    s_add_u32 s64, s65, 1024
    v_cvt_pk_bf16_f32 v84, v20, v21
    v_cvt_pk_bf16_f32 v85, v22, v23
    v_cvt_pk_bf16_f32 v86, v28, v29
    v_cvt_pk_bf16_f32 v87, v30, v31
    buffer_store_dwordx4 v[84:87], v1, s[4:7], s64 offen sc1
    s_mul_i32 s65, s17, 1
    s_add_u32 s65, s65, s22
    s_add_u32 s64, s65, 0
    v_cvt_pk_bf16_f32 v88, v32, v33
    v_cvt_pk_bf16_f32 v89, v34, v35
    v_cvt_pk_bf16_f32 v90, v40, v41
    v_cvt_pk_bf16_f32 v91, v42, v43
    buffer_store_dwordx4 v[88:91], v1, s[4:7], s64 offen sc1
    s_add_u32 s64, s65, 1024
    v_cvt_pk_bf16_f32 v92, v36, v37
    v_cvt_pk_bf16_f32 v93, v38, v39
    v_cvt_pk_bf16_f32 v94, v44, v45
    v_cvt_pk_bf16_f32 v95, v46, v47
    buffer_store_dwordx4 v[92:95], v1, s[4:7], s64 offen sc1
    s_mul_i32 s65, s17, 2
    s_add_u32 s65, s65, s22
    s_add_u32 s64, s65, 0
    v_cvt_pk_bf16_f32 v80, v48, v49
    v_cvt_pk_bf16_f32 v81, v50, v51
    v_cvt_pk_bf16_f32 v82, v56, v57
    v_cvt_pk_bf16_f32 v83, v58, v59
    buffer_store_dwordx4 v[80:83], v1, s[4:7], s64 offen sc1
    s_add_u32 s64, s65, 1024
    v_cvt_pk_bf16_f32 v84, v52, v53
    v_cvt_pk_bf16_f32 v85, v54, v55
    v_cvt_pk_bf16_f32 v86, v60, v61
    v_cvt_pk_bf16_f32 v87, v62, v63
    buffer_store_dwordx4 v[84:87], v1, s[4:7], s64 offen sc1
    s_mul_i32 s65, s17, 3
    s_add_u32 s65, s65, s22
    s_add_u32 s64, s65, 0
    v_cvt_pk_bf16_f32 v88, v64, v65
    v_cvt_pk_bf16_f32 v89, v66, v67
    v_cvt_pk_bf16_f32 v90, v72, v73
    v_cvt_pk_bf16_f32 v91, v74, v75
    buffer_store_dwordx4 v[88:91], v1, s[4:7], s64 offen sc1
    s_add_u32 s64, s65, 1024
    v_cvt_pk_bf16_f32 v92, v68, v69
    v_cvt_pk_bf16_f32 v93, v70, v71
    v_cvt_pk_bf16_f32 v94, v76, v77
    v_cvt_pk_bf16_f32 v95, v78, v79
    buffer_store_dwordx4 v[92:95], v1, s[4:7], s64 offen sc1
    s_lshl_b32 s64, s19, 1
    s_add_u32 s64, s64, s12
    s_lshl_b32 s64, s64, 9
    s_add_u32 s23, s18, s64
    s_lshl_b32 s64, s17, 3
    s_add_u32 s22, s22, s64
    s_add_u32 s19, s19, 1
    s_add_u32 s20, s20, 0x50000
    s_cmp_lt_u32 s19, 8
    s_cbranch_scc1 G_N_LOOP
    s_waitcnt vmcnt(0) lgkmcnt(0)
    s_barrier
    s_cmp_lg_u32 s14, 0
    s_cbranch_scc1 GF_123
    v_mov_b32 v7, 1
    v_mov_b32 v8, 0
    s_mov_b64 exec, 1
    buffer_store_dword v7, v8, s[4:7], s23 offen sc1
    s_mov_b64 exec, -1
GF_123:
    s_cmp_eq_u32 s12, 1
    s_cbranch_scc1 H_OUT
    s_lshl_b32 s88, s3, 5
    s_add_u32 s88, s88, s13
    s_mov_b32 s29, 0
    v_lshlrev_b32 v1, 4, v0
    s_mov_b32 s65, 0
CW_124:
    buffer_load_dwordx2 v[8:9], off, s[60:63], 0 offset:132 sc1
    s_add_u32 s65, s65, 1
    s_waitcnt vmcnt(0)
    v_readfirstlane_b32 s66, v8
    v_readfirstlane_b32 s67, v9
    s_min_u32 s64, s66, s67
    s_cmp_lg_u32 s64, 0
    s_cbranch_scc1 CWD_125
    s_cmp_gt_u32 s65, 65536
    s_cbranch_scc1 CWD_125
    s_sleep 4
    s_branch CW_124
CWD_125:
    s_sub_u32 s66, s66, 1
    s_and_b32 s66, s66, 3
    s_sub_u32 s67, s67, 1
    s_and_b32 s67, s67, 3
    s_mov_b32 s64, s66
    s_mov_b32 s65, s67
    s_and_b32 s64, s64, 3
    s_lshl_b32 s64, s64, 13
    s_and_b32 s65, s65, 3
    s_lshl_b32 s65, s65, 13
    s_add_u32 s25, s64, 0x6000000
    s_add_u32 s30, s65, 0x6200000
    v_bfe_u32 v4, v0, 3, 1
    v_mul_u32_u24 v2, 0x8000, v4
    v_lshrrev_b32 v4, 5, v0
    v_lshl_add_u32 v2, v4, 8, v2
    v_bfe_u32 v4, v0, 4, 1
    v_lshl_add_u32 v2, v4, 7, v2
    v_and_b32 v4, 7, v0
    v_lshl_add_u32 v2, v4, 4, v2
    v_lshrrev_b32 v4, 5, v0
    v_lshlrev_b32 v3, 16, v4
    v_bfe_u32 v4, v0, 4, 1
    v_lshl_add_u32 v3, v4, 7, v3
    v_and_b32 v4, 15, v0
    v_lshl_add_u32 v3, v4, 3, v3
    s_lshl_b32 s26, s13, 11
    s_lshl_b32 s64, s14, 9
    s_add_u32 s26, s26, s64
    s_add_u32 s26, s26, 0xa40000
    s_lshl_b32 s27, s13, 3
    s_add_u32 s27, s27, 0x294004
    s_mov_b32 s28, 0x29a000
    s_mov_b32 s24, 0
    v_lshlrev_b32 v6, 7, v0
MKN_LOOP:
    s_cmp_lg_u32 s24, 10
    s_cbranch_scc1 MKH_126
    v_mov_b32 v10, v2
    v_mov_b32 v11, v3
    s_cmp_ge_u32 s88, 60
    s_cbranch_scc1 NOWO_127
    s_mov_b32 s89, s13
    s_mul_hi_u32 s65, s88, 0xccccccd
    s_mul_i32 s65, s65, 20
    s_sub_u32 s13, s88, s65
    s_load_dwordx2 s[44:45], s[0:1], 40
    s_mov_b32 s46, 0x500000
    s_mov_b32 s47, 0x00020000
    s_waitcnt lgkmcnt(0)
    s_mul_i32 s21, s14, 36864
    v_lshrrev_b32 v7, 2, v0
    v_mul_u32_u24 v4, 1280, v7
    v_bfe_u32 v7, v0, 4, 1
    v_lshlrev_b32 v7, 1, v7
    v_and_b32 v8, 3, v0
    v_xor_b32 v7, v7, v8
    v_lshl_add_u32 v4, v7, 4, v4
    v_lshrrev_b32 v7, 4, v0
    v_lshlrev_b32 v2, 8, v7
    v_bfe_u32 v7, v0, 2, 2
    v_lshl_add_u32 v2, v7, 6, v2
    v_and_b32 v7, 3, v0
    v_lshl_add_u32 v2, v7, 3, v2
    v_add_u32 v2, s21, v2
    v_bfe_u32 v7, v0, 4, 1
    v_lshlrev_b32 v7, 5, v7
    v_sub_u32 v3, 32, v7
    v_add_u32 v3, v3, v2
    v_add_u32 v2, v2, v7
    s_mul_i32 s65, s14, 1310720
    s_lshl_b32 s66, s13, 6
    s_add_u32 s65, s65, s66
    s_add_u32 m0, s21, 0
    s_add_u32 s64, s65, 0x0
    buffer_load_dwordx4 v4, s[44:47], s64 offen lds
    s_add_u32 m0, s21, 1024
    s_add_u32 s64, s65, 0x5000
    buffer_load_dwordx4 v4, s[44:47], s64 offen lds
    s_add_u32 m0, s21, 2048
    s_add_u32 s64, s65, 0xa000
    buffer_load_dwordx4 v4, s[44:47], s64 offen lds
    s_add_u32 m0, s21, 3072
    s_add_u32 s64, s65, 0xf000
    buffer_load_dwordx4 v4, s[44:47], s64 offen lds
    s_add_u32 m0, s21, 4096
    s_add_u32 s64, s65, 0x14000
    buffer_load_dwordx4 v4, s[44:47], s64 offen lds
    s_add_u32 m0, s21, 5120
    s_add_u32 s64, s65, 0x19000
    buffer_load_dwordx4 v4, s[44:47], s64 offen lds
    s_add_u32 m0, s21, 6144
    s_add_u32 s64, s65, 0x1e000
    buffer_load_dwordx4 v4, s[44:47], s64 offen lds
    s_add_u32 m0, s21, 7168
    s_add_u32 s64, s65, 0x23000
    buffer_load_dwordx4 v4, s[44:47], s64 offen lds
    s_add_u32 m0, s21, 8192
    s_add_u32 s64, s65, 0x28000
    buffer_load_dwordx4 v4, s[44:47], s64 offen lds
    s_add_u32 m0, s21, 9216
    s_add_u32 s64, s65, 0x2d000
    buffer_load_dwordx4 v4, s[44:47], s64 offen lds
    s_add_u32 m0, s21, 10240
    s_add_u32 s64, s65, 0x32000
    buffer_load_dwordx4 v4, s[44:47], s64 offen lds
    s_add_u32 m0, s21, 11264
    s_add_u32 s64, s65, 0x37000
    buffer_load_dwordx4 v4, s[44:47], s64 offen lds
    s_add_u32 m0, s21, 12288
    s_add_u32 s64, s65, 0x3c000
    buffer_load_dwordx4 v4, s[44:47], s64 offen lds
    s_add_u32 m0, s21, 13312
    s_add_u32 s64, s65, 0x41000
    buffer_load_dwordx4 v4, s[44:47], s64 offen lds
    s_add_u32 m0, s21, 14336
    s_add_u32 s64, s65, 0x46000
    buffer_load_dwordx4 v4, s[44:47], s64 offen lds
    s_add_u32 m0, s21, 15360
    s_add_u32 s64, s65, 0x4b000
    buffer_load_dwordx4 v4, s[44:47], s64 offen lds
    s_add_u32 m0, s21, 16384
    s_add_u32 s64, s65, 0x50000
    buffer_load_dwordx4 v4, s[44:47], s64 offen lds
    s_add_u32 m0, s21, 17408
    s_add_u32 s64, s65, 0x55000
    buffer_load_dwordx4 v4, s[44:47], s64 offen lds
    s_add_u32 m0, s21, 18432
    s_add_u32 s64, s65, 0x5a000
    buffer_load_dwordx4 v4, s[44:47], s64 offen lds
    s_add_u32 m0, s21, 19456
    s_add_u32 s64, s65, 0x5f000
    buffer_load_dwordx4 v4, s[44:47], s64 offen lds
    s_add_u32 m0, s21, 20480
    s_add_u32 s64, s65, 0x64000
    buffer_load_dwordx4 v4, s[44:47], s64 offen lds
    s_add_u32 m0, s21, 21504
    s_add_u32 s64, s65, 0x69000
    buffer_load_dwordx4 v4, s[44:47], s64 offen lds
    s_add_u32 m0, s21, 22528
    s_add_u32 s64, s65, 0x6e000
    buffer_load_dwordx4 v4, s[44:47], s64 offen lds
    s_add_u32 m0, s21, 23552
    s_add_u32 s64, s65, 0x73000
    buffer_load_dwordx4 v4, s[44:47], s64 offen lds
    s_add_u32 m0, s21, 24576
    s_add_u32 s64, s65, 0x78000
    buffer_load_dwordx4 v4, s[44:47], s64 offen lds
    s_add_u32 m0, s21, 25600
    s_add_u32 s64, s65, 0x7d000
    buffer_load_dwordx4 v4, s[44:47], s64 offen lds
    s_add_u32 m0, s21, 26624
    s_add_u32 s64, s65, 0x82000
    buffer_load_dwordx4 v4, s[44:47], s64 offen lds
    s_add_u32 m0, s21, 27648
    s_add_u32 s64, s65, 0x87000
    buffer_load_dwordx4 v4, s[44:47], s64 offen lds
    s_add_u32 m0, s21, 28672
    s_add_u32 s64, s65, 0x8c000
    buffer_load_dwordx4 v4, s[44:47], s64 offen lds
    s_add_u32 m0, s21, 29696
    s_add_u32 s64, s65, 0x91000
    buffer_load_dwordx4 v4, s[44:47], s64 offen lds
    s_add_u32 m0, s21, 30720
    s_add_u32 s64, s65, 0x96000
    buffer_load_dwordx4 v4, s[44:47], s64 offen lds
    s_add_u32 m0, s21, 31744
    s_add_u32 s64, s65, 0x9b000
    buffer_load_dwordx4 v4, s[44:47], s64 offen lds
    s_add_u32 m0, s21, 32768
    s_add_u32 s64, s65, 0xa0000
    buffer_load_dwordx4 v4, s[44:47], s64 offen lds
    s_add_u32 m0, s21, 33792
    s_add_u32 s64, s65, 0xa5000
    buffer_load_dwordx4 v4, s[44:47], s64 offen lds
    s_add_u32 m0, s21, 34816
    s_add_u32 s64, s65, 0xaa000
    buffer_load_dwordx4 v4, s[44:47], s64 offen lds
    s_add_u32 m0, s21, 35840
    s_add_u32 s64, s65, 0xaf000
    buffer_load_dwordx4 v4, s[44:47], s64 offen lds
    s_waitcnt vmcnt(32)
    ds_read_b64_tr_b16 a[0:1], v2 offset:0
    ds_read_b64_tr_b16 a[2:3], v2 offset:1024
    ds_read_b64_tr_b16 a[4:5], v3 offset:0
    ds_read_b64_tr_b16 a[6:7], v3 offset:1024
    ds_read_b64_tr_b16 a[8:9], v2 offset:2048
    ds_read_b64_tr_b16 a[10:11], v2 offset:3072
    ds_read_b64_tr_b16 a[12:13], v3 offset:2048
    ds_read_b64_tr_b16 a[14:15], v3 offset:3072
    s_waitcnt lgkmcnt(0)
    s_add_u32 m0, s21, 0
    s_add_u32 s64, s65, 0xb4000
    buffer_load_dwordx4 v4, s[44:47], s64 offen lds
    s_add_u32 m0, s21, 1024
    s_add_u32 s64, s65, 0xb9000
    buffer_load_dwordx4 v4, s[44:47], s64 offen lds
    s_add_u32 m0, s21, 2048
    s_add_u32 s64, s65, 0xbe000
    buffer_load_dwordx4 v4, s[44:47], s64 offen lds
    s_add_u32 m0, s21, 3072
    s_add_u32 s64, s65, 0xc3000
    buffer_load_dwordx4 v4, s[44:47], s64 offen lds
    s_waitcnt vmcnt(32)
    ds_read_b64_tr_b16 a[16:17], v2 offset:4096
    ds_read_b64_tr_b16 a[18:19], v2 offset:5120
    ds_read_b64_tr_b16 a[20:21], v3 offset:4096
    ds_read_b64_tr_b16 a[22:23], v3 offset:5120
    ds_read_b64_tr_b16 a[24:25], v2 offset:6144
    ds_read_b64_tr_b16 a[26:27], v2 offset:7168
    ds_read_b64_tr_b16 a[28:29], v3 offset:6144
    ds_read_b64_tr_b16 a[30:31], v3 offset:7168
    s_waitcnt lgkmcnt(0)
    s_add_u32 m0, s21, 4096
    s_add_u32 s64, s65, 0xc8000
    buffer_load_dwordx4 v4, s[44:47], s64 offen lds
    s_add_u32 m0, s21, 5120
    s_add_u32 s64, s65, 0xcd000
    buffer_load_dwordx4 v4, s[44:47], s64 offen lds
    s_add_u32 m0, s21, 6144
    s_add_u32 s64, s65, 0xd2000
    buffer_load_dwordx4 v4, s[44:47], s64 offen lds
    s_add_u32 m0, s21, 7168
    s_add_u32 s64, s65, 0xd7000
    buffer_load_dwordx4 v4, s[44:47], s64 offen lds
    s_waitcnt vmcnt(32)
    ds_read_b64_tr_b16 a[32:33], v2 offset:8192
    ds_read_b64_tr_b16 a[34:35], v2 offset:9216
    ds_read_b64_tr_b16 a[36:37], v3 offset:8192
    ds_read_b64_tr_b16 a[38:39], v3 offset:9216
    ds_read_b64_tr_b16 a[40:41], v2 offset:10240
    ds_read_b64_tr_b16 a[42:43], v2 offset:11264
    ds_read_b64_tr_b16 a[44:45], v3 offset:10240
    ds_read_b64_tr_b16 a[46:47], v3 offset:11264
    s_waitcnt lgkmcnt(0)
    s_add_u32 m0, s21, 8192
    s_add_u32 s64, s65, 0xdc000
    buffer_load_dwordx4 v4, s[44:47], s64 offen lds
    s_add_u32 m0, s21, 9216
    s_add_u32 s64, s65, 0xe1000
    buffer_load_dwordx4 v4, s[44:47], s64 offen lds
    s_add_u32 m0, s21, 10240
    s_add_u32 s64, s65, 0xe6000
    buffer_load_dwordx4 v4, s[44:47], s64 offen lds
    s_add_u32 m0, s21, 11264
    s_add_u32 s64, s65, 0xeb000
    buffer_load_dwordx4 v4, s[44:47], s64 offen lds
    s_waitcnt vmcnt(32)
    ds_read_b64_tr_b16 a[48:49], v2 offset:12288
    ds_read_b64_tr_b16 a[50:51], v2 offset:13312
    ds_read_b64_tr_b16 a[52:53], v3 offset:12288
    ds_read_b64_tr_b16 a[54:55], v3 offset:13312
    ds_read_b64_tr_b16 a[56:57], v2 offset:14336
    ds_read_b64_tr_b16 a[58:59], v2 offset:15360
    ds_read_b64_tr_b16 a[60:61], v3 offset:14336
    ds_read_b64_tr_b16 a[62:63], v3 offset:15360
    s_waitcnt lgkmcnt(0)
    s_add_u32 m0, s21, 12288
    s_add_u32 s64, s65, 0xf0000
    buffer_load_dwordx4 v4, s[44:47], s64 offen lds
    s_add_u32 m0, s21, 13312
    s_add_u32 s64, s65, 0xf5000
    buffer_load_dwordx4 v4, s[44:47], s64 offen lds
    s_add_u32 m0, s21, 14336
    s_add_u32 s64, s65, 0xfa000
    buffer_load_dwordx4 v4, s[44:47], s64 offen lds
    s_add_u32 m0, s21, 15360
    s_add_u32 s64, s65, 0xff000
    buffer_load_dwordx4 v4, s[44:47], s64 offen lds
    s_waitcnt vmcnt(32)
    ds_read_b64_tr_b16 a[64:65], v2 offset:16384
    ds_read_b64_tr_b16 a[66:67], v2 offset:17408
    ds_read_b64_tr_b16 a[68:69], v3 offset:16384
    ds_read_b64_tr_b16 a[70:71], v3 offset:17408
    ds_read_b64_tr_b16 a[72:73], v2 offset:18432
    ds_read_b64_tr_b16 a[74:75], v2 offset:19456
    ds_read_b64_tr_b16 a[76:77], v3 offset:18432
    ds_read_b64_tr_b16 a[78:79], v3 offset:19456
    s_waitcnt lgkmcnt(0)
    s_add_u32 m0, s21, 16384
    s_add_u32 s64, s65, 0x104000
    buffer_load_dwordx4 v4, s[44:47], s64 offen lds
    s_add_u32 m0, s21, 17408
    s_add_u32 s64, s65, 0x109000
    buffer_load_dwordx4 v4, s[44:47], s64 offen lds
    s_add_u32 m0, s21, 18432
    s_add_u32 s64, s65, 0x10e000
    buffer_load_dwordx4 v4, s[44:47], s64 offen lds
    s_add_u32 m0, s21, 19456
    s_add_u32 s64, s65, 0x113000
    buffer_load_dwordx4 v4, s[44:47], s64 offen lds
    s_waitcnt vmcnt(32)
    ds_read_b64_tr_b16 a[80:81], v2 offset:20480
    ds_read_b64_tr_b16 a[82:83], v2 offset:21504
    ds_read_b64_tr_b16 a[84:85], v3 offset:20480
    ds_read_b64_tr_b16 a[86:87], v3 offset:21504
    ds_read_b64_tr_b16 a[88:89], v2 offset:22528
    ds_read_b64_tr_b16 a[90:91], v2 offset:23552
    ds_read_b64_tr_b16 a[92:93], v3 offset:22528
    ds_read_b64_tr_b16 a[94:95], v3 offset:23552
    s_waitcnt lgkmcnt(0)
    s_add_u32 m0, s21, 20480
    s_add_u32 s64, s65, 0x118000
    buffer_load_dwordx4 v4, s[44:47], s64 offen lds
    s_add_u32 m0, s21, 21504
    s_add_u32 s64, s65, 0x11d000
    buffer_load_dwordx4 v4, s[44:47], s64 offen lds
    s_add_u32 m0, s21, 22528
    s_add_u32 s64, s65, 0x122000
    buffer_load_dwordx4 v4, s[44:47], s64 offen lds
    s_add_u32 m0, s21, 23552
    s_add_u32 s64, s65, 0x127000
    buffer_load_dwordx4 v4, s[44:47], s64 offen lds
    s_waitcnt vmcnt(32)
    ds_read_b64_tr_b16 a[96:97], v2 offset:24576
    ds_read_b64_tr_b16 a[98:99], v2 offset:25600
    ds_read_b64_tr_b16 a[100:101], v3 offset:24576
    ds_read_b64_tr_b16 a[102:103], v3 offset:25600
    ds_read_b64_tr_b16 a[104:105], v2 offset:26624
    ds_read_b64_tr_b16 a[106:107], v2 offset:27648
    ds_read_b64_tr_b16 a[108:109], v3 offset:26624
    ds_read_b64_tr_b16 a[110:111], v3 offset:27648
    s_waitcnt lgkmcnt(0)
    s_add_u32 m0, s21, 24576
    s_add_u32 s64, s65, 0x12c000
    buffer_load_dwordx4 v4, s[44:47], s64 offen lds
    s_add_u32 m0, s21, 25600
    s_add_u32 s64, s65, 0x131000
    buffer_load_dwordx4 v4, s[44:47], s64 offen lds
    s_add_u32 m0, s21, 26624
    s_add_u32 s64, s65, 0x136000
    buffer_load_dwordx4 v4, s[44:47], s64 offen lds
    s_add_u32 m0, s21, 27648
    s_add_u32 s64, s65, 0x13b000
    buffer_load_dwordx4 v4, s[44:47], s64 offen lds
    s_waitcnt vmcnt(32)
    ds_read_b64_tr_b16 a[112:113], v2 offset:28672
    ds_read_b64_tr_b16 a[114:115], v2 offset:29696
    ds_read_b64_tr_b16 a[116:117], v3 offset:28672
    ds_read_b64_tr_b16 a[118:119], v3 offset:29696
    ds_read_b64_tr_b16 a[120:121], v2 offset:30720
    ds_read_b64_tr_b16 a[122:123], v2 offset:31744
    ds_read_b64_tr_b16 a[124:125], v3 offset:30720
    ds_read_b64_tr_b16 a[126:127], v3 offset:31744
    s_waitcnt lgkmcnt(0)
    s_waitcnt vmcnt(28)
    ds_read_b64_tr_b16 a[128:129], v2 offset:32768
    ds_read_b64_tr_b16 a[130:131], v2 offset:33792
    ds_read_b64_tr_b16 a[132:133], v3 offset:32768
    ds_read_b64_tr_b16 a[134:135], v3 offset:33792
    ds_read_b64_tr_b16 a[136:137], v2 offset:34816
    ds_read_b64_tr_b16 a[138:139], v2 offset:35840
    ds_read_b64_tr_b16 a[140:141], v3 offset:34816
    ds_read_b64_tr_b16 a[142:143], v3 offset:35840
    s_waitcnt lgkmcnt(0)
    s_waitcnt vmcnt(24)
    ds_read_b64_tr_b16 a[144:145], v2 offset:0
    ds_read_b64_tr_b16 a[146:147], v2 offset:1024
    ds_read_b64_tr_b16 a[148:149], v3 offset:0
    ds_read_b64_tr_b16 a[150:151], v3 offset:1024
    ds_read_b64_tr_b16 a[152:153], v2 offset:2048
    ds_read_b64_tr_b16 a[154:155], v2 offset:3072
    ds_read_b64_tr_b16 a[156:157], v3 offset:2048
    ds_read_b64_tr_b16 a[158:159], v3 offset:3072
    s_waitcnt lgkmcnt(0)
    s_waitcnt vmcnt(20)
    ds_read_b64_tr_b16 a[160:161], v2 offset:4096
    ds_read_b64_tr_b16 a[162:163], v2 offset:5120
    ds_read_b64_tr_b16 a[164:165], v3 offset:4096
    ds_read_b64_tr_b16 a[166:167], v3 offset:5120
    ds_read_b64_tr_b16 a[168:169], v2 offset:6144
    ds_read_b64_tr_b16 a[170:171], v2 offset:7168
    ds_read_b64_tr_b16 a[172:173], v3 offset:6144
    ds_read_b64_tr_b16 a[174:175], v3 offset:7168
    s_waitcnt lgkmcnt(0)
    s_waitcnt vmcnt(16)
    ds_read_b64_tr_b16 a[176:177], v2 offset:8192
    ds_read_b64_tr_b16 a[178:179], v2 offset:9216
    ds_read_b64_tr_b16 a[180:181], v3 offset:8192
    ds_read_b64_tr_b16 a[182:183], v3 offset:9216
    ds_read_b64_tr_b16 a[184:185], v2 offset:10240
    ds_read_b64_tr_b16 a[186:187], v2 offset:11264
    ds_read_b64_tr_b16 a[188:189], v3 offset:10240
    ds_read_b64_tr_b16 a[190:191], v3 offset:11264
    s_waitcnt lgkmcnt(0)
    s_waitcnt vmcnt(12)
    ds_read_b64_tr_b16 a[192:193], v2 offset:12288
    ds_read_b64_tr_b16 a[194:195], v2 offset:13312
    ds_read_b64_tr_b16 a[196:197], v3 offset:12288
    ds_read_b64_tr_b16 a[198:199], v3 offset:13312
    ds_read_b64_tr_b16 a[200:201], v2 offset:14336
    ds_read_b64_tr_b16 a[202:203], v2 offset:15360
    ds_read_b64_tr_b16 a[204:205], v3 offset:14336
    ds_read_b64_tr_b16 a[206:207], v3 offset:15360
    s_waitcnt lgkmcnt(0)
    s_waitcnt vmcnt(8)
    ds_read_b64_tr_b16 a[208:209], v2 offset:16384
    ds_read_b64_tr_b16 a[210:211], v2 offset:17408
    ds_read_b64_tr_b16 a[212:213], v3 offset:16384
    ds_read_b64_tr_b16 a[214:215], v3 offset:17408
    ds_read_b64_tr_b16 a[216:217], v2 offset:18432
    ds_read_b64_tr_b16 a[218:219], v2 offset:19456
    ds_read_b64_tr_b16 a[220:221], v3 offset:18432
    ds_read_b64_tr_b16 a[222:223], v3 offset:19456
    s_waitcnt lgkmcnt(0)
    s_waitcnt vmcnt(4)
    ds_read_b64_tr_b16 a[224:225], v2 offset:20480
    ds_read_b64_tr_b16 a[226:227], v2 offset:21504
    ds_read_b64_tr_b16 a[228:229], v3 offset:20480
    ds_read_b64_tr_b16 a[230:231], v3 offset:21504
    ds_read_b64_tr_b16 a[232:233], v2 offset:22528
    ds_read_b64_tr_b16 a[234:235], v2 offset:23552
    ds_read_b64_tr_b16 a[236:237], v3 offset:22528
    ds_read_b64_tr_b16 a[238:239], v3 offset:23552
    s_waitcnt lgkmcnt(0)
    s_waitcnt vmcnt(0)
    ds_read_b64_tr_b16 a[240:241], v2 offset:24576
    ds_read_b64_tr_b16 a[242:243], v2 offset:25600
    ds_read_b64_tr_b16 a[244:245], v3 offset:24576
    ds_read_b64_tr_b16 a[246:247], v3 offset:25600
    ds_read_b64_tr_b16 a[248:249], v2 offset:26624
    ds_read_b64_tr_b16 a[250:251], v2 offset:27648
    ds_read_b64_tr_b16 a[252:253], v3 offset:26624
    ds_read_b64_tr_b16 a[254:255], v3 offset:27648
    s_waitcnt lgkmcnt(0)
    s_mov_b32 s13, s89
NOWO_127:
    v_mov_b32 v2, v10
    v_mov_b32 v3, v11
MKH_126:
    s_mov_b64 exec, 0xf
MKN_M_128:
    buffer_load_dword v5, v6, s[4:7], s28 offen sc1
    s_add_u32 s29, s29, 1
    s_waitcnt vmcnt(0)
    v_cmp_eq_u32 vcc, 0, v5
    s_cbranch_vccz MKN_MD_129
    s_cmp_gt_u32 s29, 262144
    s_cbranch_scc1 MKN_MD_129
    s_sleep 1
    s_branch MKN_M_128
MKN_MD_129:
    s_mov_b64 exec, -1
MKR_130:
    s_add_u32 s64, s25, 0x0
    buffer_load_dwordx4 v[16:19], v2, s[4:7], s64 offen sc1
    s_add_u32 s64, s25, 0x200
    buffer_load_dwordx4 v[20:23], v2, s[4:7], s64 offen sc1
    s_add_u32 s64, s25, 0x400
    buffer_load_dwordx4 v[24:27], v2, s[4:7], s64 offen sc1
    s_add_u32 s64, s25, 0x600
    buffer_load_dwordx4 v[28:31], v2, s[4:7], s64 offen sc1
    s_add_u32 s64, s25, 0x800
    buffer_load_dwordx4 v[32:35], v2, s[4:7], s64 offen sc1
    s_add_u32 s64, s25, 0xa00
    buffer_load_dwordx4 v[36:39], v2, s[4:7], s64 offen sc1
    s_add_u32 s64, s25, 0xc00
    buffer_load_dwordx4 v[40:43], v2, s[4:7], s64 offen sc1
    s_add_u32 s64, s25, 0xe00
    buffer_load_dwordx4 v[44:47], v2, s[4:7], s64 offen sc1
    s_add_u32 s64, s25, 0x1000
    buffer_load_dwordx4 v[48:51], v2, s[4:7], s64 offen sc1
    s_add_u32 s64, s25, 0x1200
    buffer_load_dwordx4 v[52:55], v2, s[4:7], s64 offen sc1
    s_add_u32 s64, s30, 0x0
    buffer_load_dwordx4 v[56:59], v2, s[4:7], s64 offen sc1
    s_add_u32 s64, s30, 0x200
    buffer_load_dwordx4 v[60:63], v2, s[4:7], s64 offen sc1
    s_add_u32 s64, s30, 0x400
    buffer_load_dwordx4 v[64:67], v2, s[4:7], s64 offen sc1
    s_add_u32 s64, s30, 0x600
    buffer_load_dwordx4 v[68:71], v2, s[4:7], s64 offen sc1
    s_add_u32 s64, s30, 0x800
    buffer_load_dwordx4 v[72:75], v2, s[4:7], s64 offen sc1
    s_add_u32 s64, s30, 0xa00
    buffer_load_dwordx4 v[76:79], v2, s[4:7], s64 offen sc1
    s_add_u32 s64, s30, 0xc00
    buffer_load_dwordx4 v[80:83], v2, s[4:7], s64 offen sc1
    s_add_u32 s64, s30, 0xe00
    buffer_load_dwordx4 v[84:87], v2, s[4:7], s64 offen sc1
    s_add_u32 s64, s30, 0x1000
    buffer_load_dwordx4 v[88:91], v2, s[4:7], s64 offen sc1
    s_add_u32 s64, s30, 0x1200
    buffer_load_dwordx4 v[92:95], v2, s[4:7], s64 offen sc1
    s_add_u32 s29, s29, 1
    s_waitcnt vmcnt(0)
    v_max3_u32 v4, v19, v23, v27
    v_max3_u32 v4, v4, v31, v35
    v_max3_u32 v4, v4, v39, v43
    v_max3_u32 v4, v4, v47, v51
    v_max3_u32 v4, v4, v55, v59
    v_max3_u32 v4, v4, v63, v67
    v_max3_u32 v4, v4, v71, v75
    v_max3_u32 v4, v4, v79, v83
    v_max3_u32 v4, v4, v87, v91
    v_max_u32 v4, v4, v95
    v_cmp_eq_u32 vcc, -1, v4
    s_cbranch_vccz MKO_131
    s_cmp_gt_u32 s29, 262144
    s_cbranch_scc0 MKR_130
MKO_131:
    v_mfma_f32_16x16x32_bf16 v[8:11], v[16:19], v[96:99], 0
    v_mfma_f32_16x16x32_bf16 v[12:15], v[16:19], v[100:103], 0
    v_mfma_f32_16x16x32_bf16 v[8:11], v[20:23], v[104:107], v[8:11]
    v_mfma_f32_16x16x32_bf16 v[12:15], v[20:23], v[108:111], v[12:15]
    v_mfma_f32_16x16x32_bf16 v[8:11], v[24:27], v[112:115], v[8:11]
    v_mfma_f32_16x16x32_bf16 v[12:15], v[24:27], v[116:119], v[12:15]
    v_mfma_f32_16x16x32_bf16 v[8:11], v[28:31], v[120:123], v[8:11]
    v_mfma_f32_16x16x32_bf16 v[12:15], v[28:31], v[124:127], v[12:15]
    v_mfma_f32_16x16x32_bf16 v[8:11], v[32:35], v[128:131], v[8:11]
    v_mfma_f32_16x16x32_bf16 v[12:15], v[32:35], v[132:135], v[12:15]
    v_mfma_f32_16x16x32_bf16 v[8:11], v[36:39], v[136:139], v[8:11]
    v_mfma_f32_16x16x32_bf16 v[12:15], v[36:39], v[140:143], v[12:15]
    v_mfma_f32_16x16x32_bf16 v[8:11], v[40:43], v[144:147], v[8:11]
    v_mfma_f32_16x16x32_bf16 v[12:15], v[40:43], v[148:151], v[12:15]
    v_mfma_f32_16x16x32_bf16 v[8:11], v[44:47], v[152:155], v[8:11]
    v_mfma_f32_16x16x32_bf16 v[12:15], v[44:47], v[156:159], v[12:15]
    v_mfma_f32_16x16x32_bf16 v[8:11], v[48:51], v[160:163], v[8:11]
    v_mfma_f32_16x16x32_bf16 v[12:15], v[48:51], v[164:167], v[12:15]
    v_mfma_f32_16x16x32_bf16 v[8:11], v[52:55], v[168:171], v[8:11]
    v_mfma_f32_16x16x32_bf16 v[12:15], v[52:55], v[172:175], v[12:15]
    v_mfma_f32_16x16x32_bf16 v[8:11], v[56:59], v[176:179], v[8:11]
    v_mfma_f32_16x16x32_bf16 v[12:15], v[56:59], v[180:183], v[12:15]
    v_mfma_f32_16x16x32_bf16 v[8:11], v[60:63], v[184:187], v[8:11]
    v_mfma_f32_16x16x32_bf16 v[12:15], v[60:63], v[188:191], v[12:15]
    v_mfma_f32_16x16x32_bf16 v[8:11], v[64:67], v[192:195], v[8:11]
    v_mfma_f32_16x16x32_bf16 v[12:15], v[64:67], v[196:199], v[12:15]
    v_mfma_f32_16x16x32_bf16 v[8:11], v[68:71], v[200:203], v[8:11]
    v_mfma_f32_16x16x32_bf16 v[12:15], v[68:71], v[204:207], v[12:15]
    v_mfma_f32_16x16x32_bf16 v[8:11], v[72:75], v[208:211], v[8:11]
    v_mfma_f32_16x16x32_bf16 v[12:15], v[72:75], v[212:215], v[12:15]
    v_mfma_f32_16x16x32_bf16 v[8:11], v[76:79], v[216:219], v[8:11]
    v_mfma_f32_16x16x32_bf16 v[12:15], v[76:79], v[220:223], v[12:15]
    v_mfma_f32_16x16x32_bf16 v[8:11], v[80:83], v[224:227], v[8:11]
    v_mfma_f32_16x16x32_bf16 v[12:15], v[80:83], v[228:231], v[12:15]
    v_mfma_f32_16x16x32_bf16 v[8:11], v[84:87], v[232:235], v[8:11]
    v_mfma_f32_16x16x32_bf16 v[12:15], v[84:87], v[236:239], v[12:15]
    v_mfma_f32_16x16x32_bf16 v[8:11], v[88:91], v[240:243], v[8:11]
    v_mfma_f32_16x16x32_bf16 v[12:15], v[88:91], v[244:247], v[12:15]
    v_mfma_f32_16x16x32_bf16 v[8:11], v[92:95], v[248:251], v[8:11]
    v_mfma_f32_16x16x32_bf16 v[12:15], v[92:95], v[252:255], v[12:15]
    s_nop 7
    v_cvt_pk_bf16_f32 v16, v8, v9
    v_cvt_pk_bf16_f32 v17, v10, v11
    v_cvt_pk_bf16_f32 v18, v12, v13
    v_cvt_pk_bf16_f32 v19, v14, v15
    buffer_store_dwordx2 v[16:17], v3, s[4:7], s26 offen sc1
    buffer_store_dwordx2 v[18:19], v3, s[4:7], s26 offen offset:256 sc1
    s_waitcnt vmcnt(0)
    s_barrier
    s_cmp_lg_u32 s14, 0
    s_cbranch_scc1 GF_132
    v_mov_b32 v7, 1
    v_mov_b32 v8, 0
    s_mov_b64 exec, 1
    buffer_store_dword v7, v8, s[4:7], s27 offen sc1
    s_mov_b64 exec, -1
GF_132:
    s_add_u32 s25, s25, 0x10000
    s_add_u32 s30, s30, 0x10000
    s_add_u32 s26, s26, 0x20000
    s_add_u32 s27, s27, 256
    s_add_u32 s28, s28, 512
    s_add_u32 s24, s24, 1
    s_cmp_lt_u32 s24, 32
    s_cbranch_scc1 MKN_LOOP
    s_cmp_ge_u32 s88, 60
    s_cbranch_scc1 M_EXIT
    s_branch H_EXTRA
H_OUT:
    s_lshl_b32 s64, s3, 5
    s_add_u32 s64, s64, s13
    s_cmp_ge_u32 s64, 60
    s_cbranch_scc1 M_EXIT
    s_mul_hi_u32 s12, s64, 0xccccccd
    s_mul_i32 s65, s12, 20
    s_sub_u32 s13, s64, s65
    s_load_dwordx2 s[44:45], s[0:1], 40
    s_mov_b32 s46, 0x500000
    s_mov_b32 s47, 0x00020000
    s_load_dwordx2 s[48:49], s[0:1], 0
    s_mov_b32 s50, 0x280000
    s_mov_b32 s51, 0x00020000
    s_load_dwordx2 s[52:53], s[0:1], 96
    s_mov_b32 s54, 0x280000
    s_mov_b32 s55, 0x00020000
    s_mov_b32 s36, -1
    s_mov_b32 s37, 0
    s_waitcnt lgkmcnt(0)
    s_mul_i32 s21, s14, 36864
    v_lshrrev_b32 v7, 2, v0
    v_mul_u32_u24 v4, 1280, v7
    v_bfe_u32 v7, v0, 4, 1
    v_lshlrev_b32 v7, 1, v7
    v_and_b32 v8, 3, v0
    v_xor_b32 v7, v7, v8
    v_lshl_add_u32 v4, v7, 4, v4
    v_lshrrev_b32 v7, 4, v0
    v_lshlrev_b32 v2, 8, v7
    v_bfe_u32 v7, v0, 2, 2
    v_lshl_add_u32 v2, v7, 6, v2
    v_and_b32 v7, 3, v0
    v_lshl_add_u32 v2, v7, 3, v2
    v_add_u32 v2, s21, v2
    v_bfe_u32 v7, v0, 4, 1
    v_lshlrev_b32 v7, 5, v7
    v_sub_u32 v3, 32, v7
    v_add_u32 v3, v3, v2
    v_add_u32 v2, v2, v7
    s_mul_i32 s65, s14, 1310720
    s_lshl_b32 s66, s13, 6
    s_add_u32 s65, s65, s66
    s_add_u32 m0, s21, 0
    s_add_u32 s64, s65, 0x0
    buffer_load_dwordx4 v4, s[44:47], s64 offen lds
    s_add_u32 m0, s21, 1024
    s_add_u32 s64, s65, 0x5000
    buffer_load_dwordx4 v4, s[44:47], s64 offen lds
    s_add_u32 m0, s21, 2048
    s_add_u32 s64, s65, 0xa000
    buffer_load_dwordx4 v4, s[44:47], s64 offen lds
    s_add_u32 m0, s21, 3072
    s_add_u32 s64, s65, 0xf000
    buffer_load_dwordx4 v4, s[44:47], s64 offen lds
    s_add_u32 m0, s21, 4096
    s_add_u32 s64, s65, 0x14000
    buffer_load_dwordx4 v4, s[44:47], s64 offen lds
    s_add_u32 m0, s21, 5120
    s_add_u32 s64, s65, 0x19000
    buffer_load_dwordx4 v4, s[44:47], s64 offen lds
    s_add_u32 m0, s21, 6144
    s_add_u32 s64, s65, 0x1e000
    buffer_load_dwordx4 v4, s[44:47], s64 offen lds
    s_add_u32 m0, s21, 7168
    s_add_u32 s64, s65, 0x23000
    buffer_load_dwordx4 v4, s[44:47], s64 offen lds
    s_add_u32 m0, s21, 8192
    s_add_u32 s64, s65, 0x28000
    buffer_load_dwordx4 v4, s[44:47], s64 offen lds
    s_add_u32 m0, s21, 9216
    s_add_u32 s64, s65, 0x2d000
    buffer_load_dwordx4 v4, s[44:47], s64 offen lds
    s_add_u32 m0, s21, 10240
    s_add_u32 s64, s65, 0x32000
    buffer_load_dwordx4 v4, s[44:47], s64 offen lds
    s_add_u32 m0, s21, 11264
    s_add_u32 s64, s65, 0x37000
    buffer_load_dwordx4 v4, s[44:47], s64 offen lds
    s_add_u32 m0, s21, 12288
    s_add_u32 s64, s65, 0x3c000
    buffer_load_dwordx4 v4, s[44:47], s64 offen lds
    s_add_u32 m0, s21, 13312
    s_add_u32 s64, s65, 0x41000
    buffer_load_dwordx4 v4, s[44:47], s64 offen lds
    s_add_u32 m0, s21, 14336
    s_add_u32 s64, s65, 0x46000
    buffer_load_dwordx4 v4, s[44:47], s64 offen lds
    s_add_u32 m0, s21, 15360
    s_add_u32 s64, s65, 0x4b000
    buffer_load_dwordx4 v4, s[44:47], s64 offen lds
    s_add_u32 m0, s21, 16384
    s_add_u32 s64, s65, 0x50000
    buffer_load_dwordx4 v4, s[44:47], s64 offen lds
    s_add_u32 m0, s21, 17408
    s_add_u32 s64, s65, 0x55000
    buffer_load_dwordx4 v4, s[44:47], s64 offen lds
    s_add_u32 m0, s21, 18432
    s_add_u32 s64, s65, 0x5a000
    buffer_load_dwordx4 v4, s[44:47], s64 offen lds
    s_add_u32 m0, s21, 19456
    s_add_u32 s64, s65, 0x5f000
    buffer_load_dwordx4 v4, s[44:47], s64 offen lds
    s_add_u32 m0, s21, 20480
    s_add_u32 s64, s65, 0x64000
    buffer_load_dwordx4 v4, s[44:47], s64 offen lds
    s_add_u32 m0, s21, 21504
    s_add_u32 s64, s65, 0x69000
    buffer_load_dwordx4 v4, s[44:47], s64 offen lds
    s_add_u32 m0, s21, 22528
    s_add_u32 s64, s65, 0x6e000
    buffer_load_dwordx4 v4, s[44:47], s64 offen lds
    s_add_u32 m0, s21, 23552
    s_add_u32 s64, s65, 0x73000
    buffer_load_dwordx4 v4, s[44:47], s64 offen lds
    s_add_u32 m0, s21, 24576
    s_add_u32 s64, s65, 0x78000
    buffer_load_dwordx4 v4, s[44:47], s64 offen lds
    s_add_u32 m0, s21, 25600
    s_add_u32 s64, s65, 0x7d000
    buffer_load_dwordx4 v4, s[44:47], s64 offen lds
    s_add_u32 m0, s21, 26624
    s_add_u32 s64, s65, 0x82000
    buffer_load_dwordx4 v4, s[44:47], s64 offen lds
    s_add_u32 m0, s21, 27648
    s_add_u32 s64, s65, 0x87000
    buffer_load_dwordx4 v4, s[44:47], s64 offen lds
    s_add_u32 m0, s21, 28672
    s_add_u32 s64, s65, 0x8c000
    buffer_load_dwordx4 v4, s[44:47], s64 offen lds
    s_add_u32 m0, s21, 29696
    s_add_u32 s64, s65, 0x91000
    buffer_load_dwordx4 v4, s[44:47], s64 offen lds
    s_add_u32 m0, s21, 30720
    s_add_u32 s64, s65, 0x96000
    buffer_load_dwordx4 v4, s[44:47], s64 offen lds
    s_add_u32 m0, s21, 31744
    s_add_u32 s64, s65, 0x9b000
    buffer_load_dwordx4 v4, s[44:47], s64 offen lds
    s_add_u32 m0, s21, 32768
    s_add_u32 s64, s65, 0xa0000
    buffer_load_dwordx4 v4, s[44:47], s64 offen lds
    s_add_u32 m0, s21, 33792
    s_add_u32 s64, s65, 0xa5000
    buffer_load_dwordx4 v4, s[44:47], s64 offen lds
    s_add_u32 m0, s21, 34816
    s_add_u32 s64, s65, 0xaa000
    buffer_load_dwordx4 v4, s[44:47], s64 offen lds
    s_add_u32 m0, s21, 35840
    s_add_u32 s64, s65, 0xaf000
    buffer_load_dwordx4 v4, s[44:47], s64 offen lds
    s_waitcnt vmcnt(32)
    ds_read_b64_tr_b16 a[0:1], v2 offset:0
    ds_read_b64_tr_b16 a[2:3], v2 offset:1024
    ds_read_b64_tr_b16 a[4:5], v3 offset:0
    ds_read_b64_tr_b16 a[6:7], v3 offset:1024
    ds_read_b64_tr_b16 a[8:9], v2 offset:2048
    ds_read_b64_tr_b16 a[10:11], v2 offset:3072
    ds_read_b64_tr_b16 a[12:13], v3 offset:2048
    ds_read_b64_tr_b16 a[14:15], v3 offset:3072
    s_waitcnt lgkmcnt(0)
    s_add_u32 m0, s21, 0
    s_add_u32 s64, s65, 0xb4000
    buffer_load_dwordx4 v4, s[44:47], s64 offen lds
    s_add_u32 m0, s21, 1024
    s_add_u32 s64, s65, 0xb9000
    buffer_load_dwordx4 v4, s[44:47], s64 offen lds
    s_add_u32 m0, s21, 2048
    s_add_u32 s64, s65, 0xbe000
    buffer_load_dwordx4 v4, s[44:47], s64 offen lds
    s_add_u32 m0, s21, 3072
    s_add_u32 s64, s65, 0xc3000
    buffer_load_dwordx4 v4, s[44:47], s64 offen lds
    s_waitcnt vmcnt(32)
    ds_read_b64_tr_b16 a[16:17], v2 offset:4096
    ds_read_b64_tr_b16 a[18:19], v2 offset:5120
    ds_read_b64_tr_b16 a[20:21], v3 offset:4096
    ds_read_b64_tr_b16 a[22:23], v3 offset:5120
    ds_read_b64_tr_b16 a[24:25], v2 offset:6144
    ds_read_b64_tr_b16 a[26:27], v2 offset:7168
    ds_read_b64_tr_b16 a[28:29], v3 offset:6144
    ds_read_b64_tr_b16 a[30:31], v3 offset:7168
    s_waitcnt lgkmcnt(0)
    s_add_u32 m0, s21, 4096
    s_add_u32 s64, s65, 0xc8000
    buffer_load_dwordx4 v4, s[44:47], s64 offen lds
    s_add_u32 m0, s21, 5120
    s_add_u32 s64, s65, 0xcd000
    buffer_load_dwordx4 v4, s[44:47], s64 offen lds
    s_add_u32 m0, s21, 6144
    s_add_u32 s64, s65, 0xd2000
    buffer_load_dwordx4 v4, s[44:47], s64 offen lds
    s_add_u32 m0, s21, 7168
    s_add_u32 s64, s65, 0xd7000
    buffer_load_dwordx4 v4, s[44:47], s64 offen lds
    s_waitcnt vmcnt(32)
    ds_read_b64_tr_b16 a[32:33], v2 offset:8192
    ds_read_b64_tr_b16 a[34:35], v2 offset:9216
    ds_read_b64_tr_b16 a[36:37], v3 offset:8192
    ds_read_b64_tr_b16 a[38:39], v3 offset:9216
    ds_read_b64_tr_b16 a[40:41], v2 offset:10240
    ds_read_b64_tr_b16 a[42:43], v2 offset:11264
    ds_read_b64_tr_b16 a[44:45], v3 offset:10240
    ds_read_b64_tr_b16 a[46:47], v3 offset:11264
    s_waitcnt lgkmcnt(0)
    s_add_u32 m0, s21, 8192
    s_add_u32 s64, s65, 0xdc000
    buffer_load_dwordx4 v4, s[44:47], s64 offen lds
    s_add_u32 m0, s21, 9216
    s_add_u32 s64, s65, 0xe1000
    buffer_load_dwordx4 v4, s[44:47], s64 offen lds
    s_add_u32 m0, s21, 10240
    s_add_u32 s64, s65, 0xe6000
    buffer_load_dwordx4 v4, s[44:47], s64 offen lds
    s_add_u32 m0, s21, 11264
    s_add_u32 s64, s65, 0xeb000
    buffer_load_dwordx4 v4, s[44:47], s64 offen lds
    s_waitcnt vmcnt(32)
    ds_read_b64_tr_b16 a[48:49], v2 offset:12288
    ds_read_b64_tr_b16 a[50:51], v2 offset:13312
    ds_read_b64_tr_b16 a[52:53], v3 offset:12288
    ds_read_b64_tr_b16 a[54:55], v3 offset:13312
    ds_read_b64_tr_b16 a[56:57], v2 offset:14336
    ds_read_b64_tr_b16 a[58:59], v2 offset:15360
    ds_read_b64_tr_b16 a[60:61], v3 offset:14336
    ds_read_b64_tr_b16 a[62:63], v3 offset:15360
    s_waitcnt lgkmcnt(0)
    s_add_u32 m0, s21, 12288
    s_add_u32 s64, s65, 0xf0000
    buffer_load_dwordx4 v4, s[44:47], s64 offen lds
    s_add_u32 m0, s21, 13312
    s_add_u32 s64, s65, 0xf5000
    buffer_load_dwordx4 v4, s[44:47], s64 offen lds
    s_add_u32 m0, s21, 14336
    s_add_u32 s64, s65, 0xfa000
    buffer_load_dwordx4 v4, s[44:47], s64 offen lds
    s_add_u32 m0, s21, 15360
    s_add_u32 s64, s65, 0xff000
    buffer_load_dwordx4 v4, s[44:47], s64 offen lds
    s_waitcnt vmcnt(32)
    ds_read_b64_tr_b16 a[64:65], v2 offset:16384
    ds_read_b64_tr_b16 a[66:67], v2 offset:17408
    ds_read_b64_tr_b16 a[68:69], v3 offset:16384
    ds_read_b64_tr_b16 a[70:71], v3 offset:17408
    ds_read_b64_tr_b16 a[72:73], v2 offset:18432
    ds_read_b64_tr_b16 a[74:75], v2 offset:19456
    ds_read_b64_tr_b16 a[76:77], v3 offset:18432
    ds_read_b64_tr_b16 a[78:79], v3 offset:19456
    s_waitcnt lgkmcnt(0)
    s_add_u32 m0, s21, 16384
    s_add_u32 s64, s65, 0x104000
    buffer_load_dwordx4 v4, s[44:47], s64 offen lds
    s_add_u32 m0, s21, 17408
    s_add_u32 s64, s65, 0x109000
    buffer_load_dwordx4 v4, s[44:47], s64 offen lds
    s_add_u32 m0, s21, 18432
    s_add_u32 s64, s65, 0x10e000
    buffer_load_dwordx4 v4, s[44:47], s64 offen lds
    s_add_u32 m0, s21, 19456
    s_add_u32 s64, s65, 0x113000
    buffer_load_dwordx4 v4, s[44:47], s64 offen lds
    s_waitcnt vmcnt(32)
    ds_read_b64_tr_b16 a[80:81], v2 offset:20480
    ds_read_b64_tr_b16 a[82:83], v2 offset:21504
    ds_read_b64_tr_b16 a[84:85], v3 offset:20480
    ds_read_b64_tr_b16 a[86:87], v3 offset:21504
    ds_read_b64_tr_b16 a[88:89], v2 offset:22528
    ds_read_b64_tr_b16 a[90:91], v2 offset:23552
    ds_read_b64_tr_b16 a[92:93], v3 offset:22528
    ds_read_b64_tr_b16 a[94:95], v3 offset:23552
    s_waitcnt lgkmcnt(0)
    s_add_u32 m0, s21, 20480
    s_add_u32 s64, s65, 0x118000
    buffer_load_dwordx4 v4, s[44:47], s64 offen lds
    s_add_u32 m0, s21, 21504
    s_add_u32 s64, s65, 0x11d000
    buffer_load_dwordx4 v4, s[44:47], s64 offen lds
    s_add_u32 m0, s21, 22528
    s_add_u32 s64, s65, 0x122000
    buffer_load_dwordx4 v4, s[44:47], s64 offen lds
    s_add_u32 m0, s21, 23552
    s_add_u32 s64, s65, 0x127000
    buffer_load_dwordx4 v4, s[44:47], s64 offen lds
    s_waitcnt vmcnt(32)
    ds_read_b64_tr_b16 a[96:97], v2 offset:24576
    ds_read_b64_tr_b16 a[98:99], v2 offset:25600
    ds_read_b64_tr_b16 a[100:101], v3 offset:24576
    ds_read_b64_tr_b16 a[102:103], v3 offset:25600
    ds_read_b64_tr_b16 a[104:105], v2 offset:26624
    ds_read_b64_tr_b16 a[106:107], v2 offset:27648
    ds_read_b64_tr_b16 a[108:109], v3 offset:26624
    ds_read_b64_tr_b16 a[110:111], v3 offset:27648
    s_waitcnt lgkmcnt(0)
    s_add_u32 m0, s21, 24576
    s_add_u32 s64, s65, 0x12c000
    buffer_load_dwordx4 v4, s[44:47], s64 offen lds
    s_add_u32 m0, s21, 25600
    s_add_u32 s64, s65, 0x131000
    buffer_load_dwordx4 v4, s[44:47], s64 offen lds
    s_add_u32 m0, s21, 26624
    s_add_u32 s64, s65, 0x136000
    buffer_load_dwordx4 v4, s[44:47], s64 offen lds
    s_add_u32 m0, s21, 27648
    s_add_u32 s64, s65, 0x13b000
    buffer_load_dwordx4 v4, s[44:47], s64 offen lds
    s_waitcnt vmcnt(32)
    ds_read_b64_tr_b16 a[112:113], v2 offset:28672
    ds_read_b64_tr_b16 a[114:115], v2 offset:29696
    ds_read_b64_tr_b16 a[116:117], v3 offset:28672
    ds_read_b64_tr_b16 a[118:119], v3 offset:29696
    ds_read_b64_tr_b16 a[120:121], v2 offset:30720
    ds_read_b64_tr_b16 a[122:123], v2 offset:31744
    ds_read_b64_tr_b16 a[124:125], v3 offset:30720
    ds_read_b64_tr_b16 a[126:127], v3 offset:31744
    s_waitcnt lgkmcnt(0)
    s_waitcnt vmcnt(28)
    ds_read_b64_tr_b16 a[128:129], v2 offset:32768
    ds_read_b64_tr_b16 a[130:131], v2 offset:33792
    ds_read_b64_tr_b16 a[132:133], v3 offset:32768
    ds_read_b64_tr_b16 a[134:135], v3 offset:33792
    ds_read_b64_tr_b16 a[136:137], v2 offset:34816
    ds_read_b64_tr_b16 a[138:139], v2 offset:35840
    ds_read_b64_tr_b16 a[140:141], v3 offset:34816
    ds_read_b64_tr_b16 a[142:143], v3 offset:35840
    s_waitcnt lgkmcnt(0)
    s_waitcnt vmcnt(24)
    ds_read_b64_tr_b16 a[144:145], v2 offset:0
    ds_read_b64_tr_b16 a[146:147], v2 offset:1024
    ds_read_b64_tr_b16 a[148:149], v3 offset:0
    ds_read_b64_tr_b16 a[150:151], v3 offset:1024
    ds_read_b64_tr_b16 a[152:153], v2 offset:2048
    ds_read_b64_tr_b16 a[154:155], v2 offset:3072
    ds_read_b64_tr_b16 a[156:157], v3 offset:2048
    ds_read_b64_tr_b16 a[158:159], v3 offset:3072
    s_waitcnt lgkmcnt(0)
    s_waitcnt vmcnt(20)
    ds_read_b64_tr_b16 a[160:161], v2 offset:4096
    ds_read_b64_tr_b16 a[162:163], v2 offset:5120
    ds_read_b64_tr_b16 a[164:165], v3 offset:4096
    ds_read_b64_tr_b16 a[166:167], v3 offset:5120
    ds_read_b64_tr_b16 a[168:169], v2 offset:6144
    ds_read_b64_tr_b16 a[170:171], v2 offset:7168
    ds_read_b64_tr_b16 a[172:173], v3 offset:6144
    ds_read_b64_tr_b16 a[174:175], v3 offset:7168
    s_waitcnt lgkmcnt(0)
    s_waitcnt vmcnt(16)
    ds_read_b64_tr_b16 a[176:177], v2 offset:8192
    ds_read_b64_tr_b16 a[178:179], v2 offset:9216
    ds_read_b64_tr_b16 a[180:181], v3 offset:8192
    ds_read_b64_tr_b16 a[182:183], v3 offset:9216
    ds_read_b64_tr_b16 a[184:185], v2 offset:10240
    ds_read_b64_tr_b16 a[186:187], v2 offset:11264
    ds_read_b64_tr_b16 a[188:189], v3 offset:10240
    ds_read_b64_tr_b16 a[190:191], v3 offset:11264
    s_waitcnt lgkmcnt(0)
    s_waitcnt vmcnt(12)
    ds_read_b64_tr_b16 a[192:193], v2 offset:12288
    ds_read_b64_tr_b16 a[194:195], v2 offset:13312
    ds_read_b64_tr_b16 a[196:197], v3 offset:12288
    ds_read_b64_tr_b16 a[198:199], v3 offset:13312
    ds_read_b64_tr_b16 a[200:201], v2 offset:14336
    ds_read_b64_tr_b16 a[202:203], v2 offset:15360
    ds_read_b64_tr_b16 a[204:205], v3 offset:14336
    ds_read_b64_tr_b16 a[206:207], v3 offset:15360
    s_waitcnt lgkmcnt(0)
    s_waitcnt vmcnt(8)
    ds_read_b64_tr_b16 a[208:209], v2 offset:16384
    ds_read_b64_tr_b16 a[210:211], v2 offset:17408
    ds_read_b64_tr_b16 a[212:213], v3 offset:16384
    ds_read_b64_tr_b16 a[214:215], v3 offset:17408
    ds_read_b64_tr_b16 a[216:217], v2 offset:18432
    ds_read_b64_tr_b16 a[218:219], v2 offset:19456
    ds_read_b64_tr_b16 a[220:221], v3 offset:18432
    ds_read_b64_tr_b16 a[222:223], v3 offset:19456
    s_waitcnt lgkmcnt(0)
    s_waitcnt vmcnt(4)
    ds_read_b64_tr_b16 a[224:225], v2 offset:20480
    ds_read_b64_tr_b16 a[226:227], v2 offset:21504
    ds_read_b64_tr_b16 a[228:229], v3 offset:20480
    ds_read_b64_tr_b16 a[230:231], v3 offset:21504
    ds_read_b64_tr_b16 a[232:233], v2 offset:22528
    ds_read_b64_tr_b16 a[234:235], v2 offset:23552
    ds_read_b64_tr_b16 a[236:237], v3 offset:22528
    ds_read_b64_tr_b16 a[238:239], v3 offset:23552
    s_waitcnt lgkmcnt(0)
    s_waitcnt vmcnt(0)
    ds_read_b64_tr_b16 a[240:241], v2 offset:24576
    ds_read_b64_tr_b16 a[242:243], v2 offset:25600
    ds_read_b64_tr_b16 a[244:245], v3 offset:24576
    ds_read_b64_tr_b16 a[246:247], v3 offset:25600
    ds_read_b64_tr_b16 a[248:249], v2 offset:26624
    ds_read_b64_tr_b16 a[250:251], v2 offset:27648
    ds_read_b64_tr_b16 a[252:253], v3 offset:26624
    ds_read_b64_tr_b16 a[254:255], v3 offset:27648
    s_waitcnt lgkmcnt(0)
    s_barrier
    s_mov_b32 s29, 0
    v_lshlrev_b32 v1, 4, v0
    v_mov_b32 v8, 0
    s_mov_b32 s64, 0x298000
OUS_133:
    buffer_load_dword v7, v8, s[4:7], s64 offen sc1
    s_add_u32 s29, s29, 1
    s_waitcnt vmcnt(0)
    v_cmp_gt_u32 vcc, 1, v7
    s_cbranch_vccz OUSD_134
    s_cmp_gt_u32 s29, 262144
    s_cbranch_scc1 OUSD_134
    s_sleep 8
    s_branch OUS_133
OUSD_134:
    v_lshlrev_b32 v6, 2, v0
    s_mov_b32 s64, 0x5400000
    buffer_load_dword v7, v6, s[4:7], s64 offen sc1
    s_waitcnt vmcnt(0)
    v_readlane_b32 s72, v7, 0
    v_readlane_b32 s73, v7, 1
    v_readlane_b32 s74, v7, 2
    v_readlane_b32 s75, v7, 3
    v_readlane_b32 s76, v7, 4
    v_readlane_b32 s77, v7, 5
    v_readlane_b32 s78, v7, 6
    v_readlane_b32 s79, v7, 7
    s_and_b32 s64, s14, 1
    s_lshl_b32 s64, s64, 4
    v_and_b32 v6, 15, v0
    v_add_u32 v6, s64, v6
    v_mov_b32 v9, v6
    v_mul_u32_u24 v5, 1280, v6
    v_lshrrev_b32 v6, 4, v0
    v_lshl_add_u32 v5, v6, 3, v5
    s_lshr_b32 s64, s14, 1
    s_lshl_b32 s64, s64, 5
    s_lshl_b32 s65, s13, 6
    s_add_u32 s64, s64, s65
    v_add_u32 v5, s64, v5
    v_lshlrev_b32 v6, 2, v0
    s_mov_b32 s80, 0x49249249
    s_mov_b32 s81, 0x92492492
    s_lshl_b64 s[80:81], s[80:81], s12
    s_bitset0_b64 s[80:81], 63
    s_bitset0_b64 s[80:81], 62
    s_mov_b64 s[82:83], 0
    s_lshr_b32 s64, s72, 5
    s_bitset1_b64 s[82:83], s64
    s_lshr_b32 s64, s73, 5
    s_bitset1_b64 s[82:83], s64
    s_lshr_b32 s64, s74, 5
    s_bitset1_b64 s[82:83], s64
    s_lshr_b32 s64, s75, 5
    s_bitset1_b64 s[82:83], s64
    s_lshr_b32 s64, s76, 5
    s_bitset1_b64 s[82:83], s64
    s_lshr_b32 s64, s77, 5
    s_bitset1_b64 s[82:83], s64
    s_lshr_b32 s64, s78, 5
    s_bitset1_b64 s[82:83], s64
    s_lshr_b32 s64, s79, 5
    s_bitset1_b64 s[82:83], s64
OU_LOOP:
    s_cmp_eq_u64 s[80:81], 0
    s_cbranch_scc1 OU_END
    s_andn2_b64 s[84:85], s[80:81], s[82:83]
    s_cbranch_scc0 OU_WM
    s_ff1_i32_b64 s24, s[84:85]
    s_branch OU_GO
OU_WM:
    v_mov_b32 v8, 0
    s_mov_b32 s64, 0x298100
OUW_135:
    buffer_load_dword v7, v8, s[4:7], s64 offen sc1
    s_add_u32 s29, s29, 1
    s_waitcnt vmcnt(0)
    v_cmp_gt_u32 vcc, 40, v7
    s_cbranch_vccz OUWD_136
    s_cmp_gt_u32 s29, 262144
    s_cbranch_scc1 OUWD_136
    s_sleep 8
    s_branch OUW_135
OUWD_136:
    s_mov_b64 s[82:83], 0
    s_branch OU_LOOP
OU_GO:
    s_bitset0_b64 s[80:81], s24
    s_lshr_b32 s86, s14, 1
    s_mul_i32 s67, s24, 40960
    buffer_load_dwordx2 v[160:161], v5, s[48:51], s67 offen
    s_add_u32 s64, s67, 0x0
    buffer_load_dwordx2 v[162:163], v5, s[4:7], s64 offen
    s_mov_b32 s64, 0x298100
    buffer_load_dword v12, off, s[4:7], s64 sc1
    s_lshl_b32 s64, s24, 7
    s_add_u32 s64, s64, 0x296000
    s_mov_b64 exec, s[36:37]
OU_F_137:
    buffer_load_dword v7, v6, s[4:7], s64 offen sc1
    s_add_u32 s29, s29, 1
    s_waitcnt vmcnt(0)
    v_cmp_eq_u32 vcc, 0, v7
    s_cbranch_vccz OU_FD_138
    s_cmp_gt_u32 s29, 262144
    s_cbranch_scc1 OU_FD_138
    s_sleep 1
    s_branch OU_F_137
OU_FD_138:
    s_mov_b64 exec, -1
    s_lshl_b32 s25, s24, 18
    s_lshl_b32 s64, s14, 15
    s_add_u32 s25, s25, s64
    s_add_u32 s25, s25, 0x4400000
    s_add_u32 s64, s25, 0x0
    buffer_load_dwordx4 v[16:19], v1, s[4:7], s64 offen
    s_add_u32 s64, s25, 0x20000
    buffer_load_dwordx4 v[20:23], v1, s[4:7], s64 offen
    s_add_u32 s64, s25, 0x400
    buffer_load_dwordx4 v[24:27], v1, s[4:7], s64 offen
    s_add_u32 s64, s25, 0x20400
    buffer_load_dwordx4 v[28:31], v1, s[4:7], s64 offen
    s_add_u32 s64, s25, 0x800
    buffer_load_dwordx4 v[32:35], v1, s[4:7], s64 offen
    s_add_u32 s64, s25, 0x20800
    buffer_load_dwordx4 v[36:39], v1, s[4:7], s64 offen
    s_add_u32 s64, s25, 0xc00
    buffer_load_dwordx4 v[40:43], v1, s[4:7], s64 offen
    s_add_u32 s64, s25, 0x20c00
    buffer_load_dwordx4 v[44:47], v1, s[4:7], s64 offen
    s_add_u32 s64, s25, 0x1000
    buffer_load_dwordx4 v[48:51], v1, s[4:7], s64 offen
    s_add_u32 s64, s25, 0x21000
    buffer_load_dwordx4 v[52:55], v1, s[4:7], s64 offen
    s_add_u32 s64, s25, 0x1400
    buffer_load_dwordx4 v[56:59], v1, s[4:7], s64 offen
    s_add_u32 s64, s25, 0x21400
    buffer_load_dwordx4 v[60:63], v1, s[4:7], s64 offen
    s_add_u32 s64, s25, 0x1800
    buffer_load_dwordx4 v[64:67], v1, s[4:7], s64 offen
    s_add_u32 s64, s25, 0x21800
    buffer_load_dwordx4 v[68:71], v1, s[4:7], s64 offen
    s_add_u32 s64, s25, 0x1c00
    buffer_load_dwordx4 v[72:75], v1, s[4:7], s64 offen
    s_add_u32 s64, s25, 0x21c00
    buffer_load_dwordx4 v[76:79], v1, s[4:7], s64 offen
    s_add_u32 s64, s25, 0x2000
    buffer_load_dwordx4 v[80:83], v1, s[4:7], s64 offen
    s_add_u32 s64, s25, 0x22000
    buffer_load_dwordx4 v[84:87], v1, s[4:7], s64 offen
    s_add_u32 s64, s25, 0x2400
    buffer_load_dwordx4 v[88:91], v1, s[4:7], s64 offen
    s_add_u32 s64, s25, 0x22400
    buffer_load_dwordx4 v[92:95], v1, s[4:7], s64 offen
    s_add_u32 s64, s25, 0x2800
    buffer_load_dwordx4 v[96:99], v1, s[4:7], s64 offen
    s_add_u32 s64, s25, 0x22800
    buffer_load_dwordx4 v[100:103], v1, s[4:7], s64 offen
    s_add_u32 s64, s25, 0x2c00
    buffer_load_dwordx4 v[104:107], v1, s[4:7], s64 offen
    s_add_u32 s64, s25, 0x22c00
    buffer_load_dwordx4 v[108:111], v1, s[4:7], s64 offen
    s_add_u32 s64, s25, 0x3000
    buffer_load_dwordx4 v[112:115], v1, s[4:7], s64 offen
    s_add_u32 s64, s25, 0x23000
    buffer_load_dwordx4 v[116:119], v1, s[4:7], s64 offen
    s_add_u32 s64, s25, 0x3400
    buffer_load_dwordx4 v[120:123], v1, s[4:7], s64 offen
    s_add_u32 s64, s25, 0x23400
    buffer_load_dwordx4 v[124:127], v1, s[4:7], s64 offen
    s_add_u32 s64, s25, 0x3800
    buffer_load_dwordx4 v[128:131], v1, s[4:7], s64 offen
    s_add_u32 s64, s25, 0x23800
    buffer_load_dwordx4 v[132:135], v1, s[4:7], s64 offen
    s_add_u32 s64, s25, 0x3c00
    buffer_load_dwordx4 v[136:139], v1, s[4:7], s64 offen
    s_add_u32 s64, s25, 0x23c00
    buffer_load_dwordx4 v[140:143], v1, s[4:7], s64 offen
    s_waitcnt vmcnt(30)
    v_mfma_f32_16x16x32_bf16 v[144:147], a[0:3], v[16:19], 0
    v_mfma_f32_16x16x32_bf16 v[148:151], a[0:3], v[20:23], 0
    v_mfma_f32_16x16x32_bf16 v[152:155], a[4:7], v[16:19], 0
    v_mfma_f32_16x16x32_bf16 v[156:159], a[4:7], v[20:23], 0
    s_add_u32 s64, s25, 0x4000
    buffer_load_dwordx4 v[16:19], v1, s[4:7], s64 offen
    s_add_u32 s64, s25, 0x24000
    buffer_load_dwordx4 v[20:23], v1, s[4:7], s64 offen
    s_waitcnt vmcnt(30)
    v_mfma_f32_16x16x32_bf16 v[144:147], a[8:11], v[24:27], v[144:147]
    v_mfma_f32_16x16x32_bf16 v[148:151], a[8:11], v[28:31], v[148:151]
    v_mfma_f32_16x16x32_bf16 v[152:155], a[12:15], v[24:27], v[152:155]
    v_mfma_f32_16x16x32_bf16 v[156:159], a[12:15], v[28:31], v[156:159]
    s_add_u32 s64, s25, 0x4400
    buffer_load_dwordx4 v[24:27], v1, s[4:7], s64 offen
    s_add_u32 s64, s25, 0x24400
    buffer_load_dwordx4 v[28:31], v1, s[4:7], s64 offen
    s_waitcnt vmcnt(30)
    v_mfma_f32_16x16x32_bf16 v[144:147], a[16:19], v[32:35], v[144:147]
    v_mfma_f32_16x16x32_bf16 v[148:151], a[16:19], v[36:39], v[148:151]
    v_mfma_f32_16x16x32_bf16 v[152:155], a[20:23], v[32:35], v[152:155]
    v_mfma_f32_16x16x32_bf16 v[156:159], a[20:23], v[36:39], v[156:159]
    s_add_u32 s64, s25, 0x4800
    buffer_load_dwordx4 v[32:35], v1, s[4:7], s64 offen
    s_add_u32 s64, s25, 0x24800
    buffer_load_dwordx4 v[36:39], v1, s[4:7], s64 offen
    s_waitcnt vmcnt(30)
    v_mfma_f32_16x16x32_bf16 v[144:147], a[24:27], v[40:43], v[144:147]
    v_mfma_f32_16x16x32_bf16 v[148:151], a[24:27], v[44:47], v[148:151]
    v_mfma_f32_16x16x32_bf16 v[152:155], a[28:31], v[40:43], v[152:155]
    v_mfma_f32_16x16x32_bf16 v[156:159], a[28:31], v[44:47], v[156:159]
    s_add_u32 s64, s25, 0x4c00
    buffer_load_dwordx4 v[40:43], v1, s[4:7], s64 offen
    s_add_u32 s64, s25, 0x24c00
    buffer_load_dwordx4 v[44:47], v1, s[4:7], s64 offen
    s_waitcnt vmcnt(30)
    v_mfma_f32_16x16x32_bf16 v[144:147], a[32:35], v[48:51], v[144:147]
    v_mfma_f32_16x16x32_bf16 v[148:151], a[32:35], v[52:55], v[148:151]
    v_mfma_f32_16x16x32_bf16 v[152:155], a[36:39], v[48:51], v[152:155]
    v_mfma_f32_16x16x32_bf16 v[156:159], a[36:39], v[52:55], v[156:159]
    s_add_u32 s64, s25, 0x5000
    buffer_load_dwordx4 v[48:51], v1, s[4:7], s64 offen
    s_add_u32 s64, s25, 0x25000
    buffer_load_dwordx4 v[52:55], v1, s[4:7], s64 offen
    s_waitcnt vmcnt(30)
    v_mfma_f32_16x16x32_bf16 v[144:147], a[40:43], v[56:59], v[144:147]
    v_mfma_f32_16x16x32_bf16 v[148:151], a[40:43], v[60:63], v[148:151]
    v_mfma_f32_16x16x32_bf16 v[152:155], a[44:47], v[56:59], v[152:155]
    v_mfma_f32_16x16x32_bf16 v[156:159], a[44:47], v[60:63], v[156:159]
    s_add_u32 s64, s25, 0x5400
    buffer_load_dwordx4 v[56:59], v1, s[4:7], s64 offen
    s_add_u32 s64, s25, 0x25400
    buffer_load_dwordx4 v[60:63], v1, s[4:7], s64 offen
    s_waitcnt vmcnt(30)
    v_mfma_f32_16x16x32_bf16 v[144:147], a[48:51], v[64:67], v[144:147]
    v_mfma_f32_16x16x32_bf16 v[148:151], a[48:51], v[68:71], v[148:151]
    v_mfma_f32_16x16x32_bf16 v[152:155], a[52:55], v[64:67], v[152:155]
    v_mfma_f32_16x16x32_bf16 v[156:159], a[52:55], v[68:71], v[156:159]
    s_add_u32 s64, s25, 0x5800
    buffer_load_dwordx4 v[64:67], v1, s[4:7], s64 offen
    s_add_u32 s64, s25, 0x25800
    buffer_load_dwordx4 v[68:71], v1, s[4:7], s64 offen
    s_waitcnt vmcnt(30)
    v_mfma_f32_16x16x32_bf16 v[144:147], a[56:59], v[72:75], v[144:147]
    v_mfma_f32_16x16x32_bf16 v[148:151], a[56:59], v[76:79], v[148:151]
    v_mfma_f32_16x16x32_bf16 v[152:155], a[60:63], v[72:75], v[152:155]
    v_mfma_f32_16x16x32_bf16 v[156:159], a[60:63], v[76:79], v[156:159]
    s_add_u32 s64, s25, 0x5c00
    buffer_load_dwordx4 v[72:75], v1, s[4:7], s64 offen
    s_add_u32 s64, s25, 0x25c00
    buffer_load_dwordx4 v[76:79], v1, s[4:7], s64 offen
    s_waitcnt vmcnt(30)
    v_mfma_f32_16x16x32_bf16 v[144:147], a[64:67], v[80:83], v[144:147]
    v_mfma_f32_16x16x32_bf16 v[148:151], a[64:67], v[84:87], v[148:151]
    v_mfma_f32_16x16x32_bf16 v[152:155], a[68:71], v[80:83], v[152:155]
    v_mfma_f32_16x16x32_bf16 v[156:159], a[68:71], v[84:87], v[156:159]
    s_add_u32 s64, s25, 0x6000
    buffer_load_dwordx4 v[80:83], v1, s[4:7], s64 offen
    s_add_u32 s64, s25, 0x26000
    buffer_load_dwordx4 v[84:87], v1, s[4:7], s64 offen
    s_waitcnt vmcnt(30)
    v_mfma_f32_16x16x32_bf16 v[144:147], a[72:75], v[88:91], v[144:147]
    v_mfma_f32_16x16x32_bf16 v[148:151], a[72:75], v[92:95], v[148:151]
    v_mfma_f32_16x16x32_bf16 v[152:155], a[76:79], v[88:91], v[152:155]
    v_mfma_f32_16x16x32_bf16 v[156:159], a[76:79], v[92:95], v[156:159]
    s_add_u32 s64, s25, 0x6400
    buffer_load_dwordx4 v[88:91], v1, s[4:7], s64 offen
    s_add_u32 s64, s25, 0x26400
    buffer_load_dwordx4 v[92:95], v1, s[4:7], s64 offen
    s_waitcnt vmcnt(30)
    v_mfma_f32_16x16x32_bf16 v[144:147], a[80:83], v[96:99], v[144:147]
    v_mfma_f32_16x16x32_bf16 v[148:151], a[80:83], v[100:103], v[148:151]
    v_mfma_f32_16x16x32_bf16 v[152:155], a[84:87], v[96:99], v[152:155]
    v_mfma_f32_16x16x32_bf16 v[156:159], a[84:87], v[100:103], v[156:159]
    s_add_u32 s64, s25, 0x6800
    buffer_load_dwordx4 v[96:99], v1, s[4:7], s64 offen
    s_add_u32 s64, s25, 0x26800
    buffer_load_dwordx4 v[100:103], v1, s[4:7], s64 offen
    s_waitcnt vmcnt(30)
    v_mfma_f32_16x16x32_bf16 v[144:147], a[88:91], v[104:107], v[144:147]
    v_mfma_f32_16x16x32_bf16 v[148:151], a[88:91], v[108:111], v[148:151]
    v_mfma_f32_16x16x32_bf16 v[152:155], a[92:95], v[104:107], v[152:155]
    v_mfma_f32_16x16x32_bf16 v[156:159], a[92:95], v[108:111], v[156:159]
    s_add_u32 s64, s25, 0x6c00
    buffer_load_dwordx4 v[104:107], v1, s[4:7], s64 offen
    s_add_u32 s64, s25, 0x26c00
    buffer_load_dwordx4 v[108:111], v1, s[4:7], s64 offen
    s_waitcnt vmcnt(30)
    v_mfma_f32_16x16x32_bf16 v[144:147], a[96:99], v[112:115], v[144:147]
    v_mfma_f32_16x16x32_bf16 v[148:151], a[96:99], v[116:119], v[148:151]
    v_mfma_f32_16x16x32_bf16 v[152:155], a[100:103], v[112:115], v[152:155]
    v_mfma_f32_16x16x32_bf16 v[156:159], a[100:103], v[116:119], v[156:159]
    s_add_u32 s64, s25, 0x7000
    buffer_load_dwordx4 v[112:115], v1, s[4:7], s64 offen
    s_add_u32 s64, s25, 0x27000
    buffer_load_dwordx4 v[116:119], v1, s[4:7], s64 offen
    s_waitcnt vmcnt(30)
    v_mfma_f32_16x16x32_bf16 v[144:147], a[104:107], v[120:123], v[144:147]
    v_mfma_f32_16x16x32_bf16 v[148:151], a[104:107], v[124:127], v[148:151]
    v_mfma_f32_16x16x32_bf16 v[152:155], a[108:111], v[120:123], v[152:155]
    v_mfma_f32_16x16x32_bf16 v[156:159], a[108:111], v[124:127], v[156:159]
    s_add_u32 s64, s25, 0x7400
    buffer_load_dwordx4 v[120:123], v1, s[4:7], s64 offen
    s_add_u32 s64, s25, 0x27400
    buffer_load_dwordx4 v[124:127], v1, s[4:7], s64 offen
    s_waitcnt vmcnt(30)
    v_mfma_f32_16x16x32_bf16 v[144:147], a[112:115], v[128:131], v[144:147]
    v_mfma_f32_16x16x32_bf16 v[148:151], a[112:115], v[132:135], v[148:151]
    v_mfma_f32_16x16x32_bf16 v[152:155], a[116:119], v[128:131], v[152:155]
    v_mfma_f32_16x16x32_bf16 v[156:159], a[116:119], v[132:135], v[156:159]
    s_add_u32 s64, s25, 0x7800
    buffer_load_dwordx4 v[128:131], v1, s[4:7], s64 offen
    s_add_u32 s64, s25, 0x27800
    buffer_load_dwordx4 v[132:135], v1, s[4:7], s64 offen
    s_waitcnt vmcnt(30)
    v_mfma_f32_16x16x32_bf16 v[144:147], a[120:123], v[136:139], v[144:147]
    v_mfma_f32_16x16x32_bf16 v[148:151], a[120:123], v[140:143], v[148:151]
    v_mfma_f32_16x16x32_bf16 v[152:155], a[124:127], v[136:139], v[152:155]
    v_mfma_f32_16x16x32_bf16 v[156:159], a[124:127], v[140:143], v[156:159]
    s_add_u32 s64, s25, 0x7c00
    buffer_load_dwordx4 v[136:139], v1, s[4:7], s64 offen
    s_add_u32 s64, s25, 0x27c00
    buffer_load_dwordx4 v[140:143], v1, s[4:7], s64 offen
    s_waitcnt vmcnt(30)
    v_mfma_f32_16x16x32_bf16 v[144:147], a[128:131], v[16:19], v[144:147]
    v_mfma_f32_16x16x32_bf16 v[148:151], a[128:131], v[20:23], v[148:151]
    v_mfma_f32_16x16x32_bf16 v[152:155], a[132:135], v[16:19], v[152:155]
    v_mfma_f32_16x16x32_bf16 v[156:159], a[132:135], v[20:23], v[156:159]
    s_waitcnt vmcnt(28)
    v_mfma_f32_16x16x32_bf16 v[144:147], a[136:139], v[24:27], v[144:147]
    v_mfma_f32_16x16x32_bf16 v[148:151], a[136:139], v[28:31], v[148:151]
    v_mfma_f32_16x16x32_bf16 v[152:155], a[140:143], v[24:27], v[152:155]
    v_mfma_f32_16x16x32_bf16 v[156:159], a[140:143], v[28:31], v[156:159]
    s_waitcnt vmcnt(26)
    v_mfma_f32_16x16x32_bf16 v[144:147], a[144:147], v[32:35], v[144:147]
    v_mfma_f32_16x16x32_bf16 v[148:151], a[144:147], v[36:39], v[148:151]
    v_mfma_f32_16x16x32_bf16 v[152:155], a[148:151], v[32:35], v[152:155]
    v_mfma_f32_16x16x32_bf16 v[156:159], a[148:151], v[36:39], v[156:159]
    s_waitcnt vmcnt(24)
    v_mfma_f32_16x16x32_bf16 v[144:147], a[152:155], v[40:43], v[144:147]
    v_mfma_f32_16x16x32_bf16 v[148:151], a[152:155], v[44:47], v[148:151]
    v_mfma_f32_16x16x32_bf16 v[152:155], a[156:159], v[40:43], v[152:155]
    v_mfma_f32_16x16x32_bf16 v[156:159], a[156:159], v[44:47], v[156:159]
    s_waitcnt vmcnt(22)
    v_mfma_f32_16x16x32_bf16 v[144:147], a[160:163], v[48:51], v[144:147]
    v_mfma_f32_16x16x32_bf16 v[148:151], a[160:163], v[52:55], v[148:151]
    v_mfma_f32_16x16x32_bf16 v[152:155], a[164:167], v[48:51], v[152:155]
    v_mfma_f32_16x16x32_bf16 v[156:159], a[164:167], v[52:55], v[156:159]
    s_waitcnt vmcnt(20)
    v_mfma_f32_16x16x32_bf16 v[144:147], a[168:171], v[56:59], v[144:147]
    v_mfma_f32_16x16x32_bf16 v[148:151], a[168:171], v[60:63], v[148:151]
    v_mfma_f32_16x16x32_bf16 v[152:155], a[172:175], v[56:59], v[152:155]
    v_mfma_f32_16x16x32_bf16 v[156:159], a[172:175], v[60:63], v[156:159]
    s_waitcnt vmcnt(18)
    v_mfma_f32_16x16x32_bf16 v[144:147], a[176:179], v[64:67], v[144:147]
    v_mfma_f32_16x16x32_bf16 v[148:151], a[176:179], v[68:71], v[148:151]
    v_mfma_f32_16x16x32_bf16 v[152:155], a[180:183], v[64:67], v[152:155]
    v_mfma_f32_16x16x32_bf16 v[156:159], a[180:183], v[68:71], v[156:159]
    s_waitcnt vmcnt(16)
    v_mfma_f32_16x16x32_bf16 v[144:147], a[184:187], v[72:75], v[144:147]
    v_mfma_f32_16x16x32_bf16 v[148:151], a[184:187], v[76:79], v[148:151]
    v_mfma_f32_16x16x32_bf16 v[152:155], a[188:191], v[72:75], v[152:155]
    v_mfma_f32_16x16x32_bf16 v[156:159], a[188:191], v[76:79], v[156:159]
    s_waitcnt vmcnt(14)
    v_mfma_f32_16x16x32_bf16 v[144:147], a[192:195], v[80:83], v[144:147]
    v_mfma_f32_16x16x32_bf16 v[148:151], a[192:195], v[84:87], v[148:151]
    v_mfma_f32_16x16x32_bf16 v[152:155], a[196:199], v[80:83], v[152:155]
    v_mfma_f32_16x16x32_bf16 v[156:159], a[196:199], v[84:87], v[156:159]
    s_waitcnt vmcnt(12)
    v_mfma_f32_16x16x32_bf16 v[144:147], a[200:203], v[88:91], v[144:147]
    v_mfma_f32_16x16x32_bf16 v[148:151], a[200:203], v[92:95], v[148:151]
    v_mfma_f32_16x16x32_bf16 v[152:155], a[204:207], v[88:91], v[152:155]
    v_mfma_f32_16x16x32_bf16 v[156:159], a[204:207], v[92:95], v[156:159]
    s_waitcnt vmcnt(10)
    v_mfma_f32_16x16x32_bf16 v[144:147], a[208:211], v[96:99], v[144:147]
    v_mfma_f32_16x16x32_bf16 v[148:151], a[208:211], v[100:103], v[148:151]
    v_mfma_f32_16x16x32_bf16 v[152:155], a[212:215], v[96:99], v[152:155]
    v_mfma_f32_16x16x32_bf16 v[156:159], a[212:215], v[100:103], v[156:159]
    s_waitcnt vmcnt(8)
    v_mfma_f32_16x16x32_bf16 v[144:147], a[216:219], v[104:107], v[144:147]
    v_mfma_f32_16x16x32_bf16 v[148:151], a[216:219], v[108:111], v[148:151]
    v_mfma_f32_16x16x32_bf16 v[152:155], a[220:223], v[104:107], v[152:155]
    v_mfma_f32_16x16x32_bf16 v[156:159], a[220:223], v[108:111], v[156:159]
    s_waitcnt vmcnt(6)
    v_mfma_f32_16x16x32_bf16 v[144:147], a[224:227], v[112:115], v[144:147]
    v_mfma_f32_16x16x32_bf16 v[148:151], a[224:227], v[116:119], v[148:151]
    v_mfma_f32_16x16x32_bf16 v[152:155], a[228:231], v[112:115], v[152:155]
    v_mfma_f32_16x16x32_bf16 v[156:159], a[228:231], v[116:119], v[156:159]
    s_waitcnt vmcnt(4)
    v_mfma_f32_16x16x32_bf16 v[144:147], a[232:235], v[120:123], v[144:147]
    v_mfma_f32_16x16x32_bf16 v[148:151], a[232:235], v[124:127], v[148:151]
    v_mfma_f32_16x16x32_bf16 v[152:155], a[236:239], v[120:123], v[152:155]
    v_mfma_f32_16x16x32_bf16 v[156:159], a[236:239], v[124:127], v[156:159]
    s_waitcnt vmcnt(2)
    v_mfma_f32_16x16x32_bf16 v[144:147], a[240:243], v[128:131], v[144:147]
    v_mfma_f32_16x16x32_bf16 v[148:151], a[240:243], v[132:135], v[148:151]
    v_mfma_f32_16x16x32_bf16 v[152:155], a[244:247], v[128:131], v[152:155]
    v_mfma_f32_16x16x32_bf16 v[156:159], a[244:247], v[132:135], v[156:159]
    s_waitcnt vmcnt(0)
    v_mfma_f32_16x16x32_bf16 v[144:147], a[248:251], v[136:139], v[144:147]
    v_mfma_f32_16x16x32_bf16 v[148:151], a[248:251], v[140:143], v[148:151]
    v_mfma_f32_16x16x32_bf16 v[152:155], a[252:255], v[136:139], v[152:155]
    v_mfma_f32_16x16x32_bf16 v[156:159], a[252:255], v[140:143], v[156:159]
    s_lshl_b32 s64, s14, 12
    v_add_u32 v7, s64, v1
    s_barrier
    s_nop 3
    ds_write_b128 v7, v[144:147] offset:0
    ds_write_b128 v7, v[148:151] offset:1024
    ds_write_b128 v7, v[152:155] offset:2048
    ds_write_b128 v7, v[156:159] offset:3072
    v_mov_b32 v13, 16384
    s_cmp_lg_u32 s14, 0
    s_cbranch_scc1 OW0_139
    ds_write_b32 v13, v12
OW0_139:
    s_waitcnt lgkmcnt(0)
    s_barrier
    ds_read_b32 v12, v13
    s_waitcnt lgkmcnt(0)
    v_readfirstlane_b32 s64, v12
    s_cmp_lt_u32 s64, 40
    s_cselect_b64 s[82:83], s[82:83], 0
    s_lshl_b32 s64, s14, 10
    v_add_u32 v7, s64, v1
    ds_read_b128 v[16:19], v7 offset:0
    ds_read_b128 v[20:23], v7 offset:4096
    ds_read_b128 v[24:27], v7 offset:8192
    ds_read_b128 v[28:31], v7 offset:12288
    s_waitcnt lgkmcnt(0)
    v_add_f32 v16, v16, v20
    v_add_f32 v24, v24, v28
    v_add_f32 v16, v16, v24
    v_add_f32 v17, v17, v21
    v_add_f32 v25, v25, v29
    v_add_f32 v17, v17, v25
    v_add_f32 v18, v18, v22
    v_add_f32 v26, v26, v30
    v_add_f32 v18, v18, v26
    v_add_f32 v19, v19, v23
    v_add_f32 v27, v27, v31
    v_add_f32 v19, v19, v27
    v_cvt_pk_bf16_f32 v16, v16, v16
    v_lshlrev_b32 v16, 16, v16
    v_cvt_pk_bf16_f32 v17, v17, v17
    v_lshlrev_b32 v17, 16, v17
    v_cvt_pk_bf16_f32 v18, v18, v18
    v_lshlrev_b32 v18, 16, v18
    v_cvt_pk_bf16_f32 v19, v19, v19
    v_lshlrev_b32 v19, 16, v19
    v_lshlrev_b32 v20, 16, v162
    v_and_b32 v21, 0xffff0000, v162
    v_lshlrev_b32 v24, 16, v160
    v_and_b32 v25, 0xffff0000, v160
    v_lshlrev_b32 v22, 16, v163
    v_and_b32 v23, 0xffff0000, v163
    v_lshlrev_b32 v26, 16, v161
    v_and_b32 v27, 0xffff0000, v161
    s_lshl_b32 s64, s24, 5
    v_add_u32 v8, s64, v9
    v_mov_b32 v10, -1
    v_cmp_eq_u32 vcc, s72, v8
    s_nop 1
    v_cndmask_b32 v10, v10, 0, vcc
    v_cmp_eq_u32 vcc, s73, v8
    s_nop 1
    v_cndmask_b32 v10, v10, 1, vcc
    v_cmp_eq_u32 vcc, s74, v8
    s_nop 1
    v_cndmask_b32 v10, v10, 2, vcc
    v_cmp_eq_u32 vcc, s75, v8
    s_nop 1
    v_cndmask_b32 v10, v10, 3, vcc
    v_cmp_eq_u32 vcc, s76, v8
    s_nop 1
    v_cndmask_b32 v10, v10, 4, vcc
    v_cmp_eq_u32 vcc, s77, v8
    s_nop 1
    v_cndmask_b32 v10, v10, 5, vcc
    v_cmp_eq_u32 vcc, s78, v8
    s_nop 1
    v_cndmask_b32 v10, v10, 6, vcc
    v_cmp_eq_u32 vcc, s79, v8
    s_nop 1
    v_cndmask_b32 v10, v10, 7, vcc
    v_cmp_le_i32 vcc, 0, v10
    s_and_saveexec_b64 s[68:69], vcc
    s_cbranch_execz NOUPD_141
    v_mul_u32_u24 v10, 2560, v10
    v_lshrrev_b32 v11, 4, v0
    v_lshl_add_u32 v10, v11, 4, v10
    s_lshl_b32 s64, s86, 6
    s_lshl_b32 s65, s13, 7
    s_add_u32 s64, s64, s65
    s_add_u32 s64, s64, 0x5410000
    buffer_load_dwordx4 v[164:167], v10, s[4:7], s64 offen sc1
    s_waitcnt vmcnt(0)
    v_add_f32 v20, v20, v164
    v_cvt_pk_bf16_f32 v20, v20, v20
    v_lshlrev_b32 v20, 16, v20
    v_add_f32 v21, v21, v165
    v_cvt_pk_bf16_f32 v21, v21, v21
    v_lshlrev_b32 v21, 16, v21
    v_add_f32 v22, v22, v166
    v_cvt_pk_bf16_f32 v22, v22, v22
    v_lshlrev_b32 v22, 16, v22
    v_add_f32 v23, v23, v167
    v_cvt_pk_bf16_f32 v23, v23, v23
    v_lshlrev_b32 v23, 16, v23
NOUPD_141:
    s_mov_b64 exec, -1
    v_mul_f32 v28, 0xbfb8aa3b, v20
    v_exp_f32 v28, v28
    s_nop 0
    v_add_f32 v28, 1.0, v28
    v_rcp_f32 v28, v28
    s_nop 0
    v_mul_f32 v28, v28, v20
    v_cvt_pk_bf16_f32 v28, v28, v28
    v_lshlrev_b32 v28, 16, v28
    v_mul_f32 v28, v28, v16
    v_cvt_pk_bf16_f32 v28, v28, v28
    v_lshlrev_b32 v28, 16, v28
    v_add_f32 v28, v28, v24
    v_mul_f32 v29, 0xbfb8aa3b, v21
    v_exp_f32 v29, v29
    s_nop 0
    v_add_f32 v29, 1.0, v29
    v_rcp_f32 v29, v29
    s_nop 0
    v_mul_f32 v29, v29, v21
    v_cvt_pk_bf16_f32 v29, v29, v29
    v_lshlrev_b32 v29, 16, v29
    v_mul_f32 v29, v29, v17
    v_cvt_pk_bf16_f32 v29, v29, v29
    v_lshlrev_b32 v29, 16, v29
    v_add_f32 v29, v29, v25
    v_mul_f32 v30, 0xbfb8aa3b, v22
    v_exp_f32 v30, v30
    s_nop 0
    v_add_f32 v30, 1.0, v30
    v_rcp_f32 v30, v30
    s_nop 0
    v_mul_f32 v30, v30, v22
    v_cvt_pk_bf16_f32 v30, v30, v30
    v_lshlrev_b32 v30, 16, v30
    v_mul_f32 v30, v30, v18
    v_cvt_pk_bf16_f32 v30, v30, v30
    v_lshlrev_b32 v30, 16, v30
    v_add_f32 v30, v30, v26
    v_mul_f32 v31, 0xbfb8aa3b, v23
    v_exp_f32 v31, v31
    s_nop 0
    v_add_f32 v31, 1.0, v31
    v_rcp_f32 v31, v31
    s_nop 0
    v_mul_f32 v31, v31, v23
    v_cvt_pk_bf16_f32 v31, v31, v31
    v_lshlrev_b32 v31, 16, v31
    v_mul_f32 v31, v31, v19
    v_cvt_pk_bf16_f32 v31, v31, v31
    v_lshlrev_b32 v31, 16, v31
    v_add_f32 v31, v31, v27
    v_cvt_pk_bf16_f32 v164, v28, v29
    v_cvt_pk_bf16_f32 v165, v30, v31
    buffer_store_dwordx2 v[164:165], v5, s[52:55], s67 offen
OTD_140:
    s_branch OU_LOOP
OU_END:
    s_cmp_lg_u32 s12, 2
    s_cbranch_scc1 OU_X
    v_mov_b32 v8, 0
    s_mov_b32 s64, 0x298100
OUW_142:
    buffer_load_dword v7, v8, s[4:7], s64 offen sc1
    s_add_u32 s29, s29, 1
    s_waitcnt vmcnt(0)
    v_cmp_gt_u32 vcc, 40, v7
    s_cbranch_vccz OUWD_143
    s_cmp_gt_u32 s29, 262144
    s_cbranch_scc1 OUWD_143
    s_sleep 8
    s_branch OUW_142
OUWD_143:
    s_mov_b32 s24, 62
    s_mov_b32 s87, 0
    s_and_b32 s86, s14, 1
    s_lshl_b32 s64, s87, 4
    v_and_b32 v6, 15, v0
    v_add_u32 v6, s64, v6
    v_mov_b32 v9, v6
    v_mul_u32_u24 v5, 1280, v6
    v_lshrrev_b32 v6, 4, v0
    v_lshl_add_u32 v5, v6, 3, v5
    s_and_b32 s64, s14, 1
    s_lshl_b32 s64, s64, 5
    s_lshl_b32 s65, s13, 6
    s_add_u32 s64, s64, s65
    v_add_u32 v5, s64, v5
    v_lshlrev_b32 v6, 2, v0
    s_mul_i32 s67, s24, 40960
    buffer_load_dwordx2 v[160:161], v5, s[48:51], s67 offen
    s_add_u32 s64, s67, 0x0
    buffer_load_dwordx2 v[162:163], v5, s[4:7], s64 offen
    s_lshl_b32 s64, s24, 7
    s_add_u32 s64, s64, 0x296000
    s_mov_b64 exec, s[36:37]
OUH_F_144:
    buffer_load_dword v7, v6, s[4:7], s64 offen sc1
    s_add_u32 s29, s29, 1
    s_waitcnt vmcnt(0)
    v_cmp_eq_u32 vcc, 0, v7
    s_cbranch_vccz OUH_FD_145
    s_cmp_gt_u32 s29, 262144
    s_cbranch_scc1 OUH_FD_145
    s_sleep 1
    s_branch OUH_F_144
OUH_FD_145:
    s_mov_b64 exec, -1
    s_lshl_b32 s25, s24, 18
    s_lshl_b32 s64, s14, 15
    s_add_u32 s25, s25, s64
    s_add_u32 s25, s25, 0x4400000
    s_lshl_b32 s64, s87, 17
    s_add_u32 s25, s25, s64
    s_add_u32 s64, s25, 0x0
    buffer_load_dwordx4 v[16:19], v1, s[4:7], s64 offen
    s_add_u32 s64, s25, 0x400
    buffer_load_dwordx4 v[20:23], v1, s[4:7], s64 offen
    s_add_u32 s64, s25, 0x800
    buffer_load_dwordx4 v[24:27], v1, s[4:7], s64 offen
    s_add_u32 s64, s25, 0xc00
    buffer_load_dwordx4 v[28:31], v1, s[4:7], s64 offen
    s_add_u32 s64, s25, 0x1000
    buffer_load_dwordx4 v[32:35], v1, s[4:7], s64 offen
    s_add_u32 s64, s25, 0x1400
    buffer_load_dwordx4 v[36:39], v1, s[4:7], s64 offen
    s_add_u32 s64, s25, 0x1800
    buffer_load_dwordx4 v[40:43], v1, s[4:7], s64 offen
    s_add_u32 s64, s25, 0x1c00
    buffer_load_dwordx4 v[44:47], v1, s[4:7], s64 offen
    s_add_u32 s64, s25, 0x2000
    buffer_load_dwordx4 v[48:51], v1, s[4:7], s64 offen
    s_add_u32 s64, s25, 0x2400
    buffer_load_dwordx4 v[52:55], v1, s[4:7], s64 offen
    s_add_u32 s64, s25, 0x2800
    buffer_load_dwordx4 v[56:59], v1, s[4:7], s64 offen
    s_add_u32 s64, s25, 0x2c00
    buffer_load_dwordx4 v[60:63], v1, s[4:7], s64 offen
    s_add_u32 s64, s25, 0x3000
    buffer_load_dwordx4 v[64:67], v1, s[4:7], s64 offen
    s_add_u32 s64, s25, 0x3400
    buffer_load_dwordx4 v[68:71], v1, s[4:7], s64 offen
    s_add_u32 s64, s25, 0x3800
    buffer_load_dwordx4 v[72:75], v1, s[4:7], s64 offen
    s_add_u32 s64, s25, 0x3c00
    buffer_load_dwordx4 v[76:79], v1, s[4:7], s64 offen
    s_add_u32 s64, s25, 0x4000
    buffer_load_dwordx4 v[80:83], v1, s[4:7], s64 offen
    s_add_u32 s64, s25, 0x4400
    buffer_load_dwordx4 v[84:87], v1, s[4:7], s64 offen
    s_add_u32 s64, s25, 0x4800
    buffer_load_dwordx4 v[88:91], v1, s[4:7], s64 offen
    s_add_u32 s64, s25, 0x4c00
    buffer_load_dwordx4 v[92:95], v1, s[4:7], s64 offen
    s_add_u32 s64, s25, 0x5000
    buffer_load_dwordx4 v[96:99], v1, s[4:7], s64 offen
    s_add_u32 s64, s25, 0x5400
    buffer_load_dwordx4 v[100:103], v1, s[4:7], s64 offen
    s_add_u32 s64, s25, 0x5800
    buffer_load_dwordx4 v[104:107], v1, s[4:7], s64 offen
    s_add_u32 s64, s25, 0x5c00
    buffer_load_dwordx4 v[108:111], v1, s[4:7], s64 offen
    s_add_u32 s64, s25, 0x6000
    buffer_load_dwordx4 v[112:115], v1, s[4:7], s64 offen
    s_add_u32 s64, s25, 0x6400
    buffer_load_dwordx4 v[116:119], v1, s[4:7], s64 offen
    s_add_u32 s64, s25, 0x6800
    buffer_load_dwordx4 v[120:123], v1, s[4:7], s64 offen
    s_add_u32 s64, s25, 0x6c00
    buffer_load_dwordx4 v[124:127], v1, s[4:7], s64 offen
    s_add_u32 s64, s25, 0x7000
    buffer_load_dwordx4 v[128:131], v1, s[4:7], s64 offen
    s_add_u32 s64, s25, 0x7400
    buffer_load_dwordx4 v[132:135], v1, s[4:7], s64 offen
    s_add_u32 s64, s25, 0x7800
    buffer_load_dwordx4 v[136:139], v1, s[4:7], s64 offen
    s_add_u32 s64, s25, 0x7c00
    buffer_load_dwordx4 v[140:143], v1, s[4:7], s64 offen
    s_waitcnt vmcnt(31)
    v_mfma_f32_16x16x32_bf16 v[144:147], a[0:3], v[16:19], 0
    v_mfma_f32_16x16x32_bf16 v[148:151], a[4:7], v[16:19], 0
    s_waitcnt vmcnt(30)
    v_mfma_f32_16x16x32_bf16 v[144:147], a[8:11], v[20:23], v[144:147]
    v_mfma_f32_16x16x32_bf16 v[148:151], a[12:15], v[20:23], v[148:151]
    s_waitcnt vmcnt(29)
    v_mfma_f32_16x16x32_bf16 v[144:147], a[16:19], v[24:27], v[144:147]
    v_mfma_f32_16x16x32_bf16 v[148:151], a[20:23], v[24:27], v[148:151]
    s_waitcnt vmcnt(28)
    v_mfma_f32_16x16x32_bf16 v[144:147], a[24:27], v[28:31], v[144:147]
    v_mfma_f32_16x16x32_bf16 v[148:151], a[28:31], v[28:31], v[148:151]
    s_waitcnt vmcnt(27)
    v_mfma_f32_16x16x32_bf16 v[144:147], a[32:35], v[32:35], v[144:147]
    v_mfma_f32_16x16x32_bf16 v[148:151], a[36:39], v[32:35], v[148:151]
    s_waitcnt vmcnt(26)
    v_mfma_f32_16x16x32_bf16 v[144:147], a[40:43], v[36:39], v[144:147]
    v_mfma_f32_16x16x32_bf16 v[148:151], a[44:47], v[36:39], v[148:151]
    s_waitcnt vmcnt(25)
    v_mfma_f32_16x16x32_bf16 v[144:147], a[48:51], v[40:43], v[144:147]
    v_mfma_f32_16x16x32_bf16 v[148:151], a[52:55], v[40:43], v[148:151]
    s_waitcnt vmcnt(24)
    v_mfma_f32_16x16x32_bf16 v[144:147], a[56:59], v[44:47], v[144:147]
    v_mfma_f32_16x16x32_bf16 v[148:151], a[60:63], v[44:47], v[148:151]
    s_waitcnt vmcnt(23)
    v_mfma_f32_16x16x32_bf16 v[144:147], a[64:67], v[48:51], v[144:147]
    v_mfma_f32_16x16x32_bf16 v[148:151], a[68:71], v[48:51], v[148:151]
    s_waitcnt vmcnt(22)
    v_mfma_f32_16x16x32_bf16 v[144:147], a[72:75], v[52:55], v[144:147]
    v_mfma_f32_16x16x32_bf16 v[148:151], a[76:79], v[52:55], v[148:151]
    s_waitcnt vmcnt(21)
    v_mfma_f32_16x16x32_bf16 v[144:147], a[80:83], v[56:59], v[144:147]
    v_mfma_f32_16x16x32_bf16 v[148:151], a[84:87], v[56:59], v[148:151]
    s_waitcnt vmcnt(20)
    v_mfma_f32_16x16x32_bf16 v[144:147], a[88:91], v[60:63], v[144:147]
    v_mfma_f32_16x16x32_bf16 v[148:151], a[92:95], v[60:63], v[148:151]
    s_waitcnt vmcnt(19)
    v_mfma_f32_16x16x32_bf16 v[144:147], a[96:99], v[64:67], v[144:147]
    v_mfma_f32_16x16x32_bf16 v[148:151], a[100:103], v[64:67], v[148:151]
    s_waitcnt vmcnt(18)
    v_mfma_f32_16x16x32_bf16 v[144:147], a[104:107], v[68:71], v[144:147]
    v_mfma_f32_16x16x32_bf16 v[148:151], a[108:111], v[68:71], v[148:151]
    s_waitcnt vmcnt(17)
    v_mfma_f32_16x16x32_bf16 v[144:147], a[112:115], v[72:75], v[144:147]
    v_mfma_f32_16x16x32_bf16 v[148:151], a[116:119], v[72:75], v[148:151]
    s_waitcnt vmcnt(16)
    v_mfma_f32_16x16x32_bf16 v[144:147], a[120:123], v[76:79], v[144:147]
    v_mfma_f32_16x16x32_bf16 v[148:151], a[124:127], v[76:79], v[148:151]
    s_waitcnt vmcnt(15)
    v_mfma_f32_16x16x32_bf16 v[144:147], a[128:131], v[80:83], v[144:147]
    v_mfma_f32_16x16x32_bf16 v[148:151], a[132:135], v[80:83], v[148:151]
    s_waitcnt vmcnt(14)
    v_mfma_f32_16x16x32_bf16 v[144:147], a[136:139], v[84:87], v[144:147]
    v_mfma_f32_16x16x32_bf16 v[148:151], a[140:143], v[84:87], v[148:151]
    s_waitcnt vmcnt(13)
    v_mfma_f32_16x16x32_bf16 v[144:147], a[144:147], v[88:91], v[144:147]
    v_mfma_f32_16x16x32_bf16 v[148:151], a[148:151], v[88:91], v[148:151]
    s_waitcnt vmcnt(12)
    v_mfma_f32_16x16x32_bf16 v[144:147], a[152:155], v[92:95], v[144:147]
    v_mfma_f32_16x16x32_bf16 v[148:151], a[156:159], v[92:95], v[148:151]
    s_waitcnt vmcnt(11)
    v_mfma_f32_16x16x32_bf16 v[144:147], a[160:163], v[96:99], v[144:147]
    v_mfma_f32_16x16x32_bf16 v[148:151], a[164:167], v[96:99], v[148:151]
    s_waitcnt vmcnt(10)
    v_mfma_f32_16x16x32_bf16 v[144:147], a[168:171], v[100:103], v[144:147]
    v_mfma_f32_16x16x32_bf16 v[148:151], a[172:175], v[100:103], v[148:151]
    s_waitcnt vmcnt(9)
    v_mfma_f32_16x16x32_bf16 v[144:147], a[176:179], v[104:107], v[144:147]
    v_mfma_f32_16x16x32_bf16 v[148:151], a[180:183], v[104:107], v[148:151]
    s_waitcnt vmcnt(8)
    v_mfma_f32_16x16x32_bf16 v[144:147], a[184:187], v[108:111], v[144:147]
    v_mfma_f32_16x16x32_bf16 v[148:151], a[188:191], v[108:111], v[148:151]
    s_waitcnt vmcnt(7)
    v_mfma_f32_16x16x32_bf16 v[144:147], a[192:195], v[112:115], v[144:147]
    v_mfma_f32_16x16x32_bf16 v[148:151], a[196:199], v[112:115], v[148:151]
    s_waitcnt vmcnt(6)
    v_mfma_f32_16x16x32_bf16 v[144:147], a[200:203], v[116:119], v[144:147]
    v_mfma_f32_16x16x32_bf16 v[148:151], a[204:207], v[116:119], v[148:151]
    s_waitcnt vmcnt(5)
    v_mfma_f32_16x16x32_bf16 v[144:147], a[208:211], v[120:123], v[144:147]
    v_mfma_f32_16x16x32_bf16 v[148:151], a[212:215], v[120:123], v[148:151]
    s_waitcnt vmcnt(4)
    v_mfma_f32_16x16x32_bf16 v[144:147], a[216:219], v[124:127], v[144:147]
    v_mfma_f32_16x16x32_bf16 v[148:151], a[220:223], v[124:127], v[148:151]
    s_waitcnt vmcnt(3)
    v_mfma_f32_16x16x32_bf16 v[144:147], a[224:227], v[128:131], v[144:147]
    v_mfma_f32_16x16x32_bf16 v[148:151], a[228:231], v[128:131], v[148:151]
    s_waitcnt vmcnt(2)
    v_mfma_f32_16x16x32_bf16 v[144:147], a[232:235], v[132:135], v[144:147]
    v_mfma_f32_16x16x32_bf16 v[148:151], a[236:239], v[132:135], v[148:151]
    s_waitcnt vmcnt(1)
    v_mfma_f32_16x16x32_bf16 v[144:147], a[240:243], v[136:139], v[144:147]
    v_mfma_f32_16x16x32_bf16 v[148:151], a[244:247], v[136:139], v[148:151]
    s_waitcnt vmcnt(0)
    v_mfma_f32_16x16x32_bf16 v[144:147], a[248:251], v[140:143], v[144:147]
    v_mfma_f32_16x16x32_bf16 v[148:151], a[252:255], v[140:143], v[148:151]
    s_lshl_b32 s64, s14, 12
    v_add_u32 v7, s64, v1
    s_barrier
    s_nop 3
    ds_write_b128 v7, v[144:147] offset:0
    ds_write_b128 v7, v[148:151] offset:1024
    s_waitcnt lgkmcnt(0)
    s_barrier
    s_cmp_ge_u32 s14, 2
    s_cbranch_scc1 OTD_146
    s_lshl_b32 s64, s14, 10
    v_add_u32 v7, s64, v1
    ds_read_b128 v[16:19], v7 offset:0
    ds_read_b128 v[20:23], v7 offset:4096
    ds_read_b128 v[24:27], v7 offset:8192
    ds_read_b128 v[28:31], v7 offset:12288
    s_waitcnt lgkmcnt(0)
    v_add_f32 v16, v16, v20
    v_add_f32 v24, v24, v28
    v_add_f32 v16, v16, v24
    v_add_f32 v17, v17, v21
    v_add_f32 v25, v25, v29
    v_add_f32 v17, v17, v25
    v_add_f32 v18, v18, v22
    v_add_f32 v26, v26, v30
    v_add_f32 v18, v18, v26
    v_add_f32 v19, v19, v23
    v_add_f32 v27, v27, v31
    v_add_f32 v19, v19, v27
    v_cvt_pk_bf16_f32 v16, v16, v16
    v_lshlrev_b32 v16, 16, v16
    v_cvt_pk_bf16_f32 v17, v17, v17
    v_lshlrev_b32 v17, 16, v17
    v_cvt_pk_bf16_f32 v18, v18, v18
    v_lshlrev_b32 v18, 16, v18
    v_cvt_pk_bf16_f32 v19, v19, v19
    v_lshlrev_b32 v19, 16, v19
    v_lshlrev_b32 v20, 16, v162
    v_and_b32 v21, 0xffff0000, v162
    v_lshlrev_b32 v24, 16, v160
    v_and_b32 v25, 0xffff0000, v160
    v_lshlrev_b32 v22, 16, v163
    v_and_b32 v23, 0xffff0000, v163
    v_lshlrev_b32 v26, 16, v161
    v_and_b32 v27, 0xffff0000, v161
    s_lshl_b32 s64, s24, 5
    v_add_u32 v8, s64, v9
    v_mov_b32 v10, -1
    v_cmp_eq_u32 vcc, s72, v8
    s_nop 1
    v_cndmask_b32 v10, v10, 0, vcc
    v_cmp_eq_u32 vcc, s73, v8
    s_nop 1
    v_cndmask_b32 v10, v10, 1, vcc
    v_cmp_eq_u32 vcc, s74, v8
    s_nop 1
    v_cndmask_b32 v10, v10, 2, vcc
    v_cmp_eq_u32 vcc, s75, v8
    s_nop 1
    v_cndmask_b32 v10, v10, 3, vcc
    v_cmp_eq_u32 vcc, s76, v8
    s_nop 1
    v_cndmask_b32 v10, v10, 4, vcc
    v_cmp_eq_u32 vcc, s77, v8
    s_nop 1
    v_cndmask_b32 v10, v10, 5, vcc
    v_cmp_eq_u32 vcc, s78, v8
    s_nop 1
    v_cndmask_b32 v10, v10, 6, vcc
    v_cmp_eq_u32 vcc, s79, v8
    s_nop 1
    v_cndmask_b32 v10, v10, 7, vcc
    v_cmp_le_i32 vcc, 0, v10
    s_and_saveexec_b64 s[68:69], vcc
    s_cbranch_execz NOUPD_147
    v_mul_u32_u24 v10, 2560, v10
    v_lshrrev_b32 v11, 4, v0
    v_lshl_add_u32 v10, v11, 4, v10
    s_lshl_b32 s64, s86, 6
    s_lshl_b32 s65, s13, 7
    s_add_u32 s64, s64, s65
    s_add_u32 s64, s64, 0x5410000
    buffer_load_dwordx4 v[164:167], v10, s[4:7], s64 offen sc1
    s_waitcnt vmcnt(0)
    v_add_f32 v20, v20, v164
    v_cvt_pk_bf16_f32 v20, v20, v20
    v_lshlrev_b32 v20, 16, v20
    v_add_f32 v21, v21, v165
    v_cvt_pk_bf16_f32 v21, v21, v21
    v_lshlrev_b32 v21, 16, v21
    v_add_f32 v22, v22, v166
    v_cvt_pk_bf16_f32 v22, v22, v22
    v_lshlrev_b32 v22, 16, v22
    v_add_f32 v23, v23, v167
    v_cvt_pk_bf16_f32 v23, v23, v23
    v_lshlrev_b32 v23, 16, v23
NOUPD_147:
    s_mov_b64 exec, -1
    v_mul_f32 v28, 0xbfb8aa3b, v20
    v_exp_f32 v28, v28
    s_nop 0
    v_add_f32 v28, 1.0, v28
    v_rcp_f32 v28, v28
    s_nop 0
    v_mul_f32 v28, v28, v20
    v_cvt_pk_bf16_f32 v28, v28, v28
    v_lshlrev_b32 v28, 16, v28
    v_mul_f32 v28, v28, v16
    v_cvt_pk_bf16_f32 v28, v28, v28
    v_lshlrev_b32 v28, 16, v28
    v_add_f32 v28, v28, v24
    v_mul_f32 v29, 0xbfb8aa3b, v21
    v_exp_f32 v29, v29
    s_nop 0
    v_add_f32 v29, 1.0, v29
    v_rcp_f32 v29, v29
    s_nop 0
    v_mul_f32 v29, v29, v21
    v_cvt_pk_bf16_f32 v29, v29, v29
    v_lshlrev_b32 v29, 16, v29
    v_mul_f32 v29, v29, v17
    v_cvt_pk_bf16_f32 v29, v29, v29
    v_lshlrev_b32 v29, 16, v29
    v_add_f32 v29, v29, v25
    v_mul_f32 v30, 0xbfb8aa3b, v22
    v_exp_f32 v30, v30
    s_nop 0
    v_add_f32 v30, 1.0, v30
    v_rcp_f32 v30, v30
    s_nop 0
    v_mul_f32 v30, v30, v22
    v_cvt_pk_bf16_f32 v30, v30, v30
    v_lshlrev_b32 v30, 16, v30
    v_mul_f32 v30, v30, v18
    v_cvt_pk_bf16_f32 v30, v30, v30
    v_lshlrev_b32 v30, 16, v30
    v_add_f32 v30, v30, v26
    v_mul_f32 v31, 0xbfb8aa3b, v23
    v_exp_f32 v31, v31
    s_nop 0
    v_add_f32 v31, 1.0, v31
    v_rcp_f32 v31, v31
    s_nop 0
    v_mul_f32 v31, v31, v23
    v_cvt_pk_bf16_f32 v31, v31, v31
    v_lshlrev_b32 v31, 16, v31
    v_mul_f32 v31, v31, v19
    v_cvt_pk_bf16_f32 v31, v31, v31
    v_lshlrev_b32 v31, 16, v31
    v_add_f32 v31, v31, v27
    v_cvt_pk_bf16_f32 v164, v28, v29
    v_cvt_pk_bf16_f32 v165, v30, v31
    buffer_store_dwordx2 v[164:165], v5, s[52:55], s67 offen
OTD_146:
OU_X:
    s_branch M_EXIT
H_EXTRA:
    s_mul_hi_u32 s12, s88, 0xccccccd
    s_mul_i32 s65, s12, 20
    s_sub_u32 s13, s88, s65
    s_add_u32 s12, s12, 3
    s_load_dwordx2 s[48:49], s[0:1], 0
    s_mov_b32 s50, 0x280000
    s_mov_b32 s51, 0x00020000
    s_load_dwordx2 s[52:53], s[0:1], 96
    s_mov_b32 s54, 0x280000
    s_mov_b32 s55, 0x00020000
    s_mov_b32 s36, -1
    s_mov_b32 s37, 0
    s_waitcnt lgkmcnt(0)
    v_mbcnt_lo_u32_b32 v0, -1, 0
    v_mbcnt_hi_u32_b32 v0, -1, v0
    s_mov_b32 s29, 0
    v_lshlrev_b32 v1, 4, v0
    v_lshlrev_b32 v6, 2, v0
    v_mov_b32 v8, 0
    s_mov_b32 s64, 0x298100
OXW_148:
    buffer_load_dword v7, v8, s[4:7], s64 offen sc1
    s_add_u32 s29, s29, 1
    s_waitcnt vmcnt(0)
    v_cmp_gt_u32 vcc, 40, v7
    s_cbranch_vccz OXWD_149
    s_cmp_gt_u32 s29, 262144
    s_cbranch_scc1 OXWD_149
    s_sleep 8
    s_branch OXW_148
OXWD_149:
    v_lshlrev_b32 v6, 2, v0
    s_mov_b32 s64, 0x5400000
    buffer_load_dword v7, v6, s[4:7], s64 offen sc1
    s_waitcnt vmcnt(0)
    v_readlane_b32 s72, v7, 0
    v_readlane_b32 s73, v7, 1
    v_readlane_b32 s74, v7, 2
    v_readlane_b32 s75, v7, 3
    v_readlane_b32 s76, v7, 4
    v_readlane_b32 s77, v7, 5
    v_readlane_b32 s78, v7, 6
    v_readlane_b32 s79, v7, 7
    s_cmp_eq_u32 s12, 3
    s_cselect_b32 s24, 62, 63
    s_cmp_eq_u32 s12, 4
    s_cselect_b32 s87, 0, 1
    s_and_b32 s86, s14, 1
    s_lshl_b32 s64, s87, 4
    v_and_b32 v6, 15, v0
    v_add_u32 v6, s64, v6
    v_mov_b32 v9, v6
    v_mul_u32_u24 v5, 1280, v6
    v_lshrrev_b32 v6, 4, v0
    v_lshl_add_u32 v5, v6, 3, v5
    s_and_b32 s64, s14, 1
    s_lshl_b32 s64, s64, 5
    s_lshl_b32 s65, s13, 6
    s_add_u32 s64, s64, s65
    v_add_u32 v5, s64, v5
    v_lshlrev_b32 v6, 2, v0
    s_mul_i32 s67, s24, 40960
    buffer_load_dwordx2 v[160:161], v5, s[48:51], s67 offen
    s_add_u32 s64, s67, 0x0
    buffer_load_dwordx2 v[162:163], v5, s[4:7], s64 offen
    s_lshl_b32 s64, s24, 7
    s_add_u32 s64, s64, 0x296000
    s_mov_b64 exec, s[36:37]
OX_F_150:
    buffer_load_dword v7, v6, s[4:7], s64 offen sc1
    s_add_u32 s29, s29, 1
    s_waitcnt vmcnt(0)
    v_cmp_eq_u32 vcc, 0, v7
    s_cbranch_vccz OX_FD_151
    s_cmp_gt_u32 s29, 262144
    s_cbranch_scc1 OX_FD_151
    s_sleep 1
    s_branch OX_F_150
OX_FD_151:
    s_mov_b64 exec, -1
    s_lshl_b32 s25, s24, 18
    s_lshl_b32 s64, s14, 15
    s_add_u32 s25, s25, s64
    s_add_u32 s25, s25, 0x4400000
    s_lshl_b32 s64, s87, 17
    s_add_u32 s25, s25, s64
    s_add_u32 s64, s25, 0x0
    buffer_load_dwordx4 v[16:19], v1, s[4:7], s64 offen
    s_add_u32 s64, s25, 0x400
    buffer_load_dwordx4 v[20:23], v1, s[4:7], s64 offen
    s_add_u32 s64, s25, 0x800
    buffer_load_dwordx4 v[24:27], v1, s[4:7], s64 offen
    s_add_u32 s64, s25, 0xc00
    buffer_load_dwordx4 v[28:31], v1, s[4:7], s64 offen
    s_add_u32 s64, s25, 0x1000
    buffer_load_dwordx4 v[32:35], v1, s[4:7], s64 offen
    s_add_u32 s64, s25, 0x1400
    buffer_load_dwordx4 v[36:39], v1, s[4:7], s64 offen
    s_add_u32 s64, s25, 0x1800
    buffer_load_dwordx4 v[40:43], v1, s[4:7], s64 offen
    s_add_u32 s64, s25, 0x1c00
    buffer_load_dwordx4 v[44:47], v1, s[4:7], s64 offen
    s_add_u32 s64, s25, 0x2000
    buffer_load_dwordx4 v[48:51], v1, s[4:7], s64 offen
    s_add_u32 s64, s25, 0x2400
    buffer_load_dwordx4 v[52:55], v1, s[4:7], s64 offen
    s_add_u32 s64, s25, 0x2800
    buffer_load_dwordx4 v[56:59], v1, s[4:7], s64 offen
    s_add_u32 s64, s25, 0x2c00
    buffer_load_dwordx4 v[60:63], v1, s[4:7], s64 offen
    s_add_u32 s64, s25, 0x3000
    buffer_load_dwordx4 v[64:67], v1, s[4:7], s64 offen
    s_add_u32 s64, s25, 0x3400
    buffer_load_dwordx4 v[68:71], v1, s[4:7], s64 offen
    s_add_u32 s64, s25, 0x3800
    buffer_load_dwordx4 v[72:75], v1, s[4:7], s64 offen
    s_add_u32 s64, s25, 0x3c00
    buffer_load_dwordx4 v[76:79], v1, s[4:7], s64 offen
    s_add_u32 s64, s25, 0x4000
    buffer_load_dwordx4 v[80:83], v1, s[4:7], s64 offen
    s_add_u32 s64, s25, 0x4400
    buffer_load_dwordx4 v[84:87], v1, s[4:7], s64 offen
    s_add_u32 s64, s25, 0x4800
    buffer_load_dwordx4 v[88:91], v1, s[4:7], s64 offen
    s_add_u32 s64, s25, 0x4c00
    buffer_load_dwordx4 v[92:95], v1, s[4:7], s64 offen
    s_add_u32 s64, s25, 0x5000
    buffer_load_dwordx4 v[96:99], v1, s[4:7], s64 offen
    s_add_u32 s64, s25, 0x5400
    buffer_load_dwordx4 v[100:103], v1, s[4:7], s64 offen
    s_add_u32 s64, s25, 0x5800
    buffer_load_dwordx4 v[104:107], v1, s[4:7], s64 offen
    s_add_u32 s64, s25, 0x5c00
    buffer_load_dwordx4 v[108:111], v1, s[4:7], s64 offen
    s_add_u32 s64, s25, 0x6000
    buffer_load_dwordx4 v[112:115], v1, s[4:7], s64 offen
    s_add_u32 s64, s25, 0x6400
    buffer_load_dwordx4 v[116:119], v1, s[4:7], s64 offen
    s_add_u32 s64, s25, 0x6800
    buffer_load_dwordx4 v[120:123], v1, s[4:7], s64 offen
    s_add_u32 s64, s25, 0x6c00
    buffer_load_dwordx4 v[124:127], v1, s[4:7], s64 offen
    s_add_u32 s64, s25, 0x7000
    buffer_load_dwordx4 v[128:131], v1, s[4:7], s64 offen
    s_add_u32 s64, s25, 0x7400
    buffer_load_dwordx4 v[132:135], v1, s[4:7], s64 offen
    s_add_u32 s64, s25, 0x7800
    buffer_load_dwordx4 v[136:139], v1, s[4:7], s64 offen
    s_add_u32 s64, s25, 0x7c00
    buffer_load_dwordx4 v[140:143], v1, s[4:7], s64 offen
    s_waitcnt vmcnt(31)
    v_mfma_f32_16x16x32_bf16 v[144:147], a[0:3], v[16:19], 0
    v_mfma_f32_16x16x32_bf16 v[148:151], a[4:7], v[16:19], 0
    s_waitcnt vmcnt(30)
    v_mfma_f32_16x16x32_bf16 v[144:147], a[8:11], v[20:23], v[144:147]
    v_mfma_f32_16x16x32_bf16 v[148:151], a[12:15], v[20:23], v[148:151]
    s_waitcnt vmcnt(29)
    v_mfma_f32_16x16x32_bf16 v[144:147], a[16:19], v[24:27], v[144:147]
    v_mfma_f32_16x16x32_bf16 v[148:151], a[20:23], v[24:27], v[148:151]
    s_waitcnt vmcnt(28)
    v_mfma_f32_16x16x32_bf16 v[144:147], a[24:27], v[28:31], v[144:147]
    v_mfma_f32_16x16x32_bf16 v[148:151], a[28:31], v[28:31], v[148:151]
    s_waitcnt vmcnt(27)
    v_mfma_f32_16x16x32_bf16 v[144:147], a[32:35], v[32:35], v[144:147]
    v_mfma_f32_16x16x32_bf16 v[148:151], a[36:39], v[32:35], v[148:151]
    s_waitcnt vmcnt(26)
    v_mfma_f32_16x16x32_bf16 v[144:147], a[40:43], v[36:39], v[144:147]
    v_mfma_f32_16x16x32_bf16 v[148:151], a[44:47], v[36:39], v[148:151]
    s_waitcnt vmcnt(25)
    v_mfma_f32_16x16x32_bf16 v[144:147], a[48:51], v[40:43], v[144:147]
    v_mfma_f32_16x16x32_bf16 v[148:151], a[52:55], v[40:43], v[148:151]
    s_waitcnt vmcnt(24)
    v_mfma_f32_16x16x32_bf16 v[144:147], a[56:59], v[44:47], v[144:147]
    v_mfma_f32_16x16x32_bf16 v[148:151], a[60:63], v[44:47], v[148:151]
    s_waitcnt vmcnt(23)
    v_mfma_f32_16x16x32_bf16 v[144:147], a[64:67], v[48:51], v[144:147]
    v_mfma_f32_16x16x32_bf16 v[148:151], a[68:71], v[48:51], v[148:151]
    s_waitcnt vmcnt(22)
    v_mfma_f32_16x16x32_bf16 v[144:147], a[72:75], v[52:55], v[144:147]
    v_mfma_f32_16x16x32_bf16 v[148:151], a[76:79], v[52:55], v[148:151]
    s_waitcnt vmcnt(21)
    v_mfma_f32_16x16x32_bf16 v[144:147], a[80:83], v[56:59], v[144:147]
    v_mfma_f32_16x16x32_bf16 v[148:151], a[84:87], v[56:59], v[148:151]
    s_waitcnt vmcnt(20)
    v_mfma_f32_16x16x32_bf16 v[144:147], a[88:91], v[60:63], v[144:147]
    v_mfma_f32_16x16x32_bf16 v[148:151], a[92:95], v[60:63], v[148:151]
    s_waitcnt vmcnt(19)
    v_mfma_f32_16x16x32_bf16 v[144:147], a[96:99], v[64:67], v[144:147]
    v_mfma_f32_16x16x32_bf16 v[148:151], a[100:103], v[64:67], v[148:151]
    s_waitcnt vmcnt(18)
    v_mfma_f32_16x16x32_bf16 v[144:147], a[104:107], v[68:71], v[144:147]
    v_mfma_f32_16x16x32_bf16 v[148:151], a[108:111], v[68:71], v[148:151]
    s_waitcnt vmcnt(17)
    v_mfma_f32_16x16x32_bf16 v[144:147], a[112:115], v[72:75], v[144:147]
    v_mfma_f32_16x16x32_bf16 v[148:151], a[116:119], v[72:75], v[148:151]
    s_waitcnt vmcnt(16)
    v_mfma_f32_16x16x32_bf16 v[144:147], a[120:123], v[76:79], v[144:147]
    v_mfma_f32_16x16x32_bf16 v[148:151], a[124:127], v[76:79], v[148:151]
    s_waitcnt vmcnt(15)
    v_mfma_f32_16x16x32_bf16 v[144:147], a[128:131], v[80:83], v[144:147]
    v_mfma_f32_16x16x32_bf16 v[148:151], a[132:135], v[80:83], v[148:151]
    s_waitcnt vmcnt(14)
    v_mfma_f32_16x16x32_bf16 v[144:147], a[136:139], v[84:87], v[144:147]
    v_mfma_f32_16x16x32_bf16 v[148:151], a[140:143], v[84:87], v[148:151]
    s_waitcnt vmcnt(13)
    v_mfma_f32_16x16x32_bf16 v[144:147], a[144:147], v[88:91], v[144:147]
    v_mfma_f32_16x16x32_bf16 v[148:151], a[148:151], v[88:91], v[148:151]
    s_waitcnt vmcnt(12)
    v_mfma_f32_16x16x32_bf16 v[144:147], a[152:155], v[92:95], v[144:147]
    v_mfma_f32_16x16x32_bf16 v[148:151], a[156:159], v[92:95], v[148:151]
    s_waitcnt vmcnt(11)
    v_mfma_f32_16x16x32_bf16 v[144:147], a[160:163], v[96:99], v[144:147]
    v_mfma_f32_16x16x32_bf16 v[148:151], a[164:167], v[96:99], v[148:151]
    s_waitcnt vmcnt(10)
    v_mfma_f32_16x16x32_bf16 v[144:147], a[168:171], v[100:103], v[144:147]
    v_mfma_f32_16x16x32_bf16 v[148:151], a[172:175], v[100:103], v[148:151]
    s_waitcnt vmcnt(9)
    v_mfma_f32_16x16x32_bf16 v[144:147], a[176:179], v[104:107], v[144:147]
    v_mfma_f32_16x16x32_bf16 v[148:151], a[180:183], v[104:107], v[148:151]
    s_waitcnt vmcnt(8)
    v_mfma_f32_16x16x32_bf16 v[144:147], a[184:187], v[108:111], v[144:147]
    v_mfma_f32_16x16x32_bf16 v[148:151], a[188:191], v[108:111], v[148:151]
    s_waitcnt vmcnt(7)
    v_mfma_f32_16x16x32_bf16 v[144:147], a[192:195], v[112:115], v[144:147]
    v_mfma_f32_16x16x32_bf16 v[148:151], a[196:199], v[112:115], v[148:151]
    s_waitcnt vmcnt(6)
    v_mfma_f32_16x16x32_bf16 v[144:147], a[200:203], v[116:119], v[144:147]
    v_mfma_f32_16x16x32_bf16 v[148:151], a[204:207], v[116:119], v[148:151]
    s_waitcnt vmcnt(5)
    v_mfma_f32_16x16x32_bf16 v[144:147], a[208:211], v[120:123], v[144:147]
    v_mfma_f32_16x16x32_bf16 v[148:151], a[212:215], v[120:123], v[148:151]
    s_waitcnt vmcnt(4)
    v_mfma_f32_16x16x32_bf16 v[144:147], a[216:219], v[124:127], v[144:147]
    v_mfma_f32_16x16x32_bf16 v[148:151], a[220:223], v[124:127], v[148:151]
    s_waitcnt vmcnt(3)
    v_mfma_f32_16x16x32_bf16 v[144:147], a[224:227], v[128:131], v[144:147]
    v_mfma_f32_16x16x32_bf16 v[148:151], a[228:231], v[128:131], v[148:151]
    s_waitcnt vmcnt(2)
    v_mfma_f32_16x16x32_bf16 v[144:147], a[232:235], v[132:135], v[144:147]
    v_mfma_f32_16x16x32_bf16 v[148:151], a[236:239], v[132:135], v[148:151]
    s_waitcnt vmcnt(1)
    v_mfma_f32_16x16x32_bf16 v[144:147], a[240:243], v[136:139], v[144:147]
    v_mfma_f32_16x16x32_bf16 v[148:151], a[244:247], v[136:139], v[148:151]
    s_waitcnt vmcnt(0)
    v_mfma_f32_16x16x32_bf16 v[144:147], a[248:251], v[140:143], v[144:147]
    v_mfma_f32_16x16x32_bf16 v[148:151], a[252:255], v[140:143], v[148:151]
    s_lshl_b32 s64, s14, 12
    v_add_u32 v7, s64, v1
    s_barrier
    s_nop 3
    ds_write_b128 v7, v[144:147] offset:0
    ds_write_b128 v7, v[148:151] offset:1024
    s_waitcnt lgkmcnt(0)
    s_barrier
    s_cmp_ge_u32 s14, 2
    s_cbranch_scc1 OTD_152
    s_lshl_b32 s64, s14, 10
    v_add_u32 v7, s64, v1
    ds_read_b128 v[16:19], v7 offset:0
    ds_read_b128 v[20:23], v7 offset:4096
    ds_read_b128 v[24:27], v7 offset:8192
    ds_read_b128 v[28:31], v7 offset:12288
    s_waitcnt lgkmcnt(0)
    v_add_f32 v16, v16, v20
    v_add_f32 v24, v24, v28
    v_add_f32 v16, v16, v24
    v_add_f32 v17, v17, v21
    v_add_f32 v25, v25, v29
    v_add_f32 v17, v17, v25
    v_add_f32 v18, v18, v22
    v_add_f32 v26, v26, v30
    v_add_f32 v18, v18, v26
    v_add_f32 v19, v19, v23
    v_add_f32 v27, v27, v31
    v_add_f32 v19, v19, v27
    v_cvt_pk_bf16_f32 v16, v16, v16
    v_lshlrev_b32 v16, 16, v16
    v_cvt_pk_bf16_f32 v17, v17, v17
    v_lshlrev_b32 v17, 16, v17
    v_cvt_pk_bf16_f32 v18, v18, v18
    v_lshlrev_b32 v18, 16, v18
    v_cvt_pk_bf16_f32 v19, v19, v19
    v_lshlrev_b32 v19, 16, v19
    v_lshlrev_b32 v20, 16, v162
    v_and_b32 v21, 0xffff0000, v162
    v_lshlrev_b32 v24, 16, v160
    v_and_b32 v25, 0xffff0000, v160
    v_lshlrev_b32 v22, 16, v163
    v_and_b32 v23, 0xffff0000, v163
    v_lshlrev_b32 v26, 16, v161
    v_and_b32 v27, 0xffff0000, v161
    s_lshl_b32 s64, s24, 5
    v_add_u32 v8, s64, v9
    v_mov_b32 v10, -1
    v_cmp_eq_u32 vcc, s72, v8
    s_nop 1
    v_cndmask_b32 v10, v10, 0, vcc
    v_cmp_eq_u32 vcc, s73, v8
    s_nop 1
    v_cndmask_b32 v10, v10, 1, vcc
    v_cmp_eq_u32 vcc, s74, v8
    s_nop 1
    v_cndmask_b32 v10, v10, 2, vcc
    v_cmp_eq_u32 vcc, s75, v8
    s_nop 1
    v_cndmask_b32 v10, v10, 3, vcc
    v_cmp_eq_u32 vcc, s76, v8
    s_nop 1
    v_cndmask_b32 v10, v10, 4, vcc
    v_cmp_eq_u32 vcc, s77, v8
    s_nop 1
    v_cndmask_b32 v10, v10, 5, vcc
    v_cmp_eq_u32 vcc, s78, v8
    s_nop 1
    v_cndmask_b32 v10, v10, 6, vcc
    v_cmp_eq_u32 vcc, s79, v8
    s_nop 1
    v_cndmask_b32 v10, v10, 7, vcc
    v_cmp_le_i32 vcc, 0, v10
    s_and_saveexec_b64 s[68:69], vcc
    s_cbranch_execz NOUPD_153
    v_mul_u32_u24 v10, 2560, v10
    v_lshrrev_b32 v11, 4, v0
    v_lshl_add_u32 v10, v11, 4, v10
    s_lshl_b32 s64, s86, 6
    s_lshl_b32 s65, s13, 7
    s_add_u32 s64, s64, s65
    s_add_u32 s64, s64, 0x5410000
    buffer_load_dwordx4 v[164:167], v10, s[4:7], s64 offen sc1
    s_waitcnt vmcnt(0)
    v_add_f32 v20, v20, v164
    v_cvt_pk_bf16_f32 v20, v20, v20
    v_lshlrev_b32 v20, 16, v20
    v_add_f32 v21, v21, v165
    v_cvt_pk_bf16_f32 v21, v21, v21
    v_lshlrev_b32 v21, 16, v21
    v_add_f32 v22, v22, v166
    v_cvt_pk_bf16_f32 v22, v22, v22
    v_lshlrev_b32 v22, 16, v22
    v_add_f32 v23, v23, v167
    v_cvt_pk_bf16_f32 v23, v23, v23
    v_lshlrev_b32 v23, 16, v23
NOUPD_153:
    s_mov_b64 exec, -1
    v_mul_f32 v28, 0xbfb8aa3b, v20
    v_exp_f32 v28, v28
    s_nop 0
    v_add_f32 v28, 1.0, v28
    v_rcp_f32 v28, v28
    s_nop 0
    v_mul_f32 v28, v28, v20
    v_cvt_pk_bf16_f32 v28, v28, v28
    v_lshlrev_b32 v28, 16, v28
    v_mul_f32 v28, v28, v16
    v_cvt_pk_bf16_f32 v28, v28, v28
    v_lshlrev_b32 v28, 16, v28
    v_add_f32 v28, v28, v24
    v_mul_f32 v29, 0xbfb8aa3b, v21
    v_exp_f32 v29, v29
    s_nop 0
    v_add_f32 v29, 1.0, v29
    v_rcp_f32 v29, v29
    s_nop 0
    v_mul_f32 v29, v29, v21
    v_cvt_pk_bf16_f32 v29, v29, v29
    v_lshlrev_b32 v29, 16, v29
    v_mul_f32 v29, v29, v17
    v_cvt_pk_bf16_f32 v29, v29, v29
    v_lshlrev_b32 v29, 16, v29
    v_add_f32 v29, v29, v25
    v_mul_f32 v30, 0xbfb8aa3b, v22
    v_exp_f32 v30, v30
    s_nop 0
    v_add_f32 v30, 1.0, v30
    v_rcp_f32 v30, v30
    s_nop 0
    v_mul_f32 v30, v30, v22
    v_cvt_pk_bf16_f32 v30, v30, v30
    v_lshlrev_b32 v30, 16, v30
    v_mul_f32 v30, v30, v18
    v_cvt_pk_bf16_f32 v30, v30, v30
    v_lshlrev_b32 v30, 16, v30
    v_add_f32 v30, v30, v26
    v_mul_f32 v31, 0xbfb8aa3b, v23
    v_exp_f32 v31, v31
    s_nop 0
    v_add_f32 v31, 1.0, v31
    v_rcp_f32 v31, v31
    s_nop 0
    v_mul_f32 v31, v31, v23
    v_cvt_pk_bf16_f32 v31, v31, v31
    v_lshlrev_b32 v31, 16, v31
    v_mul_f32 v31, v31, v19
    v_cvt_pk_bf16_f32 v31, v31, v31
    v_lshlrev_b32 v31, 16, v31
    v_add_f32 v31, v31, v27
    v_cvt_pk_bf16_f32 v164, v28, v29
    v_cvt_pk_bf16_f32 v165, v30, v31
    buffer_store_dwordx2 v[164:165], v5, s[52:55], s67 offen
OTD_152:
    s_branch M_EXIT
H_Q:
    s_mov_b32 s29, 0
    v_lshlrev_b32 v1, 4, v0
    v_lshrrev_b32 v5, 4, v0
    v_lshlrev_b32 v2, 7, v5
    v_and_b32 v5, 7, v0
    v_lshl_add_u32 v2, v5, 4, v2
    v_bfe_u32 v5, v0, 4, 1
    v_lshlrev_b32 v3, 7, v5
    v_and_b32 v5, 15, v0
    v_lshl_add_u32 v3, v5, 3, v3
    s_mov_b32 s34, 0x3e0293ee
    s_mov_b32 s35, 0x3e0293ee
    s_mov_b32 s36, -1
    s_mov_b32 s37, 0
    v_lshrrev_b32 v5, 4, v0
    v_lshlrev_b32 v5, 2, v5
    v_and_b32 v6, 15, v0
    v_add_u32 v7, 0, v5
    v_cmp_le_u32 s[38:39], v7, v6
    v_add_u32 v7, 1, v5
    v_cmp_le_u32 s[40:41], v7, v6
    v_add_u32 v7, 2, v5
    v_cmp_le_u32 s[42:43], v7, v6
    v_add_u32 v7, 3, v5
    v_cmp_le_u32 s[44:45], v7, v6
    v_mov_b32 v248, 0x3f803f80
    v_mov_b32 v249, 0x3f803f80
    v_mov_b32 v250, 0x3f803f80
    v_mov_b32 v251, 0x3f803f80
    s_lshl_b32 s24, s12, 2
    s_add_u32 s24, s24, s14
    s_mov_b32 s25, 0
AT0_LOOP:
    s_lshl_b32 s64, s24, 5
    s_add_u32 s64, s64, s13
    s_lshl_b32 s26, s64, 13
    s_add_u32 s26, s26, 0x3400000
    s_lshl_b32 s27, s64, 14
    s_add_u32 s27, s27, 0x1400000
    s_lshl_b32 s65, s64, 11
    s_add_u32 s30, s65, 0x640000
    s_add_u32 s31, s65, 0xa40000
    s_lshl_b32 s33, s64, 2
    s_add_u32 s33, s33, 0x296000
    s_lshl_b32 s32, s24, 18
    s_lshl_b32 s65, s13, 12
    s_add_u32 s32, s32, s65
    s_add_u32 s32, s32, 0x4400000
    s_lshr_b32 s65, s24, 2
    s_lshl_b32 s65, s65, 9
    s_lshl_b32 s66, s13, 4
    s_add_u32 s65, s65, s66
    s_add_u32 s65, s65, 0x291000
    s_lshr_b32 s66, s24, 1
    s_lshl_b32 s66, s66, 8
    s_lshl_b32 s64, s13, 3
    s_add_u32 s66, s66, s64
    s_add_u32 s66, s66, 0x293ff4
    v_lshlrev_b32 v5, 2, v0
    v_mov_b32 v6, s65
    v_mov_b32 v7, s66
    v_cmp_gt_u32 vcc, 3, v0
    s_nop 1
    v_cndmask_b32 v6, v7, v6, vcc
    v_add_u32 v4, v5, v6
    s_mov_b32 s64, 0
    s_mov_b64 exec, 7
AT0_F_154:
    buffer_load_dword v5, v4, s[4:7], s64 offen sc1
    s_add_u32 s29, s29, 1
    s_waitcnt vmcnt(0)
    v_cmp_eq_u32 vcc, 0, v5
    s_cbranch_vccz AT0_FD_155
    s_cmp_gt_u32 s29, 262144
    s_cbranch_scc1 AT0_FD_155
    s_sleep 1
    s_branch AT0_F_154
AT0_FD_155:
    s_mov_b64 exec, -1
    buffer_load_dwordx4 v[16:19], v1, s[4:7], s26 offen offset:0
    buffer_load_dwordx4 v[20:23], v1, s[4:7], s26 offen offset:1024
    buffer_load_dwordx4 v[24:27], v1, s[4:7], s26 offen offset:2048
    buffer_load_dwordx4 v[28:31], v1, s[4:7], s26 offen offset:3072
    s_add_u32 s26, s26, 4096
    buffer_load_dwordx4 v[32:35], v1, s[4:7], s26 offen offset:0
    buffer_load_dwordx4 v[36:39], v1, s[4:7], s26 offen offset:1024
    buffer_load_dwordx4 v[40:43], v1, s[4:7], s26 offen offset:2048
    buffer_load_dwordx4 v[44:47], v1, s[4:7], s26 offen offset:3072
    buffer_load_dwordx4 v[48:51], v1, s[4:7], s27 offen offset:0
    buffer_load_dwordx4 v[52:55], v1, s[4:7], s27 offen offset:1024
    buffer_load_dwordx4 v[56:59], v1, s[4:7], s27 offen offset:2048
    buffer_load_dwordx4 v[60:63], v1, s[4:7], s27 offen offset:3072
    s_add_u32 s27, s27, 4096
    buffer_load_dwordx4 v[64:67], v1, s[4:7], s27 offen offset:0
    buffer_load_dwordx4 v[68:71], v1, s[4:7], s27 offen offset:1024
    buffer_load_dwordx4 v[72:75], v1, s[4:7], s27 offen offset:2048
    buffer_load_dwordx4 v[76:79], v1, s[4:7], s27 offen offset:3072
    s_add_u32 s27, s27, 4096
    buffer_load_dwordx4 v[80:83], v1, s[4:7], s27 offen offset:0
    buffer_load_dwordx4 v[84:87], v1, s[4:7], s27 offen offset:1024
    buffer_load_dwordx4 v[88:91], v1, s[4:7], s27 offen offset:2048
    buffer_load_dwordx4 v[92:95], v1, s[4:7], s27 offen offset:3072
    s_add_u32 s27, s27, 4096
    buffer_load_dwordx4 v[96:99], v1, s[4:7], s27 offen offset:0
    buffer_load_dwordx4 v[100:103], v1, s[4:7], s27 offen offset:1024
    buffer_load_dwordx4 v[104:107], v1, s[4:7], s27 offen offset:2048
    buffer_load_dwordx4 v[108:111], v1, s[4:7], s27 offen offset:3072
    s_mov_b64 exec, 0x18
AT0_G_156:
    buffer_load_dword v5, v4, s[4:7], s64 offen sc1
    s_add_u32 s29, s29, 1
    s_waitcnt vmcnt(0)
    v_cmp_eq_u32 vcc, 0, v5
    s_cbranch_vccz AT0_GD_157
    s_cmp_gt_u32 s29, 262144
    s_cbranch_scc1 AT0_GD_157
    s_sleep 1
    s_branch AT0_G_156
AT0_GD_157:
    s_mov_b64 exec, -1
    buffer_load_dwordx4 v[112:115], v2, s[4:7], s30 offen offset:0
    buffer_load_dwordx4 v[116:119], v2, s[4:7], s30 offen offset:512
    buffer_load_dwordx4 v[120:123], v2, s[4:7], s30 offen offset:1024
    buffer_load_dwordx4 v[124:127], v2, s[4:7], s30 offen offset:1536
    buffer_load_dwordx2 v[128:129], v3, s[4:7], s31 offen offset:0
    buffer_load_dwordx2 v[130:131], v3, s[4:7], s31 offen offset:256
    buffer_load_dwordx2 v[132:133], v3, s[4:7], s31 offen offset:512
    buffer_load_dwordx2 v[134:135], v3, s[4:7], s31 offen offset:768
    buffer_load_dwordx2 v[136:137], v3, s[4:7], s31 offen offset:1024
    buffer_load_dwordx2 v[138:139], v3, s[4:7], s31 offen offset:1280
    buffer_load_dwordx2 v[140:141], v3, s[4:7], s31 offen offset:1536
    buffer_load_dwordx2 v[142:143], v3, s[4:7], s31 offen offset:1792
    v_mfma_f32_16x16x32_bf16 v[148:151], v[48:51], v[16:19], 0
    v_mfma_f32_16x16x32_bf16 v[156:159], v[48:51], v[32:35], 0
    v_mfma_f32_16x16x32_bf16 v[160:163], v[64:67], v[32:35], 0
    v_mfma_f32_16x16x32_bf16 v[148:151], v[52:55], v[20:23], v[148:151]
    v_mfma_f32_16x16x32_bf16 v[156:159], v[52:55], v[36:39], v[156:159]
    v_mfma_f32_16x16x32_bf16 v[160:163], v[68:71], v[36:39], v[160:163]
    v_mfma_f32_16x16x32_bf16 v[148:151], v[56:59], v[24:27], v[148:151]
    v_mfma_f32_16x16x32_bf16 v[156:159], v[56:59], v[40:43], v[156:159]
    v_mfma_f32_16x16x32_bf16 v[160:163], v[72:75], v[40:43], v[160:163]
    v_mfma_f32_16x16x32_bf16 v[148:151], v[60:63], v[28:31], v[148:151]
    v_mfma_f32_16x16x32_bf16 v[156:159], v[60:63], v[44:47], v[156:159]
    v_mfma_f32_16x16x32_bf16 v[160:163], v[76:79], v[44:47], v[160:163]
    s_waitcnt vmcnt(8)
    v_mfma_f32_16x16x32_bf16 v[144:147], v[112:115], v[16:19], 0
    v_mfma_f32_16x16x32_bf16 v[152:155], v[112:115], v[32:35], 0
    v_mfma_f32_16x16x32_bf16 v[144:147], v[116:119], v[20:23], v[144:147]
    v_mfma_f32_16x16x32_bf16 v[152:155], v[116:119], v[36:39], v[152:155]
    v_mfma_f32_16x16x32_bf16 v[144:147], v[120:123], v[24:27], v[144:147]
    v_mfma_f32_16x16x32_bf16 v[152:155], v[120:123], v[40:43], v[152:155]
    v_mfma_f32_16x16x32_bf16 v[144:147], v[124:127], v[28:31], v[144:147]
    v_mfma_f32_16x16x32_bf16 v[152:155], v[124:127], v[44:47], v[152:155]
    v_mov_b32 v11, 0xff800000
    s_nop 7
    v_cndmask_b32 v148, v11, v148, s[38:39]
    v_cndmask_b32 v160, v11, v160, s[38:39]
    v_cndmask_b32 v144, v11, v144, s[36:37]
    v_cndmask_b32 v152, v11, v152, s[36:37]
    v_cndmask_b32 v149, v11, v149, s[40:41]
    v_cndmask_b32 v161, v11, v161, s[40:41]
    v_cndmask_b32 v145, v11, v145, s[36:37]
    v_cndmask_b32 v153, v11, v153, s[36:37]
    v_cndmask_b32 v150, v11, v150, s[42:43]
    v_cndmask_b32 v162, v11, v162, s[42:43]
    v_cndmask_b32 v146, v11, v146, s[36:37]
    v_cndmask_b32 v154, v11, v154, s[36:37]
    v_cndmask_b32 v151, v11, v151, s[44:45]
    v_cndmask_b32 v163, v11, v163, s[44:45]
    v_cndmask_b32 v147, v11, v147, s[36:37]
    v_cndmask_b32 v155, v11, v155, s[36:37]
    v_max3_f32 v8, v144, v145, v146
    v_max3_f32 v8, v8, v147, v148
    v_max3_f32 v8, v8, v149, v150
    v_max_f32 v8, v8, v151
    v_mov_b32 v9, v8
    s_nop 1
    v_permlane16_swap_b32 v8, v9
    v_max_f32 v8, v8, v9
    v_mov_b32 v9, v8
    s_nop 1
    v_permlane32_swap_b32 v8, v9
    v_max_f32 v8, v8, v9
    v_mul_f32 v8, s34, v8
    v_fma_f32 v144, v144, s34, -v8
    v_fma_f32 v145, v145, s34, -v8
    v_fma_f32 v146, v146, s34, -v8
    v_fma_f32 v147, v147, s34, -v8
    v_fma_f32 v148, v148, s34, -v8
    v_fma_f32 v149, v149, s34, -v8
    v_fma_f32 v150, v150, s34, -v8
    v_fma_f32 v151, v151, s34, -v8
    v_exp_f32 v144, v144
    v_exp_f32 v145, v145
    v_exp_f32 v146, v146
    v_exp_f32 v147, v147
    v_exp_f32 v148, v148
    v_exp_f32 v149, v149
    v_exp_f32 v150, v150
    v_exp_f32 v151, v151
    s_nop 0
    v_cvt_pk_bf16_f32 v164, v148, v149
    v_cvt_pk_bf16_f32 v165, v150, v151
    v_mov_b32 v166, 0
    v_mov_b32 v167, 0
    v_cvt_pk_bf16_f32 v168, v144, v145
    v_cvt_pk_bf16_f32 v169, v146, v147
    v_max3_f32 v8, v152, v153, v154
    v_max3_f32 v8, v8, v155, v156
    v_max3_f32 v8, v8, v157, v158
    v_max3_f32 v8, v8, v159, v160
    v_max3_f32 v8, v8, v161, v162
    v_max_f32 v8, v8, v163
    v_mov_b32 v9, v8
    s_nop 1
    v_permlane16_swap_b32 v8, v9
    v_max_f32 v8, v8, v9
    v_mov_b32 v9, v8
    s_nop 1
    v_permlane32_swap_b32 v8, v9
    v_max_f32 v8, v8, v9
    v_mul_f32 v8, s34, v8
    v_fma_f32 v152, v152, s34, -v8
    v_fma_f32 v153, v153, s34, -v8
    v_fma_f32 v154, v154, s34, -v8
    v_fma_f32 v155, v155, s34, -v8
    v_fma_f32 v156, v156, s34, -v8
    v_fma_f32 v157, v157, s34, -v8
    v_fma_f32 v158, v158, s34, -v8
    v_fma_f32 v159, v159, s34, -v8
    v_fma_f32 v160, v160, s34, -v8
    v_fma_f32 v161, v161, s34, -v8
    v_fma_f32 v162, v162, s34, -v8
    v_fma_f32 v163, v163, s34, -v8
    v_exp_f32 v152, v152
    v_exp_f32 v153, v153
    v_exp_f32 v154, v154
    v_exp_f32 v155, v155
    v_exp_f32 v156, v156
    v_exp_f32 v157, v157
    v_exp_f32 v158, v158
    v_exp_f32 v159, v159
    v_exp_f32 v160, v160
    v_exp_f32 v161, v161
    v_exp_f32 v162, v162
    v_exp_f32 v163, v163
    s_nop 0
    v_cvt_pk_bf16_f32 v170, v156, v157
    v_cvt_pk_bf16_f32 v171, v158, v159
    v_cvt_pk_bf16_f32 v172, v160, v161
    v_cvt_pk_bf16_f32 v173, v162, v163
    v_cvt_pk_bf16_f32 v174, v152, v153
    v_cvt_pk_bf16_f32 v175, v154, v155
    s_waitcnt vmcnt(0)
    v_mfma_f32_16x16x32_bf16 v[240:243], v[248:251], v[164:167], 0
    v_mfma_f32_16x16x32_bf16 v[244:247], v[248:251], v[170:173], 0
    v_mfma_f32_16x16x32_bf16 v[176:179], v[80:83], v[164:167], 0
    v_mfma_f32_16x16x32_bf16 v[180:183], v[80:83], v[170:173], 0
    v_mfma_f32_16x16x32_bf16 v[184:187], v[84:87], v[164:167], 0
    v_mfma_f32_16x16x32_bf16 v[188:191], v[84:87], v[170:173], 0
    v_mfma_f32_16x16x32_bf16 v[192:195], v[88:91], v[164:167], 0
    v_mfma_f32_16x16x32_bf16 v[196:199], v[88:91], v[170:173], 0
    v_mfma_f32_16x16x32_bf16 v[200:203], v[92:95], v[164:167], 0
    v_mfma_f32_16x16x32_bf16 v[204:207], v[92:95], v[170:173], 0
    v_mfma_f32_16x16x32_bf16 v[208:211], v[96:99], v[164:167], 0
    v_mfma_f32_16x16x32_bf16 v[212:215], v[96:99], v[170:173], 0
    v_mfma_f32_16x16x32_bf16 v[216:219], v[100:103], v[164:167], 0
    v_mfma_f32_16x16x32_bf16 v[220:223], v[100:103], v[170:173], 0
    v_mfma_f32_16x16x32_bf16 v[224:227], v[104:107], v[164:167], 0
    v_mfma_f32_16x16x32_bf16 v[228:231], v[104:107], v[170:173], 0
    v_mfma_f32_16x16x32_bf16 v[232:235], v[108:111], v[164:167], 0
    v_mfma_f32_16x16x32_bf16 v[236:239], v[108:111], v[170:173], 0
    v_mfma_f32_16x16x16_bf16 v[240:243], v[248:249], v[168:169], v[240:243]
    v_mfma_f32_16x16x16_bf16 v[244:247], v[248:249], v[174:175], v[244:247]
    v_mfma_f32_16x16x16_bf16 v[176:179], v[128:129], v[168:169], v[176:179]
    v_mfma_f32_16x16x16_bf16 v[180:183], v[128:129], v[174:175], v[180:183]
    v_mfma_f32_16x16x16_bf16 v[184:187], v[130:131], v[168:169], v[184:187]
    v_mfma_f32_16x16x16_bf16 v[188:191], v[130:131], v[174:175], v[188:191]
    v_mfma_f32_16x16x16_bf16 v[192:195], v[132:133], v[168:169], v[192:195]
    v_mfma_f32_16x16x16_bf16 v[196:199], v[132:133], v[174:175], v[196:199]
    v_mfma_f32_16x16x16_bf16 v[200:203], v[134:135], v[168:169], v[200:203]
    v_mfma_f32_16x16x16_bf16 v[204:207], v[134:135], v[174:175], v[204:207]
    v_mfma_f32_16x16x16_bf16 v[208:211], v[136:137], v[168:169], v[208:211]
    v_mfma_f32_16x16x16_bf16 v[212:215], v[136:137], v[174:175], v[212:215]
    v_mfma_f32_16x16x16_bf16 v[216:219], v[138:139], v[168:169], v[216:219]
    v_mfma_f32_16x16x16_bf16 v[220:223], v[138:139], v[174:175], v[220:223]
    v_mfma_f32_16x16x16_bf16 v[224:227], v[140:141], v[168:169], v[224:227]
    v_mfma_f32_16x16x16_bf16 v[228:231], v[140:141], v[174:175], v[228:231]
    v_mfma_f32_16x16x16_bf16 v[232:235], v[142:143], v[168:169], v[232:235]
    v_mfma_f32_16x16x16_bf16 v[236:239], v[142:143], v[174:175], v[236:239]
    v_rcp_f32 v8, v240
    v_rcp_f32 v9, v244
    s_nop 7
    v_mul_f32 v176, v176, v8
    v_mul_f32 v177, v177, v8
    v_mul_f32 v178, v178, v8
    v_mul_f32 v179, v179, v8
    v_cvt_pk_bf16_f32 v16, v176, v177
    v_cvt_pk_bf16_f32 v17, v178, v179
    v_mul_f32 v184, v184, v8
    v_mul_f32 v185, v185, v8
    v_mul_f32 v186, v186, v8
    v_mul_f32 v187, v187, v8
    v_cvt_pk_bf16_f32 v18, v184, v185
    v_cvt_pk_bf16_f32 v19, v186, v187
    s_add_u32 s64, s32, 0x0
    buffer_store_dwordx4 v[16:19], v1, s[4:7], s64 offen offset:0 sc1
    v_mul_f32 v192, v192, v8
    v_mul_f32 v193, v193, v8
    v_mul_f32 v194, v194, v8
    v_mul_f32 v195, v195, v8
    v_cvt_pk_bf16_f32 v20, v192, v193
    v_cvt_pk_bf16_f32 v21, v194, v195
    v_mul_f32 v200, v200, v8
    v_mul_f32 v201, v201, v8
    v_mul_f32 v202, v202, v8
    v_mul_f32 v203, v203, v8
    v_cvt_pk_bf16_f32 v22, v200, v201
    v_cvt_pk_bf16_f32 v23, v202, v203
    s_add_u32 s64, s32, 0x0
    buffer_store_dwordx4 v[20:23], v1, s[4:7], s64 offen offset:1024 sc1
    v_mul_f32 v208, v208, v8
    v_mul_f32 v209, v209, v8
    v_mul_f32 v210, v210, v8
    v_mul_f32 v211, v211, v8
    v_cvt_pk_bf16_f32 v24, v208, v209
    v_cvt_pk_bf16_f32 v25, v210, v211
    v_mul_f32 v216, v216, v8
    v_mul_f32 v217, v217, v8
    v_mul_f32 v218, v218, v8
    v_mul_f32 v219, v219, v8
    v_cvt_pk_bf16_f32 v26, v216, v217
    v_cvt_pk_bf16_f32 v27, v218, v219
    s_add_u32 s64, s32, 0x0
    buffer_store_dwordx4 v[24:27], v1, s[4:7], s64 offen offset:2048 sc1
    v_mul_f32 v224, v224, v8
    v_mul_f32 v225, v225, v8
    v_mul_f32 v226, v226, v8
    v_mul_f32 v227, v227, v8
    v_cvt_pk_bf16_f32 v28, v224, v225
    v_cvt_pk_bf16_f32 v29, v226, v227
    v_mul_f32 v232, v232, v8
    v_mul_f32 v233, v233, v8
    v_mul_f32 v234, v234, v8
    v_mul_f32 v235, v235, v8
    v_cvt_pk_bf16_f32 v30, v232, v233
    v_cvt_pk_bf16_f32 v31, v234, v235
    s_add_u32 s64, s32, 0x0
    buffer_store_dwordx4 v[28:31], v1, s[4:7], s64 offen offset:3072 sc1
    v_mul_f32 v180, v180, v9
    v_mul_f32 v181, v181, v9
    v_mul_f32 v182, v182, v9
    v_mul_f32 v183, v183, v9
    v_cvt_pk_bf16_f32 v32, v180, v181
    v_cvt_pk_bf16_f32 v33, v182, v183
    v_mul_f32 v188, v188, v9
    v_mul_f32 v189, v189, v9
    v_mul_f32 v190, v190, v9
    v_mul_f32 v191, v191, v9
    v_cvt_pk_bf16_f32 v34, v188, v189
    v_cvt_pk_bf16_f32 v35, v190, v191
    s_add_u32 s64, s32, 0x20000
    buffer_store_dwordx4 v[32:35], v1, s[4:7], s64 offen offset:0 sc1
    v_mul_f32 v196, v196, v9
    v_mul_f32 v197, v197, v9
    v_mul_f32 v198, v198, v9
    v_mul_f32 v199, v199, v9
    v_cvt_pk_bf16_f32 v36, v196, v197
    v_cvt_pk_bf16_f32 v37, v198, v199
    v_mul_f32 v204, v204, v9
    v_mul_f32 v205, v205, v9
    v_mul_f32 v206, v206, v9
    v_mul_f32 v207, v207, v9
    v_cvt_pk_bf16_f32 v38, v204, v205
    v_cvt_pk_bf16_f32 v39, v206, v207
    s_add_u32 s64, s32, 0x20000
    buffer_store_dwordx4 v[36:39], v1, s[4:7], s64 offen offset:1024 sc1
    v_mul_f32 v212, v212, v9
    v_mul_f32 v213, v213, v9
    v_mul_f32 v214, v214, v9
    v_mul_f32 v215, v215, v9
    v_cvt_pk_bf16_f32 v40, v212, v213
    v_cvt_pk_bf16_f32 v41, v214, v215
    v_mul_f32 v220, v220, v9
    v_mul_f32 v221, v221, v9
    v_mul_f32 v222, v222, v9
    v_mul_f32 v223, v223, v9
    v_cvt_pk_bf16_f32 v42, v220, v221
    v_cvt_pk_bf16_f32 v43, v222, v223
    s_add_u32 s64, s32, 0x20000
    buffer_store_dwordx4 v[40:43], v1, s[4:7], s64 offen offset:2048 sc1
    v_mul_f32 v228, v228, v9
    v_mul_f32 v229, v229, v9
    v_mul_f32 v230, v230, v9
    v_mul_f32 v231, v231, v9
    v_cvt_pk_bf16_f32 v44, v228, v229
    v_cvt_pk_bf16_f32 v45, v230, v231
    v_mul_f32 v236, v236, v9
    v_mul_f32 v237, v237, v9
    v_mul_f32 v238, v238, v9
    v_mul_f32 v239, v239, v9
    v_cvt_pk_bf16_f32 v46, v236, v237
    v_cvt_pk_bf16_f32 v47, v238, v239
    s_add_u32 s64, s32, 0x20000
    buffer_store_dwordx4 v[44:47], v1, s[4:7], s64 offen offset:3072 sc1
    s_waitcnt vmcnt(0)
    v_mov_b32 v7, 1
    v_mov_b32 v8, 0
    s_mov_b64 exec, 1
    buffer_store_dword v7, v8, s[4:7], s33 offen sc1
    s_mov_b64 exec, -1
    s_add_u32 s24, s24, 8
    s_add_u32 s25, s25, 1
    s_cmp_lt_u32 s25, 1
    s_cbranch_scc1 AT0_LOOP
    s_lshl_b32 s70, s13, 1
    s_add_u32 s70, s70, s12
    s_load_dwordx2 s[44:45], s[0:1], 72
    s_mov_b32 s46, 0x21c000
    s_mov_b32 s47, 0x00020000
    s_load_dwordx2 s[48:49], s[0:1], 80
    s_mov_b32 s50, 0x21c000
    s_mov_b32 s51, 0x00020000
    s_load_dwordx2 s[52:53], s[0:1], 88
    s_mov_b32 s54, 0x21c000
    s_mov_b32 s55, 0x00020000
    s_mov_b32 s29, 0
    s_waitcnt lgkmcnt(0)
    v_mbcnt_lo_u32_b32 v0, -1, 0
    v_mbcnt_hi_u32_b32 v0, -1, v0
    s_lshl_b32 s24, s70, 2
    s_add_u32 s24, s24, s14
    s_cmp_ge_u32 s24, 108
    s_cbranch_scc1 H_A1
    v_mov_b32 v8, 0
    s_mov_b32 s64, 0x298000
F1W_158:
    buffer_load_dword v7, v8, s[4:7], s64 offen sc1
    s_add_u32 s29, s29, 1
    s_waitcnt vmcnt(0)
    v_cmp_gt_u32 vcc, 1, v7
    s_cbranch_vccz F1WD_159
    s_cmp_gt_u32 s29, 262144
    s_cbranch_scc1 F1WD_159
    s_sleep 8
    s_branch F1W_158
F1WD_159:
    s_mul_i32 s25, s14, 40960
    v_lshrrev_b32 v7, 1, v0
    v_mul_u32_u24 v2, 3456, v7
    v_and_b32 v7, 1, v0
    v_lshl_add_u32 v2, v7, 4, v2
    v_lshrrev_b32 v7, 4, v0
    v_lshlrev_b32 v3, 8, v7
    v_bfe_u32 v7, v0, 2, 2
    v_lshl_add_u32 v3, v7, 5, v3
    v_and_b32 v7, 3, v0
    v_lshl_add_u32 v3, v7, 3, v3
    v_add_u32 v3, s25, v3
    v_and_b32 v7, 7, v0
    v_lshlrev_b32 v7, 2, v7
    s_mov_b32 s64, 0x5400000
    buffer_load_dword v4, v7, s[4:7], s64 offen sc1
    s_waitcnt vmcnt(0)
    v_mul_u32_u24 v4, 1280, v4
    v_lshrrev_b32 v7, 4, v0
    v_lshl_add_u32 v4, v7, 4, v4
    s_mov_b32 s65, 0x0
    buffer_load_dwordx4 v[16:19], v4, s[4:7], s65 offen offset:0 sc1
    buffer_load_dwordx4 v[20:23], v4, s[4:7], s65 offen offset:64 sc1
    buffer_load_dwordx4 v[24:27], v4, s[4:7], s65 offen offset:128 sc1
    buffer_load_dwordx4 v[28:31], v4, s[4:7], s65 offen offset:192 sc1
    buffer_load_dwordx4 v[32:35], v4, s[4:7], s65 offen offset:256 sc1
    buffer_load_dwordx4 v[36:39], v4, s[4:7], s65 offen offset:320 sc1
    buffer_load_dwordx4 v[40:43], v4, s[4:7], s65 offen offset:384 sc1
    buffer_load_dwordx4 v[44:47], v4, s[4:7], s65 offen offset:448 sc1
    buffer_load_dwordx4 v[48:51], v4, s[4:7], s65 offen offset:512 sc1
    buffer_load_dwordx4 v[52:55], v4, s[4:7], s65 offen offset:576 sc1
    buffer_load_dwordx4 v[56:59], v4, s[4:7], s65 offen offset:640 sc1
    buffer_load_dwordx4 v[60:63], v4, s[4:7], s65 offen offset:704 sc1
    buffer_load_dwordx4 v[64:67], v4, s[4:7], s65 offen offset:768 sc1
    buffer_load_dwordx4 v[68:71], v4, s[4:7], s65 offen offset:832 sc1
    buffer_load_dwordx4 v[72:75], v4, s[4:7], s65 offen offset:896 sc1
    buffer_load_dwordx4 v[76:79], v4, s[4:7], s65 offen offset:960 sc1
    buffer_load_dwordx4 v[80:83], v4, s[4:7], s65 offen offset:1024 sc1
    buffer_load_dwordx4 v[84:87], v4, s[4:7], s65 offen offset:1088 sc1
    buffer_load_dwordx4 v[88:91], v4, s[4:7], s65 offen offset:1152 sc1
    buffer_load_dwordx4 v[92:95], v4, s[4:7], s65 offen offset:1216 sc1
    s_lshl_b32 s26, s24, 5
    s_add_u32 m0, s25, 0
    s_add_u32 s64, s26, 0x0
    buffer_load_dwordx4 v2, s[44:47], s64 offen lds
    s_add_u32 m0, s25, 1024
    s_add_u32 s64, s26, 0x1b000
    buffer_load_dwordx4 v2, s[44:47], s64 offen lds
    s_add_u32 m0, s25, 2048
    s_add_u32 s64, s26, 0x36000
    buffer_load_dwordx4 v2, s[44:47], s64 offen lds
    s_add_u32 m0, s25, 3072
    s_add_u32 s64, s26, 0x51000
    buffer_load_dwordx4 v2, s[44:47], s64 offen lds
    s_add_u32 m0, s25, 4096
    s_add_u32 s64, s26, 0x6c000
    buffer_load_dwordx4 v2, s[44:47], s64 offen lds
    s_add_u32 m0, s25, 5120
    s_add_u32 s64, s26, 0x87000
    buffer_load_dwordx4 v2, s[44:47], s64 offen lds
    s_add_u32 m0, s25, 6144
    s_add_u32 s64, s26, 0xa2000
    buffer_load_dwordx4 v2, s[44:47], s64 offen lds
    s_add_u32 m0, s25, 7168
    s_add_u32 s64, s26, 0xbd000
    buffer_load_dwordx4 v2, s[44:47], s64 offen lds
    s_add_u32 m0, s25, 8192
    s_add_u32 s64, s26, 0xd8000
    buffer_load_dwordx4 v2, s[44:47], s64 offen lds
    s_add_u32 m0, s25, 9216
    s_add_u32 s64, s26, 0xf3000
    buffer_load_dwordx4 v2, s[44:47], s64 offen lds
    s_add_u32 m0, s25, 10240
    s_add_u32 s64, s26, 0x10e000
    buffer_load_dwordx4 v2, s[44:47], s64 offen lds
    s_add_u32 m0, s25, 11264
    s_add_u32 s64, s26, 0x129000
    buffer_load_dwordx4 v2, s[44:47], s64 offen lds
    s_add_u32 m0, s25, 12288
    s_add_u32 s64, s26, 0x144000
    buffer_load_dwordx4 v2, s[44:47], s64 offen lds
    s_add_u32 m0, s25, 13312
    s_add_u32 s64, s26, 0x15f000
    buffer_load_dwordx4 v2, s[44:47], s64 offen lds
    s_add_u32 m0, s25, 14336
    s_add_u32 s64, s26, 0x17a000
    buffer_load_dwordx4 v2, s[44:47], s64 offen lds
    s_add_u32 m0, s25, 15360
    s_add_u32 s64, s26, 0x195000
    buffer_load_dwordx4 v2, s[44:47], s64 offen lds
    s_add_u32 m0, s25, 16384
    s_add_u32 s64, s26, 0x1b0000
    buffer_load_dwordx4 v2, s[44:47], s64 offen lds
    s_add_u32 m0, s25, 17408
    s_add_u32 s64, s26, 0x1cb000
    buffer_load_dwordx4 v2, s[44:47], s64 offen lds
    s_add_u32 m0, s25, 18432
    s_add_u32 s64, s26, 0x1e6000
    buffer_load_dwordx4 v2, s[44:47], s64 offen lds
    s_add_u32 m0, s25, 19456
    s_add_u32 s64, s26, 0x201000
    buffer_load_dwordx4 v2, s[44:47], s64 offen lds
    s_waitcnt vmcnt(0)
    ds_read_b64_tr_b16 v[96:97], v3 offset:0
    ds_read_b64_tr_b16 v[98:99], v3 offset:128
    ds_read_b64_tr_b16 v[100:101], v3 offset:1024
    ds_read_b64_tr_b16 v[102:103], v3 offset:1152
    ds_read_b64_tr_b16 v[104:105], v3 offset:2048
    ds_read_b64_tr_b16 v[106:107], v3 offset:2176
    ds_read_b64_tr_b16 v[108:109], v3 offset:3072
    ds_read_b64_tr_b16 v[110:111], v3 offset:3200
    ds_read_b64_tr_b16 v[112:113], v3 offset:4096
    ds_read_b64_tr_b16 v[114:115], v3 offset:4224
    ds_read_b64_tr_b16 v[116:117], v3 offset:5120
    ds_read_b64_tr_b16 v[118:119], v3 offset:5248
    s_waitcnt lgkmcnt(4)
    ds_read_b64_tr_b16 v[120:121], v3 offset:6144
    ds_read_b64_tr_b16 v[122:123], v3 offset:6272
    ds_read_b64_tr_b16 v[124:125], v3 offset:7168
    ds_read_b64_tr_b16 v[126:127], v3 offset:7296
    ds_read_b64_tr_b16 v[128:129], v3 offset:8192
    ds_read_b64_tr_b16 v[130:131], v3 offset:8320
    ds_read_b64_tr_b16 v[132:133], v3 offset:9216
    ds_read_b64_tr_b16 v[134:135], v3 offset:9344
    ds_read_b64_tr_b16 v[136:137], v3 offset:10240
    ds_read_b64_tr_b16 v[138:139], v3 offset:10368
    ds_read_b64_tr_b16 v[140:141], v3 offset:11264
    ds_read_b64_tr_b16 v[142:143], v3 offset:11392
    s_waitcnt lgkmcnt(4)
    ds_read_b64_tr_b16 v[144:145], v3 offset:12288
    ds_read_b64_tr_b16 v[146:147], v3 offset:12416
    ds_read_b64_tr_b16 v[148:149], v3 offset:13312
    ds_read_b64_tr_b16 v[150:151], v3 offset:13440
    ds_read_b64_tr_b16 v[152:153], v3 offset:14336
    ds_read_b64_tr_b16 v[154:155], v3 offset:14464
    ds_read_b64_tr_b16 v[156:157], v3 offset:15360
    ds_read_b64_tr_b16 v[158:159], v3 offset:15488
    ds_read_b64_tr_b16 v[160:161], v3 offset:16384
    ds_read_b64_tr_b16 v[162:163], v3 offset:16512
    ds_read_b64_tr_b16 v[164:165], v3 offset:17408
    ds_read_b64_tr_b16 v[166:167], v3 offset:17536
    s_waitcnt lgkmcnt(4)
    ds_read_b64_tr_b16 v[168:169], v3 offset:18432
    ds_read_b64_tr_b16 v[170:171], v3 offset:18560
    ds_read_b64_tr_b16 v[172:173], v3 offset:19456
    ds_read_b64_tr_b16 v[174:175], v3 offset:19584
    s_waitcnt lgkmcnt(0)
    s_add_u32 s25, s25, 20480
    v_add_u32 v3, 20480, v3
    s_add_u32 m0, s25, 0
    s_add_u32 s64, s26, 0x0
    buffer_load_dwordx4 v2, s[48:51], s64 offen lds
    s_add_u32 m0, s25, 1024
    s_add_u32 s64, s26, 0x1b000
    buffer_load_dwordx4 v2, s[48:51], s64 offen lds
    s_add_u32 m0, s25, 2048
    s_add_u32 s64, s26, 0x36000
    buffer_load_dwordx4 v2, s[48:51], s64 offen lds
    s_add_u32 m0, s25, 3072
    s_add_u32 s64, s26, 0x51000
    buffer_load_dwordx4 v2, s[48:51], s64 offen lds
    s_add_u32 m0, s25, 4096
    s_add_u32 s64, s26, 0x6c000
    buffer_load_dwordx4 v2, s[48:51], s64 offen lds
    s_add_u32 m0, s25, 5120
    s_add_u32 s64, s26, 0x87000
    buffer_load_dwordx4 v2, s[48:51], s64 offen lds
    s_add_u32 m0, s25, 6144
    s_add_u32 s64, s26, 0xa2000
    buffer_load_dwordx4 v2, s[48:51], s64 offen lds
    s_add_u32 m0, s25, 7168
    s_add_u32 s64, s26, 0xbd000
    buffer_load_dwordx4 v2, s[48:51], s64 offen lds
    s_add_u32 m0, s25, 8192
    s_add_u32 s64, s26, 0xd8000
    buffer_load_dwordx4 v2, s[48:51], s64 offen lds
    s_add_u32 m0, s25, 9216
    s_add_u32 s64, s26, 0xf3000
    buffer_load_dwordx4 v2, s[48:51], s64 offen lds
    s_add_u32 m0, s25, 10240
    s_add_u32 s64, s26, 0x10e000
    buffer_load_dwordx4 v2, s[48:51], s64 offen lds
    s_add_u32 m0, s25, 11264
    s_add_u32 s64, s26, 0x129000
    buffer_load_dwordx4 v2, s[48:51], s64 offen lds
    s_add_u32 m0, s25, 12288
    s_add_u32 s64, s26, 0x144000
    buffer_load_dwordx4 v2, s[48:51], s64 offen lds
    s_add_u32 m0, s25, 13312
    s_add_u32 s64, s26, 0x15f000
    buffer_load_dwordx4 v2, s[48:51], s64 offen lds
    s_add_u32 m0, s25, 14336
    s_add_u32 s64, s26, 0x17a000
    buffer_load_dwordx4 v2, s[48:51], s64 offen lds
    s_add_u32 m0, s25, 15360
    s_add_u32 s64, s26, 0x195000
    buffer_load_dwordx4 v2, s[48:51], s64 offen lds
    s_add_u32 m0, s25, 16384
    s_add_u32 s64, s26, 0x1b0000
    buffer_load_dwordx4 v2, s[48:51], s64 offen lds
    s_add_u32 m0, s25, 17408
    s_add_u32 s64, s26, 0x1cb000
    buffer_load_dwordx4 v2, s[48:51], s64 offen lds
    s_add_u32 m0, s25, 18432
    s_add_u32 s64, s26, 0x1e6000
    buffer_load_dwordx4 v2, s[48:51], s64 offen lds
    s_add_u32 m0, s25, 19456
    s_add_u32 s64, s26, 0x201000
    buffer_load_dwordx4 v2, s[48:51], s64 offen lds
    s_waitcnt vmcnt(0)
    ds_read_b64_tr_b16 v[176:177], v3 offset:0
    ds_read_b64_tr_b16 v[178:179], v3 offset:128
    ds_read_b64_tr_b16 v[180:181], v3 offset:1024
    ds_read_b64_tr_b16 v[182:183], v3 offset:1152
    ds_read_b64_tr_b16 v[184:185], v3 offset:2048
    ds_read_b64_tr_b16 v[186:187], v3 offset:2176
    ds_read_b64_tr_b16 v[188:189], v3 offset:3072
    ds_read_b64_tr_b16 v[190:191], v3 offset:3200
    ds_read_b64_tr_b16 v[192:193], v3 offset:4096
    ds_read_b64_tr_b16 v[194:195], v3 offset:4224
    ds_read_b64_tr_b16 v[196:197], v3 offset:5120
    ds_read_b64_tr_b16 v[198:199], v3 offset:5248
    s_waitcnt lgkmcnt(4)
    ds_read_b64_tr_b16 v[200:201], v3 offset:6144
    ds_read_b64_tr_b16 v[202:203], v3 offset:6272
    ds_read_b64_tr_b16 v[204:205], v3 offset:7168
    ds_read_b64_tr_b16 v[206:207], v3 offset:7296
    ds_read_b64_tr_b16 v[208:209], v3 offset:8192
    ds_read_b64_tr_b16 v[210:211], v3 offset:8320
    ds_read_b64_tr_b16 v[212:213], v3 offset:9216
    ds_read_b64_tr_b16 v[214:215], v3 offset:9344
    ds_read_b64_tr_b16 v[216:217], v3 offset:10240
    ds_read_b64_tr_b16 v[218:219], v3 offset:10368
    ds_read_b64_tr_b16 v[220:221], v3 offset:11264
    ds_read_b64_tr_b16 v[222:223], v3 offset:11392
    s_waitcnt lgkmcnt(4)
    ds_read_b64_tr_b16 v[224:225], v3 offset:12288
    ds_read_b64_tr_b16 v[226:227], v3 offset:12416
    ds_read_b64_tr_b16 v[228:229], v3 offset:13312
    ds_read_b64_tr_b16 v[230:231], v3 offset:13440
    ds_read_b64_tr_b16 v[232:233], v3 offset:14336
    ds_read_b64_tr_b16 v[234:235], v3 offset:14464
    ds_read_b64_tr_b16 v[236:237], v3 offset:15360
    ds_read_b64_tr_b16 v[238:239], v3 offset:15488
    ds_read_b64_tr_b16 v[240:241], v3 offset:16384
    ds_read_b64_tr_b16 v[242:243], v3 offset:16512
    ds_read_b64_tr_b16 v[244:245], v3 offset:17408
    ds_read_b64_tr_b16 v[246:247], v3 offset:17536
    s_waitcnt lgkmcnt(4)
    ds_read_b64_tr_b16 v[248:249], v3 offset:18432
    ds_read_b64_tr_b16 v[250:251], v3 offset:18560
    ds_read_b64_tr_b16 v[252:253], v3 offset:19456
    ds_read_b64_tr_b16 v[254:255], v3 offset:19584
    s_waitcnt lgkmcnt(0)
    v_mfma_f32_16x16x32_bf16 v[8:11], v[96:99], v[16:19], 0
    v_mfma_f32_16x16x32_bf16 v[12:15], v[176:179], v[16:19], 0
    v_mfma_f32_16x16x32_bf16 v[8:11], v[100:103], v[20:23], v[8:11]
    v_mfma_f32_16x16x32_bf16 v[12:15], v[180:183], v[20:23], v[12:15]
    v_mfma_f32_16x16x32_bf16 v[8:11], v[104:107], v[24:27], v[8:11]
    v_mfma_f32_16x16x32_bf16 v[12:15], v[184:187], v[24:27], v[12:15]
    v_mfma_f32_16x16x32_bf16 v[8:11], v[108:111], v[28:31], v[8:11]
    v_mfma_f32_16x16x32_bf16 v[12:15], v[188:191], v[28:31], v[12:15]
    v_mfma_f32_16x16x32_bf16 v[8:11], v[112:115], v[32:35], v[8:11]
    v_mfma_f32_16x16x32_bf16 v[12:15], v[192:195], v[32:35], v[12:15]
    v_mfma_f32_16x16x32_bf16 v[8:11], v[116:119], v[36:39], v[8:11]
    v_mfma_f32_16x16x32_bf16 v[12:15], v[196:199], v[36:39], v[12:15]
    v_mfma_f32_16x16x32_bf16 v[8:11], v[120:123], v[40:43], v[8:11]
    v_mfma_f32_16x16x32_bf16 v[12:15], v[200:203], v[40:43], v[12:15]
    v_mfma_f32_16x16x32_bf16 v[8:11], v[124:127], v[44:47], v[8:11]
    v_mfma_f32_16x16x32_bf16 v[12:15], v[204:207], v[44:47], v[12:15]
    v_mfma_f32_16x16x32_bf16 v[8:11], v[128:131], v[48:51], v[8:11]
    v_mfma_f32_16x16x32_bf16 v[12:15], v[208:211], v[48:51], v[12:15]
    v_mfma_f32_16x16x32_bf16 v[8:11], v[132:135], v[52:55], v[8:11]
    v_mfma_f32_16x16x32_bf16 v[12:15], v[212:215], v[52:55], v[12:15]
    v_mfma_f32_16x16x32_bf16 v[8:11], v[136:139], v[56:59], v[8:11]
    v_mfma_f32_16x16x32_bf16 v[12:15], v[216:219], v[56:59], v[12:15]
    v_mfma_f32_16x16x32_bf16 v[8:11], v[140:143], v[60:63], v[8:11]
    v_mfma_f32_16x16x32_bf16 v[12:15], v[220:223], v[60:63], v[12:15]
    v_mfma_f32_16x16x32_bf16 v[8:11], v[144:147], v[64:67], v[8:11]
    v_mfma_f32_16x16x32_bf16 v[12:15], v[224:227], v[64:67], v[12:15]
    v_mfma_f32_16x16x32_bf16 v[8:11], v[148:151], v[68:71], v[8:11]
    v_mfma_f32_16x16x32_bf16 v[12:15], v[228:231], v[68:71], v[12:15]
    v_mfma_f32_16x16x32_bf16 v[8:11], v[152:155], v[72:75], v[8:11]
    v_mfma_f32_16x16x32_bf16 v[12:15], v[232:235], v[72:75], v[12:15]
    v_mfma_f32_16x16x32_bf16 v[8:11], v[156:159], v[76:79], v[8:11]
    v_mfma_f32_16x16x32_bf16 v[12:15], v[236:239], v[76:79], v[12:15]
    v_mfma_f32_16x16x32_bf16 v[8:11], v[160:163], v[80:83], v[8:11]
    v_mfma_f32_16x16x32_bf16 v[12:15], v[240:243], v[80:83], v[12:15]
    v_mfma_f32_16x16x32_bf16 v[8:11], v[164:167], v[84:87], v[8:11]
    v_mfma_f32_16x16x32_bf16 v[12:15], v[244:247], v[84:87], v[12:15]
    v_mfma_f32_16x16x32_bf16 v[8:11], v[168:171], v[88:91], v[8:11]
    v_mfma_f32_16x16x32_bf16 v[12:15], v[248:251], v[88:91], v[12:15]
    v_mfma_f32_16x16x32_bf16 v[8:11], v[172:175], v[92:95], v[8:11]
    v_mfma_f32_16x16x32_bf16 v[12:15], v[252:255], v[92:95], v[12:15]
    s_nop 7
    v_cvt_pk_bf16_f32 v8, v8, v8
    v_lshlrev_b32 v8, 16, v8
    v_cvt_pk_bf16_f32 v12, v12, v12
    v_lshlrev_b32 v12, 16, v12
    v_mul_f32 v16, 0xbfb8aa3b, v8
    v_exp_f32 v16, v16
    s_nop 0
    v_add_f32 v16, 1.0, v16
    v_rcp_f32 v16, v16
    s_nop 0
    v_mul_f32 v8, v8, v16
    v_cvt_pk_bf16_f32 v8, v8, v8
    v_lshlrev_b32 v8, 16, v8
    v_mul_f32 v8, v8, v12
    v_cvt_pk_bf16_f32 v9, v9, v9
    v_lshlrev_b32 v9, 16, v9
    v_cvt_pk_bf16_f32 v13, v13, v13
    v_lshlrev_b32 v13, 16, v13
    v_mul_f32 v17, 0xbfb8aa3b, v9
    v_exp_f32 v17, v17
    s_nop 0
    v_add_f32 v17, 1.0, v17
    v_rcp_f32 v17, v17
    s_nop 0
    v_mul_f32 v9, v9, v17
    v_cvt_pk_bf16_f32 v9, v9, v9
    v_lshlrev_b32 v9, 16, v9
    v_mul_f32 v9, v9, v13
    v_cvt_pk_bf16_f32 v10, v10, v10
    v_lshlrev_b32 v10, 16, v10
    v_cvt_pk_bf16_f32 v14, v14, v14
    v_lshlrev_b32 v14, 16, v14
    v_mul_f32 v18, 0xbfb8aa3b, v10
    v_exp_f32 v18, v18
    s_nop 0
    v_add_f32 v18, 1.0, v18
    v_rcp_f32 v18, v18
    s_nop 0
    v_mul_f32 v10, v10, v18
    v_cvt_pk_bf16_f32 v10, v10, v10
    v_lshlrev_b32 v10, 16, v10
    v_mul_f32 v10, v10, v14
    v_cvt_pk_bf16_f32 v11, v11, v11
    v_lshlrev_b32 v11, 16, v11
    v_cvt_pk_bf16_f32 v15, v15, v15
    v_lshlrev_b32 v15, 16, v15
    v_mul_f32 v19, 0xbfb8aa3b, v11
    v_exp_f32 v19, v19
    s_nop 0
    v_add_f32 v19, 1.0, v19
    v_rcp_f32 v19, v19
    s_nop 0
    v_mul_f32 v11, v11, v19
    v_cvt_pk_bf16_f32 v11, v11, v11
    v_lshlrev_b32 v11, 16, v11
    v_mul_f32 v11, v11, v15
    v_cvt_pk_bf16_f32 v16, v8, v9
    v_cvt_pk_bf16_f32 v17, v10, v11
    s_lshr_b32 s65, s24, 1
    s_lshl_b32 s65, s65, 10
    s_and_b32 s66, s24, 1
    s_lshl_b32 s66, s66, 3
    s_add_u32 s65, s65, s66
    s_add_u32 s65, s65, 0x5401000
    v_lshlrev_b32 v4, 4, v0
    buffer_store_dwordx2 v[16:17], v4, s[4:7], s65 offen sc1
    s_waitcnt vmcnt(0)
    v_mov_b32 v7, 1
    v_mov_b32 v8, 0
    s_mov_b32 s64, 0x298080
    s_mov_b64 exec, 1
    buffer_atomic_add v7, v8, s[4:7], s64 offen sc1
    s_mov_b64 exec, -1
H_A1:
    v_mbcnt_lo_u32_b32 v0, -1, 0
    v_mbcnt_hi_u32_b32 v0, -1, v0
    s_mov_b32 s29, 0
    v_lshlrev_b32 v1, 4, v0
    v_lshrrev_b32 v5, 4, v0
    v_lshlrev_b32 v2, 7, v5
    v_and_b32 v5, 7, v0
    v_lshl_add_u32 v2, v5, 4, v2
    v_bfe_u32 v5, v0, 4, 1
    v_lshlrev_b32 v3, 7, v5
    v_and_b32 v5, 15, v0
    v_lshl_add_u32 v3, v5, 3, v3
    s_mov_b32 s34, 0x3e0293ee
    s_mov_b32 s35, 0x3e0293ee
    s_mov_b32 s36, -1
    s_mov_b32 s37, 0
    v_lshrrev_b32 v5, 4, v0
    v_lshlrev_b32 v5, 2, v5
    v_and_b32 v6, 15, v0
    v_add_u32 v7, 0, v5
    v_cmp_le_u32 s[38:39], v7, v6
    v_add_u32 v7, 1, v5
    v_cmp_le_u32 s[40:41], v7, v6
    v_add_u32 v7, 2, v5
    v_cmp_le_u32 s[42:43], v7, v6
    v_add_u32 v7, 3, v5
    v_cmp_le_u32 s[44:45], v7, v6
    v_mov_b32 v248, 0x3f803f80
    v_mov_b32 v249, 0x3f803f80
    v_mov_b32 v250, 0x3f803f80
    v_mov_b32 v251, 0x3f803f80
    s_lshl_b32 s24, s12, 2
    s_add_u32 s24, s24, s14
    s_add_u32 s24, s24, 8
    s_mov_b32 s25, 1
AT1_LOOP:
    s_lshl_b32 s64, s24, 5
    s_add_u32 s64, s64, s13
    s_lshl_b32 s26, s64, 13
    s_add_u32 s26, s26, 0x3400000
    s_lshl_b32 s27, s64, 14
    s_add_u32 s27, s27, 0x1400000
    s_lshl_b32 s65, s64, 11
    s_add_u32 s30, s65, 0x640000
    s_add_u32 s31, s65, 0xa40000
    s_lshl_b32 s33, s64, 2
    s_add_u32 s33, s33, 0x296000
    s_lshl_b32 s32, s24, 18
    s_lshl_b32 s65, s13, 12
    s_add_u32 s32, s32, s65
    s_add_u32 s32, s32, 0x4400000
    s_lshr_b32 s65, s24, 2
    s_lshl_b32 s65, s65, 9
    s_lshl_b32 s66, s13, 4
    s_add_u32 s65, s65, s66
    s_add_u32 s65, s65, 0x291000
    s_lshr_b32 s66, s24, 1
    s_lshl_b32 s66, s66, 8
    s_lshl_b32 s64, s13, 3
    s_add_u32 s66, s66, s64
    s_add_u32 s66, s66, 0x293ff4
    v_lshlrev_b32 v5, 2, v0
    v_mov_b32 v6, s65
    v_mov_b32 v7, s66
    v_cmp_gt_u32 vcc, 3, v0
    s_nop 1
    v_cndmask_b32 v6, v7, v6, vcc
    v_add_u32 v4, v5, v6
    s_mov_b32 s64, 0
    s_mov_b64 exec, 7
AT1_F_160:
    buffer_load_dword v5, v4, s[4:7], s64 offen sc1
    s_add_u32 s29, s29, 1
    s_waitcnt vmcnt(0)
    v_cmp_eq_u32 vcc, 0, v5
    s_cbranch_vccz AT1_FD_161
    s_cmp_gt_u32 s29, 262144
    s_cbranch_scc1 AT1_FD_161
    s_sleep 1
    s_branch AT1_F_160
AT1_FD_161:
    s_mov_b64 exec, -1
    buffer_load_dwordx4 v[16:19], v1, s[4:7], s26 offen offset:0
    buffer_load_dwordx4 v[20:23], v1, s[4:7], s26 offen offset:1024
    buffer_load_dwordx4 v[24:27], v1, s[4:7], s26 offen offset:2048
    buffer_load_dwordx4 v[28:31], v1, s[4:7], s26 offen offset:3072
    s_add_u32 s26, s26, 4096
    buffer_load_dwordx4 v[32:35], v1, s[4:7], s26 offen offset:0
    buffer_load_dwordx4 v[36:39], v1, s[4:7], s26 offen offset:1024
    buffer_load_dwordx4 v[40:43], v1, s[4:7], s26 offen offset:2048
    buffer_load_dwordx4 v[44:47], v1, s[4:7], s26 offen offset:3072
    buffer_load_dwordx4 v[48:51], v1, s[4:7], s27 offen offset:0
    buffer_load_dwordx4 v[52:55], v1, s[4:7], s27 offen offset:1024
    buffer_load_dwordx4 v[56:59], v1, s[4:7], s27 offen offset:2048
    buffer_load_dwordx4 v[60:63], v1, s[4:7], s27 offen offset:3072
    s_add_u32 s27, s27, 4096
    buffer_load_dwordx4 v[64:67], v1, s[4:7], s27 offen offset:0
    buffer_load_dwordx4 v[68:71], v1, s[4:7], s27 offen offset:1024
    buffer_load_dwordx4 v[72:75], v1, s[4:7], s27 offen offset:2048
    buffer_load_dwordx4 v[76:79], v1, s[4:7], s27 offen offset:3072
    s_add_u32 s27, s27, 4096
    buffer_load_dwordx4 v[80:83], v1, s[4:7], s27 offen offset:0
    buffer_load_dwordx4 v[84:87], v1, s[4:7], s27 offen offset:1024
    buffer_load_dwordx4 v[88:91], v1, s[4:7], s27 offen offset:2048
    buffer_load_dwordx4 v[92:95], v1, s[4:7], s27 offen offset:3072
    s_add_u32 s27, s27, 4096
    buffer_load_dwordx4 v[96:99], v1, s[4:7], s27 offen offset:0
    buffer_load_dwordx4 v[100:103], v1, s[4:7], s27 offen offset:1024
    buffer_load_dwordx4 v[104:107], v1, s[4:7], s27 offen offset:2048
    buffer_load_dwordx4 v[108:111], v1, s[4:7], s27 offen offset:3072
    s_mov_b64 exec, 0x18
AT1_G_162:
    buffer_load_dword v5, v4, s[4:7], s64 offen sc1
    s_add_u32 s29, s29, 1
    s_waitcnt vmcnt(0)
    v_cmp_eq_u32 vcc, 0, v5
    s_cbranch_vccz AT1_GD_163
    s_cmp_gt_u32 s29, 262144
    s_cbranch_scc1 AT1_GD_163
    s_sleep 1
    s_branch AT1_G_162
AT1_GD_163:
    s_mov_b64 exec, -1
    buffer_load_dwordx4 v[112:115], v2, s[4:7], s30 offen offset:0
    buffer_load_dwordx4 v[116:119], v2, s[4:7], s30 offen offset:512
    buffer_load_dwordx4 v[120:123], v2, s[4:7], s30 offen offset:1024
    buffer_load_dwordx4 v[124:127], v2, s[4:7], s30 offen offset:1536
    buffer_load_dwordx2 v[128:129], v3, s[4:7], s31 offen offset:0
    buffer_load_dwordx2 v[130:131], v3, s[4:7], s31 offen offset:256
    buffer_load_dwordx2 v[132:133], v3, s[4:7], s31 offen offset:512
    buffer_load_dwordx2 v[134:135], v3, s[4:7], s31 offen offset:768
    buffer_load_dwordx2 v[136:137], v3, s[4:7], s31 offen offset:1024
    buffer_load_dwordx2 v[138:139], v3, s[4:7], s31 offen offset:1280
    buffer_load_dwordx2 v[140:141], v3, s[4:7], s31 offen offset:1536
    buffer_load_dwordx2 v[142:143], v3, s[4:7], s31 offen offset:1792
    v_mfma_f32_16x16x32_bf16 v[148:151], v[48:51], v[16:19], 0
    v_mfma_f32_16x16x32_bf16 v[156:159], v[48:51], v[32:35], 0
    v_mfma_f32_16x16x32_bf16 v[160:163], v[64:67], v[32:35], 0
    v_mfma_f32_16x16x32_bf16 v[148:151], v[52:55], v[20:23], v[148:151]
    v_mfma_f32_16x16x32_bf16 v[156:159], v[52:55], v[36:39], v[156:159]
    v_mfma_f32_16x16x32_bf16 v[160:163], v[68:71], v[36:39], v[160:163]
    v_mfma_f32_16x16x32_bf16 v[148:151], v[56:59], v[24:27], v[148:151]
    v_mfma_f32_16x16x32_bf16 v[156:159], v[56:59], v[40:43], v[156:159]
    v_mfma_f32_16x16x32_bf16 v[160:163], v[72:75], v[40:43], v[160:163]
    v_mfma_f32_16x16x32_bf16 v[148:151], v[60:63], v[28:31], v[148:151]
    v_mfma_f32_16x16x32_bf16 v[156:159], v[60:63], v[44:47], v[156:159]
    v_mfma_f32_16x16x32_bf16 v[160:163], v[76:79], v[44:47], v[160:163]
    s_waitcnt vmcnt(8)
    v_mfma_f32_16x16x32_bf16 v[144:147], v[112:115], v[16:19], 0
    v_mfma_f32_16x16x32_bf16 v[152:155], v[112:115], v[32:35], 0
    v_mfma_f32_16x16x32_bf16 v[144:147], v[116:119], v[20:23], v[144:147]
    v_mfma_f32_16x16x32_bf16 v[152:155], v[116:119], v[36:39], v[152:155]
    v_mfma_f32_16x16x32_bf16 v[144:147], v[120:123], v[24:27], v[144:147]
    v_mfma_f32_16x16x32_bf16 v[152:155], v[120:123], v[40:43], v[152:155]
    v_mfma_f32_16x16x32_bf16 v[144:147], v[124:127], v[28:31], v[144:147]
    v_mfma_f32_16x16x32_bf16 v[152:155], v[124:127], v[44:47], v[152:155]
    v_mov_b32 v11, 0xff800000
    s_nop 7
    v_cndmask_b32 v148, v11, v148, s[38:39]
    v_cndmask_b32 v160, v11, v160, s[38:39]
    v_cndmask_b32 v144, v11, v144, s[36:37]
    v_cndmask_b32 v152, v11, v152, s[36:37]
    v_cndmask_b32 v149, v11, v149, s[40:41]
    v_cndmask_b32 v161, v11, v161, s[40:41]
    v_cndmask_b32 v145, v11, v145, s[36:37]
    v_cndmask_b32 v153, v11, v153, s[36:37]
    v_cndmask_b32 v150, v11, v150, s[42:43]
    v_cndmask_b32 v162, v11, v162, s[42:43]
    v_cndmask_b32 v146, v11, v146, s[36:37]
    v_cndmask_b32 v154, v11, v154, s[36:37]
    v_cndmask_b32 v151, v11, v151, s[44:45]
    v_cndmask_b32 v163, v11, v163, s[44:45]
    v_cndmask_b32 v147, v11, v147, s[36:37]
    v_cndmask_b32 v155, v11, v155, s[36:37]
    v_max3_f32 v8, v144, v145, v146
    v_max3_f32 v8, v8, v147, v148
    v_max3_f32 v8, v8, v149, v150
    v_max_f32 v8, v8, v151
    v_mov_b32 v9, v8
    s_nop 1
    v_permlane16_swap_b32 v8, v9
    v_max_f32 v8, v8, v9
    v_mov_b32 v9, v8
    s_nop 1
    v_permlane32_swap_b32 v8, v9
    v_max_f32 v8, v8, v9
    v_mul_f32 v8, s34, v8
    v_fma_f32 v144, v144, s34, -v8
    v_fma_f32 v145, v145, s34, -v8
    v_fma_f32 v146, v146, s34, -v8
    v_fma_f32 v147, v147, s34, -v8
    v_fma_f32 v148, v148, s34, -v8
    v_fma_f32 v149, v149, s34, -v8
    v_fma_f32 v150, v150, s34, -v8
    v_fma_f32 v151, v151, s34, -v8
    v_exp_f32 v144, v144
    v_exp_f32 v145, v145
    v_exp_f32 v146, v146
    v_exp_f32 v147, v147
    v_exp_f32 v148, v148
    v_exp_f32 v149, v149
    v_exp_f32 v150, v150
    v_exp_f32 v151, v151
    s_nop 0
    v_cvt_pk_bf16_f32 v164, v148, v149
    v_cvt_pk_bf16_f32 v165, v150, v151
    v_mov_b32 v166, 0
    v_mov_b32 v167, 0
    v_cvt_pk_bf16_f32 v168, v144, v145
    v_cvt_pk_bf16_f32 v169, v146, v147
    v_max3_f32 v8, v152, v153, v154
    v_max3_f32 v8, v8, v155, v156
    v_max3_f32 v8, v8, v157, v158
    v_max3_f32 v8, v8, v159, v160
    v_max3_f32 v8, v8, v161, v162
    v_max_f32 v8, v8, v163
    v_mov_b32 v9, v8
    s_nop 1
    v_permlane16_swap_b32 v8, v9
    v_max_f32 v8, v8, v9
    v_mov_b32 v9, v8
    s_nop 1
    v_permlane32_swap_b32 v8, v9
    v_max_f32 v8, v8, v9
    v_mul_f32 v8, s34, v8
    v_fma_f32 v152, v152, s34, -v8
    v_fma_f32 v153, v153, s34, -v8
    v_fma_f32 v154, v154, s34, -v8
    v_fma_f32 v155, v155, s34, -v8
    v_fma_f32 v156, v156, s34, -v8
    v_fma_f32 v157, v157, s34, -v8
    v_fma_f32 v158, v158, s34, -v8
    v_fma_f32 v159, v159, s34, -v8
    v_fma_f32 v160, v160, s34, -v8
    v_fma_f32 v161, v161, s34, -v8
    v_fma_f32 v162, v162, s34, -v8
    v_fma_f32 v163, v163, s34, -v8
    v_exp_f32 v152, v152
    v_exp_f32 v153, v153
    v_exp_f32 v154, v154
    v_exp_f32 v155, v155
    v_exp_f32 v156, v156
    v_exp_f32 v157, v157
    v_exp_f32 v158, v158
    v_exp_f32 v159, v159
    v_exp_f32 v160, v160
    v_exp_f32 v161, v161
    v_exp_f32 v162, v162
    v_exp_f32 v163, v163
    s_nop 0
    v_cvt_pk_bf16_f32 v170, v156, v157
    v_cvt_pk_bf16_f32 v171, v158, v159
    v_cvt_pk_bf16_f32 v172, v160, v161
    v_cvt_pk_bf16_f32 v173, v162, v163
    v_cvt_pk_bf16_f32 v174, v152, v153
    v_cvt_pk_bf16_f32 v175, v154, v155
    s_waitcnt vmcnt(0)
    v_mfma_f32_16x16x32_bf16 v[240:243], v[248:251], v[164:167], 0
    v_mfma_f32_16x16x32_bf16 v[244:247], v[248:251], v[170:173], 0
    v_mfma_f32_16x16x32_bf16 v[176:179], v[80:83], v[164:167], 0
    v_mfma_f32_16x16x32_bf16 v[180:183], v[80:83], v[170:173], 0
    v_mfma_f32_16x16x32_bf16 v[184:187], v[84:87], v[164:167], 0
    v_mfma_f32_16x16x32_bf16 v[188:191], v[84:87], v[170:173], 0
    v_mfma_f32_16x16x32_bf16 v[192:195], v[88:91], v[164:167], 0
    v_mfma_f32_16x16x32_bf16 v[196:199], v[88:91], v[170:173], 0
    v_mfma_f32_16x16x32_bf16 v[200:203], v[92:95], v[164:167], 0
    v_mfma_f32_16x16x32_bf16 v[204:207], v[92:95], v[170:173], 0
    v_mfma_f32_16x16x32_bf16 v[208:211], v[96:99], v[164:167], 0
    v_mfma_f32_16x16x32_bf16 v[212:215], v[96:99], v[170:173], 0
    v_mfma_f32_16x16x32_bf16 v[216:219], v[100:103], v[164:167], 0
    v_mfma_f32_16x16x32_bf16 v[220:223], v[100:103], v[170:173], 0
    v_mfma_f32_16x16x32_bf16 v[224:227], v[104:107], v[164:167], 0
    v_mfma_f32_16x16x32_bf16 v[228:231], v[104:107], v[170:173], 0
    v_mfma_f32_16x16x32_bf16 v[232:235], v[108:111], v[164:167], 0
    v_mfma_f32_16x16x32_bf16 v[236:239], v[108:111], v[170:173], 0
    v_mfma_f32_16x16x16_bf16 v[240:243], v[248:249], v[168:169], v[240:243]
    v_mfma_f32_16x16x16_bf16 v[244:247], v[248:249], v[174:175], v[244:247]
    v_mfma_f32_16x16x16_bf16 v[176:179], v[128:129], v[168:169], v[176:179]
    v_mfma_f32_16x16x16_bf16 v[180:183], v[128:129], v[174:175], v[180:183]
    v_mfma_f32_16x16x16_bf16 v[184:187], v[130:131], v[168:169], v[184:187]
    v_mfma_f32_16x16x16_bf16 v[188:191], v[130:131], v[174:175], v[188:191]
    v_mfma_f32_16x16x16_bf16 v[192:195], v[132:133], v[168:169], v[192:195]
    v_mfma_f32_16x16x16_bf16 v[196:199], v[132:133], v[174:175], v[196:199]
    v_mfma_f32_16x16x16_bf16 v[200:203], v[134:135], v[168:169], v[200:203]
    v_mfma_f32_16x16x16_bf16 v[204:207], v[134:135], v[174:175], v[204:207]
    v_mfma_f32_16x16x16_bf16 v[208:211], v[136:137], v[168:169], v[208:211]
    v_mfma_f32_16x16x16_bf16 v[212:215], v[136:137], v[174:175], v[212:215]
    v_mfma_f32_16x16x16_bf16 v[216:219], v[138:139], v[168:169], v[216:219]
    v_mfma_f32_16x16x16_bf16 v[220:223], v[138:139], v[174:175], v[220:223]
    v_mfma_f32_16x16x16_bf16 v[224:227], v[140:141], v[168:169], v[224:227]
    v_mfma_f32_16x16x16_bf16 v[228:231], v[140:141], v[174:175], v[228:231]
    v_mfma_f32_16x16x16_bf16 v[232:235], v[142:143], v[168:169], v[232:235]
    v_mfma_f32_16x16x16_bf16 v[236:239], v[142:143], v[174:175], v[236:239]
    v_rcp_f32 v8, v240
    v_rcp_f32 v9, v244
    s_nop 7
    v_mul_f32 v176, v176, v8
    v_mul_f32 v177, v177, v8
    v_mul_f32 v178, v178, v8
    v_mul_f32 v179, v179, v8
    v_cvt_pk_bf16_f32 v16, v176, v177
    v_cvt_pk_bf16_f32 v17, v178, v179
    v_mul_f32 v184, v184, v8
    v_mul_f32 v185, v185, v8
    v_mul_f32 v186, v186, v8
    v_mul_f32 v187, v187, v8
    v_cvt_pk_bf16_f32 v18, v184, v185
    v_cvt_pk_bf16_f32 v19, v186, v187
    s_add_u32 s64, s32, 0x0
    buffer_store_dwordx4 v[16:19], v1, s[4:7], s64 offen offset:0 sc1
    v_mul_f32 v192, v192, v8
    v_mul_f32 v193, v193, v8
    v_mul_f32 v194, v194, v8
    v_mul_f32 v195, v195, v8
    v_cvt_pk_bf16_f32 v20, v192, v193
    v_cvt_pk_bf16_f32 v21, v194, v195
    v_mul_f32 v200, v200, v8
    v_mul_f32 v201, v201, v8
    v_mul_f32 v202, v202, v8
    v_mul_f32 v203, v203, v8
    v_cvt_pk_bf16_f32 v22, v200, v201
    v_cvt_pk_bf16_f32 v23, v202, v203
    s_add_u32 s64, s32, 0x0
    buffer_store_dwordx4 v[20:23], v1, s[4:7], s64 offen offset:1024 sc1
    v_mul_f32 v208, v208, v8
    v_mul_f32 v209, v209, v8
    v_mul_f32 v210, v210, v8
    v_mul_f32 v211, v211, v8
    v_cvt_pk_bf16_f32 v24, v208, v209
    v_cvt_pk_bf16_f32 v25, v210, v211
    v_mul_f32 v216, v216, v8
    v_mul_f32 v217, v217, v8
    v_mul_f32 v218, v218, v8
    v_mul_f32 v219, v219, v8
    v_cvt_pk_bf16_f32 v26, v216, v217
    v_cvt_pk_bf16_f32 v27, v218, v219
    s_add_u32 s64, s32, 0x0
    buffer_store_dwordx4 v[24:27], v1, s[4:7], s64 offen offset:2048 sc1
    v_mul_f32 v224, v224, v8
    v_mul_f32 v225, v225, v8
    v_mul_f32 v226, v226, v8
    v_mul_f32 v227, v227, v8
    v_cvt_pk_bf16_f32 v28, v224, v225
    v_cvt_pk_bf16_f32 v29, v226, v227
    v_mul_f32 v232, v232, v8
    v_mul_f32 v233, v233, v8
    v_mul_f32 v234, v234, v8
    v_mul_f32 v235, v235, v8
    v_cvt_pk_bf16_f32 v30, v232, v233
    v_cvt_pk_bf16_f32 v31, v234, v235
    s_add_u32 s64, s32, 0x0
    buffer_store_dwordx4 v[28:31], v1, s[4:7], s64 offen offset:3072 sc1
    v_mul_f32 v180, v180, v9
    v_mul_f32 v181, v181, v9
    v_mul_f32 v182, v182, v9
    v_mul_f32 v183, v183, v9
    v_cvt_pk_bf16_f32 v32, v180, v181
    v_cvt_pk_bf16_f32 v33, v182, v183
    v_mul_f32 v188, v188, v9
    v_mul_f32 v189, v189, v9
    v_mul_f32 v190, v190, v9
    v_mul_f32 v191, v191, v9
    v_cvt_pk_bf16_f32 v34, v188, v189
    v_cvt_pk_bf16_f32 v35, v190, v191
    s_add_u32 s64, s32, 0x20000
    buffer_store_dwordx4 v[32:35], v1, s[4:7], s64 offen offset:0 sc1
    v_mul_f32 v196, v196, v9
    v_mul_f32 v197, v197, v9
    v_mul_f32 v198, v198, v9
    v_mul_f32 v199, v199, v9
    v_cvt_pk_bf16_f32 v36, v196, v197
    v_cvt_pk_bf16_f32 v37, v198, v199
    v_mul_f32 v204, v204, v9
    v_mul_f32 v205, v205, v9
    v_mul_f32 v206, v206, v9
    v_mul_f32 v207, v207, v9
    v_cvt_pk_bf16_f32 v38, v204, v205
    v_cvt_pk_bf16_f32 v39, v206, v207
    s_add_u32 s64, s32, 0x20000
    buffer_store_dwordx4 v[36:39], v1, s[4:7], s64 offen offset:1024 sc1
    v_mul_f32 v212, v212, v9
    v_mul_f32 v213, v213, v9
    v_mul_f32 v214, v214, v9
    v_mul_f32 v215, v215, v9
    v_cvt_pk_bf16_f32 v40, v212, v213
    v_cvt_pk_bf16_f32 v41, v214, v215
    v_mul_f32 v220, v220, v9
    v_mul_f32 v221, v221, v9
    v_mul_f32 v222, v222, v9
    v_mul_f32 v223, v223, v9
    v_cvt_pk_bf16_f32 v42, v220, v221
    v_cvt_pk_bf16_f32 v43, v222, v223
    s_add_u32 s64, s32, 0x20000
    buffer_store_dwordx4 v[40:43], v1, s[4:7], s64 offen offset:2048 sc1
    v_mul_f32 v228, v228, v9
    v_mul_f32 v229, v229, v9
    v_mul_f32 v230, v230, v9
    v_mul_f32 v231, v231, v9
    v_cvt_pk_bf16_f32 v44, v228, v229
    v_cvt_pk_bf16_f32 v45, v230, v231
    v_mul_f32 v236, v236, v9
    v_mul_f32 v237, v237, v9
    v_mul_f32 v238, v238, v9
    v_mul_f32 v239, v239, v9
    v_cvt_pk_bf16_f32 v46, v236, v237
    v_cvt_pk_bf16_f32 v47, v238, v239
    s_add_u32 s64, s32, 0x20000
    buffer_store_dwordx4 v[44:47], v1, s[4:7], s64 offen offset:3072 sc1
    s_waitcnt vmcnt(0)
    v_mov_b32 v7, 1
    v_mov_b32 v8, 0
    s_mov_b64 exec, 1
    buffer_store_dword v7, v8, s[4:7], s33 offen sc1
    s_mov_b64 exec, -1
    s_add_u32 s24, s24, 8
    s_add_u32 s25, s25, 1
    s_cmp_lt_u32 s25, 2
    s_cbranch_scc1 AT1_LOOP
    s_lshl_b32 s70, s13, 1
    s_add_u32 s70, s70, s12
    s_load_dwordx2 s[44:45], s[0:1], 72
    s_mov_b32 s46, 0x21c000
    s_mov_b32 s47, 0x00020000
    s_load_dwordx2 s[48:49], s[0:1], 80
    s_mov_b32 s50, 0x21c000
    s_mov_b32 s51, 0x00020000
    s_load_dwordx2 s[52:53], s[0:1], 88
    s_mov_b32 s54, 0x21c000
    s_mov_b32 s55, 0x00020000
    s_mov_b32 s29, 0
    s_waitcnt lgkmcnt(0)
    v_mbcnt_lo_u32_b32 v0, -1, 0
    v_mbcnt_hi_u32_b32 v0, -1, v0
    s_cmp_lg_u32 s14, 0
    s_cbranch_scc1 H_ATT
    s_cmp_ge_u32 s70, 40
    s_cbranch_scc1 H_ATT
    s_mov_b32 s24, s70
    v_mov_b32 v8, 0
    s_mov_b32 s64, 0x298080
F2W_164:
    buffer_load_dword v7, v8, s[4:7], s64 offen sc1
    s_add_u32 s29, s29, 1
    s_waitcnt vmcnt(0)
    v_mov_b32 v9, 108
    v_cmp_gt_u32 vcc, v9, v7
    s_cbranch_vccz F2WD_165
    s_cmp_gt_u32 s29, 262144
    s_cbranch_scc1 F2WD_165
    s_sleep 8
    s_branch F2W_164
F2WD_165:
    s_mov_b32 s25, 0
    v_lshrrev_b32 v7, 1, v0
    v_mul_u32_u24 v2, 1280, v7
    v_and_b32 v7, 1, v0
    v_lshl_add_u32 v2, v7, 4, v2
    v_lshrrev_b32 v7, 4, v0
    v_lshlrev_b32 v3, 7, v7
    v_bfe_u32 v7, v0, 2, 2
    v_lshl_add_u32 v3, v7, 5, v3
    v_and_b32 v7, 3, v0
    v_lshl_add_u32 v3, v7, 3, v3
    v_add_u32 v3, s25, v3
    v_lshlrev_b32 v4, 4, v0
    s_mov_b32 s65, 0x5401000
    buffer_load_dwordx4 v[16:19], v4, s[4:7], s65 offen offset:0 sc1
    buffer_load_dwordx4 v[20:23], v4, s[4:7], s65 offen offset:1024 sc1
    buffer_load_dwordx4 v[24:27], v4, s[4:7], s65 offen offset:2048 sc1
    buffer_load_dwordx4 v[28:31], v4, s[4:7], s65 offen offset:3072 sc1
    s_add_u32 s65, s65, 4096
    buffer_load_dwordx4 v[32:35], v4, s[4:7], s65 offen offset:0 sc1
    buffer_load_dwordx4 v[36:39], v4, s[4:7], s65 offen offset:1024 sc1
    buffer_load_dwordx4 v[40:43], v4, s[4:7], s65 offen offset:2048 sc1
    buffer_load_dwordx4 v[44:47], v4, s[4:7], s65 offen offset:3072 sc1
    s_add_u32 s65, s65, 4096
    buffer_load_dwordx4 v[48:51], v4, s[4:7], s65 offen offset:0 sc1
    buffer_load_dwordx4 v[52:55], v4, s[4:7], s65 offen offset:1024 sc1
    buffer_load_dwordx4 v[56:59], v4, s[4:7], s65 offen offset:2048 sc1
    buffer_load_dwordx4 v[60:63], v4, s[4:7], s65 offen offset:3072 sc1
    s_add_u32 s65, s65, 4096
    buffer_load_dwordx4 v[64:67], v4, s[4:7], s65 offen offset:0 sc1
    buffer_load_dwordx4 v[68:71], v4, s[4:7], s65 offen offset:1024 sc1
    buffer_load_dwordx4 v[72:75], v4, s[4:7], s65 offen offset:2048 sc1
    buffer_load_dwordx4 v[76:79], v4, s[4:7], s65 offen offset:3072 sc1
    s_add_u32 s65, s65, 4096
    buffer_load_dwordx4 v[80:83], v4, s[4:7], s65 offen offset:0 sc1
    buffer_load_dwordx4 v[84:87], v4, s[4:7], s65 offen offset:1024 sc1
    buffer_load_dwordx4 v[88:91], v4, s[4:7], s65 offen offset:2048 sc1
    buffer_load_dwordx4 v[92:95], v4, s[4:7], s65 offen offset:3072 sc1
    s_add_u32 s65, s65, 4096
    buffer_load_dwordx4 v[96:99], v4, s[4:7], s65 offen offset:0 sc1
    buffer_load_dwordx4 v[100:103], v4, s[4:7], s65 offen offset:1024 sc1
    buffer_load_dwordx4 v[104:107], v4, s[4:7], s65 offen offset:2048 sc1
    buffer_load_dwordx4 v[108:111], v4, s[4:7], s65 offen offset:3072 sc1
    s_add_u32 s65, s65, 4096
    buffer_load_dwordx4 v[112:115], v4, s[4:7], s65 offen offset:0 sc1
    buffer_load_dwordx4 v[116:119], v4, s[4:7], s65 offen offset:1024 sc1
    buffer_load_dwordx4 v[120:123], v4, s[4:7], s65 offen offset:2048 sc1
    buffer_load_dwordx4 v[124:127], v4, s[4:7], s65 offen offset:3072 sc1
    s_add_u32 s65, s65, 4096
    buffer_load_dwordx4 v[128:131], v4, s[4:7], s65 offen offset:0 sc1
    buffer_load_dwordx4 v[132:135], v4, s[4:7], s65 offen offset:1024 sc1
    buffer_load_dwordx4 v[136:139], v4, s[4:7], s65 offen offset:2048 sc1
    buffer_load_dwordx4 v[140:143], v4, s[4:7], s65 offen offset:3072 sc1
    s_add_u32 s65, s65, 4096
    buffer_load_dwordx4 v[144:147], v4, s[4:7], s65 offen offset:0 sc1
    buffer_load_dwordx4 v[148:151], v4, s[4:7], s65 offen offset:1024 sc1
    buffer_load_dwordx4 v[152:155], v4, s[4:7], s65 offen offset:2048 sc1
    buffer_load_dwordx4 v[156:159], v4, s[4:7], s65 offen offset:3072 sc1
    s_add_u32 s65, s65, 4096
    buffer_load_dwordx4 v[160:163], v4, s[4:7], s65 offen offset:0 sc1
    buffer_load_dwordx4 v[164:167], v4, s[4:7], s65 offen offset:1024 sc1
    buffer_load_dwordx4 v[168:171], v4, s[4:7], s65 offen offset:2048 sc1
    buffer_load_dwordx4 v[172:175], v4, s[4:7], s65 offen offset:3072 sc1
    s_add_u32 s65, s65, 4096
    buffer_load_dwordx4 v[176:179], v4, s[4:7], s65 offen offset:0 sc1
    s_waitcnt vmcnt(20)
    buffer_load_dwordx4 v[180:183], v4, s[4:7], s65 offen offset:1024 sc1
    buffer_load_dwordx4 v[184:187], v4, s[4:7], s65 offen offset:2048 sc1
    buffer_load_dwordx4 v[188:191], v4, s[4:7], s65 offen offset:3072 sc1
    s_add_u32 s65, s65, 4096
    buffer_load_dwordx4 v[192:195], v4, s[4:7], s65 offen offset:0 sc1
    buffer_load_dwordx4 v[196:199], v4, s[4:7], s65 offen offset:1024 sc1
    buffer_load_dwordx4 v[200:203], v4, s[4:7], s65 offen offset:2048 sc1
    buffer_load_dwordx4 v[204:207], v4, s[4:7], s65 offen offset:3072 sc1
    s_add_u32 s65, s65, 4096
    buffer_load_dwordx4 v[208:211], v4, s[4:7], s65 offen offset:0 sc1
    buffer_load_dwordx4 v[212:215], v4, s[4:7], s65 offen offset:1024 sc1
    buffer_load_dwordx4 v[216:219], v4, s[4:7], s65 offen offset:2048 sc1
    buffer_load_dwordx4 v[220:223], v4, s[4:7], s65 offen offset:3072 sc1
    s_add_u32 s65, s65, 4096
    buffer_load_dwordx4 v[224:227], v4, s[4:7], s65 offen offset:0 sc1
    buffer_load_dwordx4 v[228:231], v4, s[4:7], s65 offen offset:1024 sc1
    s_waitcnt vmcnt(0)
    s_lshl_b32 s26, s24, 5
    s_add_u32 m0, s25, 0
    s_add_u32 s64, s26, 0x0
    buffer_load_dwordx4 v2, s[52:55], s64 offen lds
    s_add_u32 m0, s25, 1024
    s_add_u32 s64, s26, 0xa000
    buffer_load_dwordx4 v2, s[52:55], s64 offen lds
    s_add_u32 m0, s25, 2048
    s_add_u32 s64, s26, 0x14000
    buffer_load_dwordx4 v2, s[52:55], s64 offen lds
    s_add_u32 m0, s25, 3072
    s_add_u32 s64, s26, 0x1e000
    buffer_load_dwordx4 v2, s[52:55], s64 offen lds
    s_add_u32 m0, s25, 4096
    s_add_u32 s64, s26, 0x28000
    buffer_load_dwordx4 v2, s[52:55], s64 offen lds
    s_add_u32 m0, s25, 5120
    s_add_u32 s64, s26, 0x32000
    buffer_load_dwordx4 v2, s[52:55], s64 offen lds
    s_add_u32 m0, s25, 6144
    s_add_u32 s64, s26, 0x3c000
    buffer_load_dwordx4 v2, s[52:55], s64 offen lds
    s_add_u32 m0, s25, 7168
    s_add_u32 s64, s26, 0x46000
    buffer_load_dwordx4 v2, s[52:55], s64 offen lds
    s_add_u32 m0, s25, 8192
    s_add_u32 s64, s26, 0x50000
    buffer_load_dwordx4 v2, s[52:55], s64 offen lds
    s_add_u32 m0, s25, 9216
    s_add_u32 s64, s26, 0x5a000
    buffer_load_dwordx4 v2, s[52:55], s64 offen lds
    s_add_u32 m0, s25, 10240
    s_add_u32 s64, s26, 0x64000
    buffer_load_dwordx4 v2, s[52:55], s64 offen lds
    s_add_u32 m0, s25, 11264
    s_add_u32 s64, s26, 0x6e000
    buffer_load_dwordx4 v2, s[52:55], s64 offen lds
    s_add_u32 m0, s25, 12288
    s_add_u32 s64, s26, 0x78000
    buffer_load_dwordx4 v2, s[52:55], s64 offen lds
    s_add_u32 m0, s25, 13312
    s_add_u32 s64, s26, 0x82000
    buffer_load_dwordx4 v2, s[52:55], s64 offen lds
    s_add_u32 m0, s25, 14336
    s_add_u32 s64, s26, 0x8c000
    buffer_load_dwordx4 v2, s[52:55], s64 offen lds
    s_add_u32 m0, s25, 15360
    s_add_u32 s64, s26, 0x96000
    buffer_load_dwordx4 v2, s[52:55], s64 offen lds
    s_add_u32 m0, s25, 16384
    s_add_u32 s64, s26, 0xa0000
    buffer_load_dwordx4 v2, s[52:55], s64 offen lds
    s_add_u32 m0, s25, 17408
    s_add_u32 s64, s26, 0xaa000
    buffer_load_dwordx4 v2, s[52:55], s64 offen lds
    s_add_u32 m0, s25, 18432
    s_add_u32 s64, s26, 0xb4000
    buffer_load_dwordx4 v2, s[52:55], s64 offen lds
    s_add_u32 m0, s25, 19456
    s_add_u32 s64, s26, 0xbe000
    buffer_load_dwordx4 v2, s[52:55], s64 offen lds
    s_add_u32 m0, s25, 20480
    s_add_u32 s64, s26, 0xc8000
    buffer_load_dwordx4 v2, s[52:55], s64 offen lds
    s_add_u32 m0, s25, 21504
    s_add_u32 s64, s26, 0xd2000
    buffer_load_dwordx4 v2, s[52:55], s64 offen lds
    s_add_u32 m0, s25, 22528
    s_add_u32 s64, s26, 0xdc000
    buffer_load_dwordx4 v2, s[52:55], s64 offen lds
    s_add_u32 m0, s25, 23552
    s_add_u32 s64, s26, 0xe6000
    buffer_load_dwordx4 v2, s[52:55], s64 offen lds
    s_add_u32 m0, s25, 24576
    s_add_u32 s64, s26, 0xf0000
    buffer_load_dwordx4 v2, s[52:55], s64 offen lds
    s_add_u32 m0, s25, 25600
    s_add_u32 s64, s26, 0xfa000
    buffer_load_dwordx4 v2, s[52:55], s64 offen lds
    s_add_u32 m0, s25, 26624
    s_add_u32 s64, s26, 0x104000
    buffer_load_dwordx4 v2, s[52:55], s64 offen lds
    s_add_u32 m0, s25, 27648
    s_add_u32 s64, s26, 0x10e000
    buffer_load_dwordx4 v2, s[52:55], s64 offen lds
    s_add_u32 m0, s25, 28672
    s_add_u32 s64, s26, 0x118000
    buffer_load_dwordx4 v2, s[52:55], s64 offen lds
    s_add_u32 m0, s25, 29696
    s_add_u32 s64, s26, 0x122000
    buffer_load_dwordx4 v2, s[52:55], s64 offen lds
    s_add_u32 m0, s25, 30720
    s_add_u32 s64, s26, 0x12c000
    buffer_load_dwordx4 v2, s[52:55], s64 offen lds
    s_add_u32 m0, s25, 31744
    s_add_u32 s64, s26, 0x136000
    buffer_load_dwordx4 v2, s[52:55], s64 offen lds
    s_add_u32 m0, s25, 32768
    s_add_u32 s64, s26, 0x140000
    buffer_load_dwordx4 v2, s[52:55], s64 offen lds
    s_add_u32 m0, s25, 33792
    s_add_u32 s64, s26, 0x14a000
    buffer_load_dwordx4 v2, s[52:55], s64 offen lds
    s_add_u32 m0, s25, 34816
    s_add_u32 s64, s26, 0x154000
    buffer_load_dwordx4 v2, s[52:55], s64 offen lds
    s_add_u32 m0, s25, 35840
    s_add_u32 s64, s26, 0x15e000
    buffer_load_dwordx4 v2, s[52:55], s64 offen lds
    s_add_u32 m0, s25, 36864
    s_add_u32 s64, s26, 0x168000
    buffer_load_dwordx4 v2, s[52:55], s64 offen lds
    s_add_u32 m0, s25, 37888
    s_add_u32 s64, s26, 0x172000
    buffer_load_dwordx4 v2, s[52:55], s64 offen lds
    s_add_u32 m0, s25, 38912
    s_add_u32 s64, s26, 0x17c000
    buffer_load_dwordx4 v2, s[52:55], s64 offen lds
    s_add_u32 m0, s25, 39936
    s_add_u32 s64, s26, 0x186000
    buffer_load_dwordx4 v2, s[52:55], s64 offen lds
    s_add_u32 m0, s25, 40960
    s_add_u32 s64, s26, 0x190000
    buffer_load_dwordx4 v2, s[52:55], s64 offen lds
    s_waitcnt vmcnt(20)
    s_add_u32 m0, s25, 41984
    s_add_u32 s64, s26, 0x19a000
    buffer_load_dwordx4 v2, s[52:55], s64 offen lds
    s_add_u32 m0, s25, 43008
    s_add_u32 s64, s26, 0x1a4000
    buffer_load_dwordx4 v2, s[52:55], s64 offen lds
    s_add_u32 m0, s25, 44032
    s_add_u32 s64, s26, 0x1ae000
    buffer_load_dwordx4 v2, s[52:55], s64 offen lds
    s_add_u32 m0, s25, 45056
    s_add_u32 s64, s26, 0x1b8000
    buffer_load_dwordx4 v2, s[52:55], s64 offen lds
    s_add_u32 m0, s25, 46080
    s_add_u32 s64, s26, 0x1c2000
    buffer_load_dwordx4 v2, s[52:55], s64 offen lds
    s_add_u32 m0, s25, 47104
    s_add_u32 s64, s26, 0x1cc000
    buffer_load_dwordx4 v2, s[52:55], s64 offen lds
    s_add_u32 m0, s25, 48128
    s_add_u32 s64, s26, 0x1d6000
    buffer_load_dwordx4 v2, s[52:55], s64 offen lds
    s_add_u32 m0, s25, 49152
    s_add_u32 s64, s26, 0x1e0000
    buffer_load_dwordx4 v2, s[52:55], s64 offen lds
    s_add_u32 m0, s25, 50176
    s_add_u32 s64, s26, 0x1ea000
    buffer_load_dwordx4 v2, s[52:55], s64 offen lds
    s_add_u32 m0, s25, 51200
    s_add_u32 s64, s26, 0x1f4000
    buffer_load_dwordx4 v2, s[52:55], s64 offen lds
    s_add_u32 m0, s25, 52224
    s_add_u32 s64, s26, 0x1fe000
    buffer_load_dwordx4 v2, s[52:55], s64 offen lds
    s_add_u32 m0, s25, 53248
    s_add_u32 s64, s26, 0x208000
    buffer_load_dwordx4 v2, s[52:55], s64 offen lds
    s_add_u32 m0, s25, 54272
    s_add_u32 s64, s26, 0x212000
    buffer_load_dwordx4 v2, s[52:55], s64 offen lds
    s_waitcnt vmcnt(0)
    ds_read_b64_tr_b16 v[232:233], v3 offset:0
    ds_read_b64_tr_b16 v[234:235], v3 offset:512
    s_waitcnt lgkmcnt(0)
    v_mfma_f32_16x16x32_bf16 v[8:11], v[232:235], v[16:19], 0
    ds_read_b64_tr_b16 v[236:237], v3 offset:1024
    ds_read_b64_tr_b16 v[238:239], v3 offset:1536
    s_waitcnt lgkmcnt(0)
    v_mfma_f32_16x16x32_bf16 v[8:11], v[236:239], v[20:23], v[8:11]
    ds_read_b64_tr_b16 v[240:241], v3 offset:2048
    ds_read_b64_tr_b16 v[242:243], v3 offset:2560
    s_waitcnt lgkmcnt(0)
    v_mfma_f32_16x16x32_bf16 v[8:11], v[240:243], v[24:27], v[8:11]
    ds_read_b64_tr_b16 v[244:245], v3 offset:3072
    ds_read_b64_tr_b16 v[246:247], v3 offset:3584
    s_waitcnt lgkmcnt(0)
    v_mfma_f32_16x16x32_bf16 v[8:11], v[244:247], v[28:31], v[8:11]
    ds_read_b64_tr_b16 v[232:233], v3 offset:4096
    ds_read_b64_tr_b16 v[234:235], v3 offset:4608
    s_waitcnt lgkmcnt(0)
    v_mfma_f32_16x16x32_bf16 v[8:11], v[232:235], v[32:35], v[8:11]
    ds_read_b64_tr_b16 v[236:237], v3 offset:5120
    ds_read_b64_tr_b16 v[238:239], v3 offset:5632
    s_waitcnt lgkmcnt(0)
    v_mfma_f32_16x16x32_bf16 v[8:11], v[236:239], v[36:39], v[8:11]
    ds_read_b64_tr_b16 v[240:241], v3 offset:6144
    ds_read_b64_tr_b16 v[242:243], v3 offset:6656
    s_waitcnt lgkmcnt(0)
    v_mfma_f32_16x16x32_bf16 v[8:11], v[240:243], v[40:43], v[8:11]
    ds_read_b64_tr_b16 v[244:245], v3 offset:7168
    ds_read_b64_tr_b16 v[246:247], v3 offset:7680
    s_waitcnt lgkmcnt(0)
    v_mfma_f32_16x16x32_bf16 v[8:11], v[244:247], v[44:47], v[8:11]
    ds_read_b64_tr_b16 v[232:233], v3 offset:8192
    ds_read_b64_tr_b16 v[234:235], v3 offset:8704
    s_waitcnt lgkmcnt(0)
    v_mfma_f32_16x16x32_bf16 v[8:11], v[232:235], v[48:51], v[8:11]
    ds_read_b64_tr_b16 v[236:237], v3 offset:9216
    ds_read_b64_tr_b16 v[238:239], v3 offset:9728
    s_waitcnt lgkmcnt(0)
    v_mfma_f32_16x16x32_bf16 v[8:11], v[236:239], v[52:55], v[8:11]
    ds_read_b64_tr_b16 v[240:241], v3 offset:10240
    ds_read_b64_tr_b16 v[242:243], v3 offset:10752
    s_waitcnt lgkmcnt(0)
    v_mfma_f32_16x16x32_bf16 v[8:11], v[240:243], v[56:59], v[8:11]
    ds_read_b64_tr_b16 v[244:245], v3 offset:11264
    ds_read_b64_tr_b16 v[246:247], v3 offset:11776
    s_waitcnt lgkmcnt(0)
    v_mfma_f32_16x16x32_bf16 v[8:11], v[244:247], v[60:63], v[8:11]
    ds_read_b64_tr_b16 v[232:233], v3 offset:12288
    ds_read_b64_tr_b16 v[234:235], v3 offset:12800
    s_waitcnt lgkmcnt(0)
    v_mfma_f32_16x16x32_bf16 v[8:11], v[232:235], v[64:67], v[8:11]
    ds_read_b64_tr_b16 v[236:237], v3 offset:13312
    ds_read_b64_tr_b16 v[238:239], v3 offset:13824
    s_waitcnt lgkmcnt(0)
    v_mfma_f32_16x16x32_bf16 v[8:11], v[236:239], v[68:71], v[8:11]
    ds_read_b64_tr_b16 v[240:241], v3 offset:14336
    ds_read_b64_tr_b16 v[242:243], v3 offset:14848
    s_waitcnt lgkmcnt(0)
    v_mfma_f32_16x16x32_bf16 v[8:11], v[240:243], v[72:75], v[8:11]
    ds_read_b64_tr_b16 v[244:245], v3 offset:15360
    ds_read_b64_tr_b16 v[246:247], v3 offset:15872
    s_waitcnt lgkmcnt(0)
    v_mfma_f32_16x16x32_bf16 v[8:11], v[244:247], v[76:79], v[8:11]
    ds_read_b64_tr_b16 v[232:233], v3 offset:16384
    ds_read_b64_tr_b16 v[234:235], v3 offset:16896
    s_waitcnt lgkmcnt(0)
    v_mfma_f32_16x16x32_bf16 v[8:11], v[232:235], v[80:83], v[8:11]
    ds_read_b64_tr_b16 v[236:237], v3 offset:17408
    ds_read_b64_tr_b16 v[238:239], v3 offset:17920
    s_waitcnt lgkmcnt(0)
    v_mfma_f32_16x16x32_bf16 v[8:11], v[236:239], v[84:87], v[8:11]
    ds_read_b64_tr_b16 v[240:241], v3 offset:18432
    ds_read_b64_tr_b16 v[242:243], v3 offset:18944
    s_waitcnt lgkmcnt(0)
    v_mfma_f32_16x16x32_bf16 v[8:11], v[240:243], v[88:91], v[8:11]
    ds_read_b64_tr_b16 v[244:245], v3 offset:19456
    ds_read_b64_tr_b16 v[246:247], v3 offset:19968
    s_waitcnt lgkmcnt(0)
    v_mfma_f32_16x16x32_bf16 v[8:11], v[244:247], v[92:95], v[8:11]
    ds_read_b64_tr_b16 v[232:233], v3 offset:20480
    ds_read_b64_tr_b16 v[234:235], v3 offset:20992
    s_waitcnt lgkmcnt(0)
    v_mfma_f32_16x16x32_bf16 v[8:11], v[232:235], v[96:99], v[8:11]
    ds_read_b64_tr_b16 v[236:237], v3 offset:21504
    ds_read_b64_tr_b16 v[238:239], v3 offset:22016
    s_waitcnt lgkmcnt(0)
    v_mfma_f32_16x16x32_bf16 v[8:11], v[236:239], v[100:103], v[8:11]
    ds_read_b64_tr_b16 v[240:241], v3 offset:22528
    ds_read_b64_tr_b16 v[242:243], v3 offset:23040
    s_waitcnt lgkmcnt(0)
    v_mfma_f32_16x16x32_bf16 v[8:11], v[240:243], v[104:107], v[8:11]
    ds_read_b64_tr_b16 v[244:245], v3 offset:23552
    ds_read_b64_tr_b16 v[246:247], v3 offset:24064
    s_waitcnt lgkmcnt(0)
    v_mfma_f32_16x16x32_bf16 v[8:11], v[244:247], v[108:111], v[8:11]
    ds_read_b64_tr_b16 v[232:233], v3 offset:24576
    ds_read_b64_tr_b16 v[234:235], v3 offset:25088
    s_waitcnt lgkmcnt(0)
    v_mfma_f32_16x16x32_bf16 v[8:11], v[232:235], v[112:115], v[8:11]
    ds_read_b64_tr_b16 v[236:237], v3 offset:25600
    ds_read_b64_tr_b16 v[238:239], v3 offset:26112
    s_waitcnt lgkmcnt(0)
    v_mfma_f32_16x16x32_bf16 v[8:11], v[236:239], v[116:119], v[8:11]
    ds_read_b64_tr_b16 v[240:241], v3 offset:26624
    ds_read_b64_tr_b16 v[242:243], v3 offset:27136
    s_waitcnt lgkmcnt(0)
    v_mfma_f32_16x16x32_bf16 v[8:11], v[240:243], v[120:123], v[8:11]
    ds_read_b64_tr_b16 v[244:245], v3 offset:27648
    ds_read_b64_tr_b16 v[246:247], v3 offset:28160
    s_waitcnt lgkmcnt(0)
    v_mfma_f32_16x16x32_bf16 v[8:11], v[244:247], v[124:127], v[8:11]
    ds_read_b64_tr_b16 v[232:233], v3 offset:28672
    ds_read_b64_tr_b16 v[234:235], v3 offset:29184
    s_waitcnt lgkmcnt(0)
    v_mfma_f32_16x16x32_bf16 v[8:11], v[232:235], v[128:131], v[8:11]
    ds_read_b64_tr_b16 v[236:237], v3 offset:29696
    ds_read_b64_tr_b16 v[238:239], v3 offset:30208
    s_waitcnt lgkmcnt(0)
    v_mfma_f32_16x16x32_bf16 v[8:11], v[236:239], v[132:135], v[8:11]
    ds_read_b64_tr_b16 v[240:241], v3 offset:30720
    ds_read_b64_tr_b16 v[242:243], v3 offset:31232
    s_waitcnt lgkmcnt(0)
    v_mfma_f32_16x16x32_bf16 v[8:11], v[240:243], v[136:139], v[8:11]
    ds_read_b64_tr_b16 v[244:245], v3 offset:31744
    ds_read_b64_tr_b16 v[246:247], v3 offset:32256
    s_waitcnt lgkmcnt(0)
    v_mfma_f32_16x16x32_bf16 v[8:11], v[244:247], v[140:143], v[8:11]
    ds_read_b64_tr_b16 v[232:233], v3 offset:32768
    ds_read_b64_tr_b16 v[234:235], v3 offset:33280
    s_waitcnt lgkmcnt(0)
    v_mfma_f32_16x16x32_bf16 v[8:11], v[232:235], v[144:147], v[8:11]
    ds_read_b64_tr_b16 v[236:237], v3 offset:33792
    ds_read_b64_tr_b16 v[238:239], v3 offset:34304
    s_waitcnt lgkmcnt(0)
    v_mfma_f32_16x16x32_bf16 v[8:11], v[236:239], v[148:151], v[8:11]
    ds_read_b64_tr_b16 v[240:241], v3 offset:34816
    ds_read_b64_tr_b16 v[242:243], v3 offset:35328
    s_waitcnt lgkmcnt(0)
    v_mfma_f32_16x16x32_bf16 v[8:11], v[240:243], v[152:155], v[8:11]
    ds_read_b64_tr_b16 v[244:245], v3 offset:35840
    ds_read_b64_tr_b16 v[246:247], v3 offset:36352
    s_waitcnt lgkmcnt(0)
    v_mfma_f32_16x16x32_bf16 v[8:11], v[244:247], v[156:159], v[8:11]
    ds_read_b64_tr_b16 v[232:233], v3 offset:36864
    ds_read_b64_tr_b16 v[234:235], v3 offset:37376
    s_waitcnt lgkmcnt(0)
    v_mfma_f32_16x16x32_bf16 v[8:11], v[232:235], v[160:163], v[8:11]
    ds_read_b64_tr_b16 v[236:237], v3 offset:37888
    ds_read_b64_tr_b16 v[238:239], v3 offset:38400
    s_waitcnt lgkmcnt(0)
    v_mfma_f32_16x16x32_bf16 v[8:11], v[236:239], v[164:167], v[8:11]
    ds_read_b64_tr_b16 v[240:241], v3 offset:38912
    ds_read_b64_tr_b16 v[242:243], v3 offset:39424
    s_waitcnt lgkmcnt(0)
    v_mfma_f32_16x16x32_bf16 v[8:11], v[240:243], v[168:171], v[8:11]
    ds_read_b64_tr_b16 v[244:245], v3 offset:39936
    ds_read_b64_tr_b16 v[246:247], v3 offset:40448
    s_waitcnt lgkmcnt(0)
    v_mfma_f32_16x16x32_bf16 v[8:11], v[244:247], v[172:175], v[8:11]
    ds_read_b64_tr_b16 v[232:233], v3 offset:40960
    ds_read_b64_tr_b16 v[234:235], v3 offset:41472
    s_waitcnt lgkmcnt(0)
    v_mfma_f32_16x16x32_bf16 v[8:11], v[232:235], v[176:179], v[8:11]
    ds_read_b64_tr_b16 v[236:237], v3 offset:41984
    ds_read_b64_tr_b16 v[238:239], v3 offset:42496
    s_waitcnt lgkmcnt(0)
    v_mfma_f32_16x16x32_bf16 v[8:11], v[236:239], v[180:183], v[8:11]
    ds_read_b64_tr_b16 v[240:241], v3 offset:43008
    ds_read_b64_tr_b16 v[242:243], v3 offset:43520
    s_waitcnt lgkmcnt(0)
    v_mfma_f32_16x16x32_bf16 v[8:11], v[240:243], v[184:187], v[8:11]
    ds_read_b64_tr_b16 v[244:245], v3 offset:44032
    ds_read_b64_tr_b16 v[246:247], v3 offset:44544
    s_waitcnt lgkmcnt(0)
    v_mfma_f32_16x16x32_bf16 v[8:11], v[244:247], v[188:191], v[8:11]
    ds_read_b64_tr_b16 v[232:233], v3 offset:45056
    ds_read_b64_tr_b16 v[234:235], v3 offset:45568
    s_waitcnt lgkmcnt(0)
    v_mfma_f32_16x16x32_bf16 v[8:11], v[232:235], v[192:195], v[8:11]
    ds_read_b64_tr_b16 v[236:237], v3 offset:46080
    ds_read_b64_tr_b16 v[238:239], v3 offset:46592
    s_waitcnt lgkmcnt(0)
    v_mfma_f32_16x16x32_bf16 v[8:11], v[236:239], v[196:199], v[8:11]
    ds_read_b64_tr_b16 v[240:241], v3 offset:47104
    ds_read_b64_tr_b16 v[242:243], v3 offset:47616
    s_waitcnt lgkmcnt(0)
    v_mfma_f32_16x16x32_bf16 v[8:11], v[240:243], v[200:203], v[8:11]
    ds_read_b64_tr_b16 v[244:245], v3 offset:48128
    ds_read_b64_tr_b16 v[246:247], v3 offset:48640
    s_waitcnt lgkmcnt(0)
    v_mfma_f32_16x16x32_bf16 v[8:11], v[244:247], v[204:207], v[8:11]
    ds_read_b64_tr_b16 v[232:233], v3 offset:49152
    ds_read_b64_tr_b16 v[234:235], v3 offset:49664
    s_waitcnt lgkmcnt(0)
    v_mfma_f32_16x16x32_bf16 v[8:11], v[232:235], v[208:211], v[8:11]
    ds_read_b64_tr_b16 v[236:237], v3 offset:50176
    ds_read_b64_tr_b16 v[238:239], v3 offset:50688
    s_waitcnt lgkmcnt(0)
    v_mfma_f32_16x16x32_bf16 v[8:11], v[236:239], v[212:215], v[8:11]
    ds_read_b64_tr_b16 v[240:241], v3 offset:51200
    ds_read_b64_tr_b16 v[242:243], v3 offset:51712
    s_waitcnt lgkmcnt(0)
    v_mfma_f32_16x16x32_bf16 v[8:11], v[240:243], v[216:219], v[8:11]
    ds_read_b64_tr_b16 v[244:245], v3 offset:52224
    ds_read_b64_tr_b16 v[246:247], v3 offset:52736
    s_waitcnt lgkmcnt(0)
    v_mfma_f32_16x16x32_bf16 v[8:11], v[244:247], v[220:223], v[8:11]
    ds_read_b64_tr_b16 v[232:233], v3 offset:53248
    ds_read_b64_tr_b16 v[234:235], v3 offset:53760
    s_waitcnt lgkmcnt(0)
    v_mfma_f32_16x16x32_bf16 v[8:11], v[232:235], v[224:227], v[8:11]
    ds_read_b64_tr_b16 v[236:237], v3 offset:54272
    ds_read_b64_tr_b16 v[238:239], v3 offset:54784
    s_waitcnt lgkmcnt(0)
    v_mfma_f32_16x16x32_bf16 v[8:11], v[236:239], v[228:231], v[8:11]
    v_and_b32 v7, 7, v0
    v_lshlrev_b32 v7, 2, v7
    s_mov_b32 s64, 0x5400020
    buffer_load_dword v12, v7, s[4:7], s64 offen sc1
    s_waitcnt vmcnt(0)
    s_nop 7
    v_cvt_pk_bf16_f32 v8, v8, v8
    v_lshlrev_b32 v8, 16, v8
    v_mul_f32 v8, v8, v12
    v_cvt_pk_bf16_f32 v8, v8, v8
    v_lshlrev_b32 v8, 16, v8
    v_cvt_pk_bf16_f32 v9, v9, v9
    v_lshlrev_b32 v9, 16, v9
    v_mul_f32 v9, v9, v12
    v_cvt_pk_bf16_f32 v9, v9, v9
    v_lshlrev_b32 v9, 16, v9
    v_cvt_pk_bf16_f32 v10, v10, v10
    v_lshlrev_b32 v10, 16, v10
    v_mul_f32 v10, v10, v12
    v_cvt_pk_bf16_f32 v10, v10, v10
    v_lshlrev_b32 v10, 16, v10
    v_cvt_pk_bf16_f32 v11, v11, v11
    v_lshlrev_b32 v11, 16, v11
    v_mul_f32 v11, v11, v12
    v_cvt_pk_bf16_f32 v11, v11, v11
    v_lshlrev_b32 v11, 16, v11
    v_and_b32 v7, 7, v0
    v_mul_u32_u24 v7, 2560, v7
    v_lshrrev_b32 v13, 4, v0
    v_lshl_add_u32 v7, v13, 4, v7
    s_lshl_b32 s64, s24, 6
    s_add_u32 s64, s64, 0x5410000
    s_mov_b32 s68, 0x00ff00ff
    s_mov_b32 s69, 0x00ff00ff
    s_mov_b64 exec, s[68:69]
    buffer_store_dwordx4 v[8:11], v7, s[4:7], s64 offen sc1
    s_mov_b64 exec, -1
    s_waitcnt vmcnt(0)
    v_mov_b32 v7, 1
    v_mov_b32 v8, 0
    s_mov_b32 s64, 0x298100
    s_mov_b64 exec, 1
    buffer_atomic_add v7, v8, s[4:7], s64 offen sc1
    s_mov_b64 exec, -1
H_ATT:
    v_mbcnt_lo_u32_b32 v0, -1, 0
    v_mbcnt_hi_u32_b32 v0, -1, v0
    s_mov_b32 s29, 0
    v_lshlrev_b32 v1, 4, v0
    v_lshrrev_b32 v5, 4, v0
    v_lshlrev_b32 v2, 7, v5
    v_and_b32 v5, 7, v0
    v_lshl_add_u32 v2, v5, 4, v2
    v_bfe_u32 v5, v0, 4, 1
    v_lshlrev_b32 v3, 7, v5
    v_and_b32 v5, 15, v0
    v_lshl_add_u32 v3, v5, 3, v3
    s_mov_b32 s34, 0x3e0293ee
    s_mov_b32 s35, 0x3e0293ee
    s_mov_b32 s36, -1
    s_mov_b32 s37, 0
    v_lshrrev_b32 v5, 4, v0
    v_lshlrev_b32 v5, 2, v5
    v_and_b32 v6, 15, v0
    v_add_u32 v7, 0, v5
    v_cmp_le_u32 s[38:39], v7, v6
    v_add_u32 v7, 1, v5
    v_cmp_le_u32 s[40:41], v7, v6
    v_add_u32 v7, 2, v5
    v_cmp_le_u32 s[42:43], v7, v6
    v_add_u32 v7, 3, v5
    v_cmp_le_u32 s[44:45], v7, v6
    v_mov_b32 v248, 0x3f803f80
    v_mov_b32 v249, 0x3f803f80
    v_mov_b32 v250, 0x3f803f80
    v_mov_b32 v251, 0x3f803f80
    s_lshl_b32 s24, s12, 2
    s_add_u32 s24, s24, s14
    s_add_u32 s24, s24, 16
    s_mov_b32 s25, 2
AT2_LOOP:
    s_lshl_b32 s64, s24, 5
    s_add_u32 s64, s64, s13
    s_lshl_b32 s26, s64, 13
    s_add_u32 s26, s26, 0x3400000
    s_lshl_b32 s27, s64, 14
    s_add_u32 s27, s27, 0x1400000
    s_lshl_b32 s65, s64, 11
    s_add_u32 s30, s65, 0x640000
    s_add_u32 s31, s65, 0xa40000
    s_lshl_b32 s33, s64, 2
    s_add_u32 s33, s33, 0x296000
    s_lshl_b32 s32, s24, 18
    s_lshl_b32 s65, s13, 12
    s_add_u32 s32, s32, s65
    s_add_u32 s32, s32, 0x4400000
    s_lshr_b32 s65, s24, 2
    s_lshl_b32 s65, s65, 9
    s_lshl_b32 s66, s13, 4
    s_add_u32 s65, s65, s66
    s_add_u32 s65, s65, 0x291000
    s_lshr_b32 s66, s24, 1
    s_lshl_b32 s66, s66, 8
    s_lshl_b32 s64, s13, 3
    s_add_u32 s66, s66, s64
    s_add_u32 s66, s66, 0x293ff4
    v_lshlrev_b32 v5, 2, v0
    v_mov_b32 v6, s65
    v_mov_b32 v7, s66
    v_cmp_gt_u32 vcc, 3, v0
    s_nop 1
    v_cndmask_b32 v6, v7, v6, vcc
    v_add_u32 v4, v5, v6
    s_mov_b32 s64, 0
    s_mov_b64 exec, 7
AT2_F_166:
    buffer_load_dword v5, v4, s[4:7], s64 offen sc1
    s_add_u32 s29, s29, 1
    s_waitcnt vmcnt(0)
    v_cmp_eq_u32 vcc, 0, v5
    s_cbranch_vccz AT2_FD_167
    s_cmp_gt_u32 s29, 262144
    s_cbranch_scc1 AT2_FD_167
    s_sleep 1
    s_branch AT2_F_166
AT2_FD_167:
    s_mov_b64 exec, -1
    buffer_load_dwordx4 v[16:19], v1, s[4:7], s26 offen offset:0
    buffer_load_dwordx4 v[20:23], v1, s[4:7], s26 offen offset:1024
    buffer_load_dwordx4 v[24:27], v1, s[4:7], s26 offen offset:2048
    buffer_load_dwordx4 v[28:31], v1, s[4:7], s26 offen offset:3072
    s_add_u32 s26, s26, 4096
    buffer_load_dwordx4 v[32:35], v1, s[4:7], s26 offen offset:0
    buffer_load_dwordx4 v[36:39], v1, s[4:7], s26 offen offset:1024
    buffer_load_dwordx4 v[40:43], v1, s[4:7], s26 offen offset:2048
    buffer_load_dwordx4 v[44:47], v1, s[4:7], s26 offen offset:3072
    buffer_load_dwordx4 v[48:51], v1, s[4:7], s27 offen offset:0
    buffer_load_dwordx4 v[52:55], v1, s[4:7], s27 offen offset:1024
    buffer_load_dwordx4 v[56:59], v1, s[4:7], s27 offen offset:2048
    buffer_load_dwordx4 v[60:63], v1, s[4:7], s27 offen offset:3072
    s_add_u32 s27, s27, 4096
    buffer_load_dwordx4 v[64:67], v1, s[4:7], s27 offen offset:0
    buffer_load_dwordx4 v[68:71], v1, s[4:7], s27 offen offset:1024
    buffer_load_dwordx4 v[72:75], v1, s[4:7], s27 offen offset:2048
    buffer_load_dwordx4 v[76:79], v1, s[4:7], s27 offen offset:3072
    s_add_u32 s27, s27, 4096
    buffer_load_dwordx4 v[80:83], v1, s[4:7], s27 offen offset:0
    buffer_load_dwordx4 v[84:87], v1, s[4:7], s27 offen offset:1024
    buffer_load_dwordx4 v[88:91], v1, s[4:7], s27 offen offset:2048
    buffer_load_dwordx4 v[92:95], v1, s[4:7], s27 offen offset:3072
    s_add_u32 s27, s27, 4096
    buffer_load_dwordx4 v[96:99], v1, s[4:7], s27 offen offset:0
    buffer_load_dwordx4 v[100:103], v1, s[4:7], s27 offen offset:1024
    buffer_load_dwordx4 v[104:107], v1, s[4:7], s27 offen offset:2048
    buffer_load_dwordx4 v[108:111], v1, s[4:7], s27 offen offset:3072
    s_mov_b64 exec, 0x18
AT2_G_168:
    buffer_load_dword v5, v4, s[4:7], s64 offen sc1
    s_add_u32 s29, s29, 1
    s_waitcnt vmcnt(0)
    v_cmp_eq_u32 vcc, 0, v5
    s_cbranch_vccz AT2_GD_169
    s_cmp_gt_u32 s29, 262144
    s_cbranch_scc1 AT2_GD_169
    s_sleep 1
    s_branch AT2_G_168
AT2_GD_169:
    s_mov_b64 exec, -1
    buffer_load_dwordx4 v[112:115], v2, s[4:7], s30 offen offset:0
    buffer_load_dwordx4 v[116:119], v2, s[4:7], s30 offen offset:512
    buffer_load_dwordx4 v[120:123], v2, s[4:7], s30 offen offset:1024
    buffer_load_dwordx4 v[124:127], v2, s[4:7], s30 offen offset:1536
    buffer_load_dwordx2 v[128:129], v3, s[4:7], s31 offen offset:0
    buffer_load_dwordx2 v[130:131], v3, s[4:7], s31 offen offset:256
    buffer_load_dwordx2 v[132:133], v3, s[4:7], s31 offen offset:512
    buffer_load_dwordx2 v[134:135], v3, s[4:7], s31 offen offset:768
    buffer_load_dwordx2 v[136:137], v3, s[4:7], s31 offen offset:1024
    buffer_load_dwordx2 v[138:139], v3, s[4:7], s31 offen offset:1280
    buffer_load_dwordx2 v[140:141], v3, s[4:7], s31 offen offset:1536
    buffer_load_dwordx2 v[142:143], v3, s[4:7], s31 offen offset:1792
    v_mfma_f32_16x16x32_bf16 v[148:151], v[48:51], v[16:19], 0
    v_mfma_f32_16x16x32_bf16 v[156:159], v[48:51], v[32:35], 0
    v_mfma_f32_16x16x32_bf16 v[160:163], v[64:67], v[32:35], 0
    v_mfma_f32_16x16x32_bf16 v[148:151], v[52:55], v[20:23], v[148:151]
    v_mfma_f32_16x16x32_bf16 v[156:159], v[52:55], v[36:39], v[156:159]
    v_mfma_f32_16x16x32_bf16 v[160:163], v[68:71], v[36:39], v[160:163]
    v_mfma_f32_16x16x32_bf16 v[148:151], v[56:59], v[24:27], v[148:151]
    v_mfma_f32_16x16x32_bf16 v[156:159], v[56:59], v[40:43], v[156:159]
    v_mfma_f32_16x16x32_bf16 v[160:163], v[72:75], v[40:43], v[160:163]
    v_mfma_f32_16x16x32_bf16 v[148:151], v[60:63], v[28:31], v[148:151]
    v_mfma_f32_16x16x32_bf16 v[156:159], v[60:63], v[44:47], v[156:159]
    v_mfma_f32_16x16x32_bf16 v[160:163], v[76:79], v[44:47], v[160:163]
    s_waitcnt vmcnt(8)
    v_mfma_f32_16x16x32_bf16 v[144:147], v[112:115], v[16:19], 0
    v_mfma_f32_16x16x32_bf16 v[152:155], v[112:115], v[32:35], 0
    v_mfma_f32_16x16x32_bf16 v[144:147], v[116:119], v[20:23], v[144:147]
    v_mfma_f32_16x16x32_bf16 v[152:155], v[116:119], v[36:39], v[152:155]
    v_mfma_f32_16x16x32_bf16 v[144:147], v[120:123], v[24:27], v[144:147]
    v_mfma_f32_16x16x32_bf16 v[152:155], v[120:123], v[40:43], v[152:155]
    v_mfma_f32_16x16x32_bf16 v[144:147], v[124:127], v[28:31], v[144:147]
    v_mfma_f32_16x16x32_bf16 v[152:155], v[124:127], v[44:47], v[152:155]
    v_mov_b32 v11, 0xff800000
    s_nop 7
    v_cndmask_b32 v148, v11, v148, s[38:39]
    v_cndmask_b32 v160, v11, v160, s[38:39]
    v_cndmask_b32 v144, v11, v144, s[36:37]
    v_cndmask_b32 v152, v11, v152, s[36:37]
    v_cndmask_b32 v149, v11, v149, s[40:41]
    v_cndmask_b32 v161, v11, v161, s[40:41]
    v_cndmask_b32 v145, v11, v145, s[36:37]
    v_cndmask_b32 v153, v11, v153, s[36:37]
    v_cndmask_b32 v150, v11, v150, s[42:43]
    v_cndmask_b32 v162, v11, v162, s[42:43]
    v_cndmask_b32 v146, v11, v146, s[36:37]
    v_cndmask_b32 v154, v11, v154, s[36:37]
    v_cndmask_b32 v151, v11, v151, s[44:45]
    v_cndmask_b32 v163, v11, v163, s[44:45]
    v_cndmask_b32 v147, v11, v147, s[36:37]
    v_cndmask_b32 v155, v11, v155, s[36:37]
    v_max3_f32 v8, v144, v145, v146
    v_max3_f32 v8, v8, v147, v148
    v_max3_f32 v8, v8, v149, v150
    v_max_f32 v8, v8, v151
    v_mov_b32 v9, v8
    s_nop 1
    v_permlane16_swap_b32 v8, v9
    v_max_f32 v8, v8, v9
    v_mov_b32 v9, v8
    s_nop 1
    v_permlane32_swap_b32 v8, v9
    v_max_f32 v8, v8, v9
    v_mul_f32 v8, s34, v8
    v_fma_f32 v144, v144, s34, -v8
    v_fma_f32 v145, v145, s34, -v8
    v_fma_f32 v146, v146, s34, -v8
    v_fma_f32 v147, v147, s34, -v8
    v_fma_f32 v148, v148, s34, -v8
    v_fma_f32 v149, v149, s34, -v8
    v_fma_f32 v150, v150, s34, -v8
    v_fma_f32 v151, v151, s34, -v8
    v_exp_f32 v144, v144
    v_exp_f32 v145, v145
    v_exp_f32 v146, v146
    v_exp_f32 v147, v147
    v_exp_f32 v148, v148
    v_exp_f32 v149, v149
    v_exp_f32 v150, v150
    v_exp_f32 v151, v151
    s_nop 0
    v_cvt_pk_bf16_f32 v164, v148, v149
    v_cvt_pk_bf16_f32 v165, v150, v151
    v_mov_b32 v166, 0
    v_mov_b32 v167, 0
    v_cvt_pk_bf16_f32 v168, v144, v145
    v_cvt_pk_bf16_f32 v169, v146, v147
    v_max3_f32 v8, v152, v153, v154
    v_max3_f32 v8, v8, v155, v156
    v_max3_f32 v8, v8, v157, v158
    v_max3_f32 v8, v8, v159, v160
    v_max3_f32 v8, v8, v161, v162
    v_max_f32 v8, v8, v163
    v_mov_b32 v9, v8
    s_nop 1
    v_permlane16_swap_b32 v8, v9
    v_max_f32 v8, v8, v9
    v_mov_b32 v9, v8
    s_nop 1
    v_permlane32_swap_b32 v8, v9
    v_max_f32 v8, v8, v9
    v_mul_f32 v8, s34, v8
    v_fma_f32 v152, v152, s34, -v8
    v_fma_f32 v153, v153, s34, -v8
    v_fma_f32 v154, v154, s34, -v8
    v_fma_f32 v155, v155, s34, -v8
    v_fma_f32 v156, v156, s34, -v8
    v_fma_f32 v157, v157, s34, -v8
    v_fma_f32 v158, v158, s34, -v8
    v_fma_f32 v159, v159, s34, -v8
    v_fma_f32 v160, v160, s34, -v8
    v_fma_f32 v161, v161, s34, -v8
    v_fma_f32 v162, v162, s34, -v8
    v_fma_f32 v163, v163, s34, -v8
    v_exp_f32 v152, v152
    v_exp_f32 v153, v153
    v_exp_f32 v154, v154
    v_exp_f32 v155, v155
    v_exp_f32 v156, v156
    v_exp_f32 v157, v157
    v_exp_f32 v158, v158
    v_exp_f32 v159, v159
    v_exp_f32 v160, v160
    v_exp_f32 v161, v161
    v_exp_f32 v162, v162
    v_exp_f32 v163, v163
    s_nop 0
    v_cvt_pk_bf16_f32 v170, v156, v157
    v_cvt_pk_bf16_f32 v171, v158, v159
    v_cvt_pk_bf16_f32 v172, v160, v161
    v_cvt_pk_bf16_f32 v173, v162, v163
    v_cvt_pk_bf16_f32 v174, v152, v153
    v_cvt_pk_bf16_f32 v175, v154, v155
    s_waitcnt vmcnt(0)
    v_mfma_f32_16x16x32_bf16 v[240:243], v[248:251], v[164:167], 0
    v_mfma_f32_16x16x32_bf16 v[244:247], v[248:251], v[170:173], 0
    v_mfma_f32_16x16x32_bf16 v[176:179], v[80:83], v[164:167], 0
    v_mfma_f32_16x16x32_bf16 v[180:183], v[80:83], v[170:173], 0
    v_mfma_f32_16x16x32_bf16 v[184:187], v[84:87], v[164:167], 0
    v_mfma_f32_16x16x32_bf16 v[188:191], v[84:87], v[170:173], 0
    v_mfma_f32_16x16x32_bf16 v[192:195], v[88:91], v[164:167], 0
    v_mfma_f32_16x16x32_bf16 v[196:199], v[88:91], v[170:173], 0
    v_mfma_f32_16x16x32_bf16 v[200:203], v[92:95], v[164:167], 0
    v_mfma_f32_16x16x32_bf16 v[204:207], v[92:95], v[170:173], 0
    v_mfma_f32_16x16x32_bf16 v[208:211], v[96:99], v[164:167], 0
    v_mfma_f32_16x16x32_bf16 v[212:215], v[96:99], v[170:173], 0
    v_mfma_f32_16x16x32_bf16 v[216:219], v[100:103], v[164:167], 0
    v_mfma_f32_16x16x32_bf16 v[220:223], v[100:103], v[170:173], 0
    v_mfma_f32_16x16x32_bf16 v[224:227], v[104:107], v[164:167], 0
    v_mfma_f32_16x16x32_bf16 v[228:231], v[104:107], v[170:173], 0
    v_mfma_f32_16x16x32_bf16 v[232:235], v[108:111], v[164:167], 0
    v_mfma_f32_16x16x32_bf16 v[236:239], v[108:111], v[170:173], 0
    v_mfma_f32_16x16x16_bf16 v[240:243], v[248:249], v[168:169], v[240:243]
    v_mfma_f32_16x16x16_bf16 v[244:247], v[248:249], v[174:175], v[244:247]
    v_mfma_f32_16x16x16_bf16 v[176:179], v[128:129], v[168:169], v[176:179]
    v_mfma_f32_16x16x16_bf16 v[180:183], v[128:129], v[174:175], v[180:183]
    v_mfma_f32_16x16x16_bf16 v[184:187], v[130:131], v[168:169], v[184:187]
    v_mfma_f32_16x16x16_bf16 v[188:191], v[130:131], v[174:175], v[188:191]
    v_mfma_f32_16x16x16_bf16 v[192:195], v[132:133], v[168:169], v[192:195]
    v_mfma_f32_16x16x16_bf16 v[196:199], v[132:133], v[174:175], v[196:199]
    v_mfma_f32_16x16x16_bf16 v[200:203], v[134:135], v[168:169], v[200:203]
    v_mfma_f32_16x16x16_bf16 v[204:207], v[134:135], v[174:175], v[204:207]
    v_mfma_f32_16x16x16_bf16 v[208:211], v[136:137], v[168:169], v[208:211]
    v_mfma_f32_16x16x16_bf16 v[212:215], v[136:137], v[174:175], v[212:215]
    v_mfma_f32_16x16x16_bf16 v[216:219], v[138:139], v[168:169], v[216:219]
    v_mfma_f32_16x16x16_bf16 v[220:223], v[138:139], v[174:175], v[220:223]
    v_mfma_f32_16x16x16_bf16 v[224:227], v[140:141], v[168:169], v[224:227]
    v_mfma_f32_16x16x16_bf16 v[228:231], v[140:141], v[174:175], v[228:231]
    v_mfma_f32_16x16x16_bf16 v[232:235], v[142:143], v[168:169], v[232:235]
    v_mfma_f32_16x16x16_bf16 v[236:239], v[142:143], v[174:175], v[236:239]
    v_rcp_f32 v8, v240
    v_rcp_f32 v9, v244
    s_nop 7
    v_mul_f32 v176, v176, v8
    v_mul_f32 v177, v177, v8
    v_mul_f32 v178, v178, v8
    v_mul_f32 v179, v179, v8
    v_cvt_pk_bf16_f32 v16, v176, v177
    v_cvt_pk_bf16_f32 v17, v178, v179
    v_mul_f32 v184, v184, v8
    v_mul_f32 v185, v185, v8
    v_mul_f32 v186, v186, v8
    v_mul_f32 v187, v187, v8
    v_cvt_pk_bf16_f32 v18, v184, v185
    v_cvt_pk_bf16_f32 v19, v186, v187
    s_add_u32 s64, s32, 0x0
    buffer_store_dwordx4 v[16:19], v1, s[4:7], s64 offen offset:0 sc1
    v_mul_f32 v192, v192, v8
    v_mul_f32 v193, v193, v8
    v_mul_f32 v194, v194, v8
    v_mul_f32 v195, v195, v8
    v_cvt_pk_bf16_f32 v20, v192, v193
    v_cvt_pk_bf16_f32 v21, v194, v195
    v_mul_f32 v200, v200, v8
    v_mul_f32 v201, v201, v8
    v_mul_f32 v202, v202, v8
    v_mul_f32 v203, v203, v8
    v_cvt_pk_bf16_f32 v22, v200, v201
    v_cvt_pk_bf16_f32 v23, v202, v203
    s_add_u32 s64, s32, 0x0
    buffer_store_dwordx4 v[20:23], v1, s[4:7], s64 offen offset:1024 sc1
    v_mul_f32 v208, v208, v8
    v_mul_f32 v209, v209, v8
    v_mul_f32 v210, v210, v8
    v_mul_f32 v211, v211, v8
    v_cvt_pk_bf16_f32 v24, v208, v209
    v_cvt_pk_bf16_f32 v25, v210, v211
    v_mul_f32 v216, v216, v8
    v_mul_f32 v217, v217, v8
    v_mul_f32 v218, v218, v8
    v_mul_f32 v219, v219, v8
    v_cvt_pk_bf16_f32 v26, v216, v217
    v_cvt_pk_bf16_f32 v27, v218, v219
    s_add_u32 s64, s32, 0x0
    buffer_store_dwordx4 v[24:27], v1, s[4:7], s64 offen offset:2048 sc1
    v_mul_f32 v224, v224, v8
    v_mul_f32 v225, v225, v8
    v_mul_f32 v226, v226, v8
    v_mul_f32 v227, v227, v8
    v_cvt_pk_bf16_f32 v28, v224, v225
    v_cvt_pk_bf16_f32 v29, v226, v227
    v_mul_f32 v232, v232, v8
    v_mul_f32 v233, v233, v8
    v_mul_f32 v234, v234, v8
    v_mul_f32 v235, v235, v8
    v_cvt_pk_bf16_f32 v30, v232, v233
    v_cvt_pk_bf16_f32 v31, v234, v235
    s_add_u32 s64, s32, 0x0
    buffer_store_dwordx4 v[28:31], v1, s[4:7], s64 offen offset:3072 sc1
    v_mul_f32 v180, v180, v9
    v_mul_f32 v181, v181, v9
    v_mul_f32 v182, v182, v9
    v_mul_f32 v183, v183, v9
    v_cvt_pk_bf16_f32 v32, v180, v181
    v_cvt_pk_bf16_f32 v33, v182, v183
    v_mul_f32 v188, v188, v9
    v_mul_f32 v189, v189, v9
    v_mul_f32 v190, v190, v9
    v_mul_f32 v191, v191, v9
    v_cvt_pk_bf16_f32 v34, v188, v189
    v_cvt_pk_bf16_f32 v35, v190, v191
    s_add_u32 s64, s32, 0x20000
    buffer_store_dwordx4 v[32:35], v1, s[4:7], s64 offen offset:0 sc1
    v_mul_f32 v196, v196, v9
    v_mul_f32 v197, v197, v9
    v_mul_f32 v198, v198, v9
    v_mul_f32 v199, v199, v9
    v_cvt_pk_bf16_f32 v36, v196, v197
    v_cvt_pk_bf16_f32 v37, v198, v199
    v_mul_f32 v204, v204, v9
    v_mul_f32 v205, v205, v9
    v_mul_f32 v206, v206, v9
    v_mul_f32 v207, v207, v9
    v_cvt_pk_bf16_f32 v38, v204, v205
    v_cvt_pk_bf16_f32 v39, v206, v207
    s_add_u32 s64, s32, 0x20000
    buffer_store_dwordx4 v[36:39], v1, s[4:7], s64 offen offset:1024 sc1
    v_mul_f32 v212, v212, v9
    v_mul_f32 v213, v213, v9
    v_mul_f32 v214, v214, v9
    v_mul_f32 v215, v215, v9
    v_cvt_pk_bf16_f32 v40, v212, v213
    v_cvt_pk_bf16_f32 v41, v214, v215
    v_mul_f32 v220, v220, v9
    v_mul_f32 v221, v221, v9
    v_mul_f32 v222, v222, v9
    v_mul_f32 v223, v223, v9
    v_cvt_pk_bf16_f32 v42, v220, v221
    v_cvt_pk_bf16_f32 v43, v222, v223
    s_add_u32 s64, s32, 0x20000
    buffer_store_dwordx4 v[40:43], v1, s[4:7], s64 offen offset:2048 sc1
    v_mul_f32 v228, v228, v9
    v_mul_f32 v229, v229, v9
    v_mul_f32 v230, v230, v9
    v_mul_f32 v231, v231, v9
    v_cvt_pk_bf16_f32 v44, v228, v229
    v_cvt_pk_bf16_f32 v45, v230, v231
    v_mul_f32 v236, v236, v9
    v_mul_f32 v237, v237, v9
    v_mul_f32 v238, v238, v9
    v_mul_f32 v239, v239, v9
    v_cvt_pk_bf16_f32 v46, v236, v237
    v_cvt_pk_bf16_f32 v47, v238, v239
    s_add_u32 s64, s32, 0x20000
    buffer_store_dwordx4 v[44:47], v1, s[4:7], s64 offen offset:3072 sc1
    s_waitcnt vmcnt(0)
    v_mov_b32 v7, 1
    v_mov_b32 v8, 0
    s_mov_b64 exec, 1
    buffer_store_dword v7, v8, s[4:7], s33 offen sc1
    s_mov_b64 exec, -1
    s_add_u32 s24, s24, 8
    s_add_u32 s25, s25, 1
    s_cmp_lt_u32 s25, 8
    s_cbranch_scc1 AT2_LOOP
M_EXIT:
    s_endpgm
.section .rodata,"a"
.p2align 6
.amdhsa_kernel main_kernel
  .amdhsa_next_free_vgpr 512
  .amdhsa_next_free_sgpr 102
  .amdhsa_accum_offset 256
  .amdhsa_group_segment_fixed_size 0
  .amdhsa_kernarg_size 120
  .amdhsa_user_sgpr_count 2
  .amdhsa_user_sgpr_kernarg_segment_ptr 1
  .amdhsa_system_sgpr_workgroup_id_x 1
.end_amdhsa_kernel
```

```asm
; @launch kernel=main_kernel grid=(256,1,1) block=(256,1,1) lds=163840
.amdgcn_target "amdgcn-amd-amdhsa--gfx950"
.text
.globl main_kernel
.p2align 8
.type main_kernel,@function
main_kernel:
    s_cmp_ge_u32 s2, 256
    s_cbranch_scc1 M_EXIT
    s_load_dwordx2 s[4:5], s[0:1], 112
    s_mov_b32 s6, 0x10000000
    s_mov_b32 s7, 0x00020000
    s_load_dwordx2 s[60:61], s[0:1], 104
    s_mov_b32 s62, 256
    s_mov_b32 s63, 0x00020000
    v_lshrrev_b32 v1, 6, v0
    v_and_b32 v0, 63, v0
    s_nop 0
    v_readfirstlane_b32 s14, v1
    s_getreg_b32 s98, hwreg(HW_REG_XCC_ID)
    s_and_b32 s98, s98, 7
    s_mov_b32 s97, 0
    s_mov_b32 s95, 4
    s_waitcnt lgkmcnt(0)
    s_cmp_lg_u32 s14, 0
    s_cbranch_scc1 NOMEAS_1
    s_and_b32 s64, s2, 0xfffffffd
    s_cmp_lg_u32 s64, 1
    s_cbranch_scc1 NOMEAS_1
    s_lshr_b32 s70, s2, 1
    s_mov_b32 s72, s60
    s_mov_b32 s73, s61
    s_mov_b32 s74, s62
    s_mov_b32 s75, s63
    s_lshl_b32 s60, s70, 21
    s_add_u32 s60, s60, 0x6001800
    v_mov_b32 v60, 0
    v_mov_b32 v61, -1
    s_mov_b32 s66, 0x7fffffff
    s_mov_b32 s67, 0x7fffffff
    s_mov_b32 s68, 0x7fffffff
    s_mov_b32 s69, 0x7fffffff
    s_mov_b64 exec, 1
    s_add_u32 s61, s60, 0
    s_memtime s[62:63]
    s_waitcnt lgkmcnt(0)
    buffer_store_dword v61, v60, s[4:7], s61 offen offset:0 sc1
    s_waitcnt vmcnt(0)
    s_memtime s[64:65]
    s_waitcnt lgkmcnt(0)
    s_sub_u32 s62, s64, s62
    s_min_u32 s66, s66, s62
    s_add_u32 s61, s60, 8192
    s_memtime s[62:63]
    s_waitcnt lgkmcnt(0)
    buffer_store_dword v61, v60, s[4:7], s61 offen offset:0 sc1
    s_waitcnt vmcnt(0)
    s_memtime s[64:65]
    s_waitcnt lgkmcnt(0)
    s_sub_u32 s62, s64, s62
    s_min_u32 s67, s67, s62
    s_add_u32 s61, s60, 16384
    s_memtime s[62:63]
    s_waitcnt lgkmcnt(0)
    buffer_store_dword v61, v60, s[4:7], s61 offen offset:0 sc1
    s_waitcnt vmcnt(0)
    s_memtime s[64:65]
    s_waitcnt lgkmcnt(0)
    s_sub_u32 s62, s64, s62
    s_min_u32 s68, s68, s62
    s_add_u32 s61, s60, 24576
    s_memtime s[62:63]
    s_waitcnt lgkmcnt(0)
    buffer_store_dword v61, v60, s[4:7], s61 offen offset:0 sc1
    s_waitcnt vmcnt(0)
    s_memtime s[64:65]
    s_waitcnt lgkmcnt(0)
    s_sub_u32 s62, s64, s62
    s_min_u32 s69, s69, s62
    s_add_u32 s61, s60, 0
    s_memtime s[62:63]
    s_waitcnt lgkmcnt(0)
    buffer_store_dword v61, v60, s[4:7], s61 offen offset:128 sc1
    s_waitcnt vmcnt(0)
    s_memtime s[64:65]
    s_waitcnt lgkmcnt(0)
    s_sub_u32 s62, s64, s62
    s_min_u32 s66, s66, s62
    s_add_u32 s61, s60, 8192
    s_memtime s[62:63]
    s_waitcnt lgkmcnt(0)
    buffer_store_dword v61, v60, s[4:7], s61 offen offset:128 sc1
    s_waitcnt vmcnt(0)
    s_memtime s[64:65]
    s_waitcnt lgkmcnt(0)
    s_sub_u32 s62, s64, s62
    s_min_u32 s67, s67, s62
    s_add_u32 s61, s60, 16384
    s_memtime s[62:63]
    s_waitcnt lgkmcnt(0)
    buffer_store_dword v61, v60, s[4:7], s61 offen offset:128 sc1
    s_waitcnt vmcnt(0)
    s_memtime s[64:65]
    s_waitcnt lgkmcnt(0)
    s_sub_u32 s62, s64, s62
    s_min_u32 s68, s68, s62
    s_add_u32 s61, s60, 24576
    s_memtime s[62:63]
    s_waitcnt lgkmcnt(0)
    buffer_store_dword v61, v60, s[4:7], s61 offen offset:128 sc1
    s_waitcnt vmcnt(0)
    s_memtime s[64:65]
    s_waitcnt lgkmcnt(0)
    s_sub_u32 s62, s64, s62
    s_min_u32 s69, s69, s62
    s_mov_b64 exec, -1
    s_mov_b32 s60, 0
    s_mov_b32 s61, s66
    s_cmp_lt_u32 s67, s61
    s_cselect_b32 s60, 1, s60
    s_min_u32 s61, s61, s67
    s_cmp_lt_u32 s68, s61
    s_cselect_b32 s60, 2, s60
    s_min_u32 s61, s61, s68
    s_cmp_lt_u32 s69, s61
    s_cselect_b32 s60, 3, s60
    s_min_u32 s61, s61, s69
    s_and_b32 s61, s98, 1
    s_lshl_b32 s61, s61, 1
    s_lshr_b32 s62, s98, 2
    s_add_u32 s61, s61, s62
    s_xor_b32 s60, s60, s61
    s_add_u32 s71, s60, 1
    s_mov_b32 s60, s72
    s_mov_b32 s61, s73
    s_mov_b32 s62, s74
    s_mov_b32 s63, s75
    s_lshl_b32 s70, s70, 2
    s_add_u32 s70, s70, 132
    v_mov_b32 v61, s71
    s_mov_b64 exec, 1
    buffer_store_dword v61, off, s[60:63], s70 sc1
    s_mov_b64 exec, -1
NOMEAS_1:
    s_cmp_lg_u32 s14, 0
    s_cbranch_scc1 M_TICKW
    s_mul_i32 s64, s98, 32
    s_add_u32 s64, s64, 0x0
    v_mov_b32 v1, 0
    v_mov_b32 v2, 1
    s_mov_b64 exec, 1
    buffer_atomic_add v2, v1, s[60:63], s64 offen sc0
    s_waitcnt vmcnt(0)
    ds_write_b32 v1, v2
    s_waitcnt lgkmcnt(0)
    s_mov_b64 exec, -1
M_TICKW:
    s_barrier
    v_mov_b32 v1, 0
    ds_read_b32 v2, v1
    s_waitcnt lgkmcnt(0)
    v_readfirstlane_b32 s99, v2
    s_barrier
    s_cmp_ge_u32 s99, 32
    s_cbranch_scc1 M_SLOW0
    s_mov_b32 s12, s98
    s_cmp_eq_u32 s12, 0
    s_cbranch_scc1 XOK_2
    s_cmp_eq_u32 s12, 2
    s_cbranch_scc0 M_FH
    s_mov_b32 s12, 1
XOK_2:
    s_mov_b32 s13, s99
    s_branch M_REC
M_FH:
    s_sub_u32 s96, s98, 1
    s_cmp_gt_u32 s98, 2
    s_cselect_b32 s64, 1, 0
    s_sub_u32 s96, s96, s64
    s_lshl_b32 s96, s96, 5
    s_add_u32 s96, s96, s99
    s_branch M_HELP
M_SLOW0:
    v_mbcnt_lo_u32_b32 v0, -1, 0
    v_mbcnt_hi_u32_b32 v0, -1, v0
    v_mul_u32_u24 v8, 32, v0
    s_mov_b32 s64, 0x0
    s_mov_b32 s65, 0
    s_mov_b64 exec, 0xff
TK_3:
    buffer_load_dword v9, v8, s[60:63], s64 offen sc1
    s_add_u32 s65, s65, 1
    s_waitcnt vmcnt(0)
    s_mov_b32 s66, 0
    v_readlane_b32 s67, v9, 0
    s_add_u32 s66, s66, s67
    v_readlane_b32 s67, v9, 1
    s_add_u32 s66, s66, s67
    v_readlane_b32 s67, v9, 2
    s_add_u32 s66, s66, s67
    v_readlane_b32 s67, v9, 3
    s_add_u32 s66, s66, s67
    v_readlane_b32 s67, v9, 4
    s_add_u32 s66, s66, s67
    v_readlane_b32 s67, v9, 5
    s_add_u32 s66, s66, s67
    v_readlane_b32 s67, v9, 6
    s_add_u32 s66, s66, s67
    v_readlane_b32 s67, v9, 7
    s_add_u32 s66, s66, s67
    s_cmp_ge_u32 s66, 256
    s_cbranch_scc1 TKD_4
    s_cmp_gt_u32 s65, 262144
    s_cbranch_scc0 TK_3
TKD_4:
    v_cmp_ne_u32 vcc, 32, v9
    s_mov_b64 exec, -1
M_SLOW:
    s_waitcnt vmcnt(0) lgkmcnt(0)
    s_barrier
    s_cmp_lg_u32 s14, 0
    s_cbranch_scc1 M_SLOWB
    v_mov_b32 v8, 1
    s_mov_b64 exec, 1
    buffer_atomic_add v8, off, s[60:63], 12 sc1
    s_mov_b64 exec, -1
M_SLOWB:
    s_mov_b32 s95, 12
    s_mov_b32 s65, 0
SB_5:
    buffer_load_dword v8, off, s[60:63], s95 sc1
    s_add_u32 s65, s65, 1
    s_waitcnt vmcnt(0)
    v_readfirstlane_b32 s64, v8
    s_cmp_ge_u32 s64, 256
    s_cbranch_scc1 SBD_6
    s_cmp_gt_u32 s65, 65536
    s_cbranch_scc1 SBD_6
    s_sleep 4
    s_branch SB_5
SBD_6:
    s_mov_b32 s95, 8
    s_mov_b32 s97, 1
    s_cmp_lt_u32 s2, 64
    s_cbranch_scc0 M_SH
    s_lshr_b32 s12, s2, 5
    s_and_b32 s13, s2, 31
    s_branch M_REC
M_SH:
    s_sub_u32 s96, s2, 64
    s_branch M_HELP
M_REC:
    v_mbcnt_lo_u32_b32 v0, -1, 0
    v_mbcnt_hi_u32_b32 v0, -1, v0
    s_load_dwordx2 s[44:45], s[0:1], 16
    s_mov_b32 s46, 0x500000
    s_mov_b32 s47, 0x00020000
    s_load_dwordx2 s[48:49], s[0:1], 24
    s_mov_b32 s50, 0x500000
    s_mov_b32 s51, 0x00020000
    s_load_dwordx2 s[52:53], s[0:1], 32
    s_mov_b32 s54, 0x500000
    s_mov_b32 s55, 0x00020000
    s_load_dwordx2 s[56:57], s[0:1], 40
    s_mov_b32 s58, 0x500000
    s_mov_b32 s59, 0x00020000
    s_waitcnt lgkmcnt(0)
    v_and_b32 v0, 63, v0
    s_mul_i32 s40, s14, 36864
    s_add_u32 s40, s40, 16384
    v_bfe_u32 v95, v0, 2, 2
    v_lshlrev_b32 v88, 15, v95
    v_lshrrev_b32 v95, 5, v0
    v_lshl_add_u32 v88, v95, 14, v88
    v_bfe_u32 v95, v0, 4, 1
    v_lshl_add_u32 v88, v95, 13, v88
    v_lshlrev_b32 v95, 1, v95
    v_and_b32 v8, 3, v0
    v_xor_b32 v95, v95, v8
    v_lshl_add_u32 v88, v95, 4, v88
    v_bfe_u32 v95, v0, 2, 1
    v_mov_b32 v8, v95
    v_bfe_u32 v95, v0, 3, 1
    v_lshl_add_u32 v8, v95, 2, v8
    v_bfe_u32 v95, v0, 4, 1
    v_lshl_add_u32 v8, v95, 1, v8
    v_bfe_u32 v95, v0, 5, 1
    v_lshl_add_u32 v8, v95, 3, v8
    v_mul_u32_u24 v8, 1280, v8
    v_and_b32 v95, 3, v0
    v_lshl_add_u32 v89, v95, 4, v8
    v_lshrrev_b32 v95, 1, v0
    v_mul_u32_u24 v8, 1280, v95
    v_and_b32 v95, 1, v0
    v_lshl_add_u32 v90, v95, 4, v8
    v_lshrrev_b32 v95, 5, v0
    v_lshlrev_b32 v91, 10, v95
    v_bfe_u32 v95, v0, 2, 1
    v_lshl_add_u32 v91, v95, 8, v91
    v_bfe_u32 v95, v0, 4, 1
    v_lshl_add_u32 v91, v95, 6, v91
    v_bfe_u32 v95, v0, 3, 1
    v_lshl_add_u32 v91, v95, 7, v91
    v_and_b32 v95, 1, v0
    v_lshl_add_u32 v91, v95, 3, v91
    v_bfe_u32 v95, v0, 1, 1
    v_lshl_add_u32 v91, v95, 4, v91
    v_add_u32 v91, s40, v91
    v_bfe_u32 v95, v0, 2, 1
    v_lshlrev_b32 v95, 5, v95
    v_sub_u32 v92, 32, v95
    v_add_u32 v92, v92, v91
    v_add_u32 v91, v91, v95
    v_lshrrev_b32 v95, 5, v0
    v_lshlrev_b32 v93, 9, v95
    v_bfe_u32 v95, v0, 4, 1
    v_lshl_add_u32 v93, v95, 7, v93
    v_bfe_u32 v95, v0, 2, 1
    v_lshl_add_u32 v93, v95, 6, v93
    v_bfe_u32 v95, v0, 3, 1
    v_lshl_add_u32 v93, v95, 5, v93
    v_and_b32 v95, 3, v0
    v_lshl_add_u32 v93, v95, 3, v93
    v_add_u32 v93, s40, v93
    v_lshrrev_b32 v95, 4, v0
    v_lshlrev_b32 v94, 8, v95
    v_bfe_u32 v95, v0, 2, 2
    v_lshl_add_u32 v94, v95, 5, v94
    v_and_b32 v95, 3, v0
    v_lshl_add_u32 v94, v95, 3, v94
    v_add_u32 v94, s40, v94
    v_lshrrev_b32 v95, 4, v0
    v_lshlrev_b32 v8, 13, v95
    v_and_b32 v95, 1, v95
    v_lshlrev_b32 v95, 1, v95
    v_and_b32 v9, 15, v0
    v_xor_b32 v9, v9, v95
    v_xor_b32 v95, 0, v9
    v_lshl_add_u32 v76, v95, 4, v8
    v_xor_b32 v95, 4, v9
    v_lshl_add_u32 v77, v95, 4, v8
    v_xor_b32 v95, 8, v9
    v_lshl_add_u32 v78, v95, 4, v8
    v_xor_b32 v95, 12, v9
    v_lshl_add_u32 v79, v95, 4, v8
    v_lshrrev_b32 v95, 5, v0
    v_mul_u32_u24 v8, 36864, v95
    v_bfe_u32 v95, v0, 3, 1
    v_lshl_add_u32 v8, v95, 11, v8
    v_lshlrev_b32 v9, 3, v95
    v_bfe_u32 v95, v0, 4, 1
    v_lshl_add_u32 v8, v95, 10, v8
    v_lshl_add_u32 v9, v95, 2, v9
    v_bfe_u32 v95, v0, 2, 1
    v_lshl_add_u32 v8, v95, 8, v8
    v_lshl_add_u32 v9, v95, 1, v9
    v_and_b32 v95, 1, v0
    v_lshl_add_u32 v8, v95, 3, v8
    v_add_u32 v8, 16384, v8
    v_bfe_u32 v95, v0, 1, 1
    s_lshl_b32 s64, s14, 2
    v_add_u32 v10, s64, v95
    v_add_u32 v95, 0, v10
    v_xor_b32 v95, v95, v9
    v_lshl_add_u32 v72, v95, 4, v8
    v_add_u32 v73, 73728, v72
    v_add_u32 v95, 2, v10
    v_xor_b32 v95, v95, v9
    v_lshl_add_u32 v74, v95, 4, v8
    v_add_u32 v75, 73728, v74
    s_lshl_b32 s64, s13, 8
    s_lshl_b32 s65, s14, 17
    s_add_u32 s64, s64, s65
    s_mul_i32 s65, s12, 2621440
    s_add_u32 s71, s64, s65
    s_sub_u32 s65, 2621440, s65
    s_add_u32 s72, s64, s65
    s_mul_i32 s39, s13, 163840
    s_mul_i32 s64, s12, 640
    s_add_u32 s39, s39, s64
    s_lshl_b32 s64, s14, 5
    s_add_u32 s41, s39, s64
    s_add_u32 s41, s41, 0x200
    s_lshl_b32 s64, s14, 6
    s_add_u32 s39, s39, s64
    v_lshlrev_b32 v87, 6, v0
    s_add_u32 m0, s40, 0
    s_add_u32 s64, s71, 0x0
    buffer_load_dwordx4 v76, s[44:47], s64 offen lds
    s_add_u32 m0, s40, 1024
    s_add_u32 s64, s71, 0x8000
    buffer_load_dwordx4 v77, s[44:47], s64 offen lds
    s_add_u32 m0, s40, 2048
    s_add_u32 s64, s71, 0x10000
    buffer_load_dwordx4 v78, s[44:47], s64 offen lds
    s_add_u32 m0, s40, 3072
    s_add_u32 s64, s71, 0x18000
    buffer_load_dwordx4 v79, s[44:47], s64 offen lds
    s_add_u32 m0, s40, 4096
    s_add_u32 s64, s71, 0x80000
    buffer_load_dwordx4 v76, s[44:47], s64 offen lds
    s_add_u32 m0, s40, 5120
    s_add_u32 s64, s71, 0x88000
    buffer_load_dwordx4 v77, s[44:47], s64 offen lds
    s_add_u32 m0, s40, 6144
    s_add_u32 s64, s71, 0x90000
    buffer_load_dwordx4 v78, s[44:47], s64 offen lds
    s_add_u32 m0, s40, 7168
    s_add_u32 s64, s71, 0x98000
    buffer_load_dwordx4 v79, s[44:47], s64 offen lds
    s_add_u32 m0, s40, 8192
    s_add_u32 s64, s71, 0x100000
    buffer_load_dwordx4 v76, s[44:47], s64 offen lds
    s_add_u32 m0, s40, 9216
    s_add_u32 s64, s71, 0x108000
    buffer_load_dwordx4 v77, s[44:47], s64 offen lds
    s_add_u32 m0, s40, 10240
    s_add_u32 s64, s71, 0x110000
    buffer_load_dwordx4 v78, s[44:47], s64 offen lds
    s_add_u32 m0, s40, 11264
    s_add_u32 s64, s71, 0x118000
    buffer_load_dwordx4 v79, s[44:47], s64 offen lds
    s_add_u32 m0, s40, 12288
    s_add_u32 s64, s71, 0x180000
    buffer_load_dwordx4 v76, s[44:47], s64 offen lds
    s_add_u32 m0, s40, 13312
    s_add_u32 s64, s71, 0x188000
    buffer_load_dwordx4 v77, s[44:47], s64 offen lds
    s_add_u32 m0, s40, 14336
    s_add_u32 s64, s71, 0x190000
    buffer_load_dwordx4 v78, s[44:47], s64 offen lds
    s_add_u32 m0, s40, 15360
    s_add_u32 s64, s71, 0x198000
    buffer_load_dwordx4 v79, s[44:47], s64 offen lds
    s_add_u32 m0, s40, 16384
    s_add_u32 s64, s71, 0x200000
    buffer_load_dwordx4 v76, s[44:47], s64 offen lds
    s_add_u32 m0, s40, 17408
    s_add_u32 s64, s71, 0x208000
    buffer_load_dwordx4 v77, s[44:47], s64 offen lds
    s_add_u32 m0, s40, 18432
    s_add_u32 s64, s71, 0x210000
    buffer_load_dwordx4 v78, s[44:47], s64 offen lds
    s_add_u32 m0, s40, 19456
    s_add_u32 s64, s71, 0x218000
    buffer_load_dwordx4 v79, s[44:47], s64 offen lds
    s_add_u32 m0, s40, 20480
    s_add_u32 s64, s72, 0x0
    buffer_load_dwordx4 v76, s[44:47], s64 offen lds
    s_add_u32 m0, s40, 21504
    s_add_u32 s64, s72, 0x8000
    buffer_load_dwordx4 v77, s[44:47], s64 offen lds
    s_add_u32 m0, s40, 22528
    s_add_u32 s64, s72, 0x10000
    buffer_load_dwordx4 v78, s[44:47], s64 offen lds
    s_add_u32 m0, s40, 23552
    s_add_u32 s64, s72, 0x18000
    buffer_load_dwordx4 v79, s[44:47], s64 offen lds
    s_add_u32 m0, s40, 24576
    s_add_u32 s64, s72, 0x80000
    buffer_load_dwordx4 v76, s[44:47], s64 offen lds
    s_add_u32 m0, s40, 25600
    s_add_u32 s64, s72, 0x88000
    buffer_load_dwordx4 v77, s[44:47], s64 offen lds
    s_add_u32 m0, s40, 26624
    s_add_u32 s64, s72, 0x90000
    buffer_load_dwordx4 v78, s[44:47], s64 offen lds
    s_add_u32 m0, s40, 27648
    s_add_u32 s64, s72, 0x98000
    buffer_load_dwordx4 v79, s[44:47], s64 offen lds
    s_add_u32 m0, s40, 28672
    s_add_u32 s64, s72, 0x100000
    buffer_load_dwordx4 v76, s[44:47], s64 offen lds
    s_add_u32 m0, s40, 29696
    s_add_u32 s64, s72, 0x108000
    buffer_load_dwordx4 v77, s[44:47], s64 offen lds
    s_add_u32 m0, s40, 30720
    s_add_u32 s64, s72, 0x110000
    buffer_load_dwordx4 v78, s[44:47], s64 offen lds
    s_add_u32 m0, s40, 31744
    s_add_u32 s64, s72, 0x118000
    buffer_load_dwordx4 v79, s[44:47], s64 offen lds
    v_and_b32 v0, 63, v0
    v_lshlrev_b32 v1, 4, v0
    s_mul_i32 s64, s14, 36864
    s_add_u32 s64, s64, 16384
    v_add_u32 v2, s64, v1
    v_bfe_u32 v8, v0, 4, 1
    v_mul_u32_u24 v8, 1152, v8
    v_lshrrev_b32 v9, 5, v0
    v_lshlrev_b32 v9, 4, v9
    v_and_b32 v10, 15, v0
    v_add_u32 v9, v9, v10
    s_lshl_b32 s64, s14, 5
    v_add_u32 v9, s64, v9
    v_lshl_add_u32 v8, v9, 3, v8
    v_add_u32 v3, 8192, v8
    v_and_b32 v8, 1, v0
    v_mul_u32_u24 v8, 1152, v8
    v_lshrrev_b32 v9, 4, v0
    v_lshlrev_b32 v9, 2, v9
    v_bfe_u32 v10, v0, 2, 2
    v_add_u32 v9, v9, v10
    v_lshl_add_u32 v8, v9, 3, v8
    v_add_u32 v4, 8192, v8
    v_and_b32 v8, 7, v0
    v_mul_u32_u24 v8, 288, v8
    v_bfe_u32 v9, v0, 3, 1
    v_lshl_add_u32 v8, v9, 5, v8
    v_lshrrev_b32 v9, 4, v0
    v_lshl_add_u32 v8, v9, 3, v8
    s_lshl_b32 s64, s14, 6
    s_add_u32 s64, s64, 12800
    v_add_u32 v5, s64, v8
    s_mov_b32 s32, 0x00ff00ff
    s_mov_b32 s33, 0x00ff00ff
    s_mov_b32 s34, -1
    s_mov_b32 s35, 0
    s_mov_b32 s36, 0x00010001
    s_mov_b32 s37, 0x00010001
    v_mov_b32 v8, 0xeeee
    v_mov_b32 v9, 0x4444
    v_cndmask_b32 v6, v8, v9, s[32:33]
    v_lshrrev_b32 v8, 5, v0
    v_lshlrev_b32 v8, 13, v8
    v_bfe_u32 v9, v0, 3, 1
    v_lshl_add_u32 v8, v9, 12, v8
    v_and_b32 v9, 7, v0
    v_lshl_add_u32 v8, v9, 4, v8
    v_bfe_u32 v9, v0, 4, 1
    v_lshl_add_u32 v7, v9, 3, v8
    s_mov_b32 s10, 0x3e0293ee
    s_mov_b32 s11, 0x3e0293ee
    s_cmp_eq_u32 s14, 0
    s_cselect_b32 s42, 1, 0
    s_cmp_ge_u32 s13, 24
    s_cselect_b32 s65, 1, 0
    s_cmp_eq_u32 s14, 1
    s_cselect_b32 s65, s65, 0
    s_or_b32 s42, s42, s65
    s_lshl_b32 s65, s65, 3
    s_add_u32 s64, s13, s65
    s_cmp_eq_u32 s64, 39
    s_cselect_b32 s22, s42, 0
    s_mul_i32 s24, s12, 163840
    s_add_u32 s24, s24, 0x300000
    s_lshl_b32 s67, s13, 7
    s_add_u32 s26, s24, s67
    s_lshl_b32 s67, s14, 14
    s_add_u32 s23, s26, s67
    s_add_u32 s25, s23, 0x10000
    s_lshl_b32 s67, s14, 13
    s_add_u32 s26, s26, s67
    s_add_u32 s26, s26, 0x20000
    s_lshl_b32 s67, s64, 12
    s_add_u32 s24, s24, s67
    s_lshl_b32 s64, s64, 7
    s_lshl_b32 s65, s12, 13
    s_add_u32 s17, s65, 0x5900000
    s_add_u32 s18, s17, s64
    s_lshl_b32 s65, s12, 21
    s_add_u32 s66, s65, 0x6000000
    s_add_u32 s21, s66, s64
    s_xor_b32 s65, s65, 0x200000
    s_add_u32 s20, s65, 0x5ff8000
    s_and_b32 s64, s13, 1
    s_cmp_eq_u32 s64, s12
    s_cselect_b32 s43, 1, 0
    s_mov_b32 s43, 0
    s_lshl_b32 s64, s13, 4
    s_add_u32 s69, s64, 0x291000
    s_lshl_b32 s64, s13, 2
    s_add_u32 s70, s64, 0x294000
    s_lshl_b32 s64, s13, 14
    s_lshl_b32 s73, s14, 11
    s_lshl_b32 s65, s14, 12
    s_add_u32 s65, s65, s64
    s_add_u32 s3, s65, 0x1500000
    s_add_u32 s64, s64, s73
    s_add_u32 s28, s64, 0x1400000
    s_add_u32 s29, s64, 0x1402000
    s_lshl_b32 s64, s13, 11
    s_add_u32 s30, s64, 0x640000
    s_lshl_b32 s64, s13, 12
    s_lshl_b32 s65, s14, 10
    s_add_u32 s64, s64, s65
    s_add_u32 s31, s64, 0xa40000
    s_waitcnt vmcnt(28)
    s_barrier
    s_add_u32 m0, s40, 32768
    s_add_u32 s64, s72, 0x180000
    buffer_load_dwordx4 v76, s[44:47], s64 offen lds
    s_add_u32 m0, s40, 33792
    s_add_u32 s64, s72, 0x188000
    buffer_load_dwordx4 v77, s[44:47], s64 offen lds
    s_add_u32 m0, s40, 34816
    s_add_u32 s64, s72, 0x190000
    buffer_load_dwordx4 v78, s[44:47], s64 offen lds
    s_add_u32 m0, s40, 35840
    s_add_u32 s64, s72, 0x198000
    buffer_load_dwordx4 v79, s[44:47], s64 offen lds
    ds_read_b64_tr_b16 v[96:97], v72 offset:0
    ds_read_b64_tr_b16 v[98:99], v72 offset:512
    ds_read_b64_tr_b16 v[100:101], v73 offset:0
    ds_read_b64_tr_b16 v[102:103], v73 offset:512
    ds_read_b64_tr_b16 v[104:105], v74 offset:0
    ds_read_b64_tr_b16 v[106:107], v74 offset:512
    ds_read_b64_tr_b16 v[108:109], v75 offset:0
    ds_read_b64_tr_b16 v[110:111], v75 offset:512
    s_waitcnt lgkmcnt(0)
    s_waitcnt vmcnt(28)
    s_barrier
    s_add_u32 m0, s40, 0
    s_add_u32 s64, s72, 0x200000
    buffer_load_dwordx4 v76, s[44:47], s64 offen lds
    s_add_u32 m0, s40, 1024
    s_add_u32 s64, s72, 0x208000
    buffer_load_dwordx4 v77, s[44:47], s64 offen lds
    s_add_u32 m0, s40, 2048
    s_add_u32 s64, s72, 0x210000
    buffer_load_dwordx4 v78, s[44:47], s64 offen lds
    s_add_u32 m0, s40, 3072
    s_add_u32 s64, s72, 0x218000
    buffer_load_dwordx4 v79, s[44:47], s64 offen lds
    ds_read_b64_tr_b16 v[112:113], v72 offset:4096
    ds_read_b64_tr_b16 v[114:115], v72 offset:4608
    ds_read_b64_tr_b16 v[116:117], v73 offset:4096
    ds_read_b64_tr_b16 v[118:119], v73 offset:4608
    ds_read_b64_tr_b16 v[120:121], v74 offset:4096
    ds_read_b64_tr_b16 v[122:123], v74 offset:4608
    ds_read_b64_tr_b16 v[124:125], v75 offset:4096
    ds_read_b64_tr_b16 v[126:127], v75 offset:4608
    s_waitcnt lgkmcnt(0)
    s_waitcnt vmcnt(28)
    s_barrier
    s_add_u32 m0, s40, 4096
    s_add_u32 s64, s72, 0x200000
    buffer_load_dwordx4 v76, s[48:51], s64 offen lds
    s_add_u32 m0, s40, 5120
    s_add_u32 s64, s72, 0x208000
    buffer_load_dwordx4 v77, s[48:51], s64 offen lds
    s_add_u32 m0, s40, 6144
    s_add_u32 s64, s72, 0x210000
    buffer_load_dwordx4 v78, s[48:51], s64 offen lds
    s_add_u32 m0, s40, 7168
    s_add_u32 s64, s72, 0x218000
    buffer_load_dwordx4 v79, s[48:51], s64 offen lds
    ds_read_b64_tr_b16 v[128:129], v72 offset:8192
    ds_read_b64_tr_b16 v[130:131], v72 offset:8704
    ds_read_b64_tr_b16 v[132:133], v73 offset:8192
    ds_read_b64_tr_b16 v[134:135], v73 offset:8704
    ds_read_b64_tr_b16 v[136:137], v74 offset:8192
    ds_read_b64_tr_b16 v[138:139], v74 offset:8704
    ds_read_b64_tr_b16 v[140:141], v75 offset:8192
    ds_read_b64_tr_b16 v[142:143], v75 offset:8704
    s_waitcnt lgkmcnt(0)
    s_waitcnt vmcnt(28)
    s_barrier
    s_add_u32 m0, s40, 8192
    s_add_u32 s64, s71, 0x0
    buffer_load_dwordx4 v76, s[52:55], s64 offen lds
    s_add_u32 m0, s40, 9216
    s_add_u32 s64, s71, 0x8000
    buffer_load_dwordx4 v77, s[52:55], s64 offen lds
    s_add_u32 m0, s40, 10240
    s_add_u32 s64, s71, 0x10000
    buffer_load_dwordx4 v78, s[52:55], s64 offen lds
    s_add_u32 m0, s40, 11264
    s_add_u32 s64, s71, 0x18000
    buffer_load_dwordx4 v79, s[52:55], s64 offen lds
    ds_read_b64_tr_b16 v[144:145], v72 offset:12288
    ds_read_b64_tr_b16 v[146:147], v72 offset:12800
    ds_read_b64_tr_b16 v[148:149], v73 offset:12288
    ds_read_b64_tr_b16 v[150:151], v73 offset:12800
    ds_read_b64_tr_b16 v[152:153], v74 offset:12288
    ds_read_b64_tr_b16 v[154:155], v74 offset:12800
    ds_read_b64_tr_b16 v[156:157], v75 offset:12288
    ds_read_b64_tr_b16 v[158:159], v75 offset:12800
    s_waitcnt lgkmcnt(0)
    s_waitcnt vmcnt(28)
    s_barrier
    s_add_u32 m0, s40, 12288
    s_add_u32 s64, s71, 0x80000
    buffer_load_dwordx4 v76, s[52:55], s64 offen lds
    s_add_u32 m0, s40, 13312
    s_add_u32 s64, s71, 0x88000
    buffer_load_dwordx4 v77, s[52:55], s64 offen lds
    s_add_u32 m0, s40, 14336
    s_add_u32 s64, s71, 0x90000
    buffer_load_dwordx4 v78, s[52:55], s64 offen lds
    s_add_u32 m0, s40, 15360
    s_add_u32 s64, s71, 0x98000
    buffer_load_dwordx4 v79, s[52:55], s64 offen lds
    ds_read_b64_tr_b16 v[160:161], v72 offset:16384
    ds_read_b64_tr_b16 v[162:163], v72 offset:16896
    ds_read_b64_tr_b16 v[164:165], v73 offset:16384
    ds_read_b64_tr_b16 v[166:167], v73 offset:16896
    ds_read_b64_tr_b16 v[168:169], v74 offset:16384
    ds_read_b64_tr_b16 v[170:171], v74 offset:16896
    ds_read_b64_tr_b16 v[172:173], v75 offset:16384
    ds_read_b64_tr_b16 v[174:175], v75 offset:16896
    s_waitcnt lgkmcnt(0)
    s_waitcnt vmcnt(28)
    s_barrier
    s_add_u32 m0, s40, 16384
    s_add_u32 s64, s71, 0x100000
    buffer_load_dwordx4 v76, s[52:55], s64 offen lds
    s_add_u32 m0, s40, 17408
    s_add_u32 s64, s71, 0x108000
    buffer_load_dwordx4 v77, s[52:55], s64 offen lds
    s_add_u32 m0, s40, 18432
    s_add_u32 s64, s71, 0x110000
    buffer_load_dwordx4 v78, s[52:55], s64 offen lds
    s_add_u32 m0, s40, 19456
    s_add_u32 s64, s71, 0x118000
    buffer_load_dwordx4 v79, s[52:55], s64 offen lds
    ds_read_b64_tr_b16 v[176:177], v72 offset:20480
    ds_read_b64_tr_b16 v[178:179], v72 offset:20992
    ds_read_b64_tr_b16 v[180:181], v73 offset:20480
    ds_read_b64_tr_b16 v[182:183], v73 offset:20992
    ds_read_b64_tr_b16 v[184:185], v74 offset:20480
    ds_read_b64_tr_b16 v[186:187], v74 offset:20992
    ds_read_b64_tr_b16 v[188:189], v75 offset:20480
    ds_read_b64_tr_b16 v[190:191], v75 offset:20992
    s_waitcnt lgkmcnt(0)
    s_waitcnt vmcnt(28)
    s_barrier
    s_add_u32 m0, s40, 20480
    s_add_u32 s64, s71, 0x180000
    buffer_load_dwordx4 v76, s[52:55], s64 offen lds
    s_add_u32 m0, s40, 21504
    s_add_u32 s64, s71, 0x188000
    buffer_load_dwordx4 v77, s[52:55], s64 offen lds
    s_add_u32 m0, s40, 22528
    s_add_u32 s64, s71, 0x190000
    buffer_load_dwordx4 v78, s[52:55], s64 offen lds
    s_add_u32 m0, s40, 23552
    s_add_u32 s64, s71, 0x198000
    buffer_load_dwordx4 v79, s[52:55], s64 offen lds
    ds_read_b64_tr_b16 v[192:193], v72 offset:24576
    ds_read_b64_tr_b16 v[194:195], v72 offset:25088
    ds_read_b64_tr_b16 v[196:197], v73 offset:24576
    ds_read_b64_tr_b16 v[198:199], v73 offset:25088
    ds_read_b64_tr_b16 v[200:201], v74 offset:24576
    ds_read_b64_tr_b16 v[202:203], v74 offset:25088
    ds_read_b64_tr_b16 v[204:205], v75 offset:24576
    ds_read_b64_tr_b16 v[206:207], v75 offset:25088
    s_waitcnt lgkmcnt(0)
    s_waitcnt vmcnt(28)
    s_barrier
    s_add_u32 m0, s40, 24576
    s_add_u32 s64, s71, 0x200000
    buffer_load_dwordx4 v76, s[52:55], s64 offen lds
    s_add_u32 m0, s40, 25600
    s_add_u32 s64, s71, 0x208000
    buffer_load_dwordx4 v77, s[52:55], s64 offen lds
    s_add_u32 m0, s40, 26624
    s_add_u32 s64, s71, 0x210000
    buffer_load_dwordx4 v78, s[52:55], s64 offen lds
    s_add_u32 m0, s40, 27648
    s_add_u32 s64, s71, 0x218000
    buffer_load_dwordx4 v79, s[52:55], s64 offen lds
    ds_read_b64_tr_b16 v[208:209], v72 offset:28672
    ds_read_b64_tr_b16 v[210:211], v72 offset:29184
    ds_read_b64_tr_b16 v[212:213], v73 offset:28672
    ds_read_b64_tr_b16 v[214:215], v73 offset:29184
    ds_read_b64_tr_b16 v[216:217], v74 offset:28672
    ds_read_b64_tr_b16 v[218:219], v74 offset:29184
    ds_read_b64_tr_b16 v[220:221], v75 offset:28672
    ds_read_b64_tr_b16 v[222:223], v75 offset:29184
    s_waitcnt lgkmcnt(0)
    s_waitcnt vmcnt(28)
    s_barrier
    s_add_u32 m0, s40, 28672
    s_add_u32 s64, s72, 0x0
    buffer_load_dwordx4 v76, s[52:55], s64 offen lds
    s_add_u32 m0, s40, 29696
    s_add_u32 s64, s72, 0x8000
    buffer_load_dwordx4 v77, s[52:55], s64 offen lds
    s_add_u32 m0, s40, 30720
    s_add_u32 s64, s72, 0x10000
    buffer_load_dwordx4 v78, s[52:55], s64 offen lds
    s_add_u32 m0, s40, 31744
    s_add_u32 s64, s72, 0x18000
    buffer_load_dwordx4 v79, s[52:55], s64 offen lds
    ds_read_b64_tr_b16 v[224:225], v72 offset:32768
    ds_read_b64_tr_b16 v[226:227], v72 offset:33280
    ds_read_b64_tr_b16 v[228:229], v73 offset:32768
    ds_read_b64_tr_b16 v[230:231], v73 offset:33280
    ds_read_b64_tr_b16 v[232:233], v74 offset:32768
    ds_read_b64_tr_b16 v[234:235], v74 offset:33280
    ds_read_b64_tr_b16 v[236:237], v75 offset:32768
    ds_read_b64_tr_b16 v[238:239], v75 offset:33280
    s_waitcnt lgkmcnt(0)
    s_waitcnt vmcnt(28)
    s_barrier
    s_add_u32 m0, s40, 32768
    s_add_u32 s64, s72, 0x80000
    buffer_load_dwordx4 v76, s[52:55], s64 offen lds
    s_add_u32 m0, s40, 33792
    s_add_u32 s64, s72, 0x88000
    buffer_load_dwordx4 v77, s[52:55], s64 offen lds
    s_add_u32 m0, s40, 34816
    s_add_u32 s64, s72, 0x90000
    buffer_load_dwordx4 v78, s[52:55], s64 offen lds
    s_add_u32 m0, s40, 35840
    s_add_u32 s64, s72, 0x98000
    buffer_load_dwordx4 v79, s[52:55], s64 offen lds
    ds_read_b64_tr_b16 v[240:241], v72 offset:0
    ds_read_b64_tr_b16 v[242:243], v72 offset:512
    ds_read_b64_tr_b16 v[244:245], v73 offset:0
    ds_read_b64_tr_b16 v[246:247], v73 offset:512
    ds_read_b64_tr_b16 v[248:249], v74 offset:0
    ds_read_b64_tr_b16 v[250:251], v74 offset:512
    ds_read_b64_tr_b16 v[252:253], v75 offset:0
    ds_read_b64_tr_b16 v[254:255], v75 offset:512
    s_waitcnt lgkmcnt(0)
    s_waitcnt vmcnt(28)
    s_barrier
    s_add_u32 m0, s40, 0
    s_add_u32 s64, s72, 0x100000
    buffer_load_dwordx4 v76, s[52:55], s64 offen lds
    s_add_u32 m0, s40, 1024
    s_add_u32 s64, s72, 0x108000
    buffer_load_dwordx4 v77, s[52:55], s64 offen lds
    s_add_u32 m0, s40, 2048
    s_add_u32 s64, s72, 0x110000
    buffer_load_dwordx4 v78, s[52:55], s64 offen lds
    s_add_u32 m0, s40, 3072
    s_add_u32 s64, s72, 0x118000
    buffer_load_dwordx4 v79, s[52:55], s64 offen lds
    ds_read_b64_tr_b16 a[240:241], v72 offset:4096
    ds_read_b64_tr_b16 a[242:243], v72 offset:4608
    ds_read_b64_tr_b16 a[244:245], v73 offset:4096
    ds_read_b64_tr_b16 a[246:247], v73 offset:4608
    ds_read_b64_tr_b16 a[248:249], v74 offset:4096
    ds_read_b64_tr_b16 a[250:251], v74 offset:4608
    ds_read_b64_tr_b16 a[252:253], v75 offset:4096
    ds_read_b64_tr_b16 a[254:255], v75 offset:4608
    s_waitcnt lgkmcnt(0)
    s_waitcnt vmcnt(28)
    s_barrier
    s_add_u32 m0, s40, 4096
    s_add_u32 s64, s72, 0x180000
    buffer_load_dwordx4 v76, s[52:55], s64 offen lds
    s_add_u32 m0, s40, 5120
    s_add_u32 s64, s72, 0x188000
    buffer_load_dwordx4 v77, s[52:55], s64 offen lds
    s_add_u32 m0, s40, 6144
    s_add_u32 s64, s72, 0x190000
    buffer_load_dwordx4 v78, s[52:55], s64 offen lds
    s_add_u32 m0, s40, 7168
    s_add_u32 s64, s72, 0x198000
    buffer_load_dwordx4 v79, s[52:55], s64 offen lds
    ds_read_b64_tr_b16 a[0:1], v72 offset:8192
    ds_read_b64_tr_b16 a[2:3], v72 offset:8704
    ds_read_b64_tr_b16 a[4:5], v73 offset:8192
    ds_read_b64_tr_b16 a[6:7], v73 offset:8704
    ds_read_b64_tr_b16 a[8:9], v74 offset:8192
    ds_read_b64_tr_b16 a[10:11], v74 offset:8704
    ds_read_b64_tr_b16 a[12:13], v75 offset:8192
    ds_read_b64_tr_b16 a[14:15], v75 offset:8704
    s_waitcnt lgkmcnt(0)
    s_waitcnt vmcnt(28)
    s_barrier
    s_add_u32 m0, s40, 8192
    s_add_u32 s64, s72, 0x200000
    buffer_load_dwordx4 v76, s[52:55], s64 offen lds
    s_add_u32 m0, s40, 9216
    s_add_u32 s64, s72, 0x208000
    buffer_load_dwordx4 v77, s[52:55], s64 offen lds
    s_add_u32 m0, s40, 10240
    s_add_u32 s64, s72, 0x210000
    buffer_load_dwordx4 v78, s[52:55], s64 offen lds
    s_add_u32 m0, s40, 11264
    s_add_u32 s64, s72, 0x218000
    buffer_load_dwordx4 v79, s[52:55], s64 offen lds
    ds_read_b64_tr_b16 a[16:17], v72 offset:12288
    ds_read_b64_tr_b16 a[18:19], v72 offset:12800
    ds_read_b64_tr_b16 a[20:21], v73 offset:12288
    ds_read_b64_tr_b16 a[22:23], v73 offset:12800
    ds_read_b64_tr_b16 a[24:25], v74 offset:12288
    ds_read_b64_tr_b16 a[26:27], v74 offset:12800
    ds_read_b64_tr_b16 a[28:29], v75 offset:12288
    ds_read_b64_tr_b16 a[30:31], v75 offset:12800
    s_waitcnt lgkmcnt(0)
    s_waitcnt vmcnt(28)
    s_barrier
    s_add_u32 m0, s40, 12288
    s_add_u32 s64, s39, 0x0
    buffer_load_dwordx4 v89, s[56:59], s64 offen lds
    s_add_u32 m0, s40, 13312
    s_add_u32 s64, s39, 0x5000
    buffer_load_dwordx4 v89, s[56:59], s64 offen lds
    s_add_u32 m0, s40, 14336
    s_add_u32 s64, s39, 0xa000
    buffer_load_dwordx4 v89, s[56:59], s64 offen lds
    s_add_u32 m0, s40, 15360
    s_add_u32 s64, s39, 0xf000
    buffer_load_dwordx4 v89, s[56:59], s64 offen lds
    ds_read_b64_tr_b16 a[32:33], v72 offset:16384
    ds_read_b64_tr_b16 a[34:35], v72 offset:16896
    ds_read_b64_tr_b16 a[36:37], v73 offset:16384
    ds_read_b64_tr_b16 a[38:39], v73 offset:16896
    ds_read_b64_tr_b16 a[40:41], v74 offset:16384
    ds_read_b64_tr_b16 a[42:43], v74 offset:16896
    ds_read_b64_tr_b16 a[44:45], v75 offset:16384
    ds_read_b64_tr_b16 a[46:47], v75 offset:16896
    s_waitcnt lgkmcnt(0)
    s_waitcnt vmcnt(28)
    s_barrier
    s_add_u32 m0, s40, 16384
    s_add_u32 s64, s39, 0x14000
    buffer_load_dwordx4 v89, s[56:59], s64 offen lds
    s_add_u32 m0, s40, 17408
    s_add_u32 s64, s39, 0x19000
    buffer_load_dwordx4 v89, s[56:59], s64 offen lds
    s_add_u32 m0, s40, 18432
    s_add_u32 s64, s39, 0x1e000
    buffer_load_dwordx4 v89, s[56:59], s64 offen lds
    s_add_u32 m0, s40, 19456
    s_add_u32 s64, s39, 0x23000
    buffer_load_dwordx4 v89, s[56:59], s64 offen lds
    ds_read_b64_tr_b16 a[48:49], v72 offset:20480
    ds_read_b64_tr_b16 a[50:51], v72 offset:20992
    ds_read_b64_tr_b16 a[52:53], v73 offset:20480
    ds_read_b64_tr_b16 a[54:55], v73 offset:20992
    ds_read_b64_tr_b16 a[56:57], v74 offset:20480
    ds_read_b64_tr_b16 a[58:59], v74 offset:20992
    ds_read_b64_tr_b16 a[60:61], v75 offset:20480
    ds_read_b64_tr_b16 a[62:63], v75 offset:20992
    s_waitcnt lgkmcnt(0)
    s_waitcnt vmcnt(28)
    s_barrier
    s_add_u32 m0, s40, 20480
    s_add_u32 s64, s39, 0x100
    buffer_load_dwordx4 v89, s[56:59], s64 offen lds
    s_add_u32 m0, s40, 21504
    s_add_u32 s64, s39, 0x5100
    buffer_load_dwordx4 v89, s[56:59], s64 offen lds
    s_add_u32 m0, s40, 22528
    s_add_u32 s64, s39, 0xa100
    buffer_load_dwordx4 v89, s[56:59], s64 offen lds
    s_add_u32 m0, s40, 23552
    s_add_u32 s64, s39, 0xf100
    buffer_load_dwordx4 v89, s[56:59], s64 offen lds
    ds_read_b64_tr_b16 a[64:65], v72 offset:24576
    ds_read_b64_tr_b16 a[66:67], v72 offset:25088
    ds_read_b64_tr_b16 a[68:69], v73 offset:24576
    ds_read_b64_tr_b16 a[70:71], v73 offset:25088
    ds_read_b64_tr_b16 a[72:73], v74 offset:24576
    ds_read_b64_tr_b16 a[74:75], v74 offset:25088
    ds_read_b64_tr_b16 a[76:77], v75 offset:24576
    ds_read_b64_tr_b16 a[78:79], v75 offset:25088
    s_waitcnt lgkmcnt(0)
    s_waitcnt vmcnt(28)
    s_barrier
    s_add_u32 m0, s40, 24576
    s_add_u32 s64, s39, 0x14100
    buffer_load_dwordx4 v89, s[56:59], s64 offen lds
    s_add_u32 m0, s40, 25600
    s_add_u32 s64, s39, 0x19100
    buffer_load_dwordx4 v89, s[56:59], s64 offen lds
    s_add_u32 m0, s40, 26624
    s_add_u32 s64, s39, 0x1e100
    buffer_load_dwordx4 v89, s[56:59], s64 offen lds
    s_add_u32 m0, s40, 27648
    s_add_u32 s64, s39, 0x23100
    buffer_load_dwordx4 v89, s[56:59], s64 offen lds
    ds_read_b64_tr_b16 a[80:81], v72 offset:28672
    ds_read_b64_tr_b16 a[82:83], v72 offset:29184
    ds_read_b64_tr_b16 a[84:85], v73 offset:28672
    ds_read_b64_tr_b16 a[86:87], v73 offset:29184
    ds_read_b64_tr_b16 a[88:89], v74 offset:28672
    ds_read_b64_tr_b16 a[90:91], v74 offset:29184
    ds_read_b64_tr_b16 a[92:93], v75 offset:28672
    ds_read_b64_tr_b16 a[94:95], v75 offset:29184
    s_waitcnt lgkmcnt(0)
    s_waitcnt vmcnt(28)
    s_barrier
    s_add_u32 m0, s40, 28672
    s_add_u32 s64, s41, 0x0
    buffer_load_dwordx4 v90, s[56:59], s64 offen lds
    s_add_u32 m0, s40, 29696
    s_add_u32 s64, s41, 0xa000
    buffer_load_dwordx4 v90, s[56:59], s64 offen lds
    s_add_u32 m0, s40, 30720
    s_add_u32 s64, s41, 0x14000
    buffer_load_dwordx4 v90, s[56:59], s64 offen lds
    s_add_u32 m0, s40, 31744
    s_add_u32 s64, s41, 0x1e000
    buffer_load_dwordx4 v90, s[56:59], s64 offen lds
    ds_read_b64_tr_b16 a[96:97], v72 offset:32768
    ds_read_b64_tr_b16 a[98:99], v72 offset:33280
    ds_read_b64_tr_b16 a[100:101], v73 offset:32768
    ds_read_b64_tr_b16 a[102:103], v73 offset:33280
    ds_read_b64_tr_b16 a[104:105], v74 offset:32768
    ds_read_b64_tr_b16 a[106:107], v74 offset:33280
    ds_read_b64_tr_b16 a[108:109], v75 offset:32768
    ds_read_b64_tr_b16 a[110:111], v75 offset:33280
    s_waitcnt lgkmcnt(0)
    s_waitcnt vmcnt(28)
    s_barrier
    s_add_u32 m0, s40, 32768
    s_add_u32 s64, s72, 0x180000
    buffer_load_dwordx4 v76, s[48:51], s64 offen lds
    s_add_u32 m0, s40, 33792
    s_add_u32 s64, s72, 0x188000
    buffer_load_dwordx4 v77, s[48:51], s64 offen lds
    s_add_u32 m0, s40, 34816
    s_add_u32 s64, s72, 0x190000
    buffer_load_dwordx4 v78, s[48:51], s64 offen lds
    s_add_u32 m0, s40, 35840
    s_add_u32 s64, s72, 0x198000
    buffer_load_dwordx4 v79, s[48:51], s64 offen lds
    v_lshlrev_b32 v80, 2, v0
    buffer_load_dword v81, v80, s[60:63], 0 offen sc1
    ds_read_b64_tr_b16 a[112:113], v72 offset:0
    ds_read_b64_tr_b16 a[114:115], v72 offset:512
    ds_read_b64_tr_b16 a[116:117], v73 offset:0
    ds_read_b64_tr_b16 a[118:119], v73 offset:512
    ds_read_b64_tr_b16 a[120:121], v74 offset:0
    ds_read_b64_tr_b16 a[122:123], v74 offset:512
    ds_read_b64_tr_b16 a[124:125], v75 offset:0
    ds_read_b64_tr_b16 a[126:127], v75 offset:512
    s_waitcnt lgkmcnt(0)
    s_waitcnt vmcnt(29)
    s_barrier
    s_add_u32 m0, s40, 0
    s_add_u32 s64, s71, 0x0
    buffer_load_dwordx4 v76, s[48:51], s64 offen lds
    s_add_u32 m0, s40, 1024
    s_add_u32 s64, s71, 0x8000
    buffer_load_dwordx4 v77, s[48:51], s64 offen lds
    s_add_u32 m0, s40, 2048
    s_add_u32 s64, s71, 0x10000
    buffer_load_dwordx4 v78, s[48:51], s64 offen lds
    s_add_u32 m0, s40, 3072
    s_add_u32 s64, s71, 0x18000
    buffer_load_dwordx4 v79, s[48:51], s64 offen lds
    ds_read_b64_tr_b16 a[128:129], v72 offset:4096
    ds_read_b64_tr_b16 a[130:131], v72 offset:4608
    ds_read_b64_tr_b16 a[132:133], v73 offset:4096
    ds_read_b64_tr_b16 a[134:135], v73 offset:4608
    ds_read_b64_tr_b16 a[136:137], v74 offset:4096
    ds_read_b64_tr_b16 a[138:139], v74 offset:4608
    ds_read_b64_tr_b16 a[140:141], v75 offset:4096
    ds_read_b64_tr_b16 a[142:143], v75 offset:4608
    s_waitcnt lgkmcnt(0)
    s_waitcnt vmcnt(29)
    s_barrier
    s_add_u32 m0, s40, 4096
    s_add_u32 s64, s71, 0x80000
    buffer_load_dwordx4 v76, s[48:51], s64 offen lds
    s_add_u32 m0, s40, 5120
    s_add_u32 s64, s71, 0x88000
    buffer_load_dwordx4 v77, s[48:51], s64 offen lds
    s_add_u32 m0, s40, 6144
    s_add_u32 s64, s71, 0x90000
    buffer_load_dwordx4 v78, s[48:51], s64 offen lds
    s_add_u32 m0, s40, 7168
    s_add_u32 s64, s71, 0x98000
    buffer_load_dwordx4 v79, s[48:51], s64 offen lds
    ds_read_b64_tr_b16 a[144:145], v72 offset:8192
    ds_read_b64_tr_b16 a[146:147], v72 offset:8704
    ds_read_b64_tr_b16 a[148:149], v73 offset:8192
    ds_read_b64_tr_b16 a[150:151], v73 offset:8704
    ds_read_b64_tr_b16 a[152:153], v74 offset:8192
    ds_read_b64_tr_b16 a[154:155], v74 offset:8704
    ds_read_b64_tr_b16 a[156:157], v75 offset:8192
    ds_read_b64_tr_b16 a[158:159], v75 offset:8704
    s_waitcnt lgkmcnt(0)
    s_waitcnt vmcnt(29)
    s_barrier
    s_add_u32 m0, s40, 8192
    s_add_u32 s64, s71, 0x100000
    buffer_load_dwordx4 v76, s[48:51], s64 offen lds
    s_add_u32 m0, s40, 9216
    s_add_u32 s64, s71, 0x108000
    buffer_load_dwordx4 v77, s[48:51], s64 offen lds
    s_add_u32 m0, s40, 10240
    s_add_u32 s64, s71, 0x110000
    buffer_load_dwordx4 v78, s[48:51], s64 offen lds
    s_add_u32 m0, s40, 11264
    s_add_u32 s64, s71, 0x118000
    buffer_load_dwordx4 v79, s[48:51], s64 offen lds
    ds_read_b64_tr_b16 a[160:161], v93 offset:12288
    ds_read_b64_tr_b16 a[162:163], v93 offset:12544
    ds_read_b64_tr_b16 a[164:165], v93 offset:13312
    ds_read_b64_tr_b16 a[166:167], v93 offset:13568
    ds_read_b64_tr_b16 a[168:169], v93 offset:14336
    ds_read_b64_tr_b16 a[170:171], v93 offset:14592
    ds_read_b64_tr_b16 a[172:173], v93 offset:15360
    ds_read_b64_tr_b16 a[174:175], v93 offset:15616
    s_waitcnt lgkmcnt(0)
    s_waitcnt vmcnt(29)
    s_barrier
    s_add_u32 m0, s40, 12288
    s_add_u32 s64, s71, 0x180000
    buffer_load_dwordx4 v76, s[48:51], s64 offen lds
    s_add_u32 m0, s40, 13312
    s_add_u32 s64, s71, 0x188000
    buffer_load_dwordx4 v77, s[48:51], s64 offen lds
    s_add_u32 m0, s40, 14336
    s_add_u32 s64, s71, 0x190000
    buffer_load_dwordx4 v78, s[48:51], s64 offen lds
    s_add_u32 m0, s40, 15360
    s_add_u32 s64, s71, 0x198000
    buffer_load_dwordx4 v79, s[48:51], s64 offen lds
    ds_read_b64_tr_b16 a[176:177], v93 offset:16384
    ds_read_b64_tr_b16 a[178:179], v93 offset:16640
    ds_read_b64_tr_b16 a[180:181], v93 offset:17408
    ds_read_b64_tr_b16 a[182:183], v93 offset:17664
    ds_read_b64_tr_b16 a[184:185], v93 offset:18432
    ds_read_b64_tr_b16 a[186:187], v93 offset:18688
    ds_read_b64_tr_b16 a[188:189], v93 offset:19456
    ds_read_b64_tr_b16 a[190:191], v93 offset:19712
    s_waitcnt lgkmcnt(0)
    s_waitcnt vmcnt(29)
    s_barrier
    s_add_u32 m0, s40, 16384
    s_add_u32 s64, s71, 0x200000
    buffer_load_dwordx4 v76, s[48:51], s64 offen lds
    s_add_u32 m0, s40, 17408
    s_add_u32 s64, s71, 0x208000
    buffer_load_dwordx4 v77, s[48:51], s64 offen lds
    s_add_u32 m0, s40, 18432
    s_add_u32 s64, s71, 0x210000
    buffer_load_dwordx4 v78, s[48:51], s64 offen lds
    s_add_u32 m0, s40, 19456
    s_add_u32 s64, s71, 0x218000
    buffer_load_dwordx4 v79, s[48:51], s64 offen lds
    ds_read_b64_tr_b16 a[192:193], v93 offset:20480
    ds_read_b64_tr_b16 a[194:195], v93 offset:20736
    ds_read_b64_tr_b16 a[196:197], v93 offset:21504
    ds_read_b64_tr_b16 a[198:199], v93 offset:21760
    ds_read_b64_tr_b16 a[200:201], v93 offset:22528
    ds_read_b64_tr_b16 a[202:203], v93 offset:22784
    ds_read_b64_tr_b16 a[204:205], v93 offset:23552
    ds_read_b64_tr_b16 a[206:207], v93 offset:23808
    s_waitcnt lgkmcnt(0)
    s_waitcnt vmcnt(29)
    s_barrier
    s_add_u32 m0, s40, 20480
    s_add_u32 s64, s72, 0x0
    buffer_load_dwordx4 v76, s[48:51], s64 offen lds
    s_add_u32 m0, s40, 21504
    s_add_u32 s64, s72, 0x8000
    buffer_load_dwordx4 v77, s[48:51], s64 offen lds
    s_add_u32 m0, s40, 22528
    s_add_u32 s64, s72, 0x10000
    buffer_load_dwordx4 v78, s[48:51], s64 offen lds
    s_add_u32 m0, s40, 23552
    s_add_u32 s64, s72, 0x18000
    buffer_load_dwordx4 v79, s[48:51], s64 offen lds
    ds_read_b64_tr_b16 a[208:209], v93 offset:24576
    ds_read_b64_tr_b16 a[210:211], v93 offset:24832
    ds_read_b64_tr_b16 a[212:213], v93 offset:25600
    ds_read_b64_tr_b16 a[214:215], v93 offset:25856
    ds_read_b64_tr_b16 a[216:217], v93 offset:26624
    ds_read_b64_tr_b16 a[218:219], v93 offset:26880
    ds_read_b64_tr_b16 a[220:221], v93 offset:27648
    ds_read_b64_tr_b16 a[222:223], v93 offset:27904
    s_waitcnt lgkmcnt(0)
    s_waitcnt vmcnt(29)
    s_barrier
    s_add_u32 m0, s40, 24576
    s_add_u32 s64, s72, 0x80000
    buffer_load_dwordx4 v76, s[48:51], s64 offen lds
    s_add_u32 m0, s40, 25600
    s_add_u32 s64, s72, 0x88000
    buffer_load_dwordx4 v77, s[48:51], s64 offen lds
    s_add_u32 m0, s40, 26624
    s_add_u32 s64, s72, 0x90000
    buffer_load_dwordx4 v78, s[48:51], s64 offen lds
    s_add_u32 m0, s40, 27648
    s_add_u32 s64, s72, 0x98000
    buffer_load_dwordx4 v79, s[48:51], s64 offen lds
    ds_read_b64_tr_b16 a[224:225], v94 offset:28672
    ds_read_b64_tr_b16 a[226:227], v94 offset:28800
    ds_read_b64_tr_b16 a[228:229], v94 offset:29696
    ds_read_b64_tr_b16 a[230:231], v94 offset:29824
    ds_read_b64_tr_b16 a[232:233], v94 offset:30720
    ds_read_b64_tr_b16 a[234:235], v94 offset:30848
    ds_read_b64_tr_b16 a[236:237], v94 offset:31744
    ds_read_b64_tr_b16 a[238:239], v94 offset:31872
    s_waitcnt lgkmcnt(0)
    s_waitcnt vmcnt(29)
    s_barrier
    s_add_u32 m0, s40, 28672
    s_add_u32 s64, s72, 0x100000
    buffer_load_dwordx4 v76, s[48:51], s64 offen lds
    s_add_u32 m0, s40, 29696
    s_add_u32 s64, s72, 0x108000
    buffer_load_dwordx4 v77, s[48:51], s64 offen lds
    s_add_u32 m0, s40, 30720
    s_add_u32 s64, s72, 0x110000
    buffer_load_dwordx4 v78, s[48:51], s64 offen lds
    s_add_u32 m0, s40, 31744
    s_add_u32 s64, s72, 0x118000
    buffer_load_dwordx4 v79, s[48:51], s64 offen lds
    buffer_load_dwordx2 v[82:83], off, s[4:7], s69 sc1
    ds_read_b64_tr_b16 v[12:13], v72 offset:32768
    ds_read_b64_tr_b16 v[14:15], v72 offset:33280
    ds_read_b64_tr_b16 v[16:17], v73 offset:32768
    ds_read_b64_tr_b16 v[18:19], v73 offset:33280
    ds_read_b64_tr_b16 v[20:21], v74 offset:32768
    ds_read_b64_tr_b16 v[22:23], v74 offset:33280
    ds_read_b64_tr_b16 v[24:25], v75 offset:32768
    ds_read_b64_tr_b16 v[26:27], v75 offset:33280
    s_waitcnt lgkmcnt(0)
    s_barrier
    ds_write_b128 v2, v[12:15] offset:32768
    ds_write_b128 v2, v[16:19] offset:33792
    ds_write_b128 v2, v[20:23] offset:34816
    ds_write_b128 v2, v[24:27] offset:35840
    s_waitcnt lgkmcnt(0)
    s_waitcnt vmcnt(29)
    s_barrier
    ds_read_b64_tr_b16 v[12:13], v72 offset:0
    ds_read_b64_tr_b16 v[14:15], v72 offset:512
    ds_read_b64_tr_b16 v[16:17], v73 offset:0
    ds_read_b64_tr_b16 v[18:19], v73 offset:512
    ds_read_b64_tr_b16 v[20:21], v74 offset:0
    ds_read_b64_tr_b16 v[22:23], v74 offset:512
    ds_read_b64_tr_b16 v[24:25], v75 offset:0
    ds_read_b64_tr_b16 v[26:27], v75 offset:512
    s_waitcnt lgkmcnt(0)
    s_barrier
    ds_write_b128 v2, v[12:15] offset:0
    ds_write_b128 v2, v[16:19] offset:1024
    ds_write_b128 v2, v[20:23] offset:2048
    ds_write_b128 v2, v[24:27] offset:3072
    s_waitcnt lgkmcnt(0)
    s_waitcnt vmcnt(25)
    s_barrier
    ds_read_b64_tr_b16 v[12:13], v72 offset:4096
    ds_read_b64_tr_b16 v[14:15], v72 offset:4608
    ds_read_b64_tr_b16 v[16:17], v73 offset:4096
    ds_read_b64_tr_b16 v[18:19], v73 offset:4608
    ds_read_b64_tr_b16 v[20:21], v74 offset:4096
    ds_read_b64_tr_b16 v[22:23], v74 offset:4608
    ds_read_b64_tr_b16 v[24:25], v75 offset:4096
    ds_read_b64_tr_b16 v[26:27], v75 offset:4608
    s_waitcnt lgkmcnt(0)
    s_barrier
    ds_write_b128 v2, v[12:15] offset:4096
    ds_write_b128 v2, v[16:19] offset:5120
    ds_write_b128 v2, v[20:23] offset:6144
    ds_write_b128 v2, v[24:27] offset:7168
    s_waitcnt lgkmcnt(0)
    s_waitcnt vmcnt(21)
    s_barrier
    ds_read_b64_tr_b16 v[12:13], v72 offset:8192
    ds_read_b64_tr_b16 v[14:15], v72 offset:8704
    ds_read_b64_tr_b16 v[16:17], v73 offset:8192
    ds_read_b64_tr_b16 v[18:19], v73 offset:8704
    ds_read_b64_tr_b16 v[20:21], v74 offset:8192
    ds_read_b64_tr_b16 v[22:23], v74 offset:8704
    ds_read_b64_tr_b16 v[24:25], v75 offset:8192
    ds_read_b64_tr_b16 v[26:27], v75 offset:8704
    s_waitcnt lgkmcnt(0)
    s_barrier
    ds_write_b128 v2, v[12:15] offset:8192
    ds_write_b128 v2, v[16:19] offset:9216
    ds_write_b128 v2, v[20:23] offset:10240
    ds_write_b128 v2, v[24:27] offset:11264
    s_waitcnt lgkmcnt(0)
    s_waitcnt vmcnt(17)
    s_barrier
    ds_read_b64_tr_b16 v[12:13], v72 offset:12288
    ds_read_b64_tr_b16 v[14:15], v72 offset:12800
    ds_read_b64_tr_b16 v[16:17], v73 offset:12288
    ds_read_b64_tr_b16 v[18:19], v73 offset:12800
    ds_read_b64_tr_b16 v[20:21], v74 offset:12288
    ds_read_b64_tr_b16 v[22:23], v74 offset:12800
    ds_read_b64_tr_b16 v[24:25], v75 offset:12288
    ds_read_b64_tr_b16 v[26:27], v75 offset:12800
    s_waitcnt lgkmcnt(0)
    s_barrier
    ds_write_b128 v2, v[12:15] offset:12288
    ds_write_b128 v2, v[16:19] offset:13312
    ds_write_b128 v2, v[20:23] offset:14336
    ds_write_b128 v2, v[24:27] offset:15360
    s_waitcnt lgkmcnt(0)
    s_waitcnt vmcnt(13)
    s_barrier
    ds_read_b64_tr_b16 v[12:13], v72 offset:16384
    ds_read_b64_tr_b16 v[14:15], v72 offset:16896
    ds_read_b64_tr_b16 v[16:17], v73 offset:16384
    ds_read_b64_tr_b16 v[18:19], v73 offset:16896
    ds_read_b64_tr_b16 v[20:21], v74 offset:16384
    ds_read_b64_tr_b16 v[22:23], v74 offset:16896
    ds_read_b64_tr_b16 v[24:25], v75 offset:16384
    ds_read_b64_tr_b16 v[26:27], v75 offset:16896
    s_waitcnt lgkmcnt(0)
    s_barrier
    ds_write_b128 v2, v[12:15] offset:16384
    ds_write_b128 v2, v[16:19] offset:17408
    ds_write_b128 v2, v[20:23] offset:18432
    ds_write_b128 v2, v[24:27] offset:19456
    s_waitcnt lgkmcnt(0)
    s_waitcnt vmcnt(9)
    s_barrier
    ds_read_b64_tr_b16 v[12:13], v72 offset:20480
    ds_read_b64_tr_b16 v[14:15], v72 offset:20992
    ds_read_b64_tr_b16 v[16:17], v73 offset:20480
    ds_read_b64_tr_b16 v[18:19], v73 offset:20992
    ds_read_b64_tr_b16 v[20:21], v74 offset:20480
    ds_read_b64_tr_b16 v[22:23], v74 offset:20992
    ds_read_b64_tr_b16 v[24:25], v75 offset:20480
    ds_read_b64_tr_b16 v[26:27], v75 offset:20992
    s_waitcnt lgkmcnt(0)
    s_barrier
    ds_write_b128 v2, v[12:15] offset:20480
    ds_write_b128 v2, v[16:19] offset:21504
    ds_write_b128 v2, v[20:23] offset:22528
    ds_write_b128 v2, v[24:27] offset:23552
    s_waitcnt lgkmcnt(0)
    s_waitcnt vmcnt(5)
    s_barrier
    ds_read_b64_tr_b16 v[12:13], v72 offset:24576
    ds_read_b64_tr_b16 v[14:15], v72 offset:25088
    ds_read_b64_tr_b16 v[16:17], v73 offset:24576
    ds_read_b64_tr_b16 v[18:19], v73 offset:25088
    ds_read_b64_tr_b16 v[20:21], v74 offset:24576
    ds_read_b64_tr_b16 v[22:23], v74 offset:25088
    ds_read_b64_tr_b16 v[24:25], v75 offset:24576
    ds_read_b64_tr_b16 v[26:27], v75 offset:25088
    s_waitcnt lgkmcnt(0)
    s_barrier
    ds_write_b128 v2, v[12:15] offset:24576
    ds_write_b128 v2, v[16:19] offset:25600
    ds_write_b128 v2, v[20:23] offset:26624
    ds_write_b128 v2, v[24:27] offset:27648
    s_waitcnt lgkmcnt(0)
    s_waitcnt vmcnt(1)
    s_barrier
    ds_read_b64_tr_b16 v[12:13], v72 offset:28672
    ds_read_b64_tr_b16 v[14:15], v72 offset:29184
    ds_read_b64_tr_b16 v[16:17], v73 offset:28672
    ds_read_b64_tr_b16 v[18:19], v73 offset:29184
    ds_read_b64_tr_b16 v[20:21], v74 offset:28672
    ds_read_b64_tr_b16 v[22:23], v74 offset:29184
    ds_read_b64_tr_b16 v[24:25], v75 offset:28672
    ds_read_b64_tr_b16 v[26:27], v75 offset:29184
    s_waitcnt lgkmcnt(0)
    s_barrier
    ds_write_b128 v2, v[12:15] offset:28672
    ds_write_b128 v2, v[16:19] offset:29696
    ds_write_b128 v2, v[20:23] offset:30720
    ds_write_b128 v2, v[24:27] offset:31744
    s_waitcnt lgkmcnt(0)
    s_waitcnt vmcnt(0)
    s_cmp_lg_u32 s97, 0
    s_cbranch_scc1 NOTEARLY_8
    v_cmp_ne_u32 vcc, 32, v81
    v_readlane_b32 s64, v81, 1
    v_readlane_b32 s66, v81, 33
    v_readlane_b32 s67, v81, 34
    s_and_b32 s65, vcc_lo, 0x01010101
    s_cbranch_scc1 NOTEARLY_8
    s_and_b32 s65, vcc_hi, 0x01010101
    s_cbranch_scc1 NOTEARLY_8
    s_cmp_lt_u32 s64, 192
    s_cbranch_scc1 NOTEARLY_8
    s_min_u32 s65, s66, s67
    s_cmp_eq_u32 s65, 0
    s_cbranch_scc1 NOTEARLY_8
    s_sub_u32 s66, s66, 1
    s_sub_u32 s67, s67, 1
    s_branch EARLY_7
NOTEARLY_8:
    s_cmp_lg_u32 s97, 0
    s_cbranch_scc1 CM_9
    v_mbcnt_lo_u32_b32 v0, -1, 0
    v_mbcnt_hi_u32_b32 v0, -1, v0
    v_mul_u32_u24 v8, 32, v0
    s_mov_b32 s64, 0x0
    s_mov_b32 s65, 0
    s_mov_b64 exec, 0xff
TK_10:
    buffer_load_dword v9, v8, s[60:63], s64 offen sc1
    s_add_u32 s65, s65, 1
    s_waitcnt vmcnt(0)
    s_mov_b32 s66, 0
    v_readlane_b32 s67, v9, 0
    s_add_u32 s66, s66, s67
    v_readlane_b32 s67, v9, 1
    s_add_u32 s66, s66, s67
    v_readlane_b32 s67, v9, 2
    s_add_u32 s66, s66, s67
    v_readlane_b32 s67, v9, 3
    s_add_u32 s66, s66, s67
    v_readlane_b32 s67, v9, 4
    s_add_u32 s66, s66, s67
    v_readlane_b32 s67, v9, 5
    s_add_u32 s66, s66, s67
    v_readlane_b32 s67, v9, 6
    s_add_u32 s66, s66, s67
    v_readlane_b32 s67, v9, 7
    s_add_u32 s66, s66, s67
    s_cmp_ge_u32 s66, 256
    s_cbranch_scc1 TKD_11
    s_cmp_gt_u32 s65, 262144
    s_cbranch_scc0 TK_10
TKD_11:
    v_cmp_ne_u32 vcc, 32, v9
    s_mov_b64 exec, -1
    s_cbranch_vccnz M_SLOW
CM_9:
    s_mov_b32 s65, 0
RI_12:
    buffer_load_dword v8, off, s[60:63], s95 sc1
    s_add_u32 s65, s65, 1
    s_waitcnt vmcnt(0)
    v_readfirstlane_b32 s64, v8
    s_cmp_ge_u32 s64, 192
    s_cbranch_scc1 RID_13
    s_cmp_gt_u32 s65, 65536
    s_cbranch_scc1 RID_13
    s_sleep 4
    s_branch RI_12
RID_13:
    s_mov_b32 s65, 0
CW_14:
    buffer_load_dwordx2 v[8:9], off, s[60:63], 0 offset:132 sc1
    s_add_u32 s65, s65, 1
    s_waitcnt vmcnt(0)
    v_readfirstlane_b32 s66, v8
    v_readfirstlane_b32 s67, v9
    s_min_u32 s64, s66, s67
    s_cmp_lg_u32 s64, 0
    s_cbranch_scc1 CWD_15
    s_cmp_gt_u32 s65, 65536
    s_cbranch_scc1 CWD_15
    s_sleep 4
    s_branch CW_14
CWD_15:
    s_sub_u32 s66, s66, 1
    s_and_b32 s66, s66, 3
    s_sub_u32 s67, s67, 1
    s_and_b32 s67, s67, 3
EARLY_7:
    s_mov_b32 s56, s66
    s_mov_b32 s57, s67
    s_mov_b32 s38, 0x3f80
    s_mov_b32 s53, 0
    s_cmp_eq_u32 s14, 2
    s_cselect_b32 s52, 1024, 0
    s_cmp_eq_u32 s14, 3
    s_cselect_b32 s58, 0, 1
    s_mov_b32 s59, 0
    s_mov_b32 s44, 0x3030303
    s_mov_b32 s45, 0x3030303
    s_mov_b32 s46, 0xc0c0c0c
    s_mov_b32 s47, 0xc0c0c0c
    s_mov_b32 s48, 0x30303030
    s_mov_b32 s49, 0x30303030
    s_mov_b32 s50, 0xc0c0c0c0
    s_mov_b32 s51, 0xc0c0c0c0
    v_and_b32 v8, 7, v0
    v_mul_u32_u24 v8, 288, v8
    v_lshrrev_b32 v9, 4, v0
    v_lshl_add_u32 v8, v9, 4, v8
    v_add_u32 v0, 12800, v8
    s_mov_b32 s68, 0
    s_mov_b32 s40, 0
    s_mov_b32 s64, s56
    s_mov_b32 s65, s57
    s_cmp_eq_u32 s12, 0
    s_cselect_b32 s66, s65, s64
    s_cselect_b32 s64, s64, s65
    s_and_b32 s64, s64, 3
    s_lshl_b32 s64, s64, 13
    s_and_b32 s66, s66, 3
    s_lshl_b32 s66, s66, 13
    s_add_u32 s21, s21, s64
    s_add_u32 s20, s20, s66
    s_cmp_eq_u32 s42, 0
    s_cselect_b32 s18, 0x40000000, s18
    s_cselect_b32 s21, 0x40000000, s21
    s_lshl_b32 s65, s12, 7
    s_add_u32 s65, s65, 0x29a000
    s_cmp_eq_u32 s22, 0
    s_cselect_b32 s22, 0x40000000, s65
    s_lshl_b32 s64, s13, 2
    s_add_u32 s64, s64, s14
    s_cmp_ge_u32 s64, 40
    s_cselect_b32 s65, 40, 0
    s_sub_u32 s64, s64, s65
    s_cmp_ge_u32 s64, 40
    s_cselect_b32 s65, 40, 0
    s_sub_u32 s64, s64, s65
    s_cmp_ge_u32 s64, 40
    s_cselect_b32 s65, 40, 0
    s_sub_u32 s64, s64, s65
    s_lshl_b32 s27, s64, 7
    s_add_u32 s19, s27, 0x4000
    v_and_b32 v82, v82, v83
    v_cmp_eq_u32 vcc, 0, v82
    s_cmp_lg_u32 s97, 0
    s_cselect_b64 vcc, -1, vcc
    s_cbranch_vccz KVOK_16
    v_mov_b32 v29, 0
FSPIN_17:
    buffer_load_dwordx2 v[12:13], v29, s[4:7], s69 offen sc1
    s_add_u32 s68, s68, 1
    s_waitcnt vmcnt(0)
    v_and_b32 v12, v12, v13
    v_cmp_eq_u32 vcc, 0, v12
    s_cbranch_vccz FDONE_18
    s_cmp_gt_u32 s68, 262144
    s_cbranch_scc0 FSPIN_17
FDONE_18:
KVOK_16:
    s_barrier
    s_mov_b32 m0, s73
    s_nop 0
    buffer_load_dwordx4 v1, s[4:7], s28 offen lds
    buffer_load_dwordx4 v1, s[4:7], s28 offen offset:1024 lds
    s_mov_b32 m0, 16128
    v_lshlrev_b32 v12, 2, v1
    s_add_u32 s65, s3, 0xfff80000
    buffer_load_dword v12, s[4:7], s65 offen lds
    s_mov_b32 s15, 0
    s_mov_b32 s16, 0
    s_add_u32 s66, s17, s52
    buffer_load_dwordx4 v[12:15], v1, s[4:7], s66 offen sc1
    buffer_load_dwordx4 v[16:19], v1, s[4:7], s17 offen offset:2048 sc1
    v_add_u32 v29, s52, v1
    s_waitcnt vmcnt(0)
    ds_write_b128 v29, v[12:15] offset:12800
    ds_write_b128 v1, v[16:19] offset:15104
    s_waitcnt lgkmcnt(0)
    v_mov_b64 v[32:33], 0
    v_mov_b64 v[34:35], 0
    v_mov_b64 v[36:37], 0
    v_mov_b64 v[38:39], 0
    v_mov_b64 v[40:41], 0
    v_mov_b64 v[42:43], 0
    v_mov_b64 v[44:45], 0
    v_mov_b64 v[46:47], 0
    v_mov_b64 v[48:49], 0
    v_mov_b64 v[50:51], 0
    v_mov_b64 v[52:53], 0
    v_mov_b64 v[54:55], 0
    v_mov_b32 v9, 0x40000000
    ds_read_b128 v[56:59], v2 offset:0
    ds_read_b128 v[60:63], v2 offset:1024
    ds_read_b128 v[64:67], v2 offset:2048
    ds_read_b128 v[68:71], v2 offset:3072
    s_cmp_eq_u32 s97, 0
    s_cbranch_scc1 REC_LOOP
    s_branch REC_LOOP_S
REC_POLL_S:
    s_cmp_eq_u32 s59, 0
    s_cbranch_scc1 NOFLG_19
    s_waitcnt vmcnt(0)
    v_lshrrev_b32 v29, 2, v1
    ds_read_b32 v12, v29 offset:15104
    s_add_u32 s64, s15, 2
    s_lshr_b32 s65, s64, 1
    s_add_u32 s67, s65, 1
    s_waitcnt lgkmcnt(0)
    v_cmp_ne_u32 vcc, 0, v12
    v_readlane_b32 s65, v12, s65
    v_readlane_b32 s67, v12, s67
    s_cmp_eq_u32 vcc_lo, -1
    s_cselect_b32 s58, 1, 0
    s_and_b32 s65, s65, s67
    s_cbranch_scc1 NOFLG_19
    s_lshl_b32 s64, s64, 7
    s_add_u32 s64, s64, s69
    v_mov_b32 v29, 0
FSPIN_21:
    buffer_load_dwordx2 v[12:13], v29, s[4:7], s64 offen sc1
    s_add_u32 s68, s68, 1
    s_waitcnt vmcnt(0)
    v_and_b32 v12, v12, v13
    v_cmp_eq_u32 vcc, 0, v12
    s_cbranch_vccz FDONE_22
    s_cmp_gt_u32 s68, 262144
    s_cbranch_scc0 FSPIN_21
FDONE_22:
NOFLG_19:
    s_add_u32 s64, s15, 3
    s_and_b32 s64, s64, 0x43
    s_or_b32 s64, s64, s58
    s_cmp_eq_u32 s64, 0
    s_cselect_b32 s59, 1, 0
    s_add_u32 s66, s17, s52
    v_add_u32 v10, s52, v1
    s_xor_b32 s16, s16, 1
    v_mov_b64 v[32:33], 0
    v_mov_b64 v[34:35], 0
    v_mov_b64 v[36:37], 0
    v_mov_b64 v[38:39], 0
    v_mov_b64 v[40:41], 0
    v_mov_b64 v[42:43], 0
    v_mov_b64 v[44:45], 0
    v_mov_b64 v[46:47], 0
    v_mov_b64 v[48:49], 0
    v_mov_b64 v[50:51], 0
    v_mov_b64 v[52:53], 0
    v_mov_b64 v[54:55], 0
    ds_read_b128 v[56:59], v2 offset:0
    ds_read_b128 v[60:63], v2 offset:1024
    ds_read_b128 v[64:67], v2 offset:2048
    ds_read_b128 v[68:71], v2 offset:3072
    s_barrier
    s_cmp_lt_u32 s15, 63
    s_cbranch_scc0 REC_END
    s_nop 14
    buffer_load_dwordx4 v[20:23], v1, s[4:7], s66 offen offset:0 sc1
    s_nop 7
    buffer_load_dwordx4 v[24:27], v1, s[4:7], s66 offen offset:0 sc1
    s_nop 7
    buffer_load_dwordx4 v[28:31], v1, s[4:7], s66 offen offset:0 sc1
IPOLL_24:
    s_waitcnt vmcnt(2)
    ds_write_b128 v10, v[20:23] offset:12800
    v_max3_u32 v11, v20, v21, v22
    v_max_u32 v11, v11, v23
    v_cmp_eq_u32 vcc, -1, v11
    s_cbranch_vccz IOK_23
    buffer_load_dwordx4 v[20:23], v1, s[4:7], s66 offen offset:0 sc1
    s_waitcnt vmcnt(2)
    ds_write_b128 v10, v[24:27] offset:12800
    v_max3_u32 v11, v24, v25, v26
    v_max_u32 v11, v11, v27
    v_cmp_eq_u32 vcc, -1, v11
    s_cbranch_vccz IOK_23
    buffer_load_dwordx4 v[24:27], v1, s[4:7], s66 offen offset:0 sc1
    s_waitcnt vmcnt(2)
    ds_write_b128 v10, v[28:31] offset:12800
    v_max3_u32 v11, v28, v29, v30
    v_max_u32 v11, v11, v31
    v_cmp_eq_u32 vcc, -1, v11
    s_add_u32 s68, s68, 1
    s_add_u32 s53, s53, 1
    s_cmp_gt_u32 s68, 262144
    s_cbranch_scc1 IOK_23
    s_cbranch_vccz IOK_23
    buffer_load_dwordx4 v[28:31], v1, s[4:7], s66 offen offset:0 sc1
    s_branch IPOLL_24
IOK_23:
    s_waitcnt lgkmcnt(0)
REC_LOOP_S:
    s_barrier
    ds_read_b128 v[12:15], v1 offset:12800
    ds_read_b128 v[16:19], v1 offset:13824
    buffer_load_dwordx4 v[20:23], v1, s[4:7], s17 offen offset:2048
    ds_read_b128 v[72:75], v2 offset:4096
    ds_read_b128 v[76:79], v2 offset:5120
    ds_read_b128 v[80:83], v2 offset:6144
    ds_read_b128 v[84:87], v2 offset:7168
    s_add_u32 s74, s17, 0x1000
    s_add_u32 s20, s20, 0x8000
    s_add_u32 s75, s20, 0x1000
    s_mov_b32 m0, 16128
    s_add_u32 s65, s20, s27
    s_waitcnt lgkmcnt(5)
    v_smfmac_f32_16x16x64_bf16 v[32:35], v[12:15], v[96:103], v6
    buffer_load_dwordx4 v[24:27], v1, s[4:7], s17 offen offset:3072
    v_smfmac_f32_16x16x64_bf16 v[36:39], v[12:15], v[104:111], v6
    v_smfmac_f32_16x16x64_bf16 v[40:43], v[12:15], v[56:63], v6
    buffer_load_dwordx4 v[28:31], v1, s[4:7], s74 offen offset:0
    ds_read_b128 v[56:59], v2 offset:8192
    ds_read_b128 v[60:63], v2 offset:9216
    v_smfmac_f32_16x16x64_bf16 v[44:47], v[12:15], v[64:71], v6
    ds_read_b128 v[64:67], v2 offset:10240
    ds_read_b128 v[68:71], v2 offset:11264
    s_waitcnt lgkmcnt(8)
    v_smfmac_f32_16x16x64_bf16 v[48:51], v[12:15], a[0:7], v6
    v_smfmac_f32_16x16x64_bf16 v[52:55], v[12:15], a[8:15], v6
    buffer_load_dwordx4 v[12:15], v1, s[4:7], s20 offen offset:0
    buffer_load_dword off, s[4:7], s65 lds
    v_smfmac_f32_16x16x64_bf16 v[32:35], v[16:19], v[112:119], v6
    v_smfmac_f32_16x16x64_bf16 v[36:39], v[16:19], v[120:127], v6
    s_waitcnt lgkmcnt(4)
    v_smfmac_f32_16x16x64_bf16 v[40:43], v[16:19], v[72:79], v6
    ds_read_b128 v[72:75], v2 offset:12288
    ds_read_b128 v[76:79], v2 offset:13312
    v_smfmac_f32_16x16x64_bf16 v[44:47], v[16:19], v[80:87], v6
    ds_read_b128 v[80:83], v2 offset:14336
    ds_read_b128 v[84:87], v2 offset:15360
    s_waitcnt vmcnt(4)
    v_cmp_eq_u32 vcc, -1, v23
    v_smfmac_f32_16x16x64_bf16 v[48:51], v[16:19], a[16:23], v6
    v_smfmac_f32_16x16x64_bf16 v[52:55], v[16:19], a[24:31], v6
    s_cbranch_vccnz RETRY_25
BACK_26:
    buffer_load_dwordx4 v[16:19], v1, s[4:7], s20 offen offset:1024
    v_smfmac_f32_16x16x64_bf16 v[32:35], v[20:23], v[128:135], v6
    v_smfmac_f32_16x16x64_bf16 v[36:39], v[20:23], v[136:143], v6
    s_waitcnt lgkmcnt(4)
    v_smfmac_f32_16x16x64_bf16 v[40:43], v[20:23], v[56:63], v6
    ds_read_b128 v[56:59], v2 offset:16384
    ds_read_b128 v[60:63], v2 offset:17408
    v_smfmac_f32_16x16x64_bf16 v[44:47], v[20:23], v[64:71], v6
    ds_read_b128 v[64:67], v2 offset:18432
    ds_read_b128 v[68:71], v2 offset:19456
    s_waitcnt vmcnt(4)
    v_cmp_eq_u32 vcc, -1, v27
    v_smfmac_f32_16x16x64_bf16 v[48:51], v[20:23], a[32:39], v6
    v_smfmac_f32_16x16x64_bf16 v[52:55], v[20:23], a[40:47], v6
    s_cbranch_vccnz RETRY_27
BACK_28:
    buffer_load_dwordx4 v[20:23], v1, s[4:7], s20 offen offset:2048
    v_smfmac_f32_16x16x64_bf16 v[32:35], v[24:27], v[144:151], v6
    v_smfmac_f32_16x16x64_bf16 v[36:39], v[24:27], v[152:159], v6
    s_waitcnt lgkmcnt(4)
    v_smfmac_f32_16x16x64_bf16 v[40:43], v[24:27], v[72:79], v6
    ds_read_b128 v[72:75], v2 offset:20480
    ds_read_b128 v[76:79], v2 offset:21504
    v_smfmac_f32_16x16x64_bf16 v[44:47], v[24:27], v[80:87], v6
    ds_read_b128 v[80:83], v2 offset:22528
    ds_read_b128 v[84:87], v2 offset:23552
    s_waitcnt vmcnt(4)
    v_cmp_eq_u32 vcc, -1, v31
    v_smfmac_f32_16x16x64_bf16 v[48:51], v[24:27], a[48:55], v6
    v_smfmac_f32_16x16x64_bf16 v[52:55], v[24:27], a[56:63], v6
    s_cbranch_vccnz RETRY_29
BACK_30:
    buffer_load_dwordx4 v[24:27], v1, s[4:7], s20 offen offset:3072
    v_smfmac_f32_16x16x64_bf16 v[32:35], v[28:31], v[160:167], v6
    v_smfmac_f32_16x16x64_bf16 v[36:39], v[28:31], v[168:175], v6
    s_waitcnt lgkmcnt(4)
    v_smfmac_f32_16x16x64_bf16 v[40:43], v[28:31], v[56:63], v6
    ds_read_b128 v[56:59], v2 offset:24576
    ds_read_b128 v[60:63], v2 offset:25600
    v_smfmac_f32_16x16x64_bf16 v[44:47], v[28:31], v[64:71], v6
    ds_read_b128 v[64:67], v2 offset:26624
    ds_read_b128 v[68:71], v2 offset:27648
    s_waitcnt vmcnt(4)
    v_cmp_eq_u32 vcc, -1, v15
    v_smfmac_f32_16x16x64_bf16 v[48:51], v[28:31], a[64:71], v6
    v_smfmac_f32_16x16x64_bf16 v[52:55], v[28:31], a[72:79], v6
    s_cbranch_vccnz RETRY_31
BACK_32:
    buffer_load_dwordx4 v[28:31], v1, s[4:7], s75 offen offset:0
    v_smfmac_f32_16x16x64_bf16 v[32:35], v[12:15], v[176:183], v6
    s_waitcnt vmcnt(3)
    v_cmp_eq_u32 vcc, -1, v19
    v_smfmac_f32_16x16x64_bf16 v[36:39], v[12:15], v[184:191], v6
    s_waitcnt lgkmcnt(4)
    v_smfmac_f32_16x16x64_bf16 v[40:43], v[12:15], v[72:79], v6
    ds_read_b128 v[72:75], v2 offset:28672
    ds_read_b128 v[76:79], v2 offset:29696
    v_smfmac_f32_16x16x64_bf16 v[44:47], v[12:15], v[80:87], v6
    ds_read_b128 v[80:83], v2 offset:30720
    ds_read_b128 v[84:87], v2 offset:31744
    buffer_load_dwordx4 v[88:91], v1, s[4:7], s29 offen offset:0
    s_cbranch_vccnz RETRY_33
BACK_34:
    v_smfmac_f32_16x16x64_bf16 v[32:35], v[16:19], v[192:199], v6
    s_waitcnt vmcnt(3)
    v_cmp_eq_u32 vcc, -1, v23
    v_smfmac_f32_16x16x64_bf16 v[36:39], v[16:19], v[200:207], v6
    s_waitcnt lgkmcnt(4)
    v_smfmac_f32_16x16x64_bf16 v[40:43], v[16:19], v[56:63], v6
    ds_read_b128 v[56:59], v2 offset:32768
    ds_read_b128 v[60:63], v2 offset:33792
    v_smfmac_f32_16x16x64_bf16 v[44:47], v[16:19], v[64:71], v6
    ds_read_b128 v[64:67], v2 offset:34816
    ds_read_b128 v[68:71], v2 offset:35840
    s_cbranch_vccnz RETRY_35
BACK_36:
    v_smfmac_f32_16x16x64_bf16 v[32:35], v[20:23], v[208:215], v6
    s_waitcnt vmcnt(2)
    v_cmp_eq_u32 vcc, -1, v27
    v_smfmac_f32_16x16x64_bf16 v[36:39], v[20:23], v[216:223], v6
    s_waitcnt lgkmcnt(4)
    v_smfmac_f32_16x16x64_bf16 v[40:43], v[20:23], v[72:79], v6
    ds_read_b128 v[72:75], v1 offset:0
    ds_read_b128 v[76:79], v1 offset:4096
    v_smfmac_f32_16x16x64_bf16 v[44:47], v[20:23], v[80:87], v6
    ds_read_b128 v[80:83], v1 offset:1024
    ds_read_b128 v[84:87], v1 offset:5120
    buffer_load_dwordx4 v[92:95], v1, s[4:7], s29 offen offset:1024
    s_cbranch_vccnz RETRY_37
BACK_38:
    v_smfmac_f32_16x16x64_bf16 v[32:35], v[24:27], v[224:231], v6
    s_waitcnt vmcnt(2)
    v_cmp_eq_u32 vcc, -1, v31
    v_smfmac_f32_16x16x64_bf16 v[36:39], v[24:27], v[232:239], v6
    s_waitcnt lgkmcnt(4)
    v_smfmac_f32_16x16x64_bf16 v[40:43], v[24:27], v[56:63], v6
    ds_read_b128 v[56:59], v1 offset:2048
    ds_read_b128 v[60:63], v1 offset:6144
    v_smfmac_f32_16x16x64_bf16 v[44:47], v[24:27], v[64:71], v6
    ds_read_b128 v[64:67], v1 offset:3072
    ds_read_b128 v[68:71], v1 offset:7168
    s_cbranch_vccnz RETRY_39
BACK_40:
    v_smfmac_f32_16x16x64_bf16 v[32:35], v[28:31], v[240:247], v6
    v_smfmac_f32_16x16x64_bf16 v[36:39], v[28:31], v[248:255], v6
    v_smfmac_f32_16x16x64_bf16 v[40:43], v[28:31], a[240:247], v6
    v_smfmac_f32_16x16x64_bf16 v[44:47], v[28:31], a[248:255], v6
    v_lshlrev_b32 v8, 2, v1
    s_add_u32 s65, s17, s19
    buffer_load_dword v8, s[4:7], s3 offen lds
    buffer_load_dword off, s[4:7], s65 sc1 lds
    buffer_store_dword v6, off, s[4:7], s22 sc1
    s_add_u32 s22, s22, 256
    s_cmp_eq_u32 s59, 0
    s_cbranch_scc1 KVLOOK_41
    v_lshrrev_b32 v9, 5, v1
    v_lshlrev_b32 v9, 9, v9
    v_bfe_u32 v10, v1, 4, 1
    v_lshl_add_u32 v9, v10, 2, v9
    s_mov_b32 m0, 15104
    s_mov_b64 exec, s[34:35]
    buffer_load_dword v9, s[4:7], s69 offen sc1 lds
    s_mov_b64 exec, -1
    s_mov_b32 m0, 16128
KVLOOK_41:
    v_permlane32_swap_b32 v32, v36
    v_permlane32_swap_b32 v33, v37
    v_permlane32_swap_b32 v34, v38
    v_permlane32_swap_b32 v35, v39
    v_pk_add_f32 v[32:33], v[32:33], v[36:37]
    v_pk_add_f32 v[34:35], v[34:35], v[38:39]
    v_cvt_pk_bf16_f32 v36, v32, v33
    v_cvt_pk_bf16_f32 v37, v34, v35
    ds_write_b64 v3, v[36:37] offset:0
    v_permlane32_swap_b32 v40, v44
    v_permlane32_swap_b32 v41, v45
    v_permlane32_swap_b32 v42, v46
    v_permlane32_swap_b32 v43, v47
    v_pk_add_f32 v[40:41], v[40:41], v[44:45]
    v_pk_add_f32 v[42:43], v[42:43], v[46:47]
    v_cvt_pk_bf16_f32 v44, v40, v41
    v_cvt_pk_bf16_f32 v45, v42, v43
    ds_write_b64 v3, v[44:45] offset:2304
    v_smfmac_f32_16x16x64_bf16 v[48:51], v[12:15], a[80:87], v6
    v_smfmac_f32_16x16x64_bf16 v[52:55], v[12:15], a[88:95], v6
    v_smfmac_f32_16x16x64_bf16 v[48:51], v[16:19], a[96:103], v6
    v_smfmac_f32_16x16x64_bf16 v[52:55], v[16:19], a[104:111], v6
    s_waitcnt lgkmcnt(0)
    s_barrier
    ds_read_b64_tr_b16 v[32:33], v4 offset:0
    ds_read_b64_tr_b16 v[34:35], v4 offset:128
    ds_read_b64_tr_b16 v[36:37], v4 offset:256
    ds_read_b64_tr_b16 v[38:39], v4 offset:384
    v_smfmac_f32_16x16x64_bf16 v[48:51], v[20:23], a[112:119], v6
    v_smfmac_f32_16x16x64_bf16 v[52:55], v[20:23], a[120:127], v6
    ds_read_b64_tr_b16 v[40:41], v4 offset:512
    ds_read_b64_tr_b16 v[42:43], v4 offset:640
    ds_read_b64_tr_b16 v[44:45], v4 offset:768
    ds_read_b64_tr_b16 v[46:47], v4 offset:896
    v_smfmac_f32_16x16x64_bf16 v[48:51], v[24:27], a[128:135], v6
    v_smfmac_f32_16x16x64_bf16 v[52:55], v[24:27], a[136:143], v6
    s_waitcnt lgkmcnt(4)
    v_mfma_f32_16x16x32_bf16 v[8:11], v[72:75], v[32:35], 0
    ds_read_b64_tr_b16 v[12:13], v4 offset:2304
    ds_read_b64_tr_b16 v[14:15], v4 offset:2432
    v_mfma_f32_16x16x32_bf16 v[8:11], v[80:83], v[36:39], v[8:11]
    ds_read_b64_tr_b16 v[16:17], v4 offset:2560
    ds_read_b64_tr_b16 v[18:19], v4 offset:2688
    s_waitcnt lgkmcnt(4)
    v_mfma_f32_16x16x32_bf16 v[8:11], v[56:59], v[40:43], v[8:11]
    ds_read_b64_tr_b16 v[56:57], v4 offset:2816
    ds_read_b64_tr_b16 v[58:59], v4 offset:2944
    v_mfma_f32_16x16x32_bf16 v[8:11], v[64:67], v[44:47], v[8:11]
    ds_read_b64_tr_b16 v[64:65], v4 offset:3072
    ds_read_b64_tr_b16 v[66:67], v4 offset:3200
    v_mfma_f32_16x16x32_bf16 v[72:75], v[76:79], v[32:35], 0
    v_mfma_f32_16x16x32_bf16 v[72:75], v[84:87], v[36:39], v[72:75]
    v_mfma_f32_16x16x32_bf16 v[72:75], v[60:63], v[40:43], v[72:75]
    v_mfma_f32_16x16x32_bf16 v[72:75], v[68:71], v[44:47], v[72:75]
    s_waitcnt lgkmcnt(4)
    v_mfma_f32_16x16x32_bf16 v[80:83], v[12:15], v[32:35], 0
    v_mfma_f32_16x16x32_bf16 v[80:83], v[16:19], v[36:39], v[80:83]
    s_waitcnt lgkmcnt(0)
    v_mfma_f32_16x16x32_bf16 v[80:83], v[56:59], v[40:43], v[80:83]
    v_mfma_f32_16x16x32_bf16 v[80:83], v[64:67], v[44:47], v[80:83]
    v_smfmac_f32_16x16x64_bf16 v[48:51], v[28:31], a[144:151], v6
    v_smfmac_f32_16x16x64_bf16 v[52:55], v[28:31], a[152:159], v6
    v_mov_b32 v24, 0x3f803f80
    v_mov_b32 v25, 0x3f803f80
    v_mov_b32 v26, 0x3f803f80
    v_mov_b32 v27, 0x3f803f80
    v_max3_f32 v20, v8, v9, v10
    v_max3_f32 v21, v11, v72, v73
    v_max3_f32 v20, v20, v21, v74
    v_max3_f32 v21, v80, v81, v82
    v_max3_f32 v20, v20, v75, v83
    v_max_f32 v20, v20, v21
    v_mov_b32 v21, v20
    v_cvt_pk_bf16_f32 v48, v48, v49
    v_cvt_pk_bf16_f32 v49, v50, v51
    v_permlane16_swap_b32 v20, v21
    v_max_f32 v20, v20, v21
    v_mov_b32 v21, v20
    v_cvt_pk_bf16_f32 v50, v52, v53
    v_cvt_pk_bf16_f32 v51, v54, v55
    v_permlane32_swap_b32 v20, v21
    v_max_f32 v20, v20, v21
    v_mul_f32 v22, s10, v20
    v_pk_fma_f32 v[8:9], v[8:9], s[10:11], v[22:23] op_sel_hi:[1,1,0] neg_lo:[0,0,1] neg_hi:[0,0,1]
    v_pk_fma_f32 v[10:11], v[10:11], s[10:11], v[22:23] op_sel_hi:[1,1,0] neg_lo:[0,0,1] neg_hi:[0,0,1]
    v_pk_fma_f32 v[72:73], v[72:73], s[10:11], v[22:23] op_sel_hi:[1,1,0] neg_lo:[0,0,1] neg_hi:[0,0,1]
    v_pk_fma_f32 v[74:75], v[74:75], s[10:11], v[22:23] op_sel_hi:[1,1,0] neg_lo:[0,0,1] neg_hi:[0,0,1]
    v_pk_fma_f32 v[80:81], v[80:81], s[10:11], v[22:23] op_sel_hi:[1,1,0] neg_lo:[0,0,1] neg_hi:[0,0,1]
    v_pk_fma_f32 v[82:83], v[82:83], s[10:11], v[22:23] op_sel_hi:[1,1,0] neg_lo:[0,0,1] neg_hi:[0,0,1]
    v_exp_f32 v8, v8
    v_exp_f32 v9, v9
    v_exp_f32 v10, v10
    v_exp_f32 v11, v11
    v_exp_f32 v72, v72
    v_exp_f32 v73, v73
    v_exp_f32 v74, v74
    v_exp_f32 v75, v75
    v_cvt_pk_bf16_f32 v32, v8, v9
    v_cvt_pk_bf16_f32 v33, v10, v11
    v_exp_f32 v80, v80
    v_exp_f32 v81, v81
    v_exp_f32 v82, v82
    v_exp_f32 v83, v83
    v_cvt_pk_bf16_f32 v34, v72, v73
    v_cvt_pk_bf16_f32 v35, v74, v75
    v_cndmask_b32 v12, 0, v24, s[34:35]
    v_cndmask_b32 v13, 0, v24, s[34:35]
    s_waitcnt vmcnt(3)
    v_mfma_f32_16x16x32_bf16 v[8:11], v[24:27], v[32:35], 0
    v_cvt_pk_bf16_f32 v36, v80, v81
    v_mfma_f32_16x16x32_bf16 v[40:43], v[88:91], v[32:35], 0
    v_cvt_pk_bf16_f32 v37, v82, v83
    v_mfma_f32_16x16x32_bf16 v[44:47], v[92:95], v[32:35], 0
    v_mfma_f32_16x16x16_bf16 v[8:11], v[12:13], v[36:37], v[8:11]
    v_mov_b64 v[72:73], 0
    v_mfma_f32_16x16x16_bf16 v[40:43], v[48:49], v[36:37], v[40:43]
    v_mov_b64 v[74:75], 0
    v_mfma_f32_16x16x16_bf16 v[44:47], v[50:51], v[36:37], v[44:47]
    v_mov_b64 v[76:77], 0
    v_mov_b64 v[78:79], 0
    v_mov_b64 v[80:81], 0
    v_mov_b64 v[82:83], 0
    v_rcp_f32 v22, v8
    s_nop 2
    v_cndmask_b32 v40, v44, v40, s[32:33]
    v_cndmask_b32 v41, v45, v41, s[32:33]
    v_cndmask_b32 v42, v46, v42, s[32:33]
    v_cndmask_b32 v43, v47, v43, s[32:33]
    v_pk_mul_f32 v[40:41], v[40:41], v[22:23] op_sel_hi:[1,0]
    v_pk_mul_f32 v[42:43], v[42:43], v[22:23] op_sel_hi:[1,0]
    v_cvt_pk_bf16_f32 v44, v40, v41
    v_cvt_pk_bf16_f32 v45, v42, v43
    ds_write_b64 v5, v[44:45]
    s_mov_b32 m0, s73
    s_add_u32 s28, s28, 0x80000
    buffer_load_dwordx4 v1, s[4:7], s28 offen lds
    buffer_load_dwordx4 v1, s[4:7], s28 offen offset:1024 lds
    v_and_b32 v9, 0x70, v1
    v_bfe_u32 v29, v1, 8, 1
    v_lshl_add_u32 v9, v29, 3, v9
    v_bfe_u32 v29, v1, 9, 1
    v_lshl_add_u32 v9, v29, 2, v9
    v_mov_b32 v29, 0x40000000
    s_waitcnt lgkmcnt(0)
    s_barrier
    ds_read_b128 v[12:15], v0 offset:0
    ds_read_b128 v[16:19], v0 offset:64
    ds_read_b128 v[20:23], v0 offset:128
    ds_read_b128 v[24:27], v0 offset:192
    v_cndmask_b32 v9, v29, v9, s[32:33]
    v_and_b32 v29, 16, v1
    v_lshlrev_b32 v29, v29, s38
    v_cndmask_b32 v88, 0, v29, s[44:45]
    v_cndmask_b32 v89, 0, v29, s[46:47]
    v_cndmask_b32 v90, 0, v29, s[48:49]
    v_cndmask_b32 v91, 0, v29, s[50:51]
    s_waitcnt lgkmcnt(3)
    v_smfmac_f32_16x16x64_bf16 v[72:75], v[12:15], a[160:167], v6
    s_waitcnt lgkmcnt(2)
    v_smfmac_f32_16x16x64_bf16 v[72:75], v[16:19], a[168:175], v6
    s_waitcnt lgkmcnt(1)
    v_smfmac_f32_16x16x64_bf16 v[72:75], v[20:23], a[176:183], v6
    s_waitcnt lgkmcnt(0)
    v_smfmac_f32_16x16x64_bf16 v[72:75], v[24:27], a[184:191], v6
    v_smfmac_f32_16x16x64_bf16 v[76:79], v[12:15], a[192:199], v6
    v_smfmac_f32_16x16x64_bf16 v[76:79], v[16:19], a[200:207], v6
    v_cvt_pk_bf16_f32 v72, v72, v73
    v_smfmac_f32_16x16x64_bf16 v[76:79], v[20:23], a[208:215], v6
    v_cvt_pk_bf16_f32 v73, v74, v75
    v_smfmac_f32_16x16x64_bf16 v[76:79], v[24:27], a[216:223], v6
    v_and_or_b32 v72, v72, -2, s16
    v_mfma_f32_16x16x32_bf16 v[80:83], v[12:15], a[224:227], 0
    buffer_store_dwordx2 v[72:73], v7, s[4:7], s23 offen sc1
    v_mfma_f32_16x16x32_bf16 v[80:83], v[16:19], a[228:231], v[80:83]
    v_mfma_f32_16x16x32_bf16 v[80:83], v[20:23], a[232:235], v[80:83]
    v_cvt_pk_bf16_f32 v76, v76, v77
    v_cvt_pk_bf16_f32 v77, v78, v79
    v_mfma_f32_16x16x32_bf16 v[80:83], v[24:27], a[236:239], v[80:83]
    v_and_or_b32 v76, v76, -2, s16
    buffer_store_dwordx2 v[76:77], v7, s[4:7], s25 offen sc1
    s_add_u32 s17, s17, 0x4000
    s_add_u32 s3, s3, 0x80000
    s_add_u32 s29, s29, 0x80000
    s_add_u32 s18, s18, 0x4000
    s_add_u32 s21, s21, 0x8000
    s_add_u32 s15, s15, 1
    s_nop 0
    v_cvt_pk_bf16_f32 v80, v80, v81
    v_cvt_pk_bf16_f32 v81, v82, v83
    v_and_or_b32 v80, v80, -2, s16
    s_mov_b64 exec, s[34:35]
    buffer_store_dwordx2 v[80:81], v7, s[4:7], s26 offen sc1
    s_mov_b64 exec, -1
    s_cmp_lg_u32 s42, 0
    s_cbranch_scc1 OWN_43
    s_cmp_lt_u32 s14, 2
    s_cbranch_scc1 IDLE_42
    s_branch REC_POLL_S
OWN_43:
    s_nop 15
    s_nop 13
    buffer_load_dwordx4 v[12:15], v1, s[4:7], s24 offen offset:0 sc1
    buffer_load_dwordx4 v[16:19], v1, s[4:7], s24 offen offset:1024 sc1
    buffer_load_dwordx4 v[20:23], v1, s[4:7], s24 offen offset:2048 sc1
    buffer_load_dwordx4 v[24:27], v1, s[4:7], s24 offen offset:3072 sc1
    ds_read_b128 v[56:59], v2 offset:0
    ds_read_b128 v[60:63], v2 offset:1024
    ds_read_b128 v[64:67], v2 offset:2048
    ds_read_b128 v[68:71], v2 offset:3072
    v_mov_b64 v[32:33], 0
    v_mov_b64 v[34:35], 0
    v_mov_b64 v[36:37], 0
    v_mov_b64 v[38:39], 0
    v_mov_b64 v[40:41], 0
    v_mov_b64 v[42:43], 0
    v_mov_b64 v[44:45], 0
    v_mov_b64 v[46:47], 0
    buffer_load_dwordx4 v[72:75], v1, s[4:7], s24 offen offset:0 sc1
    buffer_load_dwordx4 v[76:79], v1, s[4:7], s24 offen offset:1024 sc1
    buffer_load_dwordx4 v[80:83], v1, s[4:7], s24 offen offset:2048 sc1
    buffer_load_dwordx4 v[84:87], v1, s[4:7], s24 offen offset:3072 sc1
    v_mov_b64 v[48:49], 0
    v_mov_b64 v[50:51], 0
    v_mov_b64 v[52:53], 0
    v_mov_b64 v[54:55], 0
OPOLL_45:
    s_waitcnt vmcnt(7)
    v_mfma_f32_16x16x32_bf16 v[92:95], v[12:15], v[88:91], 0
    v_bitop3_b32 v10, v12, v14, s16 bitop3:0x7e
    s_waitcnt vmcnt(6)
    v_mfma_f32_16x16x32_bf16 v[92:95], v[16:19], v[88:91], v[92:95]
    v_bitop3_b32 v11, v16, v18, s16 bitop3:0x7e
    s_waitcnt vmcnt(5)
    v_mfma_f32_16x16x32_bf16 v[92:95], v[20:23], v[88:91], v[92:95]
    v_bitop3_b32 v30, v20, v22, s16 bitop3:0x7e
    s_waitcnt vmcnt(4)
    v_mfma_f32_16x16x32_bf16 v[92:95], v[24:27], v[88:91], v[92:95]
    v_bitop3_b32 v31, v24, v26, s16 bitop3:0x7e
    v_or3_b32 v10, v10, v11, v30
    v_bitop3_b32 v10, v10, v31, 1 bitop3:0xa8
    v_cmp_ne_u32 vcc, 0, v10
    s_nop 3
    s_cbranch_vccz ODONE_44
    s_add_u32 s40, s40, 1
    buffer_load_dwordx4 v[12:15], v1, s[4:7], s24 offen offset:0 sc1
    buffer_load_dwordx4 v[16:19], v1, s[4:7], s24 offen offset:1024 sc1
    buffer_load_dwordx4 v[20:23], v1, s[4:7], s24 offen offset:2048 sc1
    buffer_load_dwordx4 v[24:27], v1, s[4:7], s24 offen offset:3072 sc1
    s_waitcnt vmcnt(7)
    v_mfma_f32_16x16x32_bf16 v[92:95], v[72:75], v[88:91], 0
    v_bitop3_b32 v10, v72, v74, s16 bitop3:0x7e
    s_waitcnt vmcnt(6)
    v_mfma_f32_16x16x32_bf16 v[92:95], v[76:79], v[88:91], v[92:95]
    v_bitop3_b32 v11, v76, v78, s16 bitop3:0x7e
    s_waitcnt vmcnt(5)
    v_mfma_f32_16x16x32_bf16 v[92:95], v[80:83], v[88:91], v[92:95]
    v_bitop3_b32 v30, v80, v82, s16 bitop3:0x7e
    s_waitcnt vmcnt(4)
    v_mfma_f32_16x16x32_bf16 v[92:95], v[84:87], v[88:91], v[92:95]
    v_bitop3_b32 v31, v84, v86, s16 bitop3:0x7e
    v_or3_b32 v10, v10, v11, v30
    v_bitop3_b32 v10, v10, v31, 1 bitop3:0xa8
    v_cmp_ne_u32 vcc, 0, v10
    s_add_u32 s68, s68, 1
    s_cmp_gt_u32 s68, 262144
    s_cbranch_scc1 ODONE_44
    s_nop 0
    s_cbranch_vccz ODONE_44
    s_add_u32 s40, s40, 1
    buffer_load_dwordx4 v[72:75], v1, s[4:7], s24 offen offset:0 sc1
    buffer_load_dwordx4 v[76:79], v1, s[4:7], s24 offen offset:1024 sc1
    buffer_load_dwordx4 v[80:83], v1, s[4:7], s24 offen offset:2048 sc1
    buffer_load_dwordx4 v[84:87], v1, s[4:7], s24 offen offset:3072 sc1
    s_branch OPOLL_45
ODONE_44:
    v_permlane32_swap_b32 v92, v94
    v_permlane32_swap_b32 v93, v95
    v_add_f32 v92, v92, v94
    v_add_f32 v93, v93, v95
    v_cvt_pk_bf16_f32 v8, v92, v93
    buffer_store_dword v8, v9, s[4:7], s18 offen sc1
    s_barrier
    s_nop 15
    s_nop 15
    s_nop 12
    buffer_store_dword v8, v9, s[4:7], s21 offen sc1
    s_cmp_lt_u32 s15, 61
    s_cbranch_scc1 EFLG_46
    buffer_store_dword v6, off, s[4:7], s22 sc1
EFLG_46:
    s_xor_b32 s16, s16, 1
    s_waitcnt vmcnt(2) lgkmcnt(0)
    s_cmp_lt_u32 s15, 63
    s_cbranch_scc1 REC_LOOP_S
    s_branch REC_END
IDLE_42:
    s_barrier
    v_mov_b64 v[32:33], 0
    v_mov_b64 v[34:35], 0
    v_mov_b64 v[36:37], 0
    v_mov_b64 v[38:39], 0
    v_mov_b64 v[40:41], 0
    v_mov_b64 v[42:43], 0
    v_mov_b64 v[44:45], 0
    v_mov_b64 v[46:47], 0
    v_mov_b64 v[48:49], 0
    v_mov_b64 v[50:51], 0
    v_mov_b64 v[52:53], 0
    v_mov_b64 v[54:55], 0
    ds_read_b128 v[56:59], v2 offset:0
    ds_read_b128 v[60:63], v2 offset:1024
    ds_read_b128 v[64:67], v2 offset:2048
    ds_read_b128 v[68:71], v2 offset:3072
    s_xor_b32 s16, s16, 1
    s_waitcnt vmcnt(0)
    s_cmp_lt_u32 s15, 63
    s_cbranch_scc1 REC_LOOP_S
    s_branch REC_END
REC_TAIL_S:
RETRY_25:
SPIN_47:
    buffer_load_dwordx4 v[20:23], v1, s[4:7], s17 offen offset:2048 sc1
    buffer_load_dwordx4 v[24:27], v1, s[4:7], s17 offen offset:3072 sc1
    buffer_load_dwordx4 v[28:31], v1, s[4:7], s74 offen offset:0 sc1
    s_add_u32 s68, s68, 1
    s_add_u32 s40, s40, 1024
    s_cmp_gt_u32 s68, 262144
    s_waitcnt vmcnt(0)
    s_cbranch_scc1 BACK_26
    v_cmp_eq_u32 vcc, -1, v23
    s_cbranch_vccnz SPIN_47
    s_branch BACK_26
RETRY_27:
SPIN_48:
    buffer_load_dwordx4 v[24:27], v1, s[4:7], s17 offen offset:3072 sc1
    buffer_load_dwordx4 v[28:31], v1, s[4:7], s74 offen offset:0 sc1
    s_add_u32 s68, s68, 1
    s_add_u32 s40, s40, 1024
    s_cmp_gt_u32 s68, 262144
    s_waitcnt vmcnt(0)
    s_cbranch_scc1 BACK_28
    v_cmp_eq_u32 vcc, -1, v27
    s_cbranch_vccnz SPIN_48
    s_branch BACK_28
RETRY_29:
SPIN_49:
    buffer_load_dwordx4 v[28:31], v1, s[4:7], s74 offen offset:0 sc1
    s_add_u32 s68, s68, 1
    s_add_u32 s40, s40, 1024
    s_cmp_gt_u32 s68, 262144
    s_waitcnt vmcnt(0)
    s_cbranch_scc1 BACK_30
    v_cmp_eq_u32 vcc, -1, v31
    s_cbranch_vccnz SPIN_49
    s_branch BACK_30
RETRY_31:
SPIN_50:
    buffer_load_dwordx4 v[12:15], v1, s[4:7], s20 offen offset:0 sc1
    buffer_load_dwordx4 v[16:19], v1, s[4:7], s20 offen offset:1024 sc1
    buffer_load_dwordx4 v[20:23], v1, s[4:7], s20 offen offset:2048 sc1
    buffer_load_dwordx4 v[24:27], v1, s[4:7], s20 offen offset:3072 sc1
    s_add_u32 s68, s68, 1
    s_add_u32 s40, s40, 1048576
    s_cmp_gt_u32 s68, 262144
    s_waitcnt vmcnt(0)
    s_cbranch_scc1 BACK_32
    v_cmp_eq_u32 vcc, -1, v15
    s_cbranch_vccnz SPIN_50
    s_branch BACK_32
RETRY_33:
SPIN_51:
    buffer_load_dwordx4 v[16:19], v1, s[4:7], s20 offen offset:1024 sc1
    buffer_load_dwordx4 v[20:23], v1, s[4:7], s20 offen offset:2048 sc1
    buffer_load_dwordx4 v[24:27], v1, s[4:7], s20 offen offset:3072 sc1
    buffer_load_dwordx4 v[28:31], v1, s[4:7], s75 offen offset:0 sc1
    s_add_u32 s68, s68, 1
    s_add_u32 s40, s40, 1048576
    s_cmp_gt_u32 s68, 262144
    s_waitcnt vmcnt(0)
    s_cbranch_scc1 BACK_34
    v_cmp_eq_u32 vcc, -1, v19
    s_cbranch_vccnz SPIN_51
    s_branch BACK_34
RETRY_35:
SPIN_52:
    buffer_load_dwordx4 v[20:23], v1, s[4:7], s20 offen offset:2048 sc1
    buffer_load_dwordx4 v[24:27], v1, s[4:7], s20 offen offset:3072 sc1
    buffer_load_dwordx4 v[28:31], v1, s[4:7], s75 offen offset:0 sc1
    s_add_u32 s68, s68, 1
    s_add_u32 s40, s40, 1048576
    s_cmp_gt_u32 s68, 262144
    s_waitcnt vmcnt(0)
    s_cbranch_scc1 BACK_36
    v_cmp_eq_u32 vcc, -1, v23
    s_cbranch_vccnz SPIN_52
    s_branch BACK_36
RETRY_37:
SPIN_53:
    buffer_load_dwordx4 v[24:27], v1, s[4:7], s20 offen offset:3072 sc1
    buffer_load_dwordx4 v[28:31], v1, s[4:7], s75 offen offset:0 sc1
    s_add_u32 s68, s68, 1
    s_add_u32 s40, s40, 1048576
    s_cmp_gt_u32 s68, 262144
    s_waitcnt vmcnt(0)
    s_cbranch_scc1 BACK_38
    v_cmp_eq_u32 vcc, -1, v27
    s_cbranch_vccnz SPIN_53
    s_branch BACK_38
RETRY_39:
SPIN_54:
    buffer_load_dwordx4 v[28:31], v1, s[4:7], s75 offen offset:0 sc1
    s_add_u32 s68, s68, 1
    s_add_u32 s40, s40, 1048576
    s_cmp_gt_u32 s68, 262144
    s_waitcnt vmcnt(0)
    s_cbranch_scc1 BACK_40
    v_cmp_eq_u32 vcc, -1, v31
    s_cbranch_vccnz SPIN_54
    s_branch BACK_40
REC_POLL:
    s_cmp_eq_u32 s59, 0
    s_cbranch_scc1 NOFLG_55
    s_waitcnt vmcnt(0)
    v_lshrrev_b32 v29, 2, v1
    ds_read_b32 v12, v29 offset:15104
    s_add_u32 s64, s15, 2
    s_lshr_b32 s65, s64, 1
    s_add_u32 s67, s65, 1
    s_waitcnt lgkmcnt(0)
    v_cmp_ne_u32 vcc, 0, v12
    v_readlane_b32 s65, v12, s65
    v_readlane_b32 s67, v12, s67
    s_cmp_eq_u32 vcc_lo, -1
    s_cselect_b32 s58, 1, 0
    s_and_b32 s65, s65, s67
    s_cbranch_scc1 NOFLG_55
    s_lshl_b32 s64, s64, 7
    s_add_u32 s64, s64, s69
    v_mov_b32 v29, 0
FSPIN_57:
    buffer_load_dwordx2 v[12:13], v29, s[4:7], s64 offen sc1
    s_add_u32 s68, s68, 1
    s_waitcnt vmcnt(0)
    v_and_b32 v12, v12, v13
    v_cmp_eq_u32 vcc, 0, v12
    s_cbranch_vccz FDONE_58
    s_cmp_gt_u32 s68, 262144
    s_cbranch_scc0 FSPIN_57
FDONE_58:
NOFLG_55:
    s_add_u32 s64, s15, 3
    s_and_b32 s64, s64, 0x43
    s_or_b32 s64, s64, s58
    s_cmp_eq_u32 s64, 0
    s_cselect_b32 s59, 1, 0
    s_add_u32 s66, s17, s52
    v_add_u32 v10, s52, v1
    s_xor_b32 s16, s16, 1
    v_mov_b64 v[32:33], 0
    v_mov_b64 v[34:35], 0
    v_mov_b64 v[36:37], 0
    v_mov_b64 v[38:39], 0
    v_mov_b64 v[40:41], 0
    v_mov_b64 v[42:43], 0
    v_mov_b64 v[44:45], 0
    v_mov_b64 v[46:47], 0
    v_mov_b64 v[48:49], 0
    v_mov_b64 v[50:51], 0
    v_mov_b64 v[52:53], 0
    v_mov_b64 v[54:55], 0
    ds_read_b128 v[56:59], v2 offset:0
    ds_read_b128 v[60:63], v2 offset:1024
    ds_read_b128 v[64:67], v2 offset:2048
    ds_read_b128 v[68:71], v2 offset:3072
    s_barrier
    s_cmp_lt_u32 s15, 63
    s_cbranch_scc0 REC_END
    s_nop 14
    buffer_load_dwordx4 v[20:23], v1, s[4:7], s66 offen offset:0 sc1
    s_nop 7
    buffer_load_dwordx4 v[24:27], v1, s[4:7], s66 offen offset:0 sc1
    s_nop 7
    buffer_load_dwordx4 v[28:31], v1, s[4:7], s66 offen offset:0 sc1
IPOLL_60:
    s_waitcnt vmcnt(2)
    ds_write_b128 v10, v[20:23] offset:12800
    v_max3_u32 v11, v20, v21, v22
    v_max_u32 v11, v11, v23
    v_cmp_eq_u32 vcc, -1, v11
    s_cbranch_vccz IOK_59
    buffer_load_dwordx4 v[20:23], v1, s[4:7], s66 offen offset:0 sc1
    s_waitcnt vmcnt(2)
    ds_write_b128 v10, v[24:27] offset:12800
    v_max3_u32 v11, v24, v25, v26
    v_max_u32 v11, v11, v27
    v_cmp_eq_u32 vcc, -1, v11
    s_cbranch_vccz IOK_59
    buffer_load_dwordx4 v[24:27], v1, s[4:7], s66 offen offset:0 sc1
    s_waitcnt vmcnt(2)
    ds_write_b128 v10, v[28:31] offset:12800
    v_max3_u32 v11, v28, v29, v30
    v_max_u32 v11, v11, v31
    v_cmp_eq_u32 vcc, -1, v11
    s_add_u32 s68, s68, 1
    s_add_u32 s53, s53, 1
    s_cmp_gt_u32 s68, 262144
    s_cbranch_scc1 IOK_59
    s_cbranch_vccz IOK_59
    buffer_load_dwordx4 v[28:31], v1, s[4:7], s66 offen offset:0 sc1
    s_branch IPOLL_60
IOK_59:
    s_waitcnt lgkmcnt(0)
REC_LOOP:
    s_barrier
    ds_read_b128 v[12:15], v1 offset:12800
    ds_read_b128 v[16:19], v1 offset:13824
    buffer_load_dwordx4 v[20:23], v1, s[4:7], s17 offen offset:2048
    ds_read_b128 v[72:75], v2 offset:4096
    ds_read_b128 v[76:79], v2 offset:5120
    ds_read_b128 v[80:83], v2 offset:6144
    ds_read_b128 v[84:87], v2 offset:7168
    s_add_u32 s74, s17, 0x1000
    s_add_u32 s20, s20, 0x8000
    s_add_u32 s75, s20, 0x1000
    s_mov_b32 m0, 16128
    s_add_u32 s65, s20, s27
    s_waitcnt lgkmcnt(5)
    v_smfmac_f32_16x16x64_bf16 v[32:35], v[12:15], v[96:103], v6
    buffer_load_dwordx4 v[24:27], v1, s[4:7], s17 offen offset:3072
    v_smfmac_f32_16x16x64_bf16 v[36:39], v[12:15], v[104:111], v6
    v_smfmac_f32_16x16x64_bf16 v[40:43], v[12:15], v[56:63], v6
    buffer_load_dwordx4 v[28:31], v1, s[4:7], s74 offen offset:0
    ds_read_b128 v[56:59], v2 offset:8192
    ds_read_b128 v[60:63], v2 offset:9216
    v_smfmac_f32_16x16x64_bf16 v[44:47], v[12:15], v[64:71], v6
    ds_read_b128 v[64:67], v2 offset:10240
    ds_read_b128 v[68:71], v2 offset:11264
    s_waitcnt lgkmcnt(8)
    v_smfmac_f32_16x16x64_bf16 v[48:51], v[12:15], a[0:7], v6
    v_smfmac_f32_16x16x64_bf16 v[52:55], v[12:15], a[8:15], v6
    buffer_load_dwordx4 v[12:15], v1, s[4:7], s20 offen offset:0
    buffer_load_dword off, s[4:7], s65 lds
    v_smfmac_f32_16x16x64_bf16 v[32:35], v[16:19], v[112:119], v6
    v_smfmac_f32_16x16x64_bf16 v[36:39], v[16:19], v[120:127], v6
    s_waitcnt lgkmcnt(4)
    v_smfmac_f32_16x16x64_bf16 v[40:43], v[16:19], v[72:79], v6
    ds_read_b128 v[72:75], v2 offset:12288
    ds_read_b128 v[76:79], v2 offset:13312
    v_smfmac_f32_16x16x64_bf16 v[44:47], v[16:19], v[80:87], v6
    ds_read_b128 v[80:83], v2 offset:14336
    ds_read_b128 v[84:87], v2 offset:15360
    s_waitcnt vmcnt(4)
    v_cmp_eq_u32 vcc, -1, v23
    v_smfmac_f32_16x16x64_bf16 v[48:51], v[16:19], a[16:23], v6
    v_smfmac_f32_16x16x64_bf16 v[52:55], v[16:19], a[24:31], v6
    s_cbranch_vccnz RETRY_61
BACK_62:
    buffer_load_dwordx4 v[16:19], v1, s[4:7], s20 offen offset:1024
    v_smfmac_f32_16x16x64_bf16 v[32:35], v[20:23], v[128:135], v6
    v_smfmac_f32_16x16x64_bf16 v[36:39], v[20:23], v[136:143], v6
    s_waitcnt lgkmcnt(4)
    v_smfmac_f32_16x16x64_bf16 v[40:43], v[20:23], v[56:63], v6
    ds_read_b128 v[56:59], v2 offset:16384
    ds_read_b128 v[60:63], v2 offset:17408
    v_smfmac_f32_16x16x64_bf16 v[44:47], v[20:23], v[64:71], v6
    ds_read_b128 v[64:67], v2 offset:18432
    ds_read_b128 v[68:71], v2 offset:19456
    s_waitcnt vmcnt(4)
    v_cmp_eq_u32 vcc, -1, v27
    v_smfmac_f32_16x16x64_bf16 v[48:51], v[20:23], a[32:39], v6
    v_smfmac_f32_16x16x64_bf16 v[52:55], v[20:23], a[40:47], v6
    s_cbranch_vccnz RETRY_63
BACK_64:
    buffer_load_dwordx4 v[20:23], v1, s[4:7], s20 offen offset:2048
    v_smfmac_f32_16x16x64_bf16 v[32:35], v[24:27], v[144:151], v6
    v_smfmac_f32_16x16x64_bf16 v[36:39], v[24:27], v[152:159], v6
    s_waitcnt lgkmcnt(4)
    v_smfmac_f32_16x16x64_bf16 v[40:43], v[24:27], v[72:79], v6
    ds_read_b128 v[72:75], v2 offset:20480
    ds_read_b128 v[76:79], v2 offset:21504
    v_smfmac_f32_16x16x64_bf16 v[44:47], v[24:27], v[80:87], v6
    ds_read_b128 v[80:83], v2 offset:22528
    ds_read_b128 v[84:87], v2 offset:23552
    s_waitcnt vmcnt(4)
    v_cmp_eq_u32 vcc, -1, v31
    v_smfmac_f32_16x16x64_bf16 v[48:51], v[24:27], a[48:55], v6
    v_smfmac_f32_16x16x64_bf16 v[52:55], v[24:27], a[56:63], v6
    s_cbranch_vccnz RETRY_65
BACK_66:
    buffer_load_dwordx4 v[24:27], v1, s[4:7], s20 offen offset:3072
    v_smfmac_f32_16x16x64_bf16 v[32:35], v[28:31], v[160:167], v6
    v_smfmac_f32_16x16x64_bf16 v[36:39], v[28:31], v[168:175], v6
    s_waitcnt lgkmcnt(4)
    v_smfmac_f32_16x16x64_bf16 v[40:43], v[28:31], v[56:63], v6
    ds_read_b128 v[56:59], v2 offset:24576
    ds_read_b128 v[60:63], v2 offset:25600
    v_smfmac_f32_16x16x64_bf16 v[44:47], v[28:31], v[64:71], v6
    ds_read_b128 v[64:67], v2 offset:26624
    ds_read_b128 v[68:71], v2 offset:27648
    s_waitcnt vmcnt(4)
    v_cmp_eq_u32 vcc, -1, v15
    v_smfmac_f32_16x16x64_bf16 v[48:51], v[28:31], a[64:71], v6
    v_smfmac_f32_16x16x64_bf16 v[52:55], v[28:31], a[72:79], v6
    s_cbranch_vccnz RETRY_67
BACK_68:
    buffer_load_dwordx4 v[28:31], v1, s[4:7], s75 offen offset:0
    v_smfmac_f32_16x16x64_bf16 v[32:35], v[12:15], v[176:183], v6
    s_waitcnt vmcnt(3)
    v_cmp_eq_u32 vcc, -1, v19
    v_smfmac_f32_16x16x64_bf16 v[36:39], v[12:15], v[184:191], v6
    s_waitcnt lgkmcnt(4)
    v_smfmac_f32_16x16x64_bf16 v[40:43], v[12:15], v[72:79], v6
    ds_read_b128 v[72:75], v2 offset:28672
    ds_read_b128 v[76:79], v2 offset:29696
    v_smfmac_f32_16x16x64_bf16 v[44:47], v[12:15], v[80:87], v6
    ds_read_b128 v[80:83], v2 offset:30720
    ds_read_b128 v[84:87], v2 offset:31744
    buffer_load_dwordx4 v[88:91], v1, s[4:7], s29 offen offset:0
    s_cbranch_vccnz RETRY_69
BACK_70:
    v_smfmac_f32_16x16x64_bf16 v[32:35], v[16:19], v[192:199], v6
    s_waitcnt vmcnt(3)
    v_cmp_eq_u32 vcc, -1, v23
    v_smfmac_f32_16x16x64_bf16 v[36:39], v[16:19], v[200:207], v6
    s_waitcnt lgkmcnt(4)
    v_smfmac_f32_16x16x64_bf16 v[40:43], v[16:19], v[56:63], v6
    ds_read_b128 v[56:59], v2 offset:32768
    ds_read_b128 v[60:63], v2 offset:33792
    v_smfmac_f32_16x16x64_bf16 v[44:47], v[16:19], v[64:71], v6
    ds_read_b128 v[64:67], v2 offset:34816
    ds_read_b128 v[68:71], v2 offset:35840
    s_cbranch_vccnz RETRY_71
BACK_72:
    v_smfmac_f32_16x16x64_bf16 v[32:35], v[20:23], v[208:215], v6
    s_waitcnt vmcnt(2)
    v_cmp_eq_u32 vcc, -1, v27
    v_smfmac_f32_16x16x64_bf16 v[36:39], v[20:23], v[216:223], v6
    s_waitcnt lgkmcnt(4)
    v_smfmac_f32_16x16x64_bf16 v[40:43], v[20:23], v[72:79], v6
    ds_read_b128 v[72:75], v1 offset:0
    ds_read_b128 v[76:79], v1 offset:4096
    v_smfmac_f32_16x16x64_bf16 v[44:47], v[20:23], v[80:87], v6
    ds_read_b128 v[80:83], v1 offset:1024
    ds_read_b128 v[84:87], v1 offset:5120
    buffer_load_dwordx4 v[92:95], v1, s[4:7], s29 offen offset:1024
    s_cbranch_vccnz RETRY_73
BACK_74:
    v_smfmac_f32_16x16x64_bf16 v[32:35], v[24:27], v[224:231], v6
    s_waitcnt vmcnt(2)
    v_cmp_eq_u32 vcc, -1, v31
    v_smfmac_f32_16x16x64_bf16 v[36:39], v[24:27], v[232:239], v6
    s_waitcnt lgkmcnt(4)
    v_smfmac_f32_16x16x64_bf16 v[40:43], v[24:27], v[56:63], v6
    ds_read_b128 v[56:59], v1 offset:2048
    ds_read_b128 v[60:63], v1 offset:6144
    v_smfmac_f32_16x16x64_bf16 v[44:47], v[24:27], v[64:71], v6
    ds_read_b128 v[64:67], v1 offset:3072
    ds_read_b128 v[68:71], v1 offset:7168
    s_cbranch_vccnz RETRY_75
BACK_76:
    v_smfmac_f32_16x16x64_bf16 v[32:35], v[28:31], v[240:247], v6
    v_smfmac_f32_16x16x64_bf16 v[36:39], v[28:31], v[248:255], v6
    v_smfmac_f32_16x16x64_bf16 v[40:43], v[28:31], a[240:247], v6
    v_smfmac_f32_16x16x64_bf16 v[44:47], v[28:31], a[248:255], v6
    v_lshlrev_b32 v8, 2, v1
    s_add_u32 s65, s17, s19
    buffer_load_dword v8, s[4:7], s3 offen lds
    buffer_load_dword off, s[4:7], s65 sc1 lds
    buffer_store_dword v6, off, s[4:7], s22 sc1
    s_add_u32 s22, s22, 256
    s_cmp_eq_u32 s59, 0
    s_cbranch_scc1 KVLOOK_77
    v_lshrrev_b32 v9, 5, v1
    v_lshlrev_b32 v9, 9, v9
    v_bfe_u32 v10, v1, 4, 1
    v_lshl_add_u32 v9, v10, 2, v9
    s_mov_b32 m0, 15104
    s_mov_b64 exec, s[34:35]
    buffer_load_dword v9, s[4:7], s69 offen sc1 lds
    s_mov_b64 exec, -1
    s_mov_b32 m0, 16128
KVLOOK_77:
    v_permlane32_swap_b32 v32, v36
    v_permlane32_swap_b32 v33, v37
    v_permlane32_swap_b32 v34, v38
    v_permlane32_swap_b32 v35, v39
    v_pk_add_f32 v[32:33], v[32:33], v[36:37]
    v_pk_add_f32 v[34:35], v[34:35], v[38:39]
    v_cvt_pk_bf16_f32 v36, v32, v33
    v_cvt_pk_bf16_f32 v37, v34, v35
    ds_write_b64 v3, v[36:37] offset:0
    v_permlane32_swap_b32 v40, v44
    v_permlane32_swap_b32 v41, v45
    v_permlane32_swap_b32 v42, v46
    v_permlane32_swap_b32 v43, v47
    v_pk_add_f32 v[40:41], v[40:41], v[44:45]
    v_pk_add_f32 v[42:43], v[42:43], v[46:47]
    v_cvt_pk_bf16_f32 v44, v40, v41
    v_cvt_pk_bf16_f32 v45, v42, v43
    ds_write_b64 v3, v[44:45] offset:2304
    v_smfmac_f32_16x16x64_bf16 v[48:51], v[12:15], a[80:87], v6
    v_smfmac_f32_16x16x64_bf16 v[52:55], v[12:15], a[88:95], v6
    v_smfmac_f32_16x16x64_bf16 v[48:51], v[16:19], a[96:103], v6
    v_smfmac_f32_16x16x64_bf16 v[52:55], v[16:19], a[104:111], v6
    s_waitcnt lgkmcnt(0)
    s_barrier
    ds_read_b64_tr_b16 v[32:33], v4 offset:0
    ds_read_b64_tr_b16 v[34:35], v4 offset:128
    ds_read_b64_tr_b16 v[36:37], v4 offset:256
    ds_read_b64_tr_b16 v[38:39], v4 offset:384
    v_smfmac_f32_16x16x64_bf16 v[48:51], v[20:23], a[112:119], v6
    v_smfmac_f32_16x16x64_bf16 v[52:55], v[20:23], a[120:127], v6
    ds_read_b64_tr_b16 v[40:41], v4 offset:512
    ds_read_b64_tr_b16 v[42:43], v4 offset:640
    ds_read_b64_tr_b16 v[44:45], v4 offset:768
    ds_read_b64_tr_b16 v[46:47], v4 offset:896
    v_smfmac_f32_16x16x64_bf16 v[48:51], v[24:27], a[128:135], v6
    v_smfmac_f32_16x16x64_bf16 v[52:55], v[24:27], a[136:143], v6
    s_waitcnt lgkmcnt(4)
    v_mfma_f32_16x16x32_bf16 v[8:11], v[72:75], v[32:35], 0
    ds_read_b64_tr_b16 v[12:13], v4 offset:2304
    ds_read_b64_tr_b16 v[14:15], v4 offset:2432
    v_mfma_f32_16x16x32_bf16 v[8:11], v[80:83], v[36:39], v[8:11]
    ds_read_b64_tr_b16 v[16:17], v4 offset:2560
    ds_read_b64_tr_b16 v[18:19], v4 offset:2688
    s_waitcnt lgkmcnt(4)
    v_mfma_f32_16x16x32_bf16 v[8:11], v[56:59], v[40:43], v[8:11]
    ds_read_b64_tr_b16 v[56:57], v4 offset:2816
    ds_read_b64_tr_b16 v[58:59], v4 offset:2944
    v_mfma_f32_16x16x32_bf16 v[8:11], v[64:67], v[44:47], v[8:11]
    ds_read_b64_tr_b16 v[64:65], v4 offset:3072
    ds_read_b64_tr_b16 v[66:67], v4 offset:3200
    v_mfma_f32_16x16x32_bf16 v[72:75], v[76:79], v[32:35], 0
    v_mfma_f32_16x16x32_bf16 v[72:75], v[84:87], v[36:39], v[72:75]
    v_mfma_f32_16x16x32_bf16 v[72:75], v[60:63], v[40:43], v[72:75]
    v_mfma_f32_16x16x32_bf16 v[72:75], v[68:71], v[44:47], v[72:75]
    s_waitcnt lgkmcnt(4)
    v_mfma_f32_16x16x32_bf16 v[80:83], v[12:15], v[32:35], 0
    v_mfma_f32_16x16x32_bf16 v[80:83], v[16:19], v[36:39], v[80:83]
    s_waitcnt lgkmcnt(0)
    v_mfma_f32_16x16x32_bf16 v[80:83], v[56:59], v[40:43], v[80:83]
    v_mfma_f32_16x16x32_bf16 v[80:83], v[64:67], v[44:47], v[80:83]
    v_smfmac_f32_16x16x64_bf16 v[48:51], v[28:31], a[144:151], v6
    v_smfmac_f32_16x16x64_bf16 v[52:55], v[28:31], a[152:159], v6
    v_mov_b32 v24, 0x3f803f80
    v_mov_b32 v25, 0x3f803f80
    v_mov_b32 v26, 0x3f803f80
    v_mov_b32 v27, 0x3f803f80
    v_max3_f32 v20, v8, v9, v10
    v_max3_f32 v21, v11, v72, v73
    v_max3_f32 v20, v20, v21, v74
    v_max3_f32 v21, v80, v81, v82
    v_max3_f32 v20, v20, v75, v83
    v_max_f32 v20, v20, v21
    v_mov_b32 v21, v20
    v_cvt_pk_bf16_f32 v48, v48, v49
    v_cvt_pk_bf16_f32 v49, v50, v51
    v_permlane16_swap_b32 v20, v21
    v_max_f32 v20, v20, v21
    v_mov_b32 v21, v20
    v_cvt_pk_bf16_f32 v50, v52, v53
    v_cvt_pk_bf16_f32 v51, v54, v55
    v_permlane32_swap_b32 v20, v21
    v_max_f32 v20, v20, v21
    v_mul_f32 v22, s10, v20
    v_pk_fma_f32 v[8:9], v[8:9], s[10:11], v[22:23] op_sel_hi:[1,1,0] neg_lo:[0,0,1] neg_hi:[0,0,1]
    v_pk_fma_f32 v[10:11], v[10:11], s[10:11], v[22:23] op_sel_hi:[1,1,0] neg_lo:[0,0,1] neg_hi:[0,0,1]
    v_pk_fma_f32 v[72:73], v[72:73], s[10:11], v[22:23] op_sel_hi:[1,1,0] neg_lo:[0,0,1] neg_hi:[0,0,1]
    v_pk_fma_f32 v[74:75], v[74:75], s[10:11], v[22:23] op_sel_hi:[1,1,0] neg_lo:[0,0,1] neg_hi:[0,0,1]
    v_pk_fma_f32 v[80:81], v[80:81], s[10:11], v[22:23] op_sel_hi:[1,1,0] neg_lo:[0,0,1] neg_hi:[0,0,1]
    v_pk_fma_f32 v[82:83], v[82:83], s[10:11], v[22:23] op_sel_hi:[1,1,0] neg_lo:[0,0,1] neg_hi:[0,0,1]
    v_exp_f32 v8, v8
    v_exp_f32 v9, v9
    v_exp_f32 v10, v10
    v_exp_f32 v11, v11
    v_exp_f32 v72, v72
    v_exp_f32 v73, v73
    v_exp_f32 v74, v74
    v_exp_f32 v75, v75
    v_cvt_pk_bf16_f32 v32, v8, v9
    v_cvt_pk_bf16_f32 v33, v10, v11
    v_exp_f32 v80, v80
    v_exp_f32 v81, v81
    v_exp_f32 v82, v82
    v_exp_f32 v83, v83
    v_cvt_pk_bf16_f32 v34, v72, v73
    v_cvt_pk_bf16_f32 v35, v74, v75
    v_cndmask_b32 v12, 0, v24, s[34:35]
    v_cndmask_b32 v13, 0, v24, s[34:35]
    s_waitcnt vmcnt(3)
    v_mfma_f32_16x16x32_bf16 v[8:11], v[24:27], v[32:35], 0
    v_cvt_pk_bf16_f32 v36, v80, v81
    v_mfma_f32_16x16x32_bf16 v[40:43], v[88:91], v[32:35], 0
    v_cvt_pk_bf16_f32 v37, v82, v83
    v_mfma_f32_16x16x32_bf16 v[44:47], v[92:95], v[32:35], 0
    v_mfma_f32_16x16x16_bf16 v[8:11], v[12:13], v[36:37], v[8:11]
    v_mov_b64 v[72:73], 0
    v_mfma_f32_16x16x16_bf16 v[40:43], v[48:49], v[36:37], v[40:43]
    v_mov_b64 v[74:75], 0
    v_mfma_f32_16x16x16_bf16 v[44:47], v[50:51], v[36:37], v[44:47]
    v_mov_b64 v[76:77], 0
    v_mov_b64 v[78:79], 0
    v_mov_b64 v[80:81], 0
    v_mov_b64 v[82:83], 0
    v_rcp_f32 v22, v8
    s_nop 2
    v_cndmask_b32 v40, v44, v40, s[32:33]
    v_cndmask_b32 v41, v45, v41, s[32:33]
    v_cndmask_b32 v42, v46, v42, s[32:33]
    v_cndmask_b32 v43, v47, v43, s[32:33]
    v_pk_mul_f32 v[40:41], v[40:41], v[22:23] op_sel_hi:[1,0]
    v_pk_mul_f32 v[42:43], v[42:43], v[22:23] op_sel_hi:[1,0]
    v_cvt_pk_bf16_f32 v44, v40, v41
    v_cvt_pk_bf16_f32 v45, v42, v43
    ds_write_b64 v5, v[44:45]
    s_mov_b32 m0, s73
    s_add_u32 s28, s28, 0x80000
    buffer_load_dwordx4 v1, s[4:7], s28 offen lds
    buffer_load_dwordx4 v1, s[4:7], s28 offen offset:1024 lds
    v_and_b32 v9, 0x70, v1
    v_bfe_u32 v29, v1, 8, 1
    v_lshl_add_u32 v9, v29, 3, v9
    v_bfe_u32 v29, v1, 9, 1
    v_lshl_add_u32 v9, v29, 2, v9
    v_mov_b32 v29, 0x40000000
    s_waitcnt lgkmcnt(0)
    s_barrier
    ds_read_b128 v[12:15], v0 offset:0
    ds_read_b128 v[16:19], v0 offset:64
    ds_read_b128 v[20:23], v0 offset:128
    ds_read_b128 v[24:27], v0 offset:192
    v_cndmask_b32 v9, v29, v9, s[32:33]
    v_and_b32 v29, 16, v1
    v_lshlrev_b32 v29, v29, s38
    v_cndmask_b32 v88, 0, v29, s[44:45]
    v_cndmask_b32 v89, 0, v29, s[46:47]
    v_cndmask_b32 v90, 0, v29, s[48:49]
    v_cndmask_b32 v91, 0, v29, s[50:51]
    s_waitcnt lgkmcnt(3)
    v_smfmac_f32_16x16x64_bf16 v[72:75], v[12:15], a[160:167], v6
    s_waitcnt lgkmcnt(2)
    v_smfmac_f32_16x16x64_bf16 v[72:75], v[16:19], a[168:175], v6
    s_waitcnt lgkmcnt(1)
    v_smfmac_f32_16x16x64_bf16 v[72:75], v[20:23], a[176:183], v6
    s_waitcnt lgkmcnt(0)
    v_smfmac_f32_16x16x64_bf16 v[72:75], v[24:27], a[184:191], v6
    v_smfmac_f32_16x16x64_bf16 v[76:79], v[12:15], a[192:199], v6
    v_smfmac_f32_16x16x64_bf16 v[76:79], v[16:19], a[200:207], v6
    v_cvt_pk_bf16_f32 v72, v72, v73
    v_smfmac_f32_16x16x64_bf16 v[76:79], v[20:23], a[208:215], v6
    v_cvt_pk_bf16_f32 v73, v74, v75
    v_smfmac_f32_16x16x64_bf16 v[76:79], v[24:27], a[216:223], v6
    v_and_or_b32 v72, v72, -2, s16
    v_mfma_f32_16x16x32_bf16 v[80:83], v[12:15], a[224:227], 0
    buffer_store_dwordx2 v[72:73], v7, s[4:7], s23 offen
    v_mfma_f32_16x16x32_bf16 v[80:83], v[16:19], a[228:231], v[80:83]
    v_mfma_f32_16x16x32_bf16 v[80:83], v[20:23], a[232:235], v[80:83]
    v_cvt_pk_bf16_f32 v76, v76, v77
    v_cvt_pk_bf16_f32 v77, v78, v79
    v_mfma_f32_16x16x32_bf16 v[80:83], v[24:27], a[236:239], v[80:83]
    v_and_or_b32 v76, v76, -2, s16
    buffer_store_dwordx2 v[76:77], v7, s[4:7], s25 offen
    s_add_u32 s17, s17, 0x4000
    s_add_u32 s3, s3, 0x80000
    s_add_u32 s29, s29, 0x80000
    s_add_u32 s18, s18, 0x4000
    s_add_u32 s21, s21, 0x8000
    s_add_u32 s15, s15, 1
    s_nop 0
    v_cvt_pk_bf16_f32 v80, v80, v81
    v_cvt_pk_bf16_f32 v81, v82, v83
    v_and_or_b32 v80, v80, -2, s16
    s_mov_b64 exec, s[34:35]
    buffer_store_dwordx2 v[80:81], v7, s[4:7], s26 offen
    s_mov_b64 exec, -1
    s_cmp_lg_u32 s42, 0
    s_cbranch_scc1 OWN_79
    s_cmp_lt_u32 s14, 2
    s_cbranch_scc1 IDLE_78
    s_branch REC_POLL
OWN_79:
    s_nop 15
    s_nop 13
    buffer_load_dwordx4 v[12:15], v1, s[4:7], s24 offen offset:0 sc1
    buffer_load_dwordx4 v[16:19], v1, s[4:7], s24 offen offset:1024 sc1
    buffer_load_dwordx4 v[20:23], v1, s[4:7], s24 offen offset:2048 sc1
    buffer_load_dwordx4 v[24:27], v1, s[4:7], s24 offen offset:3072 sc1
    ds_read_b128 v[56:59], v2 offset:0
    ds_read_b128 v[60:63], v2 offset:1024
    ds_read_b128 v[64:67], v2 offset:2048
    ds_read_b128 v[68:71], v2 offset:3072
    v_mov_b64 v[32:33], 0
    v_mov_b64 v[34:35], 0
    v_mov_b64 v[36:37], 0
    v_mov_b64 v[38:39], 0
    v_mov_b64 v[40:41], 0
    v_mov_b64 v[42:43], 0
    v_mov_b64 v[44:45], 0
    v_mov_b64 v[46:47], 0
    buffer_load_dwordx4 v[72:75], v1, s[4:7], s24 offen offset:0 sc1
    buffer_load_dwordx4 v[76:79], v1, s[4:7], s24 offen offset:1024 sc1
    buffer_load_dwordx4 v[80:83], v1, s[4:7], s24 offen offset:2048 sc1
    buffer_load_dwordx4 v[84:87], v1, s[4:7], s24 offen offset:3072 sc1
    v_mov_b64 v[48:49], 0
    v_mov_b64 v[50:51], 0
    v_mov_b64 v[52:53], 0
    v_mov_b64 v[54:55], 0
OPOLL_81:
    s_waitcnt vmcnt(7)
    v_mfma_f32_16x16x32_bf16 v[92:95], v[12:15], v[88:91], 0
    v_bitop3_b32 v10, v12, v14, s16 bitop3:0x7e
    s_waitcnt vmcnt(6)
    v_mfma_f32_16x16x32_bf16 v[92:95], v[16:19], v[88:91], v[92:95]
    v_bitop3_b32 v11, v16, v18, s16 bitop3:0x7e
    s_waitcnt vmcnt(5)
    v_mfma_f32_16x16x32_bf16 v[92:95], v[20:23], v[88:91], v[92:95]
    v_bitop3_b32 v30, v20, v22, s16 bitop3:0x7e
    s_waitcnt vmcnt(4)
    v_mfma_f32_16x16x32_bf16 v[92:95], v[24:27], v[88:91], v[92:95]
    v_bitop3_b32 v31, v24, v26, s16 bitop3:0x7e
    v_or3_b32 v10, v10, v11, v30
    v_bitop3_b32 v10, v10, v31, 1 bitop3:0xa8
    v_cmp_ne_u32 vcc, 0, v10
    s_nop 3
    s_cbranch_vccz ODONE_80
    s_add_u32 s40, s40, 1
    buffer_load_dwordx4 v[12:15], v1, s[4:7], s24 offen offset:0 sc1
    buffer_load_dwordx4 v[16:19], v1, s[4:7], s24 offen offset:1024 sc1
    buffer_load_dwordx4 v[20:23], v1, s[4:7], s24 offen offset:2048 sc1
    buffer_load_dwordx4 v[24:27], v1, s[4:7], s24 offen offset:3072 sc1
    s_waitcnt vmcnt(7)
    v_mfma_f32_16x16x32_bf16 v[92:95], v[72:75], v[88:91], 0
    v_bitop3_b32 v10, v72, v74, s16 bitop3:0x7e
    s_waitcnt vmcnt(6)
    v_mfma_f32_16x16x32_bf16 v[92:95], v[76:79], v[88:91], v[92:95]
    v_bitop3_b32 v11, v76, v78, s16 bitop3:0x7e
    s_waitcnt vmcnt(5)
    v_mfma_f32_16x16x32_bf16 v[92:95], v[80:83], v[88:91], v[92:95]
    v_bitop3_b32 v30, v80, v82, s16 bitop3:0x7e
    s_waitcnt vmcnt(4)
    v_mfma_f32_16x16x32_bf16 v[92:95], v[84:87], v[88:91], v[92:95]
    v_bitop3_b32 v31, v84, v86, s16 bitop3:0x7e
    v_or3_b32 v10, v10, v11, v30
    v_bitop3_b32 v10, v10, v31, 1 bitop3:0xa8
    v_cmp_ne_u32 vcc, 0, v10
    s_add_u32 s68, s68, 1
    s_cmp_gt_u32 s68, 262144
    s_cbranch_scc1 ODONE_80
    s_nop 0
    s_cbranch_vccz ODONE_80
    s_add_u32 s40, s40, 1
    buffer_load_dwordx4 v[72:75], v1, s[4:7], s24 offen offset:0 sc1
    buffer_load_dwordx4 v[76:79], v1, s[4:7], s24 offen offset:1024 sc1
    buffer_load_dwordx4 v[80:83], v1, s[4:7], s24 offen offset:2048 sc1
    buffer_load_dwordx4 v[84:87], v1, s[4:7], s24 offen offset:3072 sc1
    s_branch OPOLL_81
ODONE_80:
    v_permlane32_swap_b32 v92, v94
    v_permlane32_swap_b32 v93, v95
    v_add_f32 v92, v92, v94
    v_add_f32 v93, v93, v95
    v_cvt_pk_bf16_f32 v8, v92, v93
    buffer_store_dword v8, v9, s[4:7], s18 offen
    s_barrier
    s_nop 15
    s_nop 15
    s_nop 12
    buffer_store_dword v8, v9, s[4:7], s21 offen sc1
    s_cmp_lt_u32 s15, 61
    s_cbranch_scc1 EFLG_82
    buffer_store_dword v6, off, s[4:7], s22 sc1
EFLG_82:
    s_xor_b32 s16, s16, 1
    s_waitcnt vmcnt(2) lgkmcnt(0)
    s_cmp_lt_u32 s15, 63
    s_cbranch_scc1 REC_LOOP
    s_branch REC_END
IDLE_78:
    s_barrier
    v_mov_b64 v[32:33], 0
    v_mov_b64 v[34:35], 0
    v_mov_b64 v[36:37], 0
    v_mov_b64 v[38:39], 0
    v_mov_b64 v[40:41], 0
    v_mov_b64 v[42:43], 0
    v_mov_b64 v[44:45], 0
    v_mov_b64 v[46:47], 0
    v_mov_b64 v[48:49], 0
    v_mov_b64 v[50:51], 0
    v_mov_b64 v[52:53], 0
    v_mov_b64 v[54:55], 0
    ds_read_b128 v[56:59], v2 offset:0
    ds_read_b128 v[60:63], v2 offset:1024
    ds_read_b128 v[64:67], v2 offset:2048
    ds_read_b128 v[68:71], v2 offset:3072
    s_xor_b32 s16, s16, 1
    s_waitcnt vmcnt(0)
    s_cmp_lt_u32 s15, 63
    s_cbranch_scc1 REC_LOOP
    s_branch REC_END
REC_TAIL:
RETRY_61:
SPIN_83:
    buffer_load_dwordx4 v[20:23], v1, s[4:7], s17 offen offset:2048 sc1
    buffer_load_dwordx4 v[24:27], v1, s[4:7], s17 offen offset:3072 sc1
    buffer_load_dwordx4 v[28:31], v1, s[4:7], s74 offen offset:0 sc1
    s_add_u32 s68, s68, 1
    s_add_u32 s40, s40, 1024
    s_cmp_gt_u32 s68, 262144
    s_waitcnt vmcnt(0)
    s_cbranch_scc1 BACK_62
    v_cmp_eq_u32 vcc, -1, v23
    s_cbranch_vccnz SPIN_83
    s_branch BACK_62
RETRY_63:
SPIN_84:
    buffer_load_dwordx4 v[24:27], v1, s[4:7], s17 offen offset:3072 sc1
    buffer_load_dwordx4 v[28:31], v1, s[4:7], s74 offen offset:0 sc1
    s_add_u32 s68, s68, 1
    s_add_u32 s40, s40, 1024
    s_cmp_gt_u32 s68, 262144
    s_waitcnt vmcnt(0)
    s_cbranch_scc1 BACK_64
    v_cmp_eq_u32 vcc, -1, v27
    s_cbranch_vccnz SPIN_84
    s_branch BACK_64
RETRY_65:
SPIN_85:
    buffer_load_dwordx4 v[28:31], v1, s[4:7], s74 offen offset:0 sc1
    s_add_u32 s68, s68, 1
    s_add_u32 s40, s40, 1024
    s_cmp_gt_u32 s68, 262144
    s_waitcnt vmcnt(0)
    s_cbranch_scc1 BACK_66
    v_cmp_eq_u32 vcc, -1, v31
    s_cbranch_vccnz SPIN_85
    s_branch BACK_66
RETRY_67:
SPIN_86:
    buffer_load_dwordx4 v[12:15], v1, s[4:7], s20 offen offset:0 sc1
    buffer_load_dwordx4 v[16:19], v1, s[4:7], s20 offen offset:1024 sc1
    buffer_load_dwordx4 v[20:23], v1, s[4:7], s20 offen offset:2048 sc1
    buffer_load_dwordx4 v[24:27], v1, s[4:7], s20 offen offset:3072 sc1
    s_add_u32 s68, s68, 1
    s_add_u32 s40, s40, 1048576
    s_cmp_gt_u32 s68, 262144
    s_waitcnt vmcnt(0)
    s_cbranch_scc1 BACK_68
    v_cmp_eq_u32 vcc, -1, v15
    s_cbranch_vccnz SPIN_86
    s_branch BACK_68
RETRY_69:
SPIN_87:
    buffer_load_dwordx4 v[16:19], v1, s[4:7], s20 offen offset:1024 sc1
    buffer_load_dwordx4 v[20:23], v1, s[4:7], s20 offen offset:2048 sc1
    buffer_load_dwordx4 v[24:27], v1, s[4:7], s20 offen offset:3072 sc1
    buffer_load_dwordx4 v[28:31], v1, s[4:7], s75 offen offset:0 sc1
    s_add_u32 s68, s68, 1
    s_add_u32 s40, s40, 1048576
    s_cmp_gt_u32 s68, 262144
    s_waitcnt vmcnt(0)
    s_cbranch_scc1 BACK_70
    v_cmp_eq_u32 vcc, -1, v19
    s_cbranch_vccnz SPIN_87
    s_branch BACK_70
RETRY_71:
SPIN_88:
    buffer_load_dwordx4 v[20:23], v1, s[4:7], s20 offen offset:2048 sc1
    buffer_load_dwordx4 v[24:27], v1, s[4:7], s20 offen offset:3072 sc1
    buffer_load_dwordx4 v[28:31], v1, s[4:7], s75 offen offset:0 sc1
    s_add_u32 s68, s68, 1
    s_add_u32 s40, s40, 1048576
    s_cmp_gt_u32 s68, 262144
    s_waitcnt vmcnt(0)
    s_cbranch_scc1 BACK_72
    v_cmp_eq_u32 vcc, -1, v23
    s_cbranch_vccnz SPIN_88
    s_branch BACK_72
RETRY_73:
SPIN_89:
    buffer_load_dwordx4 v[24:27], v1, s[4:7], s20 offen offset:3072 sc1
    buffer_load_dwordx4 v[28:31], v1, s[4:7], s75 offen offset:0 sc1
    s_add_u32 s68, s68, 1
    s_add_u32 s40, s40, 1048576
    s_cmp_gt_u32 s68, 262144
    s_waitcnt vmcnt(0)
    s_cbranch_scc1 BACK_74
    v_cmp_eq_u32 vcc, -1, v27
    s_cbranch_vccnz SPIN_89
    s_branch BACK_74
RETRY_75:
SPIN_90:
    buffer_load_dwordx4 v[28:31], v1, s[4:7], s75 offen offset:0 sc1
    s_add_u32 s68, s68, 1
    s_add_u32 s40, s40, 1048576
    s_cmp_gt_u32 s68, 262144
    s_waitcnt vmcnt(0)
    s_cbranch_scc1 BACK_76
    v_cmp_eq_u32 vcc, -1, v31
    s_cbranch_vccnz SPIN_90
    s_branch BACK_76
REC_END:
    s_branch M_EXIT
M_HELP:
    v_mbcnt_lo_u32_b32 v0, -1, 0
    v_mbcnt_hi_u32_b32 v0, -1, v0
    s_load_dwordx2 s[16:17], s[0:1], 0
    s_mov_b32 s18, 2621440
    s_mov_b32 s19, 0x00020000
    s_load_dwordx2 s[20:21], s[0:1], 64
    s_mov_b32 s22, 1280
    s_mov_b32 s23, 0x00020000
    s_load_dwordx2 s[24:25], s[0:1], 8
    s_mov_b32 s26, 10240
    s_mov_b32 s27, 0x00020000
    s_lshl_b32 s28, s96, 2
    s_add_u32 s28, s28, s14
    s_mul_i32 s28, s28, 3
    v_lshlrev_b32 v3, 4, v0
    v_lshlrev_b32 v4, 2, v0
    s_waitcnt lgkmcnt(0)
    s_add_u32 s29, s28, 0
    s_mul_i32 s33, s29, 1280
    buffer_load_dwordx4 v[10:13], v3, s[16:19], s33 offen
    buffer_load_dword v14, v4, s[16:19], s33 offen offset:1024
    s_add_u32 s29, s28, 1
    s_mul_i32 s34, s29, 1280
    buffer_load_dwordx4 v[16:19], v3, s[16:19], s34 offen
    buffer_load_dword v20, v4, s[16:19], s34 offen offset:1024
    s_add_u32 s29, s28, 2
    s_mul_i32 s35, s29, 1280
    buffer_load_dwordx4 v[22:25], v3, s[16:19], s35 offen
    buffer_load_dword v26, v4, s[16:19], s35 offen offset:1024
    buffer_load_dwordx4 v[28:31], v3, s[20:23], 0 offen
    buffer_load_dword v32, v4, s[20:23], 0 offen offset:1024
    s_cmp_ge_u32 s96, 10
    s_cbranch_scc1 INM0_91
    v_and_b32 v5, 7, v0
    v_mul_u32_u24 v5, 1280, v5
    v_lshrrev_b32 v6, 4, v0
    v_lshl_add_u32 v5, v6, 5, v5
    v_bfe_u32 v6, v0, 3, 1
    v_lshl_add_u32 v5, v6, 4, v5
    s_lshl_b32 s29, s96, 7
    buffer_load_dwordx4 v[34:37], v5, s[24:27], s29 offen
INM0_91:
    s_waitcnt vmcnt(0)
    s_add_u32 s29, s28, 0
    s_cmp_ge_u32 s29, 2048
    s_cbranch_scc1 INR_92
    v_lshlrev_b32 v50, 16, v10
    v_and_b32 v60, 0xffff0000, v10
    v_lshlrev_b32 v51, 16, v11
    v_and_b32 v61, 0xffff0000, v11
    v_lshlrev_b32 v52, 16, v12
    v_and_b32 v62, 0xffff0000, v12
    v_lshlrev_b32 v53, 16, v13
    v_and_b32 v63, 0xffff0000, v13
    v_lshlrev_b32 v54, 16, v14
    v_and_b32 v64, 0xffff0000, v14
    v_add_f32 v70, v50, v60
    v_add_f32 v70, v70, v51
    v_add_f32 v70, v70, v61
    v_add_f32 v70, v70, v52
    v_add_f32 v70, v70, v62
    v_add_f32 v70, v70, v53
    v_add_f32 v70, v70, v63
    v_add_f32 v70, v70, v54
    v_add_f32 v70, v70, v64
    s_nop 1
    v_add_f32_dpp v70, v70, v70 quad_perm:[1,0,3,2] row_mask:0xf bank_mask:0xf
    s_nop 1
    v_add_f32_dpp v70, v70, v70 quad_perm:[2,3,0,1] row_mask:0xf bank_mask:0xf
    s_nop 1
    v_add_f32_dpp v70, v70, v70 row_half_mirror row_mask:0xf bank_mask:0xf
    s_nop 1
    v_add_f32_dpp v70, v70, v70 row_mirror row_mask:0xf bank_mask:0xf
    v_mov_b32 v71, v70
    s_nop 1
    v_permlane16_swap_b32 v70, v71
    v_add_f32 v70, v70, v71
    v_mov_b32 v71, v70
    s_nop 1
    v_permlane32_swap_b32 v70, v71
    v_add_f32 v70, v70, v71
    v_mul_f32 v72, 0x3acccccd, v70
    v_mov_b32 v73, 0
    v_sub_f32 v74, v50, v72
    v_fmac_f32 v73, v74, v74
    v_sub_f32 v74, v60, v72
    v_fmac_f32 v73, v74, v74
    v_sub_f32 v74, v51, v72
    v_fmac_f32 v73, v74, v74
    v_sub_f32 v74, v61, v72
    v_fmac_f32 v73, v74, v74
    v_sub_f32 v74, v52, v72
    v_fmac_f32 v73, v74, v74
    v_sub_f32 v74, v62, v72
    v_fmac_f32 v73, v74, v74
    v_sub_f32 v74, v53, v72
    v_fmac_f32 v73, v74, v74
    v_sub_f32 v74, v63, v72
    v_fmac_f32 v73, v74, v74
    v_sub_f32 v74, v54, v72
    v_fmac_f32 v73, v74, v74
    v_sub_f32 v74, v64, v72
    v_fmac_f32 v73, v74, v74
    s_nop 1
    v_add_f32_dpp v73, v73, v73 quad_perm:[1,0,3,2] row_mask:0xf bank_mask:0xf
    s_nop 1
    v_add_f32_dpp v73, v73, v73 quad_perm:[2,3,0,1] row_mask:0xf bank_mask:0xf
    s_nop 1
    v_add_f32_dpp v73, v73, v73 row_half_mirror row_mask:0xf bank_mask:0xf
    s_nop 1
    v_add_f32_dpp v73, v73, v73 row_mirror row_mask:0xf bank_mask:0xf
    v_mov_b32 v71, v73
    s_nop 1
    v_permlane16_swap_b32 v73, v71
    v_add_f32 v73, v73, v71
    v_mov_b32 v71, v73
    s_nop 1
    v_permlane32_swap_b32 v73, v71
    v_add_f32 v73, v73, v71
    v_mul_f32 v73, 0x3acccccd, v73
    v_cvt_pk_bf16_f32 v72, v72, v72
    v_lshlrev_b32 v72, 16, v72
    v_cvt_pk_bf16_f32 v73, v73, v73
    v_lshlrev_b32 v73, 16, v73
    v_add_f32 v73, 0x3727c5ac, v73
    v_cvt_pk_bf16_f32 v73, v73, v73
    v_lshlrev_b32 v73, 16, v73
    v_sqrt_f32 v73, v73
    s_nop 0
    v_cvt_pk_bf16_f32 v73, v73, v73
    v_lshlrev_b32 v73, 16, v73
    v_rcp_f32 v75, v73
    s_nop 0
    v_mov_b32 v76, 0
    v_sub_f32 v50, v50, v72
    v_cvt_pk_bf16_f32 v50, v50, v50
    v_lshlrev_b32 v50, 16, v50
    v_mul_f32 v74, v50, v75
    v_fma_f32 v77, -v74, v73, v50
    v_fma_f32 v50, v77, v75, v74
    v_sub_f32 v60, v60, v72
    v_cvt_pk_bf16_f32 v60, v60, v60
    v_lshlrev_b32 v60, 16, v60
    v_mul_f32 v74, v60, v75
    v_fma_f32 v77, -v74, v73, v60
    v_fma_f32 v60, v77, v75, v74
    v_cvt_pk_bf16_f32 v10, v50, v60
    v_lshlrev_b32 v74, 16, v10
    v_lshlrev_b32 v77, 16, v28
    v_fmac_f32 v76, v74, v77
    v_and_b32 v74, 0xffff0000, v10
    v_and_b32 v77, 0xffff0000, v28
    v_fmac_f32 v76, v74, v77
    v_sub_f32 v51, v51, v72
    v_cvt_pk_bf16_f32 v51, v51, v51
    v_lshlrev_b32 v51, 16, v51
    v_mul_f32 v74, v51, v75
    v_fma_f32 v77, -v74, v73, v51
    v_fma_f32 v51, v77, v75, v74
    v_sub_f32 v61, v61, v72
    v_cvt_pk_bf16_f32 v61, v61, v61
    v_lshlrev_b32 v61, 16, v61
    v_mul_f32 v74, v61, v75
    v_fma_f32 v77, -v74, v73, v61
    v_fma_f32 v61, v77, v75, v74
    v_cvt_pk_bf16_f32 v11, v51, v61
    v_lshlrev_b32 v74, 16, v11
    v_lshlrev_b32 v77, 16, v29
    v_fmac_f32 v76, v74, v77
    v_and_b32 v74, 0xffff0000, v11
    v_and_b32 v77, 0xffff0000, v29
    v_fmac_f32 v76, v74, v77
    v_sub_f32 v52, v52, v72
    v_cvt_pk_bf16_f32 v52, v52, v52
    v_lshlrev_b32 v52, 16, v52
    v_mul_f32 v74, v52, v75
    v_fma_f32 v77, -v74, v73, v52
    v_fma_f32 v52, v77, v75, v74
    v_sub_f32 v62, v62, v72
    v_cvt_pk_bf16_f32 v62, v62, v62
    v_lshlrev_b32 v62, 16, v62
    v_mul_f32 v74, v62, v75
    v_fma_f32 v77, -v74, v73, v62
    v_fma_f32 v62, v77, v75, v74
    v_cvt_pk_bf16_f32 v12, v52, v62
    v_lshlrev_b32 v74, 16, v12
    v_lshlrev_b32 v77, 16, v30
    v_fmac_f32 v76, v74, v77
    v_and_b32 v74, 0xffff0000, v12
    v_and_b32 v77, 0xffff0000, v30
    v_fmac_f32 v76, v74, v77
    v_sub_f32 v53, v53, v72
    v_cvt_pk_bf16_f32 v53, v53, v53
    v_lshlrev_b32 v53, 16, v53
    v_mul_f32 v74, v53, v75
    v_fma_f32 v77, -v74, v73, v53
    v_fma_f32 v53, v77, v75, v74
    v_sub_f32 v63, v63, v72
    v_cvt_pk_bf16_f32 v63, v63, v63
    v_lshlrev_b32 v63, 16, v63
    v_mul_f32 v74, v63, v75
    v_fma_f32 v77, -v74, v73, v63
    v_fma_f32 v63, v77, v75, v74
    v_cvt_pk_bf16_f32 v13, v53, v63
    v_lshlrev_b32 v74, 16, v13
    v_lshlrev_b32 v77, 16, v31
    v_fmac_f32 v76, v74, v77
    v_and_b32 v74, 0xffff0000, v13
    v_and_b32 v77, 0xffff0000, v31
    v_fmac_f32 v76, v74, v77
    v_sub_f32 v54, v54, v72
    v_cvt_pk_bf16_f32 v54, v54, v54
    v_lshlrev_b32 v54, 16, v54
    v_mul_f32 v74, v54, v75
    v_fma_f32 v77, -v74, v73, v54
    v_fma_f32 v54, v77, v75, v74
    v_sub_f32 v64, v64, v72
    v_cvt_pk_bf16_f32 v64, v64, v64
    v_lshlrev_b32 v64, 16, v64
    v_mul_f32 v74, v64, v75
    v_fma_f32 v77, -v74, v73, v64
    v_fma_f32 v64, v77, v75, v74
    v_cvt_pk_bf16_f32 v14, v54, v64
    v_lshlrev_b32 v74, 16, v14
    v_lshlrev_b32 v77, 16, v32
    v_fmac_f32 v76, v74, v77
    v_and_b32 v74, 0xffff0000, v14
    v_and_b32 v77, 0xffff0000, v32
    v_fmac_f32 v76, v74, v77
    s_add_u32 s30, s33, 0x0
    buffer_store_dwordx4 v[10:13], v3, s[4:7], s30 offen sc1
    buffer_store_dword v14, v4, s[4:7], s30 offen offset:1024 sc1
    s_nop 1
    v_add_f32_dpp v76, v76, v76 quad_perm:[1,0,3,2] row_mask:0xf bank_mask:0xf
    s_nop 1
    v_add_f32_dpp v76, v76, v76 quad_perm:[2,3,0,1] row_mask:0xf bank_mask:0xf
    s_nop 1
    v_add_f32_dpp v76, v76, v76 row_half_mirror row_mask:0xf bank_mask:0xf
    s_nop 1
    v_add_f32_dpp v76, v76, v76 row_mirror row_mask:0xf bank_mask:0xf
    v_mov_b32 v71, v76
    s_nop 1
    v_permlane16_swap_b32 v76, v71
    v_add_f32 v76, v76, v71
    v_mov_b32 v71, v76
    s_nop 1
    v_permlane32_swap_b32 v76, v71
    v_add_f32 v76, v76, v71
    v_cvt_pk_bf16_f32 v76, v76, v76
    v_lshlrev_b32 v76, 16, v76
    s_lshl_b32 s30, s29, 2
    s_add_u32 s30, s30, 0x280000
    s_mov_b64 exec, 1
    buffer_store_dword v76, off, s[4:7], s30 sc1
    s_mov_b64 exec, -1
INR_92:
    s_add_u32 s29, s28, 1
    s_cmp_ge_u32 s29, 2048
    s_cbranch_scc1 INR_93
    v_lshlrev_b32 v50, 16, v16
    v_and_b32 v60, 0xffff0000, v16
    v_lshlrev_b32 v51, 16, v17
    v_and_b32 v61, 0xffff0000, v17
    v_lshlrev_b32 v52, 16, v18
    v_and_b32 v62, 0xffff0000, v18
    v_lshlrev_b32 v53, 16, v19
    v_and_b32 v63, 0xffff0000, v19
    v_lshlrev_b32 v54, 16, v20
    v_and_b32 v64, 0xffff0000, v20
    v_add_f32 v70, v50, v60
    v_add_f32 v70, v70, v51
    v_add_f32 v70, v70, v61
    v_add_f32 v70, v70, v52
    v_add_f32 v70, v70, v62
    v_add_f32 v70, v70, v53
    v_add_f32 v70, v70, v63
    v_add_f32 v70, v70, v54
    v_add_f32 v70, v70, v64
    s_nop 1
    v_add_f32_dpp v70, v70, v70 quad_perm:[1,0,3,2] row_mask:0xf bank_mask:0xf
    s_nop 1
    v_add_f32_dpp v70, v70, v70 quad_perm:[2,3,0,1] row_mask:0xf bank_mask:0xf
    s_nop 1
    v_add_f32_dpp v70, v70, v70 row_half_mirror row_mask:0xf bank_mask:0xf
    s_nop 1
    v_add_f32_dpp v70, v70, v70 row_mirror row_mask:0xf bank_mask:0xf
    v_mov_b32 v71, v70
    s_nop 1
    v_permlane16_swap_b32 v70, v71
    v_add_f32 v70, v70, v71
    v_mov_b32 v71, v70
    s_nop 1
    v_permlane32_swap_b32 v70, v71
    v_add_f32 v70, v70, v71
    v_mul_f32 v72, 0x3acccccd, v70
    v_mov_b32 v73, 0
    v_sub_f32 v74, v50, v72
    v_fmac_f32 v73, v74, v74
    v_sub_f32 v74, v60, v72
    v_fmac_f32 v73, v74, v74
    v_sub_f32 v74, v51, v72
    v_fmac_f32 v73, v74, v74
    v_sub_f32 v74, v61, v72
    v_fmac_f32 v73, v74, v74
    v_sub_f32 v74, v52, v72
    v_fmac_f32 v73, v74, v74
    v_sub_f32 v74, v62, v72
    v_fmac_f32 v73, v74, v74
    v_sub_f32 v74, v53, v72
    v_fmac_f32 v73, v74, v74
    v_sub_f32 v74, v63, v72
    v_fmac_f32 v73, v74, v74
    v_sub_f32 v74, v54, v72
    v_fmac_f32 v73, v74, v74
    v_sub_f32 v74, v64, v72
    v_fmac_f32 v73, v74, v74
    s_nop 1
    v_add_f32_dpp v73, v73, v73 quad_perm:[1,0,3,2] row_mask:0xf bank_mask:0xf
    s_nop 1
    v_add_f32_dpp v73, v73, v73 quad_perm:[2,3,0,1] row_mask:0xf bank_mask:0xf
    s_nop 1
    v_add_f32_dpp v73, v73, v73 row_half_mirror row_mask:0xf bank_mask:0xf
    s_nop 1
    v_add_f32_dpp v73, v73, v73 row_mirror row_mask:0xf bank_mask:0xf
    v_mov_b32 v71, v73
    s_nop 1
    v_permlane16_swap_b32 v73, v71
    v_add_f32 v73, v73, v71
    v_mov_b32 v71, v73
    s_nop 1
    v_permlane32_swap_b32 v73, v71
    v_add_f32 v73, v73, v71
    v_mul_f32 v73, 0x3acccccd, v73
    v_cvt_pk_bf16_f32 v72, v72, v72
    v_lshlrev_b32 v72, 16, v72
    v_cvt_pk_bf16_f32 v73, v73, v73
    v_lshlrev_b32 v73, 16, v73
    v_add_f32 v73, 0x3727c5ac, v73
    v_cvt_pk_bf16_f32 v73, v73, v73
    v_lshlrev_b32 v73, 16, v73
    v_sqrt_f32 v73, v73
    s_nop 0
    v_cvt_pk_bf16_f32 v73, v73, v73
    v_lshlrev_b32 v73, 16, v73
    v_rcp_f32 v75, v73
    s_nop 0
    v_mov_b32 v76, 0
    v_sub_f32 v50, v50, v72
    v_cvt_pk_bf16_f32 v50, v50, v50
    v_lshlrev_b32 v50, 16, v50
    v_mul_f32 v74, v50, v75
    v_fma_f32 v77, -v74, v73, v50
    v_fma_f32 v50, v77, v75, v74
    v_sub_f32 v60, v60, v72
    v_cvt_pk_bf16_f32 v60, v60, v60
    v_lshlrev_b32 v60, 16, v60
    v_mul_f32 v74, v60, v75
    v_fma_f32 v77, -v74, v73, v60
    v_fma_f32 v60, v77, v75, v74
    v_cvt_pk_bf16_f32 v16, v50, v60
    v_lshlrev_b32 v74, 16, v16
    v_lshlrev_b32 v77, 16, v28
    v_fmac_f32 v76, v74, v77
    v_and_b32 v74, 0xffff0000, v16
    v_and_b32 v77, 0xffff0000, v28
    v_fmac_f32 v76, v74, v77
    v_sub_f32 v51, v51, v72
    v_cvt_pk_bf16_f32 v51, v51, v51
    v_lshlrev_b32 v51, 16, v51
    v_mul_f32 v74, v51, v75
    v_fma_f32 v77, -v74, v73, v51
    v_fma_f32 v51, v77, v75, v74
    v_sub_f32 v61, v61, v72
    v_cvt_pk_bf16_f32 v61, v61, v61
    v_lshlrev_b32 v61, 16, v61
    v_mul_f32 v74, v61, v75
    v_fma_f32 v77, -v74, v73, v61
    v_fma_f32 v61, v77, v75, v74
    v_cvt_pk_bf16_f32 v17, v51, v61
    v_lshlrev_b32 v74, 16, v17
    v_lshlrev_b32 v77, 16, v29
    v_fmac_f32 v76, v74, v77
    v_and_b32 v74, 0xffff0000, v17
    v_and_b32 v77, 0xffff0000, v29
    v_fmac_f32 v76, v74, v77
    v_sub_f32 v52, v52, v72
    v_cvt_pk_bf16_f32 v52, v52, v52
    v_lshlrev_b32 v52, 16, v52
    v_mul_f32 v74, v52, v75
    v_fma_f32 v77, -v74, v73, v52
    v_fma_f32 v52, v77, v75, v74
    v_sub_f32 v62, v62, v72
    v_cvt_pk_bf16_f32 v62, v62, v62
    v_lshlrev_b32 v62, 16, v62
    v_mul_f32 v74, v62, v75
    v_fma_f32 v77, -v74, v73, v62
    v_fma_f32 v62, v77, v75, v74
    v_cvt_pk_bf16_f32 v18, v52, v62
    v_lshlrev_b32 v74, 16, v18
    v_lshlrev_b32 v77, 16, v30
    v_fmac_f32 v76, v74, v77
    v_and_b32 v74, 0xffff0000, v18
    v_and_b32 v77, 0xffff0000, v30
    v_fmac_f32 v76, v74, v77
    v_sub_f32 v53, v53, v72
    v_cvt_pk_bf16_f32 v53, v53, v53
    v_lshlrev_b32 v53, 16, v53
    v_mul_f32 v74, v53, v75
    v_fma_f32 v77, -v74, v73, v53
    v_fma_f32 v53, v77, v75, v74
    v_sub_f32 v63, v63, v72
    v_cvt_pk_bf16_f32 v63, v63, v63
    v_lshlrev_b32 v63, 16, v63
    v_mul_f32 v74, v63, v75
    v_fma_f32 v77, -v74, v73, v63
    v_fma_f32 v63, v77, v75, v74
    v_cvt_pk_bf16_f32 v19, v53, v63
    v_lshlrev_b32 v74, 16, v19
    v_lshlrev_b32 v77, 16, v31
    v_fmac_f32 v76, v74, v77
    v_and_b32 v74, 0xffff0000, v19
    v_and_b32 v77, 0xffff0000, v31
    v_fmac_f32 v76, v74, v77
    v_sub_f32 v54, v54, v72
    v_cvt_pk_bf16_f32 v54, v54, v54
    v_lshlrev_b32 v54, 16, v54
    v_mul_f32 v74, v54, v75
    v_fma_f32 v77, -v74, v73, v54
    v_fma_f32 v54, v77, v75, v74
    v_sub_f32 v64, v64, v72
    v_cvt_pk_bf16_f32 v64, v64, v64
    v_lshlrev_b32 v64, 16, v64
    v_mul_f32 v74, v64, v75
    v_fma_f32 v77, -v74, v73, v64
    v_fma_f32 v64, v77, v75, v74
    v_cvt_pk_bf16_f32 v20, v54, v64
    v_lshlrev_b32 v74, 16, v20
    v_lshlrev_b32 v77, 16, v32
    v_fmac_f32 v76, v74, v77
    v_and_b32 v74, 0xffff0000, v20
    v_and_b32 v77, 0xffff0000, v32
    v_fmac_f32 v76, v74, v77
    s_add_u32 s30, s34, 0x0
    buffer_store_dwordx4 v[16:19], v3, s[4:7], s30 offen sc1
    buffer_store_dword v20, v4, s[4:7], s30 offen offset:1024 sc1
    s_nop 1
    v_add_f32_dpp v76, v76, v76 quad_perm:[1,0,3,2] row_mask:0xf bank_mask:0xf
    s_nop 1
    v_add_f32_dpp v76, v76, v76 quad_perm:[2,3,0,1] row_mask:0xf bank_mask:0xf
    s_nop 1
    v_add_f32_dpp v76, v76, v76 row_half_mirror row_mask:0xf bank_mask:0xf
    s_nop 1
    v_add_f32_dpp v76, v76, v76 row_mirror row_mask:0xf bank_mask:0xf
    v_mov_b32 v71, v76
    s_nop 1
    v_permlane16_swap_b32 v76, v71
    v_add_f32 v76, v76, v71
    v_mov_b32 v71, v76
    s_nop 1
    v_permlane32_swap_b32 v76, v71
    v_add_f32 v76, v76, v71
    v_cvt_pk_bf16_f32 v76, v76, v76
    v_lshlrev_b32 v76, 16, v76
    s_lshl_b32 s30, s29, 2
    s_add_u32 s30, s30, 0x280000
    s_mov_b64 exec, 1
    buffer_store_dword v76, off, s[4:7], s30 sc1
    s_mov_b64 exec, -1
INR_93:
    s_add_u32 s29, s28, 2
    s_cmp_ge_u32 s29, 2048
    s_cbranch_scc1 INR_94
    v_lshlrev_b32 v50, 16, v22
    v_and_b32 v60, 0xffff0000, v22
    v_lshlrev_b32 v51, 16, v23
    v_and_b32 v61, 0xffff0000, v23
    v_lshlrev_b32 v52, 16, v24
    v_and_b32 v62, 0xffff0000, v24
    v_lshlrev_b32 v53, 16, v25
    v_and_b32 v63, 0xffff0000, v25
    v_lshlrev_b32 v54, 16, v26
    v_and_b32 v64, 0xffff0000, v26
    v_add_f32 v70, v50, v60
    v_add_f32 v70, v70, v51
    v_add_f32 v70, v70, v61
    v_add_f32 v70, v70, v52
    v_add_f32 v70, v70, v62
    v_add_f32 v70, v70, v53
    v_add_f32 v70, v70, v63
    v_add_f32 v70, v70, v54
    v_add_f32 v70, v70, v64
    s_nop 1
    v_add_f32_dpp v70, v70, v70 quad_perm:[1,0,3,2] row_mask:0xf bank_mask:0xf
    s_nop 1
    v_add_f32_dpp v70, v70, v70 quad_perm:[2,3,0,1] row_mask:0xf bank_mask:0xf
    s_nop 1
    v_add_f32_dpp v70, v70, v70 row_half_mirror row_mask:0xf bank_mask:0xf
    s_nop 1
    v_add_f32_dpp v70, v70, v70 row_mirror row_mask:0xf bank_mask:0xf
    v_mov_b32 v71, v70
    s_nop 1
    v_permlane16_swap_b32 v70, v71
    v_add_f32 v70, v70, v71
    v_mov_b32 v71, v70
    s_nop 1
    v_permlane32_swap_b32 v70, v71
    v_add_f32 v70, v70, v71
    v_mul_f32 v72, 0x3acccccd, v70
    v_mov_b32 v73, 0
    v_sub_f32 v74, v50, v72
    v_fmac_f32 v73, v74, v74
    v_sub_f32 v74, v60, v72
    v_fmac_f32 v73, v74, v74
    v_sub_f32 v74, v51, v72
    v_fmac_f32 v73, v74, v74
    v_sub_f32 v74, v61, v72
    v_fmac_f32 v73, v74, v74
    v_sub_f32 v74, v52, v72
    v_fmac_f32 v73, v74, v74
    v_sub_f32 v74, v62, v72
    v_fmac_f32 v73, v74, v74
    v_sub_f32 v74, v53, v72
    v_fmac_f32 v73, v74, v74
    v_sub_f32 v74, v63, v72
    v_fmac_f32 v73, v74, v74
    v_sub_f32 v74, v54, v72
    v_fmac_f32 v73, v74, v74
    v_sub_f32 v74, v64, v72
    v_fmac_f32 v73, v74, v74
    s_nop 1
    v_add_f32_dpp v73, v73, v73 quad_perm:[1,0,3,2] row_mask:0xf bank_mask:0xf
    s_nop 1
    v_add_f32_dpp v73, v73, v73 quad_perm:[2,3,0,1] row_mask:0xf bank_mask:0xf
    s_nop 1
    v_add_f32_dpp v73, v73, v73 row_half_mirror row_mask:0xf bank_mask:0xf
    s_nop 1
    v_add_f32_dpp v73, v73, v73 row_mirror row_mask:0xf bank_mask:0xf
    v_mov_b32 v71, v73
    s_nop 1
    v_permlane16_swap_b32 v73, v71
    v_add_f32 v73, v73, v71
    v_mov_b32 v71, v73
    s_nop 1
    v_permlane32_swap_b32 v73, v71
    v_add_f32 v73, v73, v71
    v_mul_f32 v73, 0x3acccccd, v73
    v_cvt_pk_bf16_f32 v72, v72, v72
    v_lshlrev_b32 v72, 16, v72
    v_cvt_pk_bf16_f32 v73, v73, v73
    v_lshlrev_b32 v73, 16, v73
    v_add_f32 v73, 0x3727c5ac, v73
    v_cvt_pk_bf16_f32 v73, v73, v73
    v_lshlrev_b32 v73, 16, v73
    v_sqrt_f32 v73, v73
    s_nop 0
    v_cvt_pk_bf16_f32 v73, v73, v73
    v_lshlrev_b32 v73, 16, v73
    v_rcp_f32 v75, v73
    s_nop 0
    v_mov_b32 v76, 0
    v_sub_f32 v50, v50, v72
    v_cvt_pk_bf16_f32 v50, v50, v50
    v_lshlrev_b32 v50, 16, v50
    v_mul_f32 v74, v50, v75
    v_fma_f32 v77, -v74, v73, v50
    v_fma_f32 v50, v77, v75, v74
    v_sub_f32 v60, v60, v72
    v_cvt_pk_bf16_f32 v60, v60, v60
    v_lshlrev_b32 v60, 16, v60
    v_mul_f32 v74, v60, v75
    v_fma_f32 v77, -v74, v73, v60
    v_fma_f32 v60, v77, v75, v74
    v_cvt_pk_bf16_f32 v22, v50, v60
    v_lshlrev_b32 v74, 16, v22
    v_lshlrev_b32 v77, 16, v28
    v_fmac_f32 v76, v74, v77
    v_and_b32 v74, 0xffff0000, v22
    v_and_b32 v77, 0xffff0000, v28
    v_fmac_f32 v76, v74, v77
    v_sub_f32 v51, v51, v72
    v_cvt_pk_bf16_f32 v51, v51, v51
    v_lshlrev_b32 v51, 16, v51
    v_mul_f32 v74, v51, v75
    v_fma_f32 v77, -v74, v73, v51
    v_fma_f32 v51, v77, v75, v74
    v_sub_f32 v61, v61, v72
    v_cvt_pk_bf16_f32 v61, v61, v61
    v_lshlrev_b32 v61, 16, v61
    v_mul_f32 v74, v61, v75
    v_fma_f32 v77, -v74, v73, v61
    v_fma_f32 v61, v77, v75, v74
    v_cvt_pk_bf16_f32 v23, v51, v61
    v_lshlrev_b32 v74, 16, v23
    v_lshlrev_b32 v77, 16, v29
    v_fmac_f32 v76, v74, v77
    v_and_b32 v74, 0xffff0000, v23
    v_and_b32 v77, 0xffff0000, v29
    v_fmac_f32 v76, v74, v77
    v_sub_f32 v52, v52, v72
    v_cvt_pk_bf16_f32 v52, v52, v52
    v_lshlrev_b32 v52, 16, v52
    v_mul_f32 v74, v52, v75
    v_fma_f32 v77, -v74, v73, v52
    v_fma_f32 v52, v77, v75, v74
    v_sub_f32 v62, v62, v72
    v_cvt_pk_bf16_f32 v62, v62, v62
    v_lshlrev_b32 v62, 16, v62
    v_mul_f32 v74, v62, v75
    v_fma_f32 v77, -v74, v73, v62
    v_fma_f32 v62, v77, v75, v74
    v_cvt_pk_bf16_f32 v24, v52, v62
    v_lshlrev_b32 v74, 16, v24
    v_lshlrev_b32 v77, 16, v30
    v_fmac_f32 v76, v74, v77
    v_and_b32 v74, 0xffff0000, v24
    v_and_b32 v77, 0xffff0000, v30
    v_fmac_f32 v76, v74, v77
    v_sub_f32 v53, v53, v72
    v_cvt_pk_bf16_f32 v53, v53, v53
    v_lshlrev_b32 v53, 16, v53
    v_mul_f32 v74, v53, v75
    v_fma_f32 v77, -v74, v73, v53
    v_fma_f32 v53, v77, v75, v74
    v_sub_f32 v63, v63, v72
    v_cvt_pk_bf16_f32 v63, v63, v63
    v_lshlrev_b32 v63, 16, v63
    v_mul_f32 v74, v63, v75
    v_fma_f32 v77, -v74, v73, v63
    v_fma_f32 v63, v77, v75, v74
    v_cvt_pk_bf16_f32 v25, v53, v63
    v_lshlrev_b32 v74, 16, v25
    v_lshlrev_b32 v77, 16, v31
    v_fmac_f32 v76, v74, v77
    v_and_b32 v74, 0xffff0000, v25
    v_and_b32 v77, 0xffff0000, v31
    v_fmac_f32 v76, v74, v77
    v_sub_f32 v54, v54, v72
    v_cvt_pk_bf16_f32 v54, v54, v54
    v_lshlrev_b32 v54, 16, v54
    v_mul_f32 v74, v54, v75
    v_fma_f32 v77, -v74, v73, v54
    v_fma_f32 v54, v77, v75, v74
    v_sub_f32 v64, v64, v72
    v_cvt_pk_bf16_f32 v64, v64, v64
    v_lshlrev_b32 v64, 16, v64
    v_mul_f32 v74, v64, v75
    v_fma_f32 v77, -v74, v73, v64
    v_fma_f32 v64, v77, v75, v74
    v_cvt_pk_bf16_f32 v26, v54, v64
    v_lshlrev_b32 v74, 16, v26
    v_lshlrev_b32 v77, 16, v32
    v_fmac_f32 v76, v74, v77
    v_and_b32 v74, 0xffff0000, v26
    v_and_b32 v77, 0xffff0000, v32
    v_fmac_f32 v76, v74, v77
    s_add_u32 s30, s35, 0x0
    buffer_store_dwordx4 v[22:25], v3, s[4:7], s30 offen sc1
    buffer_store_dword v26, v4, s[4:7], s30 offen offset:1024 sc1
    s_nop 1
    v_add_f32_dpp v76, v76, v76 quad_perm:[1,0,3,2] row_mask:0xf bank_mask:0xf
    s_nop 1
    v_add_f32_dpp v76, v76, v76 quad_perm:[2,3,0,1] row_mask:0xf bank_mask:0xf
    s_nop 1
    v_add_f32_dpp v76, v76, v76 row_half_mirror row_mask:0xf bank_mask:0xf
    s_nop 1
    v_add_f32_dpp v76, v76, v76 row_mirror row_mask:0xf bank_mask:0xf
    v_mov_b32 v71, v76
    s_nop 1
    v_permlane16_swap_b32 v76, v71
    v_add_f32 v76, v76, v71
    v_mov_b32 v71, v76
    s_nop 1
    v_permlane32_swap_b32 v76, v71
    v_add_f32 v76, v76, v71
    v_cvt_pk_bf16_f32 v76, v76, v76
    v_lshlrev_b32 v76, 16, v76
    s_lshl_b32 s30, s29, 2
    s_add_u32 s30, s30, 0x280000
    s_mov_b64 exec, 1
    buffer_store_dword v76, off, s[4:7], s30 sc1
    s_mov_b64 exec, -1
INR_94:
    s_lshl_b32 s29, s96, 2
    s_add_u32 s29, s29, s14
    s_lshl_b32 s29, s29, 6
    v_add_u32 v5, s29, v0
    v_lshlrev_b32 v6, 4, v5
    v_mov_b32 v40, -1
    v_mov_b32 v44, 0
    v_mov_b32 v41, -1
    v_mov_b32 v45, 0
    v_mov_b32 v42, -1
    v_mov_b32 v46, 0
    v_mov_b32 v43, -1
    v_mov_b32 v47, 0
    v_cmp_gt_u32 vcc, 0x1000, v5
    s_nop 0
    s_and_saveexec_b64 s[38:39], vcc
    s_cbranch_execz INF_95
    s_mov_b32 s30, 0x290000
    buffer_store_dwordx4 v[44:47], v6, s[4:7], s30 offen sc1
INF_95:
    s_mov_b64 exec, s[38:39]
    v_cmp_gt_u32 vcc, 0x5000, v5
    s_nop 0
    s_and_saveexec_b64 s[38:39], vcc
    s_cbranch_execz INF_96
    s_mov_b32 s30, 0x300000
    buffer_store_dwordx4 v[40:43], v6, s[4:7], s30 offen sc1
INF_96:
    s_mov_b64 exec, s[38:39]
    v_lshrrev_b32 v7, 6, v5
    v_mul_u32_u24 v7, 52429, v7
    v_lshrrev_b32 v7, 18, v7
    v_mul_u32_u24 v8, 320, v7
    v_sub_u32 v8, v5, v8
    v_lshlrev_b32 v48, 4, v8
    v_lshl_add_u32 v49, v7, 13, v48
    v_cmp_gt_u32 vcc, 0xa000, v5
    s_nop 0
    s_and_saveexec_b64 s[38:39], vcc
    s_cbranch_execz INF_97
    s_mov_b32 s30, 0x5904000
    buffer_store_dwordx4 v[40:43], v49, s[4:7], s30 offen sc1
INF_97:
    s_mov_b64 exec, s[38:39]
    s_mov_b32 s65, 0
CW_98:
    buffer_load_dwordx2 v[8:9], off, s[60:63], 0 offset:132 sc1
    s_add_u32 s65, s65, 1
    s_waitcnt vmcnt(0)
    v_readfirstlane_b32 s31, v8
    v_readfirstlane_b32 s32, v9
    s_min_u32 s64, s31, s32
    s_cmp_lg_u32 s64, 0
    s_cbranch_scc1 CWD_99
    s_cmp_gt_u32 s65, 65536
    s_cbranch_scc1 CWD_99
    s_sleep 4
    s_branch CW_98
CWD_99:
    s_sub_u32 s31, s31, 1
    s_and_b32 s31, s31, 3
    s_sub_u32 s32, s32, 1
    s_and_b32 s32, s32, 3
    s_lshl_b32 s31, s31, 13
    s_lshl_b32 s32, s32, 13
    s_add_u32 s32, s32, 0x200000
    v_and_b32 v8, 1, v7
    v_cmp_eq_u32 vcc, 1, v8
    v_mov_b32 v8, s31
    v_mov_b32 v9, s32
    v_cndmask_b32 v8, v8, v9, vcc
    v_lshrrev_b32 v9, 1, v7
    v_lshl_add_u32 v8, v9, 15, v8
    v_add_u32 v49, v8, v48
    v_cmp_le_u32 vcc, 640, v5
    v_mov_b32 v9, 0x40000000
    s_nop 0
    v_cndmask_b32 v49, v9, v49, vcc
    v_cmp_gt_u32 vcc, 0xa000, v5
    s_nop 0
    s_and_saveexec_b64 s[38:39], vcc
    s_cbranch_execz INF_100
    s_mov_b32 s30, 0x6000000
    buffer_store_dwordx4 v[40:43], v49, s[4:7], s30 offen sc1
INF_100:
    s_mov_b64 exec, s[38:39]
    s_cmp_ge_u32 s96, 10
    s_cbranch_scc1 INM1_101
    s_cmp_ge_u32 s14, 2
    s_cbranch_scc1 INM1_101
    s_cmp_ge_u32 s96, 5
    s_cselect_b32 s36, 1, 0
    s_mul_i32 s29, s36, 5
    s_sub_u32 s29, s96, s29
    s_lshl_b32 s29, s29, 10
    s_lshl_b32 s30, s36, 13
    s_add_u32 s30, s30, 0x5900000
    s_cmp_eq_u32 s36, 0
    s_cselect_b32 s37, s31, s32
    s_add_u32 s37, s37, 0x6000000
    s_cmp_eq_u32 s14, 0
    s_cselect_b32 s30, s30, s37
    s_add_u32 s30, s30, s29
    buffer_store_dwordx4 v[34:37], v3, s[4:7], s30 offen sc1
INM1_101:
    s_waitcnt vmcnt(0)
    s_barrier
    s_cmp_lg_u32 s14, 0
    s_cbranch_scc1 INE_102
    s_cmp_lg_u32 s96, 10
    s_cbranch_scc1 ING_103
    v_mov_b32 v44, 1
    v_lshlrev_b32 v6, 7, v0
    s_mov_b32 s30, 0x29a000
    s_mov_b64 exec, 3
    buffer_store_dword v44, v6, s[4:7], s30 offen sc1
    s_mov_b64 exec, -1
    s_waitcnt vmcnt(0)
ING_103:
    v_mov_b32 v8, 1
    s_mov_b64 exec, 1
    buffer_atomic_add v8, off, s[60:63], s95 sc1
    s_mov_b64 exec, -1
INE_102:
    v_mbcnt_lo_u32_b32 v0, -1, 0
    v_mbcnt_hi_u32_b32 v0, -1, v0
    s_and_b32 s12, s96, 1
    s_lshr_b32 s3, s96, 1
    s_and_b32 s13, s3, 31
    s_lshr_b32 s3, s3, 5
    s_load_dwordx4 s[48:51], s[0:1], 16
    s_load_dwordx2 s[52:53], s[0:1], 32
    s_waitcnt lgkmcnt(0)
    s_mov_b32 s46, 5242880
    s_mov_b32 s47, 0x00020000
    s_cmp_eq_u32 s3, 0
    s_cbranch_scc1 H_E0
    s_cmp_eq_u32 s3, 1
    s_cbranch_scc1 H_E1
    s_cmp_eq_u32 s3, 2
    s_cbranch_scc1 H_E2
    s_branch M_EXIT
H_E0:
    s_mov_b32 s44, s50
    s_mov_b32 s45, s51
    s_lshl_b32 s16, s13, 14
    s_mov_b32 s17, 0x80000
    s_lshl_b32 s64, s14, 10
    s_add_u32 s16, s16, 0x1400000
    s_add_u32 s16, s16, s64
    s_mul_i32 s64, s12, s17
    s_lshl_b32 s64, s64, 2
    s_add_u32 s16, s16, s64
    s_lshl_b32 s18, s13, 4
    s_add_u32 s18, s18, 0x291000
    s_branch G_T
H_E1:
    s_mov_b32 s44, s52
    s_mov_b32 s45, s53
    s_lshl_b32 s16, s13, 14
    s_mov_b32 s17, 0x80000
    s_lshl_b32 s64, s14, 11
    s_add_u32 s16, s16, 0x1402000
    s_add_u32 s16, s16, s64
    s_mul_i32 s64, s12, s17
    s_lshl_b32 s64, s64, 2
    s_add_u32 s16, s16, s64
    s_lshl_b32 s18, s13, 4
    s_add_u32 s18, s18, 0x291004
    s_branch G_N
H_E2:
    s_mov_b32 s44, s48
    s_mov_b32 s45, s49
    s_lshl_b32 s16, s13, 13
    s_mov_b32 s17, 0x40000
    s_lshl_b32 s64, s14, 10
    s_add_u32 s16, s16, 0x3400000
    s_add_u32 s16, s16, s64
    s_mul_i32 s64, s12, s17
    s_lshl_b32 s64, s64, 2
    s_add_u32 s16, s16, s64
    s_lshl_b32 s18, s13, 4
    s_add_u32 s18, s18, 0x291008
    s_branch G_T
G_T:
    s_lshl_b32 s65, s13, 8
    s_lshl_b32 s66, s14, 6
    s_add_u32 s20, s65, s66
    s_mul_i32 s21, s14, 36864
    v_lshrrev_b32 v6, 2, v0
    v_mul_u32_u24 v5, 8192, v6
    v_lshrrev_b32 v6, 5, v0
    v_lshlrev_b32 v6, 1, v6
    v_and_b32 v7, 3, v0
    v_xor_b32 v6, v6, v7
    v_lshl_add_u32 v5, v6, 4, v5
    v_lshrrev_b32 v6, 5, v0
    v_lshlrev_b32 v3, 10, v6
    v_bfe_u32 v6, v0, 2, 2
    v_lshl_add_u32 v3, v6, 6, v3
    v_and_b32 v6, 3, v0
    v_lshl_add_u32 v3, v6, 3, v3
    v_bfe_u32 v6, v0, 4, 1
    v_lshl_add_u32 v3, v6, 9, v3
    v_add_u32 v3, s21, v3
    v_lshlrev_b32 v6, 5, v6
    v_sub_u32 v4, 32, v6
    v_add_u32 v4, v4, v3
    v_add_u32 v3, v3, v6
    s_add_u32 m0, s21, 0
    s_add_u32 s64, s20, 0x0
    buffer_load_dwordx4 v5, s[44:47], s64 offen lds
    s_add_u32 m0, s21, 1024
    s_add_u32 s64, s20, 0x20000
    buffer_load_dwordx4 v5, s[44:47], s64 offen lds
    s_add_u32 m0, s21, 2048
    s_add_u32 s64, s20, 0x40000
    buffer_load_dwordx4 v5, s[44:47], s64 offen lds
    s_add_u32 m0, s21, 3072
    s_add_u32 s64, s20, 0x60000
    buffer_load_dwordx4 v5, s[44:47], s64 offen lds
    s_add_u32 m0, s21, 4096
    s_add_u32 s64, s20, 0x80000
    buffer_load_dwordx4 v5, s[44:47], s64 offen lds
    s_add_u32 m0, s21, 5120
    s_add_u32 s64, s20, 0xa0000
    buffer_load_dwordx4 v5, s[44:47], s64 offen lds
    s_add_u32 m0, s21, 6144
    s_add_u32 s64, s20, 0xc0000
    buffer_load_dwordx4 v5, s[44:47], s64 offen lds
    s_add_u32 m0, s21, 7168
    s_add_u32 s64, s20, 0xe0000
    buffer_load_dwordx4 v5, s[44:47], s64 offen lds
    s_add_u32 m0, s21, 8192
    s_add_u32 s64, s20, 0x100000
    buffer_load_dwordx4 v5, s[44:47], s64 offen lds
    s_add_u32 m0, s21, 9216
    s_add_u32 s64, s20, 0x120000
    buffer_load_dwordx4 v5, s[44:47], s64 offen lds
    s_add_u32 m0, s21, 10240
    s_add_u32 s64, s20, 0x140000
    buffer_load_dwordx4 v5, s[44:47], s64 offen lds
    s_add_u32 m0, s21, 11264
    s_add_u32 s64, s20, 0x160000
    buffer_load_dwordx4 v5, s[44:47], s64 offen lds
    s_add_u32 m0, s21, 12288
    s_add_u32 s64, s20, 0x180000
    buffer_load_dwordx4 v5, s[44:47], s64 offen lds
    s_add_u32 m0, s21, 13312
    s_add_u32 s64, s20, 0x1a0000
    buffer_load_dwordx4 v5, s[44:47], s64 offen lds
    s_add_u32 m0, s21, 14336
    s_add_u32 s64, s20, 0x1c0000
    buffer_load_dwordx4 v5, s[44:47], s64 offen lds
    s_add_u32 m0, s21, 15360
    s_add_u32 s64, s20, 0x1e0000
    buffer_load_dwordx4 v5, s[44:47], s64 offen lds
    s_add_u32 m0, s21, 16384
    s_add_u32 s64, s20, 0x200000
    buffer_load_dwordx4 v5, s[44:47], s64 offen lds
    s_add_u32 m0, s21, 17408
    s_add_u32 s64, s20, 0x220000
    buffer_load_dwordx4 v5, s[44:47], s64 offen lds
    s_add_u32 m0, s21, 18432
    s_add_u32 s64, s20, 0x240000
    buffer_load_dwordx4 v5, s[44:47], s64 offen lds
    s_add_u32 m0, s21, 19456
    s_add_u32 s64, s20, 0x260000
    buffer_load_dwordx4 v5, s[44:47], s64 offen lds
    s_add_u32 m0, s21, 20480
    s_add_u32 s64, s20, 0x280000
    buffer_load_dwordx4 v5, s[44:47], s64 offen lds
    s_add_u32 m0, s21, 21504
    s_add_u32 s64, s20, 0x2a0000
    buffer_load_dwordx4 v5, s[44:47], s64 offen lds
    s_add_u32 m0, s21, 22528
    s_add_u32 s64, s20, 0x2c0000
    buffer_load_dwordx4 v5, s[44:47], s64 offen lds
    s_add_u32 m0, s21, 23552
    s_add_u32 s64, s20, 0x2e0000
    buffer_load_dwordx4 v5, s[44:47], s64 offen lds
    s_add_u32 m0, s21, 24576
    s_add_u32 s64, s20, 0x300000
    buffer_load_dwordx4 v5, s[44:47], s64 offen lds
    s_add_u32 m0, s21, 25600
    s_add_u32 s64, s20, 0x320000
    buffer_load_dwordx4 v5, s[44:47], s64 offen lds
    s_add_u32 m0, s21, 26624
    s_add_u32 s64, s20, 0x340000
    buffer_load_dwordx4 v5, s[44:47], s64 offen lds
    s_add_u32 m0, s21, 27648
    s_add_u32 s64, s20, 0x360000
    buffer_load_dwordx4 v5, s[44:47], s64 offen lds
    s_add_u32 m0, s21, 28672
    s_add_u32 s64, s20, 0x380000
    buffer_load_dwordx4 v5, s[44:47], s64 offen lds
    s_add_u32 m0, s21, 29696
    s_add_u32 s64, s20, 0x3a0000
    buffer_load_dwordx4 v5, s[44:47], s64 offen lds
    s_add_u32 m0, s21, 30720
    s_add_u32 s64, s20, 0x3c0000
    buffer_load_dwordx4 v5, s[44:47], s64 offen lds
    s_add_u32 m0, s21, 31744
    s_add_u32 s64, s20, 0x3e0000
    buffer_load_dwordx4 v5, s[44:47], s64 offen lds
    s_add_u32 m0, s21, 32768
    s_add_u32 s64, s20, 0x400000
    buffer_load_dwordx4 v5, s[44:47], s64 offen lds
    s_add_u32 m0, s21, 33792
    s_add_u32 s64, s20, 0x420000
    buffer_load_dwordx4 v5, s[44:47], s64 offen lds
    s_add_u32 m0, s21, 34816
    s_add_u32 s64, s20, 0x440000
    buffer_load_dwordx4 v5, s[44:47], s64 offen lds
    s_add_u32 m0, s21, 35840
    s_add_u32 s64, s20, 0x460000
    buffer_load_dwordx4 v5, s[44:47], s64 offen lds
    s_waitcnt vmcnt(32)
    ds_read_b64_tr_b16 v[96:97], v3 offset:0
    ds_read_b64_tr_b16 v[98:99], v3 offset:256
    ds_read_b64_tr_b16 v[100:101], v4 offset:0
    ds_read_b64_tr_b16 v[102:103], v4 offset:256
    ds_read_b64_tr_b16 v[104:105], v3 offset:2048
    ds_read_b64_tr_b16 v[106:107], v3 offset:2304
    ds_read_b64_tr_b16 v[108:109], v4 offset:2048
    ds_read_b64_tr_b16 v[110:111], v4 offset:2304
    s_waitcnt lgkmcnt(0)
    s_add_u32 m0, s21, 0
    s_add_u32 s64, s20, 0x480000
    buffer_load_dwordx4 v5, s[44:47], s64 offen lds
    s_add_u32 m0, s21, 1024
    s_add_u32 s64, s20, 0x4a0000
    buffer_load_dwordx4 v5, s[44:47], s64 offen lds
    s_add_u32 m0, s21, 2048
    s_add_u32 s64, s20, 0x4c0000
    buffer_load_dwordx4 v5, s[44:47], s64 offen lds
    s_add_u32 m0, s21, 3072
    s_add_u32 s64, s20, 0x4e0000
    buffer_load_dwordx4 v5, s[44:47], s64 offen lds
    s_waitcnt vmcnt(32)
    ds_read_b64_tr_b16 v[112:113], v3 offset:4096
    ds_read_b64_tr_b16 v[114:115], v3 offset:4352
    ds_read_b64_tr_b16 v[116:117], v4 offset:4096
    ds_read_b64_tr_b16 v[118:119], v4 offset:4352
    ds_read_b64_tr_b16 v[120:121], v3 offset:6144
    ds_read_b64_tr_b16 v[122:123], v3 offset:6400
    ds_read_b64_tr_b16 v[124:125], v4 offset:6144
    ds_read_b64_tr_b16 v[126:127], v4 offset:6400
    s_waitcnt lgkmcnt(0)
    s_waitcnt vmcnt(28)
    ds_read_b64_tr_b16 v[128:129], v3 offset:8192
    ds_read_b64_tr_b16 v[130:131], v3 offset:8448
    ds_read_b64_tr_b16 v[132:133], v4 offset:8192
    ds_read_b64_tr_b16 v[134:135], v4 offset:8448
    ds_read_b64_tr_b16 v[136:137], v3 offset:10240
    ds_read_b64_tr_b16 v[138:139], v3 offset:10496
    ds_read_b64_tr_b16 v[140:141], v4 offset:10240
    ds_read_b64_tr_b16 v[142:143], v4 offset:10496
    s_waitcnt lgkmcnt(0)
    s_waitcnt vmcnt(24)
    ds_read_b64_tr_b16 v[144:145], v3 offset:12288
    ds_read_b64_tr_b16 v[146:147], v3 offset:12544
    ds_read_b64_tr_b16 v[148:149], v4 offset:12288
    ds_read_b64_tr_b16 v[150:151], v4 offset:12544
    ds_read_b64_tr_b16 v[152:153], v3 offset:14336
    ds_read_b64_tr_b16 v[154:155], v3 offset:14592
    ds_read_b64_tr_b16 v[156:157], v4 offset:14336
    ds_read_b64_tr_b16 v[158:159], v4 offset:14592
    s_waitcnt lgkmcnt(0)
    s_waitcnt vmcnt(20)
    ds_read_b64_tr_b16 v[160:161], v3 offset:16384
    ds_read_b64_tr_b16 v[162:163], v3 offset:16640
    ds_read_b64_tr_b16 v[164:165], v4 offset:16384
    ds_read_b64_tr_b16 v[166:167], v4 offset:16640
    ds_read_b64_tr_b16 v[168:169], v3 offset:18432
    ds_read_b64_tr_b16 v[170:171], v3 offset:18688
    ds_read_b64_tr_b16 v[172:173], v4 offset:18432
    ds_read_b64_tr_b16 v[174:175], v4 offset:18688
    s_waitcnt lgkmcnt(0)
    s_waitcnt vmcnt(16)
    ds_read_b64_tr_b16 v[176:177], v3 offset:20480
    ds_read_b64_tr_b16 v[178:179], v3 offset:20736
    ds_read_b64_tr_b16 v[180:181], v4 offset:20480
    ds_read_b64_tr_b16 v[182:183], v4 offset:20736
    ds_read_b64_tr_b16 v[184:185], v3 offset:22528
    ds_read_b64_tr_b16 v[186:187], v3 offset:22784
    ds_read_b64_tr_b16 v[188:189], v4 offset:22528
    ds_read_b64_tr_b16 v[190:191], v4 offset:22784
    s_waitcnt lgkmcnt(0)
    s_waitcnt vmcnt(12)
    ds_read_b64_tr_b16 v[192:193], v3 offset:24576
    ds_read_b64_tr_b16 v[194:195], v3 offset:24832
    ds_read_b64_tr_b16 v[196:197], v4 offset:24576
    ds_read_b64_tr_b16 v[198:199], v4 offset:24832
    ds_read_b64_tr_b16 v[200:201], v3 offset:26624
    ds_read_b64_tr_b16 v[202:203], v3 offset:26880
    ds_read_b64_tr_b16 v[204:205], v4 offset:26624
    ds_read_b64_tr_b16 v[206:207], v4 offset:26880
    s_waitcnt lgkmcnt(0)
    s_waitcnt vmcnt(8)
    ds_read_b64_tr_b16 v[208:209], v3 offset:28672
    ds_read_b64_tr_b16 v[210:211], v3 offset:28928
    ds_read_b64_tr_b16 v[212:213], v4 offset:28672
    ds_read_b64_tr_b16 v[214:215], v4 offset:28928
    ds_read_b64_tr_b16 v[216:217], v3 offset:30720
    ds_read_b64_tr_b16 v[218:219], v3 offset:30976
    ds_read_b64_tr_b16 v[220:221], v4 offset:30720
    ds_read_b64_tr_b16 v[222:223], v4 offset:30976
    s_waitcnt lgkmcnt(0)
    s_waitcnt vmcnt(4)
    ds_read_b64_tr_b16 v[224:225], v3 offset:32768
    ds_read_b64_tr_b16 v[226:227], v3 offset:33024
    ds_read_b64_tr_b16 v[228:229], v4 offset:32768
    ds_read_b64_tr_b16 v[230:231], v4 offset:33024
    ds_read_b64_tr_b16 v[232:233], v3 offset:34816
    ds_read_b64_tr_b16 v[234:235], v3 offset:35072
    ds_read_b64_tr_b16 v[236:237], v4 offset:34816
    ds_read_b64_tr_b16 v[238:239], v4 offset:35072
    s_waitcnt lgkmcnt(0)
    s_waitcnt vmcnt(0)
    ds_read_b64_tr_b16 v[240:241], v3 offset:0
    ds_read_b64_tr_b16 v[242:243], v3 offset:256
    ds_read_b64_tr_b16 v[244:245], v4 offset:0
    ds_read_b64_tr_b16 v[246:247], v4 offset:256
    ds_read_b64_tr_b16 v[248:249], v3 offset:2048
    ds_read_b64_tr_b16 v[250:251], v3 offset:2304
    ds_read_b64_tr_b16 v[252:253], v4 offset:2048
    ds_read_b64_tr_b16 v[254:255], v4 offset:2304
    s_waitcnt lgkmcnt(0)
    s_cmp_lg_u32 s97, 0
    s_cbranch_scc1 CM_104
    v_mbcnt_lo_u32_b32 v0, -1, 0
    v_mbcnt_hi_u32_b32 v0, -1, v0
    v_mul_u32_u24 v8, 32, v0
    s_mov_b32 s64, 0x0
    s_mov_b32 s65, 0
    s_mov_b64 exec, 0xff
TK_105:
    buffer_load_dword v9, v8, s[60:63], s64 offen sc1
    s_add_u32 s65, s65, 1
    s_waitcnt vmcnt(0)
    s_mov_b32 s66, 0
    v_readlane_b32 s67, v9, 0
    s_add_u32 s66, s66, s67
    v_readlane_b32 s67, v9, 1
    s_add_u32 s66, s66, s67
    v_readlane_b32 s67, v9, 2
    s_add_u32 s66, s66, s67
    v_readlane_b32 s67, v9, 3
    s_add_u32 s66, s66, s67
    v_readlane_b32 s67, v9, 4
    s_add_u32 s66, s66, s67
    v_readlane_b32 s67, v9, 5
    s_add_u32 s66, s66, s67
    v_readlane_b32 s67, v9, 6
    s_add_u32 s66, s66, s67
    v_readlane_b32 s67, v9, 7
    s_add_u32 s66, s66, s67
    s_cmp_ge_u32 s66, 256
    s_cbranch_scc1 TKD_106
    s_cmp_gt_u32 s65, 262144
    s_cbranch_scc0 TK_105
TKD_106:
    v_cmp_ne_u32 vcc, 32, v9
    s_mov_b64 exec, -1
    s_cbranch_vccnz M_SLOW
CM_104:
    s_mov_b32 s65, 0
GI_107:
    buffer_load_dword v8, off, s[60:63], s95 sc1
    s_add_u32 s65, s65, 1
    s_waitcnt vmcnt(0)
    v_readfirstlane_b32 s64, v8
    s_cmp_ge_u32 s64, 192
    s_cbranch_scc1 GID_108
    s_cmp_gt_u32 s65, 65536
    s_cbranch_scc1 GID_108
    s_sleep 4
    s_branch GI_107
GID_108:
    v_mbcnt_lo_u32_b32 v0, -1, 0
    v_mbcnt_hi_u32_b32 v0, -1, v0
    s_cmp_lg_u32 s3, 2
    s_cbranch_scc1 NOSEL_109
    s_or_b32 s64, s13, s12
    s_or_b32 s64, s64, s14
    s_cmp_lg_u32 s64, 0
    s_cbranch_scc1 NOSEL_109
    s_mov_b32 s29, 0
    v_lshlrev_b32 v1, 4, v0
    s_mov_b32 s64, 0x280000
    buffer_load_dwordx4 v[16:19], v1, s[4:7], s64 offen offset:0 sc1
    buffer_load_dwordx4 v[20:23], v1, s[4:7], s64 offen offset:1024 sc1
    buffer_load_dwordx4 v[24:27], v1, s[4:7], s64 offen offset:2048 sc1
    buffer_load_dwordx4 v[28:31], v1, s[4:7], s64 offen offset:3072 sc1
    s_add_u32 s64, s64, 4096
    buffer_load_dwordx4 v[32:35], v1, s[4:7], s64 offen offset:0 sc1
    buffer_load_dwordx4 v[36:39], v1, s[4:7], s64 offen offset:1024 sc1
    buffer_load_dwordx4 v[40:43], v1, s[4:7], s64 offen offset:2048 sc1
    buffer_load_dwordx4 v[44:47], v1, s[4:7], s64 offen offset:3072 sc1
    s_waitcnt vmcnt(0)
    v_lshlrev_b32 v2, 2, v0
    v_ashrrev_i32 v3, 31, v16
    v_or_b32 v3, 0x80000000, v3
    v_xor_b32 v16, v16, v3
    v_and_b32 v16, 0xffff0000, v16
    v_sub_u32 v3, 65535, v2
    v_or_b32 v16, v16, v3
    v_ashrrev_i32 v3, 31, v17
    v_or_b32 v3, 0x80000000, v3
    v_xor_b32 v17, v17, v3
    v_and_b32 v17, 0xffff0000, v17
    v_sub_u32 v3, 65534, v2
    v_or_b32 v17, v17, v3
    v_ashrrev_i32 v3, 31, v18
    v_or_b32 v3, 0x80000000, v3
    v_xor_b32 v18, v18, v3
    v_and_b32 v18, 0xffff0000, v18
    v_sub_u32 v3, 65533, v2
    v_or_b32 v18, v18, v3
    v_ashrrev_i32 v3, 31, v19
    v_or_b32 v3, 0x80000000, v3
    v_xor_b32 v19, v19, v3
    v_and_b32 v19, 0xffff0000, v19
    v_sub_u32 v3, 65532, v2
    v_or_b32 v19, v19, v3
    v_ashrrev_i32 v3, 31, v20
    v_or_b32 v3, 0x80000000, v3
    v_xor_b32 v20, v20, v3
    v_and_b32 v20, 0xffff0000, v20
    v_sub_u32 v3, 65279, v2
    v_or_b32 v20, v20, v3
    v_ashrrev_i32 v3, 31, v21
    v_or_b32 v3, 0x80000000, v3
    v_xor_b32 v21, v21, v3
    v_and_b32 v21, 0xffff0000, v21
    v_sub_u32 v3, 65278, v2
    v_or_b32 v21, v21, v3
    v_ashrrev_i32 v3, 31, v22
    v_or_b32 v3, 0x80000000, v3
    v_xor_b32 v22, v22, v3
    v_and_b32 v22, 0xffff0000, v22
    v_sub_u32 v3, 65277, v2
    v_or_b32 v22, v22, v3
    v_ashrrev_i32 v3, 31, v23
    v_or_b32 v3, 0x80000000, v3
    v_xor_b32 v23, v23, v3
    v_and_b32 v23, 0xffff0000, v23
    v_sub_u32 v3, 65276, v2
    v_or_b32 v23, v23, v3
    v_ashrrev_i32 v3, 31, v24
    v_or_b32 v3, 0x80000000, v3
    v_xor_b32 v24, v24, v3
    v_and_b32 v24, 0xffff0000, v24
    v_sub_u32 v3, 65023, v2
    v_or_b32 v24, v24, v3
    v_ashrrev_i32 v3, 31, v25
    v_or_b32 v3, 0x80000000, v3
    v_xor_b32 v25, v25, v3
    v_and_b32 v25, 0xffff0000, v25
    v_sub_u32 v3, 65022, v2
    v_or_b32 v25, v25, v3
    v_ashrrev_i32 v3, 31, v26
    v_or_b32 v3, 0x80000000, v3
    v_xor_b32 v26, v26, v3
    v_and_b32 v26, 0xffff0000, v26
    v_sub_u32 v3, 65021, v2
    v_or_b32 v26, v26, v3
    v_ashrrev_i32 v3, 31, v27
    v_or_b32 v3, 0x80000000, v3
    v_xor_b32 v27, v27, v3
    v_and_b32 v27, 0xffff0000, v27
    v_sub_u32 v3, 65020, v2
    v_or_b32 v27, v27, v3
    v_ashrrev_i32 v3, 31, v28
    v_or_b32 v3, 0x80000000, v3
    v_xor_b32 v28, v28, v3
    v_and_b32 v28, 0xffff0000, v28
    v_sub_u32 v3, 64767, v2
    v_or_b32 v28, v28, v3
    v_ashrrev_i32 v3, 31, v29
    v_or_b32 v3, 0x80000000, v3
    v_xor_b32 v29, v29, v3
    v_and_b32 v29, 0xffff0000, v29
    v_sub_u32 v3, 64766, v2
    v_or_b32 v29, v29, v3
    v_ashrrev_i32 v3, 31, v30
    v_or_b32 v3, 0x80000000, v3
    v_xor_b32 v30, v30, v3
    v_and_b32 v30, 0xffff0000, v30
    v_sub_u32 v3, 64765, v2
    v_or_b32 v30, v30, v3
    v_ashrrev_i32 v3, 31, v31
    v_or_b32 v3, 0x80000000, v3
    v_xor_b32 v31, v31, v3
    v_and_b32 v31, 0xffff0000, v31
    v_sub_u32 v3, 64764, v2
    v_or_b32 v31, v31, v3
    v_ashrrev_i32 v3, 31, v32
    v_or_b32 v3, 0x80000000, v3
    v_xor_b32 v32, v32, v3
    v_and_b32 v32, 0xffff0000, v32
    v_sub_u32 v3, 64511, v2
    v_or_b32 v32, v32, v3
    v_ashrrev_i32 v3, 31, v33
    v_or_b32 v3, 0x80000000, v3
    v_xor_b32 v33, v33, v3
    v_and_b32 v33, 0xffff0000, v33
    v_sub_u32 v3, 64510, v2
    v_or_b32 v33, v33, v3
    v_ashrrev_i32 v3, 31, v34
    v_or_b32 v3, 0x80000000, v3
    v_xor_b32 v34, v34, v3
    v_and_b32 v34, 0xffff0000, v34
    v_sub_u32 v3, 64509, v2
    v_or_b32 v34, v34, v3
    v_ashrrev_i32 v3, 31, v35
    v_or_b32 v3, 0x80000000, v3
    v_xor_b32 v35, v35, v3
    v_and_b32 v35, 0xffff0000, v35
    v_sub_u32 v3, 64508, v2
    v_or_b32 v35, v35, v3
    v_ashrrev_i32 v3, 31, v36
    v_or_b32 v3, 0x80000000, v3
    v_xor_b32 v36, v36, v3
    v_and_b32 v36, 0xffff0000, v36
    v_sub_u32 v3, 64255, v2
    v_or_b32 v36, v36, v3
    v_ashrrev_i32 v3, 31, v37
    v_or_b32 v3, 0x80000000, v3
    v_xor_b32 v37, v37, v3
    v_and_b32 v37, 0xffff0000, v37
    v_sub_u32 v3, 64254, v2
    v_or_b32 v37, v37, v3
    v_ashrrev_i32 v3, 31, v38
    v_or_b32 v3, 0x80000000, v3
    v_xor_b32 v38, v38, v3
    v_and_b32 v38, 0xffff0000, v38
    v_sub_u32 v3, 64253, v2
    v_or_b32 v38, v38, v3
    v_ashrrev_i32 v3, 31, v39
    v_or_b32 v3, 0x80000000, v3
    v_xor_b32 v39, v39, v3
    v_and_b32 v39, 0xffff0000, v39
    v_sub_u32 v3, 64252, v2
    v_or_b32 v39, v39, v3
    v_ashrrev_i32 v3, 31, v40
    v_or_b32 v3, 0x80000000, v3
    v_xor_b32 v40, v40, v3
    v_and_b32 v40, 0xffff0000, v40
    v_sub_u32 v3, 63999, v2
    v_or_b32 v40, v40, v3
    v_ashrrev_i32 v3, 31, v41
    v_or_b32 v3, 0x80000000, v3
    v_xor_b32 v41, v41, v3
    v_and_b32 v41, 0xffff0000, v41
    v_sub_u32 v3, 63998, v2
    v_or_b32 v41, v41, v3
    v_ashrrev_i32 v3, 31, v42
    v_or_b32 v3, 0x80000000, v3
    v_xor_b32 v42, v42, v3
    v_and_b32 v42, 0xffff0000, v42
    v_sub_u32 v3, 63997, v2
    v_or_b32 v42, v42, v3
    v_ashrrev_i32 v3, 31, v43
    v_or_b32 v3, 0x80000000, v3
    v_xor_b32 v43, v43, v3
    v_and_b32 v43, 0xffff0000, v43
    v_sub_u32 v3, 63996, v2
    v_or_b32 v43, v43, v3
    v_ashrrev_i32 v3, 31, v44
    v_or_b32 v3, 0x80000000, v3
    v_xor_b32 v44, v44, v3
    v_and_b32 v44, 0xffff0000, v44
    v_sub_u32 v3, 63743, v2
    v_or_b32 v44, v44, v3
    v_ashrrev_i32 v3, 31, v45
    v_or_b32 v3, 0x80000000, v3
    v_xor_b32 v45, v45, v3
    v_and_b32 v45, 0xffff0000, v45
    v_sub_u32 v3, 63742, v2
    v_or_b32 v45, v45, v3
    v_ashrrev_i32 v3, 31, v46
    v_or_b32 v3, 0x80000000, v3
    v_xor_b32 v46, v46, v3
    v_and_b32 v46, 0xffff0000, v46
    v_sub_u32 v3, 63741, v2
    v_or_b32 v46, v46, v3
    v_ashrrev_i32 v3, 31, v47
    v_or_b32 v3, 0x80000000, v3
    v_xor_b32 v47, v47, v3
    v_and_b32 v47, 0xffff0000, v47
    v_sub_u32 v3, 63740, v2
    v_or_b32 v47, v47, v3
    v_max3_u32 v4, v16, v17, v18
    v_max3_u32 v4, v4, v19, v20
    v_max3_u32 v4, v4, v21, v22
    v_max3_u32 v4, v4, v23, v24
    v_max3_u32 v4, v4, v25, v26
    v_max3_u32 v4, v4, v27, v28
    v_max3_u32 v4, v4, v29, v30
    v_max3_u32 v4, v4, v31, v32
    v_max3_u32 v4, v4, v33, v34
    v_max3_u32 v4, v4, v35, v36
    v_max3_u32 v4, v4, v37, v38
    v_max3_u32 v4, v4, v39, v40
    v_max3_u32 v4, v4, v41, v42
    v_max3_u32 v4, v4, v43, v44
    v_max3_u32 v4, v4, v45, v46
    v_max_u32 v4, v4, v47
    s_nop 1
    v_max_u32_dpp v4, v4, v4 quad_perm:[1,0,3,2] row_mask:0xf bank_mask:0xf
    s_nop 1
    v_max_u32_dpp v4, v4, v4 quad_perm:[2,3,0,1] row_mask:0xf bank_mask:0xf
    s_nop 1
    v_max_u32_dpp v4, v4, v4 row_half_mirror row_mask:0xf bank_mask:0xf
    s_nop 1
    v_max_u32_dpp v4, v4, v4 row_mirror row_mask:0xf bank_mask:0xf
    v_mov_b32 v5, v4
    s_nop 1
    v_permlane16_swap_b32 v4, v5
    v_max_u32 v4, v4, v5
    v_mov_b32 v5, v4
    s_nop 1
    v_permlane32_swap_b32 v4, v5
    v_max_u32 v4, v4, v5
    v_mov_b32 v56, v4
    v_cmp_eq_u32 vcc, v4, v16
    s_nop 1
    v_cndmask_b32 v16, v16, 0, vcc
    v_cmp_eq_u32 vcc, v4, v17
    s_nop 1
    v_cndmask_b32 v17, v17, 0, vcc
    v_cmp_eq_u32 vcc, v4, v18
    s_nop 1
    v_cndmask_b32 v18, v18, 0, vcc
    v_cmp_eq_u32 vcc, v4, v19
    s_nop 1
    v_cndmask_b32 v19, v19, 0, vcc
    v_cmp_eq_u32 vcc, v4, v20
    s_nop 1
    v_cndmask_b32 v20, v20, 0, vcc
    v_cmp_eq_u32 vcc, v4, v21
    s_nop 1
    v_cndmask_b32 v21, v21, 0, vcc
    v_cmp_eq_u32 vcc, v4, v22
    s_nop 1
    v_cndmask_b32 v22, v22, 0, vcc
    v_cmp_eq_u32 vcc, v4, v23
    s_nop 1
    v_cndmask_b32 v23, v23, 0, vcc
    v_cmp_eq_u32 vcc, v4, v24
    s_nop 1
    v_cndmask_b32 v24, v24, 0, vcc
    v_cmp_eq_u32 vcc, v4, v25
    s_nop 1
    v_cndmask_b32 v25, v25, 0, vcc
    v_cmp_eq_u32 vcc, v4, v26
    s_nop 1
    v_cndmask_b32 v26, v26, 0, vcc
    v_cmp_eq_u32 vcc, v4, v27
    s_nop 1
    v_cndmask_b32 v27, v27, 0, vcc
    v_cmp_eq_u32 vcc, v4, v28
    s_nop 1
    v_cndmask_b32 v28, v28, 0, vcc
    v_cmp_eq_u32 vcc, v4, v29
    s_nop 1
    v_cndmask_b32 v29, v29, 0, vcc
    v_cmp_eq_u32 vcc, v4, v30
    s_nop 1
    v_cndmask_b32 v30, v30, 0, vcc
    v_cmp_eq_u32 vcc, v4, v31
    s_nop 1
    v_cndmask_b32 v31, v31, 0, vcc
    v_cmp_eq_u32 vcc, v4, v32
    s_nop 1
    v_cndmask_b32 v32, v32, 0, vcc
    v_cmp_eq_u32 vcc, v4, v33
    s_nop 1
    v_cndmask_b32 v33, v33, 0, vcc
    v_cmp_eq_u32 vcc, v4, v34
    s_nop 1
    v_cndmask_b32 v34, v34, 0, vcc
    v_cmp_eq_u32 vcc, v4, v35
    s_nop 1
    v_cndmask_b32 v35, v35, 0, vcc
    v_cmp_eq_u32 vcc, v4, v36
    s_nop 1
    v_cndmask_b32 v36, v36, 0, vcc
    v_cmp_eq_u32 vcc, v4, v37
    s_nop 1
    v_cndmask_b32 v37, v37, 0, vcc
    v_cmp_eq_u32 vcc, v4, v38
    s_nop 1
    v_cndmask_b32 v38, v38, 0, vcc
    v_cmp_eq_u32 vcc, v4, v39
    s_nop 1
    v_cndmask_b32 v39, v39, 0, vcc
    v_cmp_eq_u32 vcc, v4, v40
    s_nop 1
    v_cndmask_b32 v40, v40, 0, vcc
    v_cmp_eq_u32 vcc, v4, v41
    s_nop 1
    v_cndmask_b32 v41, v41, 0, vcc
    v_cmp_eq_u32 vcc, v4, v42
    s_nop 1
    v_cndmask_b32 v42, v42, 0, vcc
    v_cmp_eq_u32 vcc, v4, v43
    s_nop 1
    v_cndmask_b32 v43, v43, 0, vcc
    v_cmp_eq_u32 vcc, v4, v44
    s_nop 1
    v_cndmask_b32 v44, v44, 0, vcc
    v_cmp_eq_u32 vcc, v4, v45
    s_nop 1
    v_cndmask_b32 v45, v45, 0, vcc
    v_cmp_eq_u32 vcc, v4, v46
    s_nop 1
    v_cndmask_b32 v46, v46, 0, vcc
    v_cmp_eq_u32 vcc, v4, v47
    s_nop 1
    v_cndmask_b32 v47, v47, 0, vcc
    v_max3_u32 v4, v16, v17, v18
    v_max3_u32 v4, v4, v19, v20
    v_max3_u32 v4, v4, v21, v22
    v_max3_u32 v4, v4, v23, v24
    v_max3_u32 v4, v4, v25, v26
    v_max3_u32 v4, v4, v27, v28
    v_max3_u32 v4, v4, v29, v30
    v_max3_u32 v4, v4, v31, v32
    v_max3_u32 v4, v4, v33, v34
    v_max3_u32 v4, v4, v35, v36
    v_max3_u32 v4, v4, v37, v38
    v_max3_u32 v4, v4, v39, v40
    v_max3_u32 v4, v4, v41, v42
    v_max3_u32 v4, v4, v43, v44
    v_max3_u32 v4, v4, v45, v46
    v_max_u32 v4, v4, v47
    s_nop 1
    v_max_u32_dpp v4, v4, v4 quad_perm:[1,0,3,2] row_mask:0xf bank_mask:0xf
    s_nop 1
    v_max_u32_dpp v4, v4, v4 quad_perm:[2,3,0,1] row_mask:0xf bank_mask:0xf
    s_nop 1
    v_max_u32_dpp v4, v4, v4 row_half_mirror row_mask:0xf bank_mask:0xf
    s_nop 1
    v_max_u32_dpp v4, v4, v4 row_mirror row_mask:0xf bank_mask:0xf
    v_mov_b32 v5, v4
    s_nop 1
    v_permlane16_swap_b32 v4, v5
    v_max_u32 v4, v4, v5
    v_mov_b32 v5, v4
    s_nop 1
    v_permlane32_swap_b32 v4, v5
    v_max_u32 v4, v4, v5
    v_mov_b32 v57, v4
    v_cmp_eq_u32 vcc, v4, v16
    s_nop 1
    v_cndmask_b32 v16, v16, 0, vcc
    v_cmp_eq_u32 vcc, v4, v17
    s_nop 1
    v_cndmask_b32 v17, v17, 0, vcc
    v_cmp_eq_u32 vcc, v4, v18
    s_nop 1
    v_cndmask_b32 v18, v18, 0, vcc
    v_cmp_eq_u32 vcc, v4, v19
    s_nop 1
    v_cndmask_b32 v19, v19, 0, vcc
    v_cmp_eq_u32 vcc, v4, v20
    s_nop 1
    v_cndmask_b32 v20, v20, 0, vcc
    v_cmp_eq_u32 vcc, v4, v21
    s_nop 1
    v_cndmask_b32 v21, v21, 0, vcc
    v_cmp_eq_u32 vcc, v4, v22
    s_nop 1
    v_cndmask_b32 v22, v22, 0, vcc
    v_cmp_eq_u32 vcc, v4, v23
    s_nop 1
    v_cndmask_b32 v23, v23, 0, vcc
    v_cmp_eq_u32 vcc, v4, v24
    s_nop 1
    v_cndmask_b32 v24, v24, 0, vcc
    v_cmp_eq_u32 vcc, v4, v25
    s_nop 1
    v_cndmask_b32 v25, v25, 0, vcc
    v_cmp_eq_u32 vcc, v4, v26
    s_nop 1
    v_cndmask_b32 v26, v26, 0, vcc
    v_cmp_eq_u32 vcc, v4, v27
    s_nop 1
    v_cndmask_b32 v27, v27, 0, vcc
    v_cmp_eq_u32 vcc, v4, v28
    s_nop 1
    v_cndmask_b32 v28, v28, 0, vcc
    v_cmp_eq_u32 vcc, v4, v29
    s_nop 1
    v_cndmask_b32 v29, v29, 0, vcc
    v_cmp_eq_u32 vcc, v4, v30
    s_nop 1
    v_cndmask_b32 v30, v30, 0, vcc
    v_cmp_eq_u32 vcc, v4, v31
    s_nop 1
    v_cndmask_b32 v31, v31, 0, vcc
    v_cmp_eq_u32 vcc, v4, v32
    s_nop 1
    v_cndmask_b32 v32, v32, 0, vcc
    v_cmp_eq_u32 vcc, v4, v33
    s_nop 1
    v_cndmask_b32 v33, v33, 0, vcc
    v_cmp_eq_u32 vcc, v4, v34
    s_nop 1
    v_cndmask_b32 v34, v34, 0, vcc
    v_cmp_eq_u32 vcc, v4, v35
    s_nop 1
    v_cndmask_b32 v35, v35, 0, vcc
    v_cmp_eq_u32 vcc, v4, v36
    s_nop 1
    v_cndmask_b32 v36, v36, 0, vcc
    v_cmp_eq_u32 vcc, v4, v37
    s_nop 1
    v_cndmask_b32 v37, v37, 0, vcc
    v_cmp_eq_u32 vcc, v4, v38
    s_nop 1
    v_cndmask_b32 v38, v38, 0, vcc
    v_cmp_eq_u32 vcc, v4, v39
    s_nop 1
    v_cndmask_b32 v39, v39, 0, vcc
    v_cmp_eq_u32 vcc, v4, v40
    s_nop 1
    v_cndmask_b32 v40, v40, 0, vcc
    v_cmp_eq_u32 vcc, v4, v41
    s_nop 1
    v_cndmask_b32 v41, v41, 0, vcc
    v_cmp_eq_u32 vcc, v4, v42
    s_nop 1
    v_cndmask_b32 v42, v42, 0, vcc
    v_cmp_eq_u32 vcc, v4, v43
    s_nop 1
    v_cndmask_b32 v43, v43, 0, vcc
    v_cmp_eq_u32 vcc, v4, v44
    s_nop 1
    v_cndmask_b32 v44, v44, 0, vcc
    v_cmp_eq_u32 vcc, v4, v45
    s_nop 1
    v_cndmask_b32 v45, v45, 0, vcc
    v_cmp_eq_u32 vcc, v4, v46
    s_nop 1
    v_cndmask_b32 v46, v46, 0, vcc
    v_cmp_eq_u32 vcc, v4, v47
    s_nop 1
    v_cndmask_b32 v47, v47, 0, vcc
    v_max3_u32 v4, v16, v17, v18
    v_max3_u32 v4, v4, v19, v20
    v_max3_u32 v4, v4, v21, v22
    v_max3_u32 v4, v4, v23, v24
    v_max3_u32 v4, v4, v25, v26
    v_max3_u32 v4, v4, v27, v28
    v_max3_u32 v4, v4, v29, v30
    v_max3_u32 v4, v4, v31, v32
    v_max3_u32 v4, v4, v33, v34
    v_max3_u32 v4, v4, v35, v36
    v_max3_u32 v4, v4, v37, v38
    v_max3_u32 v4, v4, v39, v40
    v_max3_u32 v4, v4, v41, v42
    v_max3_u32 v4, v4, v43, v44
    v_max3_u32 v4, v4, v45, v46
    v_max_u32 v4, v4, v47
    s_nop 1
    v_max_u32_dpp v4, v4, v4 quad_perm:[1,0,3,2] row_mask:0xf bank_mask:0xf
    s_nop 1
    v_max_u32_dpp v4, v4, v4 quad_perm:[2,3,0,1] row_mask:0xf bank_mask:0xf
    s_nop 1
    v_max_u32_dpp v4, v4, v4 row_half_mirror row_mask:0xf bank_mask:0xf
    s_nop 1
    v_max_u32_dpp v4, v4, v4 row_mirror row_mask:0xf bank_mask:0xf
    v_mov_b32 v5, v4
    s_nop 1
    v_permlane16_swap_b32 v4, v5
    v_max_u32 v4, v4, v5
    v_mov_b32 v5, v4
    s_nop 1
    v_permlane32_swap_b32 v4, v5
    v_max_u32 v4, v4, v5
    v_mov_b32 v58, v4
    v_cmp_eq_u32 vcc, v4, v16
    s_nop 1
    v_cndmask_b32 v16, v16, 0, vcc
    v_cmp_eq_u32 vcc, v4, v17
    s_nop 1
    v_cndmask_b32 v17, v17, 0, vcc
    v_cmp_eq_u32 vcc, v4, v18
    s_nop 1
    v_cndmask_b32 v18, v18, 0, vcc
    v_cmp_eq_u32 vcc, v4, v19
    s_nop 1
    v_cndmask_b32 v19, v19, 0, vcc
    v_cmp_eq_u32 vcc, v4, v20
    s_nop 1
    v_cndmask_b32 v20, v20, 0, vcc
    v_cmp_eq_u32 vcc, v4, v21
    s_nop 1
    v_cndmask_b32 v21, v21, 0, vcc
    v_cmp_eq_u32 vcc, v4, v22
    s_nop 1
    v_cndmask_b32 v22, v22, 0, vcc
    v_cmp_eq_u32 vcc, v4, v23
    s_nop 1
    v_cndmask_b32 v23, v23, 0, vcc
    v_cmp_eq_u32 vcc, v4, v24
    s_nop 1
    v_cndmask_b32 v24, v24, 0, vcc
    v_cmp_eq_u32 vcc, v4, v25
    s_nop 1
    v_cndmask_b32 v25, v25, 0, vcc
    v_cmp_eq_u32 vcc, v4, v26
    s_nop 1
    v_cndmask_b32 v26, v26, 0, vcc
    v_cmp_eq_u32 vcc, v4, v27
    s_nop 1
    v_cndmask_b32 v27, v27, 0, vcc
    v_cmp_eq_u32 vcc, v4, v28
    s_nop 1
    v_cndmask_b32 v28, v28, 0, vcc
    v_cmp_eq_u32 vcc, v4, v29
    s_nop 1
    v_cndmask_b32 v29, v29, 0, vcc
    v_cmp_eq_u32 vcc, v4, v30
    s_nop 1
    v_cndmask_b32 v30, v30, 0, vcc
    v_cmp_eq_u32 vcc, v4, v31
    s_nop 1
    v_cndmask_b32 v31, v31, 0, vcc
    v_cmp_eq_u32 vcc, v4, v32
    s_nop 1
    v_cndmask_b32 v32, v32, 0, vcc
    v_cmp_eq_u32 vcc, v4, v33
    s_nop 1
    v_cndmask_b32 v33, v33, 0, vcc
    v_cmp_eq_u32 vcc, v4, v34
    s_nop 1
    v_cndmask_b32 v34, v34, 0, vcc
    v_cmp_eq_u32 vcc, v4, v35
    s_nop 1
    v_cndmask_b32 v35, v35, 0, vcc
    v_cmp_eq_u32 vcc, v4, v36
    s_nop 1
    v_cndmask_b32 v36, v36, 0, vcc
    v_cmp_eq_u32 vcc, v4, v37
    s_nop 1
    v_cndmask_b32 v37, v37, 0, vcc
    v_cmp_eq_u32 vcc, v4, v38
    s_nop 1
    v_cndmask_b32 v38, v38, 0, vcc
    v_cmp_eq_u32 vcc, v4, v39
    s_nop 1
    v_cndmask_b32 v39, v39, 0, vcc
    v_cmp_eq_u32 vcc, v4, v40
    s_nop 1
    v_cndmask_b32 v40, v40, 0, vcc
    v_cmp_eq_u32 vcc, v4, v41
    s_nop 1
    v_cndmask_b32 v41, v41, 0, vcc
    v_cmp_eq_u32 vcc, v4, v42
    s_nop 1
    v_cndmask_b32 v42, v42, 0, vcc
    v_cmp_eq_u32 vcc, v4, v43
    s_nop 1
    v_cndmask_b32 v43, v43, 0, vcc
    v_cmp_eq_u32 vcc, v4, v44
    s_nop 1
    v_cndmask_b32 v44, v44, 0, vcc
    v_cmp_eq_u32 vcc, v4, v45
    s_nop 1
    v_cndmask_b32 v45, v45, 0, vcc
    v_cmp_eq_u32 vcc, v4, v46
    s_nop 1
    v_cndmask_b32 v46, v46, 0, vcc
    v_cmp_eq_u32 vcc, v4, v47
    s_nop 1
    v_cndmask_b32 v47, v47, 0, vcc
    v_max3_u32 v4, v16, v17, v18
    v_max3_u32 v4, v4, v19, v20
    v_max3_u32 v4, v4, v21, v22
    v_max3_u32 v4, v4, v23, v24
    v_max3_u32 v4, v4, v25, v26
    v_max3_u32 v4, v4, v27, v28
    v_max3_u32 v4, v4, v29, v30
    v_max3_u32 v4, v4, v31, v32
    v_max3_u32 v4, v4, v33, v34
    v_max3_u32 v4, v4, v35, v36
    v_max3_u32 v4, v4, v37, v38
    v_max3_u32 v4, v4, v39, v40
    v_max3_u32 v4, v4, v41, v42
    v_max3_u32 v4, v4, v43, v44
    v_max3_u32 v4, v4, v45, v46
    v_max_u32 v4, v4, v47
    s_nop 1
    v_max_u32_dpp v4, v4, v4 quad_perm:[1,0,3,2] row_mask:0xf bank_mask:0xf
    s_nop 1
    v_max_u32_dpp v4, v4, v4 quad_perm:[2,3,0,1] row_mask:0xf bank_mask:0xf
    s_nop 1
    v_max_u32_dpp v4, v4, v4 row_half_mirror row_mask:0xf bank_mask:0xf
    s_nop 1
    v_max_u32_dpp v4, v4, v4 row_mirror row_mask:0xf bank_mask:0xf
    v_mov_b32 v5, v4
    s_nop 1
    v_permlane16_swap_b32 v4, v5
    v_max_u32 v4, v4, v5
    v_mov_b32 v5, v4
    s_nop 1
    v_permlane32_swap_b32 v4, v5
    v_max_u32 v4, v4, v5
    v_mov_b32 v59, v4
    v_cmp_eq_u32 vcc, v4, v16
    s_nop 1
    v_cndmask_b32 v16, v16, 0, vcc
    v_cmp_eq_u32 vcc, v4, v17
    s_nop 1
    v_cndmask_b32 v17, v17, 0, vcc
    v_cmp_eq_u32 vcc, v4, v18
    s_nop 1
    v_cndmask_b32 v18, v18, 0, vcc
    v_cmp_eq_u32 vcc, v4, v19
    s_nop 1
    v_cndmask_b32 v19, v19, 0, vcc
    v_cmp_eq_u32 vcc, v4, v20
    s_nop 1
    v_cndmask_b32 v20, v20, 0, vcc
    v_cmp_eq_u32 vcc, v4, v21
    s_nop 1
    v_cndmask_b32 v21, v21, 0, vcc
    v_cmp_eq_u32 vcc, v4, v22
    s_nop 1
    v_cndmask_b32 v22, v22, 0, vcc
    v_cmp_eq_u32 vcc, v4, v23
    s_nop 1
    v_cndmask_b32 v23, v23, 0, vcc
    v_cmp_eq_u32 vcc, v4, v24
    s_nop 1
    v_cndmask_b32 v24, v24, 0, vcc
    v_cmp_eq_u32 vcc, v4, v25
    s_nop 1
    v_cndmask_b32 v25, v25, 0, vcc
    v_cmp_eq_u32 vcc, v4, v26
    s_nop 1
    v_cndmask_b32 v26, v26, 0, vcc
    v_cmp_eq_u32 vcc, v4, v27
    s_nop 1
    v_cndmask_b32 v27, v27, 0, vcc
    v_cmp_eq_u32 vcc, v4, v28
    s_nop 1
    v_cndmask_b32 v28, v28, 0, vcc
    v_cmp_eq_u32 vcc, v4, v29
    s_nop 1
    v_cndmask_b32 v29, v29, 0, vcc
    v_cmp_eq_u32 vcc, v4, v30
    s_nop 1
    v_cndmask_b32 v30, v30, 0, vcc
    v_cmp_eq_u32 vcc, v4, v31
    s_nop 1
    v_cndmask_b32 v31, v31, 0, vcc
    v_cmp_eq_u32 vcc, v4, v32
    s_nop 1
    v_cndmask_b32 v32, v32, 0, vcc
    v_cmp_eq_u32 vcc, v4, v33
    s_nop 1
    v_cndmask_b32 v33, v33, 0, vcc
    v_cmp_eq_u32 vcc, v4, v34
    s_nop 1
    v_cndmask_b32 v34, v34, 0, vcc
    v_cmp_eq_u32 vcc, v4, v35
    s_nop 1
    v_cndmask_b32 v35, v35, 0, vcc
    v_cmp_eq_u32 vcc, v4, v36
    s_nop 1
    v_cndmask_b32 v36, v36, 0, vcc
    v_cmp_eq_u32 vcc, v4, v37
    s_nop 1
    v_cndmask_b32 v37, v37, 0, vcc
    v_cmp_eq_u32 vcc, v4, v38
    s_nop 1
    v_cndmask_b32 v38, v38, 0, vcc
    v_cmp_eq_u32 vcc, v4, v39
    s_nop 1
    v_cndmask_b32 v39, v39, 0, vcc
    v_cmp_eq_u32 vcc, v4, v40
    s_nop 1
    v_cndmask_b32 v40, v40, 0, vcc
    v_cmp_eq_u32 vcc, v4, v41
    s_nop 1
    v_cndmask_b32 v41, v41, 0, vcc
    v_cmp_eq_u32 vcc, v4, v42
    s_nop 1
    v_cndmask_b32 v42, v42, 0, vcc
    v_cmp_eq_u32 vcc, v4, v43
    s_nop 1
    v_cndmask_b32 v43, v43, 0, vcc
    v_cmp_eq_u32 vcc, v4, v44
    s_nop 1
    v_cndmask_b32 v44, v44, 0, vcc
    v_cmp_eq_u32 vcc, v4, v45
    s_nop 1
    v_cndmask_b32 v45, v45, 0, vcc
    v_cmp_eq_u32 vcc, v4, v46
    s_nop 1
    v_cndmask_b32 v46, v46, 0, vcc
    v_cmp_eq_u32 vcc, v4, v47
    s_nop 1
    v_cndmask_b32 v47, v47, 0, vcc
    v_max3_u32 v4, v16, v17, v18
    v_max3_u32 v4, v4, v19, v20
    v_max3_u32 v4, v4, v21, v22
    v_max3_u32 v4, v4, v23, v24
    v_max3_u32 v4, v4, v25, v26
    v_max3_u32 v4, v4, v27, v28
    v_max3_u32 v4, v4, v29, v30
    v_max3_u32 v4, v4, v31, v32
    v_max3_u32 v4, v4, v33, v34
    v_max3_u32 v4, v4, v35, v36
    v_max3_u32 v4, v4, v37, v38
    v_max3_u32 v4, v4, v39, v40
    v_max3_u32 v4, v4, v41, v42
    v_max3_u32 v4, v4, v43, v44
    v_max3_u32 v4, v4, v45, v46
    v_max_u32 v4, v4, v47
    s_nop 1
    v_max_u32_dpp v4, v4, v4 quad_perm:[1,0,3,2] row_mask:0xf bank_mask:0xf
    s_nop 1
    v_max_u32_dpp v4, v4, v4 quad_perm:[2,3,0,1] row_mask:0xf bank_mask:0xf
    s_nop 1
    v_max_u32_dpp v4, v4, v4 row_half_mirror row_mask:0xf bank_mask:0xf
    s_nop 1
    v_max_u32_dpp v4, v4, v4 row_mirror row_mask:0xf bank_mask:0xf
    v_mov_b32 v5, v4
    s_nop 1
    v_permlane16_swap_b32 v4, v5
    v_max_u32 v4, v4, v5
    v_mov_b32 v5, v4
    s_nop 1
    v_permlane32_swap_b32 v4, v5
    v_max_u32 v4, v4, v5
    v_mov_b32 v60, v4
    v_cmp_eq_u32 vcc, v4, v16
    s_nop 1
    v_cndmask_b32 v16, v16, 0, vcc
    v_cmp_eq_u32 vcc, v4, v17
    s_nop 1
    v_cndmask_b32 v17, v17, 0, vcc
    v_cmp_eq_u32 vcc, v4, v18
    s_nop 1
    v_cndmask_b32 v18, v18, 0, vcc
    v_cmp_eq_u32 vcc, v4, v19
    s_nop 1
    v_cndmask_b32 v19, v19, 0, vcc
    v_cmp_eq_u32 vcc, v4, v20
    s_nop 1
    v_cndmask_b32 v20, v20, 0, vcc
    v_cmp_eq_u32 vcc, v4, v21
    s_nop 1
    v_cndmask_b32 v21, v21, 0, vcc
    v_cmp_eq_u32 vcc, v4, v22
    s_nop 1
    v_cndmask_b32 v22, v22, 0, vcc
    v_cmp_eq_u32 vcc, v4, v23
    s_nop 1
    v_cndmask_b32 v23, v23, 0, vcc
    v_cmp_eq_u32 vcc, v4, v24
    s_nop 1
    v_cndmask_b32 v24, v24, 0, vcc
    v_cmp_eq_u32 vcc, v4, v25
    s_nop 1
    v_cndmask_b32 v25, v25, 0, vcc
    v_cmp_eq_u32 vcc, v4, v26
    s_nop 1
    v_cndmask_b32 v26, v26, 0, vcc
    v_cmp_eq_u32 vcc, v4, v27
    s_nop 1
    v_cndmask_b32 v27, v27, 0, vcc
    v_cmp_eq_u32 vcc, v4, v28
    s_nop 1
    v_cndmask_b32 v28, v28, 0, vcc
    v_cmp_eq_u32 vcc, v4, v29
    s_nop 1
    v_cndmask_b32 v29, v29, 0, vcc
    v_cmp_eq_u32 vcc, v4, v30
    s_nop 1
    v_cndmask_b32 v30, v30, 0, vcc
    v_cmp_eq_u32 vcc, v4, v31
    s_nop 1
    v_cndmask_b32 v31, v31, 0, vcc
    v_cmp_eq_u32 vcc, v4, v32
    s_nop 1
    v_cndmask_b32 v32, v32, 0, vcc
    v_cmp_eq_u32 vcc, v4, v33
    s_nop 1
    v_cndmask_b32 v33, v33, 0, vcc
    v_cmp_eq_u32 vcc, v4, v34
    s_nop 1
    v_cndmask_b32 v34, v34, 0, vcc
    v_cmp_eq_u32 vcc, v4, v35
    s_nop 1
    v_cndmask_b32 v35, v35, 0, vcc
    v_cmp_eq_u32 vcc, v4, v36
    s_nop 1
    v_cndmask_b32 v36, v36, 0, vcc
    v_cmp_eq_u32 vcc, v4, v37
    s_nop 1
    v_cndmask_b32 v37, v37, 0, vcc
    v_cmp_eq_u32 vcc, v4, v38
    s_nop 1
    v_cndmask_b32 v38, v38, 0, vcc
    v_cmp_eq_u32 vcc, v4, v39
    s_nop 1
    v_cndmask_b32 v39, v39, 0, vcc
    v_cmp_eq_u32 vcc, v4, v40
    s_nop 1
    v_cndmask_b32 v40, v40, 0, vcc
    v_cmp_eq_u32 vcc, v4, v41
    s_nop 1
    v_cndmask_b32 v41, v41, 0, vcc
    v_cmp_eq_u32 vcc, v4, v42
    s_nop 1
    v_cndmask_b32 v42, v42, 0, vcc
    v_cmp_eq_u32 vcc, v4, v43
    s_nop 1
    v_cndmask_b32 v43, v43, 0, vcc
    v_cmp_eq_u32 vcc, v4, v44
    s_nop 1
    v_cndmask_b32 v44, v44, 0, vcc
    v_cmp_eq_u32 vcc, v4, v45
    s_nop 1
    v_cndmask_b32 v45, v45, 0, vcc
    v_cmp_eq_u32 vcc, v4, v46
    s_nop 1
    v_cndmask_b32 v46, v46, 0, vcc
    v_cmp_eq_u32 vcc, v4, v47
    s_nop 1
    v_cndmask_b32 v47, v47, 0, vcc
    v_max3_u32 v4, v16, v17, v18
    v_max3_u32 v4, v4, v19, v20
    v_max3_u32 v4, v4, v21, v22
    v_max3_u32 v4, v4, v23, v24
    v_max3_u32 v4, v4, v25, v26
    v_max3_u32 v4, v4, v27, v28
    v_max3_u32 v4, v4, v29, v30
    v_max3_u32 v4, v4, v31, v32
    v_max3_u32 v4, v4, v33, v34
    v_max3_u32 v4, v4, v35, v36
    v_max3_u32 v4, v4, v37, v38
    v_max3_u32 v4, v4, v39, v40
    v_max3_u32 v4, v4, v41, v42
    v_max3_u32 v4, v4, v43, v44
    v_max3_u32 v4, v4, v45, v46
    v_max_u32 v4, v4, v47
    s_nop 1
    v_max_u32_dpp v4, v4, v4 quad_perm:[1,0,3,2] row_mask:0xf bank_mask:0xf
    s_nop 1
    v_max_u32_dpp v4, v4, v4 quad_perm:[2,3,0,1] row_mask:0xf bank_mask:0xf
    s_nop 1
    v_max_u32_dpp v4, v4, v4 row_half_mirror row_mask:0xf bank_mask:0xf
    s_nop 1
    v_max_u32_dpp v4, v4, v4 row_mirror row_mask:0xf bank_mask:0xf
    v_mov_b32 v5, v4
    s_nop 1
    v_permlane16_swap_b32 v4, v5
    v_max_u32 v4, v4, v5
    v_mov_b32 v5, v4
    s_nop 1
    v_permlane32_swap_b32 v4, v5
    v_max_u32 v4, v4, v5
    v_mov_b32 v61, v4
    v_cmp_eq_u32 vcc, v4, v16
    s_nop 1
    v_cndmask_b32 v16, v16, 0, vcc
    v_cmp_eq_u32 vcc, v4, v17
    s_nop 1
    v_cndmask_b32 v17, v17, 0, vcc
    v_cmp_eq_u32 vcc, v4, v18
    s_nop 1
    v_cndmask_b32 v18, v18, 0, vcc
    v_cmp_eq_u32 vcc, v4, v19
    s_nop 1
    v_cndmask_b32 v19, v19, 0, vcc
    v_cmp_eq_u32 vcc, v4, v20
    s_nop 1
    v_cndmask_b32 v20, v20, 0, vcc
    v_cmp_eq_u32 vcc, v4, v21
    s_nop 1
    v_cndmask_b32 v21, v21, 0, vcc
    v_cmp_eq_u32 vcc, v4, v22
    s_nop 1
    v_cndmask_b32 v22, v22, 0, vcc
    v_cmp_eq_u32 vcc, v4, v23
    s_nop 1
    v_cndmask_b32 v23, v23, 0, vcc
    v_cmp_eq_u32 vcc, v4, v24
    s_nop 1
    v_cndmask_b32 v24, v24, 0, vcc
    v_cmp_eq_u32 vcc, v4, v25
    s_nop 1
    v_cndmask_b32 v25, v25, 0, vcc
    v_cmp_eq_u32 vcc, v4, v26
    s_nop 1
    v_cndmask_b32 v26, v26, 0, vcc
    v_cmp_eq_u32 vcc, v4, v27
    s_nop 1
    v_cndmask_b32 v27, v27, 0, vcc
    v_cmp_eq_u32 vcc, v4, v28
    s_nop 1
    v_cndmask_b32 v28, v28, 0, vcc
    v_cmp_eq_u32 vcc, v4, v29
    s_nop 1
    v_cndmask_b32 v29, v29, 0, vcc
    v_cmp_eq_u32 vcc, v4, v30
    s_nop 1
    v_cndmask_b32 v30, v30, 0, vcc
    v_cmp_eq_u32 vcc, v4, v31
    s_nop 1
    v_cndmask_b32 v31, v31, 0, vcc
    v_cmp_eq_u32 vcc, v4, v32
    s_nop 1
    v_cndmask_b32 v32, v32, 0, vcc
    v_cmp_eq_u32 vcc, v4, v33
    s_nop 1
    v_cndmask_b32 v33, v33, 0, vcc
    v_cmp_eq_u32 vcc, v4, v34
    s_nop 1
    v_cndmask_b32 v34, v34, 0, vcc
    v_cmp_eq_u32 vcc, v4, v35
    s_nop 1
    v_cndmask_b32 v35, v35, 0, vcc
    v_cmp_eq_u32 vcc, v4, v36
    s_nop 1
    v_cndmask_b32 v36, v36, 0, vcc
    v_cmp_eq_u32 vcc, v4, v37
    s_nop 1
    v_cndmask_b32 v37, v37, 0, vcc
    v_cmp_eq_u32 vcc, v4, v38
    s_nop 1
    v_cndmask_b32 v38, v38, 0, vcc
    v_cmp_eq_u32 vcc, v4, v39
    s_nop 1
    v_cndmask_b32 v39, v39, 0, vcc
    v_cmp_eq_u32 vcc, v4, v40
    s_nop 1
    v_cndmask_b32 v40, v40, 0, vcc
    v_cmp_eq_u32 vcc, v4, v41
    s_nop 1
    v_cndmask_b32 v41, v41, 0, vcc
    v_cmp_eq_u32 vcc, v4, v42
    s_nop 1
    v_cndmask_b32 v42, v42, 0, vcc
    v_cmp_eq_u32 vcc, v4, v43
    s_nop 1
    v_cndmask_b32 v43, v43, 0, vcc
    v_cmp_eq_u32 vcc, v4, v44
    s_nop 1
    v_cndmask_b32 v44, v44, 0, vcc
    v_cmp_eq_u32 vcc, v4, v45
    s_nop 1
    v_cndmask_b32 v45, v45, 0, vcc
    v_cmp_eq_u32 vcc, v4, v46
    s_nop 1
    v_cndmask_b32 v46, v46, 0, vcc
    v_cmp_eq_u32 vcc, v4, v47
    s_nop 1
    v_cndmask_b32 v47, v47, 0, vcc
    v_max3_u32 v4, v16, v17, v18
    v_max3_u32 v4, v4, v19, v20
    v_max3_u32 v4, v4, v21, v22
    v_max3_u32 v4, v4, v23, v24
    v_max3_u32 v4, v4, v25, v26
    v_max3_u32 v4, v4, v27, v28
    v_max3_u32 v4, v4, v29, v30
    v_max3_u32 v4, v4, v31, v32
    v_max3_u32 v4, v4, v33, v34
    v_max3_u32 v4, v4, v35, v36
    v_max3_u32 v4, v4, v37, v38
    v_max3_u32 v4, v4, v39, v40
    v_max3_u32 v4, v4, v41, v42
    v_max3_u32 v4, v4, v43, v44
    v_max3_u32 v4, v4, v45, v46
    v_max_u32 v4, v4, v47
    s_nop 1
    v_max_u32_dpp v4, v4, v4 quad_perm:[1,0,3,2] row_mask:0xf bank_mask:0xf
    s_nop 1
    v_max_u32_dpp v4, v4, v4 quad_perm:[2,3,0,1] row_mask:0xf bank_mask:0xf
    s_nop 1
    v_max_u32_dpp v4, v4, v4 row_half_mirror row_mask:0xf bank_mask:0xf
    s_nop 1
    v_max_u32_dpp v4, v4, v4 row_mirror row_mask:0xf bank_mask:0xf
    v_mov_b32 v5, v4
    s_nop 1
    v_permlane16_swap_b32 v4, v5
    v_max_u32 v4, v4, v5
    v_mov_b32 v5, v4
    s_nop 1
    v_permlane32_swap_b32 v4, v5
    v_max_u32 v4, v4, v5
    v_mov_b32 v62, v4
    v_cmp_eq_u32 vcc, v4, v16
    s_nop 1
    v_cndmask_b32 v16, v16, 0, vcc
    v_cmp_eq_u32 vcc, v4, v17
    s_nop 1
    v_cndmask_b32 v17, v17, 0, vcc
    v_cmp_eq_u32 vcc, v4, v18
    s_nop 1
    v_cndmask_b32 v18, v18, 0, vcc
    v_cmp_eq_u32 vcc, v4, v19
    s_nop 1
    v_cndmask_b32 v19, v19, 0, vcc
    v_cmp_eq_u32 vcc, v4, v20
    s_nop 1
    v_cndmask_b32 v20, v20, 0, vcc
    v_cmp_eq_u32 vcc, v4, v21
    s_nop 1
    v_cndmask_b32 v21, v21, 0, vcc
    v_cmp_eq_u32 vcc, v4, v22
    s_nop 1
    v_cndmask_b32 v22, v22, 0, vcc
    v_cmp_eq_u32 vcc, v4, v23
    s_nop 1
    v_cndmask_b32 v23, v23, 0, vcc
    v_cmp_eq_u32 vcc, v4, v24
    s_nop 1
    v_cndmask_b32 v24, v24, 0, vcc
    v_cmp_eq_u32 vcc, v4, v25
    s_nop 1
    v_cndmask_b32 v25, v25, 0, vcc
    v_cmp_eq_u32 vcc, v4, v26
    s_nop 1
    v_cndmask_b32 v26, v26, 0, vcc
    v_cmp_eq_u32 vcc, v4, v27
    s_nop 1
    v_cndmask_b32 v27, v27, 0, vcc
    v_cmp_eq_u32 vcc, v4, v28
    s_nop 1
    v_cndmask_b32 v28, v28, 0, vcc
    v_cmp_eq_u32 vcc, v4, v29
    s_nop 1
    v_cndmask_b32 v29, v29, 0, vcc
    v_cmp_eq_u32 vcc, v4, v30
    s_nop 1
    v_cndmask_b32 v30, v30, 0, vcc
    v_cmp_eq_u32 vcc, v4, v31
    s_nop 1
    v_cndmask_b32 v31, v31, 0, vcc
    v_cmp_eq_u32 vcc, v4, v32
    s_nop 1
    v_cndmask_b32 v32, v32, 0, vcc
    v_cmp_eq_u32 vcc, v4, v33
    s_nop 1
    v_cndmask_b32 v33, v33, 0, vcc
    v_cmp_eq_u32 vcc, v4, v34
    s_nop 1
    v_cndmask_b32 v34, v34, 0, vcc
    v_cmp_eq_u32 vcc, v4, v35
    s_nop 1
    v_cndmask_b32 v35, v35, 0, vcc
    v_cmp_eq_u32 vcc, v4, v36
    s_nop 1
    v_cndmask_b32 v36, v36, 0, vcc
    v_cmp_eq_u32 vcc, v4, v37
    s_nop 1
    v_cndmask_b32 v37, v37, 0, vcc
    v_cmp_eq_u32 vcc, v4, v38
    s_nop 1
    v_cndmask_b32 v38, v38, 0, vcc
    v_cmp_eq_u32 vcc, v4, v39
    s_nop 1
    v_cndmask_b32 v39, v39, 0, vcc
    v_cmp_eq_u32 vcc, v4, v40
    s_nop 1
    v_cndmask_b32 v40, v40, 0, vcc
    v_cmp_eq_u32 vcc, v4, v41
    s_nop 1
    v_cndmask_b32 v41, v41, 0, vcc
    v_cmp_eq_u32 vcc, v4, v42
    s_nop 1
    v_cndmask_b32 v42, v42, 0, vcc
    v_cmp_eq_u32 vcc, v4, v43
    s_nop 1
    v_cndmask_b32 v43, v43, 0, vcc
    v_cmp_eq_u32 vcc, v4, v44
    s_nop 1
    v_cndmask_b32 v44, v44, 0, vcc
    v_cmp_eq_u32 vcc, v4, v45
    s_nop 1
    v_cndmask_b32 v45, v45, 0, vcc
    v_cmp_eq_u32 vcc, v4, v46
    s_nop 1
    v_cndmask_b32 v46, v46, 0, vcc
    v_cmp_eq_u32 vcc, v4, v47
    s_nop 1
    v_cndmask_b32 v47, v47, 0, vcc
    v_max3_u32 v4, v16, v17, v18
    v_max3_u32 v4, v4, v19, v20
    v_max3_u32 v4, v4, v21, v22
    v_max3_u32 v4, v4, v23, v24
    v_max3_u32 v4, v4, v25, v26
    v_max3_u32 v4, v4, v27, v28
    v_max3_u32 v4, v4, v29, v30
    v_max3_u32 v4, v4, v31, v32
    v_max3_u32 v4, v4, v33, v34
    v_max3_u32 v4, v4, v35, v36
    v_max3_u32 v4, v4, v37, v38
    v_max3_u32 v4, v4, v39, v40
    v_max3_u32 v4, v4, v41, v42
    v_max3_u32 v4, v4, v43, v44
    v_max3_u32 v4, v4, v45, v46
    v_max_u32 v4, v4, v47
    s_nop 1
    v_max_u32_dpp v4, v4, v4 quad_perm:[1,0,3,2] row_mask:0xf bank_mask:0xf
    s_nop 1
    v_max_u32_dpp v4, v4, v4 quad_perm:[2,3,0,1] row_mask:0xf bank_mask:0xf
    s_nop 1
    v_max_u32_dpp v4, v4, v4 row_half_mirror row_mask:0xf bank_mask:0xf
    s_nop 1
    v_max_u32_dpp v4, v4, v4 row_mirror row_mask:0xf bank_mask:0xf
    v_mov_b32 v5, v4
    s_nop 1
    v_permlane16_swap_b32 v4, v5
    v_max_u32 v4, v4, v5
    v_mov_b32 v5, v4
    s_nop 1
    v_permlane32_swap_b32 v4, v5
    v_max_u32 v4, v4, v5
    v_mov_b32 v63, v4
    v_mov_b32 v4, v56
    v_cmp_eq_u32 vcc, 1, v0
    s_nop 1
    v_cndmask_b32 v4, v4, v57, vcc
    v_cmp_eq_u32 vcc, 2, v0
    s_nop 1
    v_cndmask_b32 v4, v4, v58, vcc
    v_cmp_eq_u32 vcc, 3, v0
    s_nop 1
    v_cndmask_b32 v4, v4, v59, vcc
    v_cmp_eq_u32 vcc, 4, v0
    s_nop 1
    v_cndmask_b32 v4, v4, v60, vcc
    v_cmp_eq_u32 vcc, 5, v0
    s_nop 1
    v_cndmask_b32 v4, v4, v61, vcc
    v_cmp_eq_u32 vcc, 6, v0
    s_nop 1
    v_cndmask_b32 v4, v4, v62, vcc
    v_cmp_eq_u32 vcc, 7, v0
    s_nop 1
    v_cndmask_b32 v4, v4, v63, vcc
    v_and_b32 v5, 0xffff, v4
    v_sub_u32 v5, 0xffff, v5
    v_and_b32 v4, 0xffff0000, v4
    v_ashrrev_i32 v3, 31, v4
    v_not_b32 v3, v3
    v_or_b32 v3, 0x80000000, v3
    v_xor_b32 v4, v4, v3
    v_and_b32 v4, 0xffff0000, v4
    v_mul_f32 v4, 0xbfb8aa3b, v4
    v_exp_f32 v4, v4
    s_nop 0
    v_add_f32 v4, 1.0, v4
    v_rcp_f32 v4, v4
    s_nop 0
    v_cvt_pk_bf16_f32 v4, v4, v4
    v_lshlrev_b32 v4, 16, v4
    v_lshlrev_b32 v6, 2, v0
    s_mov_b32 s64, 0x5400000
    s_mov_b64 exec, 0xff
    buffer_store_dword v5, v6, s[4:7], s64 offen sc1
    buffer_store_dword v4, v6, s[4:7], s64 offen offset:32 sc1
    s_mov_b64 exec, -1
    s_waitcnt vmcnt(0)
    v_mov_b32 v7, 1
    v_mov_b32 v8, 0
    s_mov_b32 s64, 0x298000
    s_mov_b64 exec, 1
    buffer_atomic_add v7, v8, s[4:7], s64 offen sc1
    s_mov_b64 exec, -1
    v_mbcnt_lo_u32_b32 v0, -1, 0
    v_mbcnt_hi_u32_b32 v0, -1, v0
NOSEL_109:
    v_lshlrev_b32 v1, 4, v0
    v_lshrrev_b32 v6, 3, v0
    v_mul_u32_u24 v2, 1280, v6
    v_and_b32 v7, 7, v0
    v_xor_b32 v7, v7, v6
    v_lshl_add_u32 v2, v7, 4, v2
    v_bfe_u32 v6, v0, 3, 1
    v_lshlrev_b32 v9, 10, v6
    v_and_b32 v6, 7, v0
    v_lshl_add_u32 v9, v6, 7, v9
    v_lshrrev_b32 v7, 4, v0
    v_xor_b32 v7, v7, v6
    v_lshl_add_u32 v3, v7, 4, v9
    v_xor_b32 v7, 4, v7
    v_lshl_add_u32 v4, v7, 4, v9
    v_add_u32 v6, 0x10000, v3
    v_add_u32 v9, 0x10000, v4
    s_barrier
    s_mul_i32 s20, s12, 163840
    s_mul_i32 s64, s14, 40960
    s_add_u32 s20, s20, s64
    s_add_u32 s20, s20, 0x0
    s_lshl_b32 s21, s14, 12
    s_add_u32 m0, s21, 0
    s_add_u32 s64, s20, 0x0
    buffer_load_dwordx4 v2, s[4:7], s64 offen lds
    s_add_u32 m0, s21, 1024
    s_add_u32 s64, s20, 0x2800
    buffer_load_dwordx4 v2, s[4:7], s64 offen lds
    s_add_u32 m0, s21, 2048
    s_add_u32 s64, s20, 0x5000
    buffer_load_dwordx4 v2, s[4:7], s64 offen lds
    s_add_u32 m0, s21, 3072
    s_add_u32 s64, s20, 0x7800
    buffer_load_dwordx4 v2, s[4:7], s64 offen lds
    s_add_u32 m0, s21, 16384
    s_add_u32 s64, s20, 0x80
    buffer_load_dwordx4 v2, s[4:7], s64 offen lds
    s_add_u32 m0, s21, 17408
    s_add_u32 s64, s20, 0x2880
    buffer_load_dwordx4 v2, s[4:7], s64 offen lds
    s_add_u32 m0, s21, 18432
    s_add_u32 s64, s20, 0x5080
    buffer_load_dwordx4 v2, s[4:7], s64 offen lds
    s_add_u32 m0, s21, 19456
    s_add_u32 s64, s20, 0x7880
    buffer_load_dwordx4 v2, s[4:7], s64 offen lds
    s_add_u32 m0, s21, 32768
    s_add_u32 s64, s20, 0x100
    buffer_load_dwordx4 v2, s[4:7], s64 offen lds
    s_add_u32 m0, s21, 33792
    s_add_u32 s64, s20, 0x2900
    buffer_load_dwordx4 v2, s[4:7], s64 offen lds
    s_add_u32 m0, s21, 34816
    s_add_u32 s64, s20, 0x5100
    buffer_load_dwordx4 v2, s[4:7], s64 offen lds
    s_add_u32 m0, s21, 35840
    s_add_u32 s64, s20, 0x7900
    buffer_load_dwordx4 v2, s[4:7], s64 offen lds
    s_add_u32 m0, s21, 49152
    s_add_u32 s64, s20, 0x180
    buffer_load_dwordx4 v2, s[4:7], s64 offen lds
    s_add_u32 m0, s21, 50176
    s_add_u32 s64, s20, 0x2980
    buffer_load_dwordx4 v2, s[4:7], s64 offen lds
    s_add_u32 m0, s21, 51200
    s_add_u32 s64, s20, 0x5180
    buffer_load_dwordx4 v2, s[4:7], s64 offen lds
    s_add_u32 m0, s21, 52224
    s_add_u32 s64, s20, 0x7980
    buffer_load_dwordx4 v2, s[4:7], s64 offen lds
    s_mov_b32 s64, 0x40000000
    buffer_store_dword v7, v1, s[4:7], s64 offen
    buffer_store_dword v7, v1, s[4:7], s64 offen
    buffer_store_dword v7, v1, s[4:7], s64 offen
    buffer_store_dword v7, v1, s[4:7], s64 offen
    buffer_store_dword v7, v1, s[4:7], s64 offen
    buffer_store_dword v7, v1, s[4:7], s64 offen
    buffer_store_dword v7, v1, s[4:7], s64 offen
    buffer_store_dword v7, v1, s[4:7], s64 offen
    s_waitcnt vmcnt(20)
    s_barrier
    ds_read_b128 a[0:3], v3 offset:0
    ds_read_b128 a[4:7], v3 offset:2048
    ds_read_b128 a[8:11], v3 offset:4096
    ds_read_b128 a[12:15], v3 offset:6144
    ds_read_b128 a[16:19], v3 offset:8192
    ds_read_b128 a[20:23], v3 offset:10240
    ds_read_b128 a[24:27], v3 offset:12288
    ds_read_b128 a[28:31], v3 offset:14336
    s_mov_b32 s19, 0
    s_mov_b32 s22, s16
    s_mov_b32 s23, 0x40000000
G_T_LOOP:
    s_waitcnt lgkmcnt(4)
    v_mfma_f32_16x16x32_bf16 v[16:19], v[96:99], a[0:3], 0
    v_mfma_f32_16x16x32_bf16 v[20:23], v[100:103], a[0:3], 0
    ds_read_b128 a[32:35], v4 offset:0
    v_mfma_f32_16x16x32_bf16 v[24:27], v[96:99], a[4:7], 0
    v_mfma_f32_16x16x32_bf16 v[28:31], v[100:103], a[4:7], 0
    ds_read_b128 a[36:39], v4 offset:2048
    v_mfma_f32_16x16x32_bf16 v[32:35], v[96:99], a[8:11], 0
    v_mfma_f32_16x16x32_bf16 v[36:39], v[100:103], a[8:11], 0
    ds_read_b128 a[40:43], v4 offset:4096
    v_mfma_f32_16x16x32_bf16 v[40:43], v[96:99], a[12:15], 0
    v_mfma_f32_16x16x32_bf16 v[44:47], v[100:103], a[12:15], 0
    ds_read_b128 a[44:47], v4 offset:6144
    s_waitcnt lgkmcnt(4)
    v_mfma_f32_16x16x32_bf16 v[48:51], v[96:99], a[16:19], 0
    v_mfma_f32_16x16x32_bf16 v[52:55], v[100:103], a[16:19], 0
    ds_read_b128 a[48:51], v4 offset:8192
    v_mfma_f32_16x16x32_bf16 v[56:59], v[96:99], a[20:23], 0
    v_mfma_f32_16x16x32_bf16 v[60:63], v[100:103], a[20:23], 0
    ds_read_b128 a[52:55], v4 offset:10240
    v_mfma_f32_16x16x32_bf16 v[64:67], v[96:99], a[24:27], 0
    v_mfma_f32_16x16x32_bf16 v[68:71], v[100:103], a[24:27], 0
    ds_read_b128 a[56:59], v4 offset:12288
    v_mfma_f32_16x16x32_bf16 v[72:75], v[96:99], a[28:31], 0
    v_mfma_f32_16x16x32_bf16 v[76:79], v[100:103], a[28:31], 0
    ds_read_b128 a[60:63], v4 offset:14336
    s_waitcnt vmcnt(16)
    s_barrier
    s_waitcnt lgkmcnt(4)
    v_mfma_f32_16x16x32_bf16 v[16:19], v[104:107], a[32:35], v[16:19]
    v_mfma_f32_16x16x32_bf16 v[20:23], v[108:111], a[32:35], v[20:23]
    ds_read_b128 a[0:3], v3 offset:16384
    s_add_u32 m0, s21, 65536
    v_mfma_f32_16x16x32_bf16 v[24:27], v[104:107], a[36:39], v[24:27]
    v_mfma_f32_16x16x32_bf16 v[28:31], v[108:111], a[36:39], v[28:31]
    ds_read_b128 a[4:7], v3 offset:18432
    s_add_u32 s64, s20, 0x200
    buffer_load_dwordx4 v2, s[4:7], s64 offen lds
    v_mfma_f32_16x16x32_bf16 v[32:35], v[104:107], a[40:43], v[32:35]
    v_mfma_f32_16x16x32_bf16 v[36:39], v[108:111], a[40:43], v[36:39]
    ds_read_b128 a[8:11], v3 offset:20480
    s_add_u32 m0, s21, 66560
    v_mfma_f32_16x16x32_bf16 v[40:43], v[104:107], a[44:47], v[40:43]
    v_mfma_f32_16x16x32_bf16 v[44:47], v[108:111], a[44:47], v[44:47]
    ds_read_b128 a[12:15], v3 offset:22528
    s_add_u32 s64, s20, 0x2a00
    buffer_load_dwordx4 v2, s[4:7], s64 offen lds
    s_waitcnt lgkmcnt(4)
    v_mfma_f32_16x16x32_bf16 v[48:51], v[104:107], a[48:51], v[48:51]
    v_mfma_f32_16x16x32_bf16 v[52:55], v[108:111], a[48:51], v[52:55]
    ds_read_b128 a[16:19], v3 offset:24576
    s_add_u32 m0, s21, 67584
    v_mfma_f32_16x16x32_bf16 v[56:59], v[104:107], a[52:55], v[56:59]
    v_mfma_f32_16x16x32_bf16 v[60:63], v[108:111], a[52:55], v[60:63]
    ds_read_b128 a[20:23], v3 offset:26624
    s_add_u32 s64, s20, 0x5200
    buffer_load_dwordx4 v2, s[4:7], s64 offen lds
    v_mfma_f32_16x16x32_bf16 v[64:67], v[104:107], a[56:59], v[64:67]
    v_mfma_f32_16x16x32_bf16 v[68:71], v[108:111], a[56:59], v[68:71]
    ds_read_b128 a[24:27], v3 offset:28672
    s_add_u32 m0, s21, 68608
    v_mfma_f32_16x16x32_bf16 v[72:75], v[104:107], a[60:63], v[72:75]
    v_mfma_f32_16x16x32_bf16 v[76:79], v[108:111], a[60:63], v[76:79]
    ds_read_b128 a[28:31], v3 offset:30720
    s_add_u32 s64, s20, 0x7a00
    buffer_load_dwordx4 v2, s[4:7], s64 offen lds
    s_waitcnt lgkmcnt(4)
    v_mfma_f32_16x16x32_bf16 v[16:19], v[112:115], a[0:3], v[16:19]
    v_mfma_f32_16x16x32_bf16 v[20:23], v[116:119], a[0:3], v[20:23]
    ds_read_b128 a[32:35], v4 offset:16384
    v_mfma_f32_16x16x32_bf16 v[24:27], v[112:115], a[4:7], v[24:27]
    v_mfma_f32_16x16x32_bf16 v[28:31], v[116:119], a[4:7], v[28:31]
    ds_read_b128 a[36:39], v4 offset:18432
    v_mfma_f32_16x16x32_bf16 v[32:35], v[112:115], a[8:11], v[32:35]
    v_mfma_f32_16x16x32_bf16 v[36:39], v[116:119], a[8:11], v[36:39]
    ds_read_b128 a[40:43], v4 offset:20480
    v_mfma_f32_16x16x32_bf16 v[40:43], v[112:115], a[12:15], v[40:43]
    v_mfma_f32_16x16x32_bf16 v[44:47], v[116:119], a[12:15], v[44:47]
    ds_read_b128 a[44:47], v4 offset:22528
    s_waitcnt lgkmcnt(4)
    v_mfma_f32_16x16x32_bf16 v[48:51], v[112:115], a[16:19], v[48:51]
    v_mfma_f32_16x16x32_bf16 v[52:55], v[116:119], a[16:19], v[52:55]
    ds_read_b128 a[48:51], v4 offset:24576
    v_mfma_f32_16x16x32_bf16 v[56:59], v[112:115], a[20:23], v[56:59]
    v_mfma_f32_16x16x32_bf16 v[60:63], v[116:119], a[20:23], v[60:63]
    ds_read_b128 a[52:55], v4 offset:26624
    v_mfma_f32_16x16x32_bf16 v[64:67], v[112:115], a[24:27], v[64:67]
    v_mfma_f32_16x16x32_bf16 v[68:71], v[116:119], a[24:27], v[68:71]
    ds_read_b128 a[56:59], v4 offset:28672
    v_mfma_f32_16x16x32_bf16 v[72:75], v[112:115], a[28:31], v[72:75]
    v_mfma_f32_16x16x32_bf16 v[76:79], v[116:119], a[28:31], v[76:79]
    ds_read_b128 a[60:63], v4 offset:30720
    s_waitcnt vmcnt(16)
    s_barrier
    s_waitcnt lgkmcnt(4)
    v_mfma_f32_16x16x32_bf16 v[16:19], v[120:123], a[32:35], v[16:19]
    v_mfma_f32_16x16x32_bf16 v[20:23], v[124:127], a[32:35], v[20:23]
    ds_read_b128 a[0:3], v3 offset:32768
    s_add_u32 m0, s21, 0
    v_mfma_f32_16x16x32_bf16 v[24:27], v[120:123], a[36:39], v[24:27]
    v_mfma_f32_16x16x32_bf16 v[28:31], v[124:127], a[36:39], v[28:31]
    ds_read_b128 a[4:7], v3 offset:34816
    s_add_u32 s64, s20, 0x280
    buffer_load_dwordx4 v2, s[4:7], s64 offen lds
    v_mfma_f32_16x16x32_bf16 v[32:35], v[120:123], a[40:43], v[32:35]
    v_mfma_f32_16x16x32_bf16 v[36:39], v[124:127], a[40:43], v[36:39]
    ds_read_b128 a[8:11], v3 offset:36864
    s_add_u32 m0, s21, 1024
    v_mfma_f32_16x16x32_bf16 v[40:43], v[120:123], a[44:47], v[40:43]
    v_mfma_f32_16x16x32_bf16 v[44:47], v[124:127], a[44:47], v[44:47]
    ds_read_b128 a[12:15], v3 offset:38912
    s_add_u32 s64, s20, 0x2a80
    buffer_load_dwordx4 v2, s[4:7], s64 offen lds
    s_waitcnt lgkmcnt(4)
    v_mfma_f32_16x16x32_bf16 v[48:51], v[120:123], a[48:51], v[48:51]
    v_mfma_f32_16x16x32_bf16 v[52:55], v[124:127], a[48:51], v[52:55]
    ds_read_b128 a[16:19], v3 offset:40960
    s_add_u32 m0, s21, 2048
    v_mfma_f32_16x16x32_bf16 v[56:59], v[120:123], a[52:55], v[56:59]
    v_mfma_f32_16x16x32_bf16 v[60:63], v[124:127], a[52:55], v[60:63]
    ds_read_b128 a[20:23], v3 offset:43008
    s_add_u32 s64, s20, 0x5280
    buffer_load_dwordx4 v2, s[4:7], s64 offen lds
    v_mfma_f32_16x16x32_bf16 v[64:67], v[120:123], a[56:59], v[64:67]
    v_mfma_f32_16x16x32_bf16 v[68:71], v[124:127], a[56:59], v[68:71]
    ds_read_b128 a[24:27], v3 offset:45056
    s_add_u32 m0, s21, 3072
    v_mfma_f32_16x16x32_bf16 v[72:75], v[120:123], a[60:63], v[72:75]
    v_mfma_f32_16x16x32_bf16 v[76:79], v[124:127], a[60:63], v[76:79]
    ds_read_b128 a[28:31], v3 offset:47104
    s_add_u32 s64, s20, 0x7a80
    buffer_load_dwordx4 v2, s[4:7], s64 offen lds
    s_waitcnt lgkmcnt(4)
    v_mfma_f32_16x16x32_bf16 v[16:19], v[128:131], a[0:3], v[16:19]
    v_mfma_f32_16x16x32_bf16 v[20:23], v[132:135], a[0:3], v[20:23]
    ds_read_b128 a[32:35], v4 offset:32768
    v_mfma_f32_16x16x32_bf16 v[24:27], v[128:131], a[4:7], v[24:27]
    v_mfma_f32_16x16x32_bf16 v[28:31], v[132:135], a[4:7], v[28:31]
    ds_read_b128 a[36:39], v4 offset:34816
    v_mfma_f32_16x16x32_bf16 v[32:35], v[128:131], a[8:11], v[32:35]
    v_mfma_f32_16x16x32_bf16 v[36:39], v[132:135], a[8:11], v[36:39]
    ds_read_b128 a[40:43], v4 offset:36864
    v_mfma_f32_16x16x32_bf16 v[40:43], v[128:131], a[12:15], v[40:43]
    v_mfma_f32_16x16x32_bf16 v[44:47], v[132:135], a[12:15], v[44:47]
    ds_read_b128 a[44:47], v4 offset:38912
    s_waitcnt lgkmcnt(4)
    v_mfma_f32_16x16x32_bf16 v[48:51], v[128:131], a[16:19], v[48:51]
    v_mfma_f32_16x16x32_bf16 v[52:55], v[132:135], a[16:19], v[52:55]
    ds_read_b128 a[48:51], v4 offset:40960
    v_mfma_f32_16x16x32_bf16 v[56:59], v[128:131], a[20:23], v[56:59]
    v_mfma_f32_16x16x32_bf16 v[60:63], v[132:135], a[20:23], v[60:63]
    ds_read_b128 a[52:55], v4 offset:43008
    v_mfma_f32_16x16x32_bf16 v[64:67], v[128:131], a[24:27], v[64:67]
    v_mfma_f32_16x16x32_bf16 v[68:71], v[132:135], a[24:27], v[68:71]
    ds_read_b128 a[56:59], v4 offset:45056
    v_mfma_f32_16x16x32_bf16 v[72:75], v[128:131], a[28:31], v[72:75]
    v_mfma_f32_16x16x32_bf16 v[76:79], v[132:135], a[28:31], v[76:79]
    ds_read_b128 a[60:63], v4 offset:47104
    s_waitcnt vmcnt(16)
    s_barrier
    s_waitcnt lgkmcnt(4)
    v_mfma_f32_16x16x32_bf16 v[16:19], v[136:139], a[32:35], v[16:19]
    v_mfma_f32_16x16x32_bf16 v[20:23], v[140:143], a[32:35], v[20:23]
    ds_read_b128 a[0:3], v3 offset:49152
    s_add_u32 m0, s21, 16384
    v_mfma_f32_16x16x32_bf16 v[24:27], v[136:139], a[36:39], v[24:27]
    v_mfma_f32_16x16x32_bf16 v[28:31], v[140:143], a[36:39], v[28:31]
    ds_read_b128 a[4:7], v3 offset:51200
    s_add_u32 s64, s20, 0x300
    buffer_load_dwordx4 v2, s[4:7], s64 offen lds
    v_mfma_f32_16x16x32_bf16 v[32:35], v[136:139], a[40:43], v[32:35]
    v_mfma_f32_16x16x32_bf16 v[36:39], v[140:143], a[40:43], v[36:39]
    ds_read_b128 a[8:11], v3 offset:53248
    s_add_u32 m0, s21, 17408
    v_mfma_f32_16x16x32_bf16 v[40:43], v[136:139], a[44:47], v[40:43]
    v_mfma_f32_16x16x32_bf16 v[44:47], v[140:143], a[44:47], v[44:47]
    ds_read_b128 a[12:15], v3 offset:55296
    s_add_u32 s64, s20, 0x2b00
    buffer_load_dwordx4 v2, s[4:7], s64 offen lds
    s_waitcnt lgkmcnt(4)
    v_mfma_f32_16x16x32_bf16 v[48:51], v[136:139], a[48:51], v[48:51]
    v_mfma_f32_16x16x32_bf16 v[52:55], v[140:143], a[48:51], v[52:55]
    ds_read_b128 a[16:19], v3 offset:57344
    s_add_u32 m0, s21, 18432
    v_mfma_f32_16x16x32_bf16 v[56:59], v[136:139], a[52:55], v[56:59]
    v_mfma_f32_16x16x32_bf16 v[60:63], v[140:143], a[52:55], v[60:63]
    ds_read_b128 a[20:23], v3 offset:59392
    s_add_u32 s64, s20, 0x5300
    buffer_load_dwordx4 v2, s[4:7], s64 offen lds
    v_mfma_f32_16x16x32_bf16 v[64:67], v[136:139], a[56:59], v[64:67]
    v_mfma_f32_16x16x32_bf16 v[68:71], v[140:143], a[56:59], v[68:71]
    ds_read_b128 a[24:27], v3 offset:61440
    s_add_u32 m0, s21, 19456
    v_mfma_f32_16x16x32_bf16 v[72:75], v[136:139], a[60:63], v[72:75]
    v_mfma_f32_16x16x32_bf16 v[76:79], v[140:143], a[60:63], v[76:79]
    ds_read_b128 a[28:31], v3 offset:63488
    s_add_u32 s64, s20, 0x7b00
    buffer_load_dwordx4 v2, s[4:7], s64 offen lds
    s_waitcnt lgkmcnt(4)
    v_mfma_f32_16x16x32_bf16 v[16:19], v[144:147], a[0:3], v[16:19]
    v_mfma_f32_16x16x32_bf16 v[20:23], v[148:151], a[0:3], v[20:23]
    ds_read_b128 a[32:35], v4 offset:49152
    v_mfma_f32_16x16x32_bf16 v[24:27], v[144:147], a[4:7], v[24:27]
    v_mfma_f32_16x16x32_bf16 v[28:31], v[148:151], a[4:7], v[28:31]
    ds_read_b128 a[36:39], v4 offset:51200
    v_mfma_f32_16x16x32_bf16 v[32:35], v[144:147], a[8:11], v[32:35]
    v_mfma_f32_16x16x32_bf16 v[36:39], v[148:151], a[8:11], v[36:39]
    ds_read_b128 a[40:43], v4 offset:53248
    v_mfma_f32_16x16x32_bf16 v[40:43], v[144:147], a[12:15], v[40:43]
    v_mfma_f32_16x16x32_bf16 v[44:47], v[148:151], a[12:15], v[44:47]
    ds_read_b128 a[44:47], v4 offset:55296
    s_waitcnt lgkmcnt(4)
    v_mfma_f32_16x16x32_bf16 v[48:51], v[144:147], a[16:19], v[48:51]
    v_mfma_f32_16x16x32_bf16 v[52:55], v[148:151], a[16:19], v[52:55]
    ds_read_b128 a[48:51], v4 offset:57344
    v_mfma_f32_16x16x32_bf16 v[56:59], v[144:147], a[20:23], v[56:59]
    v_mfma_f32_16x16x32_bf16 v[60:63], v[148:151], a[20:23], v[60:63]
    ds_read_b128 a[52:55], v4 offset:59392
    v_mfma_f32_16x16x32_bf16 v[64:67], v[144:147], a[24:27], v[64:67]
    v_mfma_f32_16x16x32_bf16 v[68:71], v[148:151], a[24:27], v[68:71]
    ds_read_b128 a[56:59], v4 offset:61440
    v_mfma_f32_16x16x32_bf16 v[72:75], v[144:147], a[28:31], v[72:75]
    v_mfma_f32_16x16x32_bf16 v[76:79], v[148:151], a[28:31], v[76:79]
    ds_read_b128 a[60:63], v4 offset:63488
    s_waitcnt vmcnt(8)
    s_barrier
    s_cmp_lg_u32 s14, 0
    s_cbranch_scc1 GF_110
    v_mov_b32 v7, 1
    v_mov_b32 v8, 0
    s_mov_b64 exec, 1
    buffer_store_dword v7, v8, s[4:7], s23 offen sc1
    s_mov_b64 exec, -1
GF_110:
    s_waitcnt lgkmcnt(4)
    v_mfma_f32_16x16x32_bf16 v[16:19], v[152:155], a[32:35], v[16:19]
    v_mfma_f32_16x16x32_bf16 v[20:23], v[156:159], a[32:35], v[20:23]
    ds_read_b128 a[0:3], v6 offset:0
    s_add_u32 m0, s21, 32768
    v_mfma_f32_16x16x32_bf16 v[24:27], v[152:155], a[36:39], v[24:27]
    v_mfma_f32_16x16x32_bf16 v[28:31], v[156:159], a[36:39], v[28:31]
    ds_read_b128 a[4:7], v6 offset:2048
    s_add_u32 s64, s20, 0x380
    buffer_load_dwordx4 v2, s[4:7], s64 offen lds
    v_mfma_f32_16x16x32_bf16 v[32:35], v[152:155], a[40:43], v[32:35]
    v_mfma_f32_16x16x32_bf16 v[36:39], v[156:159], a[40:43], v[36:39]
    ds_read_b128 a[8:11], v6 offset:4096
    s_add_u32 m0, s21, 33792
    v_mfma_f32_16x16x32_bf16 v[40:43], v[152:155], a[44:47], v[40:43]
    v_mfma_f32_16x16x32_bf16 v[44:47], v[156:159], a[44:47], v[44:47]
    ds_read_b128 a[12:15], v6 offset:6144
    s_add_u32 s64, s20, 0x2b80
    buffer_load_dwordx4 v2, s[4:7], s64 offen lds
    s_waitcnt lgkmcnt(4)
    v_mfma_f32_16x16x32_bf16 v[48:51], v[152:155], a[48:51], v[48:51]
    v_mfma_f32_16x16x32_bf16 v[52:55], v[156:159], a[48:51], v[52:55]
    ds_read_b128 a[16:19], v6 offset:8192
    s_add_u32 m0, s21, 34816
    v_mfma_f32_16x16x32_bf16 v[56:59], v[152:155], a[52:55], v[56:59]
    v_mfma_f32_16x16x32_bf16 v[60:63], v[156:159], a[52:55], v[60:63]
    ds_read_b128 a[20:23], v6 offset:10240
    s_add_u32 s64, s20, 0x5380
    buffer_load_dwordx4 v2, s[4:7], s64 offen lds
    v_mfma_f32_16x16x32_bf16 v[64:67], v[152:155], a[56:59], v[64:67]
    v_mfma_f32_16x16x32_bf16 v[68:71], v[156:159], a[56:59], v[68:71]
    ds_read_b128 a[24:27], v6 offset:12288
    s_add_u32 m0, s21, 35840
    v_mfma_f32_16x16x32_bf16 v[72:75], v[152:155], a[60:63], v[72:75]
    v_mfma_f32_16x16x32_bf16 v[76:79], v[156:159], a[60:63], v[76:79]
    ds_read_b128 a[28:31], v6 offset:14336
    s_add_u32 s64, s20, 0x7b80
    buffer_load_dwordx4 v2, s[4:7], s64 offen lds
    s_waitcnt lgkmcnt(4)
    v_mfma_f32_16x16x32_bf16 v[16:19], v[160:163], a[0:3], v[16:19]
    v_mfma_f32_16x16x32_bf16 v[20:23], v[164:167], a[0:3], v[20:23]
    ds_read_b128 a[32:35], v9 offset:0
    v_mfma_f32_16x16x32_bf16 v[24:27], v[160:163], a[4:7], v[24:27]
    v_mfma_f32_16x16x32_bf16 v[28:31], v[164:167], a[4:7], v[28:31]
    ds_read_b128 a[36:39], v9 offset:2048
    v_mfma_f32_16x16x32_bf16 v[32:35], v[160:163], a[8:11], v[32:35]
    v_mfma_f32_16x16x32_bf16 v[36:39], v[164:167], a[8:11], v[36:39]
    ds_read_b128 a[40:43], v9 offset:4096
    v_mfma_f32_16x16x32_bf16 v[40:43], v[160:163], a[12:15], v[40:43]
    v_mfma_f32_16x16x32_bf16 v[44:47], v[164:167], a[12:15], v[44:47]
    ds_read_b128 a[44:47], v9 offset:6144
    s_waitcnt lgkmcnt(4)
    v_mfma_f32_16x16x32_bf16 v[48:51], v[160:163], a[16:19], v[48:51]
    v_mfma_f32_16x16x32_bf16 v[52:55], v[164:167], a[16:19], v[52:55]
    ds_read_b128 a[48:51], v9 offset:8192
    v_mfma_f32_16x16x32_bf16 v[56:59], v[160:163], a[20:23], v[56:59]
    v_mfma_f32_16x16x32_bf16 v[60:63], v[164:167], a[20:23], v[60:63]
    ds_read_b128 a[52:55], v9 offset:10240
    v_mfma_f32_16x16x32_bf16 v[64:67], v[160:163], a[24:27], v[64:67]
    v_mfma_f32_16x16x32_bf16 v[68:71], v[164:167], a[24:27], v[68:71]
    ds_read_b128 a[56:59], v9 offset:12288
    v_mfma_f32_16x16x32_bf16 v[72:75], v[160:163], a[28:31], v[72:75]
    v_mfma_f32_16x16x32_bf16 v[76:79], v[164:167], a[28:31], v[76:79]
    ds_read_b128 a[60:63], v9 offset:14336
    s_waitcnt vmcnt(8)
    s_barrier
    s_waitcnt lgkmcnt(4)
    v_mfma_f32_16x16x32_bf16 v[16:19], v[168:171], a[32:35], v[16:19]
    v_mfma_f32_16x16x32_bf16 v[20:23], v[172:175], a[32:35], v[20:23]
    ds_read_b128 a[0:3], v3 offset:0
    s_add_u32 m0, s21, 49152
    v_mfma_f32_16x16x32_bf16 v[24:27], v[168:171], a[36:39], v[24:27]
    v_mfma_f32_16x16x32_bf16 v[28:31], v[172:175], a[36:39], v[28:31]
    ds_read_b128 a[4:7], v3 offset:2048
    s_add_u32 s64, s20, 0x400
    buffer_load_dwordx4 v2, s[4:7], s64 offen lds
    v_mfma_f32_16x16x32_bf16 v[32:35], v[168:171], a[40:43], v[32:35]
    v_mfma_f32_16x16x32_bf16 v[36:39], v[172:175], a[40:43], v[36:39]
    ds_read_b128 a[8:11], v3 offset:4096
    s_add_u32 m0, s21, 50176
    v_mfma_f32_16x16x32_bf16 v[40:43], v[168:171], a[44:47], v[40:43]
    v_mfma_f32_16x16x32_bf16 v[44:47], v[172:175], a[44:47], v[44:47]
    ds_read_b128 a[12:15], v3 offset:6144
    s_add_u32 s64, s20, 0x2c00
    buffer_load_dwordx4 v2, s[4:7], s64 offen lds
    s_waitcnt lgkmcnt(4)
    v_mfma_f32_16x16x32_bf16 v[48:51], v[168:171], a[48:51], v[48:51]
    v_mfma_f32_16x16x32_bf16 v[52:55], v[172:175], a[48:51], v[52:55]
    ds_read_b128 a[16:19], v3 offset:8192
    s_add_u32 m0, s21, 51200
    v_mfma_f32_16x16x32_bf16 v[56:59], v[168:171], a[52:55], v[56:59]
    v_mfma_f32_16x16x32_bf16 v[60:63], v[172:175], a[52:55], v[60:63]
    ds_read_b128 a[20:23], v3 offset:10240
    s_add_u32 s64, s20, 0x5400
    buffer_load_dwordx4 v2, s[4:7], s64 offen lds
    v_mfma_f32_16x16x32_bf16 v[64:67], v[168:171], a[56:59], v[64:67]
    v_mfma_f32_16x16x32_bf16 v[68:71], v[172:175], a[56:59], v[68:71]
    ds_read_b128 a[24:27], v3 offset:12288
    s_add_u32 m0, s21, 52224
    v_mfma_f32_16x16x32_bf16 v[72:75], v[168:171], a[60:63], v[72:75]
    v_mfma_f32_16x16x32_bf16 v[76:79], v[172:175], a[60:63], v[76:79]
    ds_read_b128 a[28:31], v3 offset:14336
    s_add_u32 s64, s20, 0x7c00
    buffer_load_dwordx4 v2, s[4:7], s64 offen lds
    s_waitcnt lgkmcnt(4)
    v_mfma_f32_16x16x32_bf16 v[16:19], v[176:179], a[0:3], v[16:19]
    v_mfma_f32_16x16x32_bf16 v[20:23], v[180:183], a[0:3], v[20:23]
    ds_read_b128 a[32:35], v4 offset:0
    v_mfma_f32_16x16x32_bf16 v[24:27], v[176:179], a[4:7], v[24:27]
    v_mfma_f32_16x16x32_bf16 v[28:31], v[180:183], a[4:7], v[28:31]
    ds_read_b128 a[36:39], v4 offset:2048
    v_mfma_f32_16x16x32_bf16 v[32:35], v[176:179], a[8:11], v[32:35]
    v_mfma_f32_16x16x32_bf16 v[36:39], v[180:183], a[8:11], v[36:39]
    ds_read_b128 a[40:43], v4 offset:4096
    v_mfma_f32_16x16x32_bf16 v[40:43], v[176:179], a[12:15], v[40:43]
    v_mfma_f32_16x16x32_bf16 v[44:47], v[180:183], a[12:15], v[44:47]
    ds_read_b128 a[44:47], v4 offset:6144
    s_waitcnt lgkmcnt(4)
    v_mfma_f32_16x16x32_bf16 v[48:51], v[176:179], a[16:19], v[48:51]
    v_mfma_f32_16x16x32_bf16 v[52:55], v[180:183], a[16:19], v[52:55]
    ds_read_b128 a[48:51], v4 offset:8192
    v_mfma_f32_16x16x32_bf16 v[56:59], v[176:179], a[20:23], v[56:59]
    v_mfma_f32_16x16x32_bf16 v[60:63], v[180:183], a[20:23], v[60:63]
    ds_read_b128 a[52:55], v4 offset:10240
    v_mfma_f32_16x16x32_bf16 v[64:67], v[176:179], a[24:27], v[64:67]
    v_mfma_f32_16x16x32_bf16 v[68:71], v[180:183], a[24:27], v[68:71]
    ds_read_b128 a[56:59], v4 offset:12288
    v_mfma_f32_16x16x32_bf16 v[72:75], v[176:179], a[28:31], v[72:75]
    v_mfma_f32_16x16x32_bf16 v[76:79], v[180:183], a[28:31], v[76:79]
    ds_read_b128 a[60:63], v4 offset:14336
    s_waitcnt vmcnt(8)
    s_barrier
    s_waitcnt lgkmcnt(4)
    v_mfma_f32_16x16x32_bf16 v[16:19], v[184:187], a[32:35], v[16:19]
    v_mfma_f32_16x16x32_bf16 v[20:23], v[188:191], a[32:35], v[20:23]
    ds_read_b128 a[0:3], v3 offset:16384
    s_add_u32 m0, s21, 65536
    v_mfma_f32_16x16x32_bf16 v[24:27], v[184:187], a[36:39], v[24:27]
    v_mfma_f32_16x16x32_bf16 v[28:31], v[188:191], a[36:39], v[28:31]
    ds_read_b128 a[4:7], v3 offset:18432
    s_add_u32 s64, s20, 0x480
    buffer_load_dwordx4 v2, s[4:7], s64 offen lds
    v_mfma_f32_16x16x32_bf16 v[32:35], v[184:187], a[40:43], v[32:35]
    v_mfma_f32_16x16x32_bf16 v[36:39], v[188:191], a[40:43], v[36:39]
    ds_read_b128 a[8:11], v3 offset:20480
    s_add_u32 m0, s21, 66560
    v_mfma_f32_16x16x32_bf16 v[40:43], v[184:187], a[44:47], v[40:43]
    v_mfma_f32_16x16x32_bf16 v[44:47], v[188:191], a[44:47], v[44:47]
    ds_read_b128 a[12:15], v3 offset:22528
    s_add_u32 s64, s20, 0x2c80
    buffer_load_dwordx4 v2, s[4:7], s64 offen lds
    s_waitcnt lgkmcnt(4)
    v_mfma_f32_16x16x32_bf16 v[48:51], v[184:187], a[48:51], v[48:51]
    v_mfma_f32_16x16x32_bf16 v[52:55], v[188:191], a[48:51], v[52:55]
    ds_read_b128 a[16:19], v3 offset:24576
    s_add_u32 m0, s21, 67584
    v_mfma_f32_16x16x32_bf16 v[56:59], v[184:187], a[52:55], v[56:59]
    v_mfma_f32_16x16x32_bf16 v[60:63], v[188:191], a[52:55], v[60:63]
    ds_read_b128 a[20:23], v3 offset:26624
    s_add_u32 s64, s20, 0x5480
    buffer_load_dwordx4 v2, s[4:7], s64 offen lds
    v_mfma_f32_16x16x32_bf16 v[64:67], v[184:187], a[56:59], v[64:67]
    v_mfma_f32_16x16x32_bf16 v[68:71], v[188:191], a[56:59], v[68:71]
    ds_read_b128 a[24:27], v3 offset:28672
    s_add_u32 m0, s21, 68608
    v_mfma_f32_16x16x32_bf16 v[72:75], v[184:187], a[60:63], v[72:75]
    v_mfma_f32_16x16x32_bf16 v[76:79], v[188:191], a[60:63], v[76:79]
    ds_read_b128 a[28:31], v3 offset:30720
    s_add_u32 s64, s20, 0x7c80
    buffer_load_dwordx4 v2, s[4:7], s64 offen lds
    s_waitcnt lgkmcnt(4)
    v_mfma_f32_16x16x32_bf16 v[16:19], v[192:195], a[0:3], v[16:19]
    v_mfma_f32_16x16x32_bf16 v[20:23], v[196:199], a[0:3], v[20:23]
    ds_read_b128 a[32:35], v4 offset:16384
    v_mfma_f32_16x16x32_bf16 v[24:27], v[192:195], a[4:7], v[24:27]
    v_mfma_f32_16x16x32_bf16 v[28:31], v[196:199], a[4:7], v[28:31]
    ds_read_b128 a[36:39], v4 offset:18432
    v_mfma_f32_16x16x32_bf16 v[32:35], v[192:195], a[8:11], v[32:35]
    v_mfma_f32_16x16x32_bf16 v[36:39], v[196:199], a[8:11], v[36:39]
    ds_read_b128 a[40:43], v4 offset:20480
    v_mfma_f32_16x16x32_bf16 v[40:43], v[192:195], a[12:15], v[40:43]
    v_mfma_f32_16x16x32_bf16 v[44:47], v[196:199], a[12:15], v[44:47]
    ds_read_b128 a[44:47], v4 offset:22528
    s_waitcnt lgkmcnt(4)
    v_mfma_f32_16x16x32_bf16 v[48:51], v[192:195], a[16:19], v[48:51]
    v_mfma_f32_16x16x32_bf16 v[52:55], v[196:199], a[16:19], v[52:55]
    ds_read_b128 a[48:51], v4 offset:24576
    v_mfma_f32_16x16x32_bf16 v[56:59], v[192:195], a[20:23], v[56:59]
    v_mfma_f32_16x16x32_bf16 v[60:63], v[196:199], a[20:23], v[60:63]
    ds_read_b128 a[52:55], v4 offset:26624
    v_mfma_f32_16x16x32_bf16 v[64:67], v[192:195], a[24:27], v[64:67]
    v_mfma_f32_16x16x32_bf16 v[68:71], v[196:199], a[24:27], v[68:71]
    ds_read_b128 a[56:59], v4 offset:28672
    v_mfma_f32_16x16x32_bf16 v[72:75], v[192:195], a[28:31], v[72:75]
    v_mfma_f32_16x16x32_bf16 v[76:79], v[196:199], a[28:31], v[76:79]
    ds_read_b128 a[60:63], v4 offset:30720
    s_waitcnt vmcnt(8)
    s_barrier
    s_waitcnt lgkmcnt(4)
    v_mfma_f32_16x16x32_bf16 v[16:19], v[200:203], a[32:35], v[16:19]
    v_mfma_f32_16x16x32_bf16 v[20:23], v[204:207], a[32:35], v[20:23]
    ds_read_b128 a[0:3], v3 offset:32768
    s_add_u32 m0, s21, 0
    v_mfma_f32_16x16x32_bf16 v[24:27], v[200:203], a[36:39], v[24:27]
    v_mfma_f32_16x16x32_bf16 v[28:31], v[204:207], a[36:39], v[28:31]
    ds_read_b128 a[4:7], v3 offset:34816
    s_add_u32 s64, s20, 0x50000
    buffer_load_dwordx4 v2, s[4:7], s64 offen lds
    v_mfma_f32_16x16x32_bf16 v[32:35], v[200:203], a[40:43], v[32:35]
    v_mfma_f32_16x16x32_bf16 v[36:39], v[204:207], a[40:43], v[36:39]
    ds_read_b128 a[8:11], v3 offset:36864
    s_add_u32 m0, s21, 1024
    v_mfma_f32_16x16x32_bf16 v[40:43], v[200:203], a[44:47], v[40:43]
    v_mfma_f32_16x16x32_bf16 v[44:47], v[204:207], a[44:47], v[44:47]
    ds_read_b128 a[12:15], v3 offset:38912
    s_add_u32 s64, s20, 0x52800
    buffer_load_dwordx4 v2, s[4:7], s64 offen lds
    s_waitcnt lgkmcnt(4)
    v_mfma_f32_16x16x32_bf16 v[48:51], v[200:203], a[48:51], v[48:51]
    v_mfma_f32_16x16x32_bf16 v[52:55], v[204:207], a[48:51], v[52:55]
    ds_read_b128 a[16:19], v3 offset:40960
    s_add_u32 m0, s21, 2048
    v_mfma_f32_16x16x32_bf16 v[56:59], v[200:203], a[52:55], v[56:59]
    v_mfma_f32_16x16x32_bf16 v[60:63], v[204:207], a[52:55], v[60:63]
    ds_read_b128 a[20:23], v3 offset:43008
    s_add_u32 s64, s20, 0x55000
    buffer_load_dwordx4 v2, s[4:7], s64 offen lds
    v_mfma_f32_16x16x32_bf16 v[64:67], v[200:203], a[56:59], v[64:67]
    v_mfma_f32_16x16x32_bf16 v[68:71], v[204:207], a[56:59], v[68:71]
    ds_read_b128 a[24:27], v3 offset:45056
    s_add_u32 m0, s21, 3072
    v_mfma_f32_16x16x32_bf16 v[72:75], v[200:203], a[60:63], v[72:75]
    v_mfma_f32_16x16x32_bf16 v[76:79], v[204:207], a[60:63], v[76:79]
    ds_read_b128 a[28:31], v3 offset:47104
    s_add_u32 s64, s20, 0x57800
    buffer_load_dwordx4 v2, s[4:7], s64 offen lds
    s_waitcnt lgkmcnt(4)
    v_mfma_f32_16x16x32_bf16 v[16:19], v[208:211], a[0:3], v[16:19]
    v_mfma_f32_16x16x32_bf16 v[20:23], v[212:215], a[0:3], v[20:23]
    ds_read_b128 a[32:35], v4 offset:32768
    v_mfma_f32_16x16x32_bf16 v[24:27], v[208:211], a[4:7], v[24:27]
    v_mfma_f32_16x16x32_bf16 v[28:31], v[212:215], a[4:7], v[28:31]
    ds_read_b128 a[36:39], v4 offset:34816
    v_mfma_f32_16x16x32_bf16 v[32:35], v[208:211], a[8:11], v[32:35]
    v_mfma_f32_16x16x32_bf16 v[36:39], v[212:215], a[8:11], v[36:39]
    ds_read_b128 a[40:43], v4 offset:36864
    v_mfma_f32_16x16x32_bf16 v[40:43], v[208:211], a[12:15], v[40:43]
    v_mfma_f32_16x16x32_bf16 v[44:47], v[212:215], a[12:15], v[44:47]
    ds_read_b128 a[44:47], v4 offset:38912
    s_waitcnt lgkmcnt(4)
    v_mfma_f32_16x16x32_bf16 v[48:51], v[208:211], a[16:19], v[48:51]
    v_mfma_f32_16x16x32_bf16 v[52:55], v[212:215], a[16:19], v[52:55]
    ds_read_b128 a[48:51], v4 offset:40960
    v_mfma_f32_16x16x32_bf16 v[56:59], v[208:211], a[20:23], v[56:59]
    v_mfma_f32_16x16x32_bf16 v[60:63], v[212:215], a[20:23], v[60:63]
    ds_read_b128 a[52:55], v4 offset:43008
    v_mfma_f32_16x16x32_bf16 v[64:67], v[208:211], a[24:27], v[64:67]
    v_mfma_f32_16x16x32_bf16 v[68:71], v[212:215], a[24:27], v[68:71]
    ds_read_b128 a[56:59], v4 offset:45056
    v_mfma_f32_16x16x32_bf16 v[72:75], v[208:211], a[28:31], v[72:75]
    v_mfma_f32_16x16x32_bf16 v[76:79], v[212:215], a[28:31], v[76:79]
    ds_read_b128 a[60:63], v4 offset:47104
    s_waitcnt vmcnt(8)
    s_barrier
    s_waitcnt lgkmcnt(4)
    v_mfma_f32_16x16x32_bf16 v[16:19], v[216:219], a[32:35], v[16:19]
    v_mfma_f32_16x16x32_bf16 v[20:23], v[220:223], a[32:35], v[20:23]
    ds_read_b128 a[0:3], v3 offset:49152
    s_add_u32 m0, s21, 16384
    v_mfma_f32_16x16x32_bf16 v[24:27], v[216:219], a[36:39], v[24:27]
    v_mfma_f32_16x16x32_bf16 v[28:31], v[220:223], a[36:39], v[28:31]
    ds_read_b128 a[4:7], v3 offset:51200
    s_add_u32 s64, s20, 0x50080
    buffer_load_dwordx4 v2, s[4:7], s64 offen lds
    v_mfma_f32_16x16x32_bf16 v[32:35], v[216:219], a[40:43], v[32:35]
    v_mfma_f32_16x16x32_bf16 v[36:39], v[220:223], a[40:43], v[36:39]
    ds_read_b128 a[8:11], v3 offset:53248
    s_add_u32 m0, s21, 17408
    v_mfma_f32_16x16x32_bf16 v[40:43], v[216:219], a[44:47], v[40:43]
    v_mfma_f32_16x16x32_bf16 v[44:47], v[220:223], a[44:47], v[44:47]
    ds_read_b128 a[12:15], v3 offset:55296
    s_add_u32 s64, s20, 0x52880
    buffer_load_dwordx4 v2, s[4:7], s64 offen lds
    s_waitcnt lgkmcnt(4)
    v_mfma_f32_16x16x32_bf16 v[48:51], v[216:219], a[48:51], v[48:51]
    v_mfma_f32_16x16x32_bf16 v[52:55], v[220:223], a[48:51], v[52:55]
    ds_read_b128 a[16:19], v3 offset:57344
    s_add_u32 m0, s21, 18432
    v_mfma_f32_16x16x32_bf16 v[56:59], v[216:219], a[52:55], v[56:59]
    v_mfma_f32_16x16x32_bf16 v[60:63], v[220:223], a[52:55], v[60:63]
    ds_read_b128 a[20:23], v3 offset:59392
    s_add_u32 s64, s20, 0x55080
    buffer_load_dwordx4 v2, s[4:7], s64 offen lds
    v_mfma_f32_16x16x32_bf16 v[64:67], v[216:219], a[56:59], v[64:67]
    v_mfma_f32_16x16x32_bf16 v[68:71], v[220:223], a[56:59], v[68:71]
    ds_read_b128 a[24:27], v3 offset:61440
    s_add_u32 m0, s21, 19456
    v_mfma_f32_16x16x32_bf16 v[72:75], v[216:219], a[60:63], v[72:75]
    v_mfma_f32_16x16x32_bf16 v[76:79], v[220:223], a[60:63], v[76:79]
    ds_read_b128 a[28:31], v3 offset:63488
    s_add_u32 s64, s20, 0x57880
    buffer_load_dwordx4 v2, s[4:7], s64 offen lds
    s_waitcnt lgkmcnt(4)
    v_mfma_f32_16x16x32_bf16 v[16:19], v[224:227], a[0:3], v[16:19]
    v_mfma_f32_16x16x32_bf16 v[20:23], v[228:231], a[0:3], v[20:23]
    ds_read_b128 a[32:35], v4 offset:49152
    v_mfma_f32_16x16x32_bf16 v[24:27], v[224:227], a[4:7], v[24:27]
    v_mfma_f32_16x16x32_bf16 v[28:31], v[228:231], a[4:7], v[28:31]
    ds_read_b128 a[36:39], v4 offset:51200
    v_mfma_f32_16x16x32_bf16 v[32:35], v[224:227], a[8:11], v[32:35]
    v_mfma_f32_16x16x32_bf16 v[36:39], v[228:231], a[8:11], v[36:39]
    ds_read_b128 a[40:43], v4 offset:53248
    v_mfma_f32_16x16x32_bf16 v[40:43], v[224:227], a[12:15], v[40:43]
    v_mfma_f32_16x16x32_bf16 v[44:47], v[228:231], a[12:15], v[44:47]
    ds_read_b128 a[44:47], v4 offset:55296
    s_waitcnt lgkmcnt(4)
    v_mfma_f32_16x16x32_bf16 v[48:51], v[224:227], a[16:19], v[48:51]
    v_mfma_f32_16x16x32_bf16 v[52:55], v[228:231], a[16:19], v[52:55]
    ds_read_b128 a[48:51], v4 offset:57344
    v_mfma_f32_16x16x32_bf16 v[56:59], v[224:227], a[20:23], v[56:59]
    v_mfma_f32_16x16x32_bf16 v[60:63], v[228:231], a[20:23], v[60:63]
    ds_read_b128 a[52:55], v4 offset:59392
    v_mfma_f32_16x16x32_bf16 v[64:67], v[224:227], a[24:27], v[64:67]
    v_mfma_f32_16x16x32_bf16 v[68:71], v[228:231], a[24:27], v[68:71]
    ds_read_b128 a[56:59], v4 offset:61440
    v_mfma_f32_16x16x32_bf16 v[72:75], v[224:227], a[28:31], v[72:75]
    v_mfma_f32_16x16x32_bf16 v[76:79], v[228:231], a[28:31], v[76:79]
    ds_read_b128 a[60:63], v4 offset:63488
    s_waitcnt vmcnt(8)
    s_barrier
    s_waitcnt lgkmcnt(4)
    v_mfma_f32_16x16x32_bf16 v[16:19], v[232:235], a[32:35], v[16:19]
    v_mfma_f32_16x16x32_bf16 v[20:23], v[236:239], a[32:35], v[20:23]
    ds_read_b128 a[0:3], v6 offset:0
    s_add_u32 m0, s21, 32768
    v_mfma_f32_16x16x32_bf16 v[24:27], v[232:235], a[36:39], v[24:27]
    v_mfma_f32_16x16x32_bf16 v[28:31], v[236:239], a[36:39], v[28:31]
    ds_read_b128 a[4:7], v6 offset:2048
    s_add_u32 s64, s20, 0x50100
    buffer_load_dwordx4 v2, s[4:7], s64 offen lds
    v_mfma_f32_16x16x32_bf16 v[32:35], v[232:235], a[40:43], v[32:35]
    v_mfma_f32_16x16x32_bf16 v[36:39], v[236:239], a[40:43], v[36:39]
    ds_read_b128 a[8:11], v6 offset:4096
    s_add_u32 m0, s21, 33792
    v_mfma_f32_16x16x32_bf16 v[40:43], v[232:235], a[44:47], v[40:43]
    v_mfma_f32_16x16x32_bf16 v[44:47], v[236:239], a[44:47], v[44:47]
    ds_read_b128 a[12:15], v6 offset:6144
    s_add_u32 s64, s20, 0x52900
    buffer_load_dwordx4 v2, s[4:7], s64 offen lds
    s_waitcnt lgkmcnt(4)
    v_mfma_f32_16x16x32_bf16 v[48:51], v[232:235], a[48:51], v[48:51]
    v_mfma_f32_16x16x32_bf16 v[52:55], v[236:239], a[48:51], v[52:55]
    ds_read_b128 a[16:19], v6 offset:8192
    s_add_u32 m0, s21, 34816
    v_mfma_f32_16x16x32_bf16 v[56:59], v[232:235], a[52:55], v[56:59]
    v_mfma_f32_16x16x32_bf16 v[60:63], v[236:239], a[52:55], v[60:63]
    ds_read_b128 a[20:23], v6 offset:10240
    s_add_u32 s64, s20, 0x55100
    buffer_load_dwordx4 v2, s[4:7], s64 offen lds
    v_mfma_f32_16x16x32_bf16 v[64:67], v[232:235], a[56:59], v[64:67]
    v_mfma_f32_16x16x32_bf16 v[68:71], v[236:239], a[56:59], v[68:71]
    ds_read_b128 a[24:27], v6 offset:12288
    s_add_u32 m0, s21, 35840
    v_mfma_f32_16x16x32_bf16 v[72:75], v[232:235], a[60:63], v[72:75]
    v_mfma_f32_16x16x32_bf16 v[76:79], v[236:239], a[60:63], v[76:79]
    ds_read_b128 a[28:31], v6 offset:14336
    s_add_u32 s64, s20, 0x57900
    buffer_load_dwordx4 v2, s[4:7], s64 offen lds
    s_waitcnt lgkmcnt(4)
    v_mfma_f32_16x16x32_bf16 v[16:19], v[240:243], a[0:3], v[16:19]
    v_mfma_f32_16x16x32_bf16 v[20:23], v[244:247], a[0:3], v[20:23]
    ds_read_b128 a[32:35], v9 offset:0
    v_mfma_f32_16x16x32_bf16 v[24:27], v[240:243], a[4:7], v[24:27]
    v_mfma_f32_16x16x32_bf16 v[28:31], v[244:247], a[4:7], v[28:31]
    ds_read_b128 a[36:39], v9 offset:2048
    v_mfma_f32_16x16x32_bf16 v[32:35], v[240:243], a[8:11], v[32:35]
    v_mfma_f32_16x16x32_bf16 v[36:39], v[244:247], a[8:11], v[36:39]
    ds_read_b128 a[40:43], v9 offset:4096
    v_mfma_f32_16x16x32_bf16 v[40:43], v[240:243], a[12:15], v[40:43]
    v_mfma_f32_16x16x32_bf16 v[44:47], v[244:247], a[12:15], v[44:47]
    ds_read_b128 a[44:47], v9 offset:6144
    s_waitcnt lgkmcnt(4)
    v_mfma_f32_16x16x32_bf16 v[48:51], v[240:243], a[16:19], v[48:51]
    v_mfma_f32_16x16x32_bf16 v[52:55], v[244:247], a[16:19], v[52:55]
    ds_read_b128 a[48:51], v9 offset:8192
    v_mfma_f32_16x16x32_bf16 v[56:59], v[240:243], a[20:23], v[56:59]
    v_mfma_f32_16x16x32_bf16 v[60:63], v[244:247], a[20:23], v[60:63]
    ds_read_b128 a[52:55], v9 offset:10240
    v_mfma_f32_16x16x32_bf16 v[64:67], v[240:243], a[24:27], v[64:67]
    v_mfma_f32_16x16x32_bf16 v[68:71], v[244:247], a[24:27], v[68:71]
    ds_read_b128 a[56:59], v9 offset:12288
    v_mfma_f32_16x16x32_bf16 v[72:75], v[240:243], a[28:31], v[72:75]
    v_mfma_f32_16x16x32_bf16 v[76:79], v[244:247], a[28:31], v[76:79]
    ds_read_b128 a[60:63], v9 offset:14336
    s_waitcnt vmcnt(8)
    s_barrier
    s_waitcnt lgkmcnt(4)
    v_mfma_f32_16x16x32_bf16 v[16:19], v[248:251], a[32:35], v[16:19]
    v_mfma_f32_16x16x32_bf16 v[20:23], v[252:255], a[32:35], v[20:23]
    ds_read_b128 a[0:3], v3 offset:0
    s_add_u32 m0, s21, 49152
    v_mfma_f32_16x16x32_bf16 v[24:27], v[248:251], a[36:39], v[24:27]
    v_mfma_f32_16x16x32_bf16 v[28:31], v[252:255], a[36:39], v[28:31]
    ds_read_b128 a[4:7], v3 offset:2048
    s_add_u32 s64, s20, 0x50180
    buffer_load_dwordx4 v2, s[4:7], s64 offen lds
    v_mfma_f32_16x16x32_bf16 v[32:35], v[248:251], a[40:43], v[32:35]
    v_mfma_f32_16x16x32_bf16 v[36:39], v[252:255], a[40:43], v[36:39]
    ds_read_b128 a[8:11], v3 offset:4096
    s_add_u32 m0, s21, 50176
    v_mfma_f32_16x16x32_bf16 v[40:43], v[248:251], a[44:47], v[40:43]
    v_mfma_f32_16x16x32_bf16 v[44:47], v[252:255], a[44:47], v[44:47]
    ds_read_b128 a[12:15], v3 offset:6144
    s_add_u32 s64, s20, 0x52980
    buffer_load_dwordx4 v2, s[4:7], s64 offen lds
    s_waitcnt lgkmcnt(4)
    v_mfma_f32_16x16x32_bf16 v[48:51], v[248:251], a[48:51], v[48:51]
    v_mfma_f32_16x16x32_bf16 v[52:55], v[252:255], a[48:51], v[52:55]
    ds_read_b128 a[16:19], v3 offset:8192
    s_add_u32 m0, s21, 51200
    v_mfma_f32_16x16x32_bf16 v[56:59], v[248:251], a[52:55], v[56:59]
    v_mfma_f32_16x16x32_bf16 v[60:63], v[252:255], a[52:55], v[60:63]
    ds_read_b128 a[20:23], v3 offset:10240
    s_add_u32 s64, s20, 0x55180
    buffer_load_dwordx4 v2, s[4:7], s64 offen lds
    v_mfma_f32_16x16x32_bf16 v[64:67], v[248:251], a[56:59], v[64:67]
    v_mfma_f32_16x16x32_bf16 v[68:71], v[252:255], a[56:59], v[68:71]
    ds_read_b128 a[24:27], v3 offset:12288
    s_add_u32 m0, s21, 52224
    v_mfma_f32_16x16x32_bf16 v[72:75], v[248:251], a[60:63], v[72:75]
    v_mfma_f32_16x16x32_bf16 v[76:79], v[252:255], a[60:63], v[76:79]
    ds_read_b128 a[28:31], v3 offset:14336
    s_add_u32 s64, s20, 0x57980
    buffer_load_dwordx4 v2, s[4:7], s64 offen lds
    s_nop 5
    s_mul_i32 s65, s17, 0
    s_add_u32 s65, s65, s22
    s_add_u32 s64, s65, 0
    v_cvt_pk_bf16_f32 v80, v16, v17
    v_cvt_pk_bf16_f32 v81, v18, v19
    v_cvt_pk_bf16_f32 v82, v20, v21
    v_cvt_pk_bf16_f32 v83, v22, v23
    buffer_store_dwordx4 v[80:83], v1, s[4:7], s64 offen sc1
    s_add_u32 s64, s65, 4096
    v_cvt_pk_bf16_f32 v84, v24, v25
    v_cvt_pk_bf16_f32 v85, v26, v27
    v_cvt_pk_bf16_f32 v86, v28, v29
    v_cvt_pk_bf16_f32 v87, v30, v31
    buffer_store_dwordx4 v[84:87], v1, s[4:7], s64 offen sc1
    s_mul_i32 s65, s17, 1
    s_add_u32 s65, s65, s22
    s_add_u32 s64, s65, 0
    v_cvt_pk_bf16_f32 v88, v32, v33
    v_cvt_pk_bf16_f32 v89, v34, v35
    v_cvt_pk_bf16_f32 v90, v36, v37
    v_cvt_pk_bf16_f32 v91, v38, v39
    buffer_store_dwordx4 v[88:91], v1, s[4:7], s64 offen sc1
    s_add_u32 s64, s65, 4096
    v_cvt_pk_bf16_f32 v92, v40, v41
    v_cvt_pk_bf16_f32 v93, v42, v43
    v_cvt_pk_bf16_f32 v94, v44, v45
    v_cvt_pk_bf16_f32 v95, v46, v47
    buffer_store_dwordx4 v[92:95], v1, s[4:7], s64 offen sc1
    s_mul_i32 s65, s17, 2
    s_add_u32 s65, s65, s22
    s_add_u32 s64, s65, 0
    v_cvt_pk_bf16_f32 v80, v48, v49
    v_cvt_pk_bf16_f32 v81, v50, v51
    v_cvt_pk_bf16_f32 v82, v52, v53
    v_cvt_pk_bf16_f32 v83, v54, v55
    buffer_store_dwordx4 v[80:83], v1, s[4:7], s64 offen sc1
    s_add_u32 s64, s65, 4096
    v_cvt_pk_bf16_f32 v84, v56, v57
    v_cvt_pk_bf16_f32 v85, v58, v59
    v_cvt_pk_bf16_f32 v86, v60, v61
    v_cvt_pk_bf16_f32 v87, v62, v63
    buffer_store_dwordx4 v[84:87], v1, s[4:7], s64 offen sc1
    s_mul_i32 s65, s17, 3
    s_add_u32 s65, s65, s22
    s_add_u32 s64, s65, 0
    v_cvt_pk_bf16_f32 v88, v64, v65
    v_cvt_pk_bf16_f32 v89, v66, v67
    v_cvt_pk_bf16_f32 v90, v68, v69
    v_cvt_pk_bf16_f32 v91, v70, v71
    buffer_store_dwordx4 v[88:91], v1, s[4:7], s64 offen sc1
    s_add_u32 s64, s65, 4096
    v_cvt_pk_bf16_f32 v92, v72, v73
    v_cvt_pk_bf16_f32 v93, v74, v75
    v_cvt_pk_bf16_f32 v94, v76, v77
    v_cvt_pk_bf16_f32 v95, v78, v79
    buffer_store_dwordx4 v[92:95], v1, s[4:7], s64 offen sc1
    s_lshl_b32 s64, s19, 1
    s_add_u32 s64, s64, s12
    s_lshl_b32 s64, s64, 9
    s_add_u32 s23, s18, s64
    s_lshl_b32 s64, s17, 3
    s_add_u32 s22, s22, s64
    s_add_u32 s19, s19, 1
    s_add_u32 s20, s20, 0x50000
    s_cmp_lt_u32 s19, 8
    s_cbranch_scc1 G_T_LOOP
    s_waitcnt vmcnt(0) lgkmcnt(0)
    s_barrier
    s_cmp_lg_u32 s14, 0
    s_cbranch_scc1 GF_111
    v_mov_b32 v7, 1
    v_mov_b32 v8, 0
    s_mov_b64 exec, 1
    buffer_store_dword v7, v8, s[4:7], s23 offen sc1
    s_mov_b64 exec, -1
GF_111:
    s_cmp_eq_u32 s3, 2
    s_cbranch_scc1 H_Q
    s_cmp_eq_u32 s12, 1
    s_cbranch_scc1 H_OUT
    s_lshl_b32 s88, s3, 5
    s_add_u32 s88, s88, s13
    s_mov_b32 s29, 0
    v_lshlrev_b32 v1, 4, v0
    s_mov_b32 s65, 0
CW_112:
    buffer_load_dwordx2 v[8:9], off, s[60:63], 0 offset:132 sc1
    s_add_u32 s65, s65, 1
    s_waitcnt vmcnt(0)
    v_readfirstlane_b32 s66, v8
    v_readfirstlane_b32 s67, v9
    s_min_u32 s64, s66, s67
    s_cmp_lg_u32 s64, 0
    s_cbranch_scc1 CWD_113
    s_cmp_gt_u32 s65, 65536
    s_cbranch_scc1 CWD_113
    s_sleep 4
    s_branch CW_112
CWD_113:
    s_sub_u32 s66, s66, 1
    s_and_b32 s66, s66, 3
    s_sub_u32 s67, s67, 1
    s_and_b32 s67, s67, 3
    s_mov_b32 s64, s66
    s_mov_b32 s65, s67
    s_and_b32 s64, s64, 3
    s_lshl_b32 s64, s64, 13
    s_and_b32 s65, s65, 3
    s_lshl_b32 s65, s65, 13
    s_add_u32 s25, s64, 0x6000000
    s_add_u32 s30, s65, 0x6200000
    v_bfe_u32 v4, v0, 3, 1
    v_mul_u32_u24 v2, 0x8000, v4
    v_lshrrev_b32 v4, 5, v0
    v_lshl_add_u32 v2, v4, 8, v2
    v_bfe_u32 v4, v0, 4, 1
    v_lshl_add_u32 v2, v4, 7, v2
    v_and_b32 v4, 7, v0
    v_lshl_add_u32 v2, v4, 4, v2
    v_bfe_u32 v4, v0, 3, 1
    v_lshlrev_b32 v3, 16, v4
    v_lshrrev_b32 v4, 4, v0
    v_lshl_add_u32 v3, v4, 7, v3
    v_and_b32 v4, 7, v0
    v_lshl_add_u32 v3, v4, 4, v3
    s_lshl_b32 s26, s13, 11
    s_lshl_b32 s64, s14, 9
    s_add_u32 s26, s26, s64
    s_add_u32 s26, s26, 0x640000
    s_lshl_b32 s27, s13, 3
    s_add_u32 s27, s27, 0x294000
    s_mov_b32 s28, 0x29a000
    s_mov_b32 s24, 0
    v_lshlrev_b32 v6, 7, v0
MKT_LOOP:
    s_cmp_lg_u32 s24, 10
    s_cbranch_scc1 MKH_114
    v_mov_b32 v10, v2
    v_mov_b32 v11, v3
    s_cmp_ge_u32 s88, 60
    s_cbranch_scc1 NOWO_115
    s_mov_b32 s89, s13
    s_mul_hi_u32 s65, s88, 0xccccccd
    s_mul_i32 s65, s65, 20
    s_sub_u32 s13, s88, s65
    s_load_dwordx2 s[44:45], s[0:1], 40
    s_mov_b32 s46, 0x500000
    s_mov_b32 s47, 0x00020000
    s_waitcnt lgkmcnt(0)
    s_mul_i32 s21, s14, 36864
    v_lshrrev_b32 v7, 2, v0
    v_mul_u32_u24 v4, 1280, v7
    v_bfe_u32 v7, v0, 4, 1
    v_lshlrev_b32 v7, 1, v7
    v_and_b32 v8, 3, v0
    v_xor_b32 v7, v7, v8
    v_lshl_add_u32 v4, v7, 4, v4
    v_lshrrev_b32 v7, 4, v0
    v_lshlrev_b32 v2, 8, v7
    v_bfe_u32 v7, v0, 2, 2
    v_lshl_add_u32 v2, v7, 6, v2
    v_and_b32 v7, 3, v0
    v_lshl_add_u32 v2, v7, 3, v2
    v_add_u32 v2, s21, v2
    v_bfe_u32 v7, v0, 4, 1
    v_lshlrev_b32 v7, 5, v7
    v_sub_u32 v3, 32, v7
    v_add_u32 v3, v3, v2
    v_add_u32 v2, v2, v7
    s_mul_i32 s65, s14, 1310720
    s_lshl_b32 s66, s13, 6
    s_add_u32 s65, s65, s66
    s_add_u32 m0, s21, 0
    s_add_u32 s64, s65, 0x0
    buffer_load_dwordx4 v4, s[44:47], s64 offen lds
    s_add_u32 m0, s21, 1024
    s_add_u32 s64, s65, 0x5000
    buffer_load_dwordx4 v4, s[44:47], s64 offen lds
    s_add_u32 m0, s21, 2048
    s_add_u32 s64, s65, 0xa000
    buffer_load_dwordx4 v4, s[44:47], s64 offen lds
    s_add_u32 m0, s21, 3072
    s_add_u32 s64, s65, 0xf000
    buffer_load_dwordx4 v4, s[44:47], s64 offen lds
    s_add_u32 m0, s21, 4096
    s_add_u32 s64, s65, 0x14000
    buffer_load_dwordx4 v4, s[44:47], s64 offen lds
    s_add_u32 m0, s21, 5120
    s_add_u32 s64, s65, 0x19000
    buffer_load_dwordx4 v4, s[44:47], s64 offen lds
    s_add_u32 m0, s21, 6144
    s_add_u32 s64, s65, 0x1e000
    buffer_load_dwordx4 v4, s[44:47], s64 offen lds
    s_add_u32 m0, s21, 7168
    s_add_u32 s64, s65, 0x23000
    buffer_load_dwordx4 v4, s[44:47], s64 offen lds
    s_add_u32 m0, s21, 8192
    s_add_u32 s64, s65, 0x28000
    buffer_load_dwordx4 v4, s[44:47], s64 offen lds
    s_add_u32 m0, s21, 9216
    s_add_u32 s64, s65, 0x2d000
    buffer_load_dwordx4 v4, s[44:47], s64 offen lds
    s_add_u32 m0, s21, 10240
    s_add_u32 s64, s65, 0x32000
    buffer_load_dwordx4 v4, s[44:47], s64 offen lds
    s_add_u32 m0, s21, 11264
    s_add_u32 s64, s65, 0x37000
    buffer_load_dwordx4 v4, s[44:47], s64 offen lds
    s_add_u32 m0, s21, 12288
    s_add_u32 s64, s65, 0x3c000
    buffer_load_dwordx4 v4, s[44:47], s64 offen lds
    s_add_u32 m0, s21, 13312
    s_add_u32 s64, s65, 0x41000
    buffer_load_dwordx4 v4, s[44:47], s64 offen lds
    s_add_u32 m0, s21, 14336
    s_add_u32 s64, s65, 0x46000
    buffer_load_dwordx4 v4, s[44:47], s64 offen lds
    s_add_u32 m0, s21, 15360
    s_add_u32 s64, s65, 0x4b000
    buffer_load_dwordx4 v4, s[44:47], s64 offen lds
    s_add_u32 m0, s21, 16384
    s_add_u32 s64, s65, 0x50000
    buffer_load_dwordx4 v4, s[44:47], s64 offen lds
    s_add_u32 m0, s21, 17408
    s_add_u32 s64, s65, 0x55000
    buffer_load_dwordx4 v4, s[44:47], s64 offen lds
    s_add_u32 m0, s21, 18432
    s_add_u32 s64, s65, 0x5a000
    buffer_load_dwordx4 v4, s[44:47], s64 offen lds
    s_add_u32 m0, s21, 19456
    s_add_u32 s64, s65, 0x5f000
    buffer_load_dwordx4 v4, s[44:47], s64 offen lds
    s_add_u32 m0, s21, 20480
    s_add_u32 s64, s65, 0x64000
    buffer_load_dwordx4 v4, s[44:47], s64 offen lds
    s_add_u32 m0, s21, 21504
    s_add_u32 s64, s65, 0x69000
    buffer_load_dwordx4 v4, s[44:47], s64 offen lds
    s_add_u32 m0, s21, 22528
    s_add_u32 s64, s65, 0x6e000
    buffer_load_dwordx4 v4, s[44:47], s64 offen lds
    s_add_u32 m0, s21, 23552
    s_add_u32 s64, s65, 0x73000
    buffer_load_dwordx4 v4, s[44:47], s64 offen lds
    s_add_u32 m0, s21, 24576
    s_add_u32 s64, s65, 0x78000
    buffer_load_dwordx4 v4, s[44:47], s64 offen lds
    s_add_u32 m0, s21, 25600
    s_add_u32 s64, s65, 0x7d000
    buffer_load_dwordx4 v4, s[44:47], s64 offen lds
    s_add_u32 m0, s21, 26624
    s_add_u32 s64, s65, 0x82000
    buffer_load_dwordx4 v4, s[44:47], s64 offen lds
    s_add_u32 m0, s21, 27648
    s_add_u32 s64, s65, 0x87000
    buffer_load_dwordx4 v4, s[44:47], s64 offen lds
    s_add_u32 m0, s21, 28672
    s_add_u32 s64, s65, 0x8c000
    buffer_load_dwordx4 v4, s[44:47], s64 offen lds
    s_add_u32 m0, s21, 29696
    s_add_u32 s64, s65, 0x91000
    buffer_load_dwordx4 v4, s[44:47], s64 offen lds
    s_add_u32 m0, s21, 30720
    s_add_u32 s64, s65, 0x96000
    buffer_load_dwordx4 v4, s[44:47], s64 offen lds
    s_add_u32 m0, s21, 31744
    s_add_u32 s64, s65, 0x9b000
    buffer_load_dwordx4 v4, s[44:47], s64 offen lds
    s_add_u32 m0, s21, 32768
    s_add_u32 s64, s65, 0xa0000
    buffer_load_dwordx4 v4, s[44:47], s64 offen lds
    s_add_u32 m0, s21, 33792
    s_add_u32 s64, s65, 0xa5000
    buffer_load_dwordx4 v4, s[44:47], s64 offen lds
    s_add_u32 m0, s21, 34816
    s_add_u32 s64, s65, 0xaa000
    buffer_load_dwordx4 v4, s[44:47], s64 offen lds
    s_add_u32 m0, s21, 35840
    s_add_u32 s64, s65, 0xaf000
    buffer_load_dwordx4 v4, s[44:47], s64 offen lds
    s_waitcnt vmcnt(32)
    ds_read_b64_tr_b16 a[0:1], v2 offset:0
    ds_read_b64_tr_b16 a[2:3], v2 offset:1024
    ds_read_b64_tr_b16 a[4:5], v3 offset:0
    ds_read_b64_tr_b16 a[6:7], v3 offset:1024
    ds_read_b64_tr_b16 a[8:9], v2 offset:2048
    ds_read_b64_tr_b16 a[10:11], v2 offset:3072
    ds_read_b64_tr_b16 a[12:13], v3 offset:2048
    ds_read_b64_tr_b16 a[14:15], v3 offset:3072
    s_waitcnt lgkmcnt(0)
    s_add_u32 m0, s21, 0
    s_add_u32 s64, s65, 0xb4000
    buffer_load_dwordx4 v4, s[44:47], s64 offen lds
    s_add_u32 m0, s21, 1024
    s_add_u32 s64, s65, 0xb9000
    buffer_load_dwordx4 v4, s[44:47], s64 offen lds
    s_add_u32 m0, s21, 2048
    s_add_u32 s64, s65, 0xbe000
    buffer_load_dwordx4 v4, s[44:47], s64 offen lds
    s_add_u32 m0, s21, 3072
    s_add_u32 s64, s65, 0xc3000
    buffer_load_dwordx4 v4, s[44:47], s64 offen lds
    s_waitcnt vmcnt(32)
    ds_read_b64_tr_b16 a[16:17], v2 offset:4096
    ds_read_b64_tr_b16 a[18:19], v2 offset:5120
    ds_read_b64_tr_b16 a[20:21], v3 offset:4096
    ds_read_b64_tr_b16 a[22:23], v3 offset:5120
    ds_read_b64_tr_b16 a[24:25], v2 offset:6144
    ds_read_b64_tr_b16 a[26:27], v2 offset:7168
    ds_read_b64_tr_b16 a[28:29], v3 offset:6144
    ds_read_b64_tr_b16 a[30:31], v3 offset:7168
    s_waitcnt lgkmcnt(0)
    s_add_u32 m0, s21, 4096
    s_add_u32 s64, s65, 0xc8000
    buffer_load_dwordx4 v4, s[44:47], s64 offen lds
    s_add_u32 m0, s21, 5120
    s_add_u32 s64, s65, 0xcd000
    buffer_load_dwordx4 v4, s[44:47], s64 offen lds
    s_add_u32 m0, s21, 6144
    s_add_u32 s64, s65, 0xd2000
    buffer_load_dwordx4 v4, s[44:47], s64 offen lds
    s_add_u32 m0, s21, 7168
    s_add_u32 s64, s65, 0xd7000
    buffer_load_dwordx4 v4, s[44:47], s64 offen lds
    s_waitcnt vmcnt(32)
    ds_read_b64_tr_b16 a[32:33], v2 offset:8192
    ds_read_b64_tr_b16 a[34:35], v2 offset:9216
    ds_read_b64_tr_b16 a[36:37], v3 offset:8192
    ds_read_b64_tr_b16 a[38:39], v3 offset:9216
    ds_read_b64_tr_b16 a[40:41], v2 offset:10240
    ds_read_b64_tr_b16 a[42:43], v2 offset:11264
    ds_read_b64_tr_b16 a[44:45], v3 offset:10240
    ds_read_b64_tr_b16 a[46:47], v3 offset:11264
    s_waitcnt lgkmcnt(0)
    s_add_u32 m0, s21, 8192
    s_add_u32 s64, s65, 0xdc000
    buffer_load_dwordx4 v4, s[44:47], s64 offen lds
    s_add_u32 m0, s21, 9216
    s_add_u32 s64, s65, 0xe1000
    buffer_load_dwordx4 v4, s[44:47], s64 offen lds
    s_add_u32 m0, s21, 10240
    s_add_u32 s64, s65, 0xe6000
    buffer_load_dwordx4 v4, s[44:47], s64 offen lds
    s_add_u32 m0, s21, 11264
    s_add_u32 s64, s65, 0xeb000
    buffer_load_dwordx4 v4, s[44:47], s64 offen lds
    s_waitcnt vmcnt(32)
    ds_read_b64_tr_b16 a[48:49], v2 offset:12288
    ds_read_b64_tr_b16 a[50:51], v2 offset:13312
    ds_read_b64_tr_b16 a[52:53], v3 offset:12288
    ds_read_b64_tr_b16 a[54:55], v3 offset:13312
    ds_read_b64_tr_b16 a[56:57], v2 offset:14336
    ds_read_b64_tr_b16 a[58:59], v2 offset:15360
    ds_read_b64_tr_b16 a[60:61], v3 offset:14336
    ds_read_b64_tr_b16 a[62:63], v3 offset:15360
    s_waitcnt lgkmcnt(0)
    s_add_u32 m0, s21, 12288
    s_add_u32 s64, s65, 0xf0000
    buffer_load_dwordx4 v4, s[44:47], s64 offen lds
    s_add_u32 m0, s21, 13312
    s_add_u32 s64, s65, 0xf5000
    buffer_load_dwordx4 v4, s[44:47], s64 offen lds
    s_add_u32 m0, s21, 14336
    s_add_u32 s64, s65, 0xfa000
    buffer_load_dwordx4 v4, s[44:47], s64 offen lds
    s_add_u32 m0, s21, 15360
    s_add_u32 s64, s65, 0xff000
    buffer_load_dwordx4 v4, s[44:47], s64 offen lds
    s_waitcnt vmcnt(32)
    ds_read_b64_tr_b16 a[64:65], v2 offset:16384
    ds_read_b64_tr_b16 a[66:67], v2 offset:17408
    ds_read_b64_tr_b16 a[68:69], v3 offset:16384
    ds_read_b64_tr_b16 a[70:71], v3 offset:17408
    ds_read_b64_tr_b16 a[72:73], v2 offset:18432
    ds_read_b64_tr_b16 a[74:75], v2 offset:19456
    ds_read_b64_tr_b16 a[76:77], v3 offset:18432
    ds_read_b64_tr_b16 a[78:79], v3 offset:19456
    s_waitcnt lgkmcnt(0)
    s_add_u32 m0, s21, 16384
    s_add_u32 s64, s65, 0x104000
    buffer_load_dwordx4 v4, s[44:47], s64 offen lds
    s_add_u32 m0, s21, 17408
    s_add_u32 s64, s65, 0x109000
    buffer_load_dwordx4 v4, s[44:47], s64 offen lds
    s_add_u32 m0, s21, 18432
    s_add_u32 s64, s65, 0x10e000
    buffer_load_dwordx4 v4, s[44:47], s64 offen lds
    s_add_u32 m0, s21, 19456
    s_add_u32 s64, s65, 0x113000
    buffer_load_dwordx4 v4, s[44:47], s64 offen lds
    s_waitcnt vmcnt(32)
    ds_read_b64_tr_b16 a[80:81], v2 offset:20480
    ds_read_b64_tr_b16 a[82:83], v2 offset:21504
    ds_read_b64_tr_b16 a[84:85], v3 offset:20480
    ds_read_b64_tr_b16 a[86:87], v3 offset:21504
    ds_read_b64_tr_b16 a[88:89], v2 offset:22528
    ds_read_b64_tr_b16 a[90:91], v2 offset:23552
    ds_read_b64_tr_b16 a[92:93], v3 offset:22528
    ds_read_b64_tr_b16 a[94:95], v3 offset:23552
    s_waitcnt lgkmcnt(0)
    s_add_u32 m0, s21, 20480
    s_add_u32 s64, s65, 0x118000
    buffer_load_dwordx4 v4, s[44:47], s64 offen lds
    s_add_u32 m0, s21, 21504
    s_add_u32 s64, s65, 0x11d000
    buffer_load_dwordx4 v4, s[44:47], s64 offen lds
    s_add_u32 m0, s21, 22528
    s_add_u32 s64, s65, 0x122000
    buffer_load_dwordx4 v4, s[44:47], s64 offen lds
    s_add_u32 m0, s21, 23552
    s_add_u32 s64, s65, 0x127000
    buffer_load_dwordx4 v4, s[44:47], s64 offen lds
    s_waitcnt vmcnt(32)
    ds_read_b64_tr_b16 a[96:97], v2 offset:24576
    ds_read_b64_tr_b16 a[98:99], v2 offset:25600
    ds_read_b64_tr_b16 a[100:101], v3 offset:24576
    ds_read_b64_tr_b16 a[102:103], v3 offset:25600
    ds_read_b64_tr_b16 a[104:105], v2 offset:26624
    ds_read_b64_tr_b16 a[106:107], v2 offset:27648
    ds_read_b64_tr_b16 a[108:109], v3 offset:26624
    ds_read_b64_tr_b16 a[110:111], v3 offset:27648
    s_waitcnt lgkmcnt(0)
    s_add_u32 m0, s21, 24576
    s_add_u32 s64, s65, 0x12c000
    buffer_load_dwordx4 v4, s[44:47], s64 offen lds
    s_add_u32 m0, s21, 25600
    s_add_u32 s64, s65, 0x131000
    buffer_load_dwordx4 v4, s[44:47], s64 offen lds
    s_add_u32 m0, s21, 26624
    s_add_u32 s64, s65, 0x136000
    buffer_load_dwordx4 v4, s[44:47], s64 offen lds
    s_add_u32 m0, s21, 27648
    s_add_u32 s64, s65, 0x13b000
    buffer_load_dwordx4 v4, s[44:47], s64 offen lds
    s_waitcnt vmcnt(32)
    ds_read_b64_tr_b16 a[112:113], v2 offset:28672
    ds_read_b64_tr_b16 a[114:115], v2 offset:29696
    ds_read_b64_tr_b16 a[116:117], v3 offset:28672
    ds_read_b64_tr_b16 a[118:119], v3 offset:29696
    ds_read_b64_tr_b16 a[120:121], v2 offset:30720
    ds_read_b64_tr_b16 a[122:123], v2 offset:31744
    ds_read_b64_tr_b16 a[124:125], v3 offset:30720
    ds_read_b64_tr_b16 a[126:127], v3 offset:31744
    s_waitcnt lgkmcnt(0)
    s_waitcnt vmcnt(28)
    ds_read_b64_tr_b16 a[128:129], v2 offset:32768
    ds_read_b64_tr_b16 a[130:131], v2 offset:33792
    ds_read_b64_tr_b16 a[132:133], v3 offset:32768
    ds_read_b64_tr_b16 a[134:135], v3 offset:33792
    ds_read_b64_tr_b16 a[136:137], v2 offset:34816
    ds_read_b64_tr_b16 a[138:139], v2 offset:35840
    ds_read_b64_tr_b16 a[140:141], v3 offset:34816
    ds_read_b64_tr_b16 a[142:143], v3 offset:35840
    s_waitcnt lgkmcnt(0)
    s_waitcnt vmcnt(24)
    ds_read_b64_tr_b16 a[144:145], v2 offset:0
    ds_read_b64_tr_b16 a[146:147], v2 offset:1024
    ds_read_b64_tr_b16 a[148:149], v3 offset:0
    ds_read_b64_tr_b16 a[150:151], v3 offset:1024
    ds_read_b64_tr_b16 a[152:153], v2 offset:2048
    ds_read_b64_tr_b16 a[154:155], v2 offset:3072
    ds_read_b64_tr_b16 a[156:157], v3 offset:2048
    ds_read_b64_tr_b16 a[158:159], v3 offset:3072
    s_waitcnt lgkmcnt(0)
    s_waitcnt vmcnt(20)
    ds_read_b64_tr_b16 a[160:161], v2 offset:4096
    ds_read_b64_tr_b16 a[162:163], v2 offset:5120
    ds_read_b64_tr_b16 a[164:165], v3 offset:4096
    ds_read_b64_tr_b16 a[166:167], v3 offset:5120
    ds_read_b64_tr_b16 a[168:169], v2 offset:6144
    ds_read_b64_tr_b16 a[170:171], v2 offset:7168
    ds_read_b64_tr_b16 a[172:173], v3 offset:6144
    ds_read_b64_tr_b16 a[174:175], v3 offset:7168
    s_waitcnt lgkmcnt(0)
    s_waitcnt vmcnt(16)
    ds_read_b64_tr_b16 a[176:177], v2 offset:8192
    ds_read_b64_tr_b16 a[178:179], v2 offset:9216
    ds_read_b64_tr_b16 a[180:181], v3 offset:8192
    ds_read_b64_tr_b16 a[182:183], v3 offset:9216
    ds_read_b64_tr_b16 a[184:185], v2 offset:10240
    ds_read_b64_tr_b16 a[186:187], v2 offset:11264
    ds_read_b64_tr_b16 a[188:189], v3 offset:10240
    ds_read_b64_tr_b16 a[190:191], v3 offset:11264
    s_waitcnt lgkmcnt(0)
    s_waitcnt vmcnt(12)
    ds_read_b64_tr_b16 a[192:193], v2 offset:12288
    ds_read_b64_tr_b16 a[194:195], v2 offset:13312
    ds_read_b64_tr_b16 a[196:197], v3 offset:12288
    ds_read_b64_tr_b16 a[198:199], v3 offset:13312
    ds_read_b64_tr_b16 a[200:201], v2 offset:14336
    ds_read_b64_tr_b16 a[202:203], v2 offset:15360
    ds_read_b64_tr_b16 a[204:205], v3 offset:14336
    ds_read_b64_tr_b16 a[206:207], v3 offset:15360
    s_waitcnt lgkmcnt(0)
    s_waitcnt vmcnt(8)
    ds_read_b64_tr_b16 a[208:209], v2 offset:16384
    ds_read_b64_tr_b16 a[210:211], v2 offset:17408
    ds_read_b64_tr_b16 a[212:213], v3 offset:16384
    ds_read_b64_tr_b16 a[214:215], v3 offset:17408
    ds_read_b64_tr_b16 a[216:217], v2 offset:18432
    ds_read_b64_tr_b16 a[218:219], v2 offset:19456
    ds_read_b64_tr_b16 a[220:221], v3 offset:18432
    ds_read_b64_tr_b16 a[222:223], v3 offset:19456
    s_waitcnt lgkmcnt(0)
    s_waitcnt vmcnt(4)
    ds_read_b64_tr_b16 a[224:225], v2 offset:20480
    ds_read_b64_tr_b16 a[226:227], v2 offset:21504
    ds_read_b64_tr_b16 a[228:229], v3 offset:20480
    ds_read_b64_tr_b16 a[230:231], v3 offset:21504
    ds_read_b64_tr_b16 a[232:233], v2 offset:22528
    ds_read_b64_tr_b16 a[234:235], v2 offset:23552
    ds_read_b64_tr_b16 a[236:237], v3 offset:22528
    ds_read_b64_tr_b16 a[238:239], v3 offset:23552
    s_waitcnt lgkmcnt(0)
    s_waitcnt vmcnt(0)
    ds_read_b64_tr_b16 a[240:241], v2 offset:24576
    ds_read_b64_tr_b16 a[242:243], v2 offset:25600
    ds_read_b64_tr_b16 a[244:245], v3 offset:24576
    ds_read_b64_tr_b16 a[246:247], v3 offset:25600
    ds_read_b64_tr_b16 a[248:249], v2 offset:26624
    ds_read_b64_tr_b16 a[250:251], v2 offset:27648
    ds_read_b64_tr_b16 a[252:253], v3 offset:26624
    ds_read_b64_tr_b16 a[254:255], v3 offset:27648
    s_waitcnt lgkmcnt(0)
    s_mov_b32 s13, s89
NOWO_115:
    v_mov_b32 v2, v10
    v_mov_b32 v3, v11
MKH_114:
    s_mov_b64 exec, 0xf
MKT_M_116:
    buffer_load_dword v5, v6, s[4:7], s28 offen sc1
    s_add_u32 s29, s29, 1
    s_waitcnt vmcnt(0)
    v_cmp_eq_u32 vcc, 0, v5
    s_cbranch_vccz MKT_MD_117
    s_cmp_gt_u32 s29, 262144
    s_cbranch_scc1 MKT_MD_117
    s_sleep 1
    s_branch MKT_M_116
MKT_MD_117:
    s_mov_b64 exec, -1
MKR_118:
    s_add_u32 s64, s25, 0x0
    buffer_load_dwordx4 v[16:19], v2, s[4:7], s64 offen sc1
    s_add_u32 s64, s25, 0x200
    buffer_load_dwordx4 v[20:23], v2, s[4:7], s64 offen sc1
    s_add_u32 s64, s25, 0x400
    buffer_load_dwordx4 v[24:27], v2, s[4:7], s64 offen sc1
    s_add_u32 s64, s25, 0x600
    buffer_load_dwordx4 v[28:31], v2, s[4:7], s64 offen sc1
    s_add_u32 s64, s25, 0x800
    buffer_load_dwordx4 v[32:35], v2, s[4:7], s64 offen sc1
    s_add_u32 s64, s25, 0xa00
    buffer_load_dwordx4 v[36:39], v2, s[4:7], s64 offen sc1
    s_add_u32 s64, s25, 0xc00
    buffer_load_dwordx4 v[40:43], v2, s[4:7], s64 offen sc1
    s_add_u32 s64, s25, 0xe00
    buffer_load_dwordx4 v[44:47], v2, s[4:7], s64 offen sc1
    s_add_u32 s64, s25, 0x1000
    buffer_load_dwordx4 v[48:51], v2, s[4:7], s64 offen sc1
    s_add_u32 s64, s25, 0x1200
    buffer_load_dwordx4 v[52:55], v2, s[4:7], s64 offen sc1
    s_add_u32 s64, s30, 0x0
    buffer_load_dwordx4 v[56:59], v2, s[4:7], s64 offen sc1
    s_add_u32 s64, s30, 0x200
    buffer_load_dwordx4 v[60:63], v2, s[4:7], s64 offen sc1
    s_add_u32 s64, s30, 0x400
    buffer_load_dwordx4 v[64:67], v2, s[4:7], s64 offen sc1
    s_add_u32 s64, s30, 0x600
    buffer_load_dwordx4 v[68:71], v2, s[4:7], s64 offen sc1
    s_add_u32 s64, s30, 0x800
    buffer_load_dwordx4 v[72:75], v2, s[4:7], s64 offen sc1
    s_add_u32 s64, s30, 0xa00
    buffer_load_dwordx4 v[76:79], v2, s[4:7], s64 offen sc1
    s_add_u32 s64, s30, 0xc00
    buffer_load_dwordx4 v[80:83], v2, s[4:7], s64 offen sc1
    s_add_u32 s64, s30, 0xe00
    buffer_load_dwordx4 v[84:87], v2, s[4:7], s64 offen sc1
    s_add_u32 s64, s30, 0x1000
    buffer_load_dwordx4 v[88:91], v2, s[4:7], s64 offen sc1
    s_add_u32 s64, s30, 0x1200
    buffer_load_dwordx4 v[92:95], v2, s[4:7], s64 offen sc1
    s_add_u32 s29, s29, 1
    s_waitcnt vmcnt(0)
    v_max3_u32 v4, v19, v23, v27
    v_max3_u32 v4, v4, v31, v35
    v_max3_u32 v4, v4, v39, v43
    v_max3_u32 v4, v4, v47, v51
    v_max3_u32 v4, v4, v55, v59
    v_max3_u32 v4, v4, v63, v67
    v_max3_u32 v4, v4, v71, v75
    v_max3_u32 v4, v4, v79, v83
    v_max3_u32 v4, v4, v87, v91
    v_max_u32 v4, v4, v95
    v_cmp_eq_u32 vcc, -1, v4
    s_cbranch_vccz MKO_119
    s_cmp_gt_u32 s29, 262144
    s_cbranch_scc0 MKR_118
MKO_119:
    v_mfma_f32_16x16x32_bf16 v[8:11], v[96:99], v[16:19], 0
    v_mfma_f32_16x16x32_bf16 v[12:15], v[100:103], v[16:19], 0
    v_mfma_f32_16x16x32_bf16 v[8:11], v[104:107], v[20:23], v[8:11]
    v_mfma_f32_16x16x32_bf16 v[12:15], v[108:111], v[20:23], v[12:15]
    v_mfma_f32_16x16x32_bf16 v[8:11], v[112:115], v[24:27], v[8:11]
    v_mfma_f32_16x16x32_bf16 v[12:15], v[116:119], v[24:27], v[12:15]
    v_mfma_f32_16x16x32_bf16 v[8:11], v[120:123], v[28:31], v[8:11]
    v_mfma_f32_16x16x32_bf16 v[12:15], v[124:127], v[28:31], v[12:15]
    v_mfma_f32_16x16x32_bf16 v[8:11], v[128:131], v[32:35], v[8:11]
    v_mfma_f32_16x16x32_bf16 v[12:15], v[132:135], v[32:35], v[12:15]
    v_mfma_f32_16x16x32_bf16 v[8:11], v[136:139], v[36:39], v[8:11]
    v_mfma_f32_16x16x32_bf16 v[12:15], v[140:143], v[36:39], v[12:15]
    v_mfma_f32_16x16x32_bf16 v[8:11], v[144:147], v[40:43], v[8:11]
    v_mfma_f32_16x16x32_bf16 v[12:15], v[148:151], v[40:43], v[12:15]
    v_mfma_f32_16x16x32_bf16 v[8:11], v[152:155], v[44:47], v[8:11]
    v_mfma_f32_16x16x32_bf16 v[12:15], v[156:159], v[44:47], v[12:15]
    v_mfma_f32_16x16x32_bf16 v[8:11], v[160:163], v[48:51], v[8:11]
    v_mfma_f32_16x16x32_bf16 v[12:15], v[164:167], v[48:51], v[12:15]
    v_mfma_f32_16x16x32_bf16 v[8:11], v[168:171], v[52:55], v[8:11]
    v_mfma_f32_16x16x32_bf16 v[12:15], v[172:175], v[52:55], v[12:15]
    v_mfma_f32_16x16x32_bf16 v[8:11], v[176:179], v[56:59], v[8:11]
    v_mfma_f32_16x16x32_bf16 v[12:15], v[180:183], v[56:59], v[12:15]
    v_mfma_f32_16x16x32_bf16 v[8:11], v[184:187], v[60:63], v[8:11]
    v_mfma_f32_16x16x32_bf16 v[12:15], v[188:191], v[60:63], v[12:15]
    v_mfma_f32_16x16x32_bf16 v[8:11], v[192:195], v[64:67], v[8:11]
    v_mfma_f32_16x16x32_bf16 v[12:15], v[196:199], v[64:67], v[12:15]
    v_mfma_f32_16x16x32_bf16 v[8:11], v[200:203], v[68:71], v[8:11]
    v_mfma_f32_16x16x32_bf16 v[12:15], v[204:207], v[68:71], v[12:15]
    v_mfma_f32_16x16x32_bf16 v[8:11], v[208:211], v[72:75], v[8:11]
    v_mfma_f32_16x16x32_bf16 v[12:15], v[212:215], v[72:75], v[12:15]
    v_mfma_f32_16x16x32_bf16 v[8:11], v[216:219], v[76:79], v[8:11]
    v_mfma_f32_16x16x32_bf16 v[12:15], v[220:223], v[76:79], v[12:15]
    v_mfma_f32_16x16x32_bf16 v[8:11], v[224:227], v[80:83], v[8:11]
    v_mfma_f32_16x16x32_bf16 v[12:15], v[228:231], v[80:83], v[12:15]
    v_mfma_f32_16x16x32_bf16 v[8:11], v[232:235], v[84:87], v[8:11]
    v_mfma_f32_16x16x32_bf16 v[12:15], v[236:239], v[84:87], v[12:15]
    v_mfma_f32_16x16x32_bf16 v[8:11], v[240:243], v[88:91], v[8:11]
    v_mfma_f32_16x16x32_bf16 v[12:15], v[244:247], v[88:91], v[12:15]
    v_mfma_f32_16x16x32_bf16 v[8:11], v[248:251], v[92:95], v[8:11]
    v_mfma_f32_16x16x32_bf16 v[12:15], v[252:255], v[92:95], v[12:15]
    s_nop 7
    v_cvt_pk_bf16_f32 v16, v8, v9
    v_cvt_pk_bf16_f32 v17, v10, v11
    v_cvt_pk_bf16_f32 v18, v12, v13
    v_cvt_pk_bf16_f32 v19, v14, v15
    buffer_store_dwordx4 v[16:19], v3, s[4:7], s26 offen sc1
    s_waitcnt vmcnt(0)
    s_barrier
    s_cmp_lg_u32 s14, 0
    s_cbranch_scc1 GF_120
    v_mov_b32 v7, 1
    v_mov_b32 v8, 0
    s_mov_b64 exec, 1
    buffer_store_dword v7, v8, s[4:7], s27 offen sc1
    s_mov_b64 exec, -1
GF_120:
    s_add_u32 s25, s25, 0x10000
    s_add_u32 s30, s30, 0x10000
    s_add_u32 s26, s26, 0x20000
    s_add_u32 s27, s27, 256
    s_add_u32 s28, s28, 512
    s_add_u32 s24, s24, 1
    s_cmp_lt_u32 s24, 32
    s_cbranch_scc1 MKT_LOOP
    s_cmp_ge_u32 s88, 60
    s_cbranch_scc1 M_EXIT
    s_branch H_EXTRA
G_N:
    s_lshl_b32 s65, s13, 8
    s_lshl_b32 s66, s14, 6
    s_add_u32 s20, s65, s66
    s_mul_i32 s21, s14, 36864
    v_lshrrev_b32 v6, 2, v0
    v_mul_u32_u24 v5, 8192, v6
    v_lshrrev_b32 v6, 5, v0
    v_lshlrev_b32 v6, 1, v6
    v_and_b32 v7, 3, v0
    v_xor_b32 v6, v6, v7
    v_lshl_add_u32 v5, v6, 4, v5
    v_lshrrev_b32 v6, 5, v0
    v_lshlrev_b32 v3, 10, v6
    v_bfe_u32 v6, v0, 2, 2
    v_lshl_add_u32 v3, v6, 6, v3
    v_and_b32 v6, 3, v0
    v_lshl_add_u32 v3, v6, 3, v3
    v_bfe_u32 v6, v0, 4, 1
    v_lshl_add_u32 v3, v6, 9, v3
    v_add_u32 v3, s21, v3
    v_lshlrev_b32 v6, 5, v6
    v_sub_u32 v4, 32, v6
    v_add_u32 v4, v4, v3
    v_add_u32 v3, v3, v6
    s_add_u32 m0, s21, 0
    s_add_u32 s64, s20, 0x0
    buffer_load_dwordx4 v5, s[44:47], s64 offen lds
    s_add_u32 m0, s21, 1024
    s_add_u32 s64, s20, 0x20000
    buffer_load_dwordx4 v5, s[44:47], s64 offen lds
    s_add_u32 m0, s21, 2048
    s_add_u32 s64, s20, 0x40000
    buffer_load_dwordx4 v5, s[44:47], s64 offen lds
    s_add_u32 m0, s21, 3072
    s_add_u32 s64, s20, 0x60000
    buffer_load_dwordx4 v5, s[44:47], s64 offen lds
    s_add_u32 m0, s21, 4096
    s_add_u32 s64, s20, 0x80000
    buffer_load_dwordx4 v5, s[44:47], s64 offen lds
    s_add_u32 m0, s21, 5120
    s_add_u32 s64, s20, 0xa0000
    buffer_load_dwordx4 v5, s[44:47], s64 offen lds
    s_add_u32 m0, s21, 6144
    s_add_u32 s64, s20, 0xc0000
    buffer_load_dwordx4 v5, s[44:47], s64 offen lds
    s_add_u32 m0, s21, 7168
    s_add_u32 s64, s20, 0xe0000
    buffer_load_dwordx4 v5, s[44:47], s64 offen lds
    s_add_u32 m0, s21, 8192
    s_add_u32 s64, s20, 0x100000
    buffer_load_dwordx4 v5, s[44:47], s64 offen lds
    s_add_u32 m0, s21, 9216
    s_add_u32 s64, s20, 0x120000
    buffer_load_dwordx4 v5, s[44:47], s64 offen lds
    s_add_u32 m0, s21, 10240
    s_add_u32 s64, s20, 0x140000
    buffer_load_dwordx4 v5, s[44:47], s64 offen lds
    s_add_u32 m0, s21, 11264
    s_add_u32 s64, s20, 0x160000
    buffer_load_dwordx4 v5, s[44:47], s64 offen lds
    s_add_u32 m0, s21, 12288
    s_add_u32 s64, s20, 0x180000
    buffer_load_dwordx4 v5, s[44:47], s64 offen lds
    s_add_u32 m0, s21, 13312
    s_add_u32 s64, s20, 0x1a0000
    buffer_load_dwordx4 v5, s[44:47], s64 offen lds
    s_add_u32 m0, s21, 14336
    s_add_u32 s64, s20, 0x1c0000
    buffer_load_dwordx4 v5, s[44:47], s64 offen lds
    s_add_u32 m0, s21, 15360
    s_add_u32 s64, s20, 0x1e0000
    buffer_load_dwordx4 v5, s[44:47], s64 offen lds
    s_add_u32 m0, s21, 16384
    s_add_u32 s64, s20, 0x200000
    buffer_load_dwordx4 v5, s[44:47], s64 offen lds
    s_add_u32 m0, s21, 17408
    s_add_u32 s64, s20, 0x220000
    buffer_load_dwordx4 v5, s[44:47], s64 offen lds
    s_add_u32 m0, s21, 18432
    s_add_u32 s64, s20, 0x240000
    buffer_load_dwordx4 v5, s[44:47], s64 offen lds
    s_add_u32 m0, s21, 19456
    s_add_u32 s64, s20, 0x260000
    buffer_load_dwordx4 v5, s[44:47], s64 offen lds
    s_add_u32 m0, s21, 20480
    s_add_u32 s64, s20, 0x280000
    buffer_load_dwordx4 v5, s[44:47], s64 offen lds
    s_add_u32 m0, s21, 21504
    s_add_u32 s64, s20, 0x2a0000
    buffer_load_dwordx4 v5, s[44:47], s64 offen lds
    s_add_u32 m0, s21, 22528
    s_add_u32 s64, s20, 0x2c0000
    buffer_load_dwordx4 v5, s[44:47], s64 offen lds
    s_add_u32 m0, s21, 23552
    s_add_u32 s64, s20, 0x2e0000
    buffer_load_dwordx4 v5, s[44:47], s64 offen lds
    s_add_u32 m0, s21, 24576
    s_add_u32 s64, s20, 0x300000
    buffer_load_dwordx4 v5, s[44:47], s64 offen lds
    s_add_u32 m0, s21, 25600
    s_add_u32 s64, s20, 0x320000
    buffer_load_dwordx4 v5, s[44:47], s64 offen lds
    s_add_u32 m0, s21, 26624
    s_add_u32 s64, s20, 0x340000
    buffer_load_dwordx4 v5, s[44:47], s64 offen lds
    s_add_u32 m0, s21, 27648
    s_add_u32 s64, s20, 0x360000
    buffer_load_dwordx4 v5, s[44:47], s64 offen lds
    s_add_u32 m0, s21, 28672
    s_add_u32 s64, s20, 0x380000
    buffer_load_dwordx4 v5, s[44:47], s64 offen lds
    s_add_u32 m0, s21, 29696
    s_add_u32 s64, s20, 0x3a0000
    buffer_load_dwordx4 v5, s[44:47], s64 offen lds
    s_add_u32 m0, s21, 30720
    s_add_u32 s64, s20, 0x3c0000
    buffer_load_dwordx4 v5, s[44:47], s64 offen lds
    s_add_u32 m0, s21, 31744
    s_add_u32 s64, s20, 0x3e0000
    buffer_load_dwordx4 v5, s[44:47], s64 offen lds
    s_add_u32 m0, s21, 32768
    s_add_u32 s64, s20, 0x400000
    buffer_load_dwordx4 v5, s[44:47], s64 offen lds
    s_add_u32 m0, s21, 33792
    s_add_u32 s64, s20, 0x420000
    buffer_load_dwordx4 v5, s[44:47], s64 offen lds
    s_add_u32 m0, s21, 34816
    s_add_u32 s64, s20, 0x440000
    buffer_load_dwordx4 v5, s[44:47], s64 offen lds
    s_add_u32 m0, s21, 35840
    s_add_u32 s64, s20, 0x460000
    buffer_load_dwordx4 v5, s[44:47], s64 offen lds
    s_waitcnt vmcnt(32)
    ds_read_b64_tr_b16 v[96:97], v3 offset:0
    ds_read_b64_tr_b16 v[98:99], v3 offset:256
    ds_read_b64_tr_b16 v[100:101], v4 offset:0
    ds_read_b64_tr_b16 v[102:103], v4 offset:256
    ds_read_b64_tr_b16 v[104:105], v3 offset:2048
    ds_read_b64_tr_b16 v[106:107], v3 offset:2304
    ds_read_b64_tr_b16 v[108:109], v4 offset:2048
    ds_read_b64_tr_b16 v[110:111], v4 offset:2304
    s_waitcnt lgkmcnt(0)
    s_add_u32 m0, s21, 0
    s_add_u32 s64, s20, 0x480000
    buffer_load_dwordx4 v5, s[44:47], s64 offen lds
    s_add_u32 m0, s21, 1024
    s_add_u32 s64, s20, 0x4a0000
    buffer_load_dwordx4 v5, s[44:47], s64 offen lds
    s_add_u32 m0, s21, 2048
    s_add_u32 s64, s20, 0x4c0000
    buffer_load_dwordx4 v5, s[44:47], s64 offen lds
    s_add_u32 m0, s21, 3072
    s_add_u32 s64, s20, 0x4e0000
    buffer_load_dwordx4 v5, s[44:47], s64 offen lds
    s_waitcnt vmcnt(32)
    ds_read_b64_tr_b16 v[112:113], v3 offset:4096
    ds_read_b64_tr_b16 v[114:115], v3 offset:4352
    ds_read_b64_tr_b16 v[116:117], v4 offset:4096
    ds_read_b64_tr_b16 v[118:119], v4 offset:4352
    ds_read_b64_tr_b16 v[120:121], v3 offset:6144
    ds_read_b64_tr_b16 v[122:123], v3 offset:6400
    ds_read_b64_tr_b16 v[124:125], v4 offset:6144
    ds_read_b64_tr_b16 v[126:127], v4 offset:6400
    s_waitcnt lgkmcnt(0)
    s_waitcnt vmcnt(28)
    ds_read_b64_tr_b16 v[128:129], v3 offset:8192
    ds_read_b64_tr_b16 v[130:131], v3 offset:8448
    ds_read_b64_tr_b16 v[132:133], v4 offset:8192
    ds_read_b64_tr_b16 v[134:135], v4 offset:8448
    ds_read_b64_tr_b16 v[136:137], v3 offset:10240
    ds_read_b64_tr_b16 v[138:139], v3 offset:10496
    ds_read_b64_tr_b16 v[140:141], v4 offset:10240
    ds_read_b64_tr_b16 v[142:143], v4 offset:10496
    s_waitcnt lgkmcnt(0)
    s_waitcnt vmcnt(24)
    ds_read_b64_tr_b16 v[144:145], v3 offset:12288
    ds_read_b64_tr_b16 v[146:147], v3 offset:12544
    ds_read_b64_tr_b16 v[148:149], v4 offset:12288
    ds_read_b64_tr_b16 v[150:151], v4 offset:12544
    ds_read_b64_tr_b16 v[152:153], v3 offset:14336
    ds_read_b64_tr_b16 v[154:155], v3 offset:14592
    ds_read_b64_tr_b16 v[156:157], v4 offset:14336
    ds_read_b64_tr_b16 v[158:159], v4 offset:14592
    s_waitcnt lgkmcnt(0)
    s_waitcnt vmcnt(20)
    ds_read_b64_tr_b16 v[160:161], v3 offset:16384
    ds_read_b64_tr_b16 v[162:163], v3 offset:16640
    ds_read_b64_tr_b16 v[164:165], v4 offset:16384
    ds_read_b64_tr_b16 v[166:167], v4 offset:16640
    ds_read_b64_tr_b16 v[168:169], v3 offset:18432
    ds_read_b64_tr_b16 v[170:171], v3 offset:18688
    ds_read_b64_tr_b16 v[172:173], v4 offset:18432
    ds_read_b64_tr_b16 v[174:175], v4 offset:18688
    s_waitcnt lgkmcnt(0)
    s_waitcnt vmcnt(16)
    ds_read_b64_tr_b16 v[176:177], v3 offset:20480
    ds_read_b64_tr_b16 v[178:179], v3 offset:20736
    ds_read_b64_tr_b16 v[180:181], v4 offset:20480
    ds_read_b64_tr_b16 v[182:183], v4 offset:20736
    ds_read_b64_tr_b16 v[184:185], v3 offset:22528
    ds_read_b64_tr_b16 v[186:187], v3 offset:22784
    ds_read_b64_tr_b16 v[188:189], v4 offset:22528
    ds_read_b64_tr_b16 v[190:191], v4 offset:22784
    s_waitcnt lgkmcnt(0)
    s_waitcnt vmcnt(12)
    ds_read_b64_tr_b16 v[192:193], v3 offset:24576
    ds_read_b64_tr_b16 v[194:195], v3 offset:24832
    ds_read_b64_tr_b16 v[196:197], v4 offset:24576
    ds_read_b64_tr_b16 v[198:199], v4 offset:24832
    ds_read_b64_tr_b16 v[200:201], v3 offset:26624
    ds_read_b64_tr_b16 v[202:203], v3 offset:26880
    ds_read_b64_tr_b16 v[204:205], v4 offset:26624
    ds_read_b64_tr_b16 v[206:207], v4 offset:26880
    s_waitcnt lgkmcnt(0)
    s_waitcnt vmcnt(8)
    ds_read_b64_tr_b16 v[208:209], v3 offset:28672
    ds_read_b64_tr_b16 v[210:211], v3 offset:28928
    ds_read_b64_tr_b16 v[212:213], v4 offset:28672
    ds_read_b64_tr_b16 v[214:215], v4 offset:28928
    ds_read_b64_tr_b16 v[216:217], v3 offset:30720
    ds_read_b64_tr_b16 v[218:219], v3 offset:30976
    ds_read_b64_tr_b16 v[220:221], v4 offset:30720
    ds_read_b64_tr_b16 v[222:223], v4 offset:30976
    s_waitcnt lgkmcnt(0)
    s_waitcnt vmcnt(4)
    ds_read_b64_tr_b16 v[224:225], v3 offset:32768
    ds_read_b64_tr_b16 v[226:227], v3 offset:33024
    ds_read_b64_tr_b16 v[228:229], v4 offset:32768
    ds_read_b64_tr_b16 v[230:231], v4 offset:33024
    ds_read_b64_tr_b16 v[232:233], v3 offset:34816
    ds_read_b64_tr_b16 v[234:235], v3 offset:35072
    ds_read_b64_tr_b16 v[236:237], v4 offset:34816
    ds_read_b64_tr_b16 v[238:239], v4 offset:35072
    s_waitcnt lgkmcnt(0)
    s_waitcnt vmcnt(0)
    ds_read_b64_tr_b16 v[240:241], v3 offset:0
    ds_read_b64_tr_b16 v[242:243], v3 offset:256
    ds_read_b64_tr_b16 v[244:245], v4 offset:0
    ds_read_b64_tr_b16 v[246:247], v4 offset:256
    ds_read_b64_tr_b16 v[248:249], v3 offset:2048
    ds_read_b64_tr_b16 v[250:251], v3 offset:2304
    ds_read_b64_tr_b16 v[252:253], v4 offset:2048
    ds_read_b64_tr_b16 v[254:255], v4 offset:2304
    s_waitcnt lgkmcnt(0)
    s_cmp_lg_u32 s97, 0
    s_cbranch_scc1 CM_121
    v_mbcnt_lo_u32_b32 v0, -1, 0
    v_mbcnt_hi_u32_b32 v0, -1, v0
    v_mul_u32_u24 v8, 32, v0
    s_mov_b32 s64, 0x0
    s_mov_b32 s65, 0
    s_mov_b64 exec, 0xff
TK_122:
    buffer_load_dword v9, v8, s[60:63], s64 offen sc1
    s_add_u32 s65, s65, 1
    s_waitcnt vmcnt(0)
    s_mov_b32 s66, 0
    v_readlane_b32 s67, v9, 0
    s_add_u32 s66, s66, s67
    v_readlane_b32 s67, v9, 1
    s_add_u32 s66, s66, s67
    v_readlane_b32 s67, v9, 2
    s_add_u32 s66, s66, s67
    v_readlane_b32 s67, v9, 3
    s_add_u32 s66, s66, s67
    v_readlane_b32 s67, v9, 4
    s_add_u32 s66, s66, s67
    v_readlane_b32 s67, v9, 5
    s_add_u32 s66, s66, s67
    v_readlane_b32 s67, v9, 6
    s_add_u32 s66, s66, s67
    v_readlane_b32 s67, v9, 7
    s_add_u32 s66, s66, s67
    s_cmp_ge_u32 s66, 256
    s_cbranch_scc1 TKD_123
    s_cmp_gt_u32 s65, 262144
    s_cbranch_scc0 TK_122
TKD_123:
    v_cmp_ne_u32 vcc, 32, v9
    s_mov_b64 exec, -1
    s_cbranch_vccnz M_SLOW
CM_121:
    s_mov_b32 s65, 0
GI_124:
    buffer_load_dword v8, off, s[60:63], s95 sc1
    s_add_u32 s65, s65, 1
    s_waitcnt vmcnt(0)
    v_readfirstlane_b32 s64, v8
    s_cmp_ge_u32 s64, 192
    s_cbranch_scc1 GID_125
    s_cmp_gt_u32 s65, 65536
    s_cbranch_scc1 GID_125
    s_sleep 4
    s_branch GI_124
GID_125:
    v_mbcnt_lo_u32_b32 v0, -1, 0
    v_mbcnt_hi_u32_b32 v0, -1, v0
    v_lshlrev_b32 v1, 4, v0
    v_lshrrev_b32 v6, 3, v0
    v_mul_u32_u24 v2, 1280, v6
    v_and_b32 v7, 7, v0
    v_xor_b32 v7, v7, v6
    v_lshl_add_u32 v2, v7, 4, v2
    v_bfe_u32 v6, v0, 3, 1
    v_lshlrev_b32 v9, 10, v6
    v_and_b32 v6, 7, v0
    v_lshl_add_u32 v9, v6, 7, v9
    v_lshrrev_b32 v7, 4, v0
    v_xor_b32 v7, v7, v6
    v_lshl_add_u32 v3, v7, 4, v9
    v_xor_b32 v7, 4, v7
    v_lshl_add_u32 v4, v7, 4, v9
    v_add_u32 v6, 0x10000, v3
    v_add_u32 v9, 0x10000, v4
    s_barrier
    s_mul_i32 s20, s12, 163840
    s_mul_i32 s64, s14, 40960
    s_add_u32 s20, s20, s64
    s_add_u32 s20, s20, 0x0
    s_lshl_b32 s21, s14, 12
    s_add_u32 m0, s21, 0
    s_add_u32 s64, s20, 0x0
    buffer_load_dwordx4 v2, s[4:7], s64 offen lds
    s_add_u32 m0, s21, 1024
    s_add_u32 s64, s20, 0x2800
    buffer_load_dwordx4 v2, s[4:7], s64 offen lds
    s_add_u32 m0, s21, 2048
    s_add_u32 s64, s20, 0x5000
    buffer_load_dwordx4 v2, s[4:7], s64 offen lds
    s_add_u32 m0, s21, 3072
    s_add_u32 s64, s20, 0x7800
    buffer_load_dwordx4 v2, s[4:7], s64 offen lds
    s_add_u32 m0, s21, 16384
    s_add_u32 s64, s20, 0x80
    buffer_load_dwordx4 v2, s[4:7], s64 offen lds
    s_add_u32 m0, s21, 17408
    s_add_u32 s64, s20, 0x2880
    buffer_load_dwordx4 v2, s[4:7], s64 offen lds
    s_add_u32 m0, s21, 18432
    s_add_u32 s64, s20, 0x5080
    buffer_load_dwordx4 v2, s[4:7], s64 offen lds
    s_add_u32 m0, s21, 19456
    s_add_u32 s64, s20, 0x7880
    buffer_load_dwordx4 v2, s[4:7], s64 offen lds
    s_add_u32 m0, s21, 32768
    s_add_u32 s64, s20, 0x100
    buffer_load_dwordx4 v2, s[4:7], s64 offen lds
    s_add_u32 m0, s21, 33792
    s_add_u32 s64, s20, 0x2900
    buffer_load_dwordx4 v2, s[4:7], s64 offen lds
    s_add_u32 m0, s21, 34816
    s_add_u32 s64, s20, 0x5100
    buffer_load_dwordx4 v2, s[4:7], s64 offen lds
    s_add_u32 m0, s21, 35840
    s_add_u32 s64, s20, 0x7900
    buffer_load_dwordx4 v2, s[4:7], s64 offen lds
    s_add_u32 m0, s21, 49152
    s_add_u32 s64, s20, 0x180
    buffer_load_dwordx4 v2, s[4:7], s64 offen lds
    s_add_u32 m0, s21, 50176
    s_add_u32 s64, s20, 0x2980
    buffer_load_dwordx4 v2, s[4:7], s64 offen lds
    s_add_u32 m0, s21, 51200
    s_add_u32 s64, s20, 0x5180
    buffer_load_dwordx4 v2, s[4:7], s64 offen lds
    s_add_u32 m0, s21, 52224
    s_add_u32 s64, s20, 0x7980
    buffer_load_dwordx4 v2, s[4:7], s64 offen lds
    s_mov_b32 s64, 0x40000000
    buffer_store_dword v7, v1, s[4:7], s64 offen
    buffer_store_dword v7, v1, s[4:7], s64 offen
    buffer_store_dword v7, v1, s[4:7], s64 offen
    buffer_store_dword v7, v1, s[4:7], s64 offen
    buffer_store_dword v7, v1, s[4:7], s64 offen
    buffer_store_dword v7, v1, s[4:7], s64 offen
    buffer_store_dword v7, v1, s[4:7], s64 offen
    buffer_store_dword v7, v1, s[4:7], s64 offen
    s_waitcnt vmcnt(20)
    s_barrier
    ds_read_b128 a[0:3], v3 offset:0
    ds_read_b128 a[4:7], v3 offset:2048
    ds_read_b128 a[8:11], v3 offset:4096
    ds_read_b128 a[12:15], v3 offset:6144
    ds_read_b128 a[16:19], v3 offset:8192
    ds_read_b128 a[20:23], v3 offset:10240
    ds_read_b128 a[24:27], v3 offset:12288
    ds_read_b128 a[28:31], v3 offset:14336
    s_mov_b32 s19, 0
    s_mov_b32 s22, s16
    s_mov_b32 s23, 0x40000000
G_N_LOOP:
    s_waitcnt lgkmcnt(4)
    v_mfma_f32_16x16x32_bf16 v[16:19], a[0:3], v[96:99], 0
    v_mfma_f32_16x16x32_bf16 v[20:23], a[0:3], v[100:103], 0
    ds_read_b128 a[32:35], v4 offset:0
    v_mfma_f32_16x16x32_bf16 v[24:27], a[4:7], v[96:99], 0
    v_mfma_f32_16x16x32_bf16 v[28:31], a[4:7], v[100:103], 0
    ds_read_b128 a[36:39], v4 offset:2048
    v_mfma_f32_16x16x32_bf16 v[32:35], a[8:11], v[96:99], 0
    v_mfma_f32_16x16x32_bf16 v[36:39], a[8:11], v[100:103], 0
    ds_read_b128 a[40:43], v4 offset:4096
    v_mfma_f32_16x16x32_bf16 v[40:43], a[12:15], v[96:99], 0
    v_mfma_f32_16x16x32_bf16 v[44:47], a[12:15], v[100:103], 0
    ds_read_b128 a[44:47], v4 offset:6144
    s_waitcnt lgkmcnt(4)
    v_mfma_f32_16x16x32_bf16 v[48:51], a[16:19], v[96:99], 0
    v_mfma_f32_16x16x32_bf16 v[52:55], a[16:19], v[100:103], 0
    ds_read_b128 a[48:51], v4 offset:8192
    v_mfma_f32_16x16x32_bf16 v[56:59], a[20:23], v[96:99], 0
    v_mfma_f32_16x16x32_bf16 v[60:63], a[20:23], v[100:103], 0
    ds_read_b128 a[52:55], v4 offset:10240
    v_mfma_f32_16x16x32_bf16 v[64:67], a[24:27], v[96:99], 0
    v_mfma_f32_16x16x32_bf16 v[68:71], a[24:27], v[100:103], 0
    ds_read_b128 a[56:59], v4 offset:12288
    v_mfma_f32_16x16x32_bf16 v[72:75], a[28:31], v[96:99], 0
    v_mfma_f32_16x16x32_bf16 v[76:79], a[28:31], v[100:103], 0
    ds_read_b128 a[60:63], v4 offset:14336
    s_waitcnt vmcnt(16)
    s_barrier
    s_waitcnt lgkmcnt(4)
    v_mfma_f32_16x16x32_bf16 v[16:19], a[32:35], v[104:107], v[16:19]
    v_mfma_f32_16x16x32_bf16 v[20:23], a[32:35], v[108:111], v[20:23]
    ds_read_b128 a[0:3], v3 offset:16384
    s_add_u32 m0, s21, 65536
    v_mfma_f32_16x16x32_bf16 v[24:27], a[36:39], v[104:107], v[24:27]
    v_mfma_f32_16x16x32_bf16 v[28:31], a[36:39], v[108:111], v[28:31]
    ds_read_b128 a[4:7], v3 offset:18432
    s_add_u32 s64, s20, 0x200
    buffer_load_dwordx4 v2, s[4:7], s64 offen lds
    v_mfma_f32_16x16x32_bf16 v[32:35], a[40:43], v[104:107], v[32:35]
    v_mfma_f32_16x16x32_bf16 v[36:39], a[40:43], v[108:111], v[36:39]
    ds_read_b128 a[8:11], v3 offset:20480
    s_add_u32 m0, s21, 66560
    v_mfma_f32_16x16x32_bf16 v[40:43], a[44:47], v[104:107], v[40:43]
    v_mfma_f32_16x16x32_bf16 v[44:47], a[44:47], v[108:111], v[44:47]
    ds_read_b128 a[12:15], v3 offset:22528
    s_add_u32 s64, s20, 0x2a00
    buffer_load_dwordx4 v2, s[4:7], s64 offen lds
    s_waitcnt lgkmcnt(4)
    v_mfma_f32_16x16x32_bf16 v[48:51], a[48:51], v[104:107], v[48:51]
    v_mfma_f32_16x16x32_bf16 v[52:55], a[48:51], v[108:111], v[52:55]
    ds_read_b128 a[16:19], v3 offset:24576
    s_add_u32 m0, s21, 67584
    v_mfma_f32_16x16x32_bf16 v[56:59], a[52:55], v[104:107], v[56:59]
    v_mfma_f32_16x16x32_bf16 v[60:63], a[52:55], v[108:111], v[60:63]
    ds_read_b128 a[20:23], v3 offset:26624
    s_add_u32 s64, s20, 0x5200
    buffer_load_dwordx4 v2, s[4:7], s64 offen lds
    v_mfma_f32_16x16x32_bf16 v[64:67], a[56:59], v[104:107], v[64:67]
    v_mfma_f32_16x16x32_bf16 v[68:71], a[56:59], v[108:111], v[68:71]
    ds_read_b128 a[24:27], v3 offset:28672
    s_add_u32 m0, s21, 68608
    v_mfma_f32_16x16x32_bf16 v[72:75], a[60:63], v[104:107], v[72:75]
    v_mfma_f32_16x16x32_bf16 v[76:79], a[60:63], v[108:111], v[76:79]
    ds_read_b128 a[28:31], v3 offset:30720
    s_add_u32 s64, s20, 0x7a00
    buffer_load_dwordx4 v2, s[4:7], s64 offen lds
    s_waitcnt lgkmcnt(4)
    v_mfma_f32_16x16x32_bf16 v[16:19], a[0:3], v[112:115], v[16:19]
    v_mfma_f32_16x16x32_bf16 v[20:23], a[0:3], v[116:119], v[20:23]
    ds_read_b128 a[32:35], v4 offset:16384
    v_mfma_f32_16x16x32_bf16 v[24:27], a[4:7], v[112:115], v[24:27]
    v_mfma_f32_16x16x32_bf16 v[28:31], a[4:7], v[116:119], v[28:31]
    ds_read_b128 a[36:39], v4 offset:18432
    v_mfma_f32_16x16x32_bf16 v[32:35], a[8:11], v[112:115], v[32:35]
    v_mfma_f32_16x16x32_bf16 v[36:39], a[8:11], v[116:119], v[36:39]
    ds_read_b128 a[40:43], v4 offset:20480
    v_mfma_f32_16x16x32_bf16 v[40:43], a[12:15], v[112:115], v[40:43]
    v_mfma_f32_16x16x32_bf16 v[44:47], a[12:15], v[116:119], v[44:47]
    ds_read_b128 a[44:47], v4 offset:22528
    s_waitcnt lgkmcnt(4)
    v_mfma_f32_16x16x32_bf16 v[48:51], a[16:19], v[112:115], v[48:51]
    v_mfma_f32_16x16x32_bf16 v[52:55], a[16:19], v[116:119], v[52:55]
    ds_read_b128 a[48:51], v4 offset:24576
    v_mfma_f32_16x16x32_bf16 v[56:59], a[20:23], v[112:115], v[56:59]
    v_mfma_f32_16x16x32_bf16 v[60:63], a[20:23], v[116:119], v[60:63]
    ds_read_b128 a[52:55], v4 offset:26624
    v_mfma_f32_16x16x32_bf16 v[64:67], a[24:27], v[112:115], v[64:67]
    v_mfma_f32_16x16x32_bf16 v[68:71], a[24:27], v[116:119], v[68:71]
    ds_read_b128 a[56:59], v4 offset:28672
    v_mfma_f32_16x16x32_bf16 v[72:75], a[28:31], v[112:115], v[72:75]
    v_mfma_f32_16x16x32_bf16 v[76:79], a[28:31], v[116:119], v[76:79]
    ds_read_b128 a[60:63], v4 offset:30720
    s_waitcnt vmcnt(16)
    s_barrier
    s_waitcnt lgkmcnt(4)
    v_mfma_f32_16x16x32_bf16 v[16:19], a[32:35], v[120:123], v[16:19]
    v_mfma_f32_16x16x32_bf16 v[20:23], a[32:35], v[124:127], v[20:23]
    ds_read_b128 a[0:3], v3 offset:32768
    s_add_u32 m0, s21, 0
    v_mfma_f32_16x16x32_bf16 v[24:27], a[36:39], v[120:123], v[24:27]
    v_mfma_f32_16x16x32_bf16 v[28:31], a[36:39], v[124:127], v[28:31]
    ds_read_b128 a[4:7], v3 offset:34816
    s_add_u32 s64, s20, 0x280
    buffer_load_dwordx4 v2, s[4:7], s64 offen lds
    v_mfma_f32_16x16x32_bf16 v[32:35], a[40:43], v[120:123], v[32:35]
    v_mfma_f32_16x16x32_bf16 v[36:39], a[40:43], v[124:127], v[36:39]
    ds_read_b128 a[8:11], v3 offset:36864
    s_add_u32 m0, s21, 1024
    v_mfma_f32_16x16x32_bf16 v[40:43], a[44:47], v[120:123], v[40:43]
    v_mfma_f32_16x16x32_bf16 v[44:47], a[44:47], v[124:127], v[44:47]
    ds_read_b128 a[12:15], v3 offset:38912
    s_add_u32 s64, s20, 0x2a80
    buffer_load_dwordx4 v2, s[4:7], s64 offen lds
    s_waitcnt lgkmcnt(4)
    v_mfma_f32_16x16x32_bf16 v[48:51], a[48:51], v[120:123], v[48:51]
    v_mfma_f32_16x16x32_bf16 v[52:55], a[48:51], v[124:127], v[52:55]
    ds_read_b128 a[16:19], v3 offset:40960
    s_add_u32 m0, s21, 2048
    v_mfma_f32_16x16x32_bf16 v[56:59], a[52:55], v[120:123], v[56:59]
    v_mfma_f32_16x16x32_bf16 v[60:63], a[52:55], v[124:127], v[60:63]
    ds_read_b128 a[20:23], v3 offset:43008
    s_add_u32 s64, s20, 0x5280
    buffer_load_dwordx4 v2, s[4:7], s64 offen lds
    v_mfma_f32_16x16x32_bf16 v[64:67], a[56:59], v[120:123], v[64:67]
    v_mfma_f32_16x16x32_bf16 v[68:71], a[56:59], v[124:127], v[68:71]
    ds_read_b128 a[24:27], v3 offset:45056
    s_add_u32 m0, s21, 3072
    v_mfma_f32_16x16x32_bf16 v[72:75], a[60:63], v[120:123], v[72:75]
    v_mfma_f32_16x16x32_bf16 v[76:79], a[60:63], v[124:127], v[76:79]
    ds_read_b128 a[28:31], v3 offset:47104
    s_add_u32 s64, s20, 0x7a80
    buffer_load_dwordx4 v2, s[4:7], s64 offen lds
    s_waitcnt lgkmcnt(4)
    v_mfma_f32_16x16x32_bf16 v[16:19], a[0:3], v[128:131], v[16:19]
    v_mfma_f32_16x16x32_bf16 v[20:23], a[0:3], v[132:135], v[20:23]
    ds_read_b128 a[32:35], v4 offset:32768
    v_mfma_f32_16x16x32_bf16 v[24:27], a[4:7], v[128:131], v[24:27]
    v_mfma_f32_16x16x32_bf16 v[28:31], a[4:7], v[132:135], v[28:31]
    ds_read_b128 a[36:39], v4 offset:34816
    v_mfma_f32_16x16x32_bf16 v[32:35], a[8:11], v[128:131], v[32:35]
    v_mfma_f32_16x16x32_bf16 v[36:39], a[8:11], v[132:135], v[36:39]
    ds_read_b128 a[40:43], v4 offset:36864
    v_mfma_f32_16x16x32_bf16 v[40:43], a[12:15], v[128:131], v[40:43]
    v_mfma_f32_16x16x32_bf16 v[44:47], a[12:15], v[132:135], v[44:47]
    ds_read_b128 a[44:47], v4 offset:38912
    s_waitcnt lgkmcnt(4)
    v_mfma_f32_16x16x32_bf16 v[48:51], a[16:19], v[128:131], v[48:51]
    v_mfma_f32_16x16x32_bf16 v[52:55], a[16:19], v[132:135], v[52:55]
    ds_read_b128 a[48:51], v4 offset:40960
    v_mfma_f32_16x16x32_bf16 v[56:59], a[20:23], v[128:131], v[56:59]
    v_mfma_f32_16x16x32_bf16 v[60:63], a[20:23], v[132:135], v[60:63]
    ds_read_b128 a[52:55], v4 offset:43008
    v_mfma_f32_16x16x32_bf16 v[64:67], a[24:27], v[128:131], v[64:67]
    v_mfma_f32_16x16x32_bf16 v[68:71], a[24:27], v[132:135], v[68:71]
    ds_read_b128 a[56:59], v4 offset:45056
    v_mfma_f32_16x16x32_bf16 v[72:75], a[28:31], v[128:131], v[72:75]
    v_mfma_f32_16x16x32_bf16 v[76:79], a[28:31], v[132:135], v[76:79]
    ds_read_b128 a[60:63], v4 offset:47104
    s_waitcnt vmcnt(16)
    s_barrier
    s_waitcnt lgkmcnt(4)
    v_mfma_f32_16x16x32_bf16 v[16:19], a[32:35], v[136:139], v[16:19]
    v_mfma_f32_16x16x32_bf16 v[20:23], a[32:35], v[140:143], v[20:23]
    ds_read_b128 a[0:3], v3 offset:49152
    s_add_u32 m0, s21, 16384
    v_mfma_f32_16x16x32_bf16 v[24:27], a[36:39], v[136:139], v[24:27]
    v_mfma_f32_16x16x32_bf16 v[28:31], a[36:39], v[140:143], v[28:31]
    ds_read_b128 a[4:7], v3 offset:51200
    s_add_u32 s64, s20, 0x300
    buffer_load_dwordx4 v2, s[4:7], s64 offen lds
    v_mfma_f32_16x16x32_bf16 v[32:35], a[40:43], v[136:139], v[32:35]
    v_mfma_f32_16x16x32_bf16 v[36:39], a[40:43], v[140:143], v[36:39]
    ds_read_b128 a[8:11], v3 offset:53248
    s_add_u32 m0, s21, 17408
    v_mfma_f32_16x16x32_bf16 v[40:43], a[44:47], v[136:139], v[40:43]
    v_mfma_f32_16x16x32_bf16 v[44:47], a[44:47], v[140:143], v[44:47]
    ds_read_b128 a[12:15], v3 offset:55296
    s_add_u32 s64, s20, 0x2b00
    buffer_load_dwordx4 v2, s[4:7], s64 offen lds
    s_waitcnt lgkmcnt(4)
    v_mfma_f32_16x16x32_bf16 v[48:51], a[48:51], v[136:139], v[48:51]
    v_mfma_f32_16x16x32_bf16 v[52:55], a[48:51], v[140:143], v[52:55]
    ds_read_b128 a[16:19], v3 offset:57344
    s_add_u32 m0, s21, 18432
    v_mfma_f32_16x16x32_bf16 v[56:59], a[52:55], v[136:139], v[56:59]
    v_mfma_f32_16x16x32_bf16 v[60:63], a[52:55], v[140:143], v[60:63]
    ds_read_b128 a[20:23], v3 offset:59392
    s_add_u32 s64, s20, 0x5300
    buffer_load_dwordx4 v2, s[4:7], s64 offen lds
    v_mfma_f32_16x16x32_bf16 v[64:67], a[56:59], v[136:139], v[64:67]
    v_mfma_f32_16x16x32_bf16 v[68:71], a[56:59], v[140:143], v[68:71]
    ds_read_b128 a[24:27], v3 offset:61440
    s_add_u32 m0, s21, 19456
    v_mfma_f32_16x16x32_bf16 v[72:75], a[60:63], v[136:139], v[72:75]
    v_mfma_f32_16x16x32_bf16 v[76:79], a[60:63], v[140:143], v[76:79]
    ds_read_b128 a[28:31], v3 offset:63488
    s_add_u32 s64, s20, 0x7b00
    buffer_load_dwordx4 v2, s[4:7], s64 offen lds
    s_waitcnt lgkmcnt(4)
    v_mfma_f32_16x16x32_bf16 v[16:19], a[0:3], v[144:147], v[16:19]
    v_mfma_f32_16x16x32_bf16 v[20:23], a[0:3], v[148:151], v[20:23]
    ds_read_b128 a[32:35], v4 offset:49152
    v_mfma_f32_16x16x32_bf16 v[24:27], a[4:7], v[144:147], v[24:27]
    v_mfma_f32_16x16x32_bf16 v[28:31], a[4:7], v[148:151], v[28:31]
    ds_read_b128 a[36:39], v4 offset:51200
    v_mfma_f32_16x16x32_bf16 v[32:35], a[8:11], v[144:147], v[32:35]
    v_mfma_f32_16x16x32_bf16 v[36:39], a[8:11], v[148:151], v[36:39]
    ds_read_b128 a[40:43], v4 offset:53248
    v_mfma_f32_16x16x32_bf16 v[40:43], a[12:15], v[144:147], v[40:43]
    v_mfma_f32_16x16x32_bf16 v[44:47], a[12:15], v[148:151], v[44:47]
    ds_read_b128 a[44:47], v4 offset:55296
    s_waitcnt lgkmcnt(4)
    v_mfma_f32_16x16x32_bf16 v[48:51], a[16:19], v[144:147], v[48:51]
    v_mfma_f32_16x16x32_bf16 v[52:55], a[16:19], v[148:151], v[52:55]
    ds_read_b128 a[48:51], v4 offset:57344
    v_mfma_f32_16x16x32_bf16 v[56:59], a[20:23], v[144:147], v[56:59]
    v_mfma_f32_16x16x32_bf16 v[60:63], a[20:23], v[148:151], v[60:63]
    ds_read_b128 a[52:55], v4 offset:59392
    v_mfma_f32_16x16x32_bf16 v[64:67], a[24:27], v[144:147], v[64:67]
    v_mfma_f32_16x16x32_bf16 v[68:71], a[24:27], v[148:151], v[68:71]
    ds_read_b128 a[56:59], v4 offset:61440
    v_mfma_f32_16x16x32_bf16 v[72:75], a[28:31], v[144:147], v[72:75]
    v_mfma_f32_16x16x32_bf16 v[76:79], a[28:31], v[148:151], v[76:79]
    ds_read_b128 a[60:63], v4 offset:63488
    s_waitcnt vmcnt(8)
    s_barrier
    s_cmp_lg_u32 s14, 0
    s_cbranch_scc1 GF_126
    v_mov_b32 v7, 1
    v_mov_b32 v8, 0
    s_mov_b64 exec, 1
    buffer_store_dword v7, v8, s[4:7], s23 offen sc1
    s_mov_b64 exec, -1
GF_126:
    s_waitcnt lgkmcnt(4)
    v_mfma_f32_16x16x32_bf16 v[16:19], a[32:35], v[152:155], v[16:19]
    v_mfma_f32_16x16x32_bf16 v[20:23], a[32:35], v[156:159], v[20:23]
    ds_read_b128 a[0:3], v6 offset:0
    s_add_u32 m0, s21, 32768
    v_mfma_f32_16x16x32_bf16 v[24:27], a[36:39], v[152:155], v[24:27]
    v_mfma_f32_16x16x32_bf16 v[28:31], a[36:39], v[156:159], v[28:31]
    ds_read_b128 a[4:7], v6 offset:2048
    s_add_u32 s64, s20, 0x380
    buffer_load_dwordx4 v2, s[4:7], s64 offen lds
    v_mfma_f32_16x16x32_bf16 v[32:35], a[40:43], v[152:155], v[32:35]
    v_mfma_f32_16x16x32_bf16 v[36:39], a[40:43], v[156:159], v[36:39]
    ds_read_b128 a[8:11], v6 offset:4096
    s_add_u32 m0, s21, 33792
    v_mfma_f32_16x16x32_bf16 v[40:43], a[44:47], v[152:155], v[40:43]
    v_mfma_f32_16x16x32_bf16 v[44:47], a[44:47], v[156:159], v[44:47]
    ds_read_b128 a[12:15], v6 offset:6144
    s_add_u32 s64, s20, 0x2b80
    buffer_load_dwordx4 v2, s[4:7], s64 offen lds
    s_waitcnt lgkmcnt(4)
    v_mfma_f32_16x16x32_bf16 v[48:51], a[48:51], v[152:155], v[48:51]
    v_mfma_f32_16x16x32_bf16 v[52:55], a[48:51], v[156:159], v[52:55]
    ds_read_b128 a[16:19], v6 offset:8192
    s_add_u32 m0, s21, 34816
    v_mfma_f32_16x16x32_bf16 v[56:59], a[52:55], v[152:155], v[56:59]
    v_mfma_f32_16x16x32_bf16 v[60:63], a[52:55], v[156:159], v[60:63]
    ds_read_b128 a[20:23], v6 offset:10240
    s_add_u32 s64, s20, 0x5380
    buffer_load_dwordx4 v2, s[4:7], s64 offen lds
    v_mfma_f32_16x16x32_bf16 v[64:67], a[56:59], v[152:155], v[64:67]
    v_mfma_f32_16x16x32_bf16 v[68:71], a[56:59], v[156:159], v[68:71]
    ds_read_b128 a[24:27], v6 offset:12288
    s_add_u32 m0, s21, 35840
    v_mfma_f32_16x16x32_bf16 v[72:75], a[60:63], v[152:155], v[72:75]
    v_mfma_f32_16x16x32_bf16 v[76:79], a[60:63], v[156:159], v[76:79]
    ds_read_b128 a[28:31], v6 offset:14336
    s_add_u32 s64, s20, 0x7b80
    buffer_load_dwordx4 v2, s[4:7], s64 offen lds
    s_waitcnt lgkmcnt(4)
    v_mfma_f32_16x16x32_bf16 v[16:19], a[0:3], v[160:163], v[16:19]
    v_mfma_f32_16x16x32_bf16 v[20:23], a[0:3], v[164:167], v[20:23]
    ds_read_b128 a[32:35], v9 offset:0
    v_mfma_f32_16x16x32_bf16 v[24:27], a[4:7], v[160:163], v[24:27]
    v_mfma_f32_16x16x32_bf16 v[28:31], a[4:7], v[164:167], v[28:31]
    ds_read_b128 a[36:39], v9 offset:2048
    v_mfma_f32_16x16x32_bf16 v[32:35], a[8:11], v[160:163], v[32:35]
    v_mfma_f32_16x16x32_bf16 v[36:39], a[8:11], v[164:167], v[36:39]
    ds_read_b128 a[40:43], v9 offset:4096
    v_mfma_f32_16x16x32_bf16 v[40:43], a[12:15], v[160:163], v[40:43]
    v_mfma_f32_16x16x32_bf16 v[44:47], a[12:15], v[164:167], v[44:47]
    ds_read_b128 a[44:47], v9 offset:6144
    s_waitcnt lgkmcnt(4)
    v_mfma_f32_16x16x32_bf16 v[48:51], a[16:19], v[160:163], v[48:51]
    v_mfma_f32_16x16x32_bf16 v[52:55], a[16:19], v[164:167], v[52:55]
    ds_read_b128 a[48:51], v9 offset:8192
    v_mfma_f32_16x16x32_bf16 v[56:59], a[20:23], v[160:163], v[56:59]
    v_mfma_f32_16x16x32_bf16 v[60:63], a[20:23], v[164:167], v[60:63]
    ds_read_b128 a[52:55], v9 offset:10240
    v_mfma_f32_16x16x32_bf16 v[64:67], a[24:27], v[160:163], v[64:67]
    v_mfma_f32_16x16x32_bf16 v[68:71], a[24:27], v[164:167], v[68:71]
    ds_read_b128 a[56:59], v9 offset:12288
    v_mfma_f32_16x16x32_bf16 v[72:75], a[28:31], v[160:163], v[72:75]
    v_mfma_f32_16x16x32_bf16 v[76:79], a[28:31], v[164:167], v[76:79]
    ds_read_b128 a[60:63], v9 offset:14336
    s_waitcnt vmcnt(8)
    s_barrier
    s_waitcnt lgkmcnt(4)
    v_mfma_f32_16x16x32_bf16 v[16:19], a[32:35], v[168:171], v[16:19]
    v_mfma_f32_16x16x32_bf16 v[20:23], a[32:35], v[172:175], v[20:23]
    ds_read_b128 a[0:3], v3 offset:0
    s_add_u32 m0, s21, 49152
    v_mfma_f32_16x16x32_bf16 v[24:27], a[36:39], v[168:171], v[24:27]
    v_mfma_f32_16x16x32_bf16 v[28:31], a[36:39], v[172:175], v[28:31]
    ds_read_b128 a[4:7], v3 offset:2048
    s_add_u32 s64, s20, 0x400
    buffer_load_dwordx4 v2, s[4:7], s64 offen lds
    v_mfma_f32_16x16x32_bf16 v[32:35], a[40:43], v[168:171], v[32:35]
    v_mfma_f32_16x16x32_bf16 v[36:39], a[40:43], v[172:175], v[36:39]
    ds_read_b128 a[8:11], v3 offset:4096
    s_add_u32 m0, s21, 50176
    v_mfma_f32_16x16x32_bf16 v[40:43], a[44:47], v[168:171], v[40:43]
    v_mfma_f32_16x16x32_bf16 v[44:47], a[44:47], v[172:175], v[44:47]
    ds_read_b128 a[12:15], v3 offset:6144
    s_add_u32 s64, s20, 0x2c00
    buffer_load_dwordx4 v2, s[4:7], s64 offen lds
    s_waitcnt lgkmcnt(4)
    v_mfma_f32_16x16x32_bf16 v[48:51], a[48:51], v[168:171], v[48:51]
    v_mfma_f32_16x16x32_bf16 v[52:55], a[48:51], v[172:175], v[52:55]
    ds_read_b128 a[16:19], v3 offset:8192
    s_add_u32 m0, s21, 51200
    v_mfma_f32_16x16x32_bf16 v[56:59], a[52:55], v[168:171], v[56:59]
    v_mfma_f32_16x16x32_bf16 v[60:63], a[52:55], v[172:175], v[60:63]
    ds_read_b128 a[20:23], v3 offset:10240
    s_add_u32 s64, s20, 0x5400
    buffer_load_dwordx4 v2, s[4:7], s64 offen lds
    v_mfma_f32_16x16x32_bf16 v[64:67], a[56:59], v[168:171], v[64:67]
    v_mfma_f32_16x16x32_bf16 v[68:71], a[56:59], v[172:175], v[68:71]
    ds_read_b128 a[24:27], v3 offset:12288
    s_add_u32 m0, s21, 52224
    v_mfma_f32_16x16x32_bf16 v[72:75], a[60:63], v[168:171], v[72:75]
    v_mfma_f32_16x16x32_bf16 v[76:79], a[60:63], v[172:175], v[76:79]
    ds_read_b128 a[28:31], v3 offset:14336
    s_add_u32 s64, s20, 0x7c00
    buffer_load_dwordx4 v2, s[4:7], s64 offen lds
    s_waitcnt lgkmcnt(4)
    v_mfma_f32_16x16x32_bf16 v[16:19], a[0:3], v[176:179], v[16:19]
    v_mfma_f32_16x16x32_bf16 v[20:23], a[0:3], v[180:183], v[20:23]
    ds_read_b128 a[32:35], v4 offset:0
    v_mfma_f32_16x16x32_bf16 v[24:27], a[4:7], v[176:179], v[24:27]
    v_mfma_f32_16x16x32_bf16 v[28:31], a[4:7], v[180:183], v[28:31]
    ds_read_b128 a[36:39], v4 offset:2048
    v_mfma_f32_16x16x32_bf16 v[32:35], a[8:11], v[176:179], v[32:35]
    v_mfma_f32_16x16x32_bf16 v[36:39], a[8:11], v[180:183], v[36:39]
    ds_read_b128 a[40:43], v4 offset:4096
    v_mfma_f32_16x16x32_bf16 v[40:43], a[12:15], v[176:179], v[40:43]
    v_mfma_f32_16x16x32_bf16 v[44:47], a[12:15], v[180:183], v[44:47]
    ds_read_b128 a[44:47], v4 offset:6144
    s_waitcnt lgkmcnt(4)
    v_mfma_f32_16x16x32_bf16 v[48:51], a[16:19], v[176:179], v[48:51]
    v_mfma_f32_16x16x32_bf16 v[52:55], a[16:19], v[180:183], v[52:55]
    ds_read_b128 a[48:51], v4 offset:8192
    v_mfma_f32_16x16x32_bf16 v[56:59], a[20:23], v[176:179], v[56:59]
    v_mfma_f32_16x16x32_bf16 v[60:63], a[20:23], v[180:183], v[60:63]
    ds_read_b128 a[52:55], v4 offset:10240
    v_mfma_f32_16x16x32_bf16 v[64:67], a[24:27], v[176:179], v[64:67]
    v_mfma_f32_16x16x32_bf16 v[68:71], a[24:27], v[180:183], v[68:71]
    ds_read_b128 a[56:59], v4 offset:12288
    v_mfma_f32_16x16x32_bf16 v[72:75], a[28:31], v[176:179], v[72:75]
    v_mfma_f32_16x16x32_bf16 v[76:79], a[28:31], v[180:183], v[76:79]
    ds_read_b128 a[60:63], v4 offset:14336
    s_waitcnt vmcnt(8)
    s_barrier
    s_waitcnt lgkmcnt(4)
    v_mfma_f32_16x16x32_bf16 v[16:19], a[32:35], v[184:187], v[16:19]
    v_mfma_f32_16x16x32_bf16 v[20:23], a[32:35], v[188:191], v[20:23]
    ds_read_b128 a[0:3], v3 offset:16384
    s_add_u32 m0, s21, 65536
    v_mfma_f32_16x16x32_bf16 v[24:27], a[36:39], v[184:187], v[24:27]
    v_mfma_f32_16x16x32_bf16 v[28:31], a[36:39], v[188:191], v[28:31]
    ds_read_b128 a[4:7], v3 offset:18432
    s_add_u32 s64, s20, 0x480
    buffer_load_dwordx4 v2, s[4:7], s64 offen lds
    v_mfma_f32_16x16x32_bf16 v[32:35], a[40:43], v[184:187], v[32:35]
    v_mfma_f32_16x16x32_bf16 v[36:39], a[40:43], v[188:191], v[36:39]
    ds_read_b128 a[8:11], v3 offset:20480
    s_add_u32 m0, s21, 66560
    v_mfma_f32_16x16x32_bf16 v[40:43], a[44:47], v[184:187], v[40:43]
    v_mfma_f32_16x16x32_bf16 v[44:47], a[44:47], v[188:191], v[44:47]
    ds_read_b128 a[12:15], v3 offset:22528
    s_add_u32 s64, s20, 0x2c80
    buffer_load_dwordx4 v2, s[4:7], s64 offen lds
    s_waitcnt lgkmcnt(4)
    v_mfma_f32_16x16x32_bf16 v[48:51], a[48:51], v[184:187], v[48:51]
    v_mfma_f32_16x16x32_bf16 v[52:55], a[48:51], v[188:191], v[52:55]
    ds_read_b128 a[16:19], v3 offset:24576
    s_add_u32 m0, s21, 67584
    v_mfma_f32_16x16x32_bf16 v[56:59], a[52:55], v[184:187], v[56:59]
    v_mfma_f32_16x16x32_bf16 v[60:63], a[52:55], v[188:191], v[60:63]
    ds_read_b128 a[20:23], v3 offset:26624
    s_add_u32 s64, s20, 0x5480
    buffer_load_dwordx4 v2, s[4:7], s64 offen lds
    v_mfma_f32_16x16x32_bf16 v[64:67], a[56:59], v[184:187], v[64:67]
    v_mfma_f32_16x16x32_bf16 v[68:71], a[56:59], v[188:191], v[68:71]
    ds_read_b128 a[24:27], v3 offset:28672
    s_add_u32 m0, s21, 68608
    v_mfma_f32_16x16x32_bf16 v[72:75], a[60:63], v[184:187], v[72:75]
    v_mfma_f32_16x16x32_bf16 v[76:79], a[60:63], v[188:191], v[76:79]
    ds_read_b128 a[28:31], v3 offset:30720
    s_add_u32 s64, s20, 0x7c80
    buffer_load_dwordx4 v2, s[4:7], s64 offen lds
    s_waitcnt lgkmcnt(4)
    v_mfma_f32_16x16x32_bf16 v[16:19], a[0:3], v[192:195], v[16:19]
    v_mfma_f32_16x16x32_bf16 v[20:23], a[0:3], v[196:199], v[20:23]
    ds_read_b128 a[32:35], v4 offset:16384
    v_mfma_f32_16x16x32_bf16 v[24:27], a[4:7], v[192:195], v[24:27]
    v_mfma_f32_16x16x32_bf16 v[28:31], a[4:7], v[196:199], v[28:31]
    ds_read_b128 a[36:39], v4 offset:18432
    v_mfma_f32_16x16x32_bf16 v[32:35], a[8:11], v[192:195], v[32:35]
    v_mfma_f32_16x16x32_bf16 v[36:39], a[8:11], v[196:199], v[36:39]
    ds_read_b128 a[40:43], v4 offset:20480
    v_mfma_f32_16x16x32_bf16 v[40:43], a[12:15], v[192:195], v[40:43]
    v_mfma_f32_16x16x32_bf16 v[44:47], a[12:15], v[196:199], v[44:47]
    ds_read_b128 a[44:47], v4 offset:22528
    s_waitcnt lgkmcnt(4)
    v_mfma_f32_16x16x32_bf16 v[48:51], a[16:19], v[192:195], v[48:51]
    v_mfma_f32_16x16x32_bf16 v[52:55], a[16:19], v[196:199], v[52:55]
    ds_read_b128 a[48:51], v4 offset:24576
    v_mfma_f32_16x16x32_bf16 v[56:59], a[20:23], v[192:195], v[56:59]
    v_mfma_f32_16x16x32_bf16 v[60:63], a[20:23], v[196:199], v[60:63]
    ds_read_b128 a[52:55], v4 offset:26624
    v_mfma_f32_16x16x32_bf16 v[64:67], a[24:27], v[192:195], v[64:67]
    v_mfma_f32_16x16x32_bf16 v[68:71], a[24:27], v[196:199], v[68:71]
    ds_read_b128 a[56:59], v4 offset:28672
    v_mfma_f32_16x16x32_bf16 v[72:75], a[28:31], v[192:195], v[72:75]
    v_mfma_f32_16x16x32_bf16 v[76:79], a[28:31], v[196:199], v[76:79]
    ds_read_b128 a[60:63], v4 offset:30720
    s_waitcnt vmcnt(8)
    s_barrier
    s_waitcnt lgkmcnt(4)
    v_mfma_f32_16x16x32_bf16 v[16:19], a[32:35], v[200:203], v[16:19]
    v_mfma_f32_16x16x32_bf16 v[20:23], a[32:35], v[204:207], v[20:23]
    ds_read_b128 a[0:3], v3 offset:32768
    s_add_u32 m0, s21, 0
    v_mfma_f32_16x16x32_bf16 v[24:27], a[36:39], v[200:203], v[24:27]
    v_mfma_f32_16x16x32_bf16 v[28:31], a[36:39], v[204:207], v[28:31]
    ds_read_b128 a[4:7], v3 offset:34816
    s_add_u32 s64, s20, 0x50000
    buffer_load_dwordx4 v2, s[4:7], s64 offen lds
    v_mfma_f32_16x16x32_bf16 v[32:35], a[40:43], v[200:203], v[32:35]
    v_mfma_f32_16x16x32_bf16 v[36:39], a[40:43], v[204:207], v[36:39]
    ds_read_b128 a[8:11], v3 offset:36864
    s_add_u32 m0, s21, 1024
    v_mfma_f32_16x16x32_bf16 v[40:43], a[44:47], v[200:203], v[40:43]
    v_mfma_f32_16x16x32_bf16 v[44:47], a[44:47], v[204:207], v[44:47]
    ds_read_b128 a[12:15], v3 offset:38912
    s_add_u32 s64, s20, 0x52800
    buffer_load_dwordx4 v2, s[4:7], s64 offen lds
    s_waitcnt lgkmcnt(4)
    v_mfma_f32_16x16x32_bf16 v[48:51], a[48:51], v[200:203], v[48:51]
    v_mfma_f32_16x16x32_bf16 v[52:55], a[48:51], v[204:207], v[52:55]
    ds_read_b128 a[16:19], v3 offset:40960
    s_add_u32 m0, s21, 2048
    v_mfma_f32_16x16x32_bf16 v[56:59], a[52:55], v[200:203], v[56:59]
    v_mfma_f32_16x16x32_bf16 v[60:63], a[52:55], v[204:207], v[60:63]
    ds_read_b128 a[20:23], v3 offset:43008
    s_add_u32 s64, s20, 0x55000
    buffer_load_dwordx4 v2, s[4:7], s64 offen lds
    v_mfma_f32_16x16x32_bf16 v[64:67], a[56:59], v[200:203], v[64:67]
    v_mfma_f32_16x16x32_bf16 v[68:71], a[56:59], v[204:207], v[68:71]
    ds_read_b128 a[24:27], v3 offset:45056
    s_add_u32 m0, s21, 3072
    v_mfma_f32_16x16x32_bf16 v[72:75], a[60:63], v[200:203], v[72:75]
    v_mfma_f32_16x16x32_bf16 v[76:79], a[60:63], v[204:207], v[76:79]
    ds_read_b128 a[28:31], v3 offset:47104
    s_add_u32 s64, s20, 0x57800
    buffer_load_dwordx4 v2, s[4:7], s64 offen lds
    s_waitcnt lgkmcnt(4)
    v_mfma_f32_16x16x32_bf16 v[16:19], a[0:3], v[208:211], v[16:19]
    v_mfma_f32_16x16x32_bf16 v[20:23], a[0:3], v[212:215], v[20:23]
    ds_read_b128 a[32:35], v4 offset:32768
    v_mfma_f32_16x16x32_bf16 v[24:27], a[4:7], v[208:211], v[24:27]
    v_mfma_f32_16x16x32_bf16 v[28:31], a[4:7], v[212:215], v[28:31]
    ds_read_b128 a[36:39], v4 offset:34816
    v_mfma_f32_16x16x32_bf16 v[32:35], a[8:11], v[208:211], v[32:35]
    v_mfma_f32_16x16x32_bf16 v[36:39], a[8:11], v[212:215], v[36:39]
    ds_read_b128 a[40:43], v4 offset:36864
    v_mfma_f32_16x16x32_bf16 v[40:43], a[12:15], v[208:211], v[40:43]
    v_mfma_f32_16x16x32_bf16 v[44:47], a[12:15], v[212:215], v[44:47]
    ds_read_b128 a[44:47], v4 offset:38912
    s_waitcnt lgkmcnt(4)
    v_mfma_f32_16x16x32_bf16 v[48:51], a[16:19], v[208:211], v[48:51]
    v_mfma_f32_16x16x32_bf16 v[52:55], a[16:19], v[212:215], v[52:55]
    ds_read_b128 a[48:51], v4 offset:40960
    v_mfma_f32_16x16x32_bf16 v[56:59], a[20:23], v[208:211], v[56:59]
    v_mfma_f32_16x16x32_bf16 v[60:63], a[20:23], v[212:215], v[60:63]
    ds_read_b128 a[52:55], v4 offset:43008
    v_mfma_f32_16x16x32_bf16 v[64:67], a[24:27], v[208:211], v[64:67]
    v_mfma_f32_16x16x32_bf16 v[68:71], a[24:27], v[212:215], v[68:71]
    ds_read_b128 a[56:59], v4 offset:45056
    v_mfma_f32_16x16x32_bf16 v[72:75], a[28:31], v[208:211], v[72:75]
    v_mfma_f32_16x16x32_bf16 v[76:79], a[28:31], v[212:215], v[76:79]
    ds_read_b128 a[60:63], v4 offset:47104
    s_waitcnt vmcnt(8)
    s_barrier
    s_waitcnt lgkmcnt(4)
    v_mfma_f32_16x16x32_bf16 v[16:19], a[32:35], v[216:219], v[16:19]
    v_mfma_f32_16x16x32_bf16 v[20:23], a[32:35], v[220:223], v[20:23]
    ds_read_b128 a[0:3], v3 offset:49152
    s_add_u32 m0, s21, 16384
    v_mfma_f32_16x16x32_bf16 v[24:27], a[36:39], v[216:219], v[24:27]
    v_mfma_f32_16x16x32_bf16 v[28:31], a[36:39], v[220:223], v[28:31]
    ds_read_b128 a[4:7], v3 offset:51200
    s_add_u32 s64, s20, 0x50080
    buffer_load_dwordx4 v2, s[4:7], s64 offen lds
    v_mfma_f32_16x16x32_bf16 v[32:35], a[40:43], v[216:219], v[32:35]
    v_mfma_f32_16x16x32_bf16 v[36:39], a[40:43], v[220:223], v[36:39]
    ds_read_b128 a[8:11], v3 offset:53248
    s_add_u32 m0, s21, 17408
    v_mfma_f32_16x16x32_bf16 v[40:43], a[44:47], v[216:219], v[40:43]
    v_mfma_f32_16x16x32_bf16 v[44:47], a[44:47], v[220:223], v[44:47]
    ds_read_b128 a[12:15], v3 offset:55296
    s_add_u32 s64, s20, 0x52880
    buffer_load_dwordx4 v2, s[4:7], s64 offen lds
    s_waitcnt lgkmcnt(4)
    v_mfma_f32_16x16x32_bf16 v[48:51], a[48:51], v[216:219], v[48:51]
    v_mfma_f32_16x16x32_bf16 v[52:55], a[48:51], v[220:223], v[52:55]
    ds_read_b128 a[16:19], v3 offset:57344
    s_add_u32 m0, s21, 18432
    v_mfma_f32_16x16x32_bf16 v[56:59], a[52:55], v[216:219], v[56:59]
    v_mfma_f32_16x16x32_bf16 v[60:63], a[52:55], v[220:223], v[60:63]
    ds_read_b128 a[20:23], v3 offset:59392
    s_add_u32 s64, s20, 0x55080
    buffer_load_dwordx4 v2, s[4:7], s64 offen lds
    v_mfma_f32_16x16x32_bf16 v[64:67], a[56:59], v[216:219], v[64:67]
    v_mfma_f32_16x16x32_bf16 v[68:71], a[56:59], v[220:223], v[68:71]
    ds_read_b128 a[24:27], v3 offset:61440
    s_add_u32 m0, s21, 19456
    v_mfma_f32_16x16x32_bf16 v[72:75], a[60:63], v[216:219], v[72:75]
    v_mfma_f32_16x16x32_bf16 v[76:79], a[60:63], v[220:223], v[76:79]
    ds_read_b128 a[28:31], v3 offset:63488
    s_add_u32 s64, s20, 0x57880
    buffer_load_dwordx4 v2, s[4:7], s64 offen lds
    s_waitcnt lgkmcnt(4)
    v_mfma_f32_16x16x32_bf16 v[16:19], a[0:3], v[224:227], v[16:19]
    v_mfma_f32_16x16x32_bf16 v[20:23], a[0:3], v[228:231], v[20:23]
    ds_read_b128 a[32:35], v4 offset:49152
    v_mfma_f32_16x16x32_bf16 v[24:27], a[4:7], v[224:227], v[24:27]
    v_mfma_f32_16x16x32_bf16 v[28:31], a[4:7], v[228:231], v[28:31]
    ds_read_b128 a[36:39], v4 offset:51200
    v_mfma_f32_16x16x32_bf16 v[32:35], a[8:11], v[224:227], v[32:35]
    v_mfma_f32_16x16x32_bf16 v[36:39], a[8:11], v[228:231], v[36:39]
    ds_read_b128 a[40:43], v4 offset:53248
    v_mfma_f32_16x16x32_bf16 v[40:43], a[12:15], v[224:227], v[40:43]
    v_mfma_f32_16x16x32_bf16 v[44:47], a[12:15], v[228:231], v[44:47]
    ds_read_b128 a[44:47], v4 offset:55296
    s_waitcnt lgkmcnt(4)
    v_mfma_f32_16x16x32_bf16 v[48:51], a[16:19], v[224:227], v[48:51]
    v_mfma_f32_16x16x32_bf16 v[52:55], a[16:19], v[228:231], v[52:55]
    ds_read_b128 a[48:51], v4 offset:57344
    v_mfma_f32_16x16x32_bf16 v[56:59], a[20:23], v[224:227], v[56:59]
    v_mfma_f32_16x16x32_bf16 v[60:63], a[20:23], v[228:231], v[60:63]
    ds_read_b128 a[52:55], v4 offset:59392
    v_mfma_f32_16x16x32_bf16 v[64:67], a[24:27], v[224:227], v[64:67]
    v_mfma_f32_16x16x32_bf16 v[68:71], a[24:27], v[228:231], v[68:71]
    ds_read_b128 a[56:59], v4 offset:61440
    v_mfma_f32_16x16x32_bf16 v[72:75], a[28:31], v[224:227], v[72:75]
    v_mfma_f32_16x16x32_bf16 v[76:79], a[28:31], v[228:231], v[76:79]
    ds_read_b128 a[60:63], v4 offset:63488
    s_waitcnt vmcnt(8)
    s_barrier
    s_waitcnt lgkmcnt(4)
    v_mfma_f32_16x16x32_bf16 v[16:19], a[32:35], v[232:235], v[16:19]
    v_mfma_f32_16x16x32_bf16 v[20:23], a[32:35], v[236:239], v[20:23]
    ds_read_b128 a[0:3], v6 offset:0
    s_add_u32 m0, s21, 32768
    v_mfma_f32_16x16x32_bf16 v[24:27], a[36:39], v[232:235], v[24:27]
    v_mfma_f32_16x16x32_bf16 v[28:31], a[36:39], v[236:239], v[28:31]
    ds_read_b128 a[4:7], v6 offset:2048
    s_add_u32 s64, s20, 0x50100
    buffer_load_dwordx4 v2, s[4:7], s64 offen lds
    v_mfma_f32_16x16x32_bf16 v[32:35], a[40:43], v[232:235], v[32:35]
    v_mfma_f32_16x16x32_bf16 v[36:39], a[40:43], v[236:239], v[36:39]
    ds_read_b128 a[8:11], v6 offset:4096
    s_add_u32 m0, s21, 33792
    v_mfma_f32_16x16x32_bf16 v[40:43], a[44:47], v[232:235], v[40:43]
    v_mfma_f32_16x16x32_bf16 v[44:47], a[44:47], v[236:239], v[44:47]
    ds_read_b128 a[12:15], v6 offset:6144
    s_add_u32 s64, s20, 0x52900
    buffer_load_dwordx4 v2, s[4:7], s64 offen lds
    s_waitcnt lgkmcnt(4)
    v_mfma_f32_16x16x32_bf16 v[48:51], a[48:51], v[232:235], v[48:51]
    v_mfma_f32_16x16x32_bf16 v[52:55], a[48:51], v[236:239], v[52:55]
    ds_read_b128 a[16:19], v6 offset:8192
    s_add_u32 m0, s21, 34816
    v_mfma_f32_16x16x32_bf16 v[56:59], a[52:55], v[232:235], v[56:59]
    v_mfma_f32_16x16x32_bf16 v[60:63], a[52:55], v[236:239], v[60:63]
    ds_read_b128 a[20:23], v6 offset:10240
    s_add_u32 s64, s20, 0x55100
    buffer_load_dwordx4 v2, s[4:7], s64 offen lds
    v_mfma_f32_16x16x32_bf16 v[64:67], a[56:59], v[232:235], v[64:67]
    v_mfma_f32_16x16x32_bf16 v[68:71], a[56:59], v[236:239], v[68:71]
    ds_read_b128 a[24:27], v6 offset:12288
    s_add_u32 m0, s21, 35840
    v_mfma_f32_16x16x32_bf16 v[72:75], a[60:63], v[232:235], v[72:75]
    v_mfma_f32_16x16x32_bf16 v[76:79], a[60:63], v[236:239], v[76:79]
    ds_read_b128 a[28:31], v6 offset:14336
    s_add_u32 s64, s20, 0x57900
    buffer_load_dwordx4 v2, s[4:7], s64 offen lds
    s_waitcnt lgkmcnt(4)
    v_mfma_f32_16x16x32_bf16 v[16:19], a[0:3], v[240:243], v[16:19]
    v_mfma_f32_16x16x32_bf16 v[20:23], a[0:3], v[244:247], v[20:23]
    ds_read_b128 a[32:35], v9 offset:0
    v_mfma_f32_16x16x32_bf16 v[24:27], a[4:7], v[240:243], v[24:27]
    v_mfma_f32_16x16x32_bf16 v[28:31], a[4:7], v[244:247], v[28:31]
    ds_read_b128 a[36:39], v9 offset:2048
    v_mfma_f32_16x16x32_bf16 v[32:35], a[8:11], v[240:243], v[32:35]
    v_mfma_f32_16x16x32_bf16 v[36:39], a[8:11], v[244:247], v[36:39]
    ds_read_b128 a[40:43], v9 offset:4096
    v_mfma_f32_16x16x32_bf16 v[40:43], a[12:15], v[240:243], v[40:43]
    v_mfma_f32_16x16x32_bf16 v[44:47], a[12:15], v[244:247], v[44:47]
    ds_read_b128 a[44:47], v9 offset:6144
    s_waitcnt lgkmcnt(4)
    v_mfma_f32_16x16x32_bf16 v[48:51], a[16:19], v[240:243], v[48:51]
    v_mfma_f32_16x16x32_bf16 v[52:55], a[16:19], v[244:247], v[52:55]
    ds_read_b128 a[48:51], v9 offset:8192
    v_mfma_f32_16x16x32_bf16 v[56:59], a[20:23], v[240:243], v[56:59]
    v_mfma_f32_16x16x32_bf16 v[60:63], a[20:23], v[244:247], v[60:63]
    ds_read_b128 a[52:55], v9 offset:10240
    v_mfma_f32_16x16x32_bf16 v[64:67], a[24:27], v[240:243], v[64:67]
    v_mfma_f32_16x16x32_bf16 v[68:71], a[24:27], v[244:247], v[68:71]
    ds_read_b128 a[56:59], v9 offset:12288
    v_mfma_f32_16x16x32_bf16 v[72:75], a[28:31], v[240:243], v[72:75]
    v_mfma_f32_16x16x32_bf16 v[76:79], a[28:31], v[244:247], v[76:79]
    ds_read_b128 a[60:63], v9 offset:14336
    s_waitcnt vmcnt(8)
    s_barrier
    s_waitcnt lgkmcnt(4)
    v_mfma_f32_16x16x32_bf16 v[16:19], a[32:35], v[248:251], v[16:19]
    v_mfma_f32_16x16x32_bf16 v[20:23], a[32:35], v[252:255], v[20:23]
    ds_read_b128 a[0:3], v3 offset:0
    s_add_u32 m0, s21, 49152
    v_mfma_f32_16x16x32_bf16 v[24:27], a[36:39], v[248:251], v[24:27]
    v_mfma_f32_16x16x32_bf16 v[28:31], a[36:39], v[252:255], v[28:31]
    ds_read_b128 a[4:7], v3 offset:2048
    s_add_u32 s64, s20, 0x50180
    buffer_load_dwordx4 v2, s[4:7], s64 offen lds
    v_mfma_f32_16x16x32_bf16 v[32:35], a[40:43], v[248:251], v[32:35]
    v_mfma_f32_16x16x32_bf16 v[36:39], a[40:43], v[252:255], v[36:39]
    ds_read_b128 a[8:11], v3 offset:4096
    s_add_u32 m0, s21, 50176
    v_mfma_f32_16x16x32_bf16 v[40:43], a[44:47], v[248:251], v[40:43]
    v_mfma_f32_16x16x32_bf16 v[44:47], a[44:47], v[252:255], v[44:47]
    ds_read_b128 a[12:15], v3 offset:6144
    s_add_u32 s64, s20, 0x52980
    buffer_load_dwordx4 v2, s[4:7], s64 offen lds
    s_waitcnt lgkmcnt(4)
    v_mfma_f32_16x16x32_bf16 v[48:51], a[48:51], v[248:251], v[48:51]
    v_mfma_f32_16x16x32_bf16 v[52:55], a[48:51], v[252:255], v[52:55]
    ds_read_b128 a[16:19], v3 offset:8192
    s_add_u32 m0, s21, 51200
    v_mfma_f32_16x16x32_bf16 v[56:59], a[52:55], v[248:251], v[56:59]
    v_mfma_f32_16x16x32_bf16 v[60:63], a[52:55], v[252:255], v[60:63]
    ds_read_b128 a[20:23], v3 offset:10240
    s_add_u32 s64, s20, 0x55180
    buffer_load_dwordx4 v2, s[4:7], s64 offen lds
    v_mfma_f32_16x16x32_bf16 v[64:67], a[56:59], v[248:251], v[64:67]
    v_mfma_f32_16x16x32_bf16 v[68:71], a[56:59], v[252:255], v[68:71]
    ds_read_b128 a[24:27], v3 offset:12288
    s_add_u32 m0, s21, 52224
    v_mfma_f32_16x16x32_bf16 v[72:75], a[60:63], v[248:251], v[72:75]
    v_mfma_f32_16x16x32_bf16 v[76:79], a[60:63], v[252:255], v[76:79]
    ds_read_b128 a[28:31], v3 offset:14336
    s_add_u32 s64, s20, 0x57980
    buffer_load_dwordx4 v2, s[4:7], s64 offen lds
    s_nop 5
    s_mul_i32 s65, s17, 0
    s_add_u32 s65, s65, s22
    s_add_u32 s64, s65, 0
    v_cvt_pk_bf16_f32 v80, v16, v17
    v_cvt_pk_bf16_f32 v81, v18, v19
    v_cvt_pk_bf16_f32 v82, v24, v25
    v_cvt_pk_bf16_f32 v83, v26, v27
    buffer_store_dwordx4 v[80:83], v1, s[4:7], s64 offen sc1
    s_add_u32 s64, s65, 1024
    v_cvt_pk_bf16_f32 v84, v20, v21
    v_cvt_pk_bf16_f32 v85, v22, v23
    v_cvt_pk_bf16_f32 v86, v28, v29
    v_cvt_pk_bf16_f32 v87, v30, v31
    buffer_store_dwordx4 v[84:87], v1, s[4:7], s64 offen sc1
    s_mul_i32 s65, s17, 1
    s_add_u32 s65, s65, s22
    s_add_u32 s64, s65, 0
    v_cvt_pk_bf16_f32 v88, v32, v33
    v_cvt_pk_bf16_f32 v89, v34, v35
    v_cvt_pk_bf16_f32 v90, v40, v41
    v_cvt_pk_bf16_f32 v91, v42, v43
    buffer_store_dwordx4 v[88:91], v1, s[4:7], s64 offen sc1
    s_add_u32 s64, s65, 1024
    v_cvt_pk_bf16_f32 v92, v36, v37
    v_cvt_pk_bf16_f32 v93, v38, v39
    v_cvt_pk_bf16_f32 v94, v44, v45
    v_cvt_pk_bf16_f32 v95, v46, v47
    buffer_store_dwordx4 v[92:95], v1, s[4:7], s64 offen sc1
    s_mul_i32 s65, s17, 2
    s_add_u32 s65, s65, s22
    s_add_u32 s64, s65, 0
    v_cvt_pk_bf16_f32 v80, v48, v49
    v_cvt_pk_bf16_f32 v81, v50, v51
    v_cvt_pk_bf16_f32 v82, v56, v57
    v_cvt_pk_bf16_f32 v83, v58, v59
    buffer_store_dwordx4 v[80:83], v1, s[4:7], s64 offen sc1
    s_add_u32 s64, s65, 1024
    v_cvt_pk_bf16_f32 v84, v52, v53
    v_cvt_pk_bf16_f32 v85, v54, v55
    v_cvt_pk_bf16_f32 v86, v60, v61
    v_cvt_pk_bf16_f32 v87, v62, v63
    buffer_store_dwordx4 v[84:87], v1, s[4:7], s64 offen sc1
    s_mul_i32 s65, s17, 3
    s_add_u32 s65, s65, s22
    s_add_u32 s64, s65, 0
    v_cvt_pk_bf16_f32 v88, v64, v65
    v_cvt_pk_bf16_f32 v89, v66, v67
    v_cvt_pk_bf16_f32 v90, v72, v73
    v_cvt_pk_bf16_f32 v91, v74, v75
    buffer_store_dwordx4 v[88:91], v1, s[4:7], s64 offen sc1
    s_add_u32 s64, s65, 1024
    v_cvt_pk_bf16_f32 v92, v68, v69
    v_cvt_pk_bf16_f32 v93, v70, v71
    v_cvt_pk_bf16_f32 v94, v76, v77
    v_cvt_pk_bf16_f32 v95, v78, v79
    buffer_store_dwordx4 v[92:95], v1, s[4:7], s64 offen sc1
    s_lshl_b32 s64, s19, 1
    s_add_u32 s64, s64, s12
    s_lshl_b32 s64, s64, 9
    s_add_u32 s23, s18, s64
    s_lshl_b32 s64, s17, 3
    s_add_u32 s22, s22, s64
    s_add_u32 s19, s19, 1
    s_add_u32 s20, s20, 0x50000
    s_cmp_lt_u32 s19, 8
    s_cbranch_scc1 G_N_LOOP
    s_waitcnt vmcnt(0) lgkmcnt(0)
    s_barrier
    s_cmp_lg_u32 s14, 0
    s_cbranch_scc1 GF_127
    v_mov_b32 v7, 1
    v_mov_b32 v8, 0
    s_mov_b64 exec, 1
    buffer_store_dword v7, v8, s[4:7], s23 offen sc1
    s_mov_b64 exec, -1
GF_127:
    s_cmp_eq_u32 s12, 1
    s_cbranch_scc1 H_OUT
    s_lshl_b32 s88, s3, 5
    s_add_u32 s88, s88, s13
    s_mov_b32 s29, 0
    v_lshlrev_b32 v1, 4, v0
    s_mov_b32 s65, 0
CW_128:
    buffer_load_dwordx2 v[8:9], off, s[60:63], 0 offset:132 sc1
    s_add_u32 s65, s65, 1
    s_waitcnt vmcnt(0)
    v_readfirstlane_b32 s66, v8
    v_readfirstlane_b32 s67, v9
    s_min_u32 s64, s66, s67
    s_cmp_lg_u32 s64, 0
    s_cbranch_scc1 CWD_129
    s_cmp_gt_u32 s65, 65536
    s_cbranch_scc1 CWD_129
    s_sleep 4
    s_branch CW_128
CWD_129:
    s_sub_u32 s66, s66, 1
    s_and_b32 s66, s66, 3
    s_sub_u32 s67, s67, 1
    s_and_b32 s67, s67, 3
    s_mov_b32 s64, s66
    s_mov_b32 s65, s67
    s_and_b32 s64, s64, 3
    s_lshl_b32 s64, s64, 13
    s_and_b32 s65, s65, 3
    s_lshl_b32 s65, s65, 13
    s_add_u32 s25, s64, 0x6000000
    s_add_u32 s30, s65, 0x6200000
    v_bfe_u32 v4, v0, 3, 1
    v_mul_u32_u24 v2, 0x8000, v4
    v_lshrrev_b32 v4, 5, v0
    v_lshl_add_u32 v2, v4, 8, v2
    v_bfe_u32 v4, v0, 4, 1
    v_lshl_add_u32 v2, v4, 7, v2
    v_and_b32 v4, 7, v0
    v_lshl_add_u32 v2, v4, 4, v2
    v_lshrrev_b32 v4, 5, v0
    v_lshlrev_b32 v3, 16, v4
    v_bfe_u32 v4, v0, 4, 1
    v_lshl_add_u32 v3, v4, 7, v3
    v_and_b32 v4, 15, v0
    v_lshl_add_u32 v3, v4, 3, v3
    s_lshl_b32 s26, s13, 11
    s_lshl_b32 s64, s14, 9
    s_add_u32 s26, s26, s64
    s_add_u32 s26, s26, 0xa40000
    s_lshl_b32 s27, s13, 3
    s_add_u32 s27, s27, 0x294004
    s_mov_b32 s28, 0x29a000
    s_mov_b32 s24, 0
    v_lshlrev_b32 v6, 7, v0
MKN_LOOP:
    s_cmp_lg_u32 s24, 10
    s_cbranch_scc1 MKH_130
    v_mov_b32 v10, v2
    v_mov_b32 v11, v3
    s_cmp_ge_u32 s88, 60
    s_cbranch_scc1 NOWO_131
    s_mov_b32 s89, s13
    s_mul_hi_u32 s65, s88, 0xccccccd
    s_mul_i32 s65, s65, 20
    s_sub_u32 s13, s88, s65
    s_load_dwordx2 s[44:45], s[0:1], 40
    s_mov_b32 s46, 0x500000
    s_mov_b32 s47, 0x00020000
    s_waitcnt lgkmcnt(0)
    s_mul_i32 s21, s14, 36864
    v_lshrrev_b32 v7, 2, v0
    v_mul_u32_u24 v4, 1280, v7
    v_bfe_u32 v7, v0, 4, 1
    v_lshlrev_b32 v7, 1, v7
    v_and_b32 v8, 3, v0
    v_xor_b32 v7, v7, v8
    v_lshl_add_u32 v4, v7, 4, v4
    v_lshrrev_b32 v7, 4, v0
    v_lshlrev_b32 v2, 8, v7
    v_bfe_u32 v7, v0, 2, 2
    v_lshl_add_u32 v2, v7, 6, v2
    v_and_b32 v7, 3, v0
    v_lshl_add_u32 v2, v7, 3, v2
    v_add_u32 v2, s21, v2
    v_bfe_u32 v7, v0, 4, 1
    v_lshlrev_b32 v7, 5, v7
    v_sub_u32 v3, 32, v7
    v_add_u32 v3, v3, v2
    v_add_u32 v2, v2, v7
    s_mul_i32 s65, s14, 1310720
    s_lshl_b32 s66, s13, 6
    s_add_u32 s65, s65, s66
    s_add_u32 m0, s21, 0
    s_add_u32 s64, s65, 0x0
    buffer_load_dwordx4 v4, s[44:47], s64 offen lds
    s_add_u32 m0, s21, 1024
    s_add_u32 s64, s65, 0x5000
    buffer_load_dwordx4 v4, s[44:47], s64 offen lds
    s_add_u32 m0, s21, 2048
    s_add_u32 s64, s65, 0xa000
    buffer_load_dwordx4 v4, s[44:47], s64 offen lds
    s_add_u32 m0, s21, 3072
    s_add_u32 s64, s65, 0xf000
    buffer_load_dwordx4 v4, s[44:47], s64 offen lds
    s_add_u32 m0, s21, 4096
    s_add_u32 s64, s65, 0x14000
    buffer_load_dwordx4 v4, s[44:47], s64 offen lds
    s_add_u32 m0, s21, 5120
    s_add_u32 s64, s65, 0x19000
    buffer_load_dwordx4 v4, s[44:47], s64 offen lds
    s_add_u32 m0, s21, 6144
    s_add_u32 s64, s65, 0x1e000
    buffer_load_dwordx4 v4, s[44:47], s64 offen lds
    s_add_u32 m0, s21, 7168
    s_add_u32 s64, s65, 0x23000
    buffer_load_dwordx4 v4, s[44:47], s64 offen lds
    s_add_u32 m0, s21, 8192
    s_add_u32 s64, s65, 0x28000
    buffer_load_dwordx4 v4, s[44:47], s64 offen lds
    s_add_u32 m0, s21, 9216
    s_add_u32 s64, s65, 0x2d000
    buffer_load_dwordx4 v4, s[44:47], s64 offen lds
    s_add_u32 m0, s21, 10240
    s_add_u32 s64, s65, 0x32000
    buffer_load_dwordx4 v4, s[44:47], s64 offen lds
    s_add_u32 m0, s21, 11264
    s_add_u32 s64, s65, 0x37000
    buffer_load_dwordx4 v4, s[44:47], s64 offen lds
    s_add_u32 m0, s21, 12288
    s_add_u32 s64, s65, 0x3c000
    buffer_load_dwordx4 v4, s[44:47], s64 offen lds
    s_add_u32 m0, s21, 13312
    s_add_u32 s64, s65, 0x41000
    buffer_load_dwordx4 v4, s[44:47], s64 offen lds
    s_add_u32 m0, s21, 14336
    s_add_u32 s64, s65, 0x46000
    buffer_load_dwordx4 v4, s[44:47], s64 offen lds
    s_add_u32 m0, s21, 15360
    s_add_u32 s64, s65, 0x4b000
    buffer_load_dwordx4 v4, s[44:47], s64 offen lds
    s_add_u32 m0, s21, 16384
    s_add_u32 s64, s65, 0x50000
    buffer_load_dwordx4 v4, s[44:47], s64 offen lds
    s_add_u32 m0, s21, 17408
    s_add_u32 s64, s65, 0x55000
    buffer_load_dwordx4 v4, s[44:47], s64 offen lds
    s_add_u32 m0, s21, 18432
    s_add_u32 s64, s65, 0x5a000
    buffer_load_dwordx4 v4, s[44:47], s64 offen lds
    s_add_u32 m0, s21, 19456
    s_add_u32 s64, s65, 0x5f000
    buffer_load_dwordx4 v4, s[44:47], s64 offen lds
    s_add_u32 m0, s21, 20480
    s_add_u32 s64, s65, 0x64000
    buffer_load_dwordx4 v4, s[44:47], s64 offen lds
    s_add_u32 m0, s21, 21504
    s_add_u32 s64, s65, 0x69000
    buffer_load_dwordx4 v4, s[44:47], s64 offen lds
    s_add_u32 m0, s21, 22528
    s_add_u32 s64, s65, 0x6e000
    buffer_load_dwordx4 v4, s[44:47], s64 offen lds
    s_add_u32 m0, s21, 23552
    s_add_u32 s64, s65, 0x73000
    buffer_load_dwordx4 v4, s[44:47], s64 offen lds
    s_add_u32 m0, s21, 24576
    s_add_u32 s64, s65, 0x78000
    buffer_load_dwordx4 v4, s[44:47], s64 offen lds
    s_add_u32 m0, s21, 25600
    s_add_u32 s64, s65, 0x7d000
    buffer_load_dwordx4 v4, s[44:47], s64 offen lds
    s_add_u32 m0, s21, 26624
    s_add_u32 s64, s65, 0x82000
    buffer_load_dwordx4 v4, s[44:47], s64 offen lds
    s_add_u32 m0, s21, 27648
    s_add_u32 s64, s65, 0x87000
    buffer_load_dwordx4 v4, s[44:47], s64 offen lds
    s_add_u32 m0, s21, 28672
    s_add_u32 s64, s65, 0x8c000
    buffer_load_dwordx4 v4, s[44:47], s64 offen lds
    s_add_u32 m0, s21, 29696
    s_add_u32 s64, s65, 0x91000
    buffer_load_dwordx4 v4, s[44:47], s64 offen lds
    s_add_u32 m0, s21, 30720
    s_add_u32 s64, s65, 0x96000
    buffer_load_dwordx4 v4, s[44:47], s64 offen lds
    s_add_u32 m0, s21, 31744
    s_add_u32 s64, s65, 0x9b000
    buffer_load_dwordx4 v4, s[44:47], s64 offen lds
    s_add_u32 m0, s21, 32768
    s_add_u32 s64, s65, 0xa0000
    buffer_load_dwordx4 v4, s[44:47], s64 offen lds
    s_add_u32 m0, s21, 33792
    s_add_u32 s64, s65, 0xa5000
    buffer_load_dwordx4 v4, s[44:47], s64 offen lds
    s_add_u32 m0, s21, 34816
    s_add_u32 s64, s65, 0xaa000
    buffer_load_dwordx4 v4, s[44:47], s64 offen lds
    s_add_u32 m0, s21, 35840
    s_add_u32 s64, s65, 0xaf000
    buffer_load_dwordx4 v4, s[44:47], s64 offen lds
    s_waitcnt vmcnt(32)
    ds_read_b64_tr_b16 a[0:1], v2 offset:0
    ds_read_b64_tr_b16 a[2:3], v2 offset:1024
    ds_read_b64_tr_b16 a[4:5], v3 offset:0
    ds_read_b64_tr_b16 a[6:7], v3 offset:1024
    ds_read_b64_tr_b16 a[8:9], v2 offset:2048
    ds_read_b64_tr_b16 a[10:11], v2 offset:3072
    ds_read_b64_tr_b16 a[12:13], v3 offset:2048
    ds_read_b64_tr_b16 a[14:15], v3 offset:3072
    s_waitcnt lgkmcnt(0)
    s_add_u32 m0, s21, 0
    s_add_u32 s64, s65, 0xb4000
    buffer_load_dwordx4 v4, s[44:47], s64 offen lds
    s_add_u32 m0, s21, 1024
    s_add_u32 s64, s65, 0xb9000
    buffer_load_dwordx4 v4, s[44:47], s64 offen lds
    s_add_u32 m0, s21, 2048
    s_add_u32 s64, s65, 0xbe000
    buffer_load_dwordx4 v4, s[44:47], s64 offen lds
    s_add_u32 m0, s21, 3072
    s_add_u32 s64, s65, 0xc3000
    buffer_load_dwordx4 v4, s[44:47], s64 offen lds
    s_waitcnt vmcnt(32)
    ds_read_b64_tr_b16 a[16:17], v2 offset:4096
    ds_read_b64_tr_b16 a[18:19], v2 offset:5120
    ds_read_b64_tr_b16 a[20:21], v3 offset:4096
    ds_read_b64_tr_b16 a[22:23], v3 offset:5120
    ds_read_b64_tr_b16 a[24:25], v2 offset:6144
    ds_read_b64_tr_b16 a[26:27], v2 offset:7168
    ds_read_b64_tr_b16 a[28:29], v3 offset:6144
    ds_read_b64_tr_b16 a[30:31], v3 offset:7168
    s_waitcnt lgkmcnt(0)
    s_add_u32 m0, s21, 4096
    s_add_u32 s64, s65, 0xc8000
    buffer_load_dwordx4 v4, s[44:47], s64 offen lds
    s_add_u32 m0, s21, 5120
    s_add_u32 s64, s65, 0xcd000
    buffer_load_dwordx4 v4, s[44:47], s64 offen lds
    s_add_u32 m0, s21, 6144
    s_add_u32 s64, s65, 0xd2000
    buffer_load_dwordx4 v4, s[44:47], s64 offen lds
    s_add_u32 m0, s21, 7168
    s_add_u32 s64, s65, 0xd7000
    buffer_load_dwordx4 v4, s[44:47], s64 offen lds
    s_waitcnt vmcnt(32)
    ds_read_b64_tr_b16 a[32:33], v2 offset:8192
    ds_read_b64_tr_b16 a[34:35], v2 offset:9216
    ds_read_b64_tr_b16 a[36:37], v3 offset:8192
    ds_read_b64_tr_b16 a[38:39], v3 offset:9216
    ds_read_b64_tr_b16 a[40:41], v2 offset:10240
    ds_read_b64_tr_b16 a[42:43], v2 offset:11264
    ds_read_b64_tr_b16 a[44:45], v3 offset:10240
    ds_read_b64_tr_b16 a[46:47], v3 offset:11264
    s_waitcnt lgkmcnt(0)
    s_add_u32 m0, s21, 8192
    s_add_u32 s64, s65, 0xdc000
    buffer_load_dwordx4 v4, s[44:47], s64 offen lds
    s_add_u32 m0, s21, 9216
    s_add_u32 s64, s65, 0xe1000
    buffer_load_dwordx4 v4, s[44:47], s64 offen lds
    s_add_u32 m0, s21, 10240
    s_add_u32 s64, s65, 0xe6000
    buffer_load_dwordx4 v4, s[44:47], s64 offen lds
    s_add_u32 m0, s21, 11264
    s_add_u32 s64, s65, 0xeb000
    buffer_load_dwordx4 v4, s[44:47], s64 offen lds
    s_waitcnt vmcnt(32)
    ds_read_b64_tr_b16 a[48:49], v2 offset:12288
    ds_read_b64_tr_b16 a[50:51], v2 offset:13312
    ds_read_b64_tr_b16 a[52:53], v3 offset:12288
    ds_read_b64_tr_b16 a[54:55], v3 offset:13312
    ds_read_b64_tr_b16 a[56:57], v2 offset:14336
    ds_read_b64_tr_b16 a[58:59], v2 offset:15360
    ds_read_b64_tr_b16 a[60:61], v3 offset:14336
    ds_read_b64_tr_b16 a[62:63], v3 offset:15360
    s_waitcnt lgkmcnt(0)
    s_add_u32 m0, s21, 12288
    s_add_u32 s64, s65, 0xf0000
    buffer_load_dwordx4 v4, s[44:47], s64 offen lds
    s_add_u32 m0, s21, 13312
    s_add_u32 s64, s65, 0xf5000
    buffer_load_dwordx4 v4, s[44:47], s64 offen lds
    s_add_u32 m0, s21, 14336
    s_add_u32 s64, s65, 0xfa000
    buffer_load_dwordx4 v4, s[44:47], s64 offen lds
    s_add_u32 m0, s21, 15360
    s_add_u32 s64, s65, 0xff000
    buffer_load_dwordx4 v4, s[44:47], s64 offen lds
    s_waitcnt vmcnt(32)
    ds_read_b64_tr_b16 a[64:65], v2 offset:16384
    ds_read_b64_tr_b16 a[66:67], v2 offset:17408
    ds_read_b64_tr_b16 a[68:69], v3 offset:16384
    ds_read_b64_tr_b16 a[70:71], v3 offset:17408
    ds_read_b64_tr_b16 a[72:73], v2 offset:18432
    ds_read_b64_tr_b16 a[74:75], v2 offset:19456
    ds_read_b64_tr_b16 a[76:77], v3 offset:18432
    ds_read_b64_tr_b16 a[78:79], v3 offset:19456
    s_waitcnt lgkmcnt(0)
    s_add_u32 m0, s21, 16384
    s_add_u32 s64, s65, 0x104000
    buffer_load_dwordx4 v4, s[44:47], s64 offen lds
    s_add_u32 m0, s21, 17408
    s_add_u32 s64, s65, 0x109000
    buffer_load_dwordx4 v4, s[44:47], s64 offen lds
    s_add_u32 m0, s21, 18432
    s_add_u32 s64, s65, 0x10e000
    buffer_load_dwordx4 v4, s[44:47], s64 offen lds
    s_add_u32 m0, s21, 19456
    s_add_u32 s64, s65, 0x113000
    buffer_load_dwordx4 v4, s[44:47], s64 offen lds
    s_waitcnt vmcnt(32)
    ds_read_b64_tr_b16 a[80:81], v2 offset:20480
    ds_read_b64_tr_b16 a[82:83], v2 offset:21504
    ds_read_b64_tr_b16 a[84:85], v3 offset:20480
    ds_read_b64_tr_b16 a[86:87], v3 offset:21504
    ds_read_b64_tr_b16 a[88:89], v2 offset:22528
    ds_read_b64_tr_b16 a[90:91], v2 offset:23552
    ds_read_b64_tr_b16 a[92:93], v3 offset:22528
    ds_read_b64_tr_b16 a[94:95], v3 offset:23552
    s_waitcnt lgkmcnt(0)
    s_add_u32 m0, s21, 20480
    s_add_u32 s64, s65, 0x118000
    buffer_load_dwordx4 v4, s[44:47], s64 offen lds
    s_add_u32 m0, s21, 21504
    s_add_u32 s64, s65, 0x11d000
    buffer_load_dwordx4 v4, s[44:47], s64 offen lds
    s_add_u32 m0, s21, 22528
    s_add_u32 s64, s65, 0x122000
    buffer_load_dwordx4 v4, s[44:47], s64 offen lds
    s_add_u32 m0, s21, 23552
    s_add_u32 s64, s65, 0x127000
    buffer_load_dwordx4 v4, s[44:47], s64 offen lds
    s_waitcnt vmcnt(32)
    ds_read_b64_tr_b16 a[96:97], v2 offset:24576
    ds_read_b64_tr_b16 a[98:99], v2 offset:25600
    ds_read_b64_tr_b16 a[100:101], v3 offset:24576
    ds_read_b64_tr_b16 a[102:103], v3 offset:25600
    ds_read_b64_tr_b16 a[104:105], v2 offset:26624
    ds_read_b64_tr_b16 a[106:107], v2 offset:27648
    ds_read_b64_tr_b16 a[108:109], v3 offset:26624
    ds_read_b64_tr_b16 a[110:111], v3 offset:27648
    s_waitcnt lgkmcnt(0)
    s_add_u32 m0, s21, 24576
    s_add_u32 s64, s65, 0x12c000
    buffer_load_dwordx4 v4, s[44:47], s64 offen lds
    s_add_u32 m0, s21, 25600
    s_add_u32 s64, s65, 0x131000
    buffer_load_dwordx4 v4, s[44:47], s64 offen lds
    s_add_u32 m0, s21, 26624
    s_add_u32 s64, s65, 0x136000
    buffer_load_dwordx4 v4, s[44:47], s64 offen lds
    s_add_u32 m0, s21, 27648
    s_add_u32 s64, s65, 0x13b000
    buffer_load_dwordx4 v4, s[44:47], s64 offen lds
    s_waitcnt vmcnt(32)
    ds_read_b64_tr_b16 a[112:113], v2 offset:28672
    ds_read_b64_tr_b16 a[114:115], v2 offset:29696
    ds_read_b64_tr_b16 a[116:117], v3 offset:28672
    ds_read_b64_tr_b16 a[118:119], v3 offset:29696
    ds_read_b64_tr_b16 a[120:121], v2 offset:30720
    ds_read_b64_tr_b16 a[122:123], v2 offset:31744
    ds_read_b64_tr_b16 a[124:125], v3 offset:30720
    ds_read_b64_tr_b16 a[126:127], v3 offset:31744
    s_waitcnt lgkmcnt(0)
    s_waitcnt vmcnt(28)
    ds_read_b64_tr_b16 a[128:129], v2 offset:32768
    ds_read_b64_tr_b16 a[130:131], v2 offset:33792
    ds_read_b64_tr_b16 a[132:133], v3 offset:32768
    ds_read_b64_tr_b16 a[134:135], v3 offset:33792
    ds_read_b64_tr_b16 a[136:137], v2 offset:34816
    ds_read_b64_tr_b16 a[138:139], v2 offset:35840
    ds_read_b64_tr_b16 a[140:141], v3 offset:34816
    ds_read_b64_tr_b16 a[142:143], v3 offset:35840
    s_waitcnt lgkmcnt(0)
    s_waitcnt vmcnt(24)
    ds_read_b64_tr_b16 a[144:145], v2 offset:0
    ds_read_b64_tr_b16 a[146:147], v2 offset:1024
    ds_read_b64_tr_b16 a[148:149], v3 offset:0
    ds_read_b64_tr_b16 a[150:151], v3 offset:1024
    ds_read_b64_tr_b16 a[152:153], v2 offset:2048
    ds_read_b64_tr_b16 a[154:155], v2 offset:3072
    ds_read_b64_tr_b16 a[156:157], v3 offset:2048
    ds_read_b64_tr_b16 a[158:159], v3 offset:3072
    s_waitcnt lgkmcnt(0)
    s_waitcnt vmcnt(20)
    ds_read_b64_tr_b16 a[160:161], v2 offset:4096
    ds_read_b64_tr_b16 a[162:163], v2 offset:5120
    ds_read_b64_tr_b16 a[164:165], v3 offset:4096
    ds_read_b64_tr_b16 a[166:167], v3 offset:5120
    ds_read_b64_tr_b16 a[168:169], v2 offset:6144
    ds_read_b64_tr_b16 a[170:171], v2 offset:7168
    ds_read_b64_tr_b16 a[172:173], v3 offset:6144
    ds_read_b64_tr_b16 a[174:175], v3 offset:7168
    s_waitcnt lgkmcnt(0)
    s_waitcnt vmcnt(16)
    ds_read_b64_tr_b16 a[176:177], v2 offset:8192
    ds_read_b64_tr_b16 a[178:179], v2 offset:9216
    ds_read_b64_tr_b16 a[180:181], v3 offset:8192
    ds_read_b64_tr_b16 a[182:183], v3 offset:9216
    ds_read_b64_tr_b16 a[184:185], v2 offset:10240
    ds_read_b64_tr_b16 a[186:187], v2 offset:11264
    ds_read_b64_tr_b16 a[188:189], v3 offset:10240
    ds_read_b64_tr_b16 a[190:191], v3 offset:11264
    s_waitcnt lgkmcnt(0)
    s_waitcnt vmcnt(12)
    ds_read_b64_tr_b16 a[192:193], v2 offset:12288
    ds_read_b64_tr_b16 a[194:195], v2 offset:13312
    ds_read_b64_tr_b16 a[196:197], v3 offset:12288
    ds_read_b64_tr_b16 a[198:199], v3 offset:13312
    ds_read_b64_tr_b16 a[200:201], v2 offset:14336
    ds_read_b64_tr_b16 a[202:203], v2 offset:15360
    ds_read_b64_tr_b16 a[204:205], v3 offset:14336
    ds_read_b64_tr_b16 a[206:207], v3 offset:15360
    s_waitcnt lgkmcnt(0)
    s_waitcnt vmcnt(8)
    ds_read_b64_tr_b16 a[208:209], v2 offset:16384
    ds_read_b64_tr_b16 a[210:211], v2 offset:17408
    ds_read_b64_tr_b16 a[212:213], v3 offset:16384
    ds_read_b64_tr_b16 a[214:215], v3 offset:17408
    ds_read_b64_tr_b16 a[216:217], v2 offset:18432
    ds_read_b64_tr_b16 a[218:219], v2 offset:19456
    ds_read_b64_tr_b16 a[220:221], v3 offset:18432
    ds_read_b64_tr_b16 a[222:223], v3 offset:19456
    s_waitcnt lgkmcnt(0)
    s_waitcnt vmcnt(4)
    ds_read_b64_tr_b16 a[224:225], v2 offset:20480
    ds_read_b64_tr_b16 a[226:227], v2 offset:21504
    ds_read_b64_tr_b16 a[228:229], v3 offset:20480
    ds_read_b64_tr_b16 a[230:231], v3 offset:21504
    ds_read_b64_tr_b16 a[232:233], v2 offset:22528
    ds_read_b64_tr_b16 a[234:235], v2 offset:23552
    ds_read_b64_tr_b16 a[236:237], v3 offset:22528
    ds_read_b64_tr_b16 a[238:239], v3 offset:23552
    s_waitcnt lgkmcnt(0)
    s_waitcnt vmcnt(0)
    ds_read_b64_tr_b16 a[240:241], v2 offset:24576
    ds_read_b64_tr_b16 a[242:243], v2 offset:25600
    ds_read_b64_tr_b16 a[244:245], v3 offset:24576
    ds_read_b64_tr_b16 a[246:247], v3 offset:25600
    ds_read_b64_tr_b16 a[248:249], v2 offset:26624
    ds_read_b64_tr_b16 a[250:251], v2 offset:27648
    ds_read_b64_tr_b16 a[252:253], v3 offset:26624
    ds_read_b64_tr_b16 a[254:255], v3 offset:27648
    s_waitcnt lgkmcnt(0)
    s_mov_b32 s13, s89
NOWO_131:
    v_mov_b32 v2, v10
    v_mov_b32 v3, v11
MKH_130:
    s_mov_b64 exec, 0xf
MKN_M_132:
    buffer_load_dword v5, v6, s[4:7], s28 offen sc1
    s_add_u32 s29, s29, 1
    s_waitcnt vmcnt(0)
    v_cmp_eq_u32 vcc, 0, v5
    s_cbranch_vccz MKN_MD_133
    s_cmp_gt_u32 s29, 262144
    s_cbranch_scc1 MKN_MD_133
    s_sleep 1
    s_branch MKN_M_132
MKN_MD_133:
    s_mov_b64 exec, -1
MKR_134:
    s_add_u32 s64, s25, 0x0
    buffer_load_dwordx4 v[16:19], v2, s[4:7], s64 offen sc1
    s_add_u32 s64, s25, 0x200
    buffer_load_dwordx4 v[20:23], v2, s[4:7], s64 offen sc1
    s_add_u32 s64, s25, 0x400
    buffer_load_dwordx4 v[24:27], v2, s[4:7], s64 offen sc1
    s_add_u32 s64, s25, 0x600
    buffer_load_dwordx4 v[28:31], v2, s[4:7], s64 offen sc1
    s_add_u32 s64, s25, 0x800
    buffer_load_dwordx4 v[32:35], v2, s[4:7], s64 offen sc1
    s_add_u32 s64, s25, 0xa00
    buffer_load_dwordx4 v[36:39], v2, s[4:7], s64 offen sc1
    s_add_u32 s64, s25, 0xc00
    buffer_load_dwordx4 v[40:43], v2, s[4:7], s64 offen sc1
    s_add_u32 s64, s25, 0xe00
    buffer_load_dwordx4 v[44:47], v2, s[4:7], s64 offen sc1
    s_add_u32 s64, s25, 0x1000
    buffer_load_dwordx4 v[48:51], v2, s[4:7], s64 offen sc1
    s_add_u32 s64, s25, 0x1200
    buffer_load_dwordx4 v[52:55], v2, s[4:7], s64 offen sc1
    s_add_u32 s64, s30, 0x0
    buffer_load_dwordx4 v[56:59], v2, s[4:7], s64 offen sc1
    s_add_u32 s64, s30, 0x200
    buffer_load_dwordx4 v[60:63], v2, s[4:7], s64 offen sc1
    s_add_u32 s64, s30, 0x400
    buffer_load_dwordx4 v[64:67], v2, s[4:7], s64 offen sc1
    s_add_u32 s64, s30, 0x600
    buffer_load_dwordx4 v[68:71], v2, s[4:7], s64 offen sc1
    s_add_u32 s64, s30, 0x800
    buffer_load_dwordx4 v[72:75], v2, s[4:7], s64 offen sc1
    s_add_u32 s64, s30, 0xa00
    buffer_load_dwordx4 v[76:79], v2, s[4:7], s64 offen sc1
    s_add_u32 s64, s30, 0xc00
    buffer_load_dwordx4 v[80:83], v2, s[4:7], s64 offen sc1
    s_add_u32 s64, s30, 0xe00
    buffer_load_dwordx4 v[84:87], v2, s[4:7], s64 offen sc1
    s_add_u32 s64, s30, 0x1000
    buffer_load_dwordx4 v[88:91], v2, s[4:7], s64 offen sc1
    s_add_u32 s64, s30, 0x1200
    buffer_load_dwordx4 v[92:95], v2, s[4:7], s64 offen sc1
    s_add_u32 s29, s29, 1
    s_waitcnt vmcnt(0)
    v_max3_u32 v4, v19, v23, v27
    v_max3_u32 v4, v4, v31, v35
    v_max3_u32 v4, v4, v39, v43
    v_max3_u32 v4, v4, v47, v51
    v_max3_u32 v4, v4, v55, v59
    v_max3_u32 v4, v4, v63, v67
    v_max3_u32 v4, v4, v71, v75
    v_max3_u32 v4, v4, v79, v83
    v_max3_u32 v4, v4, v87, v91
    v_max_u32 v4, v4, v95
    v_cmp_eq_u32 vcc, -1, v4
    s_cbranch_vccz MKO_135
    s_cmp_gt_u32 s29, 262144
    s_cbranch_scc0 MKR_134
MKO_135:
    v_mfma_f32_16x16x32_bf16 v[8:11], v[16:19], v[96:99], 0
    v_mfma_f32_16x16x32_bf16 v[12:15], v[16:19], v[100:103], 0
    v_mfma_f32_16x16x32_bf16 v[8:11], v[20:23], v[104:107], v[8:11]
    v_mfma_f32_16x16x32_bf16 v[12:15], v[20:23], v[108:111], v[12:15]
    v_mfma_f32_16x16x32_bf16 v[8:11], v[24:27], v[112:115], v[8:11]
    v_mfma_f32_16x16x32_bf16 v[12:15], v[24:27], v[116:119], v[12:15]
    v_mfma_f32_16x16x32_bf16 v[8:11], v[28:31], v[120:123], v[8:11]
    v_mfma_f32_16x16x32_bf16 v[12:15], v[28:31], v[124:127], v[12:15]
    v_mfma_f32_16x16x32_bf16 v[8:11], v[32:35], v[128:131], v[8:11]
    v_mfma_f32_16x16x32_bf16 v[12:15], v[32:35], v[132:135], v[12:15]
    v_mfma_f32_16x16x32_bf16 v[8:11], v[36:39], v[136:139], v[8:11]
    v_mfma_f32_16x16x32_bf16 v[12:15], v[36:39], v[140:143], v[12:15]
    v_mfma_f32_16x16x32_bf16 v[8:11], v[40:43], v[144:147], v[8:11]
    v_mfma_f32_16x16x32_bf16 v[12:15], v[40:43], v[148:151], v[12:15]
    v_mfma_f32_16x16x32_bf16 v[8:11], v[44:47], v[152:155], v[8:11]
    v_mfma_f32_16x16x32_bf16 v[12:15], v[44:47], v[156:159], v[12:15]
    v_mfma_f32_16x16x32_bf16 v[8:11], v[48:51], v[160:163], v[8:11]
    v_mfma_f32_16x16x32_bf16 v[12:15], v[48:51], v[164:167], v[12:15]
    v_mfma_f32_16x16x32_bf16 v[8:11], v[52:55], v[168:171], v[8:11]
    v_mfma_f32_16x16x32_bf16 v[12:15], v[52:55], v[172:175], v[12:15]
    v_mfma_f32_16x16x32_bf16 v[8:11], v[56:59], v[176:179], v[8:11]
    v_mfma_f32_16x16x32_bf16 v[12:15], v[56:59], v[180:183], v[12:15]
    v_mfma_f32_16x16x32_bf16 v[8:11], v[60:63], v[184:187], v[8:11]
    v_mfma_f32_16x16x32_bf16 v[12:15], v[60:63], v[188:191], v[12:15]
    v_mfma_f32_16x16x32_bf16 v[8:11], v[64:67], v[192:195], v[8:11]
    v_mfma_f32_16x16x32_bf16 v[12:15], v[64:67], v[196:199], v[12:15]
    v_mfma_f32_16x16x32_bf16 v[8:11], v[68:71], v[200:203], v[8:11]
    v_mfma_f32_16x16x32_bf16 v[12:15], v[68:71], v[204:207], v[12:15]
    v_mfma_f32_16x16x32_bf16 v[8:11], v[72:75], v[208:211], v[8:11]
    v_mfma_f32_16x16x32_bf16 v[12:15], v[72:75], v[212:215], v[12:15]
    v_mfma_f32_16x16x32_bf16 v[8:11], v[76:79], v[216:219], v[8:11]
    v_mfma_f32_16x16x32_bf16 v[12:15], v[76:79], v[220:223], v[12:15]
    v_mfma_f32_16x16x32_bf16 v[8:11], v[80:83], v[224:227], v[8:11]
    v_mfma_f32_16x16x32_bf16 v[12:15], v[80:83], v[228:231], v[12:15]
    v_mfma_f32_16x16x32_bf16 v[8:11], v[84:87], v[232:235], v[8:11]
    v_mfma_f32_16x16x32_bf16 v[12:15], v[84:87], v[236:239], v[12:15]
    v_mfma_f32_16x16x32_bf16 v[8:11], v[88:91], v[240:243], v[8:11]
    v_mfma_f32_16x16x32_bf16 v[12:15], v[88:91], v[244:247], v[12:15]
    v_mfma_f32_16x16x32_bf16 v[8:11], v[92:95], v[248:251], v[8:11]
    v_mfma_f32_16x16x32_bf16 v[12:15], v[92:95], v[252:255], v[12:15]
    s_nop 7
    v_cvt_pk_bf16_f32 v16, v8, v9
    v_cvt_pk_bf16_f32 v17, v10, v11
    v_cvt_pk_bf16_f32 v18, v12, v13
    v_cvt_pk_bf16_f32 v19, v14, v15
    buffer_store_dwordx2 v[16:17], v3, s[4:7], s26 offen sc1
    buffer_store_dwordx2 v[18:19], v3, s[4:7], s26 offen offset:256 sc1
    s_waitcnt vmcnt(0)
    s_barrier
    s_cmp_lg_u32 s14, 0
    s_cbranch_scc1 GF_136
    v_mov_b32 v7, 1
    v_mov_b32 v8, 0
    s_mov_b64 exec, 1
    buffer_store_dword v7, v8, s[4:7], s27 offen sc1
    s_mov_b64 exec, -1
GF_136:
    s_add_u32 s25, s25, 0x10000
    s_add_u32 s30, s30, 0x10000
    s_add_u32 s26, s26, 0x20000
    s_add_u32 s27, s27, 256
    s_add_u32 s28, s28, 512
    s_add_u32 s24, s24, 1
    s_cmp_lt_u32 s24, 32
    s_cbranch_scc1 MKN_LOOP
    s_cmp_ge_u32 s88, 60
    s_cbranch_scc1 M_EXIT
    s_branch H_EXTRA
H_OUT:
    s_lshl_b32 s64, s3, 5
    s_add_u32 s64, s64, s13
    s_cmp_ge_u32 s64, 60
    s_cbranch_scc1 M_EXIT
    s_mul_hi_u32 s12, s64, 0xccccccd
    s_mul_i32 s65, s12, 20
    s_sub_u32 s13, s64, s65
    s_load_dwordx2 s[44:45], s[0:1], 40
    s_mov_b32 s46, 0x500000
    s_mov_b32 s47, 0x00020000
    s_load_dwordx2 s[48:49], s[0:1], 0
    s_mov_b32 s50, 0x280000
    s_mov_b32 s51, 0x00020000
    s_load_dwordx2 s[52:53], s[0:1], 96
    s_mov_b32 s54, 0x280000
    s_mov_b32 s55, 0x00020000
    s_mov_b32 s36, -1
    s_mov_b32 s37, 0
    s_waitcnt lgkmcnt(0)
    s_mul_i32 s21, s14, 36864
    v_lshrrev_b32 v7, 2, v0
    v_mul_u32_u24 v4, 1280, v7
    v_bfe_u32 v7, v0, 4, 1
    v_lshlrev_b32 v7, 1, v7
    v_and_b32 v8, 3, v0
    v_xor_b32 v7, v7, v8
    v_lshl_add_u32 v4, v7, 4, v4
    v_lshrrev_b32 v7, 4, v0
    v_lshlrev_b32 v2, 8, v7
    v_bfe_u32 v7, v0, 2, 2
    v_lshl_add_u32 v2, v7, 6, v2
    v_and_b32 v7, 3, v0
    v_lshl_add_u32 v2, v7, 3, v2
    v_add_u32 v2, s21, v2
    v_bfe_u32 v7, v0, 4, 1
    v_lshlrev_b32 v7, 5, v7
    v_sub_u32 v3, 32, v7
    v_add_u32 v3, v3, v2
    v_add_u32 v2, v2, v7
    s_mul_i32 s65, s14, 1310720
    s_lshl_b32 s66, s13, 6
    s_add_u32 s65, s65, s66
    s_add_u32 m0, s21, 0
    s_add_u32 s64, s65, 0x0
    buffer_load_dwordx4 v4, s[44:47], s64 offen lds
    s_add_u32 m0, s21, 1024
    s_add_u32 s64, s65, 0x5000
    buffer_load_dwordx4 v4, s[44:47], s64 offen lds
    s_add_u32 m0, s21, 2048
    s_add_u32 s64, s65, 0xa000
    buffer_load_dwordx4 v4, s[44:47], s64 offen lds
    s_add_u32 m0, s21, 3072
    s_add_u32 s64, s65, 0xf000
    buffer_load_dwordx4 v4, s[44:47], s64 offen lds
    s_add_u32 m0, s21, 4096
    s_add_u32 s64, s65, 0x14000
    buffer_load_dwordx4 v4, s[44:47], s64 offen lds
    s_add_u32 m0, s21, 5120
    s_add_u32 s64, s65, 0x19000
    buffer_load_dwordx4 v4, s[44:47], s64 offen lds
    s_add_u32 m0, s21, 6144
    s_add_u32 s64, s65, 0x1e000
    buffer_load_dwordx4 v4, s[44:47], s64 offen lds
    s_add_u32 m0, s21, 7168
    s_add_u32 s64, s65, 0x23000
    buffer_load_dwordx4 v4, s[44:47], s64 offen lds
    s_add_u32 m0, s21, 8192
    s_add_u32 s64, s65, 0x28000
    buffer_load_dwordx4 v4, s[44:47], s64 offen lds
    s_add_u32 m0, s21, 9216
    s_add_u32 s64, s65, 0x2d000
    buffer_load_dwordx4 v4, s[44:47], s64 offen lds
    s_add_u32 m0, s21, 10240
    s_add_u32 s64, s65, 0x32000
    buffer_load_dwordx4 v4, s[44:47], s64 offen lds
    s_add_u32 m0, s21, 11264
    s_add_u32 s64, s65, 0x37000
    buffer_load_dwordx4 v4, s[44:47], s64 offen lds
    s_add_u32 m0, s21, 12288
    s_add_u32 s64, s65, 0x3c000
    buffer_load_dwordx4 v4, s[44:47], s64 offen lds
    s_add_u32 m0, s21, 13312
    s_add_u32 s64, s65, 0x41000
    buffer_load_dwordx4 v4, s[44:47], s64 offen lds
    s_add_u32 m0, s21, 14336
    s_add_u32 s64, s65, 0x46000
    buffer_load_dwordx4 v4, s[44:47], s64 offen lds
    s_add_u32 m0, s21, 15360
    s_add_u32 s64, s65, 0x4b000
    buffer_load_dwordx4 v4, s[44:47], s64 offen lds
    s_add_u32 m0, s21, 16384
    s_add_u32 s64, s65, 0x50000
    buffer_load_dwordx4 v4, s[44:47], s64 offen lds
    s_add_u32 m0, s21, 17408
    s_add_u32 s64, s65, 0x55000
    buffer_load_dwordx4 v4, s[44:47], s64 offen lds
    s_add_u32 m0, s21, 18432
    s_add_u32 s64, s65, 0x5a000
    buffer_load_dwordx4 v4, s[44:47], s64 offen lds
    s_add_u32 m0, s21, 19456
    s_add_u32 s64, s65, 0x5f000
    buffer_load_dwordx4 v4, s[44:47], s64 offen lds
    s_add_u32 m0, s21, 20480
    s_add_u32 s64, s65, 0x64000
    buffer_load_dwordx4 v4, s[44:47], s64 offen lds
    s_add_u32 m0, s21, 21504
    s_add_u32 s64, s65, 0x69000
    buffer_load_dwordx4 v4, s[44:47], s64 offen lds
    s_add_u32 m0, s21, 22528
    s_add_u32 s64, s65, 0x6e000
    buffer_load_dwordx4 v4, s[44:47], s64 offen lds
    s_add_u32 m0, s21, 23552
    s_add_u32 s64, s65, 0x73000
    buffer_load_dwordx4 v4, s[44:47], s64 offen lds
    s_add_u32 m0, s21, 24576
    s_add_u32 s64, s65, 0x78000
    buffer_load_dwordx4 v4, s[44:47], s64 offen lds
    s_add_u32 m0, s21, 25600
    s_add_u32 s64, s65, 0x7d000
    buffer_load_dwordx4 v4, s[44:47], s64 offen lds
    s_add_u32 m0, s21, 26624
    s_add_u32 s64, s65, 0x82000
    buffer_load_dwordx4 v4, s[44:47], s64 offen lds
    s_add_u32 m0, s21, 27648
    s_add_u32 s64, s65, 0x87000
    buffer_load_dwordx4 v4, s[44:47], s64 offen lds
    s_add_u32 m0, s21, 28672
    s_add_u32 s64, s65, 0x8c000
    buffer_load_dwordx4 v4, s[44:47], s64 offen lds
    s_add_u32 m0, s21, 29696
    s_add_u32 s64, s65, 0x91000
    buffer_load_dwordx4 v4, s[44:47], s64 offen lds
    s_add_u32 m0, s21, 30720
    s_add_u32 s64, s65, 0x96000
    buffer_load_dwordx4 v4, s[44:47], s64 offen lds
    s_add_u32 m0, s21, 31744
    s_add_u32 s64, s65, 0x9b000
    buffer_load_dwordx4 v4, s[44:47], s64 offen lds
    s_add_u32 m0, s21, 32768
    s_add_u32 s64, s65, 0xa0000
    buffer_load_dwordx4 v4, s[44:47], s64 offen lds
    s_add_u32 m0, s21, 33792
    s_add_u32 s64, s65, 0xa5000
    buffer_load_dwordx4 v4, s[44:47], s64 offen lds
    s_add_u32 m0, s21, 34816
    s_add_u32 s64, s65, 0xaa000
    buffer_load_dwordx4 v4, s[44:47], s64 offen lds
    s_add_u32 m0, s21, 35840
    s_add_u32 s64, s65, 0xaf000
    buffer_load_dwordx4 v4, s[44:47], s64 offen lds
    s_waitcnt vmcnt(32)
    ds_read_b64_tr_b16 a[0:1], v2 offset:0
    ds_read_b64_tr_b16 a[2:3], v2 offset:1024
    ds_read_b64_tr_b16 a[4:5], v3 offset:0
    ds_read_b64_tr_b16 a[6:7], v3 offset:1024
    ds_read_b64_tr_b16 a[8:9], v2 offset:2048
    ds_read_b64_tr_b16 a[10:11], v2 offset:3072
    ds_read_b64_tr_b16 a[12:13], v3 offset:2048
    ds_read_b64_tr_b16 a[14:15], v3 offset:3072
    s_waitcnt lgkmcnt(0)
    s_add_u32 m0, s21, 0
    s_add_u32 s64, s65, 0xb4000
    buffer_load_dwordx4 v4, s[44:47], s64 offen lds
    s_add_u32 m0, s21, 1024
    s_add_u32 s64, s65, 0xb9000
    buffer_load_dwordx4 v4, s[44:47], s64 offen lds
    s_add_u32 m0, s21, 2048
    s_add_u32 s64, s65, 0xbe000
    buffer_load_dwordx4 v4, s[44:47], s64 offen lds
    s_add_u32 m0, s21, 3072
    s_add_u32 s64, s65, 0xc3000
    buffer_load_dwordx4 v4, s[44:47], s64 offen lds
    s_waitcnt vmcnt(32)
    ds_read_b64_tr_b16 a[16:17], v2 offset:4096
    ds_read_b64_tr_b16 a[18:19], v2 offset:5120
    ds_read_b64_tr_b16 a[20:21], v3 offset:4096
    ds_read_b64_tr_b16 a[22:23], v3 offset:5120
    ds_read_b64_tr_b16 a[24:25], v2 offset:6144
    ds_read_b64_tr_b16 a[26:27], v2 offset:7168
    ds_read_b64_tr_b16 a[28:29], v3 offset:6144
    ds_read_b64_tr_b16 a[30:31], v3 offset:7168
    s_waitcnt lgkmcnt(0)
    s_add_u32 m0, s21, 4096
    s_add_u32 s64, s65, 0xc8000
    buffer_load_dwordx4 v4, s[44:47], s64 offen lds
    s_add_u32 m0, s21, 5120
    s_add_u32 s64, s65, 0xcd000
    buffer_load_dwordx4 v4, s[44:47], s64 offen lds
    s_add_u32 m0, s21, 6144
    s_add_u32 s64, s65, 0xd2000
    buffer_load_dwordx4 v4, s[44:47], s64 offen lds
    s_add_u32 m0, s21, 7168
    s_add_u32 s64, s65, 0xd7000
    buffer_load_dwordx4 v4, s[44:47], s64 offen lds
    s_waitcnt vmcnt(32)
    ds_read_b64_tr_b16 a[32:33], v2 offset:8192
    ds_read_b64_tr_b16 a[34:35], v2 offset:9216
    ds_read_b64_tr_b16 a[36:37], v3 offset:8192
    ds_read_b64_tr_b16 a[38:39], v3 offset:9216
    ds_read_b64_tr_b16 a[40:41], v2 offset:10240
    ds_read_b64_tr_b16 a[42:43], v2 offset:11264
    ds_read_b64_tr_b16 a[44:45], v3 offset:10240
    ds_read_b64_tr_b16 a[46:47], v3 offset:11264
    s_waitcnt lgkmcnt(0)
    s_add_u32 m0, s21, 8192
    s_add_u32 s64, s65, 0xdc000
    buffer_load_dwordx4 v4, s[44:47], s64 offen lds
    s_add_u32 m0, s21, 9216
    s_add_u32 s64, s65, 0xe1000
    buffer_load_dwordx4 v4, s[44:47], s64 offen lds
    s_add_u32 m0, s21, 10240
    s_add_u32 s64, s65, 0xe6000
    buffer_load_dwordx4 v4, s[44:47], s64 offen lds
    s_add_u32 m0, s21, 11264
    s_add_u32 s64, s65, 0xeb000
    buffer_load_dwordx4 v4, s[44:47], s64 offen lds
    s_waitcnt vmcnt(32)
    ds_read_b64_tr_b16 a[48:49], v2 offset:12288
    ds_read_b64_tr_b16 a[50:51], v2 offset:13312
    ds_read_b64_tr_b16 a[52:53], v3 offset:12288
    ds_read_b64_tr_b16 a[54:55], v3 offset:13312
    ds_read_b64_tr_b16 a[56:57], v2 offset:14336
    ds_read_b64_tr_b16 a[58:59], v2 offset:15360
    ds_read_b64_tr_b16 a[60:61], v3 offset:14336
    ds_read_b64_tr_b16 a[62:63], v3 offset:15360
    s_waitcnt lgkmcnt(0)
    s_add_u32 m0, s21, 12288
    s_add_u32 s64, s65, 0xf0000
    buffer_load_dwordx4 v4, s[44:47], s64 offen lds
    s_add_u32 m0, s21, 13312
    s_add_u32 s64, s65, 0xf5000
    buffer_load_dwordx4 v4, s[44:47], s64 offen lds
    s_add_u32 m0, s21, 14336
    s_add_u32 s64, s65, 0xfa000
    buffer_load_dwordx4 v4, s[44:47], s64 offen lds
    s_add_u32 m0, s21, 15360
    s_add_u32 s64, s65, 0xff000
    buffer_load_dwordx4 v4, s[44:47], s64 offen lds
    s_waitcnt vmcnt(32)
    ds_read_b64_tr_b16 a[64:65], v2 offset:16384
    ds_read_b64_tr_b16 a[66:67], v2 offset:17408
    ds_read_b64_tr_b16 a[68:69], v3 offset:16384
    ds_read_b64_tr_b16 a[70:71], v3 offset:17408
    ds_read_b64_tr_b16 a[72:73], v2 offset:18432
    ds_read_b64_tr_b16 a[74:75], v2 offset:19456
    ds_read_b64_tr_b16 a[76:77], v3 offset:18432
    ds_read_b64_tr_b16 a[78:79], v3 offset:19456
    s_waitcnt lgkmcnt(0)
    s_add_u32 m0, s21, 16384
    s_add_u32 s64, s65, 0x104000
    buffer_load_dwordx4 v4, s[44:47], s64 offen lds
    s_add_u32 m0, s21, 17408
    s_add_u32 s64, s65, 0x109000
    buffer_load_dwordx4 v4, s[44:47], s64 offen lds
    s_add_u32 m0, s21, 18432
    s_add_u32 s64, s65, 0x10e000
    buffer_load_dwordx4 v4, s[44:47], s64 offen lds
    s_add_u32 m0, s21, 19456
    s_add_u32 s64, s65, 0x113000
    buffer_load_dwordx4 v4, s[44:47], s64 offen lds
    s_waitcnt vmcnt(32)
    ds_read_b64_tr_b16 a[80:81], v2 offset:20480
    ds_read_b64_tr_b16 a[82:83], v2 offset:21504
    ds_read_b64_tr_b16 a[84:85], v3 offset:20480
    ds_read_b64_tr_b16 a[86:87], v3 offset:21504
    ds_read_b64_tr_b16 a[88:89], v2 offset:22528
    ds_read_b64_tr_b16 a[90:91], v2 offset:23552
    ds_read_b64_tr_b16 a[92:93], v3 offset:22528
    ds_read_b64_tr_b16 a[94:95], v3 offset:23552
    s_waitcnt lgkmcnt(0)
    s_add_u32 m0, s21, 20480
    s_add_u32 s64, s65, 0x118000
    buffer_load_dwordx4 v4, s[44:47], s64 offen lds
    s_add_u32 m0, s21, 21504
    s_add_u32 s64, s65, 0x11d000
    buffer_load_dwordx4 v4, s[44:47], s64 offen lds
    s_add_u32 m0, s21, 22528
    s_add_u32 s64, s65, 0x122000
    buffer_load_dwordx4 v4, s[44:47], s64 offen lds
    s_add_u32 m0, s21, 23552
    s_add_u32 s64, s65, 0x127000
    buffer_load_dwordx4 v4, s[44:47], s64 offen lds
    s_waitcnt vmcnt(32)
    ds_read_b64_tr_b16 a[96:97], v2 offset:24576
    ds_read_b64_tr_b16 a[98:99], v2 offset:25600
    ds_read_b64_tr_b16 a[100:101], v3 offset:24576
    ds_read_b64_tr_b16 a[102:103], v3 offset:25600
    ds_read_b64_tr_b16 a[104:105], v2 offset:26624
    ds_read_b64_tr_b16 a[106:107], v2 offset:27648
    ds_read_b64_tr_b16 a[108:109], v3 offset:26624
    ds_read_b64_tr_b16 a[110:111], v3 offset:27648
    s_waitcnt lgkmcnt(0)
    s_add_u32 m0, s21, 24576
    s_add_u32 s64, s65, 0x12c000
    buffer_load_dwordx4 v4, s[44:47], s64 offen lds
    s_add_u32 m0, s21, 25600
    s_add_u32 s64, s65, 0x131000
    buffer_load_dwordx4 v4, s[44:47], s64 offen lds
    s_add_u32 m0, s21, 26624
    s_add_u32 s64, s65, 0x136000
    buffer_load_dwordx4 v4, s[44:47], s64 offen lds
    s_add_u32 m0, s21, 27648
    s_add_u32 s64, s65, 0x13b000
    buffer_load_dwordx4 v4, s[44:47], s64 offen lds
    s_waitcnt vmcnt(32)
    ds_read_b64_tr_b16 a[112:113], v2 offset:28672
    ds_read_b64_tr_b16 a[114:115], v2 offset:29696
    ds_read_b64_tr_b16 a[116:117], v3 offset:28672
    ds_read_b64_tr_b16 a[118:119], v3 offset:29696
    ds_read_b64_tr_b16 a[120:121], v2 offset:30720
    ds_read_b64_tr_b16 a[122:123], v2 offset:31744
    ds_read_b64_tr_b16 a[124:125], v3 offset:30720
    ds_read_b64_tr_b16 a[126:127], v3 offset:31744
    s_waitcnt lgkmcnt(0)
    s_waitcnt vmcnt(28)
    ds_read_b64_tr_b16 a[128:129], v2 offset:32768
    ds_read_b64_tr_b16 a[130:131], v2 offset:33792
    ds_read_b64_tr_b16 a[132:133], v3 offset:32768
    ds_read_b64_tr_b16 a[134:135], v3 offset:33792
    ds_read_b64_tr_b16 a[136:137], v2 offset:34816
    ds_read_b64_tr_b16 a[138:139], v2 offset:35840
    ds_read_b64_tr_b16 a[140:141], v3 offset:34816
    ds_read_b64_tr_b16 a[142:143], v3 offset:35840
    s_waitcnt lgkmcnt(0)
    s_waitcnt vmcnt(24)
    ds_read_b64_tr_b16 a[144:145], v2 offset:0
    ds_read_b64_tr_b16 a[146:147], v2 offset:1024
    ds_read_b64_tr_b16 a[148:149], v3 offset:0
    ds_read_b64_tr_b16 a[150:151], v3 offset:1024
    ds_read_b64_tr_b16 a[152:153], v2 offset:2048
    ds_read_b64_tr_b16 a[154:155], v2 offset:3072
    ds_read_b64_tr_b16 a[156:157], v3 offset:2048
    ds_read_b64_tr_b16 a[158:159], v3 offset:3072
    s_waitcnt lgkmcnt(0)
    s_waitcnt vmcnt(20)
    ds_read_b64_tr_b16 a[160:161], v2 offset:4096
    ds_read_b64_tr_b16 a[162:163], v2 offset:5120
    ds_read_b64_tr_b16 a[164:165], v3 offset:4096
    ds_read_b64_tr_b16 a[166:167], v3 offset:5120
    ds_read_b64_tr_b16 a[168:169], v2 offset:6144
    ds_read_b64_tr_b16 a[170:171], v2 offset:7168
    ds_read_b64_tr_b16 a[172:173], v3 offset:6144
    ds_read_b64_tr_b16 a[174:175], v3 offset:7168
    s_waitcnt lgkmcnt(0)
    s_waitcnt vmcnt(16)
    ds_read_b64_tr_b16 a[176:177], v2 offset:8192
    ds_read_b64_tr_b16 a[178:179], v2 offset:9216
    ds_read_b64_tr_b16 a[180:181], v3 offset:8192
    ds_read_b64_tr_b16 a[182:183], v3 offset:9216
    ds_read_b64_tr_b16 a[184:185], v2 offset:10240
    ds_read_b64_tr_b16 a[186:187], v2 offset:11264
    ds_read_b64_tr_b16 a[188:189], v3 offset:10240
    ds_read_b64_tr_b16 a[190:191], v3 offset:11264
    s_waitcnt lgkmcnt(0)
    s_waitcnt vmcnt(12)
    ds_read_b64_tr_b16 a[192:193], v2 offset:12288
    ds_read_b64_tr_b16 a[194:195], v2 offset:13312
    ds_read_b64_tr_b16 a[196:197], v3 offset:12288
    ds_read_b64_tr_b16 a[198:199], v3 offset:13312
    ds_read_b64_tr_b16 a[200:201], v2 offset:14336
    ds_read_b64_tr_b16 a[202:203], v2 offset:15360
    ds_read_b64_tr_b16 a[204:205], v3 offset:14336
    ds_read_b64_tr_b16 a[206:207], v3 offset:15360
    s_waitcnt lgkmcnt(0)
    s_waitcnt vmcnt(8)
    ds_read_b64_tr_b16 a[208:209], v2 offset:16384
    ds_read_b64_tr_b16 a[210:211], v2 offset:17408
    ds_read_b64_tr_b16 a[212:213], v3 offset:16384
    ds_read_b64_tr_b16 a[214:215], v3 offset:17408
    ds_read_b64_tr_b16 a[216:217], v2 offset:18432
    ds_read_b64_tr_b16 a[218:219], v2 offset:19456
    ds_read_b64_tr_b16 a[220:221], v3 offset:18432
    ds_read_b64_tr_b16 a[222:223], v3 offset:19456
    s_waitcnt lgkmcnt(0)
    s_waitcnt vmcnt(4)
    ds_read_b64_tr_b16 a[224:225], v2 offset:20480
    ds_read_b64_tr_b16 a[226:227], v2 offset:21504
    ds_read_b64_tr_b16 a[228:229], v3 offset:20480
    ds_read_b64_tr_b16 a[230:231], v3 offset:21504
    ds_read_b64_tr_b16 a[232:233], v2 offset:22528
    ds_read_b64_tr_b16 a[234:235], v2 offset:23552
    ds_read_b64_tr_b16 a[236:237], v3 offset:22528
    ds_read_b64_tr_b16 a[238:239], v3 offset:23552
    s_waitcnt lgkmcnt(0)
    s_waitcnt vmcnt(0)
    ds_read_b64_tr_b16 a[240:241], v2 offset:24576
    ds_read_b64_tr_b16 a[242:243], v2 offset:25600
    ds_read_b64_tr_b16 a[244:245], v3 offset:24576
    ds_read_b64_tr_b16 a[246:247], v3 offset:25600
    ds_read_b64_tr_b16 a[248:249], v2 offset:26624
    ds_read_b64_tr_b16 a[250:251], v2 offset:27648
    ds_read_b64_tr_b16 a[252:253], v3 offset:26624
    ds_read_b64_tr_b16 a[254:255], v3 offset:27648
    s_waitcnt lgkmcnt(0)
    s_barrier
    s_mov_b32 s29, 0
    v_lshlrev_b32 v1, 4, v0
    v_mov_b32 v8, 0
    s_mov_b32 s64, 0x298000
OUS_137:
    buffer_load_dword v7, v8, s[4:7], s64 offen sc1
    s_add_u32 s29, s29, 1
    s_waitcnt vmcnt(0)
    v_cmp_gt_u32 vcc, 1, v7
    s_cbranch_vccz OUSD_138
    s_cmp_gt_u32 s29, 262144
    s_cbranch_scc1 OUSD_138
    s_sleep 8
    s_branch OUS_137
OUSD_138:
    v_lshlrev_b32 v6, 2, v0
    s_mov_b32 s64, 0x5400000
    buffer_load_dword v7, v6, s[4:7], s64 offen sc1
    s_waitcnt vmcnt(0)
    v_readlane_b32 s72, v7, 0
    v_readlane_b32 s73, v7, 1
    v_readlane_b32 s74, v7, 2
    v_readlane_b32 s75, v7, 3
    v_readlane_b32 s76, v7, 4
    v_readlane_b32 s77, v7, 5
    v_readlane_b32 s78, v7, 6
    v_readlane_b32 s79, v7, 7
    s_and_b32 s64, s14, 1
    s_lshl_b32 s64, s64, 4
    v_and_b32 v6, 15, v0
    v_add_u32 v6, s64, v6
    v_mov_b32 v9, v6
    v_mul_u32_u24 v5, 1280, v6
    v_lshrrev_b32 v6, 4, v0
    v_lshl_add_u32 v5, v6, 3, v5
    s_lshr_b32 s64, s14, 1
    s_lshl_b32 s64, s64, 5
    s_lshl_b32 s65, s13, 6
    s_add_u32 s64, s64, s65
    v_add_u32 v5, s64, v5
    v_lshlrev_b32 v6, 2, v0
    s_mov_b32 s80, 0x49249249
    s_mov_b32 s81, 0x92492492
    s_lshl_b64 s[80:81], s[80:81], s12
    s_bitset0_b64 s[80:81], 63
    s_bitset0_b64 s[80:81], 62
    s_mov_b64 s[82:83], 0
    s_lshr_b32 s64, s72, 5
    s_bitset1_b64 s[82:83], s64
    s_lshr_b32 s64, s73, 5
    s_bitset1_b64 s[82:83], s64
    s_lshr_b32 s64, s74, 5
    s_bitset1_b64 s[82:83], s64
    s_lshr_b32 s64, s75, 5
    s_bitset1_b64 s[82:83], s64
    s_lshr_b32 s64, s76, 5
    s_bitset1_b64 s[82:83], s64
    s_lshr_b32 s64, s77, 5
    s_bitset1_b64 s[82:83], s64
    s_lshr_b32 s64, s78, 5
    s_bitset1_b64 s[82:83], s64
    s_lshr_b32 s64, s79, 5
    s_bitset1_b64 s[82:83], s64
OU_LOOP:
    s_cmp_eq_u64 s[80:81], 0
    s_cbranch_scc1 OU_END
    s_andn2_b64 s[84:85], s[80:81], s[82:83]
    s_cbranch_scc0 OU_WM
    s_ff1_i32_b64 s24, s[84:85]
    s_branch OU_GO
OU_WM:
    v_mov_b32 v8, 0
    s_mov_b32 s64, 0x298100
OUW_139:
    buffer_load_dword v7, v8, s[4:7], s64 offen sc1
    s_add_u32 s29, s29, 1
    s_waitcnt vmcnt(0)
    v_cmp_gt_u32 vcc, 40, v7
    s_cbranch_vccz OUWD_140
    s_cmp_gt_u32 s29, 262144
    s_cbranch_scc1 OUWD_140
    s_sleep 8
    s_branch OUW_139
OUWD_140:
    s_mov_b64 s[82:83], 0
    s_branch OU_LOOP
OU_GO:
    s_bitset0_b64 s[80:81], s24
    s_lshr_b32 s86, s14, 1
    s_mul_i32 s67, s24, 40960
    buffer_load_dwordx2 v[160:161], v5, s[48:51], s67 offen
    s_add_u32 s64, s67, 0x0
    buffer_load_dwordx2 v[162:163], v5, s[4:7], s64 offen
    s_mov_b32 s64, 0x298100
    buffer_load_dword v12, off, s[4:7], s64 sc1
    s_lshl_b32 s64, s24, 7
    s_add_u32 s64, s64, 0x296000
    s_mov_b64 exec, s[36:37]
OU_F_141:
    buffer_load_dword v7, v6, s[4:7], s64 offen sc1
    s_add_u32 s29, s29, 1
    s_waitcnt vmcnt(0)
    v_cmp_eq_u32 vcc, 0, v7
    s_cbranch_vccz OU_FD_142
    s_cmp_gt_u32 s29, 262144
    s_cbranch_scc1 OU_FD_142
    s_sleep 1
    s_branch OU_F_141
OU_FD_142:
    s_mov_b64 exec, -1
    s_lshl_b32 s25, s24, 18
    s_lshl_b32 s64, s14, 15
    s_add_u32 s25, s25, s64
    s_add_u32 s25, s25, 0x4400000
    s_add_u32 s64, s25, 0x0
    buffer_load_dwordx4 v[16:19], v1, s[4:7], s64 offen
    s_add_u32 s64, s25, 0x20000
    buffer_load_dwordx4 v[20:23], v1, s[4:7], s64 offen
    s_add_u32 s64, s25, 0x400
    buffer_load_dwordx4 v[24:27], v1, s[4:7], s64 offen
    s_add_u32 s64, s25, 0x20400
    buffer_load_dwordx4 v[28:31], v1, s[4:7], s64 offen
    s_add_u32 s64, s25, 0x800
    buffer_load_dwordx4 v[32:35], v1, s[4:7], s64 offen
    s_add_u32 s64, s25, 0x20800
    buffer_load_dwordx4 v[36:39], v1, s[4:7], s64 offen
    s_add_u32 s64, s25, 0xc00
    buffer_load_dwordx4 v[40:43], v1, s[4:7], s64 offen
    s_add_u32 s64, s25, 0x20c00
    buffer_load_dwordx4 v[44:47], v1, s[4:7], s64 offen
    s_add_u32 s64, s25, 0x1000
    buffer_load_dwordx4 v[48:51], v1, s[4:7], s64 offen
    s_add_u32 s64, s25, 0x21000
    buffer_load_dwordx4 v[52:55], v1, s[4:7], s64 offen
    s_add_u32 s64, s25, 0x1400
    buffer_load_dwordx4 v[56:59], v1, s[4:7], s64 offen
    s_add_u32 s64, s25, 0x21400
    buffer_load_dwordx4 v[60:63], v1, s[4:7], s64 offen
    s_add_u32 s64, s25, 0x1800
    buffer_load_dwordx4 v[64:67], v1, s[4:7], s64 offen
    s_add_u32 s64, s25, 0x21800
    buffer_load_dwordx4 v[68:71], v1, s[4:7], s64 offen
    s_add_u32 s64, s25, 0x1c00
    buffer_load_dwordx4 v[72:75], v1, s[4:7], s64 offen
    s_add_u32 s64, s25, 0x21c00
    buffer_load_dwordx4 v[76:79], v1, s[4:7], s64 offen
    s_add_u32 s64, s25, 0x2000
    buffer_load_dwordx4 v[80:83], v1, s[4:7], s64 offen
    s_add_u32 s64, s25, 0x22000
    buffer_load_dwordx4 v[84:87], v1, s[4:7], s64 offen
    s_add_u32 s64, s25, 0x2400
    buffer_load_dwordx4 v[88:91], v1, s[4:7], s64 offen
    s_add_u32 s64, s25, 0x22400
    buffer_load_dwordx4 v[92:95], v1, s[4:7], s64 offen
    s_add_u32 s64, s25, 0x2800
    buffer_load_dwordx4 v[96:99], v1, s[4:7], s64 offen
    s_add_u32 s64, s25, 0x22800
    buffer_load_dwordx4 v[100:103], v1, s[4:7], s64 offen
    s_add_u32 s64, s25, 0x2c00
    buffer_load_dwordx4 v[104:107], v1, s[4:7], s64 offen
    s_add_u32 s64, s25, 0x22c00
    buffer_load_dwordx4 v[108:111], v1, s[4:7], s64 offen
    s_add_u32 s64, s25, 0x3000
    buffer_load_dwordx4 v[112:115], v1, s[4:7], s64 offen
    s_add_u32 s64, s25, 0x23000
    buffer_load_dwordx4 v[116:119], v1, s[4:7], s64 offen
    s_add_u32 s64, s25, 0x3400
    buffer_load_dwordx4 v[120:123], v1, s[4:7], s64 offen
    s_add_u32 s64, s25, 0x23400
    buffer_load_dwordx4 v[124:127], v1, s[4:7], s64 offen
    s_add_u32 s64, s25, 0x3800
    buffer_load_dwordx4 v[128:131], v1, s[4:7], s64 offen
    s_add_u32 s64, s25, 0x23800
    buffer_load_dwordx4 v[132:135], v1, s[4:7], s64 offen
    s_add_u32 s64, s25, 0x3c00
    buffer_load_dwordx4 v[136:139], v1, s[4:7], s64 offen
    s_add_u32 s64, s25, 0x23c00
    buffer_load_dwordx4 v[140:143], v1, s[4:7], s64 offen
    s_waitcnt vmcnt(30)
    v_mfma_f32_16x16x32_bf16 v[144:147], a[0:3], v[16:19], 0
    v_mfma_f32_16x16x32_bf16 v[148:151], a[0:3], v[20:23], 0
    v_mfma_f32_16x16x32_bf16 v[152:155], a[4:7], v[16:19], 0
    v_mfma_f32_16x16x32_bf16 v[156:159], a[4:7], v[20:23], 0
    s_add_u32 s64, s25, 0x4000
    buffer_load_dwordx4 v[16:19], v1, s[4:7], s64 offen
    s_add_u32 s64, s25, 0x24000
    buffer_load_dwordx4 v[20:23], v1, s[4:7], s64 offen
    s_waitcnt vmcnt(30)
    v_mfma_f32_16x16x32_bf16 v[144:147], a[8:11], v[24:27], v[144:147]
    v_mfma_f32_16x16x32_bf16 v[148:151], a[8:11], v[28:31], v[148:151]
    v_mfma_f32_16x16x32_bf16 v[152:155], a[12:15], v[24:27], v[152:155]
    v_mfma_f32_16x16x32_bf16 v[156:159], a[12:15], v[28:31], v[156:159]
    s_add_u32 s64, s25, 0x4400
    buffer_load_dwordx4 v[24:27], v1, s[4:7], s64 offen
    s_add_u32 s64, s25, 0x24400
    buffer_load_dwordx4 v[28:31], v1, s[4:7], s64 offen
    s_waitcnt vmcnt(30)
    v_mfma_f32_16x16x32_bf16 v[144:147], a[16:19], v[32:35], v[144:147]
    v_mfma_f32_16x16x32_bf16 v[148:151], a[16:19], v[36:39], v[148:151]
    v_mfma_f32_16x16x32_bf16 v[152:155], a[20:23], v[32:35], v[152:155]
    v_mfma_f32_16x16x32_bf16 v[156:159], a[20:23], v[36:39], v[156:159]
    s_add_u32 s64, s25, 0x4800
    buffer_load_dwordx4 v[32:35], v1, s[4:7], s64 offen
    s_add_u32 s64, s25, 0x24800
    buffer_load_dwordx4 v[36:39], v1, s[4:7], s64 offen
    s_waitcnt vmcnt(30)
    v_mfma_f32_16x16x32_bf16 v[144:147], a[24:27], v[40:43], v[144:147]
    v_mfma_f32_16x16x32_bf16 v[148:151], a[24:27], v[44:47], v[148:151]
    v_mfma_f32_16x16x32_bf16 v[152:155], a[28:31], v[40:43], v[152:155]
    v_mfma_f32_16x16x32_bf16 v[156:159], a[28:31], v[44:47], v[156:159]
    s_add_u32 s64, s25, 0x4c00
    buffer_load_dwordx4 v[40:43], v1, s[4:7], s64 offen
    s_add_u32 s64, s25, 0x24c00
    buffer_load_dwordx4 v[44:47], v1, s[4:7], s64 offen
    s_waitcnt vmcnt(30)
    v_mfma_f32_16x16x32_bf16 v[144:147], a[32:35], v[48:51], v[144:147]
    v_mfma_f32_16x16x32_bf16 v[148:151], a[32:35], v[52:55], v[148:151]
    v_mfma_f32_16x16x32_bf16 v[152:155], a[36:39], v[48:51], v[152:155]
    v_mfma_f32_16x16x32_bf16 v[156:159], a[36:39], v[52:55], v[156:159]
    s_add_u32 s64, s25, 0x5000
    buffer_load_dwordx4 v[48:51], v1, s[4:7], s64 offen
    s_add_u32 s64, s25, 0x25000
    buffer_load_dwordx4 v[52:55], v1, s[4:7], s64 offen
    s_waitcnt vmcnt(30)
    v_mfma_f32_16x16x32_bf16 v[144:147], a[40:43], v[56:59], v[144:147]
    v_mfma_f32_16x16x32_bf16 v[148:151], a[40:43], v[60:63], v[148:151]
    v_mfma_f32_16x16x32_bf16 v[152:155], a[44:47], v[56:59], v[152:155]
    v_mfma_f32_16x16x32_bf16 v[156:159], a[44:47], v[60:63], v[156:159]
    s_add_u32 s64, s25, 0x5400
    buffer_load_dwordx4 v[56:59], v1, s[4:7], s64 offen
    s_add_u32 s64, s25, 0x25400
    buffer_load_dwordx4 v[60:63], v1, s[4:7], s64 offen
    s_waitcnt vmcnt(30)
    v_mfma_f32_16x16x32_bf16 v[144:147], a[48:51], v[64:67], v[144:147]
    v_mfma_f32_16x16x32_bf16 v[148:151], a[48:51], v[68:71], v[148:151]
    v_mfma_f32_16x16x32_bf16 v[152:155], a[52:55], v[64:67], v[152:155]
    v_mfma_f32_16x16x32_bf16 v[156:159], a[52:55], v[68:71], v[156:159]
    s_add_u32 s64, s25, 0x5800
    buffer_load_dwordx4 v[64:67], v1, s[4:7], s64 offen
    s_add_u32 s64, s25, 0x25800
    buffer_load_dwordx4 v[68:71], v1, s[4:7], s64 offen
    s_waitcnt vmcnt(30)
    v_mfma_f32_16x16x32_bf16 v[144:147], a[56:59], v[72:75], v[144:147]
    v_mfma_f32_16x16x32_bf16 v[148:151], a[56:59], v[76:79], v[148:151]
    v_mfma_f32_16x16x32_bf16 v[152:155], a[60:63], v[72:75], v[152:155]
    v_mfma_f32_16x16x32_bf16 v[156:159], a[60:63], v[76:79], v[156:159]
    s_add_u32 s64, s25, 0x5c00
    buffer_load_dwordx4 v[72:75], v1, s[4:7], s64 offen
    s_add_u32 s64, s25, 0x25c00
    buffer_load_dwordx4 v[76:79], v1, s[4:7], s64 offen
    s_waitcnt vmcnt(30)
    v_mfma_f32_16x16x32_bf16 v[144:147], a[64:67], v[80:83], v[144:147]
    v_mfma_f32_16x16x32_bf16 v[148:151], a[64:67], v[84:87], v[148:151]
    v_mfma_f32_16x16x32_bf16 v[152:155], a[68:71], v[80:83], v[152:155]
    v_mfma_f32_16x16x32_bf16 v[156:159], a[68:71], v[84:87], v[156:159]
    s_add_u32 s64, s25, 0x6000
    buffer_load_dwordx4 v[80:83], v1, s[4:7], s64 offen
    s_add_u32 s64, s25, 0x26000
    buffer_load_dwordx4 v[84:87], v1, s[4:7], s64 offen
    s_waitcnt vmcnt(30)
    v_mfma_f32_16x16x32_bf16 v[144:147], a[72:75], v[88:91], v[144:147]
    v_mfma_f32_16x16x32_bf16 v[148:151], a[72:75], v[92:95], v[148:151]
    v_mfma_f32_16x16x32_bf16 v[152:155], a[76:79], v[88:91], v[152:155]
    v_mfma_f32_16x16x32_bf16 v[156:159], a[76:79], v[92:95], v[156:159]
    s_add_u32 s64, s25, 0x6400
    buffer_load_dwordx4 v[88:91], v1, s[4:7], s64 offen
    s_add_u32 s64, s25, 0x26400
    buffer_load_dwordx4 v[92:95], v1, s[4:7], s64 offen
    s_waitcnt vmcnt(30)
    v_mfma_f32_16x16x32_bf16 v[144:147], a[80:83], v[96:99], v[144:147]
    v_mfma_f32_16x16x32_bf16 v[148:151], a[80:83], v[100:103], v[148:151]
    v_mfma_f32_16x16x32_bf16 v[152:155], a[84:87], v[96:99], v[152:155]
    v_mfma_f32_16x16x32_bf16 v[156:159], a[84:87], v[100:103], v[156:159]
    s_add_u32 s64, s25, 0x6800
    buffer_load_dwordx4 v[96:99], v1, s[4:7], s64 offen
    s_add_u32 s64, s25, 0x26800
    buffer_load_dwordx4 v[100:103], v1, s[4:7], s64 offen
    s_waitcnt vmcnt(30)
    v_mfma_f32_16x16x32_bf16 v[144:147], a[88:91], v[104:107], v[144:147]
    v_mfma_f32_16x16x32_bf16 v[148:151], a[88:91], v[108:111], v[148:151]
    v_mfma_f32_16x16x32_bf16 v[152:155], a[92:95], v[104:107], v[152:155]
    v_mfma_f32_16x16x32_bf16 v[156:159], a[92:95], v[108:111], v[156:159]
    s_add_u32 s64, s25, 0x6c00
    buffer_load_dwordx4 v[104:107], v1, s[4:7], s64 offen
    s_add_u32 s64, s25, 0x26c00
    buffer_load_dwordx4 v[108:111], v1, s[4:7], s64 offen
    s_waitcnt vmcnt(30)
    v_mfma_f32_16x16x32_bf16 v[144:147], a[96:99], v[112:115], v[144:147]
    v_mfma_f32_16x16x32_bf16 v[148:151], a[96:99], v[116:119], v[148:151]
    v_mfma_f32_16x16x32_bf16 v[152:155], a[100:103], v[112:115], v[152:155]
    v_mfma_f32_16x16x32_bf16 v[156:159], a[100:103], v[116:119], v[156:159]
    s_add_u32 s64, s25, 0x7000
    buffer_load_dwordx4 v[112:115], v1, s[4:7], s64 offen
    s_add_u32 s64, s25, 0x27000
    buffer_load_dwordx4 v[116:119], v1, s[4:7], s64 offen
    s_waitcnt vmcnt(30)
    v_mfma_f32_16x16x32_bf16 v[144:147], a[104:107], v[120:123], v[144:147]
    v_mfma_f32_16x16x32_bf16 v[148:151], a[104:107], v[124:127], v[148:151]
    v_mfma_f32_16x16x32_bf16 v[152:155], a[108:111], v[120:123], v[152:155]
    v_mfma_f32_16x16x32_bf16 v[156:159], a[108:111], v[124:127], v[156:159]
    s_add_u32 s64, s25, 0x7400
    buffer_load_dwordx4 v[120:123], v1, s[4:7], s64 offen
    s_add_u32 s64, s25, 0x27400
    buffer_load_dwordx4 v[124:127], v1, s[4:7], s64 offen
    s_waitcnt vmcnt(30)
    v_mfma_f32_16x16x32_bf16 v[144:147], a[112:115], v[128:131], v[144:147]
    v_mfma_f32_16x16x32_bf16 v[148:151], a[112:115], v[132:135], v[148:151]
    v_mfma_f32_16x16x32_bf16 v[152:155], a[116:119], v[128:131], v[152:155]
    v_mfma_f32_16x16x32_bf16 v[156:159], a[116:119], v[132:135], v[156:159]
    s_add_u32 s64, s25, 0x7800
    buffer_load_dwordx4 v[128:131], v1, s[4:7], s64 offen
    s_add_u32 s64, s25, 0x27800
    buffer_load_dwordx4 v[132:135], v1, s[4:7], s64 offen
    s_waitcnt vmcnt(30)
    v_mfma_f32_16x16x32_bf16 v[144:147], a[120:123], v[136:139], v[144:147]
    v_mfma_f32_16x16x32_bf16 v[148:151], a[120:123], v[140:143], v[148:151]
    v_mfma_f32_16x16x32_bf16 v[152:155], a[124:127], v[136:139], v[152:155]
    v_mfma_f32_16x16x32_bf16 v[156:159], a[124:127], v[140:143], v[156:159]
    s_add_u32 s64, s25, 0x7c00
    buffer_load_dwordx4 v[136:139], v1, s[4:7], s64 offen
    s_add_u32 s64, s25, 0x27c00
    buffer_load_dwordx4 v[140:143], v1, s[4:7], s64 offen
    s_waitcnt vmcnt(30)
    v_mfma_f32_16x16x32_bf16 v[144:147], a[128:131], v[16:19], v[144:147]
    v_mfma_f32_16x16x32_bf16 v[148:151], a[128:131], v[20:23], v[148:151]
    v_mfma_f32_16x16x32_bf16 v[152:155], a[132:135], v[16:19], v[152:155]
    v_mfma_f32_16x16x32_bf16 v[156:159], a[132:135], v[20:23], v[156:159]
    s_waitcnt vmcnt(28)
    v_mfma_f32_16x16x32_bf16 v[144:147], a[136:139], v[24:27], v[144:147]
    v_mfma_f32_16x16x32_bf16 v[148:151], a[136:139], v[28:31], v[148:151]
    v_mfma_f32_16x16x32_bf16 v[152:155], a[140:143], v[24:27], v[152:155]
    v_mfma_f32_16x16x32_bf16 v[156:159], a[140:143], v[28:31], v[156:159]
    s_waitcnt vmcnt(26)
    v_mfma_f32_16x16x32_bf16 v[144:147], a[144:147], v[32:35], v[144:147]
    v_mfma_f32_16x16x32_bf16 v[148:151], a[144:147], v[36:39], v[148:151]
    v_mfma_f32_16x16x32_bf16 v[152:155], a[148:151], v[32:35], v[152:155]
    v_mfma_f32_16x16x32_bf16 v[156:159], a[148:151], v[36:39], v[156:159]
    s_waitcnt vmcnt(24)
    v_mfma_f32_16x16x32_bf16 v[144:147], a[152:155], v[40:43], v[144:147]
    v_mfma_f32_16x16x32_bf16 v[148:151], a[152:155], v[44:47], v[148:151]
    v_mfma_f32_16x16x32_bf16 v[152:155], a[156:159], v[40:43], v[152:155]
    v_mfma_f32_16x16x32_bf16 v[156:159], a[156:159], v[44:47], v[156:159]
    s_waitcnt vmcnt(22)
    v_mfma_f32_16x16x32_bf16 v[144:147], a[160:163], v[48:51], v[144:147]
    v_mfma_f32_16x16x32_bf16 v[148:151], a[160:163], v[52:55], v[148:151]
    v_mfma_f32_16x16x32_bf16 v[152:155], a[164:167], v[48:51], v[152:155]
    v_mfma_f32_16x16x32_bf16 v[156:159], a[164:167], v[52:55], v[156:159]
    s_waitcnt vmcnt(20)
    v_mfma_f32_16x16x32_bf16 v[144:147], a[168:171], v[56:59], v[144:147]
    v_mfma_f32_16x16x32_bf16 v[148:151], a[168:171], v[60:63], v[148:151]
    v_mfma_f32_16x16x32_bf16 v[152:155], a[172:175], v[56:59], v[152:155]
    v_mfma_f32_16x16x32_bf16 v[156:159], a[172:175], v[60:63], v[156:159]
    s_waitcnt vmcnt(18)
    v_mfma_f32_16x16x32_bf16 v[144:147], a[176:179], v[64:67], v[144:147]
    v_mfma_f32_16x16x32_bf16 v[148:151], a[176:179], v[68:71], v[148:151]
    v_mfma_f32_16x16x32_bf16 v[152:155], a[180:183], v[64:67], v[152:155]
    v_mfma_f32_16x16x32_bf16 v[156:159], a[180:183], v[68:71], v[156:159]
    s_waitcnt vmcnt(16)
    v_mfma_f32_16x16x32_bf16 v[144:147], a[184:187], v[72:75], v[144:147]
    v_mfma_f32_16x16x32_bf16 v[148:151], a[184:187], v[76:79], v[148:151]
    v_mfma_f32_16x16x32_bf16 v[152:155], a[188:191], v[72:75], v[152:155]
    v_mfma_f32_16x16x32_bf16 v[156:159], a[188:191], v[76:79], v[156:159]
    s_waitcnt vmcnt(14)
    v_mfma_f32_16x16x32_bf16 v[144:147], a[192:195], v[80:83], v[144:147]
    v_mfma_f32_16x16x32_bf16 v[148:151], a[192:195], v[84:87], v[148:151]
    v_mfma_f32_16x16x32_bf16 v[152:155], a[196:199], v[80:83], v[152:155]
    v_mfma_f32_16x16x32_bf16 v[156:159], a[196:199], v[84:87], v[156:159]
    s_waitcnt vmcnt(12)
    v_mfma_f32_16x16x32_bf16 v[144:147], a[200:203], v[88:91], v[144:147]
    v_mfma_f32_16x16x32_bf16 v[148:151], a[200:203], v[92:95], v[148:151]
    v_mfma_f32_16x16x32_bf16 v[152:155], a[204:207], v[88:91], v[152:155]
    v_mfma_f32_16x16x32_bf16 v[156:159], a[204:207], v[92:95], v[156:159]
    s_waitcnt vmcnt(10)
    v_mfma_f32_16x16x32_bf16 v[144:147], a[208:211], v[96:99], v[144:147]
    v_mfma_f32_16x16x32_bf16 v[148:151], a[208:211], v[100:103], v[148:151]
    v_mfma_f32_16x16x32_bf16 v[152:155], a[212:215], v[96:99], v[152:155]
    v_mfma_f32_16x16x32_bf16 v[156:159], a[212:215], v[100:103], v[156:159]
    s_waitcnt vmcnt(8)
    v_mfma_f32_16x16x32_bf16 v[144:147], a[216:219], v[104:107], v[144:147]
    v_mfma_f32_16x16x32_bf16 v[148:151], a[216:219], v[108:111], v[148:151]
    v_mfma_f32_16x16x32_bf16 v[152:155], a[220:223], v[104:107], v[152:155]
    v_mfma_f32_16x16x32_bf16 v[156:159], a[220:223], v[108:111], v[156:159]
    s_waitcnt vmcnt(6)
    v_mfma_f32_16x16x32_bf16 v[144:147], a[224:227], v[112:115], v[144:147]
    v_mfma_f32_16x16x32_bf16 v[148:151], a[224:227], v[116:119], v[148:151]
    v_mfma_f32_16x16x32_bf16 v[152:155], a[228:231], v[112:115], v[152:155]
    v_mfma_f32_16x16x32_bf16 v[156:159], a[228:231], v[116:119], v[156:159]
    s_waitcnt vmcnt(4)
    v_mfma_f32_16x16x32_bf16 v[144:147], a[232:235], v[120:123], v[144:147]
    v_mfma_f32_16x16x32_bf16 v[148:151], a[232:235], v[124:127], v[148:151]
    v_mfma_f32_16x16x32_bf16 v[152:155], a[236:239], v[120:123], v[152:155]
    v_mfma_f32_16x16x32_bf16 v[156:159], a[236:239], v[124:127], v[156:159]
    s_waitcnt vmcnt(2)
    v_mfma_f32_16x16x32_bf16 v[144:147], a[240:243], v[128:131], v[144:147]
    v_mfma_f32_16x16x32_bf16 v[148:151], a[240:243], v[132:135], v[148:151]
    v_mfma_f32_16x16x32_bf16 v[152:155], a[244:247], v[128:131], v[152:155]
    v_mfma_f32_16x16x32_bf16 v[156:159], a[244:247], v[132:135], v[156:159]
    s_waitcnt vmcnt(0)
    v_mfma_f32_16x16x32_bf16 v[144:147], a[248:251], v[136:139], v[144:147]
    v_mfma_f32_16x16x32_bf16 v[148:151], a[248:251], v[140:143], v[148:151]
    v_mfma_f32_16x16x32_bf16 v[152:155], a[252:255], v[136:139], v[152:155]
    v_mfma_f32_16x16x32_bf16 v[156:159], a[252:255], v[140:143], v[156:159]
    s_lshl_b32 s64, s14, 12
    v_add_u32 v7, s64, v1
    s_barrier
    s_nop 3
    ds_write_b128 v7, v[144:147] offset:0
    ds_write_b128 v7, v[148:151] offset:1024
    ds_write_b128 v7, v[152:155] offset:2048
    ds_write_b128 v7, v[156:159] offset:3072
    v_mov_b32 v13, 16384
    s_cmp_lg_u32 s14, 0
    s_cbranch_scc1 OW0_143
    ds_write_b32 v13, v12
OW0_143:
    s_waitcnt lgkmcnt(0)
    s_barrier
    ds_read_b32 v12, v13
    s_waitcnt lgkmcnt(0)
    v_readfirstlane_b32 s64, v12
    s_cmp_lt_u32 s64, 40
    s_cselect_b64 s[82:83], s[82:83], 0
    s_lshl_b32 s64, s14, 10
    v_add_u32 v7, s64, v1
    ds_read_b128 v[16:19], v7 offset:0
    ds_read_b128 v[20:23], v7 offset:4096
    ds_read_b128 v[24:27], v7 offset:8192
    ds_read_b128 v[28:31], v7 offset:12288
    s_waitcnt lgkmcnt(0)
    v_add_f32 v16, v16, v20
    v_add_f32 v24, v24, v28
    v_add_f32 v16, v16, v24
    v_add_f32 v17, v17, v21
    v_add_f32 v25, v25, v29
    v_add_f32 v17, v17, v25
    v_add_f32 v18, v18, v22
    v_add_f32 v26, v26, v30
    v_add_f32 v18, v18, v26
    v_add_f32 v19, v19, v23
    v_add_f32 v27, v27, v31
    v_add_f32 v19, v19, v27
    v_cvt_pk_bf16_f32 v16, v16, v16
    v_lshlrev_b32 v16, 16, v16
    v_cvt_pk_bf16_f32 v17, v17, v17
    v_lshlrev_b32 v17, 16, v17
    v_cvt_pk_bf16_f32 v18, v18, v18
    v_lshlrev_b32 v18, 16, v18
    v_cvt_pk_bf16_f32 v19, v19, v19
    v_lshlrev_b32 v19, 16, v19
    v_lshlrev_b32 v20, 16, v162
    v_and_b32 v21, 0xffff0000, v162
    v_lshlrev_b32 v24, 16, v160
    v_and_b32 v25, 0xffff0000, v160
    v_lshlrev_b32 v22, 16, v163
    v_and_b32 v23, 0xffff0000, v163
    v_lshlrev_b32 v26, 16, v161
    v_and_b32 v27, 0xffff0000, v161
    s_lshl_b32 s64, s24, 5
    v_add_u32 v8, s64, v9
    v_mov_b32 v10, -1
    v_cmp_eq_u32 vcc, s72, v8
    s_nop 1
    v_cndmask_b32 v10, v10, 0, vcc
    v_cmp_eq_u32 vcc, s73, v8
    s_nop 1
    v_cndmask_b32 v10, v10, 1, vcc
    v_cmp_eq_u32 vcc, s74, v8
    s_nop 1
    v_cndmask_b32 v10, v10, 2, vcc
    v_cmp_eq_u32 vcc, s75, v8
    s_nop 1
    v_cndmask_b32 v10, v10, 3, vcc
    v_cmp_eq_u32 vcc, s76, v8
    s_nop 1
    v_cndmask_b32 v10, v10, 4, vcc
    v_cmp_eq_u32 vcc, s77, v8
    s_nop 1
    v_cndmask_b32 v10, v10, 5, vcc
    v_cmp_eq_u32 vcc, s78, v8
    s_nop 1
    v_cndmask_b32 v10, v10, 6, vcc
    v_cmp_eq_u32 vcc, s79, v8
    s_nop 1
    v_cndmask_b32 v10, v10, 7, vcc
    v_cmp_le_i32 vcc, 0, v10
    s_and_saveexec_b64 s[68:69], vcc
    s_cbranch_execz NOUPD_145
    v_mul_u32_u24 v10, 2560, v10
    v_lshrrev_b32 v11, 4, v0
    v_lshl_add_u32 v10, v11, 4, v10
    s_lshl_b32 s64, s86, 6
    s_lshl_b32 s65, s13, 7
    s_add_u32 s64, s64, s65
    s_add_u32 s64, s64, 0x5410000
    buffer_load_dwordx4 v[164:167], v10, s[4:7], s64 offen sc1
    s_waitcnt vmcnt(0)
    v_add_f32 v20, v20, v164
    v_cvt_pk_bf16_f32 v20, v20, v20
    v_lshlrev_b32 v20, 16, v20
    v_add_f32 v21, v21, v165
    v_cvt_pk_bf16_f32 v21, v21, v21
    v_lshlrev_b32 v21, 16, v21
    v_add_f32 v22, v22, v166
    v_cvt_pk_bf16_f32 v22, v22, v22
    v_lshlrev_b32 v22, 16, v22
    v_add_f32 v23, v23, v167
    v_cvt_pk_bf16_f32 v23, v23, v23
    v_lshlrev_b32 v23, 16, v23
NOUPD_145:
    s_mov_b64 exec, -1
    v_mul_f32 v28, 0xbfb8aa3b, v20
    v_exp_f32 v28, v28
    s_nop 0
    v_add_f32 v28, 1.0, v28
    v_rcp_f32 v28, v28
    s_nop 0
    v_mul_f32 v28, v28, v20
    v_cvt_pk_bf16_f32 v28, v28, v28
    v_lshlrev_b32 v28, 16, v28
    v_mul_f32 v28, v28, v16
    v_cvt_pk_bf16_f32 v28, v28, v28
    v_lshlrev_b32 v28, 16, v28
    v_add_f32 v28, v28, v24
    v_mul_f32 v29, 0xbfb8aa3b, v21
    v_exp_f32 v29, v29
    s_nop 0
    v_add_f32 v29, 1.0, v29
    v_rcp_f32 v29, v29
    s_nop 0
    v_mul_f32 v29, v29, v21
    v_cvt_pk_bf16_f32 v29, v29, v29
    v_lshlrev_b32 v29, 16, v29
    v_mul_f32 v29, v29, v17
    v_cvt_pk_bf16_f32 v29, v29, v29
    v_lshlrev_b32 v29, 16, v29
    v_add_f32 v29, v29, v25
    v_mul_f32 v30, 0xbfb8aa3b, v22
    v_exp_f32 v30, v30
    s_nop 0
    v_add_f32 v30, 1.0, v30
    v_rcp_f32 v30, v30
    s_nop 0
    v_mul_f32 v30, v30, v22
    v_cvt_pk_bf16_f32 v30, v30, v30
    v_lshlrev_b32 v30, 16, v30
    v_mul_f32 v30, v30, v18
    v_cvt_pk_bf16_f32 v30, v30, v30
    v_lshlrev_b32 v30, 16, v30
    v_add_f32 v30, v30, v26
    v_mul_f32 v31, 0xbfb8aa3b, v23
    v_exp_f32 v31, v31
    s_nop 0
    v_add_f32 v31, 1.0, v31
    v_rcp_f32 v31, v31
    s_nop 0
    v_mul_f32 v31, v31, v23
    v_cvt_pk_bf16_f32 v31, v31, v31
    v_lshlrev_b32 v31, 16, v31
    v_mul_f32 v31, v31, v19
    v_cvt_pk_bf16_f32 v31, v31, v31
    v_lshlrev_b32 v31, 16, v31
    v_add_f32 v31, v31, v27
    v_cvt_pk_bf16_f32 v164, v28, v29
    v_cvt_pk_bf16_f32 v165, v30, v31
    buffer_store_dwordx2 v[164:165], v5, s[52:55], s67 offen
OTD_144:
    s_branch OU_LOOP
OU_END:
    s_cmp_lg_u32 s12, 2
    s_cbranch_scc1 OU_X
    v_mov_b32 v8, 0
    s_mov_b32 s64, 0x298100
OUW_146:
    buffer_load_dword v7, v8, s[4:7], s64 offen sc1
    s_add_u32 s29, s29, 1
    s_waitcnt vmcnt(0)
    v_cmp_gt_u32 vcc, 40, v7
    s_cbranch_vccz OUWD_147
    s_cmp_gt_u32 s29, 262144
    s_cbranch_scc1 OUWD_147
    s_sleep 8
    s_branch OUW_146
OUWD_147:
    s_mov_b32 s24, 62
    s_mov_b32 s87, 0
    s_and_b32 s86, s14, 1
    s_lshl_b32 s64, s87, 4
    v_and_b32 v6, 15, v0
    v_add_u32 v6, s64, v6
    v_mov_b32 v9, v6
    v_mul_u32_u24 v5, 1280, v6
    v_lshrrev_b32 v6, 4, v0
    v_lshl_add_u32 v5, v6, 3, v5
    s_and_b32 s64, s14, 1
    s_lshl_b32 s64, s64, 5
    s_lshl_b32 s65, s13, 6
    s_add_u32 s64, s64, s65
    v_add_u32 v5, s64, v5
    v_lshlrev_b32 v6, 2, v0
    s_mul_i32 s67, s24, 40960
    buffer_load_dwordx2 v[160:161], v5, s[48:51], s67 offen
    s_add_u32 s64, s67, 0x0
    buffer_load_dwordx2 v[162:163], v5, s[4:7], s64 offen
    s_lshl_b32 s64, s24, 7
    s_add_u32 s64, s64, 0x296000
    s_mov_b64 exec, s[36:37]
OUH_F_148:
    buffer_load_dword v7, v6, s[4:7], s64 offen sc1
    s_add_u32 s29, s29, 1
    s_waitcnt vmcnt(0)
    v_cmp_eq_u32 vcc, 0, v7
    s_cbranch_vccz OUH_FD_149
    s_cmp_gt_u32 s29, 262144
    s_cbranch_scc1 OUH_FD_149
    s_sleep 1
    s_branch OUH_F_148
OUH_FD_149:
    s_mov_b64 exec, -1
    s_lshl_b32 s25, s24, 18
    s_lshl_b32 s64, s14, 15
    s_add_u32 s25, s25, s64
    s_add_u32 s25, s25, 0x4400000
    s_lshl_b32 s64, s87, 17
    s_add_u32 s25, s25, s64
    s_add_u32 s64, s25, 0x0
    buffer_load_dwordx4 v[16:19], v1, s[4:7], s64 offen
    s_add_u32 s64, s25, 0x400
    buffer_load_dwordx4 v[20:23], v1, s[4:7], s64 offen
    s_add_u32 s64, s25, 0x800
    buffer_load_dwordx4 v[24:27], v1, s[4:7], s64 offen
    s_add_u32 s64, s25, 0xc00
    buffer_load_dwordx4 v[28:31], v1, s[4:7], s64 offen
    s_add_u32 s64, s25, 0x1000
    buffer_load_dwordx4 v[32:35], v1, s[4:7], s64 offen
    s_add_u32 s64, s25, 0x1400
    buffer_load_dwordx4 v[36:39], v1, s[4:7], s64 offen
    s_add_u32 s64, s25, 0x1800
    buffer_load_dwordx4 v[40:43], v1, s[4:7], s64 offen
    s_add_u32 s64, s25, 0x1c00
    buffer_load_dwordx4 v[44:47], v1, s[4:7], s64 offen
    s_add_u32 s64, s25, 0x2000
    buffer_load_dwordx4 v[48:51], v1, s[4:7], s64 offen
    s_add_u32 s64, s25, 0x2400
    buffer_load_dwordx4 v[52:55], v1, s[4:7], s64 offen
    s_add_u32 s64, s25, 0x2800
    buffer_load_dwordx4 v[56:59], v1, s[4:7], s64 offen
    s_add_u32 s64, s25, 0x2c00
    buffer_load_dwordx4 v[60:63], v1, s[4:7], s64 offen
    s_add_u32 s64, s25, 0x3000
    buffer_load_dwordx4 v[64:67], v1, s[4:7], s64 offen
    s_add_u32 s64, s25, 0x3400
    buffer_load_dwordx4 v[68:71], v1, s[4:7], s64 offen
    s_add_u32 s64, s25, 0x3800
    buffer_load_dwordx4 v[72:75], v1, s[4:7], s64 offen
    s_add_u32 s64, s25, 0x3c00
    buffer_load_dwordx4 v[76:79], v1, s[4:7], s64 offen
    s_add_u32 s64, s25, 0x4000
    buffer_load_dwordx4 v[80:83], v1, s[4:7], s64 offen
    s_add_u32 s64, s25, 0x4400
    buffer_load_dwordx4 v[84:87], v1, s[4:7], s64 offen
    s_add_u32 s64, s25, 0x4800
    buffer_load_dwordx4 v[88:91], v1, s[4:7], s64 offen
    s_add_u32 s64, s25, 0x4c00
    buffer_load_dwordx4 v[92:95], v1, s[4:7], s64 offen
    s_add_u32 s64, s25, 0x5000
    buffer_load_dwordx4 v[96:99], v1, s[4:7], s64 offen
    s_add_u32 s64, s25, 0x5400
    buffer_load_dwordx4 v[100:103], v1, s[4:7], s64 offen
    s_add_u32 s64, s25, 0x5800
    buffer_load_dwordx4 v[104:107], v1, s[4:7], s64 offen
    s_add_u32 s64, s25, 0x5c00
    buffer_load_dwordx4 v[108:111], v1, s[4:7], s64 offen
    s_add_u32 s64, s25, 0x6000
    buffer_load_dwordx4 v[112:115], v1, s[4:7], s64 offen
    s_add_u32 s64, s25, 0x6400
    buffer_load_dwordx4 v[116:119], v1, s[4:7], s64 offen
    s_add_u32 s64, s25, 0x6800
    buffer_load_dwordx4 v[120:123], v1, s[4:7], s64 offen
    s_add_u32 s64, s25, 0x6c00
    buffer_load_dwordx4 v[124:127], v1, s[4:7], s64 offen
    s_add_u32 s64, s25, 0x7000
    buffer_load_dwordx4 v[128:131], v1, s[4:7], s64 offen
    s_add_u32 s64, s25, 0x7400
    buffer_load_dwordx4 v[132:135], v1, s[4:7], s64 offen
    s_add_u32 s64, s25, 0x7800
    buffer_load_dwordx4 v[136:139], v1, s[4:7], s64 offen
    s_add_u32 s64, s25, 0x7c00
    buffer_load_dwordx4 v[140:143], v1, s[4:7], s64 offen
    s_waitcnt vmcnt(31)
    v_mfma_f32_16x16x32_bf16 v[144:147], a[0:3], v[16:19], 0
    v_mfma_f32_16x16x32_bf16 v[148:151], a[4:7], v[16:19], 0
    s_waitcnt vmcnt(30)
    v_mfma_f32_16x16x32_bf16 v[144:147], a[8:11], v[20:23], v[144:147]
    v_mfma_f32_16x16x32_bf16 v[148:151], a[12:15], v[20:23], v[148:151]
    s_waitcnt vmcnt(29)
    v_mfma_f32_16x16x32_bf16 v[144:147], a[16:19], v[24:27], v[144:147]
    v_mfma_f32_16x16x32_bf16 v[148:151], a[20:23], v[24:27], v[148:151]
    s_waitcnt vmcnt(28)
    v_mfma_f32_16x16x32_bf16 v[144:147], a[24:27], v[28:31], v[144:147]
    v_mfma_f32_16x16x32_bf16 v[148:151], a[28:31], v[28:31], v[148:151]
    s_waitcnt vmcnt(27)
    v_mfma_f32_16x16x32_bf16 v[144:147], a[32:35], v[32:35], v[144:147]
    v_mfma_f32_16x16x32_bf16 v[148:151], a[36:39], v[32:35], v[148:151]
    s_waitcnt vmcnt(26)
    v_mfma_f32_16x16x32_bf16 v[144:147], a[40:43], v[36:39], v[144:147]
    v_mfma_f32_16x16x32_bf16 v[148:151], a[44:47], v[36:39], v[148:151]
    s_waitcnt vmcnt(25)
    v_mfma_f32_16x16x32_bf16 v[144:147], a[48:51], v[40:43], v[144:147]
    v_mfma_f32_16x16x32_bf16 v[148:151], a[52:55], v[40:43], v[148:151]
    s_waitcnt vmcnt(24)
    v_mfma_f32_16x16x32_bf16 v[144:147], a[56:59], v[44:47], v[144:147]
    v_mfma_f32_16x16x32_bf16 v[148:151], a[60:63], v[44:47], v[148:151]
    s_waitcnt vmcnt(23)
    v_mfma_f32_16x16x32_bf16 v[144:147], a[64:67], v[48:51], v[144:147]
    v_mfma_f32_16x16x32_bf16 v[148:151], a[68:71], v[48:51], v[148:151]
    s_waitcnt vmcnt(22)
    v_mfma_f32_16x16x32_bf16 v[144:147], a[72:75], v[52:55], v[144:147]
    v_mfma_f32_16x16x32_bf16 v[148:151], a[76:79], v[52:55], v[148:151]
    s_waitcnt vmcnt(21)
    v_mfma_f32_16x16x32_bf16 v[144:147], a[80:83], v[56:59], v[144:147]
    v_mfma_f32_16x16x32_bf16 v[148:151], a[84:87], v[56:59], v[148:151]
    s_waitcnt vmcnt(20)
    v_mfma_f32_16x16x32_bf16 v[144:147], a[88:91], v[60:63], v[144:147]
    v_mfma_f32_16x16x32_bf16 v[148:151], a[92:95], v[60:63], v[148:151]
    s_waitcnt vmcnt(19)
    v_mfma_f32_16x16x32_bf16 v[144:147], a[96:99], v[64:67], v[144:147]
    v_mfma_f32_16x16x32_bf16 v[148:151], a[100:103], v[64:67], v[148:151]
    s_waitcnt vmcnt(18)
    v_mfma_f32_16x16x32_bf16 v[144:147], a[104:107], v[68:71], v[144:147]
    v_mfma_f32_16x16x32_bf16 v[148:151], a[108:111], v[68:71], v[148:151]
    s_waitcnt vmcnt(17)
    v_mfma_f32_16x16x32_bf16 v[144:147], a[112:115], v[72:75], v[144:147]
    v_mfma_f32_16x16x32_bf16 v[148:151], a[116:119], v[72:75], v[148:151]
    s_waitcnt vmcnt(16)
    v_mfma_f32_16x16x32_bf16 v[144:147], a[120:123], v[76:79], v[144:147]
    v_mfma_f32_16x16x32_bf16 v[148:151], a[124:127], v[76:79], v[148:151]
    s_waitcnt vmcnt(15)
    v_mfma_f32_16x16x32_bf16 v[144:147], a[128:131], v[80:83], v[144:147]
    v_mfma_f32_16x16x32_bf16 v[148:151], a[132:135], v[80:83], v[148:151]
    s_waitcnt vmcnt(14)
    v_mfma_f32_16x16x32_bf16 v[144:147], a[136:139], v[84:87], v[144:147]
    v_mfma_f32_16x16x32_bf16 v[148:151], a[140:143], v[84:87], v[148:151]
    s_waitcnt vmcnt(13)
    v_mfma_f32_16x16x32_bf16 v[144:147], a[144:147], v[88:91], v[144:147]
    v_mfma_f32_16x16x32_bf16 v[148:151], a[148:151], v[88:91], v[148:151]
    s_waitcnt vmcnt(12)
    v_mfma_f32_16x16x32_bf16 v[144:147], a[152:155], v[92:95], v[144:147]
    v_mfma_f32_16x16x32_bf16 v[148:151], a[156:159], v[92:95], v[148:151]
    s_waitcnt vmcnt(11)
    v_mfma_f32_16x16x32_bf16 v[144:147], a[160:163], v[96:99], v[144:147]
    v_mfma_f32_16x16x32_bf16 v[148:151], a[164:167], v[96:99], v[148:151]
    s_waitcnt vmcnt(10)
    v_mfma_f32_16x16x32_bf16 v[144:147], a[168:171], v[100:103], v[144:147]
    v_mfma_f32_16x16x32_bf16 v[148:151], a[172:175], v[100:103], v[148:151]
    s_waitcnt vmcnt(9)
    v_mfma_f32_16x16x32_bf16 v[144:147], a[176:179], v[104:107], v[144:147]
    v_mfma_f32_16x16x32_bf16 v[148:151], a[180:183], v[104:107], v[148:151]
    s_waitcnt vmcnt(8)
    v_mfma_f32_16x16x32_bf16 v[144:147], a[184:187], v[108:111], v[144:147]
    v_mfma_f32_16x16x32_bf16 v[148:151], a[188:191], v[108:111], v[148:151]
    s_waitcnt vmcnt(7)
    v_mfma_f32_16x16x32_bf16 v[144:147], a[192:195], v[112:115], v[144:147]
    v_mfma_f32_16x16x32_bf16 v[148:151], a[196:199], v[112:115], v[148:151]
    s_waitcnt vmcnt(6)
    v_mfma_f32_16x16x32_bf16 v[144:147], a[200:203], v[116:119], v[144:147]
    v_mfma_f32_16x16x32_bf16 v[148:151], a[204:207], v[116:119], v[148:151]
    s_waitcnt vmcnt(5)
    v_mfma_f32_16x16x32_bf16 v[144:147], a[208:211], v[120:123], v[144:147]
    v_mfma_f32_16x16x32_bf16 v[148:151], a[212:215], v[120:123], v[148:151]
    s_waitcnt vmcnt(4)
    v_mfma_f32_16x16x32_bf16 v[144:147], a[216:219], v[124:127], v[144:147]
    v_mfma_f32_16x16x32_bf16 v[148:151], a[220:223], v[124:127], v[148:151]
    s_waitcnt vmcnt(3)
    v_mfma_f32_16x16x32_bf16 v[144:147], a[224:227], v[128:131], v[144:147]
    v_mfma_f32_16x16x32_bf16 v[148:151], a[228:231], v[128:131], v[148:151]
    s_waitcnt vmcnt(2)
    v_mfma_f32_16x16x32_bf16 v[144:147], a[232:235], v[132:135], v[144:147]
    v_mfma_f32_16x16x32_bf16 v[148:151], a[236:239], v[132:135], v[148:151]
    s_waitcnt vmcnt(1)
    v_mfma_f32_16x16x32_bf16 v[144:147], a[240:243], v[136:139], v[144:147]
    v_mfma_f32_16x16x32_bf16 v[148:151], a[244:247], v[136:139], v[148:151]
    s_waitcnt vmcnt(0)
    v_mfma_f32_16x16x32_bf16 v[144:147], a[248:251], v[140:143], v[144:147]
    v_mfma_f32_16x16x32_bf16 v[148:151], a[252:255], v[140:143], v[148:151]
    s_lshl_b32 s64, s14, 12
    v_add_u32 v7, s64, v1
    s_barrier
    s_nop 3
    ds_write_b128 v7, v[144:147] offset:0
    ds_write_b128 v7, v[148:151] offset:1024
    s_waitcnt lgkmcnt(0)
    s_barrier
    s_cmp_ge_u32 s14, 2
    s_cbranch_scc1 OTD_150
    s_lshl_b32 s64, s14, 10
    v_add_u32 v7, s64, v1
    ds_read_b128 v[16:19], v7 offset:0
    ds_read_b128 v[20:23], v7 offset:4096
    ds_read_b128 v[24:27], v7 offset:8192
    ds_read_b128 v[28:31], v7 offset:12288
    s_waitcnt lgkmcnt(0)
    v_add_f32 v16, v16, v20
    v_add_f32 v24, v24, v28
    v_add_f32 v16, v16, v24
    v_add_f32 v17, v17, v21
    v_add_f32 v25, v25, v29
    v_add_f32 v17, v17, v25
    v_add_f32 v18, v18, v22
    v_add_f32 v26, v26, v30
    v_add_f32 v18, v18, v26
    v_add_f32 v19, v19, v23
    v_add_f32 v27, v27, v31
    v_add_f32 v19, v19, v27
    v_cvt_pk_bf16_f32 v16, v16, v16
    v_lshlrev_b32 v16, 16, v16
    v_cvt_pk_bf16_f32 v17, v17, v17
    v_lshlrev_b32 v17, 16, v17
    v_cvt_pk_bf16_f32 v18, v18, v18
    v_lshlrev_b32 v18, 16, v18
    v_cvt_pk_bf16_f32 v19, v19, v19
    v_lshlrev_b32 v19, 16, v19
    v_lshlrev_b32 v20, 16, v162
    v_and_b32 v21, 0xffff0000, v162
    v_lshlrev_b32 v24, 16, v160
    v_and_b32 v25, 0xffff0000, v160
    v_lshlrev_b32 v22, 16, v163
    v_and_b32 v23, 0xffff0000, v163
    v_lshlrev_b32 v26, 16, v161
    v_and_b32 v27, 0xffff0000, v161
    s_lshl_b32 s64, s24, 5
    v_add_u32 v8, s64, v9
    v_mov_b32 v10, -1
    v_cmp_eq_u32 vcc, s72, v8
    s_nop 1
    v_cndmask_b32 v10, v10, 0, vcc
    v_cmp_eq_u32 vcc, s73, v8
    s_nop 1
    v_cndmask_b32 v10, v10, 1, vcc
    v_cmp_eq_u32 vcc, s74, v8
    s_nop 1
    v_cndmask_b32 v10, v10, 2, vcc
    v_cmp_eq_u32 vcc, s75, v8
    s_nop 1
    v_cndmask_b32 v10, v10, 3, vcc
    v_cmp_eq_u32 vcc, s76, v8
    s_nop 1
    v_cndmask_b32 v10, v10, 4, vcc
    v_cmp_eq_u32 vcc, s77, v8
    s_nop 1
    v_cndmask_b32 v10, v10, 5, vcc
    v_cmp_eq_u32 vcc, s78, v8
    s_nop 1
    v_cndmask_b32 v10, v10, 6, vcc
    v_cmp_eq_u32 vcc, s79, v8
    s_nop 1
    v_cndmask_b32 v10, v10, 7, vcc
    v_cmp_le_i32 vcc, 0, v10
    s_and_saveexec_b64 s[68:69], vcc
    s_cbranch_execz NOUPD_151
    v_mul_u32_u24 v10, 2560, v10
    v_lshrrev_b32 v11, 4, v0
    v_lshl_add_u32 v10, v11, 4, v10
    s_lshl_b32 s64, s86, 6
    s_lshl_b32 s65, s13, 7
    s_add_u32 s64, s64, s65
    s_add_u32 s64, s64, 0x5410000
    buffer_load_dwordx4 v[164:167], v10, s[4:7], s64 offen sc1
    s_waitcnt vmcnt(0)
    v_add_f32 v20, v20, v164
    v_cvt_pk_bf16_f32 v20, v20, v20
    v_lshlrev_b32 v20, 16, v20
    v_add_f32 v21, v21, v165
    v_cvt_pk_bf16_f32 v21, v21, v21
    v_lshlrev_b32 v21, 16, v21
    v_add_f32 v22, v22, v166
    v_cvt_pk_bf16_f32 v22, v22, v22
    v_lshlrev_b32 v22, 16, v22
    v_add_f32 v23, v23, v167
    v_cvt_pk_bf16_f32 v23, v23, v23
    v_lshlrev_b32 v23, 16, v23
NOUPD_151:
    s_mov_b64 exec, -1
    v_mul_f32 v28, 0xbfb8aa3b, v20
    v_exp_f32 v28, v28
    s_nop 0
    v_add_f32 v28, 1.0, v28
    v_rcp_f32 v28, v28
    s_nop 0
    v_mul_f32 v28, v28, v20
    v_cvt_pk_bf16_f32 v28, v28, v28
    v_lshlrev_b32 v28, 16, v28
    v_mul_f32 v28, v28, v16
    v_cvt_pk_bf16_f32 v28, v28, v28
    v_lshlrev_b32 v28, 16, v28
    v_add_f32 v28, v28, v24
    v_mul_f32 v29, 0xbfb8aa3b, v21
    v_exp_f32 v29, v29
    s_nop 0
    v_add_f32 v29, 1.0, v29
    v_rcp_f32 v29, v29
    s_nop 0
    v_mul_f32 v29, v29, v21
    v_cvt_pk_bf16_f32 v29, v29, v29
    v_lshlrev_b32 v29, 16, v29
    v_mul_f32 v29, v29, v17
    v_cvt_pk_bf16_f32 v29, v29, v29
    v_lshlrev_b32 v29, 16, v29
    v_add_f32 v29, v29, v25
    v_mul_f32 v30, 0xbfb8aa3b, v22
    v_exp_f32 v30, v30
    s_nop 0
    v_add_f32 v30, 1.0, v30
    v_rcp_f32 v30, v30
    s_nop 0
    v_mul_f32 v30, v30, v22
    v_cvt_pk_bf16_f32 v30, v30, v30
    v_lshlrev_b32 v30, 16, v30
    v_mul_f32 v30, v30, v18
    v_cvt_pk_bf16_f32 v30, v30, v30
    v_lshlrev_b32 v30, 16, v30
    v_add_f32 v30, v30, v26
    v_mul_f32 v31, 0xbfb8aa3b, v23
    v_exp_f32 v31, v31
    s_nop 0
    v_add_f32 v31, 1.0, v31
    v_rcp_f32 v31, v31
    s_nop 0
    v_mul_f32 v31, v31, v23
    v_cvt_pk_bf16_f32 v31, v31, v31
    v_lshlrev_b32 v31, 16, v31
    v_mul_f32 v31, v31, v19
    v_cvt_pk_bf16_f32 v31, v31, v31
    v_lshlrev_b32 v31, 16, v31
    v_add_f32 v31, v31, v27
    v_cvt_pk_bf16_f32 v164, v28, v29
    v_cvt_pk_bf16_f32 v165, v30, v31
    buffer_store_dwordx2 v[164:165], v5, s[52:55], s67 offen
OTD_150:
OU_X:
    s_branch M_EXIT
H_EXTRA:
    s_mul_hi_u32 s12, s88, 0xccccccd
    s_mul_i32 s65, s12, 20
    s_sub_u32 s13, s88, s65
    s_add_u32 s12, s12, 3
    s_load_dwordx2 s[48:49], s[0:1], 0
    s_mov_b32 s50, 0x280000
    s_mov_b32 s51, 0x00020000
    s_load_dwordx2 s[52:53], s[0:1], 96
    s_mov_b32 s54, 0x280000
    s_mov_b32 s55, 0x00020000
    s_mov_b32 s36, -1
    s_mov_b32 s37, 0
    s_waitcnt lgkmcnt(0)
    v_mbcnt_lo_u32_b32 v0, -1, 0
    v_mbcnt_hi_u32_b32 v0, -1, v0
    s_mov_b32 s29, 0
    v_lshlrev_b32 v1, 4, v0
    v_lshlrev_b32 v6, 2, v0
    v_mov_b32 v8, 0
    s_mov_b32 s64, 0x298100
OXW_152:
    buffer_load_dword v7, v8, s[4:7], s64 offen sc1
    s_add_u32 s29, s29, 1
    s_waitcnt vmcnt(0)
    v_cmp_gt_u32 vcc, 40, v7
    s_cbranch_vccz OXWD_153
    s_cmp_gt_u32 s29, 262144
    s_cbranch_scc1 OXWD_153
    s_sleep 8
    s_branch OXW_152
OXWD_153:
    v_lshlrev_b32 v6, 2, v0
    s_mov_b32 s64, 0x5400000
    buffer_load_dword v7, v6, s[4:7], s64 offen sc1
    s_waitcnt vmcnt(0)
    v_readlane_b32 s72, v7, 0
    v_readlane_b32 s73, v7, 1
    v_readlane_b32 s74, v7, 2
    v_readlane_b32 s75, v7, 3
    v_readlane_b32 s76, v7, 4
    v_readlane_b32 s77, v7, 5
    v_readlane_b32 s78, v7, 6
    v_readlane_b32 s79, v7, 7
    s_cmp_eq_u32 s12, 3
    s_cselect_b32 s24, 62, 63
    s_cmp_eq_u32 s12, 4
    s_cselect_b32 s87, 0, 1
    s_and_b32 s86, s14, 1
    s_lshl_b32 s64, s87, 4
    v_and_b32 v6, 15, v0
    v_add_u32 v6, s64, v6
    v_mov_b32 v9, v6
    v_mul_u32_u24 v5, 1280, v6
    v_lshrrev_b32 v6, 4, v0
    v_lshl_add_u32 v5, v6, 3, v5
    s_and_b32 s64, s14, 1
    s_lshl_b32 s64, s64, 5
    s_lshl_b32 s65, s13, 6
    s_add_u32 s64, s64, s65
    v_add_u32 v5, s64, v5
    v_lshlrev_b32 v6, 2, v0
    s_mul_i32 s67, s24, 40960
    buffer_load_dwordx2 v[160:161], v5, s[48:51], s67 offen
    s_add_u32 s64, s67, 0x0
    buffer_load_dwordx2 v[162:163], v5, s[4:7], s64 offen
    s_lshl_b32 s64, s24, 7
    s_add_u32 s64, s64, 0x296000
    s_mov_b64 exec, s[36:37]
OX_F_154:
    buffer_load_dword v7, v6, s[4:7], s64 offen sc1
    s_add_u32 s29, s29, 1
    s_waitcnt vmcnt(0)
    v_cmp_eq_u32 vcc, 0, v7
    s_cbranch_vccz OX_FD_155
    s_cmp_gt_u32 s29, 262144
    s_cbranch_scc1 OX_FD_155
    s_sleep 1
    s_branch OX_F_154
OX_FD_155:
    s_mov_b64 exec, -1
    s_lshl_b32 s25, s24, 18
    s_lshl_b32 s64, s14, 15
    s_add_u32 s25, s25, s64
    s_add_u32 s25, s25, 0x4400000
    s_lshl_b32 s64, s87, 17
    s_add_u32 s25, s25, s64
    s_add_u32 s64, s25, 0x0
    buffer_load_dwordx4 v[16:19], v1, s[4:7], s64 offen
    s_add_u32 s64, s25, 0x400
    buffer_load_dwordx4 v[20:23], v1, s[4:7], s64 offen
    s_add_u32 s64, s25, 0x800
    buffer_load_dwordx4 v[24:27], v1, s[4:7], s64 offen
    s_add_u32 s64, s25, 0xc00
    buffer_load_dwordx4 v[28:31], v1, s[4:7], s64 offen
    s_add_u32 s64, s25, 0x1000
    buffer_load_dwordx4 v[32:35], v1, s[4:7], s64 offen
    s_add_u32 s64, s25, 0x1400
    buffer_load_dwordx4 v[36:39], v1, s[4:7], s64 offen
    s_add_u32 s64, s25, 0x1800
    buffer_load_dwordx4 v[40:43], v1, s[4:7], s64 offen
    s_add_u32 s64, s25, 0x1c00
    buffer_load_dwordx4 v[44:47], v1, s[4:7], s64 offen
    s_add_u32 s64, s25, 0x2000
    buffer_load_dwordx4 v[48:51], v1, s[4:7], s64 offen
    s_add_u32 s64, s25, 0x2400
    buffer_load_dwordx4 v[52:55], v1, s[4:7], s64 offen
    s_add_u32 s64, s25, 0x2800
    buffer_load_dwordx4 v[56:59], v1, s[4:7], s64 offen
    s_add_u32 s64, s25, 0x2c00
    buffer_load_dwordx4 v[60:63], v1, s[4:7], s64 offen
    s_add_u32 s64, s25, 0x3000
    buffer_load_dwordx4 v[64:67], v1, s[4:7], s64 offen
    s_add_u32 s64, s25, 0x3400
    buffer_load_dwordx4 v[68:71], v1, s[4:7], s64 offen
    s_add_u32 s64, s25, 0x3800
    buffer_load_dwordx4 v[72:75], v1, s[4:7], s64 offen
    s_add_u32 s64, s25, 0x3c00
    buffer_load_dwordx4 v[76:79], v1, s[4:7], s64 offen
    s_add_u32 s64, s25, 0x4000
    buffer_load_dwordx4 v[80:83], v1, s[4:7], s64 offen
    s_add_u32 s64, s25, 0x4400
    buffer_load_dwordx4 v[84:87], v1, s[4:7], s64 offen
    s_add_u32 s64, s25, 0x4800
    buffer_load_dwordx4 v[88:91], v1, s[4:7], s64 offen
    s_add_u32 s64, s25, 0x4c00
    buffer_load_dwordx4 v[92:95], v1, s[4:7], s64 offen
    s_add_u32 s64, s25, 0x5000
    buffer_load_dwordx4 v[96:99], v1, s[4:7], s64 offen
    s_add_u32 s64, s25, 0x5400
    buffer_load_dwordx4 v[100:103], v1, s[4:7], s64 offen
    s_add_u32 s64, s25, 0x5800
    buffer_load_dwordx4 v[104:107], v1, s[4:7], s64 offen
    s_add_u32 s64, s25, 0x5c00
    buffer_load_dwordx4 v[108:111], v1, s[4:7], s64 offen
    s_add_u32 s64, s25, 0x6000
    buffer_load_dwordx4 v[112:115], v1, s[4:7], s64 offen
    s_add_u32 s64, s25, 0x6400
    buffer_load_dwordx4 v[116:119], v1, s[4:7], s64 offen
    s_add_u32 s64, s25, 0x6800
    buffer_load_dwordx4 v[120:123], v1, s[4:7], s64 offen
    s_add_u32 s64, s25, 0x6c00
    buffer_load_dwordx4 v[124:127], v1, s[4:7], s64 offen
    s_add_u32 s64, s25, 0x7000
    buffer_load_dwordx4 v[128:131], v1, s[4:7], s64 offen
    s_add_u32 s64, s25, 0x7400
    buffer_load_dwordx4 v[132:135], v1, s[4:7], s64 offen
    s_add_u32 s64, s25, 0x7800
    buffer_load_dwordx4 v[136:139], v1, s[4:7], s64 offen
    s_add_u32 s64, s25, 0x7c00
    buffer_load_dwordx4 v[140:143], v1, s[4:7], s64 offen
    s_waitcnt vmcnt(31)
    v_mfma_f32_16x16x32_bf16 v[144:147], a[0:3], v[16:19], 0
    v_mfma_f32_16x16x32_bf16 v[148:151], a[4:7], v[16:19], 0
    s_waitcnt vmcnt(30)
    v_mfma_f32_16x16x32_bf16 v[144:147], a[8:11], v[20:23], v[144:147]
    v_mfma_f32_16x16x32_bf16 v[148:151], a[12:15], v[20:23], v[148:151]
    s_waitcnt vmcnt(29)
    v_mfma_f32_16x16x32_bf16 v[144:147], a[16:19], v[24:27], v[144:147]
    v_mfma_f32_16x16x32_bf16 v[148:151], a[20:23], v[24:27], v[148:151]
    s_waitcnt vmcnt(28)
    v_mfma_f32_16x16x32_bf16 v[144:147], a[24:27], v[28:31], v[144:147]
    v_mfma_f32_16x16x32_bf16 v[148:151], a[28:31], v[28:31], v[148:151]
    s_waitcnt vmcnt(27)
    v_mfma_f32_16x16x32_bf16 v[144:147], a[32:35], v[32:35], v[144:147]
    v_mfma_f32_16x16x32_bf16 v[148:151], a[36:39], v[32:35], v[148:151]
    s_waitcnt vmcnt(26)
    v_mfma_f32_16x16x32_bf16 v[144:147], a[40:43], v[36:39], v[144:147]
    v_mfma_f32_16x16x32_bf16 v[148:151], a[44:47], v[36:39], v[148:151]
    s_waitcnt vmcnt(25)
    v_mfma_f32_16x16x32_bf16 v[144:147], a[48:51], v[40:43], v[144:147]
    v_mfma_f32_16x16x32_bf16 v[148:151], a[52:55], v[40:43], v[148:151]
    s_waitcnt vmcnt(24)
    v_mfma_f32_16x16x32_bf16 v[144:147], a[56:59], v[44:47], v[144:147]
    v_mfma_f32_16x16x32_bf16 v[148:151], a[60:63], v[44:47], v[148:151]
    s_waitcnt vmcnt(23)
    v_mfma_f32_16x16x32_bf16 v[144:147], a[64:67], v[48:51], v[144:147]
    v_mfma_f32_16x16x32_bf16 v[148:151], a[68:71], v[48:51], v[148:151]
    s_waitcnt vmcnt(22)
    v_mfma_f32_16x16x32_bf16 v[144:147], a[72:75], v[52:55], v[144:147]
    v_mfma_f32_16x16x32_bf16 v[148:151], a[76:79], v[52:55], v[148:151]
    s_waitcnt vmcnt(21)
    v_mfma_f32_16x16x32_bf16 v[144:147], a[80:83], v[56:59], v[144:147]
    v_mfma_f32_16x16x32_bf16 v[148:151], a[84:87], v[56:59], v[148:151]
    s_waitcnt vmcnt(20)
    v_mfma_f32_16x16x32_bf16 v[144:147], a[88:91], v[60:63], v[144:147]
    v_mfma_f32_16x16x32_bf16 v[148:151], a[92:95], v[60:63], v[148:151]
    s_waitcnt vmcnt(19)
    v_mfma_f32_16x16x32_bf16 v[144:147], a[96:99], v[64:67], v[144:147]
    v_mfma_f32_16x16x32_bf16 v[148:151], a[100:103], v[64:67], v[148:151]
    s_waitcnt vmcnt(18)
    v_mfma_f32_16x16x32_bf16 v[144:147], a[104:107], v[68:71], v[144:147]
    v_mfma_f32_16x16x32_bf16 v[148:151], a[108:111], v[68:71], v[148:151]
    s_waitcnt vmcnt(17)
    v_mfma_f32_16x16x32_bf16 v[144:147], a[112:115], v[72:75], v[144:147]
    v_mfma_f32_16x16x32_bf16 v[148:151], a[116:119], v[72:75], v[148:151]
    s_waitcnt vmcnt(16)
    v_mfma_f32_16x16x32_bf16 v[144:147], a[120:123], v[76:79], v[144:147]
    v_mfma_f32_16x16x32_bf16 v[148:151], a[124:127], v[76:79], v[148:151]
    s_waitcnt vmcnt(15)
    v_mfma_f32_16x16x32_bf16 v[144:147], a[128:131], v[80:83], v[144:147]
    v_mfma_f32_16x16x32_bf16 v[148:151], a[132:135], v[80:83], v[148:151]
    s_waitcnt vmcnt(14)
    v_mfma_f32_16x16x32_bf16 v[144:147], a[136:139], v[84:87], v[144:147]
    v_mfma_f32_16x16x32_bf16 v[148:151], a[140:143], v[84:87], v[148:151]
    s_waitcnt vmcnt(13)
    v_mfma_f32_16x16x32_bf16 v[144:147], a[144:147], v[88:91], v[144:147]
    v_mfma_f32_16x16x32_bf16 v[148:151], a[148:151], v[88:91], v[148:151]
    s_waitcnt vmcnt(12)
    v_mfma_f32_16x16x32_bf16 v[144:147], a[152:155], v[92:95], v[144:147]
    v_mfma_f32_16x16x32_bf16 v[148:151], a[156:159], v[92:95], v[148:151]
    s_waitcnt vmcnt(11)
    v_mfma_f32_16x16x32_bf16 v[144:147], a[160:163], v[96:99], v[144:147]
    v_mfma_f32_16x16x32_bf16 v[148:151], a[164:167], v[96:99], v[148:151]
    s_waitcnt vmcnt(10)
    v_mfma_f32_16x16x32_bf16 v[144:147], a[168:171], v[100:103], v[144:147]
    v_mfma_f32_16x16x32_bf16 v[148:151], a[172:175], v[100:103], v[148:151]
    s_waitcnt vmcnt(9)
    v_mfma_f32_16x16x32_bf16 v[144:147], a[176:179], v[104:107], v[144:147]
    v_mfma_f32_16x16x32_bf16 v[148:151], a[180:183], v[104:107], v[148:151]
    s_waitcnt vmcnt(8)
    v_mfma_f32_16x16x32_bf16 v[144:147], a[184:187], v[108:111], v[144:147]
    v_mfma_f32_16x16x32_bf16 v[148:151], a[188:191], v[108:111], v[148:151]
    s_waitcnt vmcnt(7)
    v_mfma_f32_16x16x32_bf16 v[144:147], a[192:195], v[112:115], v[144:147]
    v_mfma_f32_16x16x32_bf16 v[148:151], a[196:199], v[112:115], v[148:151]
    s_waitcnt vmcnt(6)
    v_mfma_f32_16x16x32_bf16 v[144:147], a[200:203], v[116:119], v[144:147]
    v_mfma_f32_16x16x32_bf16 v[148:151], a[204:207], v[116:119], v[148:151]
    s_waitcnt vmcnt(5)
    v_mfma_f32_16x16x32_bf16 v[144:147], a[208:211], v[120:123], v[144:147]
    v_mfma_f32_16x16x32_bf16 v[148:151], a[212:215], v[120:123], v[148:151]
    s_waitcnt vmcnt(4)
    v_mfma_f32_16x16x32_bf16 v[144:147], a[216:219], v[124:127], v[144:147]
    v_mfma_f32_16x16x32_bf16 v[148:151], a[220:223], v[124:127], v[148:151]
    s_waitcnt vmcnt(3)
    v_mfma_f32_16x16x32_bf16 v[144:147], a[224:227], v[128:131], v[144:147]
    v_mfma_f32_16x16x32_bf16 v[148:151], a[228:231], v[128:131], v[148:151]
    s_waitcnt vmcnt(2)
    v_mfma_f32_16x16x32_bf16 v[144:147], a[232:235], v[132:135], v[144:147]
    v_mfma_f32_16x16x32_bf16 v[148:151], a[236:239], v[132:135], v[148:151]
    s_waitcnt vmcnt(1)
    v_mfma_f32_16x16x32_bf16 v[144:147], a[240:243], v[136:139], v[144:147]
    v_mfma_f32_16x16x32_bf16 v[148:151], a[244:247], v[136:139], v[148:151]
    s_waitcnt vmcnt(0)
    v_mfma_f32_16x16x32_bf16 v[144:147], a[248:251], v[140:143], v[144:147]
    v_mfma_f32_16x16x32_bf16 v[148:151], a[252:255], v[140:143], v[148:151]
    s_lshl_b32 s64, s14, 12
    v_add_u32 v7, s64, v1
    s_barrier
    s_nop 3
    ds_write_b128 v7, v[144:147] offset:0
    ds_write_b128 v7, v[148:151] offset:1024
    s_waitcnt lgkmcnt(0)
    s_barrier
    s_cmp_ge_u32 s14, 2
    s_cbranch_scc1 OTD_156
    s_lshl_b32 s64, s14, 10
    v_add_u32 v7, s64, v1
    ds_read_b128 v[16:19], v7 offset:0
    ds_read_b128 v[20:23], v7 offset:4096
    ds_read_b128 v[24:27], v7 offset:8192
    ds_read_b128 v[28:31], v7 offset:12288
    s_waitcnt lgkmcnt(0)
    v_add_f32 v16, v16, v20
    v_add_f32 v24, v24, v28
    v_add_f32 v16, v16, v24
    v_add_f32 v17, v17, v21
    v_add_f32 v25, v25, v29
    v_add_f32 v17, v17, v25
    v_add_f32 v18, v18, v22
    v_add_f32 v26, v26, v30
    v_add_f32 v18, v18, v26
    v_add_f32 v19, v19, v23
    v_add_f32 v27, v27, v31
    v_add_f32 v19, v19, v27
    v_cvt_pk_bf16_f32 v16, v16, v16
    v_lshlrev_b32 v16, 16, v16
    v_cvt_pk_bf16_f32 v17, v17, v17
    v_lshlrev_b32 v17, 16, v17
    v_cvt_pk_bf16_f32 v18, v18, v18
    v_lshlrev_b32 v18, 16, v18
    v_cvt_pk_bf16_f32 v19, v19, v19
    v_lshlrev_b32 v19, 16, v19
    v_lshlrev_b32 v20, 16, v162
    v_and_b32 v21, 0xffff0000, v162
    v_lshlrev_b32 v24, 16, v160
    v_and_b32 v25, 0xffff0000, v160
    v_lshlrev_b32 v22, 16, v163
    v_and_b32 v23, 0xffff0000, v163
    v_lshlrev_b32 v26, 16, v161
    v_and_b32 v27, 0xffff0000, v161
    s_lshl_b32 s64, s24, 5
    v_add_u32 v8, s64, v9
    v_mov_b32 v10, -1
    v_cmp_eq_u32 vcc, s72, v8
    s_nop 1
    v_cndmask_b32 v10, v10, 0, vcc
    v_cmp_eq_u32 vcc, s73, v8
    s_nop 1
    v_cndmask_b32 v10, v10, 1, vcc
    v_cmp_eq_u32 vcc, s74, v8
    s_nop 1
    v_cndmask_b32 v10, v10, 2, vcc
    v_cmp_eq_u32 vcc, s75, v8
    s_nop 1
    v_cndmask_b32 v10, v10, 3, vcc
    v_cmp_eq_u32 vcc, s76, v8
    s_nop 1
    v_cndmask_b32 v10, v10, 4, vcc
    v_cmp_eq_u32 vcc, s77, v8
    s_nop 1
    v_cndmask_b32 v10, v10, 5, vcc
    v_cmp_eq_u32 vcc, s78, v8
    s_nop 1
    v_cndmask_b32 v10, v10, 6, vcc
    v_cmp_eq_u32 vcc, s79, v8
    s_nop 1
    v_cndmask_b32 v10, v10, 7, vcc
    v_cmp_le_i32 vcc, 0, v10
    s_and_saveexec_b64 s[68:69], vcc
    s_cbranch_execz NOUPD_157
    v_mul_u32_u24 v10, 2560, v10
    v_lshrrev_b32 v11, 4, v0
    v_lshl_add_u32 v10, v11, 4, v10
    s_lshl_b32 s64, s86, 6
    s_lshl_b32 s65, s13, 7
    s_add_u32 s64, s64, s65
    s_add_u32 s64, s64, 0x5410000
    buffer_load_dwordx4 v[164:167], v10, s[4:7], s64 offen sc1
    s_waitcnt vmcnt(0)
    v_add_f32 v20, v20, v164
    v_cvt_pk_bf16_f32 v20, v20, v20
    v_lshlrev_b32 v20, 16, v20
    v_add_f32 v21, v21, v165
    v_cvt_pk_bf16_f32 v21, v21, v21
    v_lshlrev_b32 v21, 16, v21
    v_add_f32 v22, v22, v166
    v_cvt_pk_bf16_f32 v22, v22, v22
    v_lshlrev_b32 v22, 16, v22
    v_add_f32 v23, v23, v167
    v_cvt_pk_bf16_f32 v23, v23, v23
    v_lshlrev_b32 v23, 16, v23
NOUPD_157:
    s_mov_b64 exec, -1
    v_mul_f32 v28, 0xbfb8aa3b, v20
    v_exp_f32 v28, v28
    s_nop 0
    v_add_f32 v28, 1.0, v28
    v_rcp_f32 v28, v28
    s_nop 0
    v_mul_f32 v28, v28, v20
    v_cvt_pk_bf16_f32 v28, v28, v28
    v_lshlrev_b32 v28, 16, v28
    v_mul_f32 v28, v28, v16
    v_cvt_pk_bf16_f32 v28, v28, v28
    v_lshlrev_b32 v28, 16, v28
    v_add_f32 v28, v28, v24
    v_mul_f32 v29, 0xbfb8aa3b, v21
    v_exp_f32 v29, v29
    s_nop 0
    v_add_f32 v29, 1.0, v29
    v_rcp_f32 v29, v29
    s_nop 0
    v_mul_f32 v29, v29, v21
    v_cvt_pk_bf16_f32 v29, v29, v29
    v_lshlrev_b32 v29, 16, v29
    v_mul_f32 v29, v29, v17
    v_cvt_pk_bf16_f32 v29, v29, v29
    v_lshlrev_b32 v29, 16, v29
    v_add_f32 v29, v29, v25
    v_mul_f32 v30, 0xbfb8aa3b, v22
    v_exp_f32 v30, v30
    s_nop 0
    v_add_f32 v30, 1.0, v30
    v_rcp_f32 v30, v30
    s_nop 0
    v_mul_f32 v30, v30, v22
    v_cvt_pk_bf16_f32 v30, v30, v30
    v_lshlrev_b32 v30, 16, v30
    v_mul_f32 v30, v30, v18
    v_cvt_pk_bf16_f32 v30, v30, v30
    v_lshlrev_b32 v30, 16, v30
    v_add_f32 v30, v30, v26
    v_mul_f32 v31, 0xbfb8aa3b, v23
    v_exp_f32 v31, v31
    s_nop 0
    v_add_f32 v31, 1.0, v31
    v_rcp_f32 v31, v31
    s_nop 0
    v_mul_f32 v31, v31, v23
    v_cvt_pk_bf16_f32 v31, v31, v31
    v_lshlrev_b32 v31, 16, v31
    v_mul_f32 v31, v31, v19
    v_cvt_pk_bf16_f32 v31, v31, v31
    v_lshlrev_b32 v31, 16, v31
    v_add_f32 v31, v31, v27
    v_cvt_pk_bf16_f32 v164, v28, v29
    v_cvt_pk_bf16_f32 v165, v30, v31
    buffer_store_dwordx2 v[164:165], v5, s[52:55], s67 offen
OTD_156:
    s_branch M_EXIT
H_Q:
    s_mov_b32 s29, 0
    v_lshlrev_b32 v1, 4, v0
    v_lshrrev_b32 v5, 4, v0
    v_lshlrev_b32 v2, 7, v5
    v_and_b32 v5, 7, v0
    v_lshl_add_u32 v2, v5, 4, v2
    v_bfe_u32 v5, v0, 4, 1
    v_lshlrev_b32 v3, 7, v5
    v_and_b32 v5, 15, v0
    v_lshl_add_u32 v3, v5, 3, v3
    s_mov_b32 s34, 0x3e0293ee
    s_mov_b32 s35, 0x3e0293ee
    s_mov_b32 s36, -1
    s_mov_b32 s37, 0
    v_lshrrev_b32 v5, 4, v0
    v_lshlrev_b32 v5, 2, v5
    v_and_b32 v6, 15, v0
    v_add_u32 v7, 0, v5
    v_cmp_le_u32 s[38:39], v7, v6
    v_add_u32 v7, 1, v5
    v_cmp_le_u32 s[40:41], v7, v6
    v_add_u32 v7, 2, v5
    v_cmp_le_u32 s[42:43], v7, v6
    v_add_u32 v7, 3, v5
    v_cmp_le_u32 s[44:45], v7, v6
    v_mov_b32 v248, 0x3f803f80
    v_mov_b32 v249, 0x3f803f80
    v_mov_b32 v250, 0x3f803f80
    v_mov_b32 v251, 0x3f803f80
    s_lshl_b32 s24, s12, 2
    s_add_u32 s24, s24, s14
    s_mov_b32 s25, 0
AT0_LOOP:
    s_lshl_b32 s64, s24, 5
    s_add_u32 s64, s64, s13
    s_lshl_b32 s26, s64, 13
    s_add_u32 s26, s26, 0x3400000
    s_lshl_b32 s27, s64, 14
    s_add_u32 s27, s27, 0x1400000
    s_lshl_b32 s65, s64, 11
    s_add_u32 s30, s65, 0x640000
    s_add_u32 s31, s65, 0xa40000
    s_lshl_b32 s33, s64, 2
    s_add_u32 s33, s33, 0x296000
    s_lshl_b32 s32, s24, 18
    s_lshl_b32 s65, s13, 12
    s_add_u32 s32, s32, s65
    s_add_u32 s32, s32, 0x4400000
    s_lshr_b32 s65, s24, 2
    s_lshl_b32 s65, s65, 9
    s_lshl_b32 s66, s13, 4
    s_add_u32 s65, s65, s66
    s_add_u32 s65, s65, 0x291000
    s_lshr_b32 s66, s24, 1
    s_lshl_b32 s66, s66, 8
    s_lshl_b32 s64, s13, 3
    s_add_u32 s66, s66, s64
    s_add_u32 s66, s66, 0x293ff4
    v_lshlrev_b32 v5, 2, v0
    v_mov_b32 v6, s65
    v_mov_b32 v7, s66
    v_cmp_gt_u32 vcc, 3, v0
    s_nop 1
    v_cndmask_b32 v6, v7, v6, vcc
    v_add_u32 v4, v5, v6
    s_mov_b32 s64, 0
    s_mov_b64 exec, 7
AT0_F_158:
    buffer_load_dword v5, v4, s[4:7], s64 offen sc1
    s_add_u32 s29, s29, 1
    s_waitcnt vmcnt(0)
    v_cmp_eq_u32 vcc, 0, v5
    s_cbranch_vccz AT0_FD_159
    s_cmp_gt_u32 s29, 262144
    s_cbranch_scc1 AT0_FD_159
    s_sleep 1
    s_branch AT0_F_158
AT0_FD_159:
    s_mov_b64 exec, -1
    buffer_load_dwordx4 v[16:19], v1, s[4:7], s26 offen offset:0
    buffer_load_dwordx4 v[20:23], v1, s[4:7], s26 offen offset:1024
    buffer_load_dwordx4 v[24:27], v1, s[4:7], s26 offen offset:2048
    buffer_load_dwordx4 v[28:31], v1, s[4:7], s26 offen offset:3072
    s_add_u32 s26, s26, 4096
    buffer_load_dwordx4 v[32:35], v1, s[4:7], s26 offen offset:0
    buffer_load_dwordx4 v[36:39], v1, s[4:7], s26 offen offset:1024
    buffer_load_dwordx4 v[40:43], v1, s[4:7], s26 offen offset:2048
    buffer_load_dwordx4 v[44:47], v1, s[4:7], s26 offen offset:3072
    buffer_load_dwordx4 v[48:51], v1, s[4:7], s27 offen offset:0
    buffer_load_dwordx4 v[52:55], v1, s[4:7], s27 offen offset:1024
    buffer_load_dwordx4 v[56:59], v1, s[4:7], s27 offen offset:2048
    buffer_load_dwordx4 v[60:63], v1, s[4:7], s27 offen offset:3072
    s_add_u32 s27, s27, 4096
    buffer_load_dwordx4 v[64:67], v1, s[4:7], s27 offen offset:0
    buffer_load_dwordx4 v[68:71], v1, s[4:7], s27 offen offset:1024
    buffer_load_dwordx4 v[72:75], v1, s[4:7], s27 offen offset:2048
    buffer_load_dwordx4 v[76:79], v1, s[4:7], s27 offen offset:3072
    s_add_u32 s27, s27, 4096
    buffer_load_dwordx4 v[80:83], v1, s[4:7], s27 offen offset:0
    buffer_load_dwordx4 v[84:87], v1, s[4:7], s27 offen offset:1024
    buffer_load_dwordx4 v[88:91], v1, s[4:7], s27 offen offset:2048
    buffer_load_dwordx4 v[92:95], v1, s[4:7], s27 offen offset:3072
    s_add_u32 s27, s27, 4096
    buffer_load_dwordx4 v[96:99], v1, s[4:7], s27 offen offset:0
    buffer_load_dwordx4 v[100:103], v1, s[4:7], s27 offen offset:1024
    buffer_load_dwordx4 v[104:107], v1, s[4:7], s27 offen offset:2048
    buffer_load_dwordx4 v[108:111], v1, s[4:7], s27 offen offset:3072
    s_mov_b64 exec, 0x18
AT0_G_160:
    buffer_load_dword v5, v4, s[4:7], s64 offen sc1
    s_add_u32 s29, s29, 1
    s_waitcnt vmcnt(0)
    v_cmp_eq_u32 vcc, 0, v5
    s_cbranch_vccz AT0_GD_161
    s_cmp_gt_u32 s29, 262144
    s_cbranch_scc1 AT0_GD_161
    s_sleep 1
    s_branch AT0_G_160
AT0_GD_161:
    s_mov_b64 exec, -1
    buffer_load_dwordx4 v[112:115], v2, s[4:7], s30 offen offset:0
    buffer_load_dwordx4 v[116:119], v2, s[4:7], s30 offen offset:512
    buffer_load_dwordx4 v[120:123], v2, s[4:7], s30 offen offset:1024
    buffer_load_dwordx4 v[124:127], v2, s[4:7], s30 offen offset:1536
    buffer_load_dwordx2 v[128:129], v3, s[4:7], s31 offen offset:0
    buffer_load_dwordx2 v[130:131], v3, s[4:7], s31 offen offset:256
    buffer_load_dwordx2 v[132:133], v3, s[4:7], s31 offen offset:512
    buffer_load_dwordx2 v[134:135], v3, s[4:7], s31 offen offset:768
    buffer_load_dwordx2 v[136:137], v3, s[4:7], s31 offen offset:1024
    buffer_load_dwordx2 v[138:139], v3, s[4:7], s31 offen offset:1280
    buffer_load_dwordx2 v[140:141], v3, s[4:7], s31 offen offset:1536
    buffer_load_dwordx2 v[142:143], v3, s[4:7], s31 offen offset:1792
    v_mfma_f32_16x16x32_bf16 v[148:151], v[48:51], v[16:19], 0
    v_mfma_f32_16x16x32_bf16 v[156:159], v[48:51], v[32:35], 0
    v_mfma_f32_16x16x32_bf16 v[160:163], v[64:67], v[32:35], 0
    v_mfma_f32_16x16x32_bf16 v[148:151], v[52:55], v[20:23], v[148:151]
    v_mfma_f32_16x16x32_bf16 v[156:159], v[52:55], v[36:39], v[156:159]
    v_mfma_f32_16x16x32_bf16 v[160:163], v[68:71], v[36:39], v[160:163]
    v_mfma_f32_16x16x32_bf16 v[148:151], v[56:59], v[24:27], v[148:151]
    v_mfma_f32_16x16x32_bf16 v[156:159], v[56:59], v[40:43], v[156:159]
    v_mfma_f32_16x16x32_bf16 v[160:163], v[72:75], v[40:43], v[160:163]
    v_mfma_f32_16x16x32_bf16 v[148:151], v[60:63], v[28:31], v[148:151]
    v_mfma_f32_16x16x32_bf16 v[156:159], v[60:63], v[44:47], v[156:159]
    v_mfma_f32_16x16x32_bf16 v[160:163], v[76:79], v[44:47], v[160:163]
    s_waitcnt vmcnt(8)
    v_mfma_f32_16x16x32_bf16 v[144:147], v[112:115], v[16:19], 0
    v_mfma_f32_16x16x32_bf16 v[152:155], v[112:115], v[32:35], 0
    v_mfma_f32_16x16x32_bf16 v[144:147], v[116:119], v[20:23], v[144:147]
    v_mfma_f32_16x16x32_bf16 v[152:155], v[116:119], v[36:39], v[152:155]
    v_mfma_f32_16x16x32_bf16 v[144:147], v[120:123], v[24:27], v[144:147]
    v_mfma_f32_16x16x32_bf16 v[152:155], v[120:123], v[40:43], v[152:155]
    v_mfma_f32_16x16x32_bf16 v[144:147], v[124:127], v[28:31], v[144:147]
    v_mfma_f32_16x16x32_bf16 v[152:155], v[124:127], v[44:47], v[152:155]
    v_mov_b32 v11, 0xff800000
    s_nop 7
    v_cndmask_b32 v148, v11, v148, s[38:39]
    v_cndmask_b32 v160, v11, v160, s[38:39]
    v_cndmask_b32 v144, v11, v144, s[36:37]
    v_cndmask_b32 v152, v11, v152, s[36:37]
    v_cndmask_b32 v149, v11, v149, s[40:41]
    v_cndmask_b32 v161, v11, v161, s[40:41]
    v_cndmask_b32 v145, v11, v145, s[36:37]
    v_cndmask_b32 v153, v11, v153, s[36:37]
    v_cndmask_b32 v150, v11, v150, s[42:43]
    v_cndmask_b32 v162, v11, v162, s[42:43]
    v_cndmask_b32 v146, v11, v146, s[36:37]
    v_cndmask_b32 v154, v11, v154, s[36:37]
    v_cndmask_b32 v151, v11, v151, s[44:45]
    v_cndmask_b32 v163, v11, v163, s[44:45]
    v_cndmask_b32 v147, v11, v147, s[36:37]
    v_cndmask_b32 v155, v11, v155, s[36:37]
    v_max3_f32 v8, v144, v145, v146
    v_max3_f32 v8, v8, v147, v148
    v_max3_f32 v8, v8, v149, v150
    v_max_f32 v8, v8, v151
    v_mov_b32 v9, v8
    s_nop 1
    v_permlane16_swap_b32 v8, v9
    v_max_f32 v8, v8, v9
    v_mov_b32 v9, v8
    s_nop 1
    v_permlane32_swap_b32 v8, v9
    v_max_f32 v8, v8, v9
    v_mul_f32 v8, s34, v8
    v_fma_f32 v144, v144, s34, -v8
    v_fma_f32 v145, v145, s34, -v8
    v_fma_f32 v146, v146, s34, -v8
    v_fma_f32 v147, v147, s34, -v8
    v_fma_f32 v148, v148, s34, -v8
    v_fma_f32 v149, v149, s34, -v8
    v_fma_f32 v150, v150, s34, -v8
    v_fma_f32 v151, v151, s34, -v8
    v_exp_f32 v144, v144
    v_exp_f32 v145, v145
    v_exp_f32 v146, v146
    v_exp_f32 v147, v147
    v_exp_f32 v148, v148
    v_exp_f32 v149, v149
    v_exp_f32 v150, v150
    v_exp_f32 v151, v151
    s_nop 0
    v_cvt_pk_bf16_f32 v164, v148, v149
    v_cvt_pk_bf16_f32 v165, v150, v151
    v_mov_b32 v166, 0
    v_mov_b32 v167, 0
    v_cvt_pk_bf16_f32 v168, v144, v145
    v_cvt_pk_bf16_f32 v169, v146, v147
    v_max3_f32 v8, v152, v153, v154
    v_max3_f32 v8, v8, v155, v156
    v_max3_f32 v8, v8, v157, v158
    v_max3_f32 v8, v8, v159, v160
    v_max3_f32 v8, v8, v161, v162
    v_max_f32 v8, v8, v163
    v_mov_b32 v9, v8
    s_nop 1
    v_permlane16_swap_b32 v8, v9
    v_max_f32 v8, v8, v9
    v_mov_b32 v9, v8
    s_nop 1
    v_permlane32_swap_b32 v8, v9
    v_max_f32 v8, v8, v9
    v_mul_f32 v8, s34, v8
    v_fma_f32 v152, v152, s34, -v8
    v_fma_f32 v153, v153, s34, -v8
    v_fma_f32 v154, v154, s34, -v8
    v_fma_f32 v155, v155, s34, -v8
    v_fma_f32 v156, v156, s34, -v8
    v_fma_f32 v157, v157, s34, -v8
    v_fma_f32 v158, v158, s34, -v8
    v_fma_f32 v159, v159, s34, -v8
    v_fma_f32 v160, v160, s34, -v8
    v_fma_f32 v161, v161, s34, -v8
    v_fma_f32 v162, v162, s34, -v8
    v_fma_f32 v163, v163, s34, -v8
    v_exp_f32 v152, v152
    v_exp_f32 v153, v153
    v_exp_f32 v154, v154
    v_exp_f32 v155, v155
    v_exp_f32 v156, v156
    v_exp_f32 v157, v157
    v_exp_f32 v158, v158
    v_exp_f32 v159, v159
    v_exp_f32 v160, v160
    v_exp_f32 v161, v161
    v_exp_f32 v162, v162
    v_exp_f32 v163, v163
    s_nop 0
    v_cvt_pk_bf16_f32 v170, v156, v157
    v_cvt_pk_bf16_f32 v171, v158, v159
    v_cvt_pk_bf16_f32 v172, v160, v161
    v_cvt_pk_bf16_f32 v173, v162, v163
    v_cvt_pk_bf16_f32 v174, v152, v153
    v_cvt_pk_bf16_f32 v175, v154, v155
    s_waitcnt vmcnt(0)
    v_mfma_f32_16x16x32_bf16 v[240:243], v[248:251], v[164:167], 0
    v_mfma_f32_16x16x32_bf16 v[244:247], v[248:251], v[170:173], 0
    v_mfma_f32_16x16x32_bf16 v[176:179], v[80:83], v[164:167], 0
    v_mfma_f32_16x16x32_bf16 v[180:183], v[80:83], v[170:173], 0
    v_mfma_f32_16x16x32_bf16 v[184:187], v[84:87], v[164:167], 0
    v_mfma_f32_16x16x32_bf16 v[188:191], v[84:87], v[170:173], 0
    v_mfma_f32_16x16x32_bf16 v[192:195], v[88:91], v[164:167], 0
    v_mfma_f32_16x16x32_bf16 v[196:199], v[88:91], v[170:173], 0
    v_mfma_f32_16x16x32_bf16 v[200:203], v[92:95], v[164:167], 0
    v_mfma_f32_16x16x32_bf16 v[204:207], v[92:95], v[170:173], 0
    v_mfma_f32_16x16x32_bf16 v[208:211], v[96:99], v[164:167], 0
    v_mfma_f32_16x16x32_bf16 v[212:215], v[96:99], v[170:173], 0
    v_mfma_f32_16x16x32_bf16 v[216:219], v[100:103], v[164:167], 0
    v_mfma_f32_16x16x32_bf16 v[220:223], v[100:103], v[170:173], 0
    v_mfma_f32_16x16x32_bf16 v[224:227], v[104:107], v[164:167], 0
    v_mfma_f32_16x16x32_bf16 v[228:231], v[104:107], v[170:173], 0
    v_mfma_f32_16x16x32_bf16 v[232:235], v[108:111], v[164:167], 0
    v_mfma_f32_16x16x32_bf16 v[236:239], v[108:111], v[170:173], 0
    v_mfma_f32_16x16x16_bf16 v[240:243], v[248:249], v[168:169], v[240:243]
    v_mfma_f32_16x16x16_bf16 v[244:247], v[248:249], v[174:175], v[244:247]
    v_mfma_f32_16x16x16_bf16 v[176:179], v[128:129], v[168:169], v[176:179]
    v_mfma_f32_16x16x16_bf16 v[180:183], v[128:129], v[174:175], v[180:183]
    v_mfma_f32_16x16x16_bf16 v[184:187], v[130:131], v[168:169], v[184:187]
    v_mfma_f32_16x16x16_bf16 v[188:191], v[130:131], v[174:175], v[188:191]
    v_mfma_f32_16x16x16_bf16 v[192:195], v[132:133], v[168:169], v[192:195]
    v_mfma_f32_16x16x16_bf16 v[196:199], v[132:133], v[174:175], v[196:199]
    v_mfma_f32_16x16x16_bf16 v[200:203], v[134:135], v[168:169], v[200:203]
    v_mfma_f32_16x16x16_bf16 v[204:207], v[134:135], v[174:175], v[204:207]
    v_mfma_f32_16x16x16_bf16 v[208:211], v[136:137], v[168:169], v[208:211]
    v_mfma_f32_16x16x16_bf16 v[212:215], v[136:137], v[174:175], v[212:215]
    v_mfma_f32_16x16x16_bf16 v[216:219], v[138:139], v[168:169], v[216:219]
    v_mfma_f32_16x16x16_bf16 v[220:223], v[138:139], v[174:175], v[220:223]
    v_mfma_f32_16x16x16_bf16 v[224:227], v[140:141], v[168:169], v[224:227]
    v_mfma_f32_16x16x16_bf16 v[228:231], v[140:141], v[174:175], v[228:231]
    v_mfma_f32_16x16x16_bf16 v[232:235], v[142:143], v[168:169], v[232:235]
    v_mfma_f32_16x16x16_bf16 v[236:239], v[142:143], v[174:175], v[236:239]
    v_rcp_f32 v8, v240
    v_rcp_f32 v9, v244
    s_nop 7
    v_mul_f32 v176, v176, v8
    v_mul_f32 v177, v177, v8
    v_mul_f32 v178, v178, v8
    v_mul_f32 v179, v179, v8
    v_cvt_pk_bf16_f32 v16, v176, v177
    v_cvt_pk_bf16_f32 v17, v178, v179
    v_mul_f32 v184, v184, v8
    v_mul_f32 v185, v185, v8
    v_mul_f32 v186, v186, v8
    v_mul_f32 v187, v187, v8
    v_cvt_pk_bf16_f32 v18, v184, v185
    v_cvt_pk_bf16_f32 v19, v186, v187
    s_add_u32 s64, s32, 0x0
    buffer_store_dwordx4 v[16:19], v1, s[4:7], s64 offen offset:0 sc1
    v_mul_f32 v192, v192, v8
    v_mul_f32 v193, v193, v8
    v_mul_f32 v194, v194, v8
    v_mul_f32 v195, v195, v8
    v_cvt_pk_bf16_f32 v20, v192, v193
    v_cvt_pk_bf16_f32 v21, v194, v195
    v_mul_f32 v200, v200, v8
    v_mul_f32 v201, v201, v8
    v_mul_f32 v202, v202, v8
    v_mul_f32 v203, v203, v8
    v_cvt_pk_bf16_f32 v22, v200, v201
    v_cvt_pk_bf16_f32 v23, v202, v203
    s_add_u32 s64, s32, 0x0
    buffer_store_dwordx4 v[20:23], v1, s[4:7], s64 offen offset:1024 sc1
    v_mul_f32 v208, v208, v8
    v_mul_f32 v209, v209, v8
    v_mul_f32 v210, v210, v8
    v_mul_f32 v211, v211, v8
    v_cvt_pk_bf16_f32 v24, v208, v209
    v_cvt_pk_bf16_f32 v25, v210, v211
    v_mul_f32 v216, v216, v8
    v_mul_f32 v217, v217, v8
    v_mul_f32 v218, v218, v8
    v_mul_f32 v219, v219, v8
    v_cvt_pk_bf16_f32 v26, v216, v217
    v_cvt_pk_bf16_f32 v27, v218, v219
    s_add_u32 s64, s32, 0x0
    buffer_store_dwordx4 v[24:27], v1, s[4:7], s64 offen offset:2048 sc1
    v_mul_f32 v224, v224, v8
    v_mul_f32 v225, v225, v8
    v_mul_f32 v226, v226, v8
    v_mul_f32 v227, v227, v8
    v_cvt_pk_bf16_f32 v28, v224, v225
    v_cvt_pk_bf16_f32 v29, v226, v227
    v_mul_f32 v232, v232, v8
    v_mul_f32 v233, v233, v8
    v_mul_f32 v234, v234, v8
    v_mul_f32 v235, v235, v8
    v_cvt_pk_bf16_f32 v30, v232, v233
    v_cvt_pk_bf16_f32 v31, v234, v235
    s_add_u32 s64, s32, 0x0
    buffer_store_dwordx4 v[28:31], v1, s[4:7], s64 offen offset:3072 sc1
    v_mul_f32 v180, v180, v9
    v_mul_f32 v181, v181, v9
    v_mul_f32 v182, v182, v9
    v_mul_f32 v183, v183, v9
    v_cvt_pk_bf16_f32 v32, v180, v181
    v_cvt_pk_bf16_f32 v33, v182, v183
    v_mul_f32 v188, v188, v9
    v_mul_f32 v189, v189, v9
    v_mul_f32 v190, v190, v9
    v_mul_f32 v191, v191, v9
    v_cvt_pk_bf16_f32 v34, v188, v189
    v_cvt_pk_bf16_f32 v35, v190, v191
    s_add_u32 s64, s32, 0x20000
    buffer_store_dwordx4 v[32:35], v1, s[4:7], s64 offen offset:0 sc1
    v_mul_f32 v196, v196, v9
    v_mul_f32 v197, v197, v9
    v_mul_f32 v198, v198, v9
    v_mul_f32 v199, v199, v9
    v_cvt_pk_bf16_f32 v36, v196, v197
    v_cvt_pk_bf16_f32 v37, v198, v199
    v_mul_f32 v204, v204, v9
    v_mul_f32 v205, v205, v9
    v_mul_f32 v206, v206, v9
    v_mul_f32 v207, v207, v9
    v_cvt_pk_bf16_f32 v38, v204, v205
    v_cvt_pk_bf16_f32 v39, v206, v207
    s_add_u32 s64, s32, 0x20000
    buffer_store_dwordx4 v[36:39], v1, s[4:7], s64 offen offset:1024 sc1
    v_mul_f32 v212, v212, v9
    v_mul_f32 v213, v213, v9
    v_mul_f32 v214, v214, v9
    v_mul_f32 v215, v215, v9
    v_cvt_pk_bf16_f32 v40, v212, v213
    v_cvt_pk_bf16_f32 v41, v214, v215
    v_mul_f32 v220, v220, v9
    v_mul_f32 v221, v221, v9
    v_mul_f32 v222, v222, v9
    v_mul_f32 v223, v223, v9
    v_cvt_pk_bf16_f32 v42, v220, v221
    v_cvt_pk_bf16_f32 v43, v222, v223
    s_add_u32 s64, s32, 0x20000
    buffer_store_dwordx4 v[40:43], v1, s[4:7], s64 offen offset:2048 sc1
    v_mul_f32 v228, v228, v9
    v_mul_f32 v229, v229, v9
    v_mul_f32 v230, v230, v9
    v_mul_f32 v231, v231, v9
    v_cvt_pk_bf16_f32 v44, v228, v229
    v_cvt_pk_bf16_f32 v45, v230, v231
    v_mul_f32 v236, v236, v9
    v_mul_f32 v237, v237, v9
    v_mul_f32 v238, v238, v9
    v_mul_f32 v239, v239, v9
    v_cvt_pk_bf16_f32 v46, v236, v237
    v_cvt_pk_bf16_f32 v47, v238, v239
    s_add_u32 s64, s32, 0x20000
    buffer_store_dwordx4 v[44:47], v1, s[4:7], s64 offen offset:3072 sc1
    s_waitcnt vmcnt(0)
    v_mov_b32 v7, 1
    v_mov_b32 v8, 0
    s_mov_b64 exec, 1
    buffer_store_dword v7, v8, s[4:7], s33 offen sc1
    s_mov_b64 exec, -1
    s_add_u32 s24, s24, 8
    s_add_u32 s25, s25, 1
    s_cmp_lt_u32 s25, 1
    s_cbranch_scc1 AT0_LOOP
    s_lshl_b32 s70, s13, 1
    s_add_u32 s70, s70, s12
    s_load_dwordx2 s[44:45], s[0:1], 72
    s_mov_b32 s46, 0x21c000
    s_mov_b32 s47, 0x00020000
    s_load_dwordx2 s[48:49], s[0:1], 80
    s_mov_b32 s50, 0x21c000
    s_mov_b32 s51, 0x00020000
    s_load_dwordx2 s[52:53], s[0:1], 88
    s_mov_b32 s54, 0x21c000
    s_mov_b32 s55, 0x00020000
    s_mov_b32 s29, 0
    s_waitcnt lgkmcnt(0)
    v_mbcnt_lo_u32_b32 v0, -1, 0
    v_mbcnt_hi_u32_b32 v0, -1, v0
    s_lshl_b32 s24, s70, 2
    s_add_u32 s24, s24, s14
    s_cmp_ge_u32 s24, 108
    s_cbranch_scc1 H_A1
    v_mov_b32 v8, 0
    s_mov_b32 s64, 0x298000
F1W_162:
    buffer_load_dword v7, v8, s[4:7], s64 offen sc1
    s_add_u32 s29, s29, 1
    s_waitcnt vmcnt(0)
    v_cmp_gt_u32 vcc, 1, v7
    s_cbranch_vccz F1WD_163
    s_cmp_gt_u32 s29, 262144
    s_cbranch_scc1 F1WD_163
    s_sleep 8
    s_branch F1W_162
F1WD_163:
    s_mul_i32 s25, s14, 40960
    v_lshrrev_b32 v7, 1, v0
    v_mul_u32_u24 v2, 3456, v7
    v_and_b32 v7, 1, v0
    v_lshl_add_u32 v2, v7, 4, v2
    v_lshrrev_b32 v7, 4, v0
    v_lshlrev_b32 v3, 8, v7
    v_bfe_u32 v7, v0, 2, 2
    v_lshl_add_u32 v3, v7, 5, v3
    v_and_b32 v7, 3, v0
    v_lshl_add_u32 v3, v7, 3, v3
    v_add_u32 v3, s25, v3
    v_and_b32 v7, 7, v0
    v_lshlrev_b32 v7, 2, v7
    s_mov_b32 s64, 0x5400000
    buffer_load_dword v4, v7, s[4:7], s64 offen sc1
    s_waitcnt vmcnt(0)
    v_mul_u32_u24 v4, 1280, v4
    v_lshrrev_b32 v7, 4, v0
    v_lshl_add_u32 v4, v7, 4, v4
    s_mov_b32 s65, 0x0
    buffer_load_dwordx4 v[16:19], v4, s[4:7], s65 offen offset:0 sc1
    buffer_load_dwordx4 v[20:23], v4, s[4:7], s65 offen offset:64 sc1
    buffer_load_dwordx4 v[24:27], v4, s[4:7], s65 offen offset:128 sc1
    buffer_load_dwordx4 v[28:31], v4, s[4:7], s65 offen offset:192 sc1
    buffer_load_dwordx4 v[32:35], v4, s[4:7], s65 offen offset:256 sc1
    buffer_load_dwordx4 v[36:39], v4, s[4:7], s65 offen offset:320 sc1
    buffer_load_dwordx4 v[40:43], v4, s[4:7], s65 offen offset:384 sc1
    buffer_load_dwordx4 v[44:47], v4, s[4:7], s65 offen offset:448 sc1
    buffer_load_dwordx4 v[48:51], v4, s[4:7], s65 offen offset:512 sc1
    buffer_load_dwordx4 v[52:55], v4, s[4:7], s65 offen offset:576 sc1
    buffer_load_dwordx4 v[56:59], v4, s[4:7], s65 offen offset:640 sc1
    buffer_load_dwordx4 v[60:63], v4, s[4:7], s65 offen offset:704 sc1
    buffer_load_dwordx4 v[64:67], v4, s[4:7], s65 offen offset:768 sc1
    buffer_load_dwordx4 v[68:71], v4, s[4:7], s65 offen offset:832 sc1
    buffer_load_dwordx4 v[72:75], v4, s[4:7], s65 offen offset:896 sc1
    buffer_load_dwordx4 v[76:79], v4, s[4:7], s65 offen offset:960 sc1
    buffer_load_dwordx4 v[80:83], v4, s[4:7], s65 offen offset:1024 sc1
    buffer_load_dwordx4 v[84:87], v4, s[4:7], s65 offen offset:1088 sc1
    buffer_load_dwordx4 v[88:91], v4, s[4:7], s65 offen offset:1152 sc1
    buffer_load_dwordx4 v[92:95], v4, s[4:7], s65 offen offset:1216 sc1
    s_lshl_b32 s26, s24, 5
    s_add_u32 m0, s25, 0
    s_add_u32 s64, s26, 0x0
    buffer_load_dwordx4 v2, s[44:47], s64 offen lds
    s_add_u32 m0, s25, 1024
    s_add_u32 s64, s26, 0x1b000
    buffer_load_dwordx4 v2, s[44:47], s64 offen lds
    s_add_u32 m0, s25, 2048
    s_add_u32 s64, s26, 0x36000
    buffer_load_dwordx4 v2, s[44:47], s64 offen lds
    s_add_u32 m0, s25, 3072
    s_add_u32 s64, s26, 0x51000
    buffer_load_dwordx4 v2, s[44:47], s64 offen lds
    s_add_u32 m0, s25, 4096
    s_add_u32 s64, s26, 0x6c000
    buffer_load_dwordx4 v2, s[44:47], s64 offen lds
    s_add_u32 m0, s25, 5120
    s_add_u32 s64, s26, 0x87000
    buffer_load_dwordx4 v2, s[44:47], s64 offen lds
    s_add_u32 m0, s25, 6144
    s_add_u32 s64, s26, 0xa2000
    buffer_load_dwordx4 v2, s[44:47], s64 offen lds
    s_add_u32 m0, s25, 7168
    s_add_u32 s64, s26, 0xbd000
    buffer_load_dwordx4 v2, s[44:47], s64 offen lds
    s_add_u32 m0, s25, 8192
    s_add_u32 s64, s26, 0xd8000
    buffer_load_dwordx4 v2, s[44:47], s64 offen lds
    s_add_u32 m0, s25, 9216
    s_add_u32 s64, s26, 0xf3000
    buffer_load_dwordx4 v2, s[44:47], s64 offen lds
    s_add_u32 m0, s25, 10240
    s_add_u32 s64, s26, 0x10e000
    buffer_load_dwordx4 v2, s[44:47], s64 offen lds
    s_add_u32 m0, s25, 11264
    s_add_u32 s64, s26, 0x129000
    buffer_load_dwordx4 v2, s[44:47], s64 offen lds
    s_add_u32 m0, s25, 12288
    s_add_u32 s64, s26, 0x144000
    buffer_load_dwordx4 v2, s[44:47], s64 offen lds
    s_add_u32 m0, s25, 13312
    s_add_u32 s64, s26, 0x15f000
    buffer_load_dwordx4 v2, s[44:47], s64 offen lds
    s_add_u32 m0, s25, 14336
    s_add_u32 s64, s26, 0x17a000
    buffer_load_dwordx4 v2, s[44:47], s64 offen lds
    s_add_u32 m0, s25, 15360
    s_add_u32 s64, s26, 0x195000
    buffer_load_dwordx4 v2, s[44:47], s64 offen lds
    s_add_u32 m0, s25, 16384
    s_add_u32 s64, s26, 0x1b0000
    buffer_load_dwordx4 v2, s[44:47], s64 offen lds
    s_add_u32 m0, s25, 17408
    s_add_u32 s64, s26, 0x1cb000
    buffer_load_dwordx4 v2, s[44:47], s64 offen lds
    s_add_u32 m0, s25, 18432
    s_add_u32 s64, s26, 0x1e6000
    buffer_load_dwordx4 v2, s[44:47], s64 offen lds
    s_add_u32 m0, s25, 19456
    s_add_u32 s64, s26, 0x201000
    buffer_load_dwordx4 v2, s[44:47], s64 offen lds
    s_waitcnt vmcnt(0)
    ds_read_b64_tr_b16 v[96:97], v3 offset:0
    ds_read_b64_tr_b16 v[98:99], v3 offset:128
    ds_read_b64_tr_b16 v[100:101], v3 offset:1024
    ds_read_b64_tr_b16 v[102:103], v3 offset:1152
    ds_read_b64_tr_b16 v[104:105], v3 offset:2048
    ds_read_b64_tr_b16 v[106:107], v3 offset:2176
    ds_read_b64_tr_b16 v[108:109], v3 offset:3072
    ds_read_b64_tr_b16 v[110:111], v3 offset:3200
    ds_read_b64_tr_b16 v[112:113], v3 offset:4096
    ds_read_b64_tr_b16 v[114:115], v3 offset:4224
    ds_read_b64_tr_b16 v[116:117], v3 offset:5120
    ds_read_b64_tr_b16 v[118:119], v3 offset:5248
    s_waitcnt lgkmcnt(4)
    ds_read_b64_tr_b16 v[120:121], v3 offset:6144
    ds_read_b64_tr_b16 v[122:123], v3 offset:6272
    ds_read_b64_tr_b16 v[124:125], v3 offset:7168
    ds_read_b64_tr_b16 v[126:127], v3 offset:7296
    ds_read_b64_tr_b16 v[128:129], v3 offset:8192
    ds_read_b64_tr_b16 v[130:131], v3 offset:8320
    ds_read_b64_tr_b16 v[132:133], v3 offset:9216
    ds_read_b64_tr_b16 v[134:135], v3 offset:9344
    ds_read_b64_tr_b16 v[136:137], v3 offset:10240
    ds_read_b64_tr_b16 v[138:139], v3 offset:10368
    ds_read_b64_tr_b16 v[140:141], v3 offset:11264
    ds_read_b64_tr_b16 v[142:143], v3 offset:11392
    s_waitcnt lgkmcnt(4)
    ds_read_b64_tr_b16 v[144:145], v3 offset:12288
    ds_read_b64_tr_b16 v[146:147], v3 offset:12416
    ds_read_b64_tr_b16 v[148:149], v3 offset:13312
    ds_read_b64_tr_b16 v[150:151], v3 offset:13440
    ds_read_b64_tr_b16 v[152:153], v3 offset:14336
    ds_read_b64_tr_b16 v[154:155], v3 offset:14464
    ds_read_b64_tr_b16 v[156:157], v3 offset:15360
    ds_read_b64_tr_b16 v[158:159], v3 offset:15488
    ds_read_b64_tr_b16 v[160:161], v3 offset:16384
    ds_read_b64_tr_b16 v[162:163], v3 offset:16512
    ds_read_b64_tr_b16 v[164:165], v3 offset:17408
    ds_read_b64_tr_b16 v[166:167], v3 offset:17536
    s_waitcnt lgkmcnt(4)
    ds_read_b64_tr_b16 v[168:169], v3 offset:18432
    ds_read_b64_tr_b16 v[170:171], v3 offset:18560
    ds_read_b64_tr_b16 v[172:173], v3 offset:19456
    ds_read_b64_tr_b16 v[174:175], v3 offset:19584
    s_waitcnt lgkmcnt(0)
    s_add_u32 s25, s25, 20480
    v_add_u32 v3, 20480, v3
    s_add_u32 m0, s25, 0
    s_add_u32 s64, s26, 0x0
    buffer_load_dwordx4 v2, s[48:51], s64 offen lds
    s_add_u32 m0, s25, 1024
    s_add_u32 s64, s26, 0x1b000
    buffer_load_dwordx4 v2, s[48:51], s64 offen lds
    s_add_u32 m0, s25, 2048
    s_add_u32 s64, s26, 0x36000
    buffer_load_dwordx4 v2, s[48:51], s64 offen lds
    s_add_u32 m0, s25, 3072
    s_add_u32 s64, s26, 0x51000
    buffer_load_dwordx4 v2, s[48:51], s64 offen lds
    s_add_u32 m0, s25, 4096
    s_add_u32 s64, s26, 0x6c000
    buffer_load_dwordx4 v2, s[48:51], s64 offen lds
    s_add_u32 m0, s25, 5120
    s_add_u32 s64, s26, 0x87000
    buffer_load_dwordx4 v2, s[48:51], s64 offen lds
    s_add_u32 m0, s25, 6144
    s_add_u32 s64, s26, 0xa2000
    buffer_load_dwordx4 v2, s[48:51], s64 offen lds
    s_add_u32 m0, s25, 7168
    s_add_u32 s64, s26, 0xbd000
    buffer_load_dwordx4 v2, s[48:51], s64 offen lds
    s_add_u32 m0, s25, 8192
    s_add_u32 s64, s26, 0xd8000
    buffer_load_dwordx4 v2, s[48:51], s64 offen lds
    s_add_u32 m0, s25, 9216
    s_add_u32 s64, s26, 0xf3000
    buffer_load_dwordx4 v2, s[48:51], s64 offen lds
    s_add_u32 m0, s25, 10240
    s_add_u32 s64, s26, 0x10e000
    buffer_load_dwordx4 v2, s[48:51], s64 offen lds
    s_add_u32 m0, s25, 11264
    s_add_u32 s64, s26, 0x129000
    buffer_load_dwordx4 v2, s[48:51], s64 offen lds
    s_add_u32 m0, s25, 12288
    s_add_u32 s64, s26, 0x144000
    buffer_load_dwordx4 v2, s[48:51], s64 offen lds
    s_add_u32 m0, s25, 13312
    s_add_u32 s64, s26, 0x15f000
    buffer_load_dwordx4 v2, s[48:51], s64 offen lds
    s_add_u32 m0, s25, 14336
    s_add_u32 s64, s26, 0x17a000
    buffer_load_dwordx4 v2, s[48:51], s64 offen lds
    s_add_u32 m0, s25, 15360
    s_add_u32 s64, s26, 0x195000
    buffer_load_dwordx4 v2, s[48:51], s64 offen lds
    s_add_u32 m0, s25, 16384
    s_add_u32 s64, s26, 0x1b0000
    buffer_load_dwordx4 v2, s[48:51], s64 offen lds
    s_add_u32 m0, s25, 17408
    s_add_u32 s64, s26, 0x1cb000
    buffer_load_dwordx4 v2, s[48:51], s64 offen lds
    s_add_u32 m0, s25, 18432
    s_add_u32 s64, s26, 0x1e6000
    buffer_load_dwordx4 v2, s[48:51], s64 offen lds
    s_add_u32 m0, s25, 19456
    s_add_u32 s64, s26, 0x201000
    buffer_load_dwordx4 v2, s[48:51], s64 offen lds
    s_waitcnt vmcnt(0)
    ds_read_b64_tr_b16 v[176:177], v3 offset:0
    ds_read_b64_tr_b16 v[178:179], v3 offset:128
    ds_read_b64_tr_b16 v[180:181], v3 offset:1024
    ds_read_b64_tr_b16 v[182:183], v3 offset:1152
    ds_read_b64_tr_b16 v[184:185], v3 offset:2048
    ds_read_b64_tr_b16 v[186:187], v3 offset:2176
    ds_read_b64_tr_b16 v[188:189], v3 offset:3072
    ds_read_b64_tr_b16 v[190:191], v3 offset:3200
    ds_read_b64_tr_b16 v[192:193], v3 offset:4096
    ds_read_b64_tr_b16 v[194:195], v3 offset:4224
    ds_read_b64_tr_b16 v[196:197], v3 offset:5120
    ds_read_b64_tr_b16 v[198:199], v3 offset:5248
    s_waitcnt lgkmcnt(4)
    ds_read_b64_tr_b16 v[200:201], v3 offset:6144
    ds_read_b64_tr_b16 v[202:203], v3 offset:6272
    ds_read_b64_tr_b16 v[204:205], v3 offset:7168
    ds_read_b64_tr_b16 v[206:207], v3 offset:7296
    ds_read_b64_tr_b16 v[208:209], v3 offset:8192
    ds_read_b64_tr_b16 v[210:211], v3 offset:8320
    ds_read_b64_tr_b16 v[212:213], v3 offset:9216
    ds_read_b64_tr_b16 v[214:215], v3 offset:9344
    ds_read_b64_tr_b16 v[216:217], v3 offset:10240
    ds_read_b64_tr_b16 v[218:219], v3 offset:10368
    ds_read_b64_tr_b16 v[220:221], v3 offset:11264
    ds_read_b64_tr_b16 v[222:223], v3 offset:11392
    s_waitcnt lgkmcnt(4)
    ds_read_b64_tr_b16 v[224:225], v3 offset:12288
    ds_read_b64_tr_b16 v[226:227], v3 offset:12416
    ds_read_b64_tr_b16 v[228:229], v3 offset:13312
    ds_read_b64_tr_b16 v[230:231], v3 offset:13440
    ds_read_b64_tr_b16 v[232:233], v3 offset:14336
    ds_read_b64_tr_b16 v[234:235], v3 offset:14464
    ds_read_b64_tr_b16 v[236:237], v3 offset:15360
    ds_read_b64_tr_b16 v[238:239], v3 offset:15488
    ds_read_b64_tr_b16 v[240:241], v3 offset:16384
    ds_read_b64_tr_b16 v[242:243], v3 offset:16512
    ds_read_b64_tr_b16 v[244:245], v3 offset:17408
    ds_read_b64_tr_b16 v[246:247], v3 offset:17536
    s_waitcnt lgkmcnt(4)
    ds_read_b64_tr_b16 v[248:249], v3 offset:18432
    ds_read_b64_tr_b16 v[250:251], v3 offset:18560
    ds_read_b64_tr_b16 v[252:253], v3 offset:19456
    ds_read_b64_tr_b16 v[254:255], v3 offset:19584
    s_waitcnt lgkmcnt(0)
    v_mfma_f32_16x16x32_bf16 v[8:11], v[96:99], v[16:19], 0
    v_mfma_f32_16x16x32_bf16 v[12:15], v[176:179], v[16:19], 0
    v_mfma_f32_16x16x32_bf16 v[8:11], v[100:103], v[20:23], v[8:11]
    v_mfma_f32_16x16x32_bf16 v[12:15], v[180:183], v[20:23], v[12:15]
    v_mfma_f32_16x16x32_bf16 v[8:11], v[104:107], v[24:27], v[8:11]
    v_mfma_f32_16x16x32_bf16 v[12:15], v[184:187], v[24:27], v[12:15]
    v_mfma_f32_16x16x32_bf16 v[8:11], v[108:111], v[28:31], v[8:11]
    v_mfma_f32_16x16x32_bf16 v[12:15], v[188:191], v[28:31], v[12:15]
    v_mfma_f32_16x16x32_bf16 v[8:11], v[112:115], v[32:35], v[8:11]
    v_mfma_f32_16x16x32_bf16 v[12:15], v[192:195], v[32:35], v[12:15]
    v_mfma_f32_16x16x32_bf16 v[8:11], v[116:119], v[36:39], v[8:11]
    v_mfma_f32_16x16x32_bf16 v[12:15], v[196:199], v[36:39], v[12:15]
    v_mfma_f32_16x16x32_bf16 v[8:11], v[120:123], v[40:43], v[8:11]
    v_mfma_f32_16x16x32_bf16 v[12:15], v[200:203], v[40:43], v[12:15]
    v_mfma_f32_16x16x32_bf16 v[8:11], v[124:127], v[44:47], v[8:11]
    v_mfma_f32_16x16x32_bf16 v[12:15], v[204:207], v[44:47], v[12:15]
    v_mfma_f32_16x16x32_bf16 v[8:11], v[128:131], v[48:51], v[8:11]
    v_mfma_f32_16x16x32_bf16 v[12:15], v[208:211], v[48:51], v[12:15]
    v_mfma_f32_16x16x32_bf16 v[8:11], v[132:135], v[52:55], v[8:11]
    v_mfma_f32_16x16x32_bf16 v[12:15], v[212:215], v[52:55], v[12:15]
    v_mfma_f32_16x16x32_bf16 v[8:11], v[136:139], v[56:59], v[8:11]
    v_mfma_f32_16x16x32_bf16 v[12:15], v[216:219], v[56:59], v[12:15]
    v_mfma_f32_16x16x32_bf16 v[8:11], v[140:143], v[60:63], v[8:11]
    v_mfma_f32_16x16x32_bf16 v[12:15], v[220:223], v[60:63], v[12:15]
    v_mfma_f32_16x16x32_bf16 v[8:11], v[144:147], v[64:67], v[8:11]
    v_mfma_f32_16x16x32_bf16 v[12:15], v[224:227], v[64:67], v[12:15]
    v_mfma_f32_16x16x32_bf16 v[8:11], v[148:151], v[68:71], v[8:11]
    v_mfma_f32_16x16x32_bf16 v[12:15], v[228:231], v[68:71], v[12:15]
    v_mfma_f32_16x16x32_bf16 v[8:11], v[152:155], v[72:75], v[8:11]
    v_mfma_f32_16x16x32_bf16 v[12:15], v[232:235], v[72:75], v[12:15]
    v_mfma_f32_16x16x32_bf16 v[8:11], v[156:159], v[76:79], v[8:11]
    v_mfma_f32_16x16x32_bf16 v[12:15], v[236:239], v[76:79], v[12:15]
    v_mfma_f32_16x16x32_bf16 v[8:11], v[160:163], v[80:83], v[8:11]
    v_mfma_f32_16x16x32_bf16 v[12:15], v[240:243], v[80:83], v[12:15]
    v_mfma_f32_16x16x32_bf16 v[8:11], v[164:167], v[84:87], v[8:11]
    v_mfma_f32_16x16x32_bf16 v[12:15], v[244:247], v[84:87], v[12:15]
    v_mfma_f32_16x16x32_bf16 v[8:11], v[168:171], v[88:91], v[8:11]
    v_mfma_f32_16x16x32_bf16 v[12:15], v[248:251], v[88:91], v[12:15]
    v_mfma_f32_16x16x32_bf16 v[8:11], v[172:175], v[92:95], v[8:11]
    v_mfma_f32_16x16x32_bf16 v[12:15], v[252:255], v[92:95], v[12:15]
    s_nop 7
    v_cvt_pk_bf16_f32 v8, v8, v8
    v_lshlrev_b32 v8, 16, v8
    v_cvt_pk_bf16_f32 v12, v12, v12
    v_lshlrev_b32 v12, 16, v12
    v_mul_f32 v16, 0xbfb8aa3b, v8
    v_exp_f32 v16, v16
    s_nop 0
    v_add_f32 v16, 1.0, v16
    v_rcp_f32 v16, v16
    s_nop 0
    v_mul_f32 v8, v8, v16
    v_cvt_pk_bf16_f32 v8, v8, v8
    v_lshlrev_b32 v8, 16, v8
    v_mul_f32 v8, v8, v12
    v_cvt_pk_bf16_f32 v9, v9, v9
    v_lshlrev_b32 v9, 16, v9
    v_cvt_pk_bf16_f32 v13, v13, v13
    v_lshlrev_b32 v13, 16, v13
    v_mul_f32 v17, 0xbfb8aa3b, v9
    v_exp_f32 v17, v17
    s_nop 0
    v_add_f32 v17, 1.0, v17
    v_rcp_f32 v17, v17
    s_nop 0
    v_mul_f32 v9, v9, v17
    v_cvt_pk_bf16_f32 v9, v9, v9
    v_lshlrev_b32 v9, 16, v9
    v_mul_f32 v9, v9, v13
    v_cvt_pk_bf16_f32 v10, v10, v10
    v_lshlrev_b32 v10, 16, v10
    v_cvt_pk_bf16_f32 v14, v14, v14
    v_lshlrev_b32 v14, 16, v14
    v_mul_f32 v18, 0xbfb8aa3b, v10
    v_exp_f32 v18, v18
    s_nop 0
    v_add_f32 v18, 1.0, v18
    v_rcp_f32 v18, v18
    s_nop 0
    v_mul_f32 v10, v10, v18
    v_cvt_pk_bf16_f32 v10, v10, v10
    v_lshlrev_b32 v10, 16, v10
    v_mul_f32 v10, v10, v14
    v_cvt_pk_bf16_f32 v11, v11, v11
    v_lshlrev_b32 v11, 16, v11
    v_cvt_pk_bf16_f32 v15, v15, v15
    v_lshlrev_b32 v15, 16, v15
    v_mul_f32 v19, 0xbfb8aa3b, v11
    v_exp_f32 v19, v19
    s_nop 0
    v_add_f32 v19, 1.0, v19
    v_rcp_f32 v19, v19
    s_nop 0
    v_mul_f32 v11, v11, v19
    v_cvt_pk_bf16_f32 v11, v11, v11
    v_lshlrev_b32 v11, 16, v11
    v_mul_f32 v11, v11, v15
    v_cvt_pk_bf16_f32 v16, v8, v9
    v_cvt_pk_bf16_f32 v17, v10, v11
    s_lshr_b32 s65, s24, 1
    s_lshl_b32 s65, s65, 10
    s_and_b32 s66, s24, 1
    s_lshl_b32 s66, s66, 3
    s_add_u32 s65, s65, s66
    s_add_u32 s65, s65, 0x5401000
    v_lshlrev_b32 v4, 4, v0
    buffer_store_dwordx2 v[16:17], v4, s[4:7], s65 offen sc1
    s_waitcnt vmcnt(0)
    v_mov_b32 v7, 1
    v_mov_b32 v8, 0
    s_mov_b32 s64, 0x298080
    s_mov_b64 exec, 1
    buffer_atomic_add v7, v8, s[4:7], s64 offen sc1
    s_mov_b64 exec, -1
H_A1:
    v_mbcnt_lo_u32_b32 v0, -1, 0
    v_mbcnt_hi_u32_b32 v0, -1, v0
    s_mov_b32 s29, 0
    v_lshlrev_b32 v1, 4, v0
    v_lshrrev_b32 v5, 4, v0
    v_lshlrev_b32 v2, 7, v5
    v_and_b32 v5, 7, v0
    v_lshl_add_u32 v2, v5, 4, v2
    v_bfe_u32 v5, v0, 4, 1
    v_lshlrev_b32 v3, 7, v5
    v_and_b32 v5, 15, v0
    v_lshl_add_u32 v3, v5, 3, v3
    s_mov_b32 s34, 0x3e0293ee
    s_mov_b32 s35, 0x3e0293ee
    s_mov_b32 s36, -1
    s_mov_b32 s37, 0
    v_lshrrev_b32 v5, 4, v0
    v_lshlrev_b32 v5, 2, v5
    v_and_b32 v6, 15, v0
    v_add_u32 v7, 0, v5
    v_cmp_le_u32 s[38:39], v7, v6
    v_add_u32 v7, 1, v5
    v_cmp_le_u32 s[40:41], v7, v6
    v_add_u32 v7, 2, v5
    v_cmp_le_u32 s[42:43], v7, v6
    v_add_u32 v7, 3, v5
    v_cmp_le_u32 s[44:45], v7, v6
    v_mov_b32 v248, 0x3f803f80
    v_mov_b32 v249, 0x3f803f80
    v_mov_b32 v250, 0x3f803f80
    v_mov_b32 v251, 0x3f803f80
    s_lshl_b32 s24, s12, 2
    s_add_u32 s24, s24, s14
    s_add_u32 s24, s24, 8
    s_mov_b32 s25, 1
AT1_LOOP:
    s_lshl_b32 s64, s24, 5
    s_add_u32 s64, s64, s13
    s_lshl_b32 s26, s64, 13
    s_add_u32 s26, s26, 0x3400000
    s_lshl_b32 s27, s64, 14
    s_add_u32 s27, s27, 0x1400000
    s_lshl_b32 s65, s64, 11
    s_add_u32 s30, s65, 0x640000
    s_add_u32 s31, s65, 0xa40000
    s_lshl_b32 s33, s64, 2
    s_add_u32 s33, s33, 0x296000
    s_lshl_b32 s32, s24, 18
    s_lshl_b32 s65, s13, 12
    s_add_u32 s32, s32, s65
    s_add_u32 s32, s32, 0x4400000
    s_lshr_b32 s65, s24, 2
    s_lshl_b32 s65, s65, 9
    s_lshl_b32 s66, s13, 4
    s_add_u32 s65, s65, s66
    s_add_u32 s65, s65, 0x291000
    s_lshr_b32 s66, s24, 1
    s_lshl_b32 s66, s66, 8
    s_lshl_b32 s64, s13, 3
    s_add_u32 s66, s66, s64
    s_add_u32 s66, s66, 0x293ff4
    v_lshlrev_b32 v5, 2, v0
    v_mov_b32 v6, s65
    v_mov_b32 v7, s66
    v_cmp_gt_u32 vcc, 3, v0
    s_nop 1
    v_cndmask_b32 v6, v7, v6, vcc
    v_add_u32 v4, v5, v6
    s_mov_b32 s64, 0
    s_mov_b64 exec, 7
AT1_F_164:
    buffer_load_dword v5, v4, s[4:7], s64 offen sc1
    s_add_u32 s29, s29, 1
    s_waitcnt vmcnt(0)
    v_cmp_eq_u32 vcc, 0, v5
    s_cbranch_vccz AT1_FD_165
    s_cmp_gt_u32 s29, 262144
    s_cbranch_scc1 AT1_FD_165
    s_sleep 1
    s_branch AT1_F_164
AT1_FD_165:
    s_mov_b64 exec, -1
    buffer_load_dwordx4 v[16:19], v1, s[4:7], s26 offen offset:0
    buffer_load_dwordx4 v[20:23], v1, s[4:7], s26 offen offset:1024
    buffer_load_dwordx4 v[24:27], v1, s[4:7], s26 offen offset:2048
    buffer_load_dwordx4 v[28:31], v1, s[4:7], s26 offen offset:3072
    s_add_u32 s26, s26, 4096
    buffer_load_dwordx4 v[32:35], v1, s[4:7], s26 offen offset:0
    buffer_load_dwordx4 v[36:39], v1, s[4:7], s26 offen offset:1024
    buffer_load_dwordx4 v[40:43], v1, s[4:7], s26 offen offset:2048
    buffer_load_dwordx4 v[44:47], v1, s[4:7], s26 offen offset:3072
    buffer_load_dwordx4 v[48:51], v1, s[4:7], s27 offen offset:0
    buffer_load_dwordx4 v[52:55], v1, s[4:7], s27 offen offset:1024
    buffer_load_dwordx4 v[56:59], v1, s[4:7], s27 offen offset:2048
    buffer_load_dwordx4 v[60:63], v1, s[4:7], s27 offen offset:3072
    s_add_u32 s27, s27, 4096
    buffer_load_dwordx4 v[64:67], v1, s[4:7], s27 offen offset:0
    buffer_load_dwordx4 v[68:71], v1, s[4:7], s27 offen offset:1024
    buffer_load_dwordx4 v[72:75], v1, s[4:7], s27 offen offset:2048
    buffer_load_dwordx4 v[76:79], v1, s[4:7], s27 offen offset:3072
    s_add_u32 s27, s27, 4096
    buffer_load_dwordx4 v[80:83], v1, s[4:7], s27 offen offset:0
    buffer_load_dwordx4 v[84:87], v1, s[4:7], s27 offen offset:1024
    buffer_load_dwordx4 v[88:91], v1, s[4:7], s27 offen offset:2048
    buffer_load_dwordx4 v[92:95], v1, s[4:7], s27 offen offset:3072
    s_add_u32 s27, s27, 4096
    buffer_load_dwordx4 v[96:99], v1, s[4:7], s27 offen offset:0
    buffer_load_dwordx4 v[100:103], v1, s[4:7], s27 offen offset:1024
    buffer_load_dwordx4 v[104:107], v1, s[4:7], s27 offen offset:2048
    buffer_load_dwordx4 v[108:111], v1, s[4:7], s27 offen offset:3072
    s_mov_b64 exec, 0x18
AT1_G_166:
    buffer_load_dword v5, v4, s[4:7], s64 offen sc1
    s_add_u32 s29, s29, 1
    s_waitcnt vmcnt(0)
    v_cmp_eq_u32 vcc, 0, v5
    s_cbranch_vccz AT1_GD_167
    s_cmp_gt_u32 s29, 262144
    s_cbranch_scc1 AT1_GD_167
    s_sleep 1
    s_branch AT1_G_166
AT1_GD_167:
    s_mov_b64 exec, -1
    buffer_load_dwordx4 v[112:115], v2, s[4:7], s30 offen offset:0
    buffer_load_dwordx4 v[116:119], v2, s[4:7], s30 offen offset:512
    buffer_load_dwordx4 v[120:123], v2, s[4:7], s30 offen offset:1024
    buffer_load_dwordx4 v[124:127], v2, s[4:7], s30 offen offset:1536
    buffer_load_dwordx2 v[128:129], v3, s[4:7], s31 offen offset:0
    buffer_load_dwordx2 v[130:131], v3, s[4:7], s31 offen offset:256
    buffer_load_dwordx2 v[132:133], v3, s[4:7], s31 offen offset:512
    buffer_load_dwordx2 v[134:135], v3, s[4:7], s31 offen offset:768
    buffer_load_dwordx2 v[136:137], v3, s[4:7], s31 offen offset:1024
    buffer_load_dwordx2 v[138:139], v3, s[4:7], s31 offen offset:1280
    buffer_load_dwordx2 v[140:141], v3, s[4:7], s31 offen offset:1536
    buffer_load_dwordx2 v[142:143], v3, s[4:7], s31 offen offset:1792
    v_mfma_f32_16x16x32_bf16 v[148:151], v[48:51], v[16:19], 0
    v_mfma_f32_16x16x32_bf16 v[156:159], v[48:51], v[32:35], 0
    v_mfma_f32_16x16x32_bf16 v[160:163], v[64:67], v[32:35], 0
    v_mfma_f32_16x16x32_bf16 v[148:151], v[52:55], v[20:23], v[148:151]
    v_mfma_f32_16x16x32_bf16 v[156:159], v[52:55], v[36:39], v[156:159]
    v_mfma_f32_16x16x32_bf16 v[160:163], v[68:71], v[36:39], v[160:163]
    v_mfma_f32_16x16x32_bf16 v[148:151], v[56:59], v[24:27], v[148:151]
    v_mfma_f32_16x16x32_bf16 v[156:159], v[56:59], v[40:43], v[156:159]
    v_mfma_f32_16x16x32_bf16 v[160:163], v[72:75], v[40:43], v[160:163]
    v_mfma_f32_16x16x32_bf16 v[148:151], v[60:63], v[28:31], v[148:151]
    v_mfma_f32_16x16x32_bf16 v[156:159], v[60:63], v[44:47], v[156:159]
    v_mfma_f32_16x16x32_bf16 v[160:163], v[76:79], v[44:47], v[160:163]
    s_waitcnt vmcnt(8)
    v_mfma_f32_16x16x32_bf16 v[144:147], v[112:115], v[16:19], 0
    v_mfma_f32_16x16x32_bf16 v[152:155], v[112:115], v[32:35], 0
    v_mfma_f32_16x16x32_bf16 v[144:147], v[116:119], v[20:23], v[144:147]
    v_mfma_f32_16x16x32_bf16 v[152:155], v[116:119], v[36:39], v[152:155]
    v_mfma_f32_16x16x32_bf16 v[144:147], v[120:123], v[24:27], v[144:147]
    v_mfma_f32_16x16x32_bf16 v[152:155], v[120:123], v[40:43], v[152:155]
    v_mfma_f32_16x16x32_bf16 v[144:147], v[124:127], v[28:31], v[144:147]
    v_mfma_f32_16x16x32_bf16 v[152:155], v[124:127], v[44:47], v[152:155]
    v_mov_b32 v11, 0xff800000
    s_nop 7
    v_cndmask_b32 v148, v11, v148, s[38:39]
    v_cndmask_b32 v160, v11, v160, s[38:39]
    v_cndmask_b32 v144, v11, v144, s[36:37]
    v_cndmask_b32 v152, v11, v152, s[36:37]
    v_cndmask_b32 v149, v11, v149, s[40:41]
    v_cndmask_b32 v161, v11, v161, s[40:41]
    v_cndmask_b32 v145, v11, v145, s[36:37]
    v_cndmask_b32 v153, v11, v153, s[36:37]
    v_cndmask_b32 v150, v11, v150, s[42:43]
    v_cndmask_b32 v162, v11, v162, s[42:43]
    v_cndmask_b32 v146, v11, v146, s[36:37]
    v_cndmask_b32 v154, v11, v154, s[36:37]
    v_cndmask_b32 v151, v11, v151, s[44:45]
    v_cndmask_b32 v163, v11, v163, s[44:45]
    v_cndmask_b32 v147, v11, v147, s[36:37]
    v_cndmask_b32 v155, v11, v155, s[36:37]
    v_max3_f32 v8, v144, v145, v146
    v_max3_f32 v8, v8, v147, v148
    v_max3_f32 v8, v8, v149, v150
    v_max_f32 v8, v8, v151
    v_mov_b32 v9, v8
    s_nop 1
    v_permlane16_swap_b32 v8, v9
    v_max_f32 v8, v8, v9
    v_mov_b32 v9, v8
    s_nop 1
    v_permlane32_swap_b32 v8, v9
    v_max_f32 v8, v8, v9
    v_mul_f32 v8, s34, v8
    v_fma_f32 v144, v144, s34, -v8
    v_fma_f32 v145, v145, s34, -v8
    v_fma_f32 v146, v146, s34, -v8
    v_fma_f32 v147, v147, s34, -v8
    v_fma_f32 v148, v148, s34, -v8
    v_fma_f32 v149, v149, s34, -v8
    v_fma_f32 v150, v150, s34, -v8
    v_fma_f32 v151, v151, s34, -v8
    v_exp_f32 v144, v144
    v_exp_f32 v145, v145
    v_exp_f32 v146, v146
    v_exp_f32 v147, v147
    v_exp_f32 v148, v148
    v_exp_f32 v149, v149
    v_exp_f32 v150, v150
    v_exp_f32 v151, v151
    s_nop 0
    v_cvt_pk_bf16_f32 v164, v148, v149
    v_cvt_pk_bf16_f32 v165, v150, v151
    v_mov_b32 v166, 0
    v_mov_b32 v167, 0
    v_cvt_pk_bf16_f32 v168, v144, v145
    v_cvt_pk_bf16_f32 v169, v146, v147
    v_max3_f32 v8, v152, v153, v154
    v_max3_f32 v8, v8, v155, v156
    v_max3_f32 v8, v8, v157, v158
    v_max3_f32 v8, v8, v159, v160
    v_max3_f32 v8, v8, v161, v162
    v_max_f32 v8, v8, v163
    v_mov_b32 v9, v8
    s_nop 1
    v_permlane16_swap_b32 v8, v9
    v_max_f32 v8, v8, v9
    v_mov_b32 v9, v8
    s_nop 1
    v_permlane32_swap_b32 v8, v9
    v_max_f32 v8, v8, v9
    v_mul_f32 v8, s34, v8
    v_fma_f32 v152, v152, s34, -v8
    v_fma_f32 v153, v153, s34, -v8
    v_fma_f32 v154, v154, s34, -v8
    v_fma_f32 v155, v155, s34, -v8
    v_fma_f32 v156, v156, s34, -v8
    v_fma_f32 v157, v157, s34, -v8
    v_fma_f32 v158, v158, s34, -v8
    v_fma_f32 v159, v159, s34, -v8
    v_fma_f32 v160, v160, s34, -v8
    v_fma_f32 v161, v161, s34, -v8
    v_fma_f32 v162, v162, s34, -v8
    v_fma_f32 v163, v163, s34, -v8
    v_exp_f32 v152, v152
    v_exp_f32 v153, v153
    v_exp_f32 v154, v154
    v_exp_f32 v155, v155
    v_exp_f32 v156, v156
    v_exp_f32 v157, v157
    v_exp_f32 v158, v158
    v_exp_f32 v159, v159
    v_exp_f32 v160, v160
    v_exp_f32 v161, v161
    v_exp_f32 v162, v162
    v_exp_f32 v163, v163
    s_nop 0
    v_cvt_pk_bf16_f32 v170, v156, v157
    v_cvt_pk_bf16_f32 v171, v158, v159
    v_cvt_pk_bf16_f32 v172, v160, v161
    v_cvt_pk_bf16_f32 v173, v162, v163
    v_cvt_pk_bf16_f32 v174, v152, v153
    v_cvt_pk_bf16_f32 v175, v154, v155
    s_waitcnt vmcnt(0)
    v_mfma_f32_16x16x32_bf16 v[240:243], v[248:251], v[164:167], 0
    v_mfma_f32_16x16x32_bf16 v[244:247], v[248:251], v[170:173], 0
    v_mfma_f32_16x16x32_bf16 v[176:179], v[80:83], v[164:167], 0
    v_mfma_f32_16x16x32_bf16 v[180:183], v[80:83], v[170:173], 0
    v_mfma_f32_16x16x32_bf16 v[184:187], v[84:87], v[164:167], 0
    v_mfma_f32_16x16x32_bf16 v[188:191], v[84:87], v[170:173], 0
    v_mfma_f32_16x16x32_bf16 v[192:195], v[88:91], v[164:167], 0
    v_mfma_f32_16x16x32_bf16 v[196:199], v[88:91], v[170:173], 0
    v_mfma_f32_16x16x32_bf16 v[200:203], v[92:95], v[164:167], 0
    v_mfma_f32_16x16x32_bf16 v[204:207], v[92:95], v[170:173], 0
    v_mfma_f32_16x16x32_bf16 v[208:211], v[96:99], v[164:167], 0
    v_mfma_f32_16x16x32_bf16 v[212:215], v[96:99], v[170:173], 0
    v_mfma_f32_16x16x32_bf16 v[216:219], v[100:103], v[164:167], 0
    v_mfma_f32_16x16x32_bf16 v[220:223], v[100:103], v[170:173], 0
    v_mfma_f32_16x16x32_bf16 v[224:227], v[104:107], v[164:167], 0
    v_mfma_f32_16x16x32_bf16 v[228:231], v[104:107], v[170:173], 0
    v_mfma_f32_16x16x32_bf16 v[232:235], v[108:111], v[164:167], 0
    v_mfma_f32_16x16x32_bf16 v[236:239], v[108:111], v[170:173], 0
    v_mfma_f32_16x16x16_bf16 v[240:243], v[248:249], v[168:169], v[240:243]
    v_mfma_f32_16x16x16_bf16 v[244:247], v[248:249], v[174:175], v[244:247]
    v_mfma_f32_16x16x16_bf16 v[176:179], v[128:129], v[168:169], v[176:179]
    v_mfma_f32_16x16x16_bf16 v[180:183], v[128:129], v[174:175], v[180:183]
    v_mfma_f32_16x16x16_bf16 v[184:187], v[130:131], v[168:169], v[184:187]
    v_mfma_f32_16x16x16_bf16 v[188:191], v[130:131], v[174:175], v[188:191]
    v_mfma_f32_16x16x16_bf16 v[192:195], v[132:133], v[168:169], v[192:195]
    v_mfma_f32_16x16x16_bf16 v[196:199], v[132:133], v[174:175], v[196:199]
    v_mfma_f32_16x16x16_bf16 v[200:203], v[134:135], v[168:169], v[200:203]
    v_mfma_f32_16x16x16_bf16 v[204:207], v[134:135], v[174:175], v[204:207]
    v_mfma_f32_16x16x16_bf16 v[208:211], v[136:137], v[168:169], v[208:211]
    v_mfma_f32_16x16x16_bf16 v[212:215], v[136:137], v[174:175], v[212:215]
    v_mfma_f32_16x16x16_bf16 v[216:219], v[138:139], v[168:169], v[216:219]
    v_mfma_f32_16x16x16_bf16 v[220:223], v[138:139], v[174:175], v[220:223]
    v_mfma_f32_16x16x16_bf16 v[224:227], v[140:141], v[168:169], v[224:227]
    v_mfma_f32_16x16x16_bf16 v[228:231], v[140:141], v[174:175], v[228:231]
    v_mfma_f32_16x16x16_bf16 v[232:235], v[142:143], v[168:169], v[232:235]
    v_mfma_f32_16x16x16_bf16 v[236:239], v[142:143], v[174:175], v[236:239]
    v_rcp_f32 v8, v240
    v_rcp_f32 v9, v244
    s_nop 7
    v_mul_f32 v176, v176, v8
    v_mul_f32 v177, v177, v8
    v_mul_f32 v178, v178, v8
    v_mul_f32 v179, v179, v8
    v_cvt_pk_bf16_f32 v16, v176, v177
    v_cvt_pk_bf16_f32 v17, v178, v179
    v_mul_f32 v184, v184, v8
    v_mul_f32 v185, v185, v8
    v_mul_f32 v186, v186, v8
    v_mul_f32 v187, v187, v8
    v_cvt_pk_bf16_f32 v18, v184, v185
    v_cvt_pk_bf16_f32 v19, v186, v187
    s_add_u32 s64, s32, 0x0
    buffer_store_dwordx4 v[16:19], v1, s[4:7], s64 offen offset:0 sc1
    v_mul_f32 v192, v192, v8
    v_mul_f32 v193, v193, v8
    v_mul_f32 v194, v194, v8
    v_mul_f32 v195, v195, v8
    v_cvt_pk_bf16_f32 v20, v192, v193
    v_cvt_pk_bf16_f32 v21, v194, v195
    v_mul_f32 v200, v200, v8
    v_mul_f32 v201, v201, v8
    v_mul_f32 v202, v202, v8
    v_mul_f32 v203, v203, v8
    v_cvt_pk_bf16_f32 v22, v200, v201
    v_cvt_pk_bf16_f32 v23, v202, v203
    s_add_u32 s64, s32, 0x0
    buffer_store_dwordx4 v[20:23], v1, s[4:7], s64 offen offset:1024 sc1
    v_mul_f32 v208, v208, v8
    v_mul_f32 v209, v209, v8
    v_mul_f32 v210, v210, v8
    v_mul_f32 v211, v211, v8
    v_cvt_pk_bf16_f32 v24, v208, v209
    v_cvt_pk_bf16_f32 v25, v210, v211
    v_mul_f32 v216, v216, v8
    v_mul_f32 v217, v217, v8
    v_mul_f32 v218, v218, v8
    v_mul_f32 v219, v219, v8
    v_cvt_pk_bf16_f32 v26, v216, v217
    v_cvt_pk_bf16_f32 v27, v218, v219
    s_add_u32 s64, s32, 0x0
    buffer_store_dwordx4 v[24:27], v1, s[4:7], s64 offen offset:2048 sc1
    v_mul_f32 v224, v224, v8
    v_mul_f32 v225, v225, v8
    v_mul_f32 v226, v226, v8
    v_mul_f32 v227, v227, v8
    v_cvt_pk_bf16_f32 v28, v224, v225
    v_cvt_pk_bf16_f32 v29, v226, v227
    v_mul_f32 v232, v232, v8
    v_mul_f32 v233, v233, v8
    v_mul_f32 v234, v234, v8
    v_mul_f32 v235, v235, v8
    v_cvt_pk_bf16_f32 v30, v232, v233
    v_cvt_pk_bf16_f32 v31, v234, v235
    s_add_u32 s64, s32, 0x0
    buffer_store_dwordx4 v[28:31], v1, s[4:7], s64 offen offset:3072 sc1
    v_mul_f32 v180, v180, v9
    v_mul_f32 v181, v181, v9
    v_mul_f32 v182, v182, v9
    v_mul_f32 v183, v183, v9
    v_cvt_pk_bf16_f32 v32, v180, v181
    v_cvt_pk_bf16_f32 v33, v182, v183
    v_mul_f32 v188, v188, v9
    v_mul_f32 v189, v189, v9
    v_mul_f32 v190, v190, v9
    v_mul_f32 v191, v191, v9
    v_cvt_pk_bf16_f32 v34, v188, v189
    v_cvt_pk_bf16_f32 v35, v190, v191
    s_add_u32 s64, s32, 0x20000
    buffer_store_dwordx4 v[32:35], v1, s[4:7], s64 offen offset:0 sc1
    v_mul_f32 v196, v196, v9
    v_mul_f32 v197, v197, v9
    v_mul_f32 v198, v198, v9
    v_mul_f32 v199, v199, v9
    v_cvt_pk_bf16_f32 v36, v196, v197
    v_cvt_pk_bf16_f32 v37, v198, v199
    v_mul_f32 v204, v204, v9
    v_mul_f32 v205, v205, v9
    v_mul_f32 v206, v206, v9
    v_mul_f32 v207, v207, v9
    v_cvt_pk_bf16_f32 v38, v204, v205
    v_cvt_pk_bf16_f32 v39, v206, v207
    s_add_u32 s64, s32, 0x20000
    buffer_store_dwordx4 v[36:39], v1, s[4:7], s64 offen offset:1024 sc1
    v_mul_f32 v212, v212, v9
    v_mul_f32 v213, v213, v9
    v_mul_f32 v214, v214, v9
    v_mul_f32 v215, v215, v9
    v_cvt_pk_bf16_f32 v40, v212, v213
    v_cvt_pk_bf16_f32 v41, v214, v215
    v_mul_f32 v220, v220, v9
    v_mul_f32 v221, v221, v9
    v_mul_f32 v222, v222, v9
    v_mul_f32 v223, v223, v9
    v_cvt_pk_bf16_f32 v42, v220, v221
    v_cvt_pk_bf16_f32 v43, v222, v223
    s_add_u32 s64, s32, 0x20000
    buffer_store_dwordx4 v[40:43], v1, s[4:7], s64 offen offset:2048 sc1
    v_mul_f32 v228, v228, v9
    v_mul_f32 v229, v229, v9
    v_mul_f32 v230, v230, v9
    v_mul_f32 v231, v231, v9
    v_cvt_pk_bf16_f32 v44, v228, v229
    v_cvt_pk_bf16_f32 v45, v230, v231
    v_mul_f32 v236, v236, v9
    v_mul_f32 v237, v237, v9
    v_mul_f32 v238, v238, v9
    v_mul_f32 v239, v239, v9
    v_cvt_pk_bf16_f32 v46, v236, v237
    v_cvt_pk_bf16_f32 v47, v238, v239
    s_add_u32 s64, s32, 0x20000
    buffer_store_dwordx4 v[44:47], v1, s[4:7], s64 offen offset:3072 sc1
    s_waitcnt vmcnt(0)
    v_mov_b32 v7, 1
    v_mov_b32 v8, 0
    s_mov_b64 exec, 1
    buffer_store_dword v7, v8, s[4:7], s33 offen sc1
    s_mov_b64 exec, -1
    s_add_u32 s24, s24, 8
    s_add_u32 s25, s25, 1
    s_cmp_lt_u32 s25, 2
    s_cbranch_scc1 AT1_LOOP
    s_lshl_b32 s70, s13, 1
    s_add_u32 s70, s70, s12
    s_load_dwordx2 s[44:45], s[0:1], 72
    s_mov_b32 s46, 0x21c000
    s_mov_b32 s47, 0x00020000
    s_load_dwordx2 s[48:49], s[0:1], 80
    s_mov_b32 s50, 0x21c000
    s_mov_b32 s51, 0x00020000
    s_load_dwordx2 s[52:53], s[0:1], 88
    s_mov_b32 s54, 0x21c000
    s_mov_b32 s55, 0x00020000
    s_mov_b32 s29, 0
    s_waitcnt lgkmcnt(0)
    v_mbcnt_lo_u32_b32 v0, -1, 0
    v_mbcnt_hi_u32_b32 v0, -1, v0
    s_cmp_lg_u32 s14, 0
    s_cbranch_scc1 H_ATT
    s_cmp_ge_u32 s70, 40
    s_cbranch_scc1 H_ATT
    s_mov_b32 s24, s70
    v_mov_b32 v8, 0
    s_mov_b32 s64, 0x298080
F2W_168:
    buffer_load_dword v7, v8, s[4:7], s64 offen sc1
    s_add_u32 s29, s29, 1
    s_waitcnt vmcnt(0)
    v_mov_b32 v9, 108
    v_cmp_gt_u32 vcc, v9, v7
    s_cbranch_vccz F2WD_169
    s_cmp_gt_u32 s29, 262144
    s_cbranch_scc1 F2WD_169
    s_sleep 8
    s_branch F2W_168
F2WD_169:
    s_mov_b32 s25, 0
    v_lshrrev_b32 v7, 1, v0
    v_mul_u32_u24 v2, 1280, v7
    v_and_b32 v7, 1, v0
    v_lshl_add_u32 v2, v7, 4, v2
    v_lshrrev_b32 v7, 4, v0
    v_lshlrev_b32 v3, 7, v7
    v_bfe_u32 v7, v0, 2, 2
    v_lshl_add_u32 v3, v7, 5, v3
    v_and_b32 v7, 3, v0
    v_lshl_add_u32 v3, v7, 3, v3
    v_add_u32 v3, s25, v3
    v_lshlrev_b32 v4, 4, v0
    s_mov_b32 s65, 0x5401000
    buffer_load_dwordx4 v[16:19], v4, s[4:7], s65 offen offset:0 sc1
    buffer_load_dwordx4 v[20:23], v4, s[4:7], s65 offen offset:1024 sc1
    buffer_load_dwordx4 v[24:27], v4, s[4:7], s65 offen offset:2048 sc1
    buffer_load_dwordx4 v[28:31], v4, s[4:7], s65 offen offset:3072 sc1
    s_add_u32 s65, s65, 4096
    buffer_load_dwordx4 v[32:35], v4, s[4:7], s65 offen offset:0 sc1
    buffer_load_dwordx4 v[36:39], v4, s[4:7], s65 offen offset:1024 sc1
    buffer_load_dwordx4 v[40:43], v4, s[4:7], s65 offen offset:2048 sc1
    buffer_load_dwordx4 v[44:47], v4, s[4:7], s65 offen offset:3072 sc1
    s_add_u32 s65, s65, 4096
    buffer_load_dwordx4 v[48:51], v4, s[4:7], s65 offen offset:0 sc1
    buffer_load_dwordx4 v[52:55], v4, s[4:7], s65 offen offset:1024 sc1
    buffer_load_dwordx4 v[56:59], v4, s[4:7], s65 offen offset:2048 sc1
    buffer_load_dwordx4 v[60:63], v4, s[4:7], s65 offen offset:3072 sc1
    s_add_u32 s65, s65, 4096
    buffer_load_dwordx4 v[64:67], v4, s[4:7], s65 offen offset:0 sc1
    buffer_load_dwordx4 v[68:71], v4, s[4:7], s65 offen offset:1024 sc1
    buffer_load_dwordx4 v[72:75], v4, s[4:7], s65 offen offset:2048 sc1
    buffer_load_dwordx4 v[76:79], v4, s[4:7], s65 offen offset:3072 sc1
    s_add_u32 s65, s65, 4096
    buffer_load_dwordx4 v[80:83], v4, s[4:7], s65 offen offset:0 sc1
    buffer_load_dwordx4 v[84:87], v4, s[4:7], s65 offen offset:1024 sc1
    buffer_load_dwordx4 v[88:91], v4, s[4:7], s65 offen offset:2048 sc1
    buffer_load_dwordx4 v[92:95], v4, s[4:7], s65 offen offset:3072 sc1
    s_add_u32 s65, s65, 4096
    buffer_load_dwordx4 v[96:99], v4, s[4:7], s65 offen offset:0 sc1
    buffer_load_dwordx4 v[100:103], v4, s[4:7], s65 offen offset:1024 sc1
    buffer_load_dwordx4 v[104:107], v4, s[4:7], s65 offen offset:2048 sc1
    buffer_load_dwordx4 v[108:111], v4, s[4:7], s65 offen offset:3072 sc1
    s_add_u32 s65, s65, 4096
    buffer_load_dwordx4 v[112:115], v4, s[4:7], s65 offen offset:0 sc1
    buffer_load_dwordx4 v[116:119], v4, s[4:7], s65 offen offset:1024 sc1
    buffer_load_dwordx4 v[120:123], v4, s[4:7], s65 offen offset:2048 sc1
    buffer_load_dwordx4 v[124:127], v4, s[4:7], s65 offen offset:3072 sc1
    s_add_u32 s65, s65, 4096
    buffer_load_dwordx4 v[128:131], v4, s[4:7], s65 offen offset:0 sc1
    buffer_load_dwordx4 v[132:135], v4, s[4:7], s65 offen offset:1024 sc1
    buffer_load_dwordx4 v[136:139], v4, s[4:7], s65 offen offset:2048 sc1
    buffer_load_dwordx4 v[140:143], v4, s[4:7], s65 offen offset:3072 sc1
    s_add_u32 s65, s65, 4096
    buffer_load_dwordx4 v[144:147], v4, s[4:7], s65 offen offset:0 sc1
    buffer_load_dwordx4 v[148:151], v4, s[4:7], s65 offen offset:1024 sc1
    buffer_load_dwordx4 v[152:155], v4, s[4:7], s65 offen offset:2048 sc1
    buffer_load_dwordx4 v[156:159], v4, s[4:7], s65 offen offset:3072 sc1
    s_add_u32 s65, s65, 4096
    buffer_load_dwordx4 v[160:163], v4, s[4:7], s65 offen offset:0 sc1
    buffer_load_dwordx4 v[164:167], v4, s[4:7], s65 offen offset:1024 sc1
    buffer_load_dwordx4 v[168:171], v4, s[4:7], s65 offen offset:2048 sc1
    buffer_load_dwordx4 v[172:175], v4, s[4:7], s65 offen offset:3072 sc1
    s_add_u32 s65, s65, 4096
    buffer_load_dwordx4 v[176:179], v4, s[4:7], s65 offen offset:0 sc1
    s_waitcnt vmcnt(20)
    buffer_load_dwordx4 v[180:183], v4, s[4:7], s65 offen offset:1024 sc1
    buffer_load_dwordx4 v[184:187], v4, s[4:7], s65 offen offset:2048 sc1
    buffer_load_dwordx4 v[188:191], v4, s[4:7], s65 offen offset:3072 sc1
    s_add_u32 s65, s65, 4096
    buffer_load_dwordx4 v[192:195], v4, s[4:7], s65 offen offset:0 sc1
    buffer_load_dwordx4 v[196:199], v4, s[4:7], s65 offen offset:1024 sc1
    buffer_load_dwordx4 v[200:203], v4, s[4:7], s65 offen offset:2048 sc1
    buffer_load_dwordx4 v[204:207], v4, s[4:7], s65 offen offset:3072 sc1
    s_add_u32 s65, s65, 4096
    buffer_load_dwordx4 v[208:211], v4, s[4:7], s65 offen offset:0 sc1
    buffer_load_dwordx4 v[212:215], v4, s[4:7], s65 offen offset:1024 sc1
    buffer_load_dwordx4 v[216:219], v4, s[4:7], s65 offen offset:2048 sc1
    buffer_load_dwordx4 v[220:223], v4, s[4:7], s65 offen offset:3072 sc1
    s_add_u32 s65, s65, 4096
    buffer_load_dwordx4 v[224:227], v4, s[4:7], s65 offen offset:0 sc1
    buffer_load_dwordx4 v[228:231], v4, s[4:7], s65 offen offset:1024 sc1
    s_waitcnt vmcnt(0)
    s_lshl_b32 s26, s24, 5
    s_add_u32 m0, s25, 0
    s_add_u32 s64, s26, 0x0
    buffer_load_dwordx4 v2, s[52:55], s64 offen lds
    s_add_u32 m0, s25, 1024
    s_add_u32 s64, s26, 0xa000
    buffer_load_dwordx4 v2, s[52:55], s64 offen lds
    s_add_u32 m0, s25, 2048
    s_add_u32 s64, s26, 0x14000
    buffer_load_dwordx4 v2, s[52:55], s64 offen lds
    s_add_u32 m0, s25, 3072
    s_add_u32 s64, s26, 0x1e000
    buffer_load_dwordx4 v2, s[52:55], s64 offen lds
    s_add_u32 m0, s25, 4096
    s_add_u32 s64, s26, 0x28000
    buffer_load_dwordx4 v2, s[52:55], s64 offen lds
    s_add_u32 m0, s25, 5120
    s_add_u32 s64, s26, 0x32000
    buffer_load_dwordx4 v2, s[52:55], s64 offen lds
    s_add_u32 m0, s25, 6144
    s_add_u32 s64, s26, 0x3c000
    buffer_load_dwordx4 v2, s[52:55], s64 offen lds
    s_add_u32 m0, s25, 7168
    s_add_u32 s64, s26, 0x46000
    buffer_load_dwordx4 v2, s[52:55], s64 offen lds
    s_add_u32 m0, s25, 8192
    s_add_u32 s64, s26, 0x50000
    buffer_load_dwordx4 v2, s[52:55], s64 offen lds
    s_add_u32 m0, s25, 9216
    s_add_u32 s64, s26, 0x5a000
    buffer_load_dwordx4 v2, s[52:55], s64 offen lds
    s_add_u32 m0, s25, 10240
    s_add_u32 s64, s26, 0x64000
    buffer_load_dwordx4 v2, s[52:55], s64 offen lds
    s_add_u32 m0, s25, 11264
    s_add_u32 s64, s26, 0x6e000
    buffer_load_dwordx4 v2, s[52:55], s64 offen lds
    s_add_u32 m0, s25, 12288
    s_add_u32 s64, s26, 0x78000
    buffer_load_dwordx4 v2, s[52:55], s64 offen lds
    s_add_u32 m0, s25, 13312
    s_add_u32 s64, s26, 0x82000
    buffer_load_dwordx4 v2, s[52:55], s64 offen lds
    s_add_u32 m0, s25, 14336
    s_add_u32 s64, s26, 0x8c000
    buffer_load_dwordx4 v2, s[52:55], s64 offen lds
    s_add_u32 m0, s25, 15360
    s_add_u32 s64, s26, 0x96000
    buffer_load_dwordx4 v2, s[52:55], s64 offen lds
    s_add_u32 m0, s25, 16384
    s_add_u32 s64, s26, 0xa0000
    buffer_load_dwordx4 v2, s[52:55], s64 offen lds
    s_add_u32 m0, s25, 17408
    s_add_u32 s64, s26, 0xaa000
    buffer_load_dwordx4 v2, s[52:55], s64 offen lds
    s_add_u32 m0, s25, 18432
    s_add_u32 s64, s26, 0xb4000
    buffer_load_dwordx4 v2, s[52:55], s64 offen lds
    s_add_u32 m0, s25, 19456
    s_add_u32 s64, s26, 0xbe000
    buffer_load_dwordx4 v2, s[52:55], s64 offen lds
    s_add_u32 m0, s25, 20480
    s_add_u32 s64, s26, 0xc8000
    buffer_load_dwordx4 v2, s[52:55], s64 offen lds
    s_add_u32 m0, s25, 21504
    s_add_u32 s64, s26, 0xd2000
    buffer_load_dwordx4 v2, s[52:55], s64 offen lds
    s_add_u32 m0, s25, 22528
    s_add_u32 s64, s26, 0xdc000
    buffer_load_dwordx4 v2, s[52:55], s64 offen lds
    s_add_u32 m0, s25, 23552
    s_add_u32 s64, s26, 0xe6000
    buffer_load_dwordx4 v2, s[52:55], s64 offen lds
    s_add_u32 m0, s25, 24576
    s_add_u32 s64, s26, 0xf0000
    buffer_load_dwordx4 v2, s[52:55], s64 offen lds
    s_add_u32 m0, s25, 25600
    s_add_u32 s64, s26, 0xfa000
    buffer_load_dwordx4 v2, s[52:55], s64 offen lds
    s_add_u32 m0, s25, 26624
    s_add_u32 s64, s26, 0x104000
    buffer_load_dwordx4 v2, s[52:55], s64 offen lds
    s_add_u32 m0, s25, 27648
    s_add_u32 s64, s26, 0x10e000
    buffer_load_dwordx4 v2, s[52:55], s64 offen lds
    s_add_u32 m0, s25, 28672
    s_add_u32 s64, s26, 0x118000
    buffer_load_dwordx4 v2, s[52:55], s64 offen lds
    s_add_u32 m0, s25, 29696
    s_add_u32 s64, s26, 0x122000
    buffer_load_dwordx4 v2, s[52:55], s64 offen lds
    s_add_u32 m0, s25, 30720
    s_add_u32 s64, s26, 0x12c000
    buffer_load_dwordx4 v2, s[52:55], s64 offen lds
    s_add_u32 m0, s25, 31744
    s_add_u32 s64, s26, 0x136000
    buffer_load_dwordx4 v2, s[52:55], s64 offen lds
    s_add_u32 m0, s25, 32768
    s_add_u32 s64, s26, 0x140000
    buffer_load_dwordx4 v2, s[52:55], s64 offen lds
    s_add_u32 m0, s25, 33792
    s_add_u32 s64, s26, 0x14a000
    buffer_load_dwordx4 v2, s[52:55], s64 offen lds
    s_add_u32 m0, s25, 34816
    s_add_u32 s64, s26, 0x154000
    buffer_load_dwordx4 v2, s[52:55], s64 offen lds
    s_add_u32 m0, s25, 35840
    s_add_u32 s64, s26, 0x15e000
    buffer_load_dwordx4 v2, s[52:55], s64 offen lds
    s_add_u32 m0, s25, 36864
    s_add_u32 s64, s26, 0x168000
    buffer_load_dwordx4 v2, s[52:55], s64 offen lds
    s_add_u32 m0, s25, 37888
    s_add_u32 s64, s26, 0x172000
    buffer_load_dwordx4 v2, s[52:55], s64 offen lds
    s_add_u32 m0, s25, 38912
    s_add_u32 s64, s26, 0x17c000
    buffer_load_dwordx4 v2, s[52:55], s64 offen lds
    s_add_u32 m0, s25, 39936
    s_add_u32 s64, s26, 0x186000
    buffer_load_dwordx4 v2, s[52:55], s64 offen lds
    s_add_u32 m0, s25, 40960
    s_add_u32 s64, s26, 0x190000
    buffer_load_dwordx4 v2, s[52:55], s64 offen lds
    s_waitcnt vmcnt(20)
    s_add_u32 m0, s25, 41984
    s_add_u32 s64, s26, 0x19a000
    buffer_load_dwordx4 v2, s[52:55], s64 offen lds
    s_add_u32 m0, s25, 43008
    s_add_u32 s64, s26, 0x1a4000
    buffer_load_dwordx4 v2, s[52:55], s64 offen lds
    s_add_u32 m0, s25, 44032
    s_add_u32 s64, s26, 0x1ae000
    buffer_load_dwordx4 v2, s[52:55], s64 offen lds
    s_add_u32 m0, s25, 45056
    s_add_u32 s64, s26, 0x1b8000
    buffer_load_dwordx4 v2, s[52:55], s64 offen lds
    s_add_u32 m0, s25, 46080
    s_add_u32 s64, s26, 0x1c2000
    buffer_load_dwordx4 v2, s[52:55], s64 offen lds
    s_add_u32 m0, s25, 47104
    s_add_u32 s64, s26, 0x1cc000
    buffer_load_dwordx4 v2, s[52:55], s64 offen lds
    s_add_u32 m0, s25, 48128
    s_add_u32 s64, s26, 0x1d6000
    buffer_load_dwordx4 v2, s[52:55], s64 offen lds
    s_add_u32 m0, s25, 49152
    s_add_u32 s64, s26, 0x1e0000
    buffer_load_dwordx4 v2, s[52:55], s64 offen lds
    s_add_u32 m0, s25, 50176
    s_add_u32 s64, s26, 0x1ea000
    buffer_load_dwordx4 v2, s[52:55], s64 offen lds
    s_add_u32 m0, s25, 51200
    s_add_u32 s64, s26, 0x1f4000
    buffer_load_dwordx4 v2, s[52:55], s64 offen lds
    s_add_u32 m0, s25, 52224
    s_add_u32 s64, s26, 0x1fe000
    buffer_load_dwordx4 v2, s[52:55], s64 offen lds
    s_add_u32 m0, s25, 53248
    s_add_u32 s64, s26, 0x208000
    buffer_load_dwordx4 v2, s[52:55], s64 offen lds
    s_add_u32 m0, s25, 54272
    s_add_u32 s64, s26, 0x212000
    buffer_load_dwordx4 v2, s[52:55], s64 offen lds
    s_waitcnt vmcnt(0)
    ds_read_b64_tr_b16 v[232:233], v3 offset:0
    ds_read_b64_tr_b16 v[234:235], v3 offset:512
    s_waitcnt lgkmcnt(0)
    v_mfma_f32_16x16x32_bf16 v[8:11], v[232:235], v[16:19], 0
    ds_read_b64_tr_b16 v[236:237], v3 offset:1024
    ds_read_b64_tr_b16 v[238:239], v3 offset:1536
    s_waitcnt lgkmcnt(0)
    v_mfma_f32_16x16x32_bf16 v[8:11], v[236:239], v[20:23], v[8:11]
    ds_read_b64_tr_b16 v[240:241], v3 offset:2048
    ds_read_b64_tr_b16 v[242:243], v3 offset:2560
    s_waitcnt lgkmcnt(0)
    v_mfma_f32_16x16x32_bf16 v[8:11], v[240:243], v[24:27], v[8:11]
    ds_read_b64_tr_b16 v[244:245], v3 offset:3072
    ds_read_b64_tr_b16 v[246:247], v3 offset:3584
    s_waitcnt lgkmcnt(0)
    v_mfma_f32_16x16x32_bf16 v[8:11], v[244:247], v[28:31], v[8:11]
    ds_read_b64_tr_b16 v[232:233], v3 offset:4096
    ds_read_b64_tr_b16 v[234:235], v3 offset:4608
    s_waitcnt lgkmcnt(0)
    v_mfma_f32_16x16x32_bf16 v[8:11], v[232:235], v[32:35], v[8:11]
    ds_read_b64_tr_b16 v[236:237], v3 offset:5120
    ds_read_b64_tr_b16 v[238:239], v3 offset:5632
    s_waitcnt lgkmcnt(0)
    v_mfma_f32_16x16x32_bf16 v[8:11], v[236:239], v[36:39], v[8:11]
    ds_read_b64_tr_b16 v[240:241], v3 offset:6144
    ds_read_b64_tr_b16 v[242:243], v3 offset:6656
    s_waitcnt lgkmcnt(0)
    v_mfma_f32_16x16x32_bf16 v[8:11], v[240:243], v[40:43], v[8:11]
    ds_read_b64_tr_b16 v[244:245], v3 offset:7168
    ds_read_b64_tr_b16 v[246:247], v3 offset:7680
    s_waitcnt lgkmcnt(0)
    v_mfma_f32_16x16x32_bf16 v[8:11], v[244:247], v[44:47], v[8:11]
    ds_read_b64_tr_b16 v[232:233], v3 offset:8192
    ds_read_b64_tr_b16 v[234:235], v3 offset:8704
    s_waitcnt lgkmcnt(0)
    v_mfma_f32_16x16x32_bf16 v[8:11], v[232:235], v[48:51], v[8:11]
    ds_read_b64_tr_b16 v[236:237], v3 offset:9216
    ds_read_b64_tr_b16 v[238:239], v3 offset:9728
    s_waitcnt lgkmcnt(0)
    v_mfma_f32_16x16x32_bf16 v[8:11], v[236:239], v[52:55], v[8:11]
    ds_read_b64_tr_b16 v[240:241], v3 offset:10240
    ds_read_b64_tr_b16 v[242:243], v3 offset:10752
    s_waitcnt lgkmcnt(0)
    v_mfma_f32_16x16x32_bf16 v[8:11], v[240:243], v[56:59], v[8:11]
    ds_read_b64_tr_b16 v[244:245], v3 offset:11264
    ds_read_b64_tr_b16 v[246:247], v3 offset:11776
    s_waitcnt lgkmcnt(0)
    v_mfma_f32_16x16x32_bf16 v[8:11], v[244:247], v[60:63], v[8:11]
    ds_read_b64_tr_b16 v[232:233], v3 offset:12288
    ds_read_b64_tr_b16 v[234:235], v3 offset:12800
    s_waitcnt lgkmcnt(0)
    v_mfma_f32_16x16x32_bf16 v[8:11], v[232:235], v[64:67], v[8:11]
    ds_read_b64_tr_b16 v[236:237], v3 offset:13312
    ds_read_b64_tr_b16 v[238:239], v3 offset:13824
    s_waitcnt lgkmcnt(0)
    v_mfma_f32_16x16x32_bf16 v[8:11], v[236:239], v[68:71], v[8:11]
    ds_read_b64_tr_b16 v[240:241], v3 offset:14336
    ds_read_b64_tr_b16 v[242:243], v3 offset:14848
    s_waitcnt lgkmcnt(0)
    v_mfma_f32_16x16x32_bf16 v[8:11], v[240:243], v[72:75], v[8:11]
    ds_read_b64_tr_b16 v[244:245], v3 offset:15360
    ds_read_b64_tr_b16 v[246:247], v3 offset:15872
    s_waitcnt lgkmcnt(0)
    v_mfma_f32_16x16x32_bf16 v[8:11], v[244:247], v[76:79], v[8:11]
    ds_read_b64_tr_b16 v[232:233], v3 offset:16384
    ds_read_b64_tr_b16 v[234:235], v3 offset:16896
    s_waitcnt lgkmcnt(0)
    v_mfma_f32_16x16x32_bf16 v[8:11], v[232:235], v[80:83], v[8:11]
    ds_read_b64_tr_b16 v[236:237], v3 offset:17408
    ds_read_b64_tr_b16 v[238:239], v3 offset:17920
    s_waitcnt lgkmcnt(0)
    v_mfma_f32_16x16x32_bf16 v[8:11], v[236:239], v[84:87], v[8:11]
    ds_read_b64_tr_b16 v[240:241], v3 offset:18432
    ds_read_b64_tr_b16 v[242:243], v3 offset:18944
    s_waitcnt lgkmcnt(0)
    v_mfma_f32_16x16x32_bf16 v[8:11], v[240:243], v[88:91], v[8:11]
    ds_read_b64_tr_b16 v[244:245], v3 offset:19456
    ds_read_b64_tr_b16 v[246:247], v3 offset:19968
    s_waitcnt lgkmcnt(0)
    v_mfma_f32_16x16x32_bf16 v[8:11], v[244:247], v[92:95], v[8:11]
    ds_read_b64_tr_b16 v[232:233], v3 offset:20480
    ds_read_b64_tr_b16 v[234:235], v3 offset:20992
    s_waitcnt lgkmcnt(0)
    v_mfma_f32_16x16x32_bf16 v[8:11], v[232:235], v[96:99], v[8:11]
    ds_read_b64_tr_b16 v[236:237], v3 offset:21504
    ds_read_b64_tr_b16 v[238:239], v3 offset:22016
    s_waitcnt lgkmcnt(0)
    v_mfma_f32_16x16x32_bf16 v[8:11], v[236:239], v[100:103], v[8:11]
    ds_read_b64_tr_b16 v[240:241], v3 offset:22528
    ds_read_b64_tr_b16 v[242:243], v3 offset:23040
    s_waitcnt lgkmcnt(0)
    v_mfma_f32_16x16x32_bf16 v[8:11], v[240:243], v[104:107], v[8:11]
    ds_read_b64_tr_b16 v[244:245], v3 offset:23552
    ds_read_b64_tr_b16 v[246:247], v3 offset:24064
    s_waitcnt lgkmcnt(0)
    v_mfma_f32_16x16x32_bf16 v[8:11], v[244:247], v[108:111], v[8:11]
    ds_read_b64_tr_b16 v[232:233], v3 offset:24576
    ds_read_b64_tr_b16 v[234:235], v3 offset:25088
    s_waitcnt lgkmcnt(0)
    v_mfma_f32_16x16x32_bf16 v[8:11], v[232:235], v[112:115], v[8:11]
    ds_read_b64_tr_b16 v[236:237], v3 offset:25600
    ds_read_b64_tr_b16 v[238:239], v3 offset:26112
    s_waitcnt lgkmcnt(0)
    v_mfma_f32_16x16x32_bf16 v[8:11], v[236:239], v[116:119], v[8:11]
    ds_read_b64_tr_b16 v[240:241], v3 offset:26624
    ds_read_b64_tr_b16 v[242:243], v3 offset:27136
    s_waitcnt lgkmcnt(0)
    v_mfma_f32_16x16x32_bf16 v[8:11], v[240:243], v[120:123], v[8:11]
    ds_read_b64_tr_b16 v[244:245], v3 offset:27648
    ds_read_b64_tr_b16 v[246:247], v3 offset:28160
    s_waitcnt lgkmcnt(0)
    v_mfma_f32_16x16x32_bf16 v[8:11], v[244:247], v[124:127], v[8:11]
    ds_read_b64_tr_b16 v[232:233], v3 offset:28672
    ds_read_b64_tr_b16 v[234:235], v3 offset:29184
    s_waitcnt lgkmcnt(0)
    v_mfma_f32_16x16x32_bf16 v[8:11], v[232:235], v[128:131], v[8:11]
    ds_read_b64_tr_b16 v[236:237], v3 offset:29696
    ds_read_b64_tr_b16 v[238:239], v3 offset:30208
    s_waitcnt lgkmcnt(0)
    v_mfma_f32_16x16x32_bf16 v[8:11], v[236:239], v[132:135], v[8:11]
    ds_read_b64_tr_b16 v[240:241], v3 offset:30720
    ds_read_b64_tr_b16 v[242:243], v3 offset:31232
    s_waitcnt lgkmcnt(0)
    v_mfma_f32_16x16x32_bf16 v[8:11], v[240:243], v[136:139], v[8:11]
    ds_read_b64_tr_b16 v[244:245], v3 offset:31744
    ds_read_b64_tr_b16 v[246:247], v3 offset:32256
    s_waitcnt lgkmcnt(0)
    v_mfma_f32_16x16x32_bf16 v[8:11], v[244:247], v[140:143], v[8:11]
    ds_read_b64_tr_b16 v[232:233], v3 offset:32768
    ds_read_b64_tr_b16 v[234:235], v3 offset:33280
    s_waitcnt lgkmcnt(0)
    v_mfma_f32_16x16x32_bf16 v[8:11], v[232:235], v[144:147], v[8:11]
    ds_read_b64_tr_b16 v[236:237], v3 offset:33792
    ds_read_b64_tr_b16 v[238:239], v3 offset:34304
    s_waitcnt lgkmcnt(0)
    v_mfma_f32_16x16x32_bf16 v[8:11], v[236:239], v[148:151], v[8:11]
    ds_read_b64_tr_b16 v[240:241], v3 offset:34816
    ds_read_b64_tr_b16 v[242:243], v3 offset:35328
    s_waitcnt lgkmcnt(0)
    v_mfma_f32_16x16x32_bf16 v[8:11], v[240:243], v[152:155], v[8:11]
    ds_read_b64_tr_b16 v[244:245], v3 offset:35840
    ds_read_b64_tr_b16 v[246:247], v3 offset:36352
    s_waitcnt lgkmcnt(0)
    v_mfma_f32_16x16x32_bf16 v[8:11], v[244:247], v[156:159], v[8:11]
    ds_read_b64_tr_b16 v[232:233], v3 offset:36864
    ds_read_b64_tr_b16 v[234:235], v3 offset:37376
    s_waitcnt lgkmcnt(0)
    v_mfma_f32_16x16x32_bf16 v[8:11], v[232:235], v[160:163], v[8:11]
    ds_read_b64_tr_b16 v[236:237], v3 offset:37888
    ds_read_b64_tr_b16 v[238:239], v3 offset:38400
    s_waitcnt lgkmcnt(0)
    v_mfma_f32_16x16x32_bf16 v[8:11], v[236:239], v[164:167], v[8:11]
    ds_read_b64_tr_b16 v[240:241], v3 offset:38912
    ds_read_b64_tr_b16 v[242:243], v3 offset:39424
    s_waitcnt lgkmcnt(0)
    v_mfma_f32_16x16x32_bf16 v[8:11], v[240:243], v[168:171], v[8:11]
    ds_read_b64_tr_b16 v[244:245], v3 offset:39936
    ds_read_b64_tr_b16 v[246:247], v3 offset:40448
    s_waitcnt lgkmcnt(0)
    v_mfma_f32_16x16x32_bf16 v[8:11], v[244:247], v[172:175], v[8:11]
    ds_read_b64_tr_b16 v[232:233], v3 offset:40960
    ds_read_b64_tr_b16 v[234:235], v3 offset:41472
    s_waitcnt lgkmcnt(0)
    v_mfma_f32_16x16x32_bf16 v[8:11], v[232:235], v[176:179], v[8:11]
    ds_read_b64_tr_b16 v[236:237], v3 offset:41984
    ds_read_b64_tr_b16 v[238:239], v3 offset:42496
    s_waitcnt lgkmcnt(0)
    v_mfma_f32_16x16x32_bf16 v[8:11], v[236:239], v[180:183], v[8:11]
    ds_read_b64_tr_b16 v[240:241], v3 offset:43008
    ds_read_b64_tr_b16 v[242:243], v3 offset:43520
    s_waitcnt lgkmcnt(0)
    v_mfma_f32_16x16x32_bf16 v[8:11], v[240:243], v[184:187], v[8:11]
    ds_read_b64_tr_b16 v[244:245], v3 offset:44032
    ds_read_b64_tr_b16 v[246:247], v3 offset:44544
    s_waitcnt lgkmcnt(0)
    v_mfma_f32_16x16x32_bf16 v[8:11], v[244:247], v[188:191], v[8:11]
    ds_read_b64_tr_b16 v[232:233], v3 offset:45056
    ds_read_b64_tr_b16 v[234:235], v3 offset:45568
    s_waitcnt lgkmcnt(0)
    v_mfma_f32_16x16x32_bf16 v[8:11], v[232:235], v[192:195], v[8:11]
    ds_read_b64_tr_b16 v[236:237], v3 offset:46080
    ds_read_b64_tr_b16 v[238:239], v3 offset:46592
    s_waitcnt lgkmcnt(0)
    v_mfma_f32_16x16x32_bf16 v[8:11], v[236:239], v[196:199], v[8:11]
    ds_read_b64_tr_b16 v[240:241], v3 offset:47104
    ds_read_b64_tr_b16 v[242:243], v3 offset:47616
    s_waitcnt lgkmcnt(0)
    v_mfma_f32_16x16x32_bf16 v[8:11], v[240:243], v[200:203], v[8:11]
    ds_read_b64_tr_b16 v[244:245], v3 offset:48128
    ds_read_b64_tr_b16 v[246:247], v3 offset:48640
    s_waitcnt lgkmcnt(0)
    v_mfma_f32_16x16x32_bf16 v[8:11], v[244:247], v[204:207], v[8:11]
    ds_read_b64_tr_b16 v[232:233], v3 offset:49152
    ds_read_b64_tr_b16 v[234:235], v3 offset:49664
    s_waitcnt lgkmcnt(0)
    v_mfma_f32_16x16x32_bf16 v[8:11], v[232:235], v[208:211], v[8:11]
    ds_read_b64_tr_b16 v[236:237], v3 offset:50176
    ds_read_b64_tr_b16 v[238:239], v3 offset:50688
    s_waitcnt lgkmcnt(0)
    v_mfma_f32_16x16x32_bf16 v[8:11], v[236:239], v[212:215], v[8:11]
    ds_read_b64_tr_b16 v[240:241], v3 offset:51200
    ds_read_b64_tr_b16 v[242:243], v3 offset:51712
    s_waitcnt lgkmcnt(0)
    v_mfma_f32_16x16x32_bf16 v[8:11], v[240:243], v[216:219], v[8:11]
    ds_read_b64_tr_b16 v[244:245], v3 offset:52224
    ds_read_b64_tr_b16 v[246:247], v3 offset:52736
    s_waitcnt lgkmcnt(0)
    v_mfma_f32_16x16x32_bf16 v[8:11], v[244:247], v[220:223], v[8:11]
    ds_read_b64_tr_b16 v[232:233], v3 offset:53248
    ds_read_b64_tr_b16 v[234:235], v3 offset:53760
    s_waitcnt lgkmcnt(0)
    v_mfma_f32_16x16x32_bf16 v[8:11], v[232:235], v[224:227], v[8:11]
    ds_read_b64_tr_b16 v[236:237], v3 offset:54272
    ds_read_b64_tr_b16 v[238:239], v3 offset:54784
    s_waitcnt lgkmcnt(0)
    v_mfma_f32_16x16x32_bf16 v[8:11], v[236:239], v[228:231], v[8:11]
    v_and_b32 v7, 7, v0
    v_lshlrev_b32 v7, 2, v7
    s_mov_b32 s64, 0x5400020
    buffer_load_dword v12, v7, s[4:7], s64 offen sc1
    s_waitcnt vmcnt(0)
    s_nop 7
    v_cvt_pk_bf16_f32 v8, v8, v8
    v_lshlrev_b32 v8, 16, v8
    v_mul_f32 v8, v8, v12
    v_cvt_pk_bf16_f32 v8, v8, v8
    v_lshlrev_b32 v8, 16, v8
    v_cvt_pk_bf16_f32 v9, v9, v9
    v_lshlrev_b32 v9, 16, v9
    v_mul_f32 v9, v9, v12
    v_cvt_pk_bf16_f32 v9, v9, v9
    v_lshlrev_b32 v9, 16, v9
    v_cvt_pk_bf16_f32 v10, v10, v10
    v_lshlrev_b32 v10, 16, v10
    v_mul_f32 v10, v10, v12
    v_cvt_pk_bf16_f32 v10, v10, v10
    v_lshlrev_b32 v10, 16, v10
    v_cvt_pk_bf16_f32 v11, v11, v11
    v_lshlrev_b32 v11, 16, v11
    v_mul_f32 v11, v11, v12
    v_cvt_pk_bf16_f32 v11, v11, v11
    v_lshlrev_b32 v11, 16, v11
    v_and_b32 v7, 7, v0
    v_mul_u32_u24 v7, 2560, v7
    v_lshrrev_b32 v13, 4, v0
    v_lshl_add_u32 v7, v13, 4, v7
    s_lshl_b32 s64, s24, 6
    s_add_u32 s64, s64, 0x5410000
    s_mov_b32 s68, 0x00ff00ff
    s_mov_b32 s69, 0x00ff00ff
    s_mov_b64 exec, s[68:69]
    buffer_store_dwordx4 v[8:11], v7, s[4:7], s64 offen sc1
    s_mov_b64 exec, -1
    s_waitcnt vmcnt(0)
    v_mov_b32 v7, 1
    v_mov_b32 v8, 0
    s_mov_b32 s64, 0x298100
    s_mov_b64 exec, 1
    buffer_atomic_add v7, v8, s[4:7], s64 offen sc1
    s_mov_b64 exec, -1
H_ATT:
    v_mbcnt_lo_u32_b32 v0, -1, 0
    v_mbcnt_hi_u32_b32 v0, -1, v0
    s_mov_b32 s29, 0
    v_lshlrev_b32 v1, 4, v0
    v_lshrrev_b32 v5, 4, v0
    v_lshlrev_b32 v2, 7, v5
    v_and_b32 v5, 7, v0
    v_lshl_add_u32 v2, v5, 4, v2
    v_bfe_u32 v5, v0, 4, 1
    v_lshlrev_b32 v3, 7, v5
    v_and_b32 v5, 15, v0
    v_lshl_add_u32 v3, v5, 3, v3
    s_mov_b32 s34, 0x3e0293ee
    s_mov_b32 s35, 0x3e0293ee
    s_mov_b32 s36, -1
    s_mov_b32 s37, 0
    v_lshrrev_b32 v5, 4, v0
    v_lshlrev_b32 v5, 2, v5
    v_and_b32 v6, 15, v0
    v_add_u32 v7, 0, v5
    v_cmp_le_u32 s[38:39], v7, v6
    v_add_u32 v7, 1, v5
    v_cmp_le_u32 s[40:41], v7, v6
    v_add_u32 v7, 2, v5
    v_cmp_le_u32 s[42:43], v7, v6
    v_add_u32 v7, 3, v5
    v_cmp_le_u32 s[44:45], v7, v6
    v_mov_b32 v248, 0x3f803f80
    v_mov_b32 v249, 0x3f803f80
    v_mov_b32 v250, 0x3f803f80
    v_mov_b32 v251, 0x3f803f80
    s_lshl_b32 s24, s12, 2
    s_add_u32 s24, s24, s14
    s_add_u32 s24, s24, 16
    s_mov_b32 s25, 2
AT2_LOOP:
    s_lshl_b32 s64, s24, 5
    s_add_u32 s64, s64, s13
    s_lshl_b32 s26, s64, 13
    s_add_u32 s26, s26, 0x3400000
    s_lshl_b32 s27, s64, 14
    s_add_u32 s27, s27, 0x1400000
    s_lshl_b32 s65, s64, 11
    s_add_u32 s30, s65, 0x640000
    s_add_u32 s31, s65, 0xa40000
    s_lshl_b32 s33, s64, 2
    s_add_u32 s33, s33, 0x296000
    s_lshl_b32 s32, s24, 18
    s_lshl_b32 s65, s13, 12
    s_add_u32 s32, s32, s65
    s_add_u32 s32, s32, 0x4400000
    s_lshr_b32 s65, s24, 2
    s_lshl_b32 s65, s65, 9
    s_lshl_b32 s66, s13, 4
    s_add_u32 s65, s65, s66
    s_add_u32 s65, s65, 0x291000
    s_lshr_b32 s66, s24, 1
    s_lshl_b32 s66, s66, 8
    s_lshl_b32 s64, s13, 3
    s_add_u32 s66, s66, s64
    s_add_u32 s66, s66, 0x293ff4
    v_lshlrev_b32 v5, 2, v0
    v_mov_b32 v6, s65
    v_mov_b32 v7, s66
    v_cmp_gt_u32 vcc, 3, v0
    s_nop 1
    v_cndmask_b32 v6, v7, v6, vcc
    v_add_u32 v4, v5, v6
    s_mov_b32 s64, 0
    s_mov_b64 exec, 7
AT2_F_170:
    buffer_load_dword v5, v4, s[4:7], s64 offen sc1
    s_add_u32 s29, s29, 1
    s_waitcnt vmcnt(0)
    v_cmp_eq_u32 vcc, 0, v5
    s_cbranch_vccz AT2_FD_171
    s_cmp_gt_u32 s29, 262144
    s_cbranch_scc1 AT2_FD_171
    s_sleep 1
    s_branch AT2_F_170
AT2_FD_171:
    s_mov_b64 exec, -1
    buffer_load_dwordx4 v[16:19], v1, s[4:7], s26 offen offset:0
    buffer_load_dwordx4 v[20:23], v1, s[4:7], s26 offen offset:1024
    buffer_load_dwordx4 v[24:27], v1, s[4:7], s26 offen offset:2048
    buffer_load_dwordx4 v[28:31], v1, s[4:7], s26 offen offset:3072
    s_add_u32 s26, s26, 4096
    buffer_load_dwordx4 v[32:35], v1, s[4:7], s26 offen offset:0
    buffer_load_dwordx4 v[36:39], v1, s[4:7], s26 offen offset:1024
    buffer_load_dwordx4 v[40:43], v1, s[4:7], s26 offen offset:2048
    buffer_load_dwordx4 v[44:47], v1, s[4:7], s26 offen offset:3072
    buffer_load_dwordx4 v[48:51], v1, s[4:7], s27 offen offset:0
    buffer_load_dwordx4 v[52:55], v1, s[4:7], s27 offen offset:1024
    buffer_load_dwordx4 v[56:59], v1, s[4:7], s27 offen offset:2048
    buffer_load_dwordx4 v[60:63], v1, s[4:7], s27 offen offset:3072
    s_add_u32 s27, s27, 4096
    buffer_load_dwordx4 v[64:67], v1, s[4:7], s27 offen offset:0
    buffer_load_dwordx4 v[68:71], v1, s[4:7], s27 offen offset:1024
    buffer_load_dwordx4 v[72:75], v1, s[4:7], s27 offen offset:2048
    buffer_load_dwordx4 v[76:79], v1, s[4:7], s27 offen offset:3072
    s_add_u32 s27, s27, 4096
    buffer_load_dwordx4 v[80:83], v1, s[4:7], s27 offen offset:0
    buffer_load_dwordx4 v[84:87], v1, s[4:7], s27 offen offset:1024
    buffer_load_dwordx4 v[88:91], v1, s[4:7], s27 offen offset:2048
    buffer_load_dwordx4 v[92:95], v1, s[4:7], s27 offen offset:3072
    s_add_u32 s27, s27, 4096
    buffer_load_dwordx4 v[96:99], v1, s[4:7], s27 offen offset:0
    buffer_load_dwordx4 v[100:103], v1, s[4:7], s27 offen offset:1024
    buffer_load_dwordx4 v[104:107], v1, s[4:7], s27 offen offset:2048
    buffer_load_dwordx4 v[108:111], v1, s[4:7], s27 offen offset:3072
    s_mov_b64 exec, 0x18
AT2_G_172:
    buffer_load_dword v5, v4, s[4:7], s64 offen sc1
    s_add_u32 s29, s29, 1
    s_waitcnt vmcnt(0)
    v_cmp_eq_u32 vcc, 0, v5
    s_cbranch_vccz AT2_GD_173
    s_cmp_gt_u32 s29, 262144
    s_cbranch_scc1 AT2_GD_173
    s_sleep 1
    s_branch AT2_G_172
AT2_GD_173:
    s_mov_b64 exec, -1
    buffer_load_dwordx4 v[112:115], v2, s[4:7], s30 offen offset:0
    buffer_load_dwordx4 v[116:119], v2, s[4:7], s30 offen offset:512
    buffer_load_dwordx4 v[120:123], v2, s[4:7], s30 offen offset:1024
    buffer_load_dwordx4 v[124:127], v2, s[4:7], s30 offen offset:1536
    buffer_load_dwordx2 v[128:129], v3, s[4:7], s31 offen offset:0
    buffer_load_dwordx2 v[130:131], v3, s[4:7], s31 offen offset:256
    buffer_load_dwordx2 v[132:133], v3, s[4:7], s31 offen offset:512
    buffer_load_dwordx2 v[134:135], v3, s[4:7], s31 offen offset:768
    buffer_load_dwordx2 v[136:137], v3, s[4:7], s31 offen offset:1024
    buffer_load_dwordx2 v[138:139], v3, s[4:7], s31 offen offset:1280
    buffer_load_dwordx2 v[140:141], v3, s[4:7], s31 offen offset:1536
    buffer_load_dwordx2 v[142:143], v3, s[4:7], s31 offen offset:1792
    v_mfma_f32_16x16x32_bf16 v[148:151], v[48:51], v[16:19], 0
    v_mfma_f32_16x16x32_bf16 v[156:159], v[48:51], v[32:35], 0
    v_mfma_f32_16x16x32_bf16 v[160:163], v[64:67], v[32:35], 0
    v_mfma_f32_16x16x32_bf16 v[148:151], v[52:55], v[20:23], v[148:151]
    v_mfma_f32_16x16x32_bf16 v[156:159], v[52:55], v[36:39], v[156:159]
    v_mfma_f32_16x16x32_bf16 v[160:163], v[68:71], v[36:39], v[160:163]
    v_mfma_f32_16x16x32_bf16 v[148:151], v[56:59], v[24:27], v[148:151]
    v_mfma_f32_16x16x32_bf16 v[156:159], v[56:59], v[40:43], v[156:159]
    v_mfma_f32_16x16x32_bf16 v[160:163], v[72:75], v[40:43], v[160:163]
    v_mfma_f32_16x16x32_bf16 v[148:151], v[60:63], v[28:31], v[148:151]
    v_mfma_f32_16x16x32_bf16 v[156:159], v[60:63], v[44:47], v[156:159]
    v_mfma_f32_16x16x32_bf16 v[160:163], v[76:79], v[44:47], v[160:163]
    s_waitcnt vmcnt(8)
    v_mfma_f32_16x16x32_bf16 v[144:147], v[112:115], v[16:19], 0
    v_mfma_f32_16x16x32_bf16 v[152:155], v[112:115], v[32:35], 0
    v_mfma_f32_16x16x32_bf16 v[144:147], v[116:119], v[20:23], v[144:147]
    v_mfma_f32_16x16x32_bf16 v[152:155], v[116:119], v[36:39], v[152:155]
    v_mfma_f32_16x16x32_bf16 v[144:147], v[120:123], v[24:27], v[144:147]
    v_mfma_f32_16x16x32_bf16 v[152:155], v[120:123], v[40:43], v[152:155]
    v_mfma_f32_16x16x32_bf16 v[144:147], v[124:127], v[28:31], v[144:147]
    v_mfma_f32_16x16x32_bf16 v[152:155], v[124:127], v[44:47], v[152:155]
    v_mov_b32 v11, 0xff800000
    s_nop 7
    v_cndmask_b32 v148, v11, v148, s[38:39]
    v_cndmask_b32 v160, v11, v160, s[38:39]
    v_cndmask_b32 v144, v11, v144, s[36:37]
    v_cndmask_b32 v152, v11, v152, s[36:37]
    v_cndmask_b32 v149, v11, v149, s[40:41]
    v_cndmask_b32 v161, v11, v161, s[40:41]
    v_cndmask_b32 v145, v11, v145, s[36:37]
    v_cndmask_b32 v153, v11, v153, s[36:37]
    v_cndmask_b32 v150, v11, v150, s[42:43]
    v_cndmask_b32 v162, v11, v162, s[42:43]
    v_cndmask_b32 v146, v11, v146, s[36:37]
    v_cndmask_b32 v154, v11, v154, s[36:37]
    v_cndmask_b32 v151, v11, v151, s[44:45]
    v_cndmask_b32 v163, v11, v163, s[44:45]
    v_cndmask_b32 v147, v11, v147, s[36:37]
    v_cndmask_b32 v155, v11, v155, s[36:37]
    v_max3_f32 v8, v144, v145, v146
    v_max3_f32 v8, v8, v147, v148
    v_max3_f32 v8, v8, v149, v150
    v_max_f32 v8, v8, v151
    v_mov_b32 v9, v8
    s_nop 1
    v_permlane16_swap_b32 v8, v9
    v_max_f32 v8, v8, v9
    v_mov_b32 v9, v8
    s_nop 1
    v_permlane32_swap_b32 v8, v9
    v_max_f32 v8, v8, v9
    v_mul_f32 v8, s34, v8
    v_fma_f32 v144, v144, s34, -v8
    v_fma_f32 v145, v145, s34, -v8
    v_fma_f32 v146, v146, s34, -v8
    v_fma_f32 v147, v147, s34, -v8
    v_fma_f32 v148, v148, s34, -v8
    v_fma_f32 v149, v149, s34, -v8
    v_fma_f32 v150, v150, s34, -v8
    v_fma_f32 v151, v151, s34, -v8
    v_exp_f32 v144, v144
    v_exp_f32 v145, v145
    v_exp_f32 v146, v146
    v_exp_f32 v147, v147
    v_exp_f32 v148, v148
    v_exp_f32 v149, v149
    v_exp_f32 v150, v150
    v_exp_f32 v151, v151
    s_nop 0
    v_cvt_pk_bf16_f32 v164, v148, v149
    v_cvt_pk_bf16_f32 v165, v150, v151
    v_mov_b32 v166, 0
    v_mov_b32 v167, 0
    v_cvt_pk_bf16_f32 v168, v144, v145
    v_cvt_pk_bf16_f32 v169, v146, v147
    v_max3_f32 v8, v152, v153, v154
    v_max3_f32 v8, v8, v155, v156
    v_max3_f32 v8, v8, v157, v158
    v_max3_f32 v8, v8, v159, v160
    v_max3_f32 v8, v8, v161, v162
    v_max_f32 v8, v8, v163
    v_mov_b32 v9, v8
    s_nop 1
    v_permlane16_swap_b32 v8, v9
    v_max_f32 v8, v8, v9
    v_mov_b32 v9, v8
    s_nop 1
    v_permlane32_swap_b32 v8, v9
    v_max_f32 v8, v8, v9
    v_mul_f32 v8, s34, v8
    v_fma_f32 v152, v152, s34, -v8
    v_fma_f32 v153, v153, s34, -v8
    v_fma_f32 v154, v154, s34, -v8
    v_fma_f32 v155, v155, s34, -v8
    v_fma_f32 v156, v156, s34, -v8
    v_fma_f32 v157, v157, s34, -v8
    v_fma_f32 v158, v158, s34, -v8
    v_fma_f32 v159, v159, s34, -v8
    v_fma_f32 v160, v160, s34, -v8
    v_fma_f32 v161, v161, s34, -v8
    v_fma_f32 v162, v162, s34, -v8
    v_fma_f32 v163, v163, s34, -v8
    v_exp_f32 v152, v152
    v_exp_f32 v153, v153
    v_exp_f32 v154, v154
    v_exp_f32 v155, v155
    v_exp_f32 v156, v156
    v_exp_f32 v157, v157
    v_exp_f32 v158, v158
    v_exp_f32 v159, v159
    v_exp_f32 v160, v160
    v_exp_f32 v161, v161
    v_exp_f32 v162, v162
    v_exp_f32 v163, v163
    s_nop 0
    v_cvt_pk_bf16_f32 v170, v156, v157
    v_cvt_pk_bf16_f32 v171, v158, v159
    v_cvt_pk_bf16_f32 v172, v160, v161
    v_cvt_pk_bf16_f32 v173, v162, v163
    v_cvt_pk_bf16_f32 v174, v152, v153
    v_cvt_pk_bf16_f32 v175, v154, v155
    s_waitcnt vmcnt(0)
    v_mfma_f32_16x16x32_bf16 v[240:243], v[248:251], v[164:167], 0
    v_mfma_f32_16x16x32_bf16 v[244:247], v[248:251], v[170:173], 0
    v_mfma_f32_16x16x32_bf16 v[176:179], v[80:83], v[164:167], 0
    v_mfma_f32_16x16x32_bf16 v[180:183], v[80:83], v[170:173], 0
    v_mfma_f32_16x16x32_bf16 v[184:187], v[84:87], v[164:167], 0
    v_mfma_f32_16x16x32_bf16 v[188:191], v[84:87], v[170:173], 0
    v_mfma_f32_16x16x32_bf16 v[192:195], v[88:91], v[164:167], 0
    v_mfma_f32_16x16x32_bf16 v[196:199], v[88:91], v[170:173], 0
    v_mfma_f32_16x16x32_bf16 v[200:203], v[92:95], v[164:167], 0
    v_mfma_f32_16x16x32_bf16 v[204:207], v[92:95], v[170:173], 0
    v_mfma_f32_16x16x32_bf16 v[208:211], v[96:99], v[164:167], 0
    v_mfma_f32_16x16x32_bf16 v[212:215], v[96:99], v[170:173], 0
    v_mfma_f32_16x16x32_bf16 v[216:219], v[100:103], v[164:167], 0
    v_mfma_f32_16x16x32_bf16 v[220:223], v[100:103], v[170:173], 0
    v_mfma_f32_16x16x32_bf16 v[224:227], v[104:107], v[164:167], 0
    v_mfma_f32_16x16x32_bf16 v[228:231], v[104:107], v[170:173], 0
    v_mfma_f32_16x16x32_bf16 v[232:235], v[108:111], v[164:167], 0
    v_mfma_f32_16x16x32_bf16 v[236:239], v[108:111], v[170:173], 0
    v_mfma_f32_16x16x16_bf16 v[240:243], v[248:249], v[168:169], v[240:243]
    v_mfma_f32_16x16x16_bf16 v[244:247], v[248:249], v[174:175], v[244:247]
    v_mfma_f32_16x16x16_bf16 v[176:179], v[128:129], v[168:169], v[176:179]
    v_mfma_f32_16x16x16_bf16 v[180:183], v[128:129], v[174:175], v[180:183]
    v_mfma_f32_16x16x16_bf16 v[184:187], v[130:131], v[168:169], v[184:187]
    v_mfma_f32_16x16x16_bf16 v[188:191], v[130:131], v[174:175], v[188:191]
    v_mfma_f32_16x16x16_bf16 v[192:195], v[132:133], v[168:169], v[192:195]
    v_mfma_f32_16x16x16_bf16 v[196:199], v[132:133], v[174:175], v[196:199]
    v_mfma_f32_16x16x16_bf16 v[200:203], v[134:135], v[168:169], v[200:203]
    v_mfma_f32_16x16x16_bf16 v[204:207], v[134:135], v[174:175], v[204:207]
    v_mfma_f32_16x16x16_bf16 v[208:211], v[136:137], v[168:169], v[208:211]
    v_mfma_f32_16x16x16_bf16 v[212:215], v[136:137], v[174:175], v[212:215]
    v_mfma_f32_16x16x16_bf16 v[216:219], v[138:139], v[168:169], v[216:219]
    v_mfma_f32_16x16x16_bf16 v[220:223], v[138:139], v[174:175], v[220:223]
    v_mfma_f32_16x16x16_bf16 v[224:227], v[140:141], v[168:169], v[224:227]
    v_mfma_f32_16x16x16_bf16 v[228:231], v[140:141], v[174:175], v[228:231]
    v_mfma_f32_16x16x16_bf16 v[232:235], v[142:143], v[168:169], v[232:235]
    v_mfma_f32_16x16x16_bf16 v[236:239], v[142:143], v[174:175], v[236:239]
    v_rcp_f32 v8, v240
    v_rcp_f32 v9, v244
    s_nop 7
    v_mul_f32 v176, v176, v8
    v_mul_f32 v177, v177, v8
    v_mul_f32 v178, v178, v8
    v_mul_f32 v179, v179, v8
    v_cvt_pk_bf16_f32 v16, v176, v177
    v_cvt_pk_bf16_f32 v17, v178, v179
    v_mul_f32 v184, v184, v8
    v_mul_f32 v185, v185, v8
    v_mul_f32 v186, v186, v8
    v_mul_f32 v187, v187, v8
    v_cvt_pk_bf16_f32 v18, v184, v185
    v_cvt_pk_bf16_f32 v19, v186, v187
    s_add_u32 s64, s32, 0x0
    buffer_store_dwordx4 v[16:19], v1, s[4:7], s64 offen offset:0 sc1
    v_mul_f32 v192, v192, v8
    v_mul_f32 v193, v193, v8
    v_mul_f32 v194, v194, v8
    v_mul_f32 v195, v195, v8
    v_cvt_pk_bf16_f32 v20, v192, v193
    v_cvt_pk_bf16_f32 v21, v194, v195
    v_mul_f32 v200, v200, v8
    v_mul_f32 v201, v201, v8
    v_mul_f32 v202, v202, v8
    v_mul_f32 v203, v203, v8
    v_cvt_pk_bf16_f32 v22, v200, v201
    v_cvt_pk_bf16_f32 v23, v202, v203
    s_add_u32 s64, s32, 0x0
    buffer_store_dwordx4 v[20:23], v1, s[4:7], s64 offen offset:1024 sc1
    v_mul_f32 v208, v208, v8
    v_mul_f32 v209, v209, v8
    v_mul_f32 v210, v210, v8
    v_mul_f32 v211, v211, v8
    v_cvt_pk_bf16_f32 v24, v208, v209
    v_cvt_pk_bf16_f32 v25, v210, v211
    v_mul_f32 v216, v216, v8
    v_mul_f32 v217, v217, v8
    v_mul_f32 v218, v218, v8
    v_mul_f32 v219, v219, v8
    v_cvt_pk_bf16_f32 v26, v216, v217
    v_cvt_pk_bf16_f32 v27, v218, v219
    s_add_u32 s64, s32, 0x0
    buffer_store_dwordx4 v[24:27], v1, s[4:7], s64 offen offset:2048 sc1
    v_mul_f32 v224, v224, v8
    v_mul_f32 v225, v225, v8
    v_mul_f32 v226, v226, v8
    v_mul_f32 v227, v227, v8
    v_cvt_pk_bf16_f32 v28, v224, v225
    v_cvt_pk_bf16_f32 v29, v226, v227
    v_mul_f32 v232, v232, v8
    v_mul_f32 v233, v233, v8
    v_mul_f32 v234, v234, v8
    v_mul_f32 v235, v235, v8
    v_cvt_pk_bf16_f32 v30, v232, v233
    v_cvt_pk_bf16_f32 v31, v234, v235
    s_add_u32 s64, s32, 0x0
    buffer_store_dwordx4 v[28:31], v1, s[4:7], s64 offen offset:3072 sc1
    v_mul_f32 v180, v180, v9
    v_mul_f32 v181, v181, v9
    v_mul_f32 v182, v182, v9
    v_mul_f32 v183, v183, v9
    v_cvt_pk_bf16_f32 v32, v180, v181
    v_cvt_pk_bf16_f32 v33, v182, v183
    v_mul_f32 v188, v188, v9
    v_mul_f32 v189, v189, v9
    v_mul_f32 v190, v190, v9
    v_mul_f32 v191, v191, v9
    v_cvt_pk_bf16_f32 v34, v188, v189
    v_cvt_pk_bf16_f32 v35, v190, v191
    s_add_u32 s64, s32, 0x20000
    buffer_store_dwordx4 v[32:35], v1, s[4:7], s64 offen offset:0 sc1
    v_mul_f32 v196, v196, v9
    v_mul_f32 v197, v197, v9
    v_mul_f32 v198, v198, v9
    v_mul_f32 v199, v199, v9
    v_cvt_pk_bf16_f32 v36, v196, v197
    v_cvt_pk_bf16_f32 v37, v198, v199
    v_mul_f32 v204, v204, v9
    v_mul_f32 v205, v205, v9
    v_mul_f32 v206, v206, v9
    v_mul_f32 v207, v207, v9
    v_cvt_pk_bf16_f32 v38, v204, v205
    v_cvt_pk_bf16_f32 v39, v206, v207
    s_add_u32 s64, s32, 0x20000
    buffer_store_dwordx4 v[36:39], v1, s[4:7], s64 offen offset:1024 sc1
    v_mul_f32 v212, v212, v9
    v_mul_f32 v213, v213, v9
    v_mul_f32 v214, v214, v9
    v_mul_f32 v215, v215, v9
    v_cvt_pk_bf16_f32 v40, v212, v213
    v_cvt_pk_bf16_f32 v41, v214, v215
    v_mul_f32 v220, v220, v9
    v_mul_f32 v221, v221, v9
    v_mul_f32 v222, v222, v9
    v_mul_f32 v223, v223, v9
    v_cvt_pk_bf16_f32 v42, v220, v221
    v_cvt_pk_bf16_f32 v43, v222, v223
    s_add_u32 s64, s32, 0x20000
    buffer_store_dwordx4 v[40:43], v1, s[4:7], s64 offen offset:2048 sc1
    v_mul_f32 v228, v228, v9
    v_mul_f32 v229, v229, v9
    v_mul_f32 v230, v230, v9
    v_mul_f32 v231, v231, v9
    v_cvt_pk_bf16_f32 v44, v228, v229
    v_cvt_pk_bf16_f32 v45, v230, v231
    v_mul_f32 v236, v236, v9
    v_mul_f32 v237, v237, v9
    v_mul_f32 v238, v238, v9
    v_mul_f32 v239, v239, v9
    v_cvt_pk_bf16_f32 v46, v236, v237
    v_cvt_pk_bf16_f32 v47, v238, v239
    s_add_u32 s64, s32, 0x20000
    buffer_store_dwordx4 v[44:47], v1, s[4:7], s64 offen offset:3072 sc1
    s_waitcnt vmcnt(0)
    v_mov_b32 v7, 1
    v_mov_b32 v8, 0
    s_mov_b64 exec, 1
    buffer_store_dword v7, v8, s[4:7], s33 offen sc1
    s_mov_b64 exec, -1
    s_add_u32 s24, s24, 8
    s_add_u32 s25, s25, 1
    s_cmp_lt_u32 s25, 8
    s_cbranch_scc1 AT2_LOOP
M_EXIT:
    s_endpgm
.section .rodata,"a"
.p2align 6
.amdhsa_kernel main_kernel
  .amdhsa_next_free_vgpr 512
  .amdhsa_next_free_sgpr 102
  .amdhsa_accum_offset 256
  .amdhsa_group_segment_fixed_size 0
  .amdhsa_kernarg_size 120
  .amdhsa_user_sgpr_count 2
  .amdhsa_user_sgpr_kernarg_segment_ptr 1
  .amdhsa_system_sgpr_workgroup_id_x 1
.end_amdhsa_kernel
```

```asm
; @launch kernel=main_kernel grid=(256,1,1) block=(256,1,1) lds=163840
.amdgcn_target "amdgcn-amd-amdhsa--gfx950"
.text
.globl main_kernel
.p2align 8
.type main_kernel,@function
main_kernel:
    s_cmp_ge_u32 s2, 256
    s_cbranch_scc1 M_EXIT
    s_load_dwordx2 s[4:5], s[0:1], 112
    s_mov_b32 s6, 0x10000000
    s_mov_b32 s7, 0x00020000
    s_load_dwordx2 s[60:61], s[0:1], 104
    s_mov_b32 s62, 256
    s_mov_b32 s63, 0x00020000
    s_load_dwordx2 s[44:45], s[0:1], 16
    s_mov_b32 s46, 0x500000
    s_mov_b32 s47, 0x00020000
    s_load_dwordx2 s[48:49], s[0:1], 24
    s_mov_b32 s50, 0x500000
    s_mov_b32 s51, 0x00020000
    s_load_dwordx2 s[52:53], s[0:1], 32
    s_mov_b32 s54, 0x500000
    s_mov_b32 s55, 0x00020000
    s_load_dwordx2 s[56:57], s[0:1], 40
    s_mov_b32 s58, 0x500000
    s_mov_b32 s59, 0x00020000
    v_lshrrev_b32 v1, 6, v0
    v_and_b32 v0, 63, v0
    s_nop 0
    v_readfirstlane_b32 s14, v1
    s_getreg_b32 s98, hwreg(HW_REG_XCC_ID)
    s_and_b32 s98, s98, 7
    s_mov_b32 s97, 0
    s_mov_b32 s95, 4
    s_waitcnt lgkmcnt(0)
    s_cmp_lg_u32 s14, 0
    s_cbranch_scc1 NOMEAS_1
    s_and_b32 s64, s2, 0xfffffffd
    s_cmp_lg_u32 s64, 1
    s_cbranch_scc1 NOMEAS_1
    s_lshr_b32 s70, s2, 1
    s_mov_b32 s72, s60
    s_mov_b32 s73, s61
    s_mov_b32 s74, s62
    s_mov_b32 s75, s63
    s_lshl_b32 s60, s70, 21
    s_add_u32 s60, s60, 0x6001800
    v_mov_b32 v60, 0
    v_mov_b32 v61, -1
    s_mov_b32 s66, 0x7fffffff
    s_mov_b32 s67, 0x7fffffff
    s_mov_b32 s68, 0x7fffffff
    s_mov_b32 s69, 0x7fffffff
    s_mov_b64 exec, 1
    s_add_u32 s61, s60, 0
    s_memtime s[62:63]
    s_waitcnt lgkmcnt(0)
    buffer_store_dword v61, v60, s[4:7], s61 offen offset:0 sc1
    s_waitcnt vmcnt(0)
    s_memtime s[64:65]
    s_waitcnt lgkmcnt(0)
    s_sub_u32 s62, s64, s62
    s_min_u32 s66, s66, s62
    s_add_u32 s61, s60, 8192
    s_memtime s[62:63]
    s_waitcnt lgkmcnt(0)
    buffer_store_dword v61, v60, s[4:7], s61 offen offset:0 sc1
    s_waitcnt vmcnt(0)
    s_memtime s[64:65]
    s_waitcnt lgkmcnt(0)
    s_sub_u32 s62, s64, s62
    s_min_u32 s67, s67, s62
    s_add_u32 s61, s60, 16384
    s_memtime s[62:63]
    s_waitcnt lgkmcnt(0)
    buffer_store_dword v61, v60, s[4:7], s61 offen offset:0 sc1
    s_waitcnt vmcnt(0)
    s_memtime s[64:65]
    s_waitcnt lgkmcnt(0)
    s_sub_u32 s62, s64, s62
    s_min_u32 s68, s68, s62
    s_add_u32 s61, s60, 24576
    s_memtime s[62:63]
    s_waitcnt lgkmcnt(0)
    buffer_store_dword v61, v60, s[4:7], s61 offen offset:0 sc1
    s_waitcnt vmcnt(0)
    s_memtime s[64:65]
    s_waitcnt lgkmcnt(0)
    s_sub_u32 s62, s64, s62
    s_min_u32 s69, s69, s62
    s_add_u32 s61, s60, 0
    s_memtime s[62:63]
    s_waitcnt lgkmcnt(0)
    buffer_store_dword v61, v60, s[4:7], s61 offen offset:128 sc1
    s_waitcnt vmcnt(0)
    s_memtime s[64:65]
    s_waitcnt lgkmcnt(0)
    s_sub_u32 s62, s64, s62
    s_min_u32 s66, s66, s62
    s_add_u32 s61, s60, 8192
    s_memtime s[62:63]
    s_waitcnt lgkmcnt(0)
    buffer_store_dword v61, v60, s[4:7], s61 offen offset:128 sc1
    s_waitcnt vmcnt(0)
    s_memtime s[64:65]
    s_waitcnt lgkmcnt(0)
    s_sub_u32 s62, s64, s62
    s_min_u32 s67, s67, s62
    s_add_u32 s61, s60, 16384
    s_memtime s[62:63]
    s_waitcnt lgkmcnt(0)
    buffer_store_dword v61, v60, s[4:7], s61 offen offset:128 sc1
    s_waitcnt vmcnt(0)
    s_memtime s[64:65]
    s_waitcnt lgkmcnt(0)
    s_sub_u32 s62, s64, s62
    s_min_u32 s68, s68, s62
    s_add_u32 s61, s60, 24576
    s_memtime s[62:63]
    s_waitcnt lgkmcnt(0)
    buffer_store_dword v61, v60, s[4:7], s61 offen offset:128 sc1
    s_waitcnt vmcnt(0)
    s_memtime s[64:65]
    s_waitcnt lgkmcnt(0)
    s_sub_u32 s62, s64, s62
    s_min_u32 s69, s69, s62
    s_mov_b64 exec, -1
    s_mov_b32 s60, 0
    s_mov_b32 s61, s66
    s_cmp_lt_u32 s67, s61
    s_cselect_b32 s60, 1, s60
    s_min_u32 s61, s61, s67
    s_cmp_lt_u32 s68, s61
    s_cselect_b32 s60, 2, s60
    s_min_u32 s61, s61, s68
    s_cmp_lt_u32 s69, s61
    s_cselect_b32 s60, 3, s60
    s_min_u32 s61, s61, s69
    s_and_b32 s61, s98, 1
    s_lshl_b32 s61, s61, 1
    s_lshr_b32 s62, s98, 2
    s_add_u32 s61, s61, s62
    s_xor_b32 s60, s60, s61
    s_add_u32 s71, s60, 1
    s_mov_b32 s60, s72
    s_mov_b32 s61, s73
    s_mov_b32 s62, s74
    s_mov_b32 s63, s75
    s_lshl_b32 s70, s70, 2
    s_add_u32 s70, s70, 132
    v_mov_b32 v61, s71
    s_mov_b64 exec, 1
    buffer_store_dword v61, off, s[60:63], s70 sc1
    s_mov_b64 exec, -1
NOMEAS_1:
    s_cmp_lg_u32 s14, 0
    s_cbranch_scc1 M_TICKW
    s_mul_i32 s64, s98, 32
    s_add_u32 s64, s64, 0x0
    v_mov_b32 v1, 0
    v_mov_b32 v2, 1
    s_mov_b64 exec, 1
    buffer_atomic_add v2, v1, s[60:63], s64 offen sc0
    s_waitcnt vmcnt(0)
    ds_write_b32 v1, v2
    s_waitcnt lgkmcnt(0)
    s_mov_b64 exec, -1
M_TICKW:
    s_barrier
    v_mov_b32 v1, 0
    ds_read_b32 v2, v1
    s_waitcnt lgkmcnt(0)
    v_readfirstlane_b32 s99, v2
    s_barrier
    s_cmp_ge_u32 s99, 32
    s_cbranch_scc1 M_SLOW0
    s_mov_b32 s12, s98
    s_cmp_eq_u32 s12, 0
    s_cbranch_scc1 XOK_2
    s_cmp_eq_u32 s12, 2
    s_cbranch_scc0 M_FH
    s_mov_b32 s12, 1
XOK_2:
    s_mov_b32 s13, s99
    s_branch M_REC
M_FH:
    s_sub_u32 s96, s98, 1
    s_cmp_gt_u32 s98, 2
    s_cselect_b32 s64, 1, 0
    s_sub_u32 s96, s96, s64
    s_lshl_b32 s96, s96, 5
    s_add_u32 s96, s96, s99
    s_branch M_HELP
M_SLOW0:
    v_mbcnt_lo_u32_b32 v0, -1, 0
    v_mbcnt_hi_u32_b32 v0, -1, v0
    v_mul_u32_u24 v8, 32, v0
    s_mov_b32 s64, 0x0
    s_mov_b32 s65, 0
    s_mov_b64 exec, 0xff
TK_3:
    buffer_load_dword v9, v8, s[60:63], s64 offen sc1
    s_add_u32 s65, s65, 1
    s_waitcnt vmcnt(0)
    s_mov_b32 s66, 0
    v_readlane_b32 s67, v9, 0
    s_add_u32 s66, s66, s67
    v_readlane_b32 s67, v9, 1
    s_add_u32 s66, s66, s67
    v_readlane_b32 s67, v9, 2
    s_add_u32 s66, s66, s67
    v_readlane_b32 s67, v9, 3
    s_add_u32 s66, s66, s67
    v_readlane_b32 s67, v9, 4
    s_add_u32 s66, s66, s67
    v_readlane_b32 s67, v9, 5
    s_add_u32 s66, s66, s67
    v_readlane_b32 s67, v9, 6
    s_add_u32 s66, s66, s67
    v_readlane_b32 s67, v9, 7
    s_add_u32 s66, s66, s67
    s_cmp_ge_u32 s66, 256
    s_cbranch_scc1 TKD_4
    s_cmp_gt_u32 s65, 262144
    s_cbranch_scc0 TK_3
TKD_4:
    v_cmp_ne_u32 vcc, 32, v9
    s_mov_b64 exec, -1
M_SLOW:
    s_waitcnt vmcnt(0) lgkmcnt(0)
    s_barrier
    s_cmp_lg_u32 s14, 0
    s_cbranch_scc1 M_SLOWB
    v_mov_b32 v8, 1
    s_mov_b64 exec, 1
    buffer_atomic_add v8, off, s[60:63], 12 sc1
    s_mov_b64 exec, -1
M_SLOWB:
    s_mov_b32 s95, 12
    s_mov_b32 s65, 0
SB_5:
    buffer_load_dword v8, off, s[60:63], s95 sc1
    s_add_u32 s65, s65, 1
    s_waitcnt vmcnt(0)
    v_readfirstlane_b32 s64, v8
    s_cmp_ge_u32 s64, 256
    s_cbranch_scc1 SBD_6
    s_cmp_gt_u32 s65, 65536
    s_cbranch_scc1 SBD_6
    s_sleep 4
    s_branch SB_5
SBD_6:
    s_mov_b32 s95, 8
    s_mov_b32 s97, 1
    s_cmp_lt_u32 s2, 64
    s_cbranch_scc0 M_SH
    s_load_dwordx2 s[44:45], s[0:1], 16
    s_mov_b32 s46, 0x500000
    s_mov_b32 s47, 0x00020000
    s_load_dwordx2 s[48:49], s[0:1], 24
    s_mov_b32 s50, 0x500000
    s_mov_b32 s51, 0x00020000
    s_load_dwordx2 s[52:53], s[0:1], 32
    s_mov_b32 s54, 0x500000
    s_mov_b32 s55, 0x00020000
    s_load_dwordx2 s[56:57], s[0:1], 40
    s_mov_b32 s58, 0x500000
    s_mov_b32 s59, 0x00020000
    s_waitcnt lgkmcnt(0)
    s_lshr_b32 s12, s2, 5
    s_and_b32 s13, s2, 31
    s_branch M_REC
M_SH:
    s_sub_u32 s96, s2, 64
    s_branch M_HELP
M_REC:
    v_mbcnt_lo_u32_b32 v0, -1, 0
    v_mbcnt_hi_u32_b32 v0, -1, v0
    v_and_b32 v0, 63, v0
    s_mul_i32 s40, s14, 36864
    s_add_u32 s40, s40, 16384
    v_lshrrev_b32 v95, 4, v0
    v_lshlrev_b32 v8, 13, v95
    v_and_b32 v95, 1, v95
    v_lshlrev_b32 v95, 1, v95
    v_and_b32 v9, 15, v0
    v_xor_b32 v9, v9, v95
    v_xor_b32 v95, 0, v9
    v_lshl_add_u32 v76, v95, 4, v8
    v_xor_b32 v95, 4, v9
    v_lshl_add_u32 v77, v95, 4, v8
    v_xor_b32 v95, 8, v9
    v_lshl_add_u32 v78, v95, 4, v8
    v_xor_b32 v95, 12, v9
    v_lshl_add_u32 v79, v95, 4, v8
    s_lshl_b32 s64, s13, 8
    s_lshl_b32 s65, s14, 17
    s_add_u32 s64, s64, s65
    s_mul_i32 s65, s12, 2621440
    s_add_u32 s71, s64, s65
    s_sub_u32 s65, 2621440, s65
    s_add_u32 s72, s64, s65
    s_add_u32 m0, s40, 0
    s_add_u32 s64, s71, 0x0
    buffer_load_dwordx4 v76, s[44:47], s64 offen lds
    s_add_u32 m0, s40, 1024
    s_add_u32 s64, s71, 0x8000
    buffer_load_dwordx4 v77, s[44:47], s64 offen lds
    s_add_u32 m0, s40, 2048
    s_add_u32 s64, s71, 0x10000
    buffer_load_dwordx4 v78, s[44:47], s64 offen lds
    s_add_u32 m0, s40, 3072
    s_add_u32 s64, s71, 0x18000
    buffer_load_dwordx4 v79, s[44:47], s64 offen lds
    s_add_u32 m0, s40, 4096
    s_add_u32 s64, s71, 0x80000
    buffer_load_dwordx4 v76, s[44:47], s64 offen lds
    s_add_u32 m0, s40, 5120
    s_add_u32 s64, s71, 0x88000
    buffer_load_dwordx4 v77, s[44:47], s64 offen lds
    s_add_u32 m0, s40, 6144
    s_add_u32 s64, s71, 0x90000
    buffer_load_dwordx4 v78, s[44:47], s64 offen lds
    s_add_u32 m0, s40, 7168
    s_add_u32 s64, s71, 0x98000
    buffer_load_dwordx4 v79, s[44:47], s64 offen lds
    s_add_u32 m0, s40, 8192
    s_add_u32 s64, s71, 0x100000
    buffer_load_dwordx4 v76, s[44:47], s64 offen lds
    s_add_u32 m0, s40, 9216
    s_add_u32 s64, s71, 0x108000
    buffer_load_dwordx4 v77, s[44:47], s64 offen lds
    s_add_u32 m0, s40, 10240
    s_add_u32 s64, s71, 0x110000
    buffer_load_dwordx4 v78, s[44:47], s64 offen lds
    s_add_u32 m0, s40, 11264
    s_add_u32 s64, s71, 0x118000
    buffer_load_dwordx4 v79, s[44:47], s64 offen lds
    s_add_u32 m0, s40, 12288
    s_add_u32 s64, s71, 0x180000
    buffer_load_dwordx4 v76, s[44:47], s64 offen lds
    s_add_u32 m0, s40, 13312
    s_add_u32 s64, s71, 0x188000
    buffer_load_dwordx4 v77, s[44:47], s64 offen lds
    s_add_u32 m0, s40, 14336
    s_add_u32 s64, s71, 0x190000
    buffer_load_dwordx4 v78, s[44:47], s64 offen lds
    s_add_u32 m0, s40, 15360
    s_add_u32 s64, s71, 0x198000
    buffer_load_dwordx4 v79, s[44:47], s64 offen lds
    s_add_u32 m0, s40, 16384
    s_add_u32 s64, s71, 0x200000
    buffer_load_dwordx4 v76, s[44:47], s64 offen lds
    s_add_u32 m0, s40, 17408
    s_add_u32 s64, s71, 0x208000
    buffer_load_dwordx4 v77, s[44:47], s64 offen lds
    s_add_u32 m0, s40, 18432
    s_add_u32 s64, s71, 0x210000
    buffer_load_dwordx4 v78, s[44:47], s64 offen lds
    s_add_u32 m0, s40, 19456
    s_add_u32 s64, s71, 0x218000
    buffer_load_dwordx4 v79, s[44:47], s64 offen lds
    s_add_u32 m0, s40, 20480
    s_add_u32 s64, s72, 0x0
    buffer_load_dwordx4 v76, s[44:47], s64 offen lds
    s_add_u32 m0, s40, 21504
    s_add_u32 s64, s72, 0x8000
    buffer_load_dwordx4 v77, s[44:47], s64 offen lds
    s_add_u32 m0, s40, 22528
    s_add_u32 s64, s72, 0x10000
    buffer_load_dwordx4 v78, s[44:47], s64 offen lds
    s_add_u32 m0, s40, 23552
    s_add_u32 s64, s72, 0x18000
    buffer_load_dwordx4 v79, s[44:47], s64 offen lds
    s_add_u32 m0, s40, 24576
    s_add_u32 s64, s72, 0x80000
    buffer_load_dwordx4 v76, s[44:47], s64 offen lds
    s_add_u32 m0, s40, 25600
    s_add_u32 s64, s72, 0x88000
    buffer_load_dwordx4 v77, s[44:47], s64 offen lds
    s_add_u32 m0, s40, 26624
    s_add_u32 s64, s72, 0x90000
    buffer_load_dwordx4 v78, s[44:47], s64 offen lds
    s_add_u32 m0, s40, 27648
    s_add_u32 s64, s72, 0x98000
    buffer_load_dwordx4 v79, s[44:47], s64 offen lds
    s_add_u32 m0, s40, 28672
    s_add_u32 s64, s72, 0x100000
    buffer_load_dwordx4 v76, s[44:47], s64 offen lds
    s_add_u32 m0, s40, 29696
    s_add_u32 s64, s72, 0x108000
    buffer_load_dwordx4 v77, s[44:47], s64 offen lds
    s_add_u32 m0, s40, 30720
    s_add_u32 s64, s72, 0x110000
    buffer_load_dwordx4 v78, s[44:47], s64 offen lds
    s_add_u32 m0, s40, 31744
    s_add_u32 s64, s72, 0x118000
    buffer_load_dwordx4 v79, s[44:47], s64 offen lds
    v_lshrrev_b32 v95, 5, v0
    v_mul_u32_u24 v8, 36864, v95
    v_bfe_u32 v95, v0, 3, 1
    v_lshl_add_u32 v8, v95, 11, v8
    v_lshlrev_b32 v9, 3, v95
    v_bfe_u32 v95, v0, 4, 1
    v_lshl_add_u32 v8, v95, 10, v8
    v_lshl_add_u32 v9, v95, 2, v9
    v_bfe_u32 v95, v0, 2, 1
    v_lshl_add_u32 v8, v95, 8, v8
    v_lshl_add_u32 v9, v95, 1, v9
    v_and_b32 v95, 1, v0
    v_lshl_add_u32 v8, v95, 3, v8
    v_add_u32 v8, 16384, v8
    v_bfe_u32 v95, v0, 1, 1
    s_lshl_b32 s64, s14, 2
    v_add_u32 v10, s64, v95
    v_add_u32 v95, 0, v10
    v_xor_b32 v95, v95, v9
    v_lshl_add_u32 v72, v95, 4, v8
    v_add_u32 v73, 73728, v72
    v_add_u32 v95, 2, v10
    v_xor_b32 v95, v95, v9
    v_lshl_add_u32 v74, v95, 4, v8
    v_add_u32 v75, 73728, v74
    v_bfe_u32 v95, v0, 2, 1
    v_mov_b32 v8, v95
    v_bfe_u32 v95, v0, 3, 1
    v_lshl_add_u32 v8, v95, 2, v8
    v_bfe_u32 v95, v0, 4, 1
    v_lshl_add_u32 v8, v95, 1, v8
    v_bfe_u32 v95, v0, 5, 1
    v_lshl_add_u32 v8, v95, 3, v8
    v_mul_u32_u24 v8, 1280, v8
    v_and_b32 v95, 3, v0
    v_lshl_add_u32 v89, v95, 4, v8
    v_lshrrev_b32 v95, 1, v0
    v_mul_u32_u24 v8, 1280, v95
    v_and_b32 v95, 1, v0
    v_lshl_add_u32 v90, v95, 4, v8
    v_lshrrev_b32 v95, 5, v0
    v_lshlrev_b32 v93, 9, v95
    v_bfe_u32 v95, v0, 4, 1
    v_lshl_add_u32 v93, v95, 7, v93
    v_bfe_u32 v95, v0, 2, 1
    v_lshl_add_u32 v93, v95, 6, v93
    v_bfe_u32 v95, v0, 3, 1
    v_lshl_add_u32 v93, v95, 5, v93
    v_and_b32 v95, 3, v0
    v_lshl_add_u32 v93, v95, 3, v93
    v_add_u32 v93, s40, v93
    v_lshrrev_b32 v95, 4, v0
    v_lshlrev_b32 v94, 8, v95
    v_bfe_u32 v95, v0, 2, 2
    v_lshl_add_u32 v94, v95, 5, v94
    v_and_b32 v95, 3, v0
    v_lshl_add_u32 v94, v95, 3, v94
    v_add_u32 v94, s40, v94
    s_mul_i32 s39, s13, 163840
    s_mul_i32 s64, s12, 640
    s_add_u32 s39, s39, s64
    s_lshl_b32 s64, s14, 5
    s_add_u32 s41, s39, s64
    s_add_u32 s41, s41, 0x200
    s_lshl_b32 s64, s14, 6
    s_add_u32 s39, s39, s64
    v_and_b32 v0, 63, v0
    v_lshlrev_b32 v1, 4, v0
    s_mul_i32 s64, s14, 36864
    s_add_u32 s64, s64, 16384
    v_add_u32 v2, s64, v1
    v_bfe_u32 v8, v0, 4, 1
    v_mul_u32_u24 v8, 1152, v8
    v_lshrrev_b32 v9, 5, v0
    v_lshlrev_b32 v9, 4, v9
    v_and_b32 v10, 15, v0
    v_add_u32 v9, v9, v10
    s_lshl_b32 s64, s14, 5
    v_add_u32 v9, s64, v9
    v_lshl_add_u32 v8, v9, 3, v8
    v_add_u32 v3, 8192, v8
    v_and_b32 v8, 1, v0
    v_mul_u32_u24 v8, 1152, v8
    v_lshrrev_b32 v9, 4, v0
    v_lshlrev_b32 v9, 2, v9
    v_bfe_u32 v10, v0, 2, 2
    v_add_u32 v9, v9, v10
    v_lshl_add_u32 v8, v9, 3, v8
    v_add_u32 v4, 8192, v8
    v_and_b32 v8, 7, v0
    v_mul_u32_u24 v8, 288, v8
    v_bfe_u32 v9, v0, 3, 1
    v_lshl_add_u32 v8, v9, 5, v8
    v_lshrrev_b32 v9, 4, v0
    v_lshl_add_u32 v8, v9, 3, v8
    s_lshl_b32 s64, s14, 6
    s_add_u32 s64, s64, 12800
    v_add_u32 v5, s64, v8
    s_mov_b32 s32, 0x00ff00ff
    s_mov_b32 s33, 0x00ff00ff
    s_mov_b32 s34, -1
    s_mov_b32 s35, 0
    s_mov_b32 s36, 0x00010001
    s_mov_b32 s37, 0x00010001
    v_mov_b32 v8, 0xeeee
    v_mov_b32 v9, 0x4444
    v_cndmask_b32 v6, v8, v9, s[32:33]
    v_lshrrev_b32 v8, 5, v0
    v_lshlrev_b32 v8, 13, v8
    v_bfe_u32 v9, v0, 3, 1
    v_lshl_add_u32 v8, v9, 12, v8
    v_and_b32 v9, 7, v0
    v_lshl_add_u32 v8, v9, 4, v8
    v_bfe_u32 v9, v0, 4, 1
    v_lshl_add_u32 v7, v9, 3, v8
    s_mov_b32 s10, 0x3e0293ee
    s_mov_b32 s11, 0x3e0293ee
    s_cmp_eq_u32 s14, 0
    s_cselect_b32 s42, 1, 0
    s_cmp_ge_u32 s13, 24
    s_cselect_b32 s65, 1, 0
    s_cmp_eq_u32 s14, 1
    s_cselect_b32 s65, s65, 0
    s_or_b32 s42, s42, s65
    s_lshl_b32 s65, s65, 3
    s_add_u32 s64, s13, s65
    s_cmp_eq_u32 s64, 39
    s_cselect_b32 s22, s42, 0
    s_mul_i32 s24, s12, 163840
    s_add_u32 s24, s24, 0x300000
    s_lshl_b32 s67, s13, 7
    s_add_u32 s26, s24, s67
    s_lshl_b32 s67, s14, 14
    s_add_u32 s23, s26, s67
    s_add_u32 s25, s23, 0x10000
    s_lshl_b32 s67, s14, 13
    s_add_u32 s26, s26, s67
    s_add_u32 s26, s26, 0x20000
    s_lshl_b32 s67, s64, 12
    s_add_u32 s24, s24, s67
    s_lshl_b32 s64, s64, 7
    s_lshl_b32 s65, s12, 13
    s_add_u32 s17, s65, 0x5900000
    s_add_u32 s18, s17, s64
    s_lshl_b32 s65, s12, 21
    s_add_u32 s66, s65, 0x6000000
    s_add_u32 s21, s66, s64
    s_xor_b32 s65, s65, 0x200000
    s_add_u32 s20, s65, 0x5ff8000
    s_and_b32 s64, s13, 1
    s_cmp_eq_u32 s64, s12
    s_cselect_b32 s43, 1, 0
    s_mov_b32 s43, 0
    s_lshl_b32 s64, s13, 4
    s_add_u32 s69, s64, 0x291000
    s_lshl_b32 s64, s13, 2
    s_add_u32 s70, s64, 0x294000
    s_lshl_b32 s64, s13, 14
    s_lshl_b32 s73, s14, 11
    s_lshl_b32 s65, s14, 12
    s_add_u32 s65, s65, s64
    s_add_u32 s3, s65, 0x1500000
    s_add_u32 s64, s64, s73
    s_add_u32 s28, s64, 0x1400000
    s_add_u32 s29, s64, 0x1402000
    s_lshl_b32 s64, s13, 11
    s_add_u32 s30, s64, 0x640000
    s_lshl_b32 s64, s13, 12
    s_lshl_b32 s65, s14, 10
    s_add_u32 s64, s64, s65
    s_add_u32 s31, s64, 0xa40000
    s_waitcnt vmcnt(28)
    s_barrier
    s_add_u32 m0, s40, 32768
    s_add_u32 s64, s72, 0x180000
    buffer_load_dwordx4 v76, s[44:47], s64 offen lds
    s_add_u32 m0, s40, 33792
    s_add_u32 s64, s72, 0x188000
    buffer_load_dwordx4 v77, s[44:47], s64 offen lds
    s_add_u32 m0, s40, 34816
    s_add_u32 s64, s72, 0x190000
    buffer_load_dwordx4 v78, s[44:47], s64 offen lds
    s_add_u32 m0, s40, 35840
    s_add_u32 s64, s72, 0x198000
    buffer_load_dwordx4 v79, s[44:47], s64 offen lds
    ds_read_b64_tr_b16 v[96:97], v72 offset:0
    ds_read_b64_tr_b16 v[98:99], v72 offset:512
    ds_read_b64_tr_b16 v[100:101], v73 offset:0
    ds_read_b64_tr_b16 v[102:103], v73 offset:512
    ds_read_b64_tr_b16 v[104:105], v74 offset:0
    ds_read_b64_tr_b16 v[106:107], v74 offset:512
    ds_read_b64_tr_b16 v[108:109], v75 offset:0
    ds_read_b64_tr_b16 v[110:111], v75 offset:512
    s_waitcnt lgkmcnt(0)
    s_waitcnt vmcnt(28)
    s_barrier
    s_add_u32 m0, s40, 0
    s_add_u32 s64, s72, 0x200000
    buffer_load_dwordx4 v76, s[44:47], s64 offen lds
    s_add_u32 m0, s40, 1024
    s_add_u32 s64, s72, 0x208000
    buffer_load_dwordx4 v77, s[44:47], s64 offen lds
    s_add_u32 m0, s40, 2048
    s_add_u32 s64, s72, 0x210000
    buffer_load_dwordx4 v78, s[44:47], s64 offen lds
    s_add_u32 m0, s40, 3072
    s_add_u32 s64, s72, 0x218000
    buffer_load_dwordx4 v79, s[44:47], s64 offen lds
    ds_read_b64_tr_b16 v[112:113], v72 offset:4096
    ds_read_b64_tr_b16 v[114:115], v72 offset:4608
    ds_read_b64_tr_b16 v[116:117], v73 offset:4096
    ds_read_b64_tr_b16 v[118:119], v73 offset:4608
    ds_read_b64_tr_b16 v[120:121], v74 offset:4096
    ds_read_b64_tr_b16 v[122:123], v74 offset:4608
    ds_read_b64_tr_b16 v[124:125], v75 offset:4096
    ds_read_b64_tr_b16 v[126:127], v75 offset:4608
    s_waitcnt lgkmcnt(0)
    s_waitcnt vmcnt(28)
    s_barrier
    s_add_u32 m0, s40, 4096
    s_add_u32 s64, s72, 0x200000
    buffer_load_dwordx4 v76, s[48:51], s64 offen lds
    s_add_u32 m0, s40, 5120
    s_add_u32 s64, s72, 0x208000
    buffer_load_dwordx4 v77, s[48:51], s64 offen lds
    s_add_u32 m0, s40, 6144
    s_add_u32 s64, s72, 0x210000
    buffer_load_dwordx4 v78, s[48:51], s64 offen lds
    s_add_u32 m0, s40, 7168
    s_add_u32 s64, s72, 0x218000
    buffer_load_dwordx4 v79, s[48:51], s64 offen lds
    ds_read_b64_tr_b16 v[128:129], v72 offset:8192
    ds_read_b64_tr_b16 v[130:131], v72 offset:8704
    ds_read_b64_tr_b16 v[132:133], v73 offset:8192
    ds_read_b64_tr_b16 v[134:135], v73 offset:8704
    ds_read_b64_tr_b16 v[136:137], v74 offset:8192
    ds_read_b64_tr_b16 v[138:139], v74 offset:8704
    ds_read_b64_tr_b16 v[140:141], v75 offset:8192
    ds_read_b64_tr_b16 v[142:143], v75 offset:8704
    s_waitcnt lgkmcnt(0)
    s_waitcnt vmcnt(28)
    s_barrier
    s_add_u32 m0, s40, 8192
    s_add_u32 s64, s71, 0x0
    buffer_load_dwordx4 v76, s[52:55], s64 offen lds
    s_add_u32 m0, s40, 9216
    s_add_u32 s64, s71, 0x8000
    buffer_load_dwordx4 v77, s[52:55], s64 offen lds
    s_add_u32 m0, s40, 10240
    s_add_u32 s64, s71, 0x10000
    buffer_load_dwordx4 v78, s[52:55], s64 offen lds
    s_add_u32 m0, s40, 11264
    s_add_u32 s64, s71, 0x18000
    buffer_load_dwordx4 v79, s[52:55], s64 offen lds
    ds_read_b64_tr_b16 v[144:145], v72 offset:12288
    ds_read_b64_tr_b16 v[146:147], v72 offset:12800
    ds_read_b64_tr_b16 v[148:149], v73 offset:12288
    ds_read_b64_tr_b16 v[150:151], v73 offset:12800
    ds_read_b64_tr_b16 v[152:153], v74 offset:12288
    ds_read_b64_tr_b16 v[154:155], v74 offset:12800
    ds_read_b64_tr_b16 v[156:157], v75 offset:12288
    ds_read_b64_tr_b16 v[158:159], v75 offset:12800
    s_waitcnt lgkmcnt(0)
    s_waitcnt vmcnt(28)
    s_barrier
    s_add_u32 m0, s40, 12288
    s_add_u32 s64, s71, 0x80000
    buffer_load_dwordx4 v76, s[52:55], s64 offen lds
    s_add_u32 m0, s40, 13312
    s_add_u32 s64, s71, 0x88000
    buffer_load_dwordx4 v77, s[52:55], s64 offen lds
    s_add_u32 m0, s40, 14336
    s_add_u32 s64, s71, 0x90000
    buffer_load_dwordx4 v78, s[52:55], s64 offen lds
    s_add_u32 m0, s40, 15360
    s_add_u32 s64, s71, 0x98000
    buffer_load_dwordx4 v79, s[52:55], s64 offen lds
    ds_read_b64_tr_b16 v[160:161], v72 offset:16384
    ds_read_b64_tr_b16 v[162:163], v72 offset:16896
    ds_read_b64_tr_b16 v[164:165], v73 offset:16384
    ds_read_b64_tr_b16 v[166:167], v73 offset:16896
    ds_read_b64_tr_b16 v[168:169], v74 offset:16384
    ds_read_b64_tr_b16 v[170:171], v74 offset:16896
    ds_read_b64_tr_b16 v[172:173], v75 offset:16384
    ds_read_b64_tr_b16 v[174:175], v75 offset:16896
    s_waitcnt lgkmcnt(0)
    s_waitcnt vmcnt(28)
    s_barrier
    s_add_u32 m0, s40, 16384
    s_add_u32 s64, s71, 0x100000
    buffer_load_dwordx4 v76, s[52:55], s64 offen lds
    s_add_u32 m0, s40, 17408
    s_add_u32 s64, s71, 0x108000
    buffer_load_dwordx4 v77, s[52:55], s64 offen lds
    s_add_u32 m0, s40, 18432
    s_add_u32 s64, s71, 0x110000
    buffer_load_dwordx4 v78, s[52:55], s64 offen lds
    s_add_u32 m0, s40, 19456
    s_add_u32 s64, s71, 0x118000
    buffer_load_dwordx4 v79, s[52:55], s64 offen lds
    ds_read_b64_tr_b16 v[176:177], v72 offset:20480
    ds_read_b64_tr_b16 v[178:179], v72 offset:20992
    ds_read_b64_tr_b16 v[180:181], v73 offset:20480
    ds_read_b64_tr_b16 v[182:183], v73 offset:20992
    ds_read_b64_tr_b16 v[184:185], v74 offset:20480
    ds_read_b64_tr_b16 v[186:187], v74 offset:20992
    ds_read_b64_tr_b16 v[188:189], v75 offset:20480
    ds_read_b64_tr_b16 v[190:191], v75 offset:20992
    s_waitcnt lgkmcnt(0)
    s_waitcnt vmcnt(28)
    s_barrier
    s_add_u32 m0, s40, 20480
    s_add_u32 s64, s71, 0x180000
    buffer_load_dwordx4 v76, s[52:55], s64 offen lds
    s_add_u32 m0, s40, 21504
    s_add_u32 s64, s71, 0x188000
    buffer_load_dwordx4 v77, s[52:55], s64 offen lds
    s_add_u32 m0, s40, 22528
    s_add_u32 s64, s71, 0x190000
    buffer_load_dwordx4 v78, s[52:55], s64 offen lds
    s_add_u32 m0, s40, 23552
    s_add_u32 s64, s71, 0x198000
    buffer_load_dwordx4 v79, s[52:55], s64 offen lds
    ds_read_b64_tr_b16 v[192:193], v72 offset:24576
    ds_read_b64_tr_b16 v[194:195], v72 offset:25088
    ds_read_b64_tr_b16 v[196:197], v73 offset:24576
    ds_read_b64_tr_b16 v[198:199], v73 offset:25088
    ds_read_b64_tr_b16 v[200:201], v74 offset:24576
    ds_read_b64_tr_b16 v[202:203], v74 offset:25088
    ds_read_b64_tr_b16 v[204:205], v75 offset:24576
    ds_read_b64_tr_b16 v[206:207], v75 offset:25088
    s_waitcnt lgkmcnt(0)
    s_waitcnt vmcnt(28)
    s_barrier
    s_add_u32 m0, s40, 24576
    s_add_u32 s64, s71, 0x200000
    buffer_load_dwordx4 v76, s[52:55], s64 offen lds
    s_add_u32 m0, s40, 25600
    s_add_u32 s64, s71, 0x208000
    buffer_load_dwordx4 v77, s[52:55], s64 offen lds
    s_add_u32 m0, s40, 26624
    s_add_u32 s64, s71, 0x210000
    buffer_load_dwordx4 v78, s[52:55], s64 offen lds
    s_add_u32 m0, s40, 27648
    s_add_u32 s64, s71, 0x218000
    buffer_load_dwordx4 v79, s[52:55], s64 offen lds
    ds_read_b64_tr_b16 v[208:209], v72 offset:28672
    ds_read_b64_tr_b16 v[210:211], v72 offset:29184
    ds_read_b64_tr_b16 v[212:213], v73 offset:28672
    ds_read_b64_tr_b16 v[214:215], v73 offset:29184
    ds_read_b64_tr_b16 v[216:217], v74 offset:28672
    ds_read_b64_tr_b16 v[218:219], v74 offset:29184
    ds_read_b64_tr_b16 v[220:221], v75 offset:28672
    ds_read_b64_tr_b16 v[222:223], v75 offset:29184
    s_waitcnt lgkmcnt(0)
    s_waitcnt vmcnt(28)
    s_barrier
    s_add_u32 m0, s40, 28672
    s_add_u32 s64, s72, 0x0
    buffer_load_dwordx4 v76, s[52:55], s64 offen lds
    s_add_u32 m0, s40, 29696
    s_add_u32 s64, s72, 0x8000
    buffer_load_dwordx4 v77, s[52:55], s64 offen lds
    s_add_u32 m0, s40, 30720
    s_add_u32 s64, s72, 0x10000
    buffer_load_dwordx4 v78, s[52:55], s64 offen lds
    s_add_u32 m0, s40, 31744
    s_add_u32 s64, s72, 0x18000
    buffer_load_dwordx4 v79, s[52:55], s64 offen lds
    ds_read_b64_tr_b16 v[224:225], v72 offset:32768
    ds_read_b64_tr_b16 v[226:227], v72 offset:33280
    ds_read_b64_tr_b16 v[228:229], v73 offset:32768
    ds_read_b64_tr_b16 v[230:231], v73 offset:33280
    ds_read_b64_tr_b16 v[232:233], v74 offset:32768
    ds_read_b64_tr_b16 v[234:235], v74 offset:33280
    ds_read_b64_tr_b16 v[236:237], v75 offset:32768
    ds_read_b64_tr_b16 v[238:239], v75 offset:33280
    s_waitcnt lgkmcnt(0)
    s_waitcnt vmcnt(28)
    s_barrier
    s_add_u32 m0, s40, 32768
    s_add_u32 s64, s72, 0x80000
    buffer_load_dwordx4 v76, s[52:55], s64 offen lds
    s_add_u32 m0, s40, 33792
    s_add_u32 s64, s72, 0x88000
    buffer_load_dwordx4 v77, s[52:55], s64 offen lds
    s_add_u32 m0, s40, 34816
    s_add_u32 s64, s72, 0x90000
    buffer_load_dwordx4 v78, s[52:55], s64 offen lds
    s_add_u32 m0, s40, 35840
    s_add_u32 s64, s72, 0x98000
    buffer_load_dwordx4 v79, s[52:55], s64 offen lds
    ds_read_b64_tr_b16 v[240:241], v72 offset:0
    ds_read_b64_tr_b16 v[242:243], v72 offset:512
    ds_read_b64_tr_b16 v[244:245], v73 offset:0
    ds_read_b64_tr_b16 v[246:247], v73 offset:512
    ds_read_b64_tr_b16 v[248:249], v74 offset:0
    ds_read_b64_tr_b16 v[250:251], v74 offset:512
    ds_read_b64_tr_b16 v[252:253], v75 offset:0
    ds_read_b64_tr_b16 v[254:255], v75 offset:512
    s_waitcnt lgkmcnt(0)
    s_waitcnt vmcnt(28)
    s_barrier
    s_add_u32 m0, s40, 0
    s_add_u32 s64, s72, 0x100000
    buffer_load_dwordx4 v76, s[52:55], s64 offen lds
    s_add_u32 m0, s40, 1024
    s_add_u32 s64, s72, 0x108000
    buffer_load_dwordx4 v77, s[52:55], s64 offen lds
    s_add_u32 m0, s40, 2048
    s_add_u32 s64, s72, 0x110000
    buffer_load_dwordx4 v78, s[52:55], s64 offen lds
    s_add_u32 m0, s40, 3072
    s_add_u32 s64, s72, 0x118000
    buffer_load_dwordx4 v79, s[52:55], s64 offen lds
    ds_read_b64_tr_b16 a[240:241], v72 offset:4096
    ds_read_b64_tr_b16 a[242:243], v72 offset:4608
    ds_read_b64_tr_b16 a[244:245], v73 offset:4096
    ds_read_b64_tr_b16 a[246:247], v73 offset:4608
    ds_read_b64_tr_b16 a[248:249], v74 offset:4096
    ds_read_b64_tr_b16 a[250:251], v74 offset:4608
    ds_read_b64_tr_b16 a[252:253], v75 offset:4096
    ds_read_b64_tr_b16 a[254:255], v75 offset:4608
    s_waitcnt lgkmcnt(0)
    s_waitcnt vmcnt(28)
    s_barrier
    s_add_u32 m0, s40, 4096
    s_add_u32 s64, s72, 0x180000
    buffer_load_dwordx4 v76, s[52:55], s64 offen lds
    s_add_u32 m0, s40, 5120
    s_add_u32 s64, s72, 0x188000
    buffer_load_dwordx4 v77, s[52:55], s64 offen lds
    s_add_u32 m0, s40, 6144
    s_add_u32 s64, s72, 0x190000
    buffer_load_dwordx4 v78, s[52:55], s64 offen lds
    s_add_u32 m0, s40, 7168
    s_add_u32 s64, s72, 0x198000
    buffer_load_dwordx4 v79, s[52:55], s64 offen lds
    ds_read_b64_tr_b16 a[0:1], v72 offset:8192
    ds_read_b64_tr_b16 a[2:3], v72 offset:8704
    ds_read_b64_tr_b16 a[4:5], v73 offset:8192
    ds_read_b64_tr_b16 a[6:7], v73 offset:8704
    ds_read_b64_tr_b16 a[8:9], v74 offset:8192
    ds_read_b64_tr_b16 a[10:11], v74 offset:8704
    ds_read_b64_tr_b16 a[12:13], v75 offset:8192
    ds_read_b64_tr_b16 a[14:15], v75 offset:8704
    s_waitcnt lgkmcnt(0)
    s_waitcnt vmcnt(28)
    s_barrier
    s_add_u32 m0, s40, 8192
    s_add_u32 s64, s72, 0x200000
    buffer_load_dwordx4 v76, s[52:55], s64 offen lds
    s_add_u32 m0, s40, 9216
    s_add_u32 s64, s72, 0x208000
    buffer_load_dwordx4 v77, s[52:55], s64 offen lds
    s_add_u32 m0, s40, 10240
    s_add_u32 s64, s72, 0x210000
    buffer_load_dwordx4 v78, s[52:55], s64 offen lds
    s_add_u32 m0, s40, 11264
    s_add_u32 s64, s72, 0x218000
    buffer_load_dwordx4 v79, s[52:55], s64 offen lds
    ds_read_b64_tr_b16 a[16:17], v72 offset:12288
    ds_read_b64_tr_b16 a[18:19], v72 offset:12800
    ds_read_b64_tr_b16 a[20:21], v73 offset:12288
    ds_read_b64_tr_b16 a[22:23], v73 offset:12800
    ds_read_b64_tr_b16 a[24:25], v74 offset:12288
    ds_read_b64_tr_b16 a[26:27], v74 offset:12800
    ds_read_b64_tr_b16 a[28:29], v75 offset:12288
    ds_read_b64_tr_b16 a[30:31], v75 offset:12800
    s_waitcnt lgkmcnt(0)
    s_waitcnt vmcnt(28)
    s_barrier
    s_add_u32 m0, s40, 12288
    s_add_u32 s64, s39, 0x0
    buffer_load_dwordx4 v89, s[56:59], s64 offen lds
    s_add_u32 m0, s40, 13312
    s_add_u32 s64, s39, 0x5000
    buffer_load_dwordx4 v89, s[56:59], s64 offen lds
    s_add_u32 m0, s40, 14336
    s_add_u32 s64, s39, 0xa000
    buffer_load_dwordx4 v89, s[56:59], s64 offen lds
    s_add_u32 m0, s40, 15360
    s_add_u32 s64, s39, 0xf000
    buffer_load_dwordx4 v89, s[56:59], s64 offen lds
    ds_read_b64_tr_b16 a[32:33], v72 offset:16384
    ds_read_b64_tr_b16 a[34:35], v72 offset:16896
    ds_read_b64_tr_b16 a[36:37], v73 offset:16384
    ds_read_b64_tr_b16 a[38:39], v73 offset:16896
    ds_read_b64_tr_b16 a[40:41], v74 offset:16384
    ds_read_b64_tr_b16 a[42:43], v74 offset:16896
    ds_read_b64_tr_b16 a[44:45], v75 offset:16384
    ds_read_b64_tr_b16 a[46:47], v75 offset:16896
    s_waitcnt lgkmcnt(0)
    s_waitcnt vmcnt(28)
    s_barrier
    s_add_u32 m0, s40, 16384
    s_add_u32 s64, s39, 0x14000
    buffer_load_dwordx4 v89, s[56:59], s64 offen lds
    s_add_u32 m0, s40, 17408
    s_add_u32 s64, s39, 0x19000
    buffer_load_dwordx4 v89, s[56:59], s64 offen lds
    s_add_u32 m0, s40, 18432
    s_add_u32 s64, s39, 0x1e000
    buffer_load_dwordx4 v89, s[56:59], s64 offen lds
    s_add_u32 m0, s40, 19456
    s_add_u32 s64, s39, 0x23000
    buffer_load_dwordx4 v89, s[56:59], s64 offen lds
    ds_read_b64_tr_b16 a[48:49], v72 offset:20480
    ds_read_b64_tr_b16 a[50:51], v72 offset:20992
    ds_read_b64_tr_b16 a[52:53], v73 offset:20480
    ds_read_b64_tr_b16 a[54:55], v73 offset:20992
    ds_read_b64_tr_b16 a[56:57], v74 offset:20480
    ds_read_b64_tr_b16 a[58:59], v74 offset:20992
    ds_read_b64_tr_b16 a[60:61], v75 offset:20480
    ds_read_b64_tr_b16 a[62:63], v75 offset:20992
    s_waitcnt lgkmcnt(0)
    s_waitcnt vmcnt(28)
    s_barrier
    s_add_u32 m0, s40, 20480
    s_add_u32 s64, s39, 0x100
    buffer_load_dwordx4 v89, s[56:59], s64 offen lds
    s_add_u32 m0, s40, 21504
    s_add_u32 s64, s39, 0x5100
    buffer_load_dwordx4 v89, s[56:59], s64 offen lds
    s_add_u32 m0, s40, 22528
    s_add_u32 s64, s39, 0xa100
    buffer_load_dwordx4 v89, s[56:59], s64 offen lds
    s_add_u32 m0, s40, 23552
    s_add_u32 s64, s39, 0xf100
    buffer_load_dwordx4 v89, s[56:59], s64 offen lds
    ds_read_b64_tr_b16 a[64:65], v72 offset:24576
    ds_read_b64_tr_b16 a[66:67], v72 offset:25088
    ds_read_b64_tr_b16 a[68:69], v73 offset:24576
    ds_read_b64_tr_b16 a[70:71], v73 offset:25088
    ds_read_b64_tr_b16 a[72:73], v74 offset:24576
    ds_read_b64_tr_b16 a[74:75], v74 offset:25088
    ds_read_b64_tr_b16 a[76:77], v75 offset:24576
    ds_read_b64_tr_b16 a[78:79], v75 offset:25088
    s_waitcnt lgkmcnt(0)
    s_waitcnt vmcnt(28)
    s_barrier
    s_add_u32 m0, s40, 24576
    s_add_u32 s64, s39, 0x14100
    buffer_load_dwordx4 v89, s[56:59], s64 offen lds
    s_add_u32 m0, s40, 25600
    s_add_u32 s64, s39, 0x19100
    buffer_load_dwordx4 v89, s[56:59], s64 offen lds
    s_add_u32 m0, s40, 26624
    s_add_u32 s64, s39, 0x1e100
    buffer_load_dwordx4 v89, s[56:59], s64 offen lds
    s_add_u32 m0, s40, 27648
    s_add_u32 s64, s39, 0x23100
    buffer_load_dwordx4 v89, s[56:59], s64 offen lds
    ds_read_b64_tr_b16 a[80:81], v72 offset:28672
    ds_read_b64_tr_b16 a[82:83], v72 offset:29184
    ds_read_b64_tr_b16 a[84:85], v73 offset:28672
    ds_read_b64_tr_b16 a[86:87], v73 offset:29184
    ds_read_b64_tr_b16 a[88:89], v74 offset:28672
    ds_read_b64_tr_b16 a[90:91], v74 offset:29184
    ds_read_b64_tr_b16 a[92:93], v75 offset:28672
    ds_read_b64_tr_b16 a[94:95], v75 offset:29184
    s_waitcnt lgkmcnt(0)
    s_waitcnt vmcnt(28)
    s_barrier
    s_add_u32 m0, s40, 28672
    s_add_u32 s64, s41, 0x0
    buffer_load_dwordx4 v90, s[56:59], s64 offen lds
    s_add_u32 m0, s40, 29696
    s_add_u32 s64, s41, 0xa000
    buffer_load_dwordx4 v90, s[56:59], s64 offen lds
    s_add_u32 m0, s40, 30720
    s_add_u32 s64, s41, 0x14000
    buffer_load_dwordx4 v90, s[56:59], s64 offen lds
    s_add_u32 m0, s40, 31744
    s_add_u32 s64, s41, 0x1e000
    buffer_load_dwordx4 v90, s[56:59], s64 offen lds
    ds_read_b64_tr_b16 a[96:97], v72 offset:32768
    ds_read_b64_tr_b16 a[98:99], v72 offset:33280
    ds_read_b64_tr_b16 a[100:101], v73 offset:32768
    ds_read_b64_tr_b16 a[102:103], v73 offset:33280
    ds_read_b64_tr_b16 a[104:105], v74 offset:32768
    ds_read_b64_tr_b16 a[106:107], v74 offset:33280
    ds_read_b64_tr_b16 a[108:109], v75 offset:32768
    ds_read_b64_tr_b16 a[110:111], v75 offset:33280
    s_waitcnt lgkmcnt(0)
    s_waitcnt vmcnt(28)
    s_barrier
    s_add_u32 m0, s40, 32768
    s_add_u32 s64, s72, 0x180000
    buffer_load_dwordx4 v76, s[48:51], s64 offen lds
    s_add_u32 m0, s40, 33792
    s_add_u32 s64, s72, 0x188000
    buffer_load_dwordx4 v77, s[48:51], s64 offen lds
    s_add_u32 m0, s40, 34816
    s_add_u32 s64, s72, 0x190000
    buffer_load_dwordx4 v78, s[48:51], s64 offen lds
    s_add_u32 m0, s40, 35840
    s_add_u32 s64, s72, 0x198000
    buffer_load_dwordx4 v79, s[48:51], s64 offen lds
    v_lshlrev_b32 v80, 2, v0
    buffer_load_dword v81, v80, s[60:63], 0 offen sc1
    ds_read_b64_tr_b16 a[112:113], v72 offset:0
    ds_read_b64_tr_b16 a[114:115], v72 offset:512
    ds_read_b64_tr_b16 a[116:117], v73 offset:0
    ds_read_b64_tr_b16 a[118:119], v73 offset:512
    ds_read_b64_tr_b16 a[120:121], v74 offset:0
    ds_read_b64_tr_b16 a[122:123], v74 offset:512
    ds_read_b64_tr_b16 a[124:125], v75 offset:0
    ds_read_b64_tr_b16 a[126:127], v75 offset:512
    s_waitcnt lgkmcnt(0)
    s_waitcnt vmcnt(29)
    s_barrier
    s_add_u32 m0, s40, 0
    s_add_u32 s64, s71, 0x0
    buffer_load_dwordx4 v76, s[48:51], s64 offen lds
    s_add_u32 m0, s40, 1024
    s_add_u32 s64, s71, 0x8000
    buffer_load_dwordx4 v77, s[48:51], s64 offen lds
    s_add_u32 m0, s40, 2048
    s_add_u32 s64, s71, 0x10000
    buffer_load_dwordx4 v78, s[48:51], s64 offen lds
    s_add_u32 m0, s40, 3072
    s_add_u32 s64, s71, 0x18000
    buffer_load_dwordx4 v79, s[48:51], s64 offen lds
    ds_read_b64_tr_b16 a[128:129], v72 offset:4096
    ds_read_b64_tr_b16 a[130:131], v72 offset:4608
    ds_read_b64_tr_b16 a[132:133], v73 offset:4096
    ds_read_b64_tr_b16 a[134:135], v73 offset:4608
    ds_read_b64_tr_b16 a[136:137], v74 offset:4096
    ds_read_b64_tr_b16 a[138:139], v74 offset:4608
    ds_read_b64_tr_b16 a[140:141], v75 offset:4096
    ds_read_b64_tr_b16 a[142:143], v75 offset:4608
    s_waitcnt lgkmcnt(0)
    s_waitcnt vmcnt(29)
    s_barrier
    s_add_u32 m0, s40, 4096
    s_add_u32 s64, s71, 0x80000
    buffer_load_dwordx4 v76, s[48:51], s64 offen lds
    s_add_u32 m0, s40, 5120
    s_add_u32 s64, s71, 0x88000
    buffer_load_dwordx4 v77, s[48:51], s64 offen lds
    s_add_u32 m0, s40, 6144
    s_add_u32 s64, s71, 0x90000
    buffer_load_dwordx4 v78, s[48:51], s64 offen lds
    s_add_u32 m0, s40, 7168
    s_add_u32 s64, s71, 0x98000
    buffer_load_dwordx4 v79, s[48:51], s64 offen lds
    ds_read_b64_tr_b16 a[144:145], v72 offset:8192
    ds_read_b64_tr_b16 a[146:147], v72 offset:8704
    ds_read_b64_tr_b16 a[148:149], v73 offset:8192
    ds_read_b64_tr_b16 a[150:151], v73 offset:8704
    ds_read_b64_tr_b16 a[152:153], v74 offset:8192
    ds_read_b64_tr_b16 a[154:155], v74 offset:8704
    ds_read_b64_tr_b16 a[156:157], v75 offset:8192
    ds_read_b64_tr_b16 a[158:159], v75 offset:8704
    s_waitcnt lgkmcnt(0)
    s_waitcnt vmcnt(29)
    s_barrier
    s_add_u32 m0, s40, 8192
    s_add_u32 s64, s71, 0x100000
    buffer_load_dwordx4 v76, s[48:51], s64 offen lds
    s_add_u32 m0, s40, 9216
    s_add_u32 s64, s71, 0x108000
    buffer_load_dwordx4 v77, s[48:51], s64 offen lds
    s_add_u32 m0, s40, 10240
    s_add_u32 s64, s71, 0x110000
    buffer_load_dwordx4 v78, s[48:51], s64 offen lds
    s_add_u32 m0, s40, 11264
    s_add_u32 s64, s71, 0x118000
    buffer_load_dwordx4 v79, s[48:51], s64 offen lds
    ds_read_b64_tr_b16 a[160:161], v93 offset:12288
    ds_read_b64_tr_b16 a[162:163], v93 offset:12544
    ds_read_b64_tr_b16 a[164:165], v93 offset:13312
    ds_read_b64_tr_b16 a[166:167], v93 offset:13568
    ds_read_b64_tr_b16 a[168:169], v93 offset:14336
    ds_read_b64_tr_b16 a[170:171], v93 offset:14592
    ds_read_b64_tr_b16 a[172:173], v93 offset:15360
    ds_read_b64_tr_b16 a[174:175], v93 offset:15616
    s_waitcnt lgkmcnt(0)
    s_waitcnt vmcnt(29)
    s_barrier
    s_add_u32 m0, s40, 12288
    s_add_u32 s64, s71, 0x180000
    buffer_load_dwordx4 v76, s[48:51], s64 offen lds
    s_add_u32 m0, s40, 13312
    s_add_u32 s64, s71, 0x188000
    buffer_load_dwordx4 v77, s[48:51], s64 offen lds
    s_add_u32 m0, s40, 14336
    s_add_u32 s64, s71, 0x190000
    buffer_load_dwordx4 v78, s[48:51], s64 offen lds
    s_add_u32 m0, s40, 15360
    s_add_u32 s64, s71, 0x198000
    buffer_load_dwordx4 v79, s[48:51], s64 offen lds
    ds_read_b64_tr_b16 a[176:177], v93 offset:16384
    ds_read_b64_tr_b16 a[178:179], v93 offset:16640
    ds_read_b64_tr_b16 a[180:181], v93 offset:17408
    ds_read_b64_tr_b16 a[182:183], v93 offset:17664
    ds_read_b64_tr_b16 a[184:185], v93 offset:18432
    ds_read_b64_tr_b16 a[186:187], v93 offset:18688
    ds_read_b64_tr_b16 a[188:189], v93 offset:19456
    ds_read_b64_tr_b16 a[190:191], v93 offset:19712
    s_waitcnt lgkmcnt(0)
    s_waitcnt vmcnt(29)
    s_barrier
    s_add_u32 m0, s40, 16384
    s_add_u32 s64, s71, 0x200000
    buffer_load_dwordx4 v76, s[48:51], s64 offen lds
    s_add_u32 m0, s40, 17408
    s_add_u32 s64, s71, 0x208000
    buffer_load_dwordx4 v77, s[48:51], s64 offen lds
    s_add_u32 m0, s40, 18432
    s_add_u32 s64, s71, 0x210000
    buffer_load_dwordx4 v78, s[48:51], s64 offen lds
    s_add_u32 m0, s40, 19456
    s_add_u32 s64, s71, 0x218000
    buffer_load_dwordx4 v79, s[48:51], s64 offen lds
    ds_read_b64_tr_b16 a[192:193], v93 offset:20480
    ds_read_b64_tr_b16 a[194:195], v93 offset:20736
    ds_read_b64_tr_b16 a[196:197], v93 offset:21504
    ds_read_b64_tr_b16 a[198:199], v93 offset:21760
    ds_read_b64_tr_b16 a[200:201], v93 offset:22528
    ds_read_b64_tr_b16 a[202:203], v93 offset:22784
    ds_read_b64_tr_b16 a[204:205], v93 offset:23552
    ds_read_b64_tr_b16 a[206:207], v93 offset:23808
    s_waitcnt lgkmcnt(0)
    s_waitcnt vmcnt(29)
    s_barrier
    s_add_u32 m0, s40, 20480
    s_add_u32 s64, s72, 0x0
    buffer_load_dwordx4 v76, s[48:51], s64 offen lds
    s_add_u32 m0, s40, 21504
    s_add_u32 s64, s72, 0x8000
    buffer_load_dwordx4 v77, s[48:51], s64 offen lds
    s_add_u32 m0, s40, 22528
    s_add_u32 s64, s72, 0x10000
    buffer_load_dwordx4 v78, s[48:51], s64 offen lds
    s_add_u32 m0, s40, 23552
    s_add_u32 s64, s72, 0x18000
    buffer_load_dwordx4 v79, s[48:51], s64 offen lds
    ds_read_b64_tr_b16 a[208:209], v93 offset:24576
    ds_read_b64_tr_b16 a[210:211], v93 offset:24832
    ds_read_b64_tr_b16 a[212:213], v93 offset:25600
    ds_read_b64_tr_b16 a[214:215], v93 offset:25856
    ds_read_b64_tr_b16 a[216:217], v93 offset:26624
    ds_read_b64_tr_b16 a[218:219], v93 offset:26880
    ds_read_b64_tr_b16 a[220:221], v93 offset:27648
    ds_read_b64_tr_b16 a[222:223], v93 offset:27904
    s_waitcnt lgkmcnt(0)
    s_waitcnt vmcnt(29)
    s_barrier
    s_add_u32 m0, s40, 24576
    s_add_u32 s64, s72, 0x80000
    buffer_load_dwordx4 v76, s[48:51], s64 offen lds
    s_add_u32 m0, s40, 25600
    s_add_u32 s64, s72, 0x88000
    buffer_load_dwordx4 v77, s[48:51], s64 offen lds
    s_add_u32 m0, s40, 26624
    s_add_u32 s64, s72, 0x90000
    buffer_load_dwordx4 v78, s[48:51], s64 offen lds
    s_add_u32 m0, s40, 27648
    s_add_u32 s64, s72, 0x98000
    buffer_load_dwordx4 v79, s[48:51], s64 offen lds
    ds_read_b64_tr_b16 a[224:225], v94 offset:28672
    ds_read_b64_tr_b16 a[226:227], v94 offset:28800
    ds_read_b64_tr_b16 a[228:229], v94 offset:29696
    ds_read_b64_tr_b16 a[230:231], v94 offset:29824
    ds_read_b64_tr_b16 a[232:233], v94 offset:30720
    ds_read_b64_tr_b16 a[234:235], v94 offset:30848
    ds_read_b64_tr_b16 a[236:237], v94 offset:31744
    ds_read_b64_tr_b16 a[238:239], v94 offset:31872
    s_waitcnt lgkmcnt(0)
    s_waitcnt vmcnt(29)
    s_barrier
    s_add_u32 m0, s40, 28672
    s_add_u32 s64, s72, 0x100000
    buffer_load_dwordx4 v76, s[48:51], s64 offen lds
    s_add_u32 m0, s40, 29696
    s_add_u32 s64, s72, 0x108000
    buffer_load_dwordx4 v77, s[48:51], s64 offen lds
    s_add_u32 m0, s40, 30720
    s_add_u32 s64, s72, 0x110000
    buffer_load_dwordx4 v78, s[48:51], s64 offen lds
    s_add_u32 m0, s40, 31744
    s_add_u32 s64, s72, 0x118000
    buffer_load_dwordx4 v79, s[48:51], s64 offen lds
    s_mov_b32 s65, 0x290800
    buffer_load_dword v84, off, s[4:7], s65 sc1
    buffer_load_dwordx2 v[82:83], off, s[4:7], s69 sc1
    ds_read_b64_tr_b16 v[12:13], v72 offset:32768
    ds_read_b64_tr_b16 v[14:15], v72 offset:33280
    ds_read_b64_tr_b16 v[16:17], v73 offset:32768
    ds_read_b64_tr_b16 v[18:19], v73 offset:33280
    ds_read_b64_tr_b16 v[20:21], v74 offset:32768
    ds_read_b64_tr_b16 v[22:23], v74 offset:33280
    ds_read_b64_tr_b16 v[24:25], v75 offset:32768
    ds_read_b64_tr_b16 v[26:27], v75 offset:33280
    s_waitcnt lgkmcnt(0)
    s_barrier
    ds_write_b128 v2, v[12:15] offset:32768
    ds_write_b128 v2, v[16:19] offset:33792
    ds_write_b128 v2, v[20:23] offset:34816
    ds_write_b128 v2, v[24:27] offset:35840
    s_waitcnt lgkmcnt(0)
    s_waitcnt vmcnt(30)
    s_barrier
    ds_read_b64_tr_b16 v[12:13], v72 offset:0
    ds_read_b64_tr_b16 v[14:15], v72 offset:512
    ds_read_b64_tr_b16 v[16:17], v73 offset:0
    ds_read_b64_tr_b16 v[18:19], v73 offset:512
    ds_read_b64_tr_b16 v[20:21], v74 offset:0
    ds_read_b64_tr_b16 v[22:23], v74 offset:512
    ds_read_b64_tr_b16 v[24:25], v75 offset:0
    ds_read_b64_tr_b16 v[26:27], v75 offset:512
    s_waitcnt lgkmcnt(0)
    s_barrier
    ds_write_b128 v2, v[12:15] offset:0
    ds_write_b128 v2, v[16:19] offset:1024
    ds_write_b128 v2, v[20:23] offset:2048
    ds_write_b128 v2, v[24:27] offset:3072
    s_waitcnt lgkmcnt(0)
    s_waitcnt vmcnt(26)
    s_barrier
    ds_read_b64_tr_b16 v[12:13], v72 offset:4096
    ds_read_b64_tr_b16 v[14:15], v72 offset:4608
    ds_read_b64_tr_b16 v[16:17], v73 offset:4096
    ds_read_b64_tr_b16 v[18:19], v73 offset:4608
    ds_read_b64_tr_b16 v[20:21], v74 offset:4096
    ds_read_b64_tr_b16 v[22:23], v74 offset:4608
    ds_read_b64_tr_b16 v[24:25], v75 offset:4096
    ds_read_b64_tr_b16 v[26:27], v75 offset:4608
    s_waitcnt lgkmcnt(0)
    s_barrier
    ds_write_b128 v2, v[12:15] offset:4096
    ds_write_b128 v2, v[16:19] offset:5120
    ds_write_b128 v2, v[20:23] offset:6144
    ds_write_b128 v2, v[24:27] offset:7168
    s_waitcnt lgkmcnt(0)
    s_waitcnt vmcnt(22)
    s_barrier
    ds_read_b64_tr_b16 v[12:13], v72 offset:8192
    ds_read_b64_tr_b16 v[14:15], v72 offset:8704
    ds_read_b64_tr_b16 v[16:17], v73 offset:8192
    ds_read_b64_tr_b16 v[18:19], v73 offset:8704
    ds_read_b64_tr_b16 v[20:21], v74 offset:8192
    ds_read_b64_tr_b16 v[22:23], v74 offset:8704
    ds_read_b64_tr_b16 v[24:25], v75 offset:8192
    ds_read_b64_tr_b16 v[26:27], v75 offset:8704
    s_waitcnt lgkmcnt(0)
    s_barrier
    ds_write_b128 v2, v[12:15] offset:8192
    ds_write_b128 v2, v[16:19] offset:9216
    ds_write_b128 v2, v[20:23] offset:10240
    ds_write_b128 v2, v[24:27] offset:11264
    s_waitcnt lgkmcnt(0)
    s_waitcnt vmcnt(18)
    s_barrier
    ds_read_b64_tr_b16 v[12:13], v72 offset:12288
    ds_read_b64_tr_b16 v[14:15], v72 offset:12800
    ds_read_b64_tr_b16 v[16:17], v73 offset:12288
    ds_read_b64_tr_b16 v[18:19], v73 offset:12800
    ds_read_b64_tr_b16 v[20:21], v74 offset:12288
    ds_read_b64_tr_b16 v[22:23], v74 offset:12800
    ds_read_b64_tr_b16 v[24:25], v75 offset:12288
    ds_read_b64_tr_b16 v[26:27], v75 offset:12800
    s_waitcnt lgkmcnt(0)
    s_barrier
    ds_write_b128 v2, v[12:15] offset:12288
    ds_write_b128 v2, v[16:19] offset:13312
    ds_write_b128 v2, v[20:23] offset:14336
    ds_write_b128 v2, v[24:27] offset:15360
    s_waitcnt lgkmcnt(0)
    s_waitcnt vmcnt(14)
    s_barrier
    ds_read_b64_tr_b16 v[12:13], v72 offset:16384
    ds_read_b64_tr_b16 v[14:15], v72 offset:16896
    ds_read_b64_tr_b16 v[16:17], v73 offset:16384
    ds_read_b64_tr_b16 v[18:19], v73 offset:16896
    ds_read_b64_tr_b16 v[20:21], v74 offset:16384
    ds_read_b64_tr_b16 v[22:23], v74 offset:16896
    ds_read_b64_tr_b16 v[24:25], v75 offset:16384
    ds_read_b64_tr_b16 v[26:27], v75 offset:16896
    s_waitcnt lgkmcnt(0)
    s_barrier
    ds_write_b128 v2, v[12:15] offset:16384
    ds_write_b128 v2, v[16:19] offset:17408
    ds_write_b128 v2, v[20:23] offset:18432
    ds_write_b128 v2, v[24:27] offset:19456
    s_waitcnt lgkmcnt(0)
    s_waitcnt vmcnt(10)
    s_barrier
    ds_read_b64_tr_b16 v[12:13], v72 offset:20480
    ds_read_b64_tr_b16 v[14:15], v72 offset:20992
    ds_read_b64_tr_b16 v[16:17], v73 offset:20480
    ds_read_b64_tr_b16 v[18:19], v73 offset:20992
    ds_read_b64_tr_b16 v[20:21], v74 offset:20480
    ds_read_b64_tr_b16 v[22:23], v74 offset:20992
    ds_read_b64_tr_b16 v[24:25], v75 offset:20480
    ds_read_b64_tr_b16 v[26:27], v75 offset:20992
    s_waitcnt lgkmcnt(0)
    s_barrier
    ds_write_b128 v2, v[12:15] offset:20480
    ds_write_b128 v2, v[16:19] offset:21504
    ds_write_b128 v2, v[20:23] offset:22528
    ds_write_b128 v2, v[24:27] offset:23552
    s_waitcnt lgkmcnt(0)
    s_waitcnt vmcnt(6)
    s_barrier
    ds_read_b64_tr_b16 v[12:13], v72 offset:24576
    ds_read_b64_tr_b16 v[14:15], v72 offset:25088
    ds_read_b64_tr_b16 v[16:17], v73 offset:24576
    ds_read_b64_tr_b16 v[18:19], v73 offset:25088
    ds_read_b64_tr_b16 v[20:21], v74 offset:24576
    ds_read_b64_tr_b16 v[22:23], v74 offset:25088
    ds_read_b64_tr_b16 v[24:25], v75 offset:24576
    ds_read_b64_tr_b16 v[26:27], v75 offset:25088
    s_waitcnt lgkmcnt(0)
    s_barrier
    ds_write_b128 v2, v[12:15] offset:24576
    ds_write_b128 v2, v[16:19] offset:25600
    ds_write_b128 v2, v[20:23] offset:26624
    ds_write_b128 v2, v[24:27] offset:27648
    s_waitcnt lgkmcnt(0)
    s_waitcnt vmcnt(2)
    s_barrier
    ds_read_b64_tr_b16 v[12:13], v72 offset:28672
    ds_read_b64_tr_b16 v[14:15], v72 offset:29184
    ds_read_b64_tr_b16 v[16:17], v73 offset:28672
    ds_read_b64_tr_b16 v[18:19], v73 offset:29184
    ds_read_b64_tr_b16 v[20:21], v74 offset:28672
    ds_read_b64_tr_b16 v[22:23], v74 offset:29184
    ds_read_b64_tr_b16 v[24:25], v75 offset:28672
    ds_read_b64_tr_b16 v[26:27], v75 offset:29184
    s_waitcnt lgkmcnt(0)
    s_barrier
    ds_write_b128 v2, v[12:15] offset:28672
    ds_write_b128 v2, v[16:19] offset:29696
    ds_write_b128 v2, v[20:23] offset:30720
    ds_write_b128 v2, v[24:27] offset:31744
    s_waitcnt lgkmcnt(0)
    s_waitcnt vmcnt(0)
    s_cmp_lg_u32 s97, 0
    s_cbranch_scc1 NOTEARLY_8
    v_cmp_ne_u32 vcc, 32, v81
    v_readlane_b32 s64, v81, 1
    v_readlane_b32 s66, v81, 33
    v_readlane_b32 s67, v81, 34
    s_and_b32 s65, vcc_lo, 0x01010101
    s_cbranch_scc1 NOTEARLY_8
    s_and_b32 s65, vcc_hi, 0x01010101
    s_cbranch_scc1 NOTEARLY_8
    s_cmp_lt_u32 s64, 192
    s_cbranch_scc1 NOTEARLY_8
    v_readfirstlane_b32 s64, v84
    s_cmp_lt_u32 s64, 192
    s_cbranch_scc1 NOTEARLY_8
    s_min_u32 s65, s66, s67
    s_cmp_eq_u32 s65, 0
    s_cbranch_scc1 NOTEARLY_8
    s_sub_u32 s66, s66, 1
    s_sub_u32 s67, s67, 1
    s_branch EARLY_7
NOTEARLY_8:
    s_cmp_lg_u32 s97, 0
    s_cbranch_scc1 CM_9
    v_mbcnt_lo_u32_b32 v0, -1, 0
    v_mbcnt_hi_u32_b32 v0, -1, v0
    v_mul_u32_u24 v8, 32, v0
    s_mov_b32 s64, 0x0
    s_mov_b32 s65, 0
    s_mov_b64 exec, 0xff
TK_10:
    buffer_load_dword v9, v8, s[60:63], s64 offen sc1
    s_add_u32 s65, s65, 1
    s_waitcnt vmcnt(0)
    s_mov_b32 s66, 0
    v_readlane_b32 s67, v9, 0
    s_add_u32 s66, s66, s67
    v_readlane_b32 s67, v9, 1
    s_add_u32 s66, s66, s67
    v_readlane_b32 s67, v9, 2
    s_add_u32 s66, s66, s67
    v_readlane_b32 s67, v9, 3
    s_add_u32 s66, s66, s67
    v_readlane_b32 s67, v9, 4
    s_add_u32 s66, s66, s67
    v_readlane_b32 s67, v9, 5
    s_add_u32 s66, s66, s67
    v_readlane_b32 s67, v9, 6
    s_add_u32 s66, s66, s67
    v_readlane_b32 s67, v9, 7
    s_add_u32 s66, s66, s67
    s_cmp_ge_u32 s66, 256
    s_cbranch_scc1 TKD_11
    s_cmp_gt_u32 s65, 262144
    s_cbranch_scc0 TK_10
TKD_11:
    v_cmp_ne_u32 vcc, 32, v9
    s_mov_b64 exec, -1
    s_cbranch_vccnz M_SLOW
CM_9:
    s_mov_b32 s65, 0
RI_12:
    buffer_load_dword v8, off, s[60:63], s95 sc1
    s_add_u32 s65, s65, 1
    s_waitcnt vmcnt(0)
    v_readfirstlane_b32 s64, v8
    s_cmp_ge_u32 s64, 192
    s_cbranch_scc1 RID_13
    s_cmp_gt_u32 s65, 65536
    s_cbranch_scc1 RID_13
    s_sleep 4
    s_branch RI_12
RID_13:
    s_mov_b32 s65, 0
    s_mov_b32 s66, 0x290800
RB_14:
    buffer_load_dword v8, off, s[4:7], s66 sc1
    s_add_u32 s65, s65, 1
    s_waitcnt vmcnt(0)
    v_readfirstlane_b32 s64, v8
    s_cmp_ge_u32 s64, 192
    s_cbranch_scc1 RBD_15
    s_cmp_gt_u32 s65, 65536
    s_cbranch_scc1 RBD_15
    s_sleep 8
    s_branch RB_14
RBD_15:
    s_mov_b32 s65, 0
CW_16:
    buffer_load_dwordx2 v[8:9], off, s[60:63], 0 offset:132 sc1
    s_add_u32 s65, s65, 1
    s_waitcnt vmcnt(0)
    v_readfirstlane_b32 s66, v8
    v_readfirstlane_b32 s67, v9
    s_min_u32 s64, s66, s67
    s_cmp_lg_u32 s64, 0
    s_cbranch_scc1 CWD_17
    s_cmp_gt_u32 s65, 65536
    s_cbranch_scc1 CWD_17
    s_sleep 4
    s_branch CW_16
CWD_17:
    s_sub_u32 s66, s66, 1
    s_and_b32 s66, s66, 3
    s_sub_u32 s67, s67, 1
    s_and_b32 s67, s67, 3
EARLY_7:
    s_mov_b32 s56, s66
    s_mov_b32 s57, s67
    s_mov_b32 s38, 0x3f80
    s_mov_b32 s53, 0
    s_cmp_eq_u32 s14, 2
    s_cselect_b32 s52, 1024, 0
    s_cmp_eq_u32 s14, 3
    s_cselect_b32 s58, 0, 1
    s_mov_b32 s59, 0
    s_or_b32 s64, s14, s12
    s_cmp_eq_u32 s64, 0
    s_cselect_b32 s55, 2, 0
    s_mov_b32 s44, 0x3030303
    s_mov_b32 s45, 0x3030303
    s_mov_b32 s46, 0xc0c0c0c
    s_mov_b32 s47, 0xc0c0c0c
    s_mov_b32 s48, 0x30303030
    s_mov_b32 s49, 0x30303030
    s_mov_b32 s50, 0xc0c0c0c0
    s_mov_b32 s51, 0xc0c0c0c0
    v_and_b32 v8, 7, v0
    v_mul_u32_u24 v8, 288, v8
    v_lshrrev_b32 v9, 4, v0
    v_lshl_add_u32 v8, v9, 4, v8
    v_add_u32 v0, 12800, v8
    s_mov_b32 s68, 0
    s_mov_b32 s40, 0
    s_mov_b32 s64, s56
    s_mov_b32 s65, s57
    s_cmp_eq_u32 s12, 0
    s_cselect_b32 s66, s65, s64
    s_cselect_b32 s64, s64, s65
    s_and_b32 s64, s64, 3
    s_lshl_b32 s64, s64, 13
    s_and_b32 s66, s66, 3
    s_lshl_b32 s66, s66, 13
    s_add_u32 s21, s21, s64
    s_add_u32 s20, s20, s66
    s_cmp_eq_u32 s42, 0
    s_cselect_b32 s18, 0x40000000, s18
    s_cselect_b32 s21, 0x40000000, s21
    s_lshl_b32 s65, s12, 7
    s_add_u32 s65, s65, 0x29a000
    s_cmp_eq_u32 s22, 0
    s_cselect_b32 s22, 0x40000000, s65
    s_lshl_b32 s64, s13, 2
    s_add_u32 s64, s64, s14
    s_cmp_ge_u32 s64, 40
    s_cselect_b32 s65, 40, 0
    s_sub_u32 s64, s64, s65
    s_cmp_ge_u32 s64, 40
    s_cselect_b32 s65, 40, 0
    s_sub_u32 s64, s64, s65
    s_cmp_ge_u32 s64, 40
    s_cselect_b32 s65, 40, 0
    s_sub_u32 s64, s64, s65
    s_lshl_b32 s27, s64, 7
    s_add_u32 s19, s27, 0x4000
    v_and_b32 v82, v82, v83
    v_cmp_eq_u32 vcc, 0, v82
    s_cmp_lg_u32 s97, 0
    s_cselect_b64 vcc, -1, vcc
    s_cbranch_vccz KVOK_18
    v_mov_b32 v29, 0
FSPIN_19:
    buffer_load_dwordx2 v[12:13], v29, s[4:7], s69 offen sc1
    s_add_u32 s68, s68, 1
    s_waitcnt vmcnt(0)
    v_and_b32 v12, v12, v13
    v_cmp_eq_u32 vcc, 0, v12
    s_cbranch_vccz FDONE_20
    s_cmp_gt_u32 s68, 262144
    s_cbranch_scc0 FSPIN_19
FDONE_20:
KVOK_18:
    s_barrier
    s_mov_b32 m0, s73
    s_nop 0
    buffer_load_dwordx4 v1, s[4:7], s28 offen lds
    buffer_load_dwordx4 v1, s[4:7], s28 offen offset:1024 lds
    s_mov_b32 m0, 16128
    v_lshlrev_b32 v12, 2, v1
    s_add_u32 s65, s3, 0xfff80000
    buffer_load_dword v12, s[4:7], s65 offen lds
    s_mov_b32 s15, 0
    s_mov_b32 s16, 0
    s_add_u32 s66, s17, s52
    buffer_load_dwordx4 v[12:15], v1, s[4:7], s66 offen sc1
    buffer_load_dwordx4 v[16:19], v1, s[4:7], s17 offen offset:2048 sc1
    v_add_u32 v29, s52, v1
    s_waitcnt vmcnt(0)
    ds_write_b128 v29, v[12:15] offset:12800
    ds_write_b128 v1, v[16:19] offset:15104
    s_waitcnt lgkmcnt(0)
    v_mov_b64 v[32:33], 0
    v_mov_b64 v[34:35], 0
    v_mov_b64 v[36:37], 0
    v_mov_b64 v[38:39], 0
    v_mov_b64 v[40:41], 0
    v_mov_b64 v[42:43], 0
    v_mov_b64 v[44:45], 0
    v_mov_b64 v[46:47], 0
    v_mov_b64 v[48:49], 0
    v_mov_b64 v[50:51], 0
    v_mov_b64 v[52:53], 0
    v_mov_b64 v[54:55], 0
    v_mov_b32 v9, 0x40000000
    ds_read_b128 v[56:59], v2 offset:0
    ds_read_b128 v[60:63], v2 offset:1024
    ds_read_b128 v[64:67], v2 offset:2048
    ds_read_b128 v[68:71], v2 offset:3072
    s_cmp_eq_u32 s97, 0
    s_cbranch_scc1 REC_LOOP
    s_branch REC_LOOP_S
REC_POLL_S:
    s_cmp_eq_u32 s59, 0
    s_cbranch_scc1 NOFLG_21
    s_waitcnt vmcnt(0)
    v_lshrrev_b32 v29, 2, v1
    ds_read_b32 v12, v29 offset:15104
    s_add_u32 s64, s15, 2
    s_lshr_b32 s65, s64, 1
    s_add_u32 s67, s65, 1
    s_waitcnt lgkmcnt(0)
    v_cmp_ne_u32 vcc, 0, v12
    v_readlane_b32 s65, v12, s65
    v_readlane_b32 s67, v12, s67
    s_cmp_eq_u32 vcc_lo, -1
    s_cselect_b32 s58, 1, 0
    s_and_b32 s65, s65, s67
    s_cbranch_scc1 NOFLG_21
    s_lshl_b32 s64, s64, 7
    s_add_u32 s64, s64, s69
    v_mov_b32 v29, 0
FSPIN_23:
    buffer_load_dwordx2 v[12:13], v29, s[4:7], s64 offen sc1
    s_add_u32 s68, s68, 1
    s_waitcnt vmcnt(0)
    v_and_b32 v12, v12, v13
    v_cmp_eq_u32 vcc, 0, v12
    s_cbranch_vccz FDONE_24
    s_cmp_gt_u32 s68, 262144
    s_cbranch_scc0 FSPIN_23
FDONE_24:
NOFLG_21:
    s_add_u32 s64, s15, 3
    s_and_b32 s64, s64, 0x43
    s_or_b32 s64, s64, s58
    s_cmp_eq_u32 s64, 0
    s_cselect_b32 s59, 1, 0
    s_add_u32 s66, s17, s52
    v_add_u32 v10, s52, v1
    s_xor_b32 s16, s16, 1
    v_mov_b64 v[32:33], 0
    v_mov_b64 v[34:35], 0
    v_mov_b64 v[36:37], 0
    v_mov_b64 v[38:39], 0
    v_mov_b64 v[40:41], 0
    v_mov_b64 v[42:43], 0
    v_mov_b64 v[44:45], 0
    v_mov_b64 v[46:47], 0
    v_mov_b64 v[48:49], 0
    v_mov_b64 v[50:51], 0
    v_mov_b64 v[52:53], 0
    v_mov_b64 v[54:55], 0
    ds_read_b128 v[56:59], v2 offset:0
    ds_read_b128 v[60:63], v2 offset:1024
    ds_read_b128 v[64:67], v2 offset:2048
    ds_read_b128 v[68:71], v2 offset:3072
    s_barrier
    s_nop 14
    buffer_load_dwordx4 v[20:23], v1, s[4:7], s66 offen offset:0 sc1
    s_nop 7
    buffer_load_dwordx4 v[24:27], v1, s[4:7], s66 offen offset:0 sc1
    s_nop 7
    buffer_load_dwordx4 v[28:31], v1, s[4:7], s66 offen offset:0 sc1
IPOLL_26:
    s_waitcnt vmcnt(2)
    ds_write_b128 v10, v[20:23] offset:12800
    v_max3_u32 v11, v20, v21, v22
    v_max_u32 v11, v11, v23
    v_cmp_eq_u32 vcc, -1, v11
    s_cbranch_vccz IOK_25
    buffer_load_dwordx4 v[20:23], v1, s[4:7], s66 offen offset:0 sc1
    s_waitcnt vmcnt(2)
    ds_write_b128 v10, v[24:27] offset:12800
    v_max3_u32 v11, v24, v25, v26
    v_max_u32 v11, v11, v27
    v_cmp_eq_u32 vcc, -1, v11
    s_cbranch_vccz IOK_25
    buffer_load_dwordx4 v[24:27], v1, s[4:7], s66 offen offset:0 sc1
    s_waitcnt vmcnt(2)
    ds_write_b128 v10, v[28:31] offset:12800
    v_max3_u32 v11, v28, v29, v30
    v_max_u32 v11, v11, v31
    v_cmp_eq_u32 vcc, -1, v11
    s_add_u32 s68, s68, 1
    s_add_u32 s53, s53, 1
    s_cmp_gt_u32 s68, 262144
    s_cbranch_scc1 IOK_25
    s_cbranch_vccz IOK_25
    buffer_load_dwordx4 v[28:31], v1, s[4:7], s66 offen offset:0 sc1
    s_branch IPOLL_26
IOK_25:
    s_waitcnt lgkmcnt(0)
REC_LOOP_S:
    s_barrier
    ds_read_b128 v[12:15], v1 offset:12800
    ds_read_b128 v[16:19], v1 offset:13824
    buffer_load_dwordx4 v[20:23], v1, s[4:7], s17 offen offset:2048
    ds_read_b128 v[72:75], v2 offset:4096
    ds_read_b128 v[76:79], v2 offset:5120
    ds_read_b128 v[80:83], v2 offset:6144
    ds_read_b128 v[84:87], v2 offset:7168
    s_add_u32 s74, s17, 0x1000
    s_add_u32 s20, s20, 0x8000
    s_add_u32 s75, s20, 0x1000
    s_mov_b32 m0, 16128
    s_add_u32 s65, s20, s27
    s_waitcnt lgkmcnt(5)
    v_smfmac_f32_16x16x64_bf16 v[32:35], v[12:15], v[96:103], v6
    buffer_load_dwordx4 v[24:27], v1, s[4:7], s17 offen offset:3072
    v_smfmac_f32_16x16x64_bf16 v[36:39], v[12:15], v[104:111], v6
    v_smfmac_f32_16x16x64_bf16 v[40:43], v[12:15], v[56:63], v6
    buffer_load_dwordx4 v[28:31], v1, s[4:7], s74 offen offset:0
    ds_read_b128 v[56:59], v2 offset:8192
    ds_read_b128 v[60:63], v2 offset:9216
    v_smfmac_f32_16x16x64_bf16 v[44:47], v[12:15], v[64:71], v6
    ds_read_b128 v[64:67], v2 offset:10240
    ds_read_b128 v[68:71], v2 offset:11264
    s_waitcnt lgkmcnt(8)
    v_smfmac_f32_16x16x64_bf16 v[48:51], v[12:15], a[0:7], v6
    v_smfmac_f32_16x16x64_bf16 v[52:55], v[12:15], a[8:15], v6
    buffer_load_dwordx4 v[12:15], v1, s[4:7], s20 offen offset:0
    buffer_load_dword off, s[4:7], s65 lds
    v_smfmac_f32_16x16x64_bf16 v[32:35], v[16:19], v[112:119], v6
    v_smfmac_f32_16x16x64_bf16 v[36:39], v[16:19], v[120:127], v6
    s_waitcnt lgkmcnt(4)
    v_smfmac_f32_16x16x64_bf16 v[40:43], v[16:19], v[72:79], v6
    ds_read_b128 v[72:75], v2 offset:12288
    ds_read_b128 v[76:79], v2 offset:13312
    v_smfmac_f32_16x16x64_bf16 v[44:47], v[16:19], v[80:87], v6
    ds_read_b128 v[80:83], v2 offset:14336
    ds_read_b128 v[84:87], v2 offset:15360
    s_waitcnt vmcnt(4)
    v_cmp_eq_u32 vcc, -1, v23
    v_smfmac_f32_16x16x64_bf16 v[48:51], v[16:19], a[16:23], v6
    v_smfmac_f32_16x16x64_bf16 v[52:55], v[16:19], a[24:31], v6
    s_cbranch_vccnz RETRY_27
BACK_28:
    buffer_load_dwordx4 v[16:19], v1, s[4:7], s20 offen offset:1024
    v_smfmac_f32_16x16x64_bf16 v[32:35], v[20:23], v[128:135], v6
    v_smfmac_f32_16x16x64_bf16 v[36:39], v[20:23], v[136:143], v6
    s_waitcnt lgkmcnt(4)
    v_smfmac_f32_16x16x64_bf16 v[40:43], v[20:23], v[56:63], v6
    ds_read_b128 v[56:59], v2 offset:16384
    ds_read_b128 v[60:63], v2 offset:17408
    v_smfmac_f32_16x16x64_bf16 v[44:47], v[20:23], v[64:71], v6
    ds_read_b128 v[64:67], v2 offset:18432
    ds_read_b128 v[68:71], v2 offset:19456
    s_waitcnt vmcnt(4)
    v_cmp_eq_u32 vcc, -1, v27
    v_smfmac_f32_16x16x64_bf16 v[48:51], v[20:23], a[32:39], v6
    v_smfmac_f32_16x16x64_bf16 v[52:55], v[20:23], a[40:47], v6
    s_cbranch_vccnz RETRY_29
BACK_30:
    buffer_load_dwordx4 v[20:23], v1, s[4:7], s20 offen offset:2048
    v_smfmac_f32_16x16x64_bf16 v[32:35], v[24:27], v[144:151], v6
    v_smfmac_f32_16x16x64_bf16 v[36:39], v[24:27], v[152:159], v6
    s_waitcnt lgkmcnt(4)
    v_smfmac_f32_16x16x64_bf16 v[40:43], v[24:27], v[72:79], v6
    ds_read_b128 v[72:75], v2 offset:20480
    ds_read_b128 v[76:79], v2 offset:21504
    v_smfmac_f32_16x16x64_bf16 v[44:47], v[24:27], v[80:87], v6
    ds_read_b128 v[80:83], v2 offset:22528
    ds_read_b128 v[84:87], v2 offset:23552
    s_waitcnt vmcnt(4)
    v_cmp_eq_u32 vcc, -1, v31
    v_smfmac_f32_16x16x64_bf16 v[48:51], v[24:27], a[48:55], v6
    v_smfmac_f32_16x16x64_bf16 v[52:55], v[24:27], a[56:63], v6
    s_cbranch_vccnz RETRY_31
BACK_32:
    buffer_load_dwordx4 v[24:27], v1, s[4:7], s20 offen offset:3072
    v_smfmac_f32_16x16x64_bf16 v[32:35], v[28:31], v[160:167], v6
    v_smfmac_f32_16x16x64_bf16 v[36:39], v[28:31], v[168:175], v6
    s_waitcnt lgkmcnt(4)
    v_smfmac_f32_16x16x64_bf16 v[40:43], v[28:31], v[56:63], v6
    ds_read_b128 v[56:59], v2 offset:24576
    ds_read_b128 v[60:63], v2 offset:25600
    v_smfmac_f32_16x16x64_bf16 v[44:47], v[28:31], v[64:71], v6
    ds_read_b128 v[64:67], v2 offset:26624
    ds_read_b128 v[68:71], v2 offset:27648
    s_waitcnt vmcnt(4)
    v_cmp_eq_u32 vcc, -1, v15
    v_smfmac_f32_16x16x64_bf16 v[48:51], v[28:31], a[64:71], v6
    v_smfmac_f32_16x16x64_bf16 v[52:55], v[28:31], a[72:79], v6
    s_cbranch_vccnz RETRY_33
BACK_34:
    buffer_load_dwordx4 v[28:31], v1, s[4:7], s75 offen offset:0
    v_smfmac_f32_16x16x64_bf16 v[32:35], v[12:15], v[176:183], v6
    s_waitcnt vmcnt(3)
    v_cmp_eq_u32 vcc, -1, v19
    v_smfmac_f32_16x16x64_bf16 v[36:39], v[12:15], v[184:191], v6
    s_waitcnt lgkmcnt(4)
    v_smfmac_f32_16x16x64_bf16 v[40:43], v[12:15], v[72:79], v6
    ds_read_b128 v[72:75], v2 offset:28672
    ds_read_b128 v[76:79], v2 offset:29696
    v_smfmac_f32_16x16x64_bf16 v[44:47], v[12:15], v[80:87], v6
    ds_read_b128 v[80:83], v2 offset:30720
    ds_read_b128 v[84:87], v2 offset:31744
    buffer_load_dwordx4 v[88:91], v1, s[4:7], s29 offen offset:0
    s_cbranch_vccnz RETRY_35
BACK_36:
    v_smfmac_f32_16x16x64_bf16 v[32:35], v[16:19], v[192:199], v6
    s_waitcnt vmcnt(3)
    v_cmp_eq_u32 vcc, -1, v23
    v_smfmac_f32_16x16x64_bf16 v[36:39], v[16:19], v[200:207], v6
    s_waitcnt lgkmcnt(4)
    v_smfmac_f32_16x16x64_bf16 v[40:43], v[16:19], v[56:63], v6
    ds_read_b128 v[56:59], v2 offset:32768
    ds_read_b128 v[60:63], v2 offset:33792
    v_smfmac_f32_16x16x64_bf16 v[44:47], v[16:19], v[64:71], v6
    ds_read_b128 v[64:67], v2 offset:34816
    ds_read_b128 v[68:71], v2 offset:35840
    s_cbranch_vccnz RETRY_37
BACK_38:
    v_smfmac_f32_16x16x64_bf16 v[32:35], v[20:23], v[208:215], v6
    s_waitcnt vmcnt(2)
    v_cmp_eq_u32 vcc, -1, v27
    v_smfmac_f32_16x16x64_bf16 v[36:39], v[20:23], v[216:223], v6
    s_waitcnt lgkmcnt(4)
    v_smfmac_f32_16x16x64_bf16 v[40:43], v[20:23], v[72:79], v6
    ds_read_b128 v[72:75], v1 offset:0
    ds_read_b128 v[76:79], v1 offset:4096
    v_smfmac_f32_16x16x64_bf16 v[44:47], v[20:23], v[80:87], v6
    ds_read_b128 v[80:83], v1 offset:1024
    ds_read_b128 v[84:87], v1 offset:5120
    buffer_load_dwordx4 v[92:95], v1, s[4:7], s29 offen offset:1024
    s_cbranch_vccnz RETRY_39
BACK_40:
    v_smfmac_f32_16x16x64_bf16 v[32:35], v[24:27], v[224:231], v6
    s_waitcnt vmcnt(2)
    v_cmp_eq_u32 vcc, -1, v31
    v_smfmac_f32_16x16x64_bf16 v[36:39], v[24:27], v[232:239], v6
    s_waitcnt lgkmcnt(4)
    v_smfmac_f32_16x16x64_bf16 v[40:43], v[24:27], v[56:63], v6
    ds_read_b128 v[56:59], v1 offset:2048
    ds_read_b128 v[60:63], v1 offset:6144
    v_smfmac_f32_16x16x64_bf16 v[44:47], v[24:27], v[64:71], v6
    ds_read_b128 v[64:67], v1 offset:3072
    ds_read_b128 v[68:71], v1 offset:7168
    s_cbranch_vccnz RETRY_41
BACK_42:
    v_smfmac_f32_16x16x64_bf16 v[32:35], v[28:31], v[240:247], v6
    v_smfmac_f32_16x16x64_bf16 v[36:39], v[28:31], v[248:255], v6
    v_smfmac_f32_16x16x64_bf16 v[40:43], v[28:31], a[240:247], v6
    v_smfmac_f32_16x16x64_bf16 v[44:47], v[28:31], a[248:255], v6
    v_lshlrev_b32 v8, 2, v1
    s_add_u32 s65, s17, s19
    buffer_load_dword v8, s[4:7], s3 offen lds
    buffer_load_dword off, s[4:7], s65 sc1 lds
    buffer_store_dword v6, off, s[4:7], s22 sc1
    s_add_u32 s22, s22, 256
    s_cmp_eq_u32 s59, 0
    s_cbranch_scc1 KVLOOK_43
    s_cmp_eq_u32 s59, 1
    s_cbranch_scc1 KVL1_44
    s_lshl_b32 s64, s13, 13
    s_add_u32 s64, s64, 0x43c0000
    s_lshl_b32 s66, s13, 14
    s_add_u32 s66, s66, 0x3382000
    buffer_load_dwordx4 v[96:99], v1, s[4:7], s64 offen offset:0
    buffer_load_dwordx4 v[100:103], v1, s[4:7], s64 offen offset:1024
    buffer_load_dwordx4 v[104:107], v1, s[4:7], s64 offen offset:2048
    buffer_load_dwordx4 v[108:111], v1, s[4:7], s64 offen offset:3072
    s_add_u32 s64, s64, 0x1000
    buffer_load_dwordx4 v[112:115], v1, s[4:7], s64 offen offset:0
    buffer_load_dwordx4 v[116:119], v1, s[4:7], s64 offen offset:1024
    buffer_load_dwordx4 v[120:123], v1, s[4:7], s64 offen offset:2048
    buffer_load_dwordx4 v[124:127], v1, s[4:7], s64 offen offset:3072
    buffer_load_dwordx4 v[128:131], v1, s[4:7], s66 offen offset:0
    buffer_load_dwordx4 v[132:135], v1, s[4:7], s66 offen offset:1024
    buffer_load_dwordx4 v[136:139], v1, s[4:7], s66 offen offset:2048
    buffer_load_dwordx4 v[140:143], v1, s[4:7], s66 offen offset:3072
    s_add_u32 s66, s66, 0x1000
    buffer_load_dwordx4 v[144:147], v1, s[4:7], s66 offen offset:0
    buffer_load_dwordx4 v[148:151], v1, s[4:7], s66 offen offset:1024
    buffer_load_dwordx4 v[152:155], v1, s[4:7], s66 offen offset:2048
    buffer_load_dwordx4 v[156:159], v1, s[4:7], s66 offen offset:3072
    s_branch KVLOOK_43
KVL1_44:
    v_lshrrev_b32 v9, 5, v1
    v_lshlrev_b32 v9, 9, v9
    v_bfe_u32 v10, v1, 4, 1
    v_lshl_add_u32 v9, v10, 2, v9
    s_mov_b32 m0, 15104
    s_mov_b64 exec, s[34:35]
    buffer_load_dword v9, s[4:7], s69 offen sc1 lds
    s_mov_b64 exec, -1
    s_mov_b32 m0, 16128
KVLOOK_43:
    v_permlane32_swap_b32 v32, v36
    v_permlane32_swap_b32 v33, v37
    v_permlane32_swap_b32 v34, v38
    v_permlane32_swap_b32 v35, v39
    v_pk_add_f32 v[32:33], v[32:33], v[36:37]
    v_pk_add_f32 v[34:35], v[34:35], v[38:39]
    v_cvt_pk_bf16_f32 v36, v32, v33
    v_cvt_pk_bf16_f32 v37, v34, v35
    ds_write_b64 v3, v[36:37] offset:0
    v_permlane32_swap_b32 v40, v44
    v_permlane32_swap_b32 v41, v45
    v_permlane32_swap_b32 v42, v46
    v_permlane32_swap_b32 v43, v47
    v_pk_add_f32 v[40:41], v[40:41], v[44:45]
    v_pk_add_f32 v[42:43], v[42:43], v[46:47]
    v_cvt_pk_bf16_f32 v44, v40, v41
    v_cvt_pk_bf16_f32 v45, v42, v43
    ds_write_b64 v3, v[44:45] offset:2304
    v_smfmac_f32_16x16x64_bf16 v[48:51], v[12:15], a[80:87], v6
    v_smfmac_f32_16x16x64_bf16 v[52:55], v[12:15], a[88:95], v6
    v_smfmac_f32_16x16x64_bf16 v[48:51], v[16:19], a[96:103], v6
    v_smfmac_f32_16x16x64_bf16 v[52:55], v[16:19], a[104:111], v6
    s_waitcnt lgkmcnt(0)
    s_barrier
    ds_read_b64_tr_b16 v[32:33], v4 offset:0
    ds_read_b64_tr_b16 v[34:35], v4 offset:128
    ds_read_b64_tr_b16 v[36:37], v4 offset:256
    ds_read_b64_tr_b16 v[38:39], v4 offset:384
    s_cmp_eq_u32 s15, 63
    s_cbranch_scc1 REC_FINAL
    v_smfmac_f32_16x16x64_bf16 v[48:51], v[20:23], a[112:119], v6
    v_smfmac_f32_16x16x64_bf16 v[52:55], v[20:23], a[120:127], v6
    ds_read_b64_tr_b16 v[40:41], v4 offset:512
    ds_read_b64_tr_b16 v[42:43], v4 offset:640
    ds_read_b64_tr_b16 v[44:45], v4 offset:768
    ds_read_b64_tr_b16 v[46:47], v4 offset:896
    v_smfmac_f32_16x16x64_bf16 v[48:51], v[24:27], a[128:135], v6
    v_smfmac_f32_16x16x64_bf16 v[52:55], v[24:27], a[136:143], v6
    s_waitcnt lgkmcnt(4)
    v_mfma_f32_16x16x32_bf16 v[8:11], v[72:75], v[32:35], 0
    ds_read_b64_tr_b16 v[12:13], v4 offset:2304
    ds_read_b64_tr_b16 v[14:15], v4 offset:2432
    v_mfma_f32_16x16x32_bf16 v[8:11], v[80:83], v[36:39], v[8:11]
    ds_read_b64_tr_b16 v[16:17], v4 offset:2560
    ds_read_b64_tr_b16 v[18:19], v4 offset:2688
    s_waitcnt lgkmcnt(4)
    v_mfma_f32_16x16x32_bf16 v[8:11], v[56:59], v[40:43], v[8:11]
    ds_read_b64_tr_b16 v[56:57], v4 offset:2816
    ds_read_b64_tr_b16 v[58:59], v4 offset:2944
    v_mfma_f32_16x16x32_bf16 v[8:11], v[64:67], v[44:47], v[8:11]
    ds_read_b64_tr_b16 v[64:65], v4 offset:3072
    ds_read_b64_tr_b16 v[66:67], v4 offset:3200
    v_mfma_f32_16x16x32_bf16 v[72:75], v[76:79], v[32:35], 0
    v_mfma_f32_16x16x32_bf16 v[72:75], v[84:87], v[36:39], v[72:75]
    v_mfma_f32_16x16x32_bf16 v[72:75], v[60:63], v[40:43], v[72:75]
    v_mfma_f32_16x16x32_bf16 v[72:75], v[68:71], v[44:47], v[72:75]
    s_waitcnt lgkmcnt(4)
    v_mfma_f32_16x16x32_bf16 v[80:83], v[12:15], v[32:35], 0
    v_mfma_f32_16x16x32_bf16 v[80:83], v[16:19], v[36:39], v[80:83]
    s_waitcnt lgkmcnt(0)
    v_mfma_f32_16x16x32_bf16 v[80:83], v[56:59], v[40:43], v[80:83]
    v_mfma_f32_16x16x32_bf16 v[80:83], v[64:67], v[44:47], v[80:83]
    v_smfmac_f32_16x16x64_bf16 v[48:51], v[28:31], a[144:151], v6
    v_smfmac_f32_16x16x64_bf16 v[52:55], v[28:31], a[152:159], v6
    v_mov_b32 v24, 0x3f803f80
    v_mov_b32 v25, 0x3f803f80
    v_mov_b32 v26, 0x3f803f80
    v_mov_b32 v27, 0x3f803f80
    v_max3_f32 v20, v8, v9, v10
    v_max3_f32 v21, v11, v72, v73
    v_max3_f32 v20, v20, v21, v74
    v_max3_f32 v21, v80, v81, v82
    v_max3_f32 v20, v20, v75, v83
    v_max_f32 v20, v20, v21
    v_mov_b32 v21, v20
    v_cvt_pk_bf16_f32 v48, v48, v49
    v_cvt_pk_bf16_f32 v49, v50, v51
    v_permlane16_swap_b32 v20, v21
    v_max_f32 v20, v20, v21
    v_mov_b32 v21, v20
    v_cvt_pk_bf16_f32 v50, v52, v53
    v_cvt_pk_bf16_f32 v51, v54, v55
    v_permlane32_swap_b32 v20, v21
    v_max_f32 v20, v20, v21
    v_mul_f32 v22, s10, v20
    v_pk_fma_f32 v[8:9], v[8:9], s[10:11], v[22:23] op_sel_hi:[1,1,0] neg_lo:[0,0,1] neg_hi:[0,0,1]
    v_pk_fma_f32 v[10:11], v[10:11], s[10:11], v[22:23] op_sel_hi:[1,1,0] neg_lo:[0,0,1] neg_hi:[0,0,1]
    v_pk_fma_f32 v[72:73], v[72:73], s[10:11], v[22:23] op_sel_hi:[1,1,0] neg_lo:[0,0,1] neg_hi:[0,0,1]
    v_pk_fma_f32 v[74:75], v[74:75], s[10:11], v[22:23] op_sel_hi:[1,1,0] neg_lo:[0,0,1] neg_hi:[0,0,1]
    v_pk_fma_f32 v[80:81], v[80:81], s[10:11], v[22:23] op_sel_hi:[1,1,0] neg_lo:[0,0,1] neg_hi:[0,0,1]
    v_pk_fma_f32 v[82:83], v[82:83], s[10:11], v[22:23] op_sel_hi:[1,1,0] neg_lo:[0,0,1] neg_hi:[0,0,1]
    v_exp_f32 v8, v8
    v_exp_f32 v9, v9
    v_exp_f32 v10, v10
    v_exp_f32 v11, v11
    v_exp_f32 v72, v72
    v_exp_f32 v73, v73
    v_exp_f32 v74, v74
    v_exp_f32 v75, v75
    v_cvt_pk_bf16_f32 v32, v8, v9
    v_cvt_pk_bf16_f32 v33, v10, v11
    v_exp_f32 v80, v80
    v_exp_f32 v81, v81
    v_exp_f32 v82, v82
    v_exp_f32 v83, v83
    v_cvt_pk_bf16_f32 v34, v72, v73
    v_cvt_pk_bf16_f32 v35, v74, v75
    v_cndmask_b32 v12, 0, v24, s[34:35]
    v_cndmask_b32 v13, 0, v24, s[34:35]
    s_waitcnt vmcnt(3)
    v_mfma_f32_16x16x32_bf16 v[8:11], v[24:27], v[32:35], 0
    v_cvt_pk_bf16_f32 v36, v80, v81
    v_mfma_f32_16x16x32_bf16 v[40:43], v[88:91], v[32:35], 0
    v_cvt_pk_bf16_f32 v37, v82, v83
    v_mfma_f32_16x16x32_bf16 v[44:47], v[92:95], v[32:35], 0
    v_mfma_f32_16x16x16_bf16 v[8:11], v[12:13], v[36:37], v[8:11]
    v_mov_b64 v[72:73], 0
    v_mfma_f32_16x16x16_bf16 v[40:43], v[48:49], v[36:37], v[40:43]
    v_mov_b64 v[74:75], 0
    v_mfma_f32_16x16x16_bf16 v[44:47], v[50:51], v[36:37], v[44:47]
    v_mov_b64 v[76:77], 0
    v_mov_b64 v[78:79], 0
    v_mov_b64 v[80:81], 0
    v_mov_b64 v[82:83], 0
    v_rcp_f32 v22, v8
    s_nop 2
    v_cndmask_b32 v40, v44, v40, s[32:33]
    v_cndmask_b32 v41, v45, v41, s[32:33]
    v_cndmask_b32 v42, v46, v42, s[32:33]
    v_cndmask_b32 v43, v47, v43, s[32:33]
    v_pk_mul_f32 v[40:41], v[40:41], v[22:23] op_sel_hi:[1,0]
    v_pk_mul_f32 v[42:43], v[42:43], v[22:23] op_sel_hi:[1,0]
    v_cvt_pk_bf16_f32 v44, v40, v41
    v_cvt_pk_bf16_f32 v45, v42, v43
    ds_write_b64 v5, v[44:45]
    s_mov_b32 m0, s73
    s_add_u32 s28, s28, 0x80000
    buffer_load_dwordx4 v1, s[4:7], s28 offen lds
    buffer_load_dwordx4 v1, s[4:7], s28 offen offset:1024 lds
    v_and_b32 v9, 0x70, v1
    v_bfe_u32 v29, v1, 8, 1
    v_lshl_add_u32 v9, v29, 3, v9
    v_bfe_u32 v29, v1, 9, 1
    v_lshl_add_u32 v9, v29, 2, v9
    v_mov_b32 v29, 0x40000000
    s_waitcnt lgkmcnt(0)
    s_barrier
    ds_read_b128 v[12:15], v0 offset:0
    ds_read_b128 v[16:19], v0 offset:64
    ds_read_b128 v[20:23], v0 offset:128
    ds_read_b128 v[24:27], v0 offset:192
    v_cndmask_b32 v9, v29, v9, s[32:33]
    v_and_b32 v29, 16, v1
    v_lshlrev_b32 v29, v29, s38
    v_cndmask_b32 v88, 0, v29, s[44:45]
    v_cndmask_b32 v89, 0, v29, s[46:47]
    v_cndmask_b32 v90, 0, v29, s[48:49]
    v_cndmask_b32 v91, 0, v29, s[50:51]
    s_waitcnt lgkmcnt(3)
    v_smfmac_f32_16x16x64_bf16 v[72:75], v[12:15], a[160:167], v6
    s_waitcnt lgkmcnt(2)
    v_smfmac_f32_16x16x64_bf16 v[72:75], v[16:19], a[168:175], v6
    s_waitcnt lgkmcnt(1)
    v_smfmac_f32_16x16x64_bf16 v[72:75], v[20:23], a[176:183], v6
    s_waitcnt lgkmcnt(0)
    v_smfmac_f32_16x16x64_bf16 v[72:75], v[24:27], a[184:191], v6
    v_smfmac_f32_16x16x64_bf16 v[76:79], v[12:15], a[192:199], v6
    v_smfmac_f32_16x16x64_bf16 v[76:79], v[16:19], a[200:207], v6
    v_cvt_pk_bf16_f32 v72, v72, v73
    v_smfmac_f32_16x16x64_bf16 v[76:79], v[20:23], a[208:215], v6
    v_cvt_pk_bf16_f32 v73, v74, v75
    v_smfmac_f32_16x16x64_bf16 v[76:79], v[24:27], a[216:223], v6
    v_and_or_b32 v72, v72, -2, s16
    v_mfma_f32_16x16x32_bf16 v[80:83], v[12:15], a[224:227], 0
    buffer_store_dwordx2 v[72:73], v7, s[4:7], s23 offen sc1
    v_mfma_f32_16x16x32_bf16 v[80:83], v[16:19], a[228:231], v[80:83]
    v_mfma_f32_16x16x32_bf16 v[80:83], v[20:23], a[232:235], v[80:83]
    v_cvt_pk_bf16_f32 v76, v76, v77
    v_cvt_pk_bf16_f32 v77, v78, v79
    v_mfma_f32_16x16x32_bf16 v[80:83], v[24:27], a[236:239], v[80:83]
    v_and_or_b32 v76, v76, -2, s16
    buffer_store_dwordx2 v[76:77], v7, s[4:7], s25 offen sc1
    s_add_u32 s17, s17, 0x4000
    s_add_u32 s3, s3, 0x80000
    s_add_u32 s29, s29, 0x80000
    s_add_u32 s18, s18, 0x4000
    s_add_u32 s21, s21, 0x8000
    s_add_u32 s15, s15, 1
    s_nop 0
    v_cvt_pk_bf16_f32 v80, v80, v81
    v_cvt_pk_bf16_f32 v81, v82, v83
    v_and_or_b32 v80, v80, -2, s16
    s_mov_b64 exec, s[34:35]
    buffer_store_dwordx2 v[80:81], v7, s[4:7], s26 offen sc1
    s_mov_b64 exec, -1
    s_cmp_lg_u32 s42, 0
    s_cbranch_scc1 OWN_46
    s_cmp_lt_u32 s14, 2
    s_cbranch_scc1 IDLE_45
    s_branch REC_POLL_S
OWN_46:
    s_nop 15
    s_nop 13
    buffer_load_dwordx4 v[12:15], v1, s[4:7], s24 offen offset:0 sc1
    buffer_load_dwordx4 v[16:19], v1, s[4:7], s24 offen offset:1024 sc1
    buffer_load_dwordx4 v[20:23], v1, s[4:7], s24 offen offset:2048 sc1
    buffer_load_dwordx4 v[24:27], v1, s[4:7], s24 offen offset:3072 sc1
    ds_read_b128 v[56:59], v2 offset:0
    ds_read_b128 v[60:63], v2 offset:1024
    ds_read_b128 v[64:67], v2 offset:2048
    ds_read_b128 v[68:71], v2 offset:3072
    v_mov_b64 v[32:33], 0
    v_mov_b64 v[34:35], 0
    v_mov_b64 v[36:37], 0
    v_mov_b64 v[38:39], 0
    v_mov_b64 v[40:41], 0
    v_mov_b64 v[42:43], 0
    v_mov_b64 v[44:45], 0
    v_mov_b64 v[46:47], 0
    buffer_load_dwordx4 v[72:75], v1, s[4:7], s24 offen offset:0 sc1
    buffer_load_dwordx4 v[76:79], v1, s[4:7], s24 offen offset:1024 sc1
    buffer_load_dwordx4 v[80:83], v1, s[4:7], s24 offen offset:2048 sc1
    buffer_load_dwordx4 v[84:87], v1, s[4:7], s24 offen offset:3072 sc1
    v_mov_b64 v[48:49], 0
    v_mov_b64 v[50:51], 0
    v_mov_b64 v[52:53], 0
    v_mov_b64 v[54:55], 0
OPOLL_48:
    s_waitcnt vmcnt(7)
    v_mfma_f32_16x16x32_bf16 v[92:95], v[12:15], v[88:91], 0
    v_bitop3_b32 v10, v12, v14, s16 bitop3:0x7e
    s_waitcnt vmcnt(6)
    v_mfma_f32_16x16x32_bf16 v[92:95], v[16:19], v[88:91], v[92:95]
    v_bitop3_b32 v11, v16, v18, s16 bitop3:0x7e
    s_waitcnt vmcnt(5)
    v_mfma_f32_16x16x32_bf16 v[92:95], v[20:23], v[88:91], v[92:95]
    v_bitop3_b32 v30, v20, v22, s16 bitop3:0x7e
    s_waitcnt vmcnt(4)
    v_mfma_f32_16x16x32_bf16 v[92:95], v[24:27], v[88:91], v[92:95]
    v_bitop3_b32 v31, v24, v26, s16 bitop3:0x7e
    v_or3_b32 v10, v10, v11, v30
    v_bitop3_b32 v10, v10, v31, 1 bitop3:0xa8
    v_cmp_ne_u32 vcc, 0, v10
    s_nop 3
    s_cbranch_vccz ODONE_47
    s_add_u32 s40, s40, 1
    buffer_load_dwordx4 v[12:15], v1, s[4:7], s24 offen offset:0 sc1
    buffer_load_dwordx4 v[16:19], v1, s[4:7], s24 offen offset:1024 sc1
    buffer_load_dwordx4 v[20:23], v1, s[4:7], s24 offen offset:2048 sc1
    buffer_load_dwordx4 v[24:27], v1, s[4:7], s24 offen offset:3072 sc1
    s_waitcnt vmcnt(7)
    v_mfma_f32_16x16x32_bf16 v[92:95], v[72:75], v[88:91], 0
    v_bitop3_b32 v10, v72, v74, s16 bitop3:0x7e
    s_waitcnt vmcnt(6)
    v_mfma_f32_16x16x32_bf16 v[92:95], v[76:79], v[88:91], v[92:95]
    v_bitop3_b32 v11, v76, v78, s16 bitop3:0x7e
    s_waitcnt vmcnt(5)
    v_mfma_f32_16x16x32_bf16 v[92:95], v[80:83], v[88:91], v[92:95]
    v_bitop3_b32 v30, v80, v82, s16 bitop3:0x7e
    s_waitcnt vmcnt(4)
    v_mfma_f32_16x16x32_bf16 v[92:95], v[84:87], v[88:91], v[92:95]
    v_bitop3_b32 v31, v84, v86, s16 bitop3:0x7e
    v_or3_b32 v10, v10, v11, v30
    v_bitop3_b32 v10, v10, v31, 1 bitop3:0xa8
    v_cmp_ne_u32 vcc, 0, v10
    s_add_u32 s68, s68, 1
    s_cmp_gt_u32 s68, 262144
    s_cbranch_scc1 ODONE_47
    s_nop 0
    s_cbranch_vccz ODONE_47
    s_add_u32 s40, s40, 1
    buffer_load_dwordx4 v[72:75], v1, s[4:7], s24 offen offset:0 sc1
    buffer_load_dwordx4 v[76:79], v1, s[4:7], s24 offen offset:1024 sc1
    buffer_load_dwordx4 v[80:83], v1, s[4:7], s24 offen offset:2048 sc1
    buffer_load_dwordx4 v[84:87], v1, s[4:7], s24 offen offset:3072 sc1
    s_branch OPOLL_48
ODONE_47:
    v_permlane32_swap_b32 v92, v94
    v_permlane32_swap_b32 v93, v95
    v_add_f32 v92, v92, v94
    v_add_f32 v93, v93, v95
    v_cvt_pk_bf16_f32 v8, v92, v93
    buffer_store_dword v8, v9, s[4:7], s18 offen sc1
    s_cmp_eq_u32 s15, 63
    s_cselect_b32 s59, s55, 0
    s_barrier
    s_nop 15
    s_nop 15
    s_nop 12
    buffer_store_dword v8, v9, s[4:7], s21 offen sc1
    s_cmp_lt_u32 s15, 61
    s_cbranch_scc1 EFLG_49
    buffer_store_dword v6, off, s[4:7], s22 sc1
EFLG_49:
    s_xor_b32 s16, s16, 1
    s_waitcnt vmcnt(2) lgkmcnt(0)
    s_branch REC_LOOP_S
IDLE_45:
    s_barrier
    v_mov_b64 v[32:33], 0
    v_mov_b64 v[34:35], 0
    v_mov_b64 v[36:37], 0
    v_mov_b64 v[38:39], 0
    v_mov_b64 v[40:41], 0
    v_mov_b64 v[42:43], 0
    v_mov_b64 v[44:45], 0
    v_mov_b64 v[46:47], 0
    v_mov_b64 v[48:49], 0
    v_mov_b64 v[50:51], 0
    v_mov_b64 v[52:53], 0
    v_mov_b64 v[54:55], 0
    ds_read_b128 v[56:59], v2 offset:0
    ds_read_b128 v[60:63], v2 offset:1024
    ds_read_b128 v[64:67], v2 offset:2048
    ds_read_b128 v[68:71], v2 offset:3072
    s_xor_b32 s16, s16, 1
    s_waitcnt vmcnt(0)
    s_branch REC_LOOP_S
REC_TAIL_S:
RETRY_27:
SPIN_50:
    buffer_load_dwordx4 v[20:23], v1, s[4:7], s17 offen offset:2048 sc1
    buffer_load_dwordx4 v[24:27], v1, s[4:7], s17 offen offset:3072 sc1
    buffer_load_dwordx4 v[28:31], v1, s[4:7], s74 offen offset:0 sc1
    s_add_u32 s68, s68, 1
    s_add_u32 s40, s40, 1024
    s_cmp_gt_u32 s68, 262144
    s_waitcnt vmcnt(0)
    s_cbranch_scc1 BACK_28
    v_cmp_eq_u32 vcc, -1, v23
    s_cbranch_vccnz SPIN_50
    s_branch BACK_28
RETRY_29:
SPIN_51:
    buffer_load_dwordx4 v[24:27], v1, s[4:7], s17 offen offset:3072 sc1
    buffer_load_dwordx4 v[28:31], v1, s[4:7], s74 offen offset:0 sc1
    s_add_u32 s68, s68, 1
    s_add_u32 s40, s40, 1024
    s_cmp_gt_u32 s68, 262144
    s_waitcnt vmcnt(0)
    s_cbranch_scc1 BACK_30
    v_cmp_eq_u32 vcc, -1, v27
    s_cbranch_vccnz SPIN_51
    s_branch BACK_30
RETRY_31:
SPIN_52:
    buffer_load_dwordx4 v[28:31], v1, s[4:7], s74 offen offset:0 sc1
    s_add_u32 s68, s68, 1
    s_add_u32 s40, s40, 1024
    s_cmp_gt_u32 s68, 262144
    s_waitcnt vmcnt(0)
    s_cbranch_scc1 BACK_32
    v_cmp_eq_u32 vcc, -1, v31
    s_cbranch_vccnz SPIN_52
    s_branch BACK_32
RETRY_33:
SPIN_53:
    buffer_load_dwordx4 v[12:15], v1, s[4:7], s20 offen offset:0 sc1
    buffer_load_dwordx4 v[16:19], v1, s[4:7], s20 offen offset:1024 sc1
    buffer_load_dwordx4 v[20:23], v1, s[4:7], s20 offen offset:2048 sc1
    buffer_load_dwordx4 v[24:27], v1, s[4:7], s20 offen offset:3072 sc1
    s_add_u32 s68, s68, 1
    s_add_u32 s40, s40, 1048576
    s_cmp_gt_u32 s68, 262144
    s_waitcnt vmcnt(0)
    s_cbranch_scc1 BACK_34
    v_cmp_eq_u32 vcc, -1, v15
    s_cbranch_vccnz SPIN_53
    s_branch BACK_34
RETRY_35:
SPIN_54:
    buffer_load_dwordx4 v[16:19], v1, s[4:7], s20 offen offset:1024 sc1
    buffer_load_dwordx4 v[20:23], v1, s[4:7], s20 offen offset:2048 sc1
    buffer_load_dwordx4 v[24:27], v1, s[4:7], s20 offen offset:3072 sc1
    buffer_load_dwordx4 v[28:31], v1, s[4:7], s75 offen offset:0 sc1
    s_add_u32 s68, s68, 1
    s_add_u32 s40, s40, 1048576
    s_cmp_gt_u32 s68, 262144
    s_waitcnt vmcnt(0)
    s_cbranch_scc1 BACK_36
    v_cmp_eq_u32 vcc, -1, v19
    s_cbranch_vccnz SPIN_54
    s_branch BACK_36
RETRY_37:
SPIN_55:
    buffer_load_dwordx4 v[20:23], v1, s[4:7], s20 offen offset:2048 sc1
    buffer_load_dwordx4 v[24:27], v1, s[4:7], s20 offen offset:3072 sc1
    buffer_load_dwordx4 v[28:31], v1, s[4:7], s75 offen offset:0 sc1
    s_add_u32 s68, s68, 1
    s_add_u32 s40, s40, 1048576
    s_cmp_gt_u32 s68, 262144
    s_waitcnt vmcnt(0)
    s_cbranch_scc1 BACK_38
    v_cmp_eq_u32 vcc, -1, v23
    s_cbranch_vccnz SPIN_55
    s_branch BACK_38
RETRY_39:
SPIN_56:
    buffer_load_dwordx4 v[24:27], v1, s[4:7], s20 offen offset:3072 sc1
    buffer_load_dwordx4 v[28:31], v1, s[4:7], s75 offen offset:0 sc1
    s_add_u32 s68, s68, 1
    s_add_u32 s40, s40, 1048576
    s_cmp_gt_u32 s68, 262144
    s_waitcnt vmcnt(0)
    s_cbranch_scc1 BACK_40
    v_cmp_eq_u32 vcc, -1, v27
    s_cbranch_vccnz SPIN_56
    s_branch BACK_40
RETRY_41:
SPIN_57:
    buffer_load_dwordx4 v[28:31], v1, s[4:7], s75 offen offset:0 sc1
    s_add_u32 s68, s68, 1
    s_add_u32 s40, s40, 1048576
    s_cmp_gt_u32 s68, 262144
    s_waitcnt vmcnt(0)
    s_cbranch_scc1 BACK_42
    v_cmp_eq_u32 vcc, -1, v31
    s_cbranch_vccnz SPIN_57
    s_branch BACK_42
REC_POLL:
    s_cmp_eq_u32 s59, 0
    s_cbranch_scc1 NOFLG_58
    s_waitcnt vmcnt(0)
    v_lshrrev_b32 v29, 2, v1
    ds_read_b32 v12, v29 offset:15104
    s_add_u32 s64, s15, 2
    s_lshr_b32 s65, s64, 1
    s_add_u32 s67, s65, 1
    s_waitcnt lgkmcnt(0)
    v_cmp_ne_u32 vcc, 0, v12
    v_readlane_b32 s65, v12, s65
    v_readlane_b32 s67, v12, s67
    s_cmp_eq_u32 vcc_lo, -1
    s_cselect_b32 s58, 1, 0
    s_and_b32 s65, s65, s67
    s_cbranch_scc1 NOFLG_58
    s_lshl_b32 s64, s64, 7
    s_add_u32 s64, s64, s69
    v_mov_b32 v29, 0
FSPIN_60:
    buffer_load_dwordx2 v[12:13], v29, s[4:7], s64 offen sc1
    s_add_u32 s68, s68, 1
    s_waitcnt vmcnt(0)
    v_and_b32 v12, v12, v13
    v_cmp_eq_u32 vcc, 0, v12
    s_cbranch_vccz FDONE_61
    s_cmp_gt_u32 s68, 262144
    s_cbranch_scc0 FSPIN_60
FDONE_61:
NOFLG_58:
    s_add_u32 s64, s15, 3
    s_and_b32 s64, s64, 0x43
    s_or_b32 s64, s64, s58
    s_cmp_eq_u32 s64, 0
    s_cselect_b32 s59, 1, 0
    s_add_u32 s66, s17, s52
    v_add_u32 v10, s52, v1
    s_xor_b32 s16, s16, 1
    v_mov_b64 v[32:33], 0
    v_mov_b64 v[34:35], 0
    v_mov_b64 v[36:37], 0
    v_mov_b64 v[38:39], 0
    v_mov_b64 v[40:41], 0
    v_mov_b64 v[42:43], 0
    v_mov_b64 v[44:45], 0
    v_mov_b64 v[46:47], 0
    v_mov_b64 v[48:49], 0
    v_mov_b64 v[50:51], 0
    v_mov_b64 v[52:53], 0
    v_mov_b64 v[54:55], 0
    ds_read_b128 v[56:59], v2 offset:0
    ds_read_b128 v[60:63], v2 offset:1024
    ds_read_b128 v[64:67], v2 offset:2048
    ds_read_b128 v[68:71], v2 offset:3072
    s_barrier
    s_nop 14
    buffer_load_dwordx4 v[20:23], v1, s[4:7], s66 offen offset:0 sc1
    s_nop 7
    buffer_load_dwordx4 v[24:27], v1, s[4:7], s66 offen offset:0 sc1
    s_nop 7
    buffer_load_dwordx4 v[28:31], v1, s[4:7], s66 offen offset:0 sc1
IPOLL_63:
    s_waitcnt vmcnt(2)
    ds_write_b128 v10, v[20:23] offset:12800
    v_max3_u32 v11, v20, v21, v22
    v_max_u32 v11, v11, v23
    v_cmp_eq_u32 vcc, -1, v11
    s_cbranch_vccz IOK_62
    buffer_load_dwordx4 v[20:23], v1, s[4:7], s66 offen offset:0 sc1
    s_waitcnt vmcnt(2)
    ds_write_b128 v10, v[24:27] offset:12800
    v_max3_u32 v11, v24, v25, v26
    v_max_u32 v11, v11, v27
    v_cmp_eq_u32 vcc, -1, v11
    s_cbranch_vccz IOK_62
    buffer_load_dwordx4 v[24:27], v1, s[4:7], s66 offen offset:0 sc1
    s_waitcnt vmcnt(2)
    ds_write_b128 v10, v[28:31] offset:12800
    v_max3_u32 v11, v28, v29, v30
    v_max_u32 v11, v11, v31
    v_cmp_eq_u32 vcc, -1, v11
    s_add_u32 s68, s68, 1
    s_add_u32 s53, s53, 1
    s_cmp_gt_u32 s68, 262144
    s_cbranch_scc1 IOK_62
    s_cbranch_vccz IOK_62
    buffer_load_dwordx4 v[28:31], v1, s[4:7], s66 offen offset:0 sc1
    s_branch IPOLL_63
IOK_62:
    s_waitcnt lgkmcnt(0)
REC_LOOP:
    s_barrier
    ds_read_b128 v[12:15], v1 offset:12800
    ds_read_b128 v[16:19], v1 offset:13824
    buffer_load_dwordx4 v[20:23], v1, s[4:7], s17 offen offset:2048
    ds_read_b128 v[72:75], v2 offset:4096
    ds_read_b128 v[76:79], v2 offset:5120
    ds_read_b128 v[80:83], v2 offset:6144
    ds_read_b128 v[84:87], v2 offset:7168
    s_add_u32 s74, s17, 0x1000
    s_add_u32 s20, s20, 0x8000
    s_add_u32 s75, s20, 0x1000
    s_mov_b32 m0, 16128
    s_add_u32 s65, s20, s27
    s_waitcnt lgkmcnt(5)
    v_smfmac_f32_16x16x64_bf16 v[32:35], v[12:15], v[96:103], v6
    buffer_load_dwordx4 v[24:27], v1, s[4:7], s17 offen offset:3072
    v_smfmac_f32_16x16x64_bf16 v[36:39], v[12:15], v[104:111], v6
    v_smfmac_f32_16x16x64_bf16 v[40:43], v[12:15], v[56:63], v6
    buffer_load_dwordx4 v[28:31], v1, s[4:7], s74 offen offset:0
    ds_read_b128 v[56:59], v2 offset:8192
    ds_read_b128 v[60:63], v2 offset:9216
    v_smfmac_f32_16x16x64_bf16 v[44:47], v[12:15], v[64:71], v6
    ds_read_b128 v[64:67], v2 offset:10240
    ds_read_b128 v[68:71], v2 offset:11264
    s_waitcnt lgkmcnt(8)
    v_smfmac_f32_16x16x64_bf16 v[48:51], v[12:15], a[0:7], v6
    v_smfmac_f32_16x16x64_bf16 v[52:55], v[12:15], a[8:15], v6
    buffer_load_dwordx4 v[12:15], v1, s[4:7], s20 offen offset:0
    buffer_load_dword off, s[4:7], s65 lds
    v_smfmac_f32_16x16x64_bf16 v[32:35], v[16:19], v[112:119], v6
    v_smfmac_f32_16x16x64_bf16 v[36:39], v[16:19], v[120:127], v6
    s_waitcnt lgkmcnt(4)
    v_smfmac_f32_16x16x64_bf16 v[40:43], v[16:19], v[72:79], v6
    ds_read_b128 v[72:75], v2 offset:12288
    ds_read_b128 v[76:79], v2 offset:13312
    v_smfmac_f32_16x16x64_bf16 v[44:47], v[16:19], v[80:87], v6
    ds_read_b128 v[80:83], v2 offset:14336
    ds_read_b128 v[84:87], v2 offset:15360
    s_waitcnt vmcnt(4)
    v_cmp_eq_u32 vcc, -1, v23
    v_smfmac_f32_16x16x64_bf16 v[48:51], v[16:19], a[16:23], v6
    v_smfmac_f32_16x16x64_bf16 v[52:55], v[16:19], a[24:31], v6
    s_cbranch_vccnz RETRY_64
BACK_65:
    buffer_load_dwordx4 v[16:19], v1, s[4:7], s20 offen offset:1024
    v_smfmac_f32_16x16x64_bf16 v[32:35], v[20:23], v[128:135], v6
    v_smfmac_f32_16x16x64_bf16 v[36:39], v[20:23], v[136:143], v6
    s_waitcnt lgkmcnt(4)
    v_smfmac_f32_16x16x64_bf16 v[40:43], v[20:23], v[56:63], v6
    ds_read_b128 v[56:59], v2 offset:16384
    ds_read_b128 v[60:63], v2 offset:17408
    v_smfmac_f32_16x16x64_bf16 v[44:47], v[20:23], v[64:71], v6
    ds_read_b128 v[64:67], v2 offset:18432
    ds_read_b128 v[68:71], v2 offset:19456
    s_waitcnt vmcnt(4)
    v_cmp_eq_u32 vcc, -1, v27
    v_smfmac_f32_16x16x64_bf16 v[48:51], v[20:23], a[32:39], v6
    v_smfmac_f32_16x16x64_bf16 v[52:55], v[20:23], a[40:47], v6
    s_cbranch_vccnz RETRY_66
BACK_67:
    buffer_load_dwordx4 v[20:23], v1, s[4:7], s20 offen offset:2048
    v_smfmac_f32_16x16x64_bf16 v[32:35], v[24:27], v[144:151], v6
    v_smfmac_f32_16x16x64_bf16 v[36:39], v[24:27], v[152:159], v6
    s_waitcnt lgkmcnt(4)
    v_smfmac_f32_16x16x64_bf16 v[40:43], v[24:27], v[72:79], v6
    ds_read_b128 v[72:75], v2 offset:20480
    ds_read_b128 v[76:79], v2 offset:21504
    v_smfmac_f32_16x16x64_bf16 v[44:47], v[24:27], v[80:87], v6
    ds_read_b128 v[80:83], v2 offset:22528
    ds_read_b128 v[84:87], v2 offset:23552
    s_waitcnt vmcnt(4)
    v_cmp_eq_u32 vcc, -1, v31
    v_smfmac_f32_16x16x64_bf16 v[48:51], v[24:27], a[48:55], v6
    v_smfmac_f32_16x16x64_bf16 v[52:55], v[24:27], a[56:63], v6
    s_cbranch_vccnz RETRY_68
BACK_69:
    buffer_load_dwordx4 v[24:27], v1, s[4:7], s20 offen offset:3072
    v_smfmac_f32_16x16x64_bf16 v[32:35], v[28:31], v[160:167], v6
    v_smfmac_f32_16x16x64_bf16 v[36:39], v[28:31], v[168:175], v6
    s_waitcnt lgkmcnt(4)
    v_smfmac_f32_16x16x64_bf16 v[40:43], v[28:31], v[56:63], v6
    ds_read_b128 v[56:59], v2 offset:24576
    ds_read_b128 v[60:63], v2 offset:25600
    v_smfmac_f32_16x16x64_bf16 v[44:47], v[28:31], v[64:71], v6
    ds_read_b128 v[64:67], v2 offset:26624
    ds_read_b128 v[68:71], v2 offset:27648
    s_waitcnt vmcnt(4)
    v_cmp_eq_u32 vcc, -1, v15
    v_smfmac_f32_16x16x64_bf16 v[48:51], v[28:31], a[64:71], v6
    v_smfmac_f32_16x16x64_bf16 v[52:55], v[28:31], a[72:79], v6
    s_cbranch_vccnz RETRY_70
BACK_71:
    buffer_load_dwordx4 v[28:31], v1, s[4:7], s75 offen offset:0
    v_smfmac_f32_16x16x64_bf16 v[32:35], v[12:15], v[176:183], v6
    s_waitcnt vmcnt(3)
    v_cmp_eq_u32 vcc, -1, v19
    v_smfmac_f32_16x16x64_bf16 v[36:39], v[12:15], v[184:191], v6
    s_waitcnt lgkmcnt(4)
    v_smfmac_f32_16x16x64_bf16 v[40:43], v[12:15], v[72:79], v6
    ds_read_b128 v[72:75], v2 offset:28672
    ds_read_b128 v[76:79], v2 offset:29696
    v_smfmac_f32_16x16x64_bf16 v[44:47], v[12:15], v[80:87], v6
    ds_read_b128 v[80:83], v2 offset:30720
    ds_read_b128 v[84:87], v2 offset:31744
    buffer_load_dwordx4 v[88:91], v1, s[4:7], s29 offen offset:0
    s_cbranch_vccnz RETRY_72
BACK_73:
    v_smfmac_f32_16x16x64_bf16 v[32:35], v[16:19], v[192:199], v6
    s_waitcnt vmcnt(3)
    v_cmp_eq_u32 vcc, -1, v23
    v_smfmac_f32_16x16x64_bf16 v[36:39], v[16:19], v[200:207], v6
    s_waitcnt lgkmcnt(4)
    v_smfmac_f32_16x16x64_bf16 v[40:43], v[16:19], v[56:63], v6
    ds_read_b128 v[56:59], v2 offset:32768
    ds_read_b128 v[60:63], v2 offset:33792
    v_smfmac_f32_16x16x64_bf16 v[44:47], v[16:19], v[64:71], v6
    ds_read_b128 v[64:67], v2 offset:34816
    ds_read_b128 v[68:71], v2 offset:35840
    s_cbranch_vccnz RETRY_74
BACK_75:
    v_smfmac_f32_16x16x64_bf16 v[32:35], v[20:23], v[208:215], v6
    s_waitcnt vmcnt(2)
    v_cmp_eq_u32 vcc, -1, v27
    v_smfmac_f32_16x16x64_bf16 v[36:39], v[20:23], v[216:223], v6
    s_waitcnt lgkmcnt(4)
    v_smfmac_f32_16x16x64_bf16 v[40:43], v[20:23], v[72:79], v6
    ds_read_b128 v[72:75], v1 offset:0
    ds_read_b128 v[76:79], v1 offset:4096
    v_smfmac_f32_16x16x64_bf16 v[44:47], v[20:23], v[80:87], v6
    ds_read_b128 v[80:83], v1 offset:1024
    ds_read_b128 v[84:87], v1 offset:5120
    buffer_load_dwordx4 v[92:95], v1, s[4:7], s29 offen offset:1024
    s_cbranch_vccnz RETRY_76
BACK_77:
    v_smfmac_f32_16x16x64_bf16 v[32:35], v[24:27], v[224:231], v6
    s_waitcnt vmcnt(2)
    v_cmp_eq_u32 vcc, -1, v31
    v_smfmac_f32_16x16x64_bf16 v[36:39], v[24:27], v[232:239], v6
    s_waitcnt lgkmcnt(4)
    v_smfmac_f32_16x16x64_bf16 v[40:43], v[24:27], v[56:63], v6
    ds_read_b128 v[56:59], v1 offset:2048
    ds_read_b128 v[60:63], v1 offset:6144
    v_smfmac_f32_16x16x64_bf16 v[44:47], v[24:27], v[64:71], v6
    ds_read_b128 v[64:67], v1 offset:3072
    ds_read_b128 v[68:71], v1 offset:7168
    s_cbranch_vccnz RETRY_78
BACK_79:
    v_smfmac_f32_16x16x64_bf16 v[32:35], v[28:31], v[240:247], v6
    v_smfmac_f32_16x16x64_bf16 v[36:39], v[28:31], v[248:255], v6
    v_smfmac_f32_16x16x64_bf16 v[40:43], v[28:31], a[240:247], v6
    v_smfmac_f32_16x16x64_bf16 v[44:47], v[28:31], a[248:255], v6
    v_lshlrev_b32 v8, 2, v1
    s_add_u32 s65, s17, s19
    buffer_load_dword v8, s[4:7], s3 offen lds
    buffer_load_dword off, s[4:7], s65 sc1 lds
    buffer_store_dword v6, off, s[4:7], s22 sc1
    s_add_u32 s22, s22, 256
    s_cmp_eq_u32 s59, 0
    s_cbranch_scc1 KVLOOK_80
    s_cmp_eq_u32 s59, 1
    s_cbranch_scc1 KVL1_81
    s_lshl_b32 s64, s13, 13
    s_add_u32 s64, s64, 0x43c0000
    s_lshl_b32 s66, s13, 14
    s_add_u32 s66, s66, 0x3382000
    buffer_load_dwordx4 v[96:99], v1, s[4:7], s64 offen offset:0
    buffer_load_dwordx4 v[100:103], v1, s[4:7], s64 offen offset:1024
    buffer_load_dwordx4 v[104:107], v1, s[4:7], s64 offen offset:2048
    buffer_load_dwordx4 v[108:111], v1, s[4:7], s64 offen offset:3072
    s_add_u32 s64, s64, 0x1000
    buffer_load_dwordx4 v[112:115], v1, s[4:7], s64 offen offset:0
    buffer_load_dwordx4 v[116:119], v1, s[4:7], s64 offen offset:1024
    buffer_load_dwordx4 v[120:123], v1, s[4:7], s64 offen offset:2048
    buffer_load_dwordx4 v[124:127], v1, s[4:7], s64 offen offset:3072
    buffer_load_dwordx4 v[128:131], v1, s[4:7], s66 offen offset:0
    buffer_load_dwordx4 v[132:135], v1, s[4:7], s66 offen offset:1024
    buffer_load_dwordx4 v[136:139], v1, s[4:7], s66 offen offset:2048
    buffer_load_dwordx4 v[140:143], v1, s[4:7], s66 offen offset:3072
    s_add_u32 s66, s66, 0x1000
    buffer_load_dwordx4 v[144:147], v1, s[4:7], s66 offen offset:0
    buffer_load_dwordx4 v[148:151], v1, s[4:7], s66 offen offset:1024
    buffer_load_dwordx4 v[152:155], v1, s[4:7], s66 offen offset:2048
    buffer_load_dwordx4 v[156:159], v1, s[4:7], s66 offen offset:3072
    s_branch KVLOOK_80
KVL1_81:
    v_lshrrev_b32 v9, 5, v1
    v_lshlrev_b32 v9, 9, v9
    v_bfe_u32 v10, v1, 4, 1
    v_lshl_add_u32 v9, v10, 2, v9
    s_mov_b32 m0, 15104
    s_mov_b64 exec, s[34:35]
    buffer_load_dword v9, s[4:7], s69 offen sc1 lds
    s_mov_b64 exec, -1
    s_mov_b32 m0, 16128
KVLOOK_80:
    v_permlane32_swap_b32 v32, v36
    v_permlane32_swap_b32 v33, v37
    v_permlane32_swap_b32 v34, v38
    v_permlane32_swap_b32 v35, v39
    v_pk_add_f32 v[32:33], v[32:33], v[36:37]
    v_pk_add_f32 v[34:35], v[34:35], v[38:39]
    v_cvt_pk_bf16_f32 v36, v32, v33
    v_cvt_pk_bf16_f32 v37, v34, v35
    ds_write_b64 v3, v[36:37] offset:0
    v_permlane32_swap_b32 v40, v44
    v_permlane32_swap_b32 v41, v45
    v_permlane32_swap_b32 v42, v46
    v_permlane32_swap_b32 v43, v47
    v_pk_add_f32 v[40:41], v[40:41], v[44:45]
    v_pk_add_f32 v[42:43], v[42:43], v[46:47]
    v_cvt_pk_bf16_f32 v44, v40, v41
    v_cvt_pk_bf16_f32 v45, v42, v43
    ds_write_b64 v3, v[44:45] offset:2304
    v_smfmac_f32_16x16x64_bf16 v[48:51], v[12:15], a[80:87], v6
    v_smfmac_f32_16x16x64_bf16 v[52:55], v[12:15], a[88:95], v6
    v_smfmac_f32_16x16x64_bf16 v[48:51], v[16:19], a[96:103], v6
    v_smfmac_f32_16x16x64_bf16 v[52:55], v[16:19], a[104:111], v6
    s_waitcnt lgkmcnt(0)
    s_barrier
    ds_read_b64_tr_b16 v[32:33], v4 offset:0
    ds_read_b64_tr_b16 v[34:35], v4 offset:128
    ds_read_b64_tr_b16 v[36:37], v4 offset:256
    ds_read_b64_tr_b16 v[38:39], v4 offset:384
    s_cmp_eq_u32 s15, 63
    s_cbranch_scc1 REC_FINAL
    v_smfmac_f32_16x16x64_bf16 v[48:51], v[20:23], a[112:119], v6
    v_smfmac_f32_16x16x64_bf16 v[52:55], v[20:23], a[120:127], v6
    ds_read_b64_tr_b16 v[40:41], v4 offset:512
    ds_read_b64_tr_b16 v[42:43], v4 offset:640
    ds_read_b64_tr_b16 v[44:45], v4 offset:768
    ds_read_b64_tr_b16 v[46:47], v4 offset:896
    v_smfmac_f32_16x16x64_bf16 v[48:51], v[24:27], a[128:135], v6
    v_smfmac_f32_16x16x64_bf16 v[52:55], v[24:27], a[136:143], v6
    s_waitcnt lgkmcnt(4)
    v_mfma_f32_16x16x32_bf16 v[8:11], v[72:75], v[32:35], 0
    ds_read_b64_tr_b16 v[12:13], v4 offset:2304
    ds_read_b64_tr_b16 v[14:15], v4 offset:2432
    v_mfma_f32_16x16x32_bf16 v[8:11], v[80:83], v[36:39], v[8:11]
    ds_read_b64_tr_b16 v[16:17], v4 offset:2560
    ds_read_b64_tr_b16 v[18:19], v4 offset:2688
    s_waitcnt lgkmcnt(4)
    v_mfma_f32_16x16x32_bf16 v[8:11], v[56:59], v[40:43], v[8:11]
    ds_read_b64_tr_b16 v[56:57], v4 offset:2816
    ds_read_b64_tr_b16 v[58:59], v4 offset:2944
    v_mfma_f32_16x16x32_bf16 v[8:11], v[64:67], v[44:47], v[8:11]
    ds_read_b64_tr_b16 v[64:65], v4 offset:3072
    ds_read_b64_tr_b16 v[66:67], v4 offset:3200
    v_mfma_f32_16x16x32_bf16 v[72:75], v[76:79], v[32:35], 0
    v_mfma_f32_16x16x32_bf16 v[72:75], v[84:87], v[36:39], v[72:75]
    v_mfma_f32_16x16x32_bf16 v[72:75], v[60:63], v[40:43], v[72:75]
    v_mfma_f32_16x16x32_bf16 v[72:75], v[68:71], v[44:47], v[72:75]
    s_waitcnt lgkmcnt(4)
    v_mfma_f32_16x16x32_bf16 v[80:83], v[12:15], v[32:35], 0
    v_mfma_f32_16x16x32_bf16 v[80:83], v[16:19], v[36:39], v[80:83]
    s_waitcnt lgkmcnt(0)
    v_mfma_f32_16x16x32_bf16 v[80:83], v[56:59], v[40:43], v[80:83]
    v_mfma_f32_16x16x32_bf16 v[80:83], v[64:67], v[44:47], v[80:83]
    v_smfmac_f32_16x16x64_bf16 v[48:51], v[28:31], a[144:151], v6
    v_smfmac_f32_16x16x64_bf16 v[52:55], v[28:31], a[152:159], v6
    v_mov_b32 v24, 0x3f803f80
    v_mov_b32 v25, 0x3f803f80
    v_mov_b32 v26, 0x3f803f80
    v_mov_b32 v27, 0x3f803f80
    v_max3_f32 v20, v8, v9, v10
    v_max3_f32 v21, v11, v72, v73
    v_max3_f32 v20, v20, v21, v74
    v_max3_f32 v21, v80, v81, v82
    v_max3_f32 v20, v20, v75, v83
    v_max_f32 v20, v20, v21
    v_mov_b32 v21, v20
    v_cvt_pk_bf16_f32 v48, v48, v49
    v_cvt_pk_bf16_f32 v49, v50, v51
    v_permlane16_swap_b32 v20, v21
    v_max_f32 v20, v20, v21
    v_mov_b32 v21, v20
    v_cvt_pk_bf16_f32 v50, v52, v53
    v_cvt_pk_bf16_f32 v51, v54, v55
    v_permlane32_swap_b32 v20, v21
    v_max_f32 v20, v20, v21
    v_mul_f32 v22, s10, v20
    v_pk_fma_f32 v[8:9], v[8:9], s[10:11], v[22:23] op_sel_hi:[1,1,0] neg_lo:[0,0,1] neg_hi:[0,0,1]
    v_pk_fma_f32 v[10:11], v[10:11], s[10:11], v[22:23] op_sel_hi:[1,1,0] neg_lo:[0,0,1] neg_hi:[0,0,1]
    v_pk_fma_f32 v[72:73], v[72:73], s[10:11], v[22:23] op_sel_hi:[1,1,0] neg_lo:[0,0,1] neg_hi:[0,0,1]
    v_pk_fma_f32 v[74:75], v[74:75], s[10:11], v[22:23] op_sel_hi:[1,1,0] neg_lo:[0,0,1] neg_hi:[0,0,1]
    v_pk_fma_f32 v[80:81], v[80:81], s[10:11], v[22:23] op_sel_hi:[1,1,0] neg_lo:[0,0,1] neg_hi:[0,0,1]
    v_pk_fma_f32 v[82:83], v[82:83], s[10:11], v[22:23] op_sel_hi:[1,1,0] neg_lo:[0,0,1] neg_hi:[0,0,1]
    v_exp_f32 v8, v8
    v_exp_f32 v9, v9
    v_exp_f32 v10, v10
    v_exp_f32 v11, v11
    v_exp_f32 v72, v72
    v_exp_f32 v73, v73
    v_exp_f32 v74, v74
    v_exp_f32 v75, v75
    v_cvt_pk_bf16_f32 v32, v8, v9
    v_cvt_pk_bf16_f32 v33, v10, v11
    v_exp_f32 v80, v80
    v_exp_f32 v81, v81
    v_exp_f32 v82, v82
    v_exp_f32 v83, v83
    v_cvt_pk_bf16_f32 v34, v72, v73
    v_cvt_pk_bf16_f32 v35, v74, v75
    v_cndmask_b32 v12, 0, v24, s[34:35]
    v_cndmask_b32 v13, 0, v24, s[34:35]
    s_waitcnt vmcnt(3)
    v_mfma_f32_16x16x32_bf16 v[8:11], v[24:27], v[32:35], 0
    v_cvt_pk_bf16_f32 v36, v80, v81
    v_mfma_f32_16x16x32_bf16 v[40:43], v[88:91], v[32:35], 0
    v_cvt_pk_bf16_f32 v37, v82, v83
    v_mfma_f32_16x16x32_bf16 v[44:47], v[92:95], v[32:35], 0
    v_mfma_f32_16x16x16_bf16 v[8:11], v[12:13], v[36:37], v[8:11]
    v_mov_b64 v[72:73], 0
    v_mfma_f32_16x16x16_bf16 v[40:43], v[48:49], v[36:37], v[40:43]
    v_mov_b64 v[74:75], 0
    v_mfma_f32_16x16x16_bf16 v[44:47], v[50:51], v[36:37], v[44:47]
    v_mov_b64 v[76:77], 0
    v_mov_b64 v[78:79], 0
    v_mov_b64 v[80:81], 0
    v_mov_b64 v[82:83], 0
    v_rcp_f32 v22, v8
    s_nop 2
    v_cndmask_b32 v40, v44, v40, s[32:33]
    v_cndmask_b32 v41, v45, v41, s[32:33]
    v_cndmask_b32 v42, v46, v42, s[32:33]
    v_cndmask_b32 v43, v47, v43, s[32:33]
    v_pk_mul_f32 v[40:41], v[40:41], v[22:23] op_sel_hi:[1,0]
    v_pk_mul_f32 v[42:43], v[42:43], v[22:23] op_sel_hi:[1,0]
    v_cvt_pk_bf16_f32 v44, v40, v41
    v_cvt_pk_bf16_f32 v45, v42, v43
    ds_write_b64 v5, v[44:45]
    s_mov_b32 m0, s73
    s_add_u32 s28, s28, 0x80000
    buffer_load_dwordx4 v1, s[4:7], s28 offen lds
    buffer_load_dwordx4 v1, s[4:7], s28 offen offset:1024 lds
    v_and_b32 v9, 0x70, v1
    v_bfe_u32 v29, v1, 8, 1
    v_lshl_add_u32 v9, v29, 3, v9
    v_bfe_u32 v29, v1, 9, 1
    v_lshl_add_u32 v9, v29, 2, v9
    v_mov_b32 v29, 0x40000000
    s_waitcnt lgkmcnt(0)
    s_barrier
    ds_read_b128 v[12:15], v0 offset:0
    ds_read_b128 v[16:19], v0 offset:64
    ds_read_b128 v[20:23], v0 offset:128
    ds_read_b128 v[24:27], v0 offset:192
    v_cndmask_b32 v9, v29, v9, s[32:33]
    v_and_b32 v29, 16, v1
    v_lshlrev_b32 v29, v29, s38
    v_cndmask_b32 v88, 0, v29, s[44:45]
    v_cndmask_b32 v89, 0, v29, s[46:47]
    v_cndmask_b32 v90, 0, v29, s[48:49]
    v_cndmask_b32 v91, 0, v29, s[50:51]
    s_waitcnt lgkmcnt(3)
    v_smfmac_f32_16x16x64_bf16 v[72:75], v[12:15], a[160:167], v6
    s_waitcnt lgkmcnt(2)
    v_smfmac_f32_16x16x64_bf16 v[72:75], v[16:19], a[168:175], v6
    s_waitcnt lgkmcnt(1)
    v_smfmac_f32_16x16x64_bf16 v[72:75], v[20:23], a[176:183], v6
    s_waitcnt lgkmcnt(0)
    v_smfmac_f32_16x16x64_bf16 v[72:75], v[24:27], a[184:191], v6
    v_smfmac_f32_16x16x64_bf16 v[76:79], v[12:15], a[192:199], v6
    v_smfmac_f32_16x16x64_bf16 v[76:79], v[16:19], a[200:207], v6
    v_cvt_pk_bf16_f32 v72, v72, v73
    v_smfmac_f32_16x16x64_bf16 v[76:79], v[20:23], a[208:215], v6
    v_cvt_pk_bf16_f32 v73, v74, v75
    v_smfmac_f32_16x16x64_bf16 v[76:79], v[24:27], a[216:223], v6
    v_and_or_b32 v72, v72, -2, s16
    v_mfma_f32_16x16x32_bf16 v[80:83], v[12:15], a[224:227], 0
    buffer_store_dwordx2 v[72:73], v7, s[4:7], s23 offen
    v_mfma_f32_16x16x32_bf16 v[80:83], v[16:19], a[228:231], v[80:83]
    v_mfma_f32_16x16x32_bf16 v[80:83], v[20:23], a[232:235], v[80:83]
    v_cvt_pk_bf16_f32 v76, v76, v77
    v_cvt_pk_bf16_f32 v77, v78, v79
    v_mfma_f32_16x16x32_bf16 v[80:83], v[24:27], a[236:239], v[80:83]
    v_and_or_b32 v76, v76, -2, s16
    buffer_store_dwordx2 v[76:77], v7, s[4:7], s25 offen
    s_add_u32 s17, s17, 0x4000
    s_add_u32 s3, s3, 0x80000
    s_add_u32 s29, s29, 0x80000
    s_add_u32 s18, s18, 0x4000
    s_add_u32 s21, s21, 0x8000
    s_add_u32 s15, s15, 1
    s_nop 0
    v_cvt_pk_bf16_f32 v80, v80, v81
    v_cvt_pk_bf16_f32 v81, v82, v83
    v_and_or_b32 v80, v80, -2, s16
    s_mov_b64 exec, s[34:35]
    buffer_store_dwordx2 v[80:81], v7, s[4:7], s26 offen
    s_mov_b64 exec, -1
    s_cmp_lg_u32 s42, 0
    s_cbranch_scc1 OWN_83
    s_cmp_lt_u32 s14, 2
    s_cbranch_scc1 IDLE_82
    s_branch REC_POLL
OWN_83:
    s_nop 15
    s_nop 13
    buffer_load_dwordx4 v[12:15], v1, s[4:7], s24 offen offset:0 sc1
    buffer_load_dwordx4 v[16:19], v1, s[4:7], s24 offen offset:1024 sc1
    buffer_load_dwordx4 v[20:23], v1, s[4:7], s24 offen offset:2048 sc1
    buffer_load_dwordx4 v[24:27], v1, s[4:7], s24 offen offset:3072 sc1
    ds_read_b128 v[56:59], v2 offset:0
    ds_read_b128 v[60:63], v2 offset:1024
    ds_read_b128 v[64:67], v2 offset:2048
    ds_read_b128 v[68:71], v2 offset:3072
    v_mov_b64 v[32:33], 0
    v_mov_b64 v[34:35], 0
    v_mov_b64 v[36:37], 0
    v_mov_b64 v[38:39], 0
    v_mov_b64 v[40:41], 0
    v_mov_b64 v[42:43], 0
    v_mov_b64 v[44:45], 0
    v_mov_b64 v[46:47], 0
    buffer_load_dwordx4 v[72:75], v1, s[4:7], s24 offen offset:0 sc1
    buffer_load_dwordx4 v[76:79], v1, s[4:7], s24 offen offset:1024 sc1
    buffer_load_dwordx4 v[80:83], v1, s[4:7], s24 offen offset:2048 sc1
    buffer_load_dwordx4 v[84:87], v1, s[4:7], s24 offen offset:3072 sc1
    v_mov_b64 v[48:49], 0
    v_mov_b64 v[50:51], 0
    v_mov_b64 v[52:53], 0
    v_mov_b64 v[54:55], 0
OPOLL_85:
    s_waitcnt vmcnt(7)
    v_mfma_f32_16x16x32_bf16 v[92:95], v[12:15], v[88:91], 0
    v_bitop3_b32 v10, v12, v14, s16 bitop3:0x7e
    s_waitcnt vmcnt(6)
    v_mfma_f32_16x16x32_bf16 v[92:95], v[16:19], v[88:91], v[92:95]
    v_bitop3_b32 v11, v16, v18, s16 bitop3:0x7e
    s_waitcnt vmcnt(5)
    v_mfma_f32_16x16x32_bf16 v[92:95], v[20:23], v[88:91], v[92:95]
    v_bitop3_b32 v30, v20, v22, s16 bitop3:0x7e
    s_waitcnt vmcnt(4)
    v_mfma_f32_16x16x32_bf16 v[92:95], v[24:27], v[88:91], v[92:95]
    v_bitop3_b32 v31, v24, v26, s16 bitop3:0x7e
    v_or3_b32 v10, v10, v11, v30
    v_bitop3_b32 v10, v10, v31, 1 bitop3:0xa8
    v_cmp_ne_u32 vcc, 0, v10
    s_nop 3
    s_cbranch_vccz ODONE_84
    s_add_u32 s40, s40, 1
    buffer_load_dwordx4 v[12:15], v1, s[4:7], s24 offen offset:0 sc1
    buffer_load_dwordx4 v[16:19], v1, s[4:7], s24 offen offset:1024 sc1
    buffer_load_dwordx4 v[20:23], v1, s[4:7], s24 offen offset:2048 sc1
    buffer_load_dwordx4 v[24:27], v1, s[4:7], s24 offen offset:3072 sc1
    s_waitcnt vmcnt(7)
    v_mfma_f32_16x16x32_bf16 v[92:95], v[72:75], v[88:91], 0
    v_bitop3_b32 v10, v72, v74, s16 bitop3:0x7e
    s_waitcnt vmcnt(6)
    v_mfma_f32_16x16x32_bf16 v[92:95], v[76:79], v[88:91], v[92:95]
    v_bitop3_b32 v11, v76, v78, s16 bitop3:0x7e
    s_waitcnt vmcnt(5)
    v_mfma_f32_16x16x32_bf16 v[92:95], v[80:83], v[88:91], v[92:95]
    v_bitop3_b32 v30, v80, v82, s16 bitop3:0x7e
    s_waitcnt vmcnt(4)
    v_mfma_f32_16x16x32_bf16 v[92:95], v[84:87], v[88:91], v[92:95]
    v_bitop3_b32 v31, v84, v86, s16 bitop3:0x7e
    v_or3_b32 v10, v10, v11, v30
    v_bitop3_b32 v10, v10, v31, 1 bitop3:0xa8
    v_cmp_ne_u32 vcc, 0, v10
    s_add_u32 s68, s68, 1
    s_cmp_gt_u32 s68, 262144
    s_cbranch_scc1 ODONE_84
    s_nop 0
    s_cbranch_vccz ODONE_84
    s_add_u32 s40, s40, 1
    buffer_load_dwordx4 v[72:75], v1, s[4:7], s24 offen offset:0 sc1
    buffer_load_dwordx4 v[76:79], v1, s[4:7], s24 offen offset:1024 sc1
    buffer_load_dwordx4 v[80:83], v1, s[4:7], s24 offen offset:2048 sc1
    buffer_load_dwordx4 v[84:87], v1, s[4:7], s24 offen offset:3072 sc1
    s_branch OPOLL_85
ODONE_84:
    v_permlane32_swap_b32 v92, v94
    v_permlane32_swap_b32 v93, v95
    v_add_f32 v92, v92, v94
    v_add_f32 v93, v93, v95
    v_cvt_pk_bf16_f32 v8, v92, v93
    buffer_store_dword v8, v9, s[4:7], s18 offen
    s_cmp_eq_u32 s15, 63
    s_cselect_b32 s59, s55, 0
    s_barrier
    s_nop 15
    s_nop 15
    s_nop 12
    buffer_store_dword v8, v9, s[4:7], s21 offen sc1
    s_cmp_lt_u32 s15, 61
    s_cbranch_scc1 EFLG_86
    buffer_store_dword v6, off, s[4:7], s22 sc1
EFLG_86:
    s_xor_b32 s16, s16, 1
    s_waitcnt vmcnt(2) lgkmcnt(0)
    s_branch REC_LOOP
IDLE_82:
    s_barrier
    v_mov_b64 v[32:33], 0
    v_mov_b64 v[34:35], 0
    v_mov_b64 v[36:37], 0
    v_mov_b64 v[38:39], 0
    v_mov_b64 v[40:41], 0
    v_mov_b64 v[42:43], 0
    v_mov_b64 v[44:45], 0
    v_mov_b64 v[46:47], 0
    v_mov_b64 v[48:49], 0
    v_mov_b64 v[50:51], 0
    v_mov_b64 v[52:53], 0
    v_mov_b64 v[54:55], 0
    ds_read_b128 v[56:59], v2 offset:0
    ds_read_b128 v[60:63], v2 offset:1024
    ds_read_b128 v[64:67], v2 offset:2048
    ds_read_b128 v[68:71], v2 offset:3072
    s_xor_b32 s16, s16, 1
    s_waitcnt vmcnt(0)
    s_branch REC_LOOP
REC_TAIL:
RETRY_64:
SPIN_87:
    buffer_load_dwordx4 v[20:23], v1, s[4:7], s17 offen offset:2048 sc1
    buffer_load_dwordx4 v[24:27], v1, s[4:7], s17 offen offset:3072 sc1
    buffer_load_dwordx4 v[28:31], v1, s[4:7], s74 offen offset:0 sc1
    s_add_u32 s68, s68, 1
    s_add_u32 s40, s40, 1024
    s_cmp_gt_u32 s68, 262144
    s_waitcnt vmcnt(0)
    s_cbranch_scc1 BACK_65
    v_cmp_eq_u32 vcc, -1, v23
    s_cbranch_vccnz SPIN_87
    s_branch BACK_65
RETRY_66:
SPIN_88:
    buffer_load_dwordx4 v[24:27], v1, s[4:7], s17 offen offset:3072 sc1
    buffer_load_dwordx4 v[28:31], v1, s[4:7], s74 offen offset:0 sc1
    s_add_u32 s68, s68, 1
    s_add_u32 s40, s40, 1024
    s_cmp_gt_u32 s68, 262144
    s_waitcnt vmcnt(0)
    s_cbranch_scc1 BACK_67
    v_cmp_eq_u32 vcc, -1, v27
    s_cbranch_vccnz SPIN_88
    s_branch BACK_67
RETRY_68:
SPIN_89:
    buffer_load_dwordx4 v[28:31], v1, s[4:7], s74 offen offset:0 sc1
    s_add_u32 s68, s68, 1
    s_add_u32 s40, s40, 1024
    s_cmp_gt_u32 s68, 262144
    s_waitcnt vmcnt(0)
    s_cbranch_scc1 BACK_69
    v_cmp_eq_u32 vcc, -1, v31
    s_cbranch_vccnz SPIN_89
    s_branch BACK_69
RETRY_70:
SPIN_90:
    buffer_load_dwordx4 v[12:15], v1, s[4:7], s20 offen offset:0 sc1
    buffer_load_dwordx4 v[16:19], v1, s[4:7], s20 offen offset:1024 sc1
    buffer_load_dwordx4 v[20:23], v1, s[4:7], s20 offen offset:2048 sc1
    buffer_load_dwordx4 v[24:27], v1, s[4:7], s20 offen offset:3072 sc1
    s_add_u32 s68, s68, 1
    s_add_u32 s40, s40, 1048576
    s_cmp_gt_u32 s68, 262144
    s_waitcnt vmcnt(0)
    s_cbranch_scc1 BACK_71
    v_cmp_eq_u32 vcc, -1, v15
    s_cbranch_vccnz SPIN_90
    s_branch BACK_71
RETRY_72:
SPIN_91:
    buffer_load_dwordx4 v[16:19], v1, s[4:7], s20 offen offset:1024 sc1
    buffer_load_dwordx4 v[20:23], v1, s[4:7], s20 offen offset:2048 sc1
    buffer_load_dwordx4 v[24:27], v1, s[4:7], s20 offen offset:3072 sc1
    buffer_load_dwordx4 v[28:31], v1, s[4:7], s75 offen offset:0 sc1
    s_add_u32 s68, s68, 1
    s_add_u32 s40, s40, 1048576
    s_cmp_gt_u32 s68, 262144
    s_waitcnt vmcnt(0)
    s_cbranch_scc1 BACK_73
    v_cmp_eq_u32 vcc, -1, v19
    s_cbranch_vccnz SPIN_91
    s_branch BACK_73
RETRY_74:
SPIN_92:
    buffer_load_dwordx4 v[20:23], v1, s[4:7], s20 offen offset:2048 sc1
    buffer_load_dwordx4 v[24:27], v1, s[4:7], s20 offen offset:3072 sc1
    buffer_load_dwordx4 v[28:31], v1, s[4:7], s75 offen offset:0 sc1
    s_add_u32 s68, s68, 1
    s_add_u32 s40, s40, 1048576
    s_cmp_gt_u32 s68, 262144
    s_waitcnt vmcnt(0)
    s_cbranch_scc1 BACK_75
    v_cmp_eq_u32 vcc, -1, v23
    s_cbranch_vccnz SPIN_92
    s_branch BACK_75
RETRY_76:
SPIN_93:
    buffer_load_dwordx4 v[24:27], v1, s[4:7], s20 offen offset:3072 sc1
    buffer_load_dwordx4 v[28:31], v1, s[4:7], s75 offen offset:0 sc1
    s_add_u32 s68, s68, 1
    s_add_u32 s40, s40, 1048576
    s_cmp_gt_u32 s68, 262144
    s_waitcnt vmcnt(0)
    s_cbranch_scc1 BACK_77
    v_cmp_eq_u32 vcc, -1, v27
    s_cbranch_vccnz SPIN_93
    s_branch BACK_77
RETRY_78:
SPIN_94:
    buffer_load_dwordx4 v[28:31], v1, s[4:7], s75 offen offset:0 sc1
    s_add_u32 s68, s68, 1
    s_add_u32 s40, s40, 1048576
    s_cmp_gt_u32 s68, 262144
    s_waitcnt vmcnt(0)
    s_cbranch_scc1 BACK_79
    v_cmp_eq_u32 vcc, -1, v31
    s_cbranch_vccnz SPIN_94
    s_branch BACK_79
REC_FINAL:
    s_cmp_lg_u32 s12, 0
    s_cbranch_scc1 REC_END
    s_waitcnt lgkmcnt(0)
    v_smfmac_f32_16x16x64_bf16 v[48:51], v[20:23], a[112:119], v6
    v_smfmac_f32_16x16x64_bf16 v[52:55], v[20:23], a[120:127], v6
    v_smfmac_f32_16x16x64_bf16 v[48:51], v[24:27], a[128:135], v6
    v_smfmac_f32_16x16x64_bf16 v[52:55], v[24:27], a[136:143], v6
    v_smfmac_f32_16x16x64_bf16 v[48:51], v[28:31], a[144:151], v6
    v_smfmac_f32_16x16x64_bf16 v[52:55], v[28:31], a[152:159], v6
    ds_read_b64_tr_b16 v[192:193], v4 offset:2304
    ds_read_b64_tr_b16 v[194:195], v4 offset:2432
    ds_read_b64_tr_b16 v[196:197], v4 offset:2560
    ds_read_b64_tr_b16 v[198:199], v4 offset:2688
    ds_read_b64_tr_b16 v[200:201], v4 offset:2816
    ds_read_b64_tr_b16 v[202:203], v4 offset:2944
    ds_read_b64_tr_b16 v[204:205], v4 offset:3072
    ds_read_b64_tr_b16 v[206:207], v4 offset:3200
    ds_read_b128 v[160:163], v1 offset:0
    ds_read_b128 v[164:167], v1 offset:1024
    ds_read_b128 v[168:171], v1 offset:2048
    ds_read_b128 v[172:175], v1 offset:3072
    ds_read_b128 v[176:179], v1 offset:4096
    ds_read_b128 v[180:183], v1 offset:5120
    ds_read_b128 v[184:187], v1 offset:6144
    ds_read_b128 v[188:191], v1 offset:7168
    v_lshrrev_b32 v8, 1, v1
    s_lshl_b32 s64, s14, 9
    v_add_u32 v8, s64, v8
    v_permlane32_swap_b32 v48, v52
    v_permlane32_swap_b32 v49, v53
    v_permlane32_swap_b32 v50, v54
    v_permlane32_swap_b32 v51, v55
    v_pk_add_f32 v[48:49], v[48:49], v[52:53]
    v_pk_add_f32 v[50:51], v[50:51], v[54:55]
    v_cvt_pk_bf16_f32 v52, v48, v49
    v_cvt_pk_bf16_f32 v53, v50, v51
    ds_write_b64 v8, v[52:53] offset:8192
    s_waitcnt lgkmcnt(0)
    s_barrier
    s_cmp_lg_u32 s14, 0
    s_cbranch_scc1 REC_END
    v_mbcnt_lo_u32_b32 v0, -1, 0
    v_mbcnt_hi_u32_b32 v0, -1, v0
    v_bfe_u32 v5, v0, 4, 1
    v_lshlrev_b32 v6, 7, v5
    v_and_b32 v5, 15, v0
    v_lshl_add_u32 v6, v5, 3, v6
    ds_read_b64 v[208:209], v6 offset:8192
    ds_read_b64 v[210:211], v6 offset:8448
    ds_read_b64 v[212:213], v6 offset:8704
    ds_read_b64 v[214:215], v6 offset:8960
    ds_read_b64 v[216:217], v6 offset:9216
    ds_read_b64 v[218:219], v6 offset:9472
    ds_read_b64 v[220:221], v6 offset:9728
    ds_read_b64 v[222:223], v6 offset:9984
    s_mov_b32 s34, 0x3e0293ee
    s_mov_b32 s35, 0x3e0293ee
    s_mov_b32 s36, -1
    s_mov_b32 s37, 0
    v_lshrrev_b32 v5, 4, v0
    v_lshlrev_b32 v5, 2, v5
    v_and_b32 v6, 15, v0
    v_add_u32 v7, 0, v5
    v_cmp_le_u32 s[38:39], v7, v6
    v_add_u32 v7, 1, v5
    v_cmp_le_u32 s[40:41], v7, v6
    v_add_u32 v7, 2, v5
    v_cmp_le_u32 s[42:43], v7, v6
    v_add_u32 v7, 3, v5
    v_cmp_le_u32 s[44:45], v7, v6
    v_mov_b32 v252, 0x3f803f80
    v_mov_b32 v253, 0x3f803f80
    v_mov_b32 v254, 0x3f803f80
    v_mov_b32 v255, 0x3f803f80
    s_mov_b32 s24, 63
    s_lshl_b32 s64, s24, 5
    s_add_u32 s64, s64, s13
    s_lshl_b32 s33, s64, 2
    s_add_u32 s33, s33, 0x296000
    s_lshl_b32 s32, s24, 18
    s_lshl_b32 s65, s13, 12
    s_add_u32 s32, s32, s65
    s_add_u32 s32, s32, 0x4400000
    s_waitcnt vmcnt(0) lgkmcnt(0)
    v_mfma_f32_16x16x32_bf16 v[228:231], v[160:163], v[96:99], 0
    v_mfma_f32_16x16x32_bf16 v[236:239], v[160:163], v[112:115], 0
    v_mfma_f32_16x16x32_bf16 v[240:243], v[176:179], v[112:115], 0
    v_mfma_f32_16x16x32_bf16 v[228:231], v[164:167], v[100:103], v[228:231]
    v_mfma_f32_16x16x32_bf16 v[236:239], v[164:167], v[116:119], v[236:239]
    v_mfma_f32_16x16x32_bf16 v[240:243], v[180:183], v[116:119], v[240:243]
    v_mfma_f32_16x16x32_bf16 v[228:231], v[168:171], v[104:107], v[228:231]
    v_mfma_f32_16x16x32_bf16 v[236:239], v[168:171], v[120:123], v[236:239]
    v_mfma_f32_16x16x32_bf16 v[240:243], v[184:187], v[120:123], v[240:243]
    v_mfma_f32_16x16x32_bf16 v[228:231], v[172:175], v[108:111], v[228:231]
    v_mfma_f32_16x16x32_bf16 v[236:239], v[172:175], v[124:127], v[236:239]
    v_mfma_f32_16x16x32_bf16 v[240:243], v[188:191], v[124:127], v[240:243]
    v_mfma_f32_16x16x32_bf16 v[224:227], v[192:195], v[96:99], 0
    v_mfma_f32_16x16x32_bf16 v[232:235], v[192:195], v[112:115], 0
    v_mfma_f32_16x16x32_bf16 v[224:227], v[196:199], v[100:103], v[224:227]
    v_mfma_f32_16x16x32_bf16 v[232:235], v[196:199], v[116:119], v[232:235]
    v_mfma_f32_16x16x32_bf16 v[224:227], v[200:203], v[104:107], v[224:227]
    v_mfma_f32_16x16x32_bf16 v[232:235], v[200:203], v[120:123], v[232:235]
    v_mfma_f32_16x16x32_bf16 v[224:227], v[204:207], v[108:111], v[224:227]
    v_mfma_f32_16x16x32_bf16 v[232:235], v[204:207], v[124:127], v[232:235]
    v_mov_b32 v11, 0xff800000
    s_nop 7
    v_cndmask_b32 v228, v11, v228, s[38:39]
    v_cndmask_b32 v240, v11, v240, s[38:39]
    v_cndmask_b32 v224, v11, v224, s[36:37]
    v_cndmask_b32 v232, v11, v232, s[36:37]
    v_cndmask_b32 v229, v11, v229, s[40:41]
    v_cndmask_b32 v241, v11, v241, s[40:41]
    v_cndmask_b32 v225, v11, v225, s[36:37]
    v_cndmask_b32 v233, v11, v233, s[36:37]
    v_cndmask_b32 v230, v11, v230, s[42:43]
    v_cndmask_b32 v242, v11, v242, s[42:43]
    v_cndmask_b32 v226, v11, v226, s[36:37]
    v_cndmask_b32 v234, v11, v234, s[36:37]
    v_cndmask_b32 v231, v11, v231, s[44:45]
    v_cndmask_b32 v243, v11, v243, s[44:45]
    v_cndmask_b32 v227, v11, v227, s[36:37]
    v_cndmask_b32 v235, v11, v235, s[36:37]
    v_max3_f32 v8, v224, v225, v226
    v_max3_f32 v8, v8, v227, v228
    v_max3_f32 v8, v8, v229, v230
    v_max_f32 v8, v8, v231
    v_mov_b32 v9, v8
    s_nop 1
    v_permlane16_swap_b32 v8, v9
    v_max_f32 v8, v8, v9
    v_mov_b32 v9, v8
    s_nop 1
    v_permlane32_swap_b32 v8, v9
    v_max_f32 v8, v8, v9
    v_mul_f32 v8, s34, v8
    v_fma_f32 v224, v224, s34, -v8
    v_fma_f32 v225, v225, s34, -v8
    v_fma_f32 v226, v226, s34, -v8
    v_fma_f32 v227, v227, s34, -v8
    v_fma_f32 v228, v228, s34, -v8
    v_fma_f32 v229, v229, s34, -v8
    v_fma_f32 v230, v230, s34, -v8
    v_fma_f32 v231, v231, s34, -v8
    v_exp_f32 v224, v224
    v_exp_f32 v225, v225
    v_exp_f32 v226, v226
    v_exp_f32 v227, v227
    v_exp_f32 v228, v228
    v_exp_f32 v229, v229
    v_exp_f32 v230, v230
    v_exp_f32 v231, v231
    s_nop 0
    v_cvt_pk_bf16_f32 v16, v228, v229
    v_cvt_pk_bf16_f32 v17, v230, v231
    v_mov_b32 v18, 0
    v_mov_b32 v19, 0
    v_cvt_pk_bf16_f32 v20, v224, v225
    v_cvt_pk_bf16_f32 v21, v226, v227
    v_max3_f32 v8, v232, v233, v234
    v_max3_f32 v8, v8, v235, v236
    v_max3_f32 v8, v8, v237, v238
    v_max3_f32 v8, v8, v239, v240
    v_max3_f32 v8, v8, v241, v242
    v_max_f32 v8, v8, v243
    v_mov_b32 v9, v8
    s_nop 1
    v_permlane16_swap_b32 v8, v9
    v_max_f32 v8, v8, v9
    v_mov_b32 v9, v8
    s_nop 1
    v_permlane32_swap_b32 v8, v9
    v_max_f32 v8, v8, v9
    v_mul_f32 v8, s34, v8
    v_fma_f32 v232, v232, s34, -v8
    v_fma_f32 v233, v233, s34, -v8
    v_fma_f32 v234, v234, s34, -v8
    v_fma_f32 v235, v235, s34, -v8
    v_fma_f32 v236, v236, s34, -v8
    v_fma_f32 v237, v237, s34, -v8
    v_fma_f32 v238, v238, s34, -v8
    v_fma_f32 v239, v239, s34, -v8
    v_fma_f32 v240, v240, s34, -v8
    v_fma_f32 v241, v241, s34, -v8
    v_fma_f32 v242, v242, s34, -v8
    v_fma_f32 v243, v243, s34, -v8
    v_exp_f32 v232, v232
    v_exp_f32 v233, v233
    v_exp_f32 v234, v234
    v_exp_f32 v235, v235
    v_exp_f32 v236, v236
    v_exp_f32 v237, v237
    v_exp_f32 v238, v238
    v_exp_f32 v239, v239
    v_exp_f32 v240, v240
    v_exp_f32 v241, v241
    v_exp_f32 v242, v242
    v_exp_f32 v243, v243
    s_nop 0
    v_cvt_pk_bf16_f32 v22, v236, v237
    v_cvt_pk_bf16_f32 v23, v238, v239
    v_cvt_pk_bf16_f32 v24, v240, v241
    v_cvt_pk_bf16_f32 v25, v242, v243
    v_cvt_pk_bf16_f32 v26, v232, v233
    v_cvt_pk_bf16_f32 v27, v234, v235
    v_mfma_f32_16x16x32_bf16 v[244:247], v[252:255], v[16:19], 0
    v_mfma_f32_16x16x32_bf16 v[248:251], v[252:255], v[22:25], 0
    v_mfma_f32_16x16x32_bf16 v[32:35], v[128:131], v[16:19], 0
    v_mfma_f32_16x16x32_bf16 v[36:39], v[128:131], v[22:25], 0
    v_mfma_f32_16x16x32_bf16 v[40:43], v[132:135], v[16:19], 0
    v_mfma_f32_16x16x32_bf16 v[44:47], v[132:135], v[22:25], 0
    v_mfma_f32_16x16x32_bf16 v[48:51], v[136:139], v[16:19], 0
    v_mfma_f32_16x16x32_bf16 v[52:55], v[136:139], v[22:25], 0
    v_mfma_f32_16x16x32_bf16 v[56:59], v[140:143], v[16:19], 0
    v_mfma_f32_16x16x32_bf16 v[60:63], v[140:143], v[22:25], 0
    v_mfma_f32_16x16x32_bf16 v[64:67], v[144:147], v[16:19], 0
    v_mfma_f32_16x16x32_bf16 v[68:71], v[144:147], v[22:25], 0
    v_mfma_f32_16x16x32_bf16 v[72:75], v[148:151], v[16:19], 0
    v_mfma_f32_16x16x32_bf16 v[76:79], v[148:151], v[22:25], 0
    v_mfma_f32_16x16x32_bf16 v[80:83], v[152:155], v[16:19], 0
    v_mfma_f32_16x16x32_bf16 v[84:87], v[152:155], v[22:25], 0
    v_mfma_f32_16x16x32_bf16 v[88:91], v[156:159], v[16:19], 0
    v_mfma_f32_16x16x32_bf16 v[92:95], v[156:159], v[22:25], 0
    v_mfma_f32_16x16x16_bf16 v[244:247], v[252:253], v[20:21], v[244:247]
    v_mfma_f32_16x16x16_bf16 v[248:251], v[252:253], v[26:27], v[248:251]
    v_mfma_f32_16x16x16_bf16 v[32:35], v[208:209], v[20:21], v[32:35]
    v_mfma_f32_16x16x16_bf16 v[36:39], v[208:209], v[26:27], v[36:39]
    v_mfma_f32_16x16x16_bf16 v[40:43], v[210:211], v[20:21], v[40:43]
    v_mfma_f32_16x16x16_bf16 v[44:47], v[210:211], v[26:27], v[44:47]
    v_mfma_f32_16x16x16_bf16 v[48:51], v[212:213], v[20:21], v[48:51]
    v_mfma_f32_16x16x16_bf16 v[52:55], v[212:213], v[26:27], v[52:55]
    v_mfma_f32_16x16x16_bf16 v[56:59], v[214:215], v[20:21], v[56:59]
    v_mfma_f32_16x16x16_bf16 v[60:63], v[214:215], v[26:27], v[60:63]
    v_mfma_f32_16x16x16_bf16 v[64:67], v[216:217], v[20:21], v[64:67]
    v_mfma_f32_16x16x16_bf16 v[68:71], v[216:217], v[26:27], v[68:71]
    v_mfma_f32_16x16x16_bf16 v[72:75], v[218:219], v[20:21], v[72:75]
    v_mfma_f32_16x16x16_bf16 v[76:79], v[218:219], v[26:27], v[76:79]
    v_mfma_f32_16x16x16_bf16 v[80:83], v[220:221], v[20:21], v[80:83]
    v_mfma_f32_16x16x16_bf16 v[84:87], v[220:221], v[26:27], v[84:87]
    v_mfma_f32_16x16x16_bf16 v[88:91], v[222:223], v[20:21], v[88:91]
    v_mfma_f32_16x16x16_bf16 v[92:95], v[222:223], v[26:27], v[92:95]
    v_rcp_f32 v8, v244
    v_rcp_f32 v9, v248
    s_nop 7
    v_mul_f32 v32, v32, v8
    v_mul_f32 v33, v33, v8
    v_mul_f32 v34, v34, v8
    v_mul_f32 v35, v35, v8
    v_cvt_pk_bf16_f32 v96, v32, v33
    v_cvt_pk_bf16_f32 v97, v34, v35
    v_mul_f32 v40, v40, v8
    v_mul_f32 v41, v41, v8
    v_mul_f32 v42, v42, v8
    v_mul_f32 v43, v43, v8
    v_cvt_pk_bf16_f32 v98, v40, v41
    v_cvt_pk_bf16_f32 v99, v42, v43
    s_add_u32 s64, s32, 0x0
    buffer_store_dwordx4 v[96:99], v1, s[4:7], s64 offen offset:0 sc1
    v_mul_f32 v48, v48, v8
    v_mul_f32 v49, v49, v8
    v_mul_f32 v50, v50, v8
    v_mul_f32 v51, v51, v8
    v_cvt_pk_bf16_f32 v100, v48, v49
    v_cvt_pk_bf16_f32 v101, v50, v51
    v_mul_f32 v56, v56, v8
    v_mul_f32 v57, v57, v8
    v_mul_f32 v58, v58, v8
    v_mul_f32 v59, v59, v8
    v_cvt_pk_bf16_f32 v102, v56, v57
    v_cvt_pk_bf16_f32 v103, v58, v59
    s_add_u32 s64, s32, 0x0
    buffer_store_dwordx4 v[100:103], v1, s[4:7], s64 offen offset:1024 sc1
    v_mul_f32 v64, v64, v8
    v_mul_f32 v65, v65, v8
    v_mul_f32 v66, v66, v8
    v_mul_f32 v67, v67, v8
    v_cvt_pk_bf16_f32 v104, v64, v65
    v_cvt_pk_bf16_f32 v105, v66, v67
    v_mul_f32 v72, v72, v8
    v_mul_f32 v73, v73, v8
    v_mul_f32 v74, v74, v8
    v_mul_f32 v75, v75, v8
    v_cvt_pk_bf16_f32 v106, v72, v73
    v_cvt_pk_bf16_f32 v107, v74, v75
    s_add_u32 s64, s32, 0x0
    buffer_store_dwordx4 v[104:107], v1, s[4:7], s64 offen offset:2048 sc1
    v_mul_f32 v80, v80, v8
    v_mul_f32 v81, v81, v8
    v_mul_f32 v82, v82, v8
    v_mul_f32 v83, v83, v8
    v_cvt_pk_bf16_f32 v108, v80, v81
    v_cvt_pk_bf16_f32 v109, v82, v83
    v_mul_f32 v88, v88, v8
    v_mul_f32 v89, v89, v8
    v_mul_f32 v90, v90, v8
    v_mul_f32 v91, v91, v8
    v_cvt_pk_bf16_f32 v110, v88, v89
    v_cvt_pk_bf16_f32 v111, v90, v91
    s_add_u32 s64, s32, 0x0
    buffer_store_dwordx4 v[108:111], v1, s[4:7], s64 offen offset:3072 sc1
    v_mul_f32 v36, v36, v9
    v_mul_f32 v37, v37, v9
    v_mul_f32 v38, v38, v9
    v_mul_f32 v39, v39, v9
    v_cvt_pk_bf16_f32 v112, v36, v37
    v_cvt_pk_bf16_f32 v113, v38, v39
    v_mul_f32 v44, v44, v9
    v_mul_f32 v45, v45, v9
    v_mul_f32 v46, v46, v9
    v_mul_f32 v47, v47, v9
    v_cvt_pk_bf16_f32 v114, v44, v45
    v_cvt_pk_bf16_f32 v115, v46, v47
    s_add_u32 s64, s32, 0x20000
    buffer_store_dwordx4 v[112:115], v1, s[4:7], s64 offen offset:0 sc1
    v_mul_f32 v52, v52, v9
    v_mul_f32 v53, v53, v9
    v_mul_f32 v54, v54, v9
    v_mul_f32 v55, v55, v9
    v_cvt_pk_bf16_f32 v116, v52, v53
    v_cvt_pk_bf16_f32 v117, v54, v55
    v_mul_f32 v60, v60, v9
    v_mul_f32 v61, v61, v9
    v_mul_f32 v62, v62, v9
    v_mul_f32 v63, v63, v9
    v_cvt_pk_bf16_f32 v118, v60, v61
    v_cvt_pk_bf16_f32 v119, v62, v63
    s_add_u32 s64, s32, 0x20000
    buffer_store_dwordx4 v[116:119], v1, s[4:7], s64 offen offset:1024 sc1
    v_mul_f32 v68, v68, v9
    v_mul_f32 v69, v69, v9
    v_mul_f32 v70, v70, v9
    v_mul_f32 v71, v71, v9
    v_cvt_pk_bf16_f32 v120, v68, v69
    v_cvt_pk_bf16_f32 v121, v70, v71
    v_mul_f32 v76, v76, v9
    v_mul_f32 v77, v77, v9
    v_mul_f32 v78, v78, v9
    v_mul_f32 v79, v79, v9
    v_cvt_pk_bf16_f32 v122, v76, v77
    v_cvt_pk_bf16_f32 v123, v78, v79
    s_add_u32 s64, s32, 0x20000
    buffer_store_dwordx4 v[120:123], v1, s[4:7], s64 offen offset:2048 sc1
    v_mul_f32 v84, v84, v9
    v_mul_f32 v85, v85, v9
    v_mul_f32 v86, v86, v9
    v_mul_f32 v87, v87, v9
    v_cvt_pk_bf16_f32 v124, v84, v85
    v_cvt_pk_bf16_f32 v125, v86, v87
    v_mul_f32 v92, v92, v9
    v_mul_f32 v93, v93, v9
    v_mul_f32 v94, v94, v9
    v_mul_f32 v95, v95, v9
    v_cvt_pk_bf16_f32 v126, v92, v93
    v_cvt_pk_bf16_f32 v127, v94, v95
    s_add_u32 s64, s32, 0x20000
    buffer_store_dwordx4 v[124:127], v1, s[4:7], s64 offen offset:3072 sc1
    s_waitcnt vmcnt(0)
    v_mov_b32 v7, 1
    v_mov_b32 v8, 0
    s_mov_b64 exec, 1
    buffer_store_dword v7, v8, s[4:7], s33 offen sc1
    s_mov_b64 exec, -1
    s_branch REC_END
REC_END:
    s_branch M_EXIT
M_HELP:
    v_mbcnt_lo_u32_b32 v0, -1, 0
    v_mbcnt_hi_u32_b32 v0, -1, v0
    s_and_b32 s12, s96, 1
    s_lshr_b32 s3, s96, 1
    s_and_b32 s13, s3, 31
    s_lshr_b32 s3, s3, 5
    s_load_dwordx4 s[48:51], s[0:1], 16
    s_load_dwordx2 s[52:53], s[0:1], 32
    s_waitcnt lgkmcnt(0)
    s_mov_b32 s46, 5242880
    s_mov_b32 s47, 0x00020000
    s_cmp_eq_u32 s3, 1
    s_cselect_b32 s44, s52, s50
    s_cselect_b32 s45, s53, s51
    s_cmp_eq_u32 s3, 2
    s_cselect_b32 s44, s48, s44
    s_cselect_b32 s45, s49, s45
    s_load_dwordx2 s[16:17], s[0:1], 0
    s_mov_b32 s18, 2621440
    s_mov_b32 s19, 0x00020000
    s_load_dwordx2 s[20:21], s[0:1], 64
    s_mov_b32 s22, 1280
    s_mov_b32 s23, 0x00020000
    s_load_dwordx2 s[24:25], s[0:1], 8
    s_mov_b32 s26, 10240
    s_mov_b32 s27, 0x00020000
    s_lshl_b32 s28, s96, 2
    s_add_u32 s28, s28, s14
    s_mul_i32 s28, s28, 3
    v_lshlrev_b32 v3, 4, v0
    v_lshlrev_b32 v4, 2, v0
    s_waitcnt lgkmcnt(0)
    s_add_u32 s29, s28, 0
    s_mul_i32 s33, s29, 1280
    buffer_load_dwordx4 v[10:13], v3, s[16:19], s33 offen
    buffer_load_dword v14, v4, s[16:19], s33 offen offset:1024
    s_add_u32 s29, s28, 1
    s_mul_i32 s34, s29, 1280
    buffer_load_dwordx4 v[16:19], v3, s[16:19], s34 offen
    buffer_load_dword v20, v4, s[16:19], s34 offen offset:1024
    s_add_u32 s29, s28, 2
    s_mul_i32 s35, s29, 1280
    buffer_load_dwordx4 v[22:25], v3, s[16:19], s35 offen
    buffer_load_dword v26, v4, s[16:19], s35 offen offset:1024
    buffer_load_dwordx4 v[28:31], v3, s[20:23], 0 offen
    buffer_load_dword v32, v4, s[20:23], 0 offen offset:1024
    s_cmp_ge_u32 s96, 10
    s_cbranch_scc1 INM0_95
    v_and_b32 v5, 7, v0
    v_mul_u32_u24 v5, 1280, v5
    v_lshrrev_b32 v6, 4, v0
    v_lshl_add_u32 v5, v6, 5, v5
    v_bfe_u32 v6, v0, 3, 1
    v_lshl_add_u32 v5, v6, 4, v5
    s_lshl_b32 s29, s96, 7
    buffer_load_dwordx4 v[34:37], v5, s[24:27], s29 offen
INM0_95:
    s_waitcnt vmcnt(0)
    s_add_u32 s29, s28, 0
    s_cmp_ge_u32 s29, 2048
    s_cbranch_scc1 INR_96
    v_lshlrev_b32 v50, 16, v10
    v_and_b32 v60, 0xffff0000, v10
    v_lshlrev_b32 v51, 16, v11
    v_and_b32 v61, 0xffff0000, v11
    v_lshlrev_b32 v52, 16, v12
    v_and_b32 v62, 0xffff0000, v12
    v_lshlrev_b32 v53, 16, v13
    v_and_b32 v63, 0xffff0000, v13
    v_lshlrev_b32 v54, 16, v14
    v_and_b32 v64, 0xffff0000, v14
    v_add_f32 v70, v50, v60
    v_add_f32 v70, v70, v51
    v_add_f32 v70, v70, v61
    v_add_f32 v70, v70, v52
    v_add_f32 v70, v70, v62
    v_add_f32 v70, v70, v53
    v_add_f32 v70, v70, v63
    v_add_f32 v70, v70, v54
    v_add_f32 v70, v70, v64
    s_nop 1
    v_add_f32_dpp v70, v70, v70 quad_perm:[1,0,3,2] row_mask:0xf bank_mask:0xf
    s_nop 1
    v_add_f32_dpp v70, v70, v70 quad_perm:[2,3,0,1] row_mask:0xf bank_mask:0xf
    s_nop 1
    v_add_f32_dpp v70, v70, v70 row_half_mirror row_mask:0xf bank_mask:0xf
    s_nop 1
    v_add_f32_dpp v70, v70, v70 row_mirror row_mask:0xf bank_mask:0xf
    v_mov_b32 v71, v70
    s_nop 1
    v_permlane16_swap_b32 v70, v71
    v_add_f32 v70, v70, v71
    v_mov_b32 v71, v70
    s_nop 1
    v_permlane32_swap_b32 v70, v71
    v_add_f32 v70, v70, v71
    v_mul_f32 v72, 0x3acccccd, v70
    v_mov_b32 v73, 0
    v_sub_f32 v74, v50, v72
    v_fmac_f32 v73, v74, v74
    v_sub_f32 v74, v60, v72
    v_fmac_f32 v73, v74, v74
    v_sub_f32 v74, v51, v72
    v_fmac_f32 v73, v74, v74
    v_sub_f32 v74, v61, v72
    v_fmac_f32 v73, v74, v74
    v_sub_f32 v74, v52, v72
    v_fmac_f32 v73, v74, v74
    v_sub_f32 v74, v62, v72
    v_fmac_f32 v73, v74, v74
    v_sub_f32 v74, v53, v72
    v_fmac_f32 v73, v74, v74
    v_sub_f32 v74, v63, v72
    v_fmac_f32 v73, v74, v74
    v_sub_f32 v74, v54, v72
    v_fmac_f32 v73, v74, v74
    v_sub_f32 v74, v64, v72
    v_fmac_f32 v73, v74, v74
    s_nop 1
    v_add_f32_dpp v73, v73, v73 quad_perm:[1,0,3,2] row_mask:0xf bank_mask:0xf
    s_nop 1
    v_add_f32_dpp v73, v73, v73 quad_perm:[2,3,0,1] row_mask:0xf bank_mask:0xf
    s_nop 1
    v_add_f32_dpp v73, v73, v73 row_half_mirror row_mask:0xf bank_mask:0xf
    s_nop 1
    v_add_f32_dpp v73, v73, v73 row_mirror row_mask:0xf bank_mask:0xf
    v_mov_b32 v71, v73
    s_nop 1
    v_permlane16_swap_b32 v73, v71
    v_add_f32 v73, v73, v71
    v_mov_b32 v71, v73
    s_nop 1
    v_permlane32_swap_b32 v73, v71
    v_add_f32 v73, v73, v71
    v_mul_f32 v73, 0x3acccccd, v73
    v_cvt_pk_bf16_f32 v72, v72, v72
    v_lshlrev_b32 v72, 16, v72
    v_cvt_pk_bf16_f32 v73, v73, v73
    v_lshlrev_b32 v73, 16, v73
    v_add_f32 v73, 0x3727c5ac, v73
    v_cvt_pk_bf16_f32 v73, v73, v73
    v_lshlrev_b32 v73, 16, v73
    v_sqrt_f32 v73, v73
    s_nop 0
    v_cvt_pk_bf16_f32 v73, v73, v73
    v_lshlrev_b32 v73, 16, v73
    v_rcp_f32 v75, v73
    s_nop 0
    v_mov_b32 v76, 0
    v_sub_f32 v50, v50, v72
    v_cvt_pk_bf16_f32 v50, v50, v50
    v_lshlrev_b32 v50, 16, v50
    v_mul_f32 v74, v50, v75
    v_fma_f32 v77, -v74, v73, v50
    v_fma_f32 v50, v77, v75, v74
    v_sub_f32 v60, v60, v72
    v_cvt_pk_bf16_f32 v60, v60, v60
    v_lshlrev_b32 v60, 16, v60
    v_mul_f32 v74, v60, v75
    v_fma_f32 v77, -v74, v73, v60
    v_fma_f32 v60, v77, v75, v74
    v_cvt_pk_bf16_f32 v10, v50, v60
    v_lshlrev_b32 v74, 16, v10
    v_lshlrev_b32 v77, 16, v28
    v_fmac_f32 v76, v74, v77
    v_and_b32 v74, 0xffff0000, v10
    v_and_b32 v77, 0xffff0000, v28
    v_fmac_f32 v76, v74, v77
    v_sub_f32 v51, v51, v72
    v_cvt_pk_bf16_f32 v51, v51, v51
    v_lshlrev_b32 v51, 16, v51
    v_mul_f32 v74, v51, v75
    v_fma_f32 v77, -v74, v73, v51
    v_fma_f32 v51, v77, v75, v74
    v_sub_f32 v61, v61, v72
    v_cvt_pk_bf16_f32 v61, v61, v61
    v_lshlrev_b32 v61, 16, v61
    v_mul_f32 v74, v61, v75
    v_fma_f32 v77, -v74, v73, v61
    v_fma_f32 v61, v77, v75, v74
    v_cvt_pk_bf16_f32 v11, v51, v61
    v_lshlrev_b32 v74, 16, v11
    v_lshlrev_b32 v77, 16, v29
    v_fmac_f32 v76, v74, v77
    v_and_b32 v74, 0xffff0000, v11
    v_and_b32 v77, 0xffff0000, v29
    v_fmac_f32 v76, v74, v77
    v_sub_f32 v52, v52, v72
    v_cvt_pk_bf16_f32 v52, v52, v52
    v_lshlrev_b32 v52, 16, v52
    v_mul_f32 v74, v52, v75
    v_fma_f32 v77, -v74, v73, v52
    v_fma_f32 v52, v77, v75, v74
    v_sub_f32 v62, v62, v72
    v_cvt_pk_bf16_f32 v62, v62, v62
    v_lshlrev_b32 v62, 16, v62
    v_mul_f32 v74, v62, v75
    v_fma_f32 v77, -v74, v73, v62
    v_fma_f32 v62, v77, v75, v74
    v_cvt_pk_bf16_f32 v12, v52, v62
    v_lshlrev_b32 v74, 16, v12
    v_lshlrev_b32 v77, 16, v30
    v_fmac_f32 v76, v74, v77
    v_and_b32 v74, 0xffff0000, v12
    v_and_b32 v77, 0xffff0000, v30
    v_fmac_f32 v76, v74, v77
    v_sub_f32 v53, v53, v72
    v_cvt_pk_bf16_f32 v53, v53, v53
    v_lshlrev_b32 v53, 16, v53
    v_mul_f32 v74, v53, v75
    v_fma_f32 v77, -v74, v73, v53
    v_fma_f32 v53, v77, v75, v74
    v_sub_f32 v63, v63, v72
    v_cvt_pk_bf16_f32 v63, v63, v63
    v_lshlrev_b32 v63, 16, v63
    v_mul_f32 v74, v63, v75
    v_fma_f32 v77, -v74, v73, v63
    v_fma_f32 v63, v77, v75, v74
    v_cvt_pk_bf16_f32 v13, v53, v63
    v_lshlrev_b32 v74, 16, v13
    v_lshlrev_b32 v77, 16, v31
    v_fmac_f32 v76, v74, v77
    v_and_b32 v74, 0xffff0000, v13
    v_and_b32 v77, 0xffff0000, v31
    v_fmac_f32 v76, v74, v77
    v_sub_f32 v54, v54, v72
    v_cvt_pk_bf16_f32 v54, v54, v54
    v_lshlrev_b32 v54, 16, v54
    v_mul_f32 v74, v54, v75
    v_fma_f32 v77, -v74, v73, v54
    v_fma_f32 v54, v77, v75, v74
    v_sub_f32 v64, v64, v72
    v_cvt_pk_bf16_f32 v64, v64, v64
    v_lshlrev_b32 v64, 16, v64
    v_mul_f32 v74, v64, v75
    v_fma_f32 v77, -v74, v73, v64
    v_fma_f32 v64, v77, v75, v74
    v_cvt_pk_bf16_f32 v14, v54, v64
    v_lshlrev_b32 v74, 16, v14
    v_lshlrev_b32 v77, 16, v32
    v_fmac_f32 v76, v74, v77
    v_and_b32 v74, 0xffff0000, v14
    v_and_b32 v77, 0xffff0000, v32
    v_fmac_f32 v76, v74, v77
    s_add_u32 s30, s33, 0x0
    buffer_store_dwordx4 v[10:13], v3, s[4:7], s30 offen sc1
    buffer_store_dword v14, v4, s[4:7], s30 offen offset:1024 sc1
    s_nop 1
    v_add_f32_dpp v76, v76, v76 quad_perm:[1,0,3,2] row_mask:0xf bank_mask:0xf
    s_nop 1
    v_add_f32_dpp v76, v76, v76 quad_perm:[2,3,0,1] row_mask:0xf bank_mask:0xf
    s_nop 1
    v_add_f32_dpp v76, v76, v76 row_half_mirror row_mask:0xf bank_mask:0xf
    s_nop 1
    v_add_f32_dpp v76, v76, v76 row_mirror row_mask:0xf bank_mask:0xf
    v_mov_b32 v71, v76
    s_nop 1
    v_permlane16_swap_b32 v76, v71
    v_add_f32 v76, v76, v71
    v_mov_b32 v71, v76
    s_nop 1
    v_permlane32_swap_b32 v76, v71
    v_add_f32 v76, v76, v71
    v_cvt_pk_bf16_f32 v76, v76, v76
    v_lshlrev_b32 v76, 16, v76
    s_lshl_b32 s30, s29, 2
    s_add_u32 s30, s30, 0x280000
    s_mov_b64 exec, 1
    buffer_store_dword v76, off, s[4:7], s30 sc1
    s_mov_b64 exec, -1
INR_96:
    s_add_u32 s29, s28, 1
    s_cmp_ge_u32 s29, 2048
    s_cbranch_scc1 INR_97
    v_lshlrev_b32 v50, 16, v16
    v_and_b32 v60, 0xffff0000, v16
    v_lshlrev_b32 v51, 16, v17
    v_and_b32 v61, 0xffff0000, v17
    v_lshlrev_b32 v52, 16, v18
    v_and_b32 v62, 0xffff0000, v18
    v_lshlrev_b32 v53, 16, v19
    v_and_b32 v63, 0xffff0000, v19
    v_lshlrev_b32 v54, 16, v20
    v_and_b32 v64, 0xffff0000, v20
    v_add_f32 v70, v50, v60
    v_add_f32 v70, v70, v51
    v_add_f32 v70, v70, v61
    v_add_f32 v70, v70, v52
    v_add_f32 v70, v70, v62
    v_add_f32 v70, v70, v53
    v_add_f32 v70, v70, v63
    v_add_f32 v70, v70, v54
    v_add_f32 v70, v70, v64
    s_nop 1
    v_add_f32_dpp v70, v70, v70 quad_perm:[1,0,3,2] row_mask:0xf bank_mask:0xf
    s_nop 1
    v_add_f32_dpp v70, v70, v70 quad_perm:[2,3,0,1] row_mask:0xf bank_mask:0xf
    s_nop 1
    v_add_f32_dpp v70, v70, v70 row_half_mirror row_mask:0xf bank_mask:0xf
    s_nop 1
    v_add_f32_dpp v70, v70, v70 row_mirror row_mask:0xf bank_mask:0xf
    v_mov_b32 v71, v70
    s_nop 1
    v_permlane16_swap_b32 v70, v71
    v_add_f32 v70, v70, v71
    v_mov_b32 v71, v70
    s_nop 1
    v_permlane32_swap_b32 v70, v71
    v_add_f32 v70, v70, v71
    v_mul_f32 v72, 0x3acccccd, v70
    v_mov_b32 v73, 0
    v_sub_f32 v74, v50, v72
    v_fmac_f32 v73, v74, v74
    v_sub_f32 v74, v60, v72
    v_fmac_f32 v73, v74, v74
    v_sub_f32 v74, v51, v72
    v_fmac_f32 v73, v74, v74
    v_sub_f32 v74, v61, v72
    v_fmac_f32 v73, v74, v74
    v_sub_f32 v74, v52, v72
    v_fmac_f32 v73, v74, v74
    v_sub_f32 v74, v62, v72
    v_fmac_f32 v73, v74, v74
    v_sub_f32 v74, v53, v72
    v_fmac_f32 v73, v74, v74
    v_sub_f32 v74, v63, v72
    v_fmac_f32 v73, v74, v74
    v_sub_f32 v74, v54, v72
    v_fmac_f32 v73, v74, v74
    v_sub_f32 v74, v64, v72
    v_fmac_f32 v73, v74, v74
    s_nop 1
    v_add_f32_dpp v73, v73, v73 quad_perm:[1,0,3,2] row_mask:0xf bank_mask:0xf
    s_nop 1
    v_add_f32_dpp v73, v73, v73 quad_perm:[2,3,0,1] row_mask:0xf bank_mask:0xf
    s_nop 1
    v_add_f32_dpp v73, v73, v73 row_half_mirror row_mask:0xf bank_mask:0xf
    s_nop 1
    v_add_f32_dpp v73, v73, v73 row_mirror row_mask:0xf bank_mask:0xf
    v_mov_b32 v71, v73
    s_nop 1
    v_permlane16_swap_b32 v73, v71
    v_add_f32 v73, v73, v71
    v_mov_b32 v71, v73
    s_nop 1
    v_permlane32_swap_b32 v73, v71
    v_add_f32 v73, v73, v71
    v_mul_f32 v73, 0x3acccccd, v73
    v_cvt_pk_bf16_f32 v72, v72, v72
    v_lshlrev_b32 v72, 16, v72
    v_cvt_pk_bf16_f32 v73, v73, v73
    v_lshlrev_b32 v73, 16, v73
    v_add_f32 v73, 0x3727c5ac, v73
    v_cvt_pk_bf16_f32 v73, v73, v73
    v_lshlrev_b32 v73, 16, v73
    v_sqrt_f32 v73, v73
    s_nop 0
    v_cvt_pk_bf16_f32 v73, v73, v73
    v_lshlrev_b32 v73, 16, v73
    v_rcp_f32 v75, v73
    s_nop 0
    v_mov_b32 v76, 0
    v_sub_f32 v50, v50, v72
    v_cvt_pk_bf16_f32 v50, v50, v50
    v_lshlrev_b32 v50, 16, v50
    v_mul_f32 v74, v50, v75
    v_fma_f32 v77, -v74, v73, v50
    v_fma_f32 v50, v77, v75, v74
    v_sub_f32 v60, v60, v72
    v_cvt_pk_bf16_f32 v60, v60, v60
    v_lshlrev_b32 v60, 16, v60
    v_mul_f32 v74, v60, v75
    v_fma_f32 v77, -v74, v73, v60
    v_fma_f32 v60, v77, v75, v74
    v_cvt_pk_bf16_f32 v16, v50, v60
    v_lshlrev_b32 v74, 16, v16
    v_lshlrev_b32 v77, 16, v28
    v_fmac_f32 v76, v74, v77
    v_and_b32 v74, 0xffff0000, v16
    v_and_b32 v77, 0xffff0000, v28
    v_fmac_f32 v76, v74, v77
    v_sub_f32 v51, v51, v72
    v_cvt_pk_bf16_f32 v51, v51, v51
    v_lshlrev_b32 v51, 16, v51
    v_mul_f32 v74, v51, v75
    v_fma_f32 v77, -v74, v73, v51
    v_fma_f32 v51, v77, v75, v74
    v_sub_f32 v61, v61, v72
    v_cvt_pk_bf16_f32 v61, v61, v61
    v_lshlrev_b32 v61, 16, v61
    v_mul_f32 v74, v61, v75
    v_fma_f32 v77, -v74, v73, v61
    v_fma_f32 v61, v77, v75, v74
    v_cvt_pk_bf16_f32 v17, v51, v61
    v_lshlrev_b32 v74, 16, v17
    v_lshlrev_b32 v77, 16, v29
    v_fmac_f32 v76, v74, v77
    v_and_b32 v74, 0xffff0000, v17
    v_and_b32 v77, 0xffff0000, v29
    v_fmac_f32 v76, v74, v77
    v_sub_f32 v52, v52, v72
    v_cvt_pk_bf16_f32 v52, v52, v52
    v_lshlrev_b32 v52, 16, v52
    v_mul_f32 v74, v52, v75
    v_fma_f32 v77, -v74, v73, v52
    v_fma_f32 v52, v77, v75, v74
    v_sub_f32 v62, v62, v72
    v_cvt_pk_bf16_f32 v62, v62, v62
    v_lshlrev_b32 v62, 16, v62
    v_mul_f32 v74, v62, v75
    v_fma_f32 v77, -v74, v73, v62
    v_fma_f32 v62, v77, v75, v74
    v_cvt_pk_bf16_f32 v18, v52, v62
    v_lshlrev_b32 v74, 16, v18
    v_lshlrev_b32 v77, 16, v30
    v_fmac_f32 v76, v74, v77
    v_and_b32 v74, 0xffff0000, v18
    v_and_b32 v77, 0xffff0000, v30
    v_fmac_f32 v76, v74, v77
    v_sub_f32 v53, v53, v72
    v_cvt_pk_bf16_f32 v53, v53, v53
    v_lshlrev_b32 v53, 16, v53
    v_mul_f32 v74, v53, v75
    v_fma_f32 v77, -v74, v73, v53
    v_fma_f32 v53, v77, v75, v74
    v_sub_f32 v63, v63, v72
    v_cvt_pk_bf16_f32 v63, v63, v63
    v_lshlrev_b32 v63, 16, v63
    v_mul_f32 v74, v63, v75
    v_fma_f32 v77, -v74, v73, v63
    v_fma_f32 v63, v77, v75, v74
    v_cvt_pk_bf16_f32 v19, v53, v63
    v_lshlrev_b32 v74, 16, v19
    v_lshlrev_b32 v77, 16, v31
    v_fmac_f32 v76, v74, v77
    v_and_b32 v74, 0xffff0000, v19
    v_and_b32 v77, 0xffff0000, v31
    v_fmac_f32 v76, v74, v77
    v_sub_f32 v54, v54, v72
    v_cvt_pk_bf16_f32 v54, v54, v54
    v_lshlrev_b32 v54, 16, v54
    v_mul_f32 v74, v54, v75
    v_fma_f32 v77, -v74, v73, v54
    v_fma_f32 v54, v77, v75, v74
    v_sub_f32 v64, v64, v72
    v_cvt_pk_bf16_f32 v64, v64, v64
    v_lshlrev_b32 v64, 16, v64
    v_mul_f32 v74, v64, v75
    v_fma_f32 v77, -v74, v73, v64
    v_fma_f32 v64, v77, v75, v74
    v_cvt_pk_bf16_f32 v20, v54, v64
    v_lshlrev_b32 v74, 16, v20
    v_lshlrev_b32 v77, 16, v32
    v_fmac_f32 v76, v74, v77
    v_and_b32 v74, 0xffff0000, v20
    v_and_b32 v77, 0xffff0000, v32
    v_fmac_f32 v76, v74, v77
    s_add_u32 s30, s34, 0x0
    buffer_store_dwordx4 v[16:19], v3, s[4:7], s30 offen sc1
    buffer_store_dword v20, v4, s[4:7], s30 offen offset:1024 sc1
    s_nop 1
    v_add_f32_dpp v76, v76, v76 quad_perm:[1,0,3,2] row_mask:0xf bank_mask:0xf
    s_nop 1
    v_add_f32_dpp v76, v76, v76 quad_perm:[2,3,0,1] row_mask:0xf bank_mask:0xf
    s_nop 1
    v_add_f32_dpp v76, v76, v76 row_half_mirror row_mask:0xf bank_mask:0xf
    s_nop 1
    v_add_f32_dpp v76, v76, v76 row_mirror row_mask:0xf bank_mask:0xf
    v_mov_b32 v71, v76
    s_nop 1
    v_permlane16_swap_b32 v76, v71
    v_add_f32 v76, v76, v71
    v_mov_b32 v71, v76
    s_nop 1
    v_permlane32_swap_b32 v76, v71
    v_add_f32 v76, v76, v71
    v_cvt_pk_bf16_f32 v76, v76, v76
    v_lshlrev_b32 v76, 16, v76
    s_lshl_b32 s30, s29, 2
    s_add_u32 s30, s30, 0x280000
    s_mov_b64 exec, 1
    buffer_store_dword v76, off, s[4:7], s30 sc1
    s_mov_b64 exec, -1
INR_97:
    s_add_u32 s29, s28, 2
    s_cmp_ge_u32 s29, 2048
    s_cbranch_scc1 INR_98
    v_lshlrev_b32 v50, 16, v22
    v_and_b32 v60, 0xffff0000, v22
    v_lshlrev_b32 v51, 16, v23
    v_and_b32 v61, 0xffff0000, v23
    v_lshlrev_b32 v52, 16, v24
    v_and_b32 v62, 0xffff0000, v24
    v_lshlrev_b32 v53, 16, v25
    v_and_b32 v63, 0xffff0000, v25
    v_lshlrev_b32 v54, 16, v26
    v_and_b32 v64, 0xffff0000, v26
    v_add_f32 v70, v50, v60
    v_add_f32 v70, v70, v51
    v_add_f32 v70, v70, v61
    v_add_f32 v70, v70, v52
    v_add_f32 v70, v70, v62
    v_add_f32 v70, v70, v53
    v_add_f32 v70, v70, v63
    v_add_f32 v70, v70, v54
    v_add_f32 v70, v70, v64
    s_nop 1
    v_add_f32_dpp v70, v70, v70 quad_perm:[1,0,3,2] row_mask:0xf bank_mask:0xf
    s_nop 1
    v_add_f32_dpp v70, v70, v70 quad_perm:[2,3,0,1] row_mask:0xf bank_mask:0xf
    s_nop 1
    v_add_f32_dpp v70, v70, v70 row_half_mirror row_mask:0xf bank_mask:0xf
    s_nop 1
    v_add_f32_dpp v70, v70, v70 row_mirror row_mask:0xf bank_mask:0xf
    v_mov_b32 v71, v70
    s_nop 1
    v_permlane16_swap_b32 v70, v71
    v_add_f32 v70, v70, v71
    v_mov_b32 v71, v70
    s_nop 1
    v_permlane32_swap_b32 v70, v71
    v_add_f32 v70, v70, v71
    v_mul_f32 v72, 0x3acccccd, v70
    v_mov_b32 v73, 0
    v_sub_f32 v74, v50, v72
    v_fmac_f32 v73, v74, v74
    v_sub_f32 v74, v60, v72
    v_fmac_f32 v73, v74, v74
    v_sub_f32 v74, v51, v72
    v_fmac_f32 v73, v74, v74
    v_sub_f32 v74, v61, v72
    v_fmac_f32 v73, v74, v74
    v_sub_f32 v74, v52, v72
    v_fmac_f32 v73, v74, v74
    v_sub_f32 v74, v62, v72
    v_fmac_f32 v73, v74, v74
    v_sub_f32 v74, v53, v72
    v_fmac_f32 v73, v74, v74
    v_sub_f32 v74, v63, v72
    v_fmac_f32 v73, v74, v74
    v_sub_f32 v74, v54, v72
    v_fmac_f32 v73, v74, v74
    v_sub_f32 v74, v64, v72
    v_fmac_f32 v73, v74, v74
    s_nop 1
    v_add_f32_dpp v73, v73, v73 quad_perm:[1,0,3,2] row_mask:0xf bank_mask:0xf
    s_nop 1
    v_add_f32_dpp v73, v73, v73 quad_perm:[2,3,0,1] row_mask:0xf bank_mask:0xf
    s_nop 1
    v_add_f32_dpp v73, v73, v73 row_half_mirror row_mask:0xf bank_mask:0xf
    s_nop 1
    v_add_f32_dpp v73, v73, v73 row_mirror row_mask:0xf bank_mask:0xf
    v_mov_b32 v71, v73
    s_nop 1
    v_permlane16_swap_b32 v73, v71
    v_add_f32 v73, v73, v71
    v_mov_b32 v71, v73
    s_nop 1
    v_permlane32_swap_b32 v73, v71
    v_add_f32 v73, v73, v71
    v_mul_f32 v73, 0x3acccccd, v73
    v_cvt_pk_bf16_f32 v72, v72, v72
    v_lshlrev_b32 v72, 16, v72
    v_cvt_pk_bf16_f32 v73, v73, v73
    v_lshlrev_b32 v73, 16, v73
    v_add_f32 v73, 0x3727c5ac, v73
    v_cvt_pk_bf16_f32 v73, v73, v73
    v_lshlrev_b32 v73, 16, v73
    v_sqrt_f32 v73, v73
    s_nop 0
    v_cvt_pk_bf16_f32 v73, v73, v73
    v_lshlrev_b32 v73, 16, v73
    v_rcp_f32 v75, v73
    s_nop 0
    v_mov_b32 v76, 0
    v_sub_f32 v50, v50, v72
    v_cvt_pk_bf16_f32 v50, v50, v50
    v_lshlrev_b32 v50, 16, v50
    v_mul_f32 v74, v50, v75
    v_fma_f32 v77, -v74, v73, v50
    v_fma_f32 v50, v77, v75, v74
    v_sub_f32 v60, v60, v72
    v_cvt_pk_bf16_f32 v60, v60, v60
    v_lshlrev_b32 v60, 16, v60
    v_mul_f32 v74, v60, v75
    v_fma_f32 v77, -v74, v73, v60
    v_fma_f32 v60, v77, v75, v74
    v_cvt_pk_bf16_f32 v22, v50, v60
    v_lshlrev_b32 v74, 16, v22
    v_lshlrev_b32 v77, 16, v28
    v_fmac_f32 v76, v74, v77
    v_and_b32 v74, 0xffff0000, v22
    v_and_b32 v77, 0xffff0000, v28
    v_fmac_f32 v76, v74, v77
    v_sub_f32 v51, v51, v72
    v_cvt_pk_bf16_f32 v51, v51, v51
    v_lshlrev_b32 v51, 16, v51
    v_mul_f32 v74, v51, v75
    v_fma_f32 v77, -v74, v73, v51
    v_fma_f32 v51, v77, v75, v74
    v_sub_f32 v61, v61, v72
    v_cvt_pk_bf16_f32 v61, v61, v61
    v_lshlrev_b32 v61, 16, v61
    v_mul_f32 v74, v61, v75
    v_fma_f32 v77, -v74, v73, v61
    v_fma_f32 v61, v77, v75, v74
    v_cvt_pk_bf16_f32 v23, v51, v61
    v_lshlrev_b32 v74, 16, v23
    v_lshlrev_b32 v77, 16, v29
    v_fmac_f32 v76, v74, v77
    v_and_b32 v74, 0xffff0000, v23
    v_and_b32 v77, 0xffff0000, v29
    v_fmac_f32 v76, v74, v77
    v_sub_f32 v52, v52, v72
    v_cvt_pk_bf16_f32 v52, v52, v52
    v_lshlrev_b32 v52, 16, v52
    v_mul_f32 v74, v52, v75
    v_fma_f32 v77, -v74, v73, v52
    v_fma_f32 v52, v77, v75, v74
    v_sub_f32 v62, v62, v72
    v_cvt_pk_bf16_f32 v62, v62, v62
    v_lshlrev_b32 v62, 16, v62
    v_mul_f32 v74, v62, v75
    v_fma_f32 v77, -v74, v73, v62
    v_fma_f32 v62, v77, v75, v74
    v_cvt_pk_bf16_f32 v24, v52, v62
    v_lshlrev_b32 v74, 16, v24
    v_lshlrev_b32 v77, 16, v30
    v_fmac_f32 v76, v74, v77
    v_and_b32 v74, 0xffff0000, v24
    v_and_b32 v77, 0xffff0000, v30
    v_fmac_f32 v76, v74, v77
    v_sub_f32 v53, v53, v72
    v_cvt_pk_bf16_f32 v53, v53, v53
    v_lshlrev_b32 v53, 16, v53
    v_mul_f32 v74, v53, v75
    v_fma_f32 v77, -v74, v73, v53
    v_fma_f32 v53, v77, v75, v74
    v_sub_f32 v63, v63, v72
    v_cvt_pk_bf16_f32 v63, v63, v63
    v_lshlrev_b32 v63, 16, v63
    v_mul_f32 v74, v63, v75
    v_fma_f32 v77, -v74, v73, v63
    v_fma_f32 v63, v77, v75, v74
    v_cvt_pk_bf16_f32 v25, v53, v63
    v_lshlrev_b32 v74, 16, v25
    v_lshlrev_b32 v77, 16, v31
    v_fmac_f32 v76, v74, v77
    v_and_b32 v74, 0xffff0000, v25
    v_and_b32 v77, 0xffff0000, v31
    v_fmac_f32 v76, v74, v77
    v_sub_f32 v54, v54, v72
    v_cvt_pk_bf16_f32 v54, v54, v54
    v_lshlrev_b32 v54, 16, v54
    v_mul_f32 v74, v54, v75
    v_fma_f32 v77, -v74, v73, v54
    v_fma_f32 v54, v77, v75, v74
    v_sub_f32 v64, v64, v72
    v_cvt_pk_bf16_f32 v64, v64, v64
    v_lshlrev_b32 v64, 16, v64
    v_mul_f32 v74, v64, v75
    v_fma_f32 v77, -v74, v73, v64
    v_fma_f32 v64, v77, v75, v74
    v_cvt_pk_bf16_f32 v26, v54, v64
    v_lshlrev_b32 v74, 16, v26
    v_lshlrev_b32 v77, 16, v32
    v_fmac_f32 v76, v74, v77
    v_and_b32 v74, 0xffff0000, v26
    v_and_b32 v77, 0xffff0000, v32
    v_fmac_f32 v76, v74, v77
    s_add_u32 s30, s35, 0x0
    buffer_store_dwordx4 v[22:25], v3, s[4:7], s30 offen sc1
    buffer_store_dword v26, v4, s[4:7], s30 offen offset:1024 sc1
    s_nop 1
    v_add_f32_dpp v76, v76, v76 quad_perm:[1,0,3,2] row_mask:0xf bank_mask:0xf
    s_nop 1
    v_add_f32_dpp v76, v76, v76 quad_perm:[2,3,0,1] row_mask:0xf bank_mask:0xf
    s_nop 1
    v_add_f32_dpp v76, v76, v76 row_half_mirror row_mask:0xf bank_mask:0xf
    s_nop 1
    v_add_f32_dpp v76, v76, v76 row_mirror row_mask:0xf bank_mask:0xf
    v_mov_b32 v71, v76
    s_nop 1
    v_permlane16_swap_b32 v76, v71
    v_add_f32 v76, v76, v71
    v_mov_b32 v71, v76
    s_nop 1
    v_permlane32_swap_b32 v76, v71
    v_add_f32 v76, v76, v71
    v_cvt_pk_bf16_f32 v76, v76, v76
    v_lshlrev_b32 v76, 16, v76
    s_lshl_b32 s30, s29, 2
    s_add_u32 s30, s30, 0x280000
    s_mov_b64 exec, 1
    buffer_store_dword v76, off, s[4:7], s30 sc1
    s_mov_b64 exec, -1
INR_98:
    s_lshl_b32 s29, s96, 2
    s_add_u32 s29, s29, s14
    s_lshl_b32 s29, s29, 6
    v_add_u32 v5, s29, v0
    v_lshlrev_b32 v6, 4, v5
    v_mov_b32 v40, -1
    v_mov_b32 v44, 0
    v_mov_b32 v41, -1
    v_mov_b32 v45, 0
    v_mov_b32 v42, -1
    v_mov_b32 v46, 0
    v_mov_b32 v43, -1
    v_mov_b32 v47, 0
    v_cmp_gt_u32 vcc, 0x1000, v5
    s_nop 0
    s_and_saveexec_b64 s[38:39], vcc
    s_cbranch_execz INF_99
    s_mov_b32 s30, 0x290000
    buffer_store_dwordx4 v[44:47], v6, s[4:7], s30 offen sc1
INF_99:
    s_mov_b64 exec, s[38:39]
    s_waitcnt vmcnt(0)
    s_barrier
    s_cmp_lg_u32 s14, 0
    s_cbranch_scc1 INA_100
    v_mov_b32 v8, 1
    s_mov_b64 exec, 1
    buffer_atomic_add v8, off, s[60:63], s95 sc1
    s_mov_b64 exec, -1
INA_100:
    v_cmp_gt_u32 vcc, 0x5000, v5
    s_nop 0
    s_and_saveexec_b64 s[38:39], vcc
    s_cbranch_execz INF_101
    s_mov_b32 s30, 0x300000
    buffer_store_dwordx4 v[40:43], v6, s[4:7], s30 offen sc1
INF_101:
    s_mov_b64 exec, s[38:39]
    v_lshrrev_b32 v7, 6, v5
    v_mul_u32_u24 v7, 52429, v7
    v_lshrrev_b32 v7, 18, v7
    v_mul_u32_u24 v8, 320, v7
    v_sub_u32 v8, v5, v8
    v_lshlrev_b32 v48, 4, v8
    v_lshl_add_u32 v49, v7, 13, v48
    v_cmp_gt_u32 vcc, 0xa000, v5
    s_nop 0
    s_and_saveexec_b64 s[38:39], vcc
    s_cbranch_execz INF_102
    s_mov_b32 s30, 0x5904000
    buffer_store_dwordx4 v[40:43], v49, s[4:7], s30 offen sc1
INF_102:
    s_mov_b64 exec, s[38:39]
    s_mov_b32 s65, 0
CW_103:
    buffer_load_dwordx2 v[8:9], off, s[60:63], 0 offset:132 sc1
    s_add_u32 s65, s65, 1
    s_waitcnt vmcnt(0)
    v_readfirstlane_b32 s31, v8
    v_readfirstlane_b32 s32, v9
    s_min_u32 s64, s31, s32
    s_cmp_lg_u32 s64, 0
    s_cbranch_scc1 CWD_104
    s_cmp_gt_u32 s65, 65536
    s_cbranch_scc1 CWD_104
    s_sleep 4
    s_branch CW_103
CWD_104:
    s_sub_u32 s31, s31, 1
    s_and_b32 s31, s31, 3
    s_sub_u32 s32, s32, 1
    s_and_b32 s32, s32, 3
    s_lshl_b32 s31, s31, 13
    s_lshl_b32 s32, s32, 13
    s_add_u32 s32, s32, 0x200000
    v_and_b32 v8, 1, v7
    v_cmp_eq_u32 vcc, 1, v8
    v_mov_b32 v8, s31
    v_mov_b32 v9, s32
    v_cndmask_b32 v8, v8, v9, vcc
    v_lshrrev_b32 v9, 1, v7
    v_lshl_add_u32 v8, v9, 15, v8
    v_add_u32 v49, v8, v48
    v_cmp_le_u32 vcc, 640, v5
    v_mov_b32 v9, 0x40000000
    s_nop 0
    v_cndmask_b32 v49, v9, v49, vcc
    v_cmp_gt_u32 vcc, 0xa000, v5
    s_nop 0
    s_and_saveexec_b64 s[38:39], vcc
    s_cbranch_execz INF_105
    s_mov_b32 s30, 0x6000000
    buffer_store_dwordx4 v[40:43], v49, s[4:7], s30 offen sc1
INF_105:
    s_mov_b64 exec, s[38:39]
    s_cmp_ge_u32 s96, 10
    s_cbranch_scc1 INM1_106
    s_cmp_ge_u32 s14, 2
    s_cbranch_scc1 INM1_106
    s_cmp_ge_u32 s96, 5
    s_cselect_b32 s36, 1, 0
    s_mul_i32 s29, s36, 5
    s_sub_u32 s29, s96, s29
    s_lshl_b32 s29, s29, 10
    s_lshl_b32 s30, s36, 13
    s_add_u32 s30, s30, 0x5900000
    s_cmp_eq_u32 s36, 0
    s_cselect_b32 s37, s31, s32
    s_add_u32 s37, s37, 0x6000000
    s_cmp_eq_u32 s14, 0
    s_cselect_b32 s30, s30, s37
    s_add_u32 s30, s30, s29
    buffer_store_dwordx4 v[34:37], v3, s[4:7], s30 offen sc1
INM1_106:
    s_lshl_b32 s40, s13, 8
    s_lshl_b32 s42, s14, 6
    s_add_u32 s40, s40, s42
    s_mul_i32 s41, s14, 36864
    v_lshrrev_b32 v80, 2, v0
    v_mul_u32_u24 v79, 8192, v80
    v_lshrrev_b32 v80, 5, v0
    v_lshlrev_b32 v80, 1, v80
    v_and_b32 v81, 3, v0
    v_xor_b32 v80, v80, v81
    v_lshl_add_u32 v79, v80, 4, v79
    s_add_u32 m0, s41, 0
    s_add_u32 s42, s40, 0x0
    buffer_load_dwordx4 v79, s[44:47], s42 offen lds
    s_add_u32 m0, s41, 1024
    s_add_u32 s42, s40, 0x20000
    buffer_load_dwordx4 v79, s[44:47], s42 offen lds
    s_add_u32 m0, s41, 2048
    s_add_u32 s42, s40, 0x40000
    buffer_load_dwordx4 v79, s[44:47], s42 offen lds
    s_add_u32 m0, s41, 3072
    s_add_u32 s42, s40, 0x60000
    buffer_load_dwordx4 v79, s[44:47], s42 offen lds
    s_add_u32 m0, s41, 4096
    s_add_u32 s42, s40, 0x80000
    buffer_load_dwordx4 v79, s[44:47], s42 offen lds
    s_add_u32 m0, s41, 5120
    s_add_u32 s42, s40, 0xa0000
    buffer_load_dwordx4 v79, s[44:47], s42 offen lds
    s_add_u32 m0, s41, 6144
    s_add_u32 s42, s40, 0xc0000
    buffer_load_dwordx4 v79, s[44:47], s42 offen lds
    s_add_u32 m0, s41, 7168
    s_add_u32 s42, s40, 0xe0000
    buffer_load_dwordx4 v79, s[44:47], s42 offen lds
    s_add_u32 m0, s41, 8192
    s_add_u32 s42, s40, 0x100000
    buffer_load_dwordx4 v79, s[44:47], s42 offen lds
    s_add_u32 m0, s41, 9216
    s_add_u32 s42, s40, 0x120000
    buffer_load_dwordx4 v79, s[44:47], s42 offen lds
    s_add_u32 m0, s41, 10240
    s_add_u32 s42, s40, 0x140000
    buffer_load_dwordx4 v79, s[44:47], s42 offen lds
    s_add_u32 m0, s41, 11264
    s_add_u32 s42, s40, 0x160000
    buffer_load_dwordx4 v79, s[44:47], s42 offen lds
    s_add_u32 m0, s41, 12288
    s_add_u32 s42, s40, 0x180000
    buffer_load_dwordx4 v79, s[44:47], s42 offen lds
    s_add_u32 m0, s41, 13312
    s_add_u32 s42, s40, 0x1a0000
    buffer_load_dwordx4 v79, s[44:47], s42 offen lds
    s_add_u32 m0, s41, 14336
    s_add_u32 s42, s40, 0x1c0000
    buffer_load_dwordx4 v79, s[44:47], s42 offen lds
    s_add_u32 m0, s41, 15360
    s_add_u32 s42, s40, 0x1e0000
    buffer_load_dwordx4 v79, s[44:47], s42 offen lds
    s_add_u32 m0, s41, 16384
    s_add_u32 s42, s40, 0x200000
    buffer_load_dwordx4 v79, s[44:47], s42 offen lds
    s_add_u32 m0, s41, 17408
    s_add_u32 s42, s40, 0x220000
    buffer_load_dwordx4 v79, s[44:47], s42 offen lds
    s_add_u32 m0, s41, 18432
    s_add_u32 s42, s40, 0x240000
    buffer_load_dwordx4 v79, s[44:47], s42 offen lds
    s_add_u32 m0, s41, 19456
    s_add_u32 s42, s40, 0x260000
    buffer_load_dwordx4 v79, s[44:47], s42 offen lds
    s_add_u32 m0, s41, 20480
    s_add_u32 s42, s40, 0x280000
    buffer_load_dwordx4 v79, s[44:47], s42 offen lds
    s_add_u32 m0, s41, 21504
    s_add_u32 s42, s40, 0x2a0000
    buffer_load_dwordx4 v79, s[44:47], s42 offen lds
    s_add_u32 m0, s41, 22528
    s_add_u32 s42, s40, 0x2c0000
    buffer_load_dwordx4 v79, s[44:47], s42 offen lds
    s_add_u32 m0, s41, 23552
    s_add_u32 s42, s40, 0x2e0000
    buffer_load_dwordx4 v79, s[44:47], s42 offen lds
    s_add_u32 m0, s41, 24576
    s_add_u32 s42, s40, 0x300000
    buffer_load_dwordx4 v79, s[44:47], s42 offen lds
    s_add_u32 m0, s41, 25600
    s_add_u32 s42, s40, 0x320000
    buffer_load_dwordx4 v79, s[44:47], s42 offen lds
    s_add_u32 m0, s41, 26624
    s_add_u32 s42, s40, 0x340000
    buffer_load_dwordx4 v79, s[44:47], s42 offen lds
    s_add_u32 m0, s41, 27648
    s_add_u32 s42, s40, 0x360000
    buffer_load_dwordx4 v79, s[44:47], s42 offen lds
    s_add_u32 m0, s41, 28672
    s_add_u32 s42, s40, 0x380000
    buffer_load_dwordx4 v79, s[44:47], s42 offen lds
    s_add_u32 m0, s41, 29696
    s_add_u32 s42, s40, 0x3a0000
    buffer_load_dwordx4 v79, s[44:47], s42 offen lds
    s_add_u32 m0, s41, 30720
    s_add_u32 s42, s40, 0x3c0000
    buffer_load_dwordx4 v79, s[44:47], s42 offen lds
    s_add_u32 m0, s41, 31744
    s_add_u32 s42, s40, 0x3e0000
    buffer_load_dwordx4 v79, s[44:47], s42 offen lds
    s_add_u32 m0, s41, 32768
    s_add_u32 s42, s40, 0x400000
    buffer_load_dwordx4 v79, s[44:47], s42 offen lds
    s_add_u32 m0, s41, 33792
    s_add_u32 s42, s40, 0x420000
    buffer_load_dwordx4 v79, s[44:47], s42 offen lds
    s_add_u32 m0, s41, 34816
    s_add_u32 s42, s40, 0x440000
    buffer_load_dwordx4 v79, s[44:47], s42 offen lds
    s_add_u32 m0, s41, 35840
    s_add_u32 s42, s40, 0x460000
    buffer_load_dwordx4 v79, s[44:47], s42 offen lds
    v_mbcnt_lo_u32_b32 v0, -1, 0
    v_mbcnt_hi_u32_b32 v0, -1, v0
    s_cmp_eq_u32 s3, 0
    s_cbranch_scc1 H_E0
    s_cmp_eq_u32 s3, 1
    s_cbranch_scc1 H_E1
    s_cmp_eq_u32 s3, 2
    s_cbranch_scc1 H_E2
    s_branch M_EXIT
H_E0:
    s_lshl_b32 s16, s13, 14
    s_mov_b32 s17, 0x80000
    s_lshl_b32 s64, s14, 10
    s_add_u32 s16, s16, 0x1400000
    s_add_u32 s16, s16, s64
    s_mul_i32 s64, s12, s17
    s_lshl_b32 s64, s64, 2
    s_add_u32 s16, s16, s64
    s_lshl_b32 s18, s13, 4
    s_add_u32 s18, s18, 0x291000
    s_branch G_T
H_E1:
    s_lshl_b32 s16, s13, 14
    s_mov_b32 s17, 0x80000
    s_lshl_b32 s64, s14, 11
    s_add_u32 s16, s16, 0x1402000
    s_add_u32 s16, s16, s64
    s_mul_i32 s64, s12, s17
    s_lshl_b32 s64, s64, 2
    s_add_u32 s16, s16, s64
    s_lshl_b32 s18, s13, 4
    s_add_u32 s18, s18, 0x291004
    s_branch G_N
H_E2:
    s_lshl_b32 s16, s13, 13
    s_mov_b32 s17, 0x40000
    s_lshl_b32 s64, s14, 10
    s_add_u32 s16, s16, 0x3400000
    s_add_u32 s16, s16, s64
    s_mul_i32 s64, s12, s17
    s_lshl_b32 s64, s64, 2
    s_add_u32 s16, s16, s64
    s_lshl_b32 s18, s13, 4
    s_add_u32 s18, s18, 0x291008
    s_branch G_T
G_T:
    s_lshl_b32 s65, s13, 8
    s_lshl_b32 s66, s14, 6
    s_add_u32 s20, s65, s66
    s_mul_i32 s21, s14, 36864
    v_lshrrev_b32 v6, 2, v0
    v_mul_u32_u24 v5, 8192, v6
    v_lshrrev_b32 v6, 5, v0
    v_lshlrev_b32 v6, 1, v6
    v_and_b32 v7, 3, v0
    v_xor_b32 v6, v6, v7
    v_lshl_add_u32 v5, v6, 4, v5
    v_lshrrev_b32 v6, 5, v0
    v_lshlrev_b32 v3, 10, v6
    v_bfe_u32 v6, v0, 2, 2
    v_lshl_add_u32 v3, v6, 6, v3
    v_and_b32 v6, 3, v0
    v_lshl_add_u32 v3, v6, 3, v3
    v_bfe_u32 v6, v0, 4, 1
    v_lshl_add_u32 v3, v6, 9, v3
    v_add_u32 v3, s21, v3
    v_lshlrev_b32 v6, 5, v6
    v_sub_u32 v4, 32, v6
    v_add_u32 v4, v4, v3
    v_add_u32 v3, v3, v6
    s_waitcnt vmcnt(0)
    ds_read_b64_tr_b16 v[96:97], v3 offset:0
    ds_read_b64_tr_b16 v[98:99], v3 offset:256
    ds_read_b64_tr_b16 v[100:101], v4 offset:0
    ds_read_b64_tr_b16 v[102:103], v4 offset:256
    ds_read_b64_tr_b16 v[104:105], v3 offset:2048
    ds_read_b64_tr_b16 v[106:107], v3 offset:2304
    ds_read_b64_tr_b16 v[108:109], v4 offset:2048
    ds_read_b64_tr_b16 v[110:111], v4 offset:2304
    s_waitcnt lgkmcnt(0)
    s_add_u32 m0, s21, 0
    s_add_u32 s64, s20, 0x480000
    buffer_load_dwordx4 v5, s[44:47], s64 offen lds
    s_add_u32 m0, s21, 1024
    s_add_u32 s64, s20, 0x4a0000
    buffer_load_dwordx4 v5, s[44:47], s64 offen lds
    s_add_u32 m0, s21, 2048
    s_add_u32 s64, s20, 0x4c0000
    buffer_load_dwordx4 v5, s[44:47], s64 offen lds
    s_add_u32 m0, s21, 3072
    s_add_u32 s64, s20, 0x4e0000
    buffer_load_dwordx4 v5, s[44:47], s64 offen lds
    ds_read_b64_tr_b16 v[112:113], v3 offset:4096
    ds_read_b64_tr_b16 v[114:115], v3 offset:4352
    ds_read_b64_tr_b16 v[116:117], v4 offset:4096
    ds_read_b64_tr_b16 v[118:119], v4 offset:4352
    ds_read_b64_tr_b16 v[120:121], v3 offset:6144
    ds_read_b64_tr_b16 v[122:123], v3 offset:6400
    ds_read_b64_tr_b16 v[124:125], v4 offset:6144
    ds_read_b64_tr_b16 v[126:127], v4 offset:6400
    s_waitcnt lgkmcnt(0)
    ds_read_b64_tr_b16 v[128:129], v3 offset:8192
    ds_read_b64_tr_b16 v[130:131], v3 offset:8448
    ds_read_b64_tr_b16 v[132:133], v4 offset:8192
    ds_read_b64_tr_b16 v[134:135], v4 offset:8448
    ds_read_b64_tr_b16 v[136:137], v3 offset:10240
    ds_read_b64_tr_b16 v[138:139], v3 offset:10496
    ds_read_b64_tr_b16 v[140:141], v4 offset:10240
    ds_read_b64_tr_b16 v[142:143], v4 offset:10496
    s_waitcnt lgkmcnt(0)
    ds_read_b64_tr_b16 v[144:145], v3 offset:12288
    ds_read_b64_tr_b16 v[146:147], v3 offset:12544
    ds_read_b64_tr_b16 v[148:149], v4 offset:12288
    ds_read_b64_tr_b16 v[150:151], v4 offset:12544
    ds_read_b64_tr_b16 v[152:153], v3 offset:14336
    ds_read_b64_tr_b16 v[154:155], v3 offset:14592
    ds_read_b64_tr_b16 v[156:157], v4 offset:14336
    ds_read_b64_tr_b16 v[158:159], v4 offset:14592
    s_waitcnt lgkmcnt(0)
    ds_read_b64_tr_b16 v[160:161], v3 offset:16384
    ds_read_b64_tr_b16 v[162:163], v3 offset:16640
    ds_read_b64_tr_b16 v[164:165], v4 offset:16384
    ds_read_b64_tr_b16 v[166:167], v4 offset:16640
    ds_read_b64_tr_b16 v[168:169], v3 offset:18432
    ds_read_b64_tr_b16 v[170:171], v3 offset:18688
    ds_read_b64_tr_b16 v[172:173], v4 offset:18432
    ds_read_b64_tr_b16 v[174:175], v4 offset:18688
    s_waitcnt lgkmcnt(0)
    ds_read_b64_tr_b16 v[176:177], v3 offset:20480
    ds_read_b64_tr_b16 v[178:179], v3 offset:20736
    ds_read_b64_tr_b16 v[180:181], v4 offset:20480
    ds_read_b64_tr_b16 v[182:183], v4 offset:20736
    ds_read_b64_tr_b16 v[184:185], v3 offset:22528
    ds_read_b64_tr_b16 v[186:187], v3 offset:22784
    ds_read_b64_tr_b16 v[188:189], v4 offset:22528
    ds_read_b64_tr_b16 v[190:191], v4 offset:22784
    s_waitcnt lgkmcnt(0)
    ds_read_b64_tr_b16 v[192:193], v3 offset:24576
    ds_read_b64_tr_b16 v[194:195], v3 offset:24832
    ds_read_b64_tr_b16 v[196:197], v4 offset:24576
    ds_read_b64_tr_b16 v[198:199], v4 offset:24832
    ds_read_b64_tr_b16 v[200:201], v3 offset:26624
    ds_read_b64_tr_b16 v[202:203], v3 offset:26880
    ds_read_b64_tr_b16 v[204:205], v4 offset:26624
    ds_read_b64_tr_b16 v[206:207], v4 offset:26880
    s_waitcnt lgkmcnt(0)
    ds_read_b64_tr_b16 v[208:209], v3 offset:28672
    ds_read_b64_tr_b16 v[210:211], v3 offset:28928
    ds_read_b64_tr_b16 v[212:213], v4 offset:28672
    ds_read_b64_tr_b16 v[214:215], v4 offset:28928
    ds_read_b64_tr_b16 v[216:217], v3 offset:30720
    ds_read_b64_tr_b16 v[218:219], v3 offset:30976
    ds_read_b64_tr_b16 v[220:221], v4 offset:30720
    ds_read_b64_tr_b16 v[222:223], v4 offset:30976
    s_waitcnt lgkmcnt(0)
    ds_read_b64_tr_b16 v[224:225], v3 offset:32768
    ds_read_b64_tr_b16 v[226:227], v3 offset:33024
    ds_read_b64_tr_b16 v[228:229], v4 offset:32768
    ds_read_b64_tr_b16 v[230:231], v4 offset:33024
    ds_read_b64_tr_b16 v[232:233], v3 offset:34816
    ds_read_b64_tr_b16 v[234:235], v3 offset:35072
    ds_read_b64_tr_b16 v[236:237], v4 offset:34816
    ds_read_b64_tr_b16 v[238:239], v4 offset:35072
    s_waitcnt lgkmcnt(0)
    s_waitcnt vmcnt(0)
    ds_read_b64_tr_b16 v[240:241], v3 offset:0
    ds_read_b64_tr_b16 v[242:243], v3 offset:256
    ds_read_b64_tr_b16 v[244:245], v4 offset:0
    ds_read_b64_tr_b16 v[246:247], v4 offset:256
    ds_read_b64_tr_b16 v[248:249], v3 offset:2048
    ds_read_b64_tr_b16 v[250:251], v3 offset:2304
    ds_read_b64_tr_b16 v[252:253], v4 offset:2048
    ds_read_b64_tr_b16 v[254:255], v4 offset:2304
    s_waitcnt lgkmcnt(0)
    s_cmp_lg_u32 s97, 0
    s_cbranch_scc1 CM_107
    v_mbcnt_lo_u32_b32 v0, -1, 0
    v_mbcnt_hi_u32_b32 v0, -1, v0
    v_mul_u32_u24 v8, 32, v0
    s_mov_b32 s64, 0x0
    s_mov_b32 s65, 0
    s_mov_b64 exec, 0xff
TK_108:
    buffer_load_dword v9, v8, s[60:63], s64 offen sc1
    s_add_u32 s65, s65, 1
    s_waitcnt vmcnt(0)
    s_mov_b32 s66, 0
    v_readlane_b32 s67, v9, 0
    s_add_u32 s66, s66, s67
    v_readlane_b32 s67, v9, 1
    s_add_u32 s66, s66, s67
    v_readlane_b32 s67, v9, 2
    s_add_u32 s66, s66, s67
    v_readlane_b32 s67, v9, 3
    s_add_u32 s66, s66, s67
    v_readlane_b32 s67, v9, 4
    s_add_u32 s66, s66, s67
    v_readlane_b32 s67, v9, 5
    s_add_u32 s66, s66, s67
    v_readlane_b32 s67, v9, 6
    s_add_u32 s66, s66, s67
    v_readlane_b32 s67, v9, 7
    s_add_u32 s66, s66, s67
    s_cmp_ge_u32 s66, 256
    s_cbranch_scc1 TKD_109
    s_cmp_gt_u32 s65, 262144
    s_cbranch_scc0 TK_108
TKD_109:
    v_cmp_ne_u32 vcc, 32, v9
    s_mov_b64 exec, -1
    s_cbranch_vccnz M_SLOW
CM_107:
    s_mov_b32 s65, 0
GI_110:
    buffer_load_dword v8, off, s[60:63], s95 sc1
    s_add_u32 s65, s65, 1
    s_waitcnt vmcnt(0)
    v_readfirstlane_b32 s64, v8
    s_cmp_ge_u32 s64, 192
    s_cbranch_scc1 GID_111
    s_cmp_gt_u32 s65, 65536
    s_cbranch_scc1 GID_111
    s_sleep 4
    s_branch GI_110
GID_111:
    v_mbcnt_lo_u32_b32 v0, -1, 0
    v_mbcnt_hi_u32_b32 v0, -1, v0
    s_waitcnt vmcnt(0)
    s_barrier
    s_cmp_lg_u32 s14, 0
    s_cbranch_scc1 INE_112
    s_cmp_lg_u32 s96, 10
    s_cbranch_scc1 ING_113
    v_mov_b32 v44, 1
    v_lshlrev_b32 v6, 7, v0
    s_mov_b32 s65, 0x29a000
    s_mov_b64 exec, 3
    buffer_store_dword v44, v6, s[4:7], s65 offen sc1
    s_mov_b64 exec, -1
    s_waitcnt vmcnt(0)
ING_113:
    v_mov_b32 v8, 1
    s_mov_b32 s65, 0x290800
    s_mov_b64 exec, 1
    buffer_atomic_add v8, off, s[4:7], s65 sc1
    s_mov_b64 exec, -1
INE_112:
    s_cmp_lg_u32 s3, 2
    s_cbranch_scc1 NOSEL_114
    s_or_b32 s64, s13, s12
    s_or_b32 s64, s64, s14
    s_cmp_lg_u32 s64, 0
    s_cbranch_scc1 NOSEL_114
    s_mov_b32 s29, 0
    v_lshlrev_b32 v1, 4, v0
    s_mov_b32 s64, 0x280000
    buffer_load_dwordx4 v[16:19], v1, s[4:7], s64 offen offset:0 sc1
    buffer_load_dwordx4 v[20:23], v1, s[4:7], s64 offen offset:1024 sc1
    buffer_load_dwordx4 v[24:27], v1, s[4:7], s64 offen offset:2048 sc1
    buffer_load_dwordx4 v[28:31], v1, s[4:7], s64 offen offset:3072 sc1
    s_add_u32 s64, s64, 4096
    buffer_load_dwordx4 v[32:35], v1, s[4:7], s64 offen offset:0 sc1
    buffer_load_dwordx4 v[36:39], v1, s[4:7], s64 offen offset:1024 sc1
    buffer_load_dwordx4 v[40:43], v1, s[4:7], s64 offen offset:2048 sc1
    buffer_load_dwordx4 v[44:47], v1, s[4:7], s64 offen offset:3072 sc1
    s_waitcnt vmcnt(0)
    v_lshlrev_b32 v2, 2, v0
    v_ashrrev_i32 v3, 31, v16
    v_or_b32 v3, 0x80000000, v3
    v_xor_b32 v16, v16, v3
    v_and_b32 v16, 0xffff0000, v16
    v_sub_u32 v3, 65535, v2
    v_or_b32 v16, v16, v3
    v_ashrrev_i32 v3, 31, v17
    v_or_b32 v3, 0x80000000, v3
    v_xor_b32 v17, v17, v3
    v_and_b32 v17, 0xffff0000, v17
    v_sub_u32 v3, 65534, v2
    v_or_b32 v17, v17, v3
    v_ashrrev_i32 v3, 31, v18
    v_or_b32 v3, 0x80000000, v3
    v_xor_b32 v18, v18, v3
    v_and_b32 v18, 0xffff0000, v18
    v_sub_u32 v3, 65533, v2
    v_or_b32 v18, v18, v3
    v_ashrrev_i32 v3, 31, v19
    v_or_b32 v3, 0x80000000, v3
    v_xor_b32 v19, v19, v3
    v_and_b32 v19, 0xffff0000, v19
    v_sub_u32 v3, 65532, v2
    v_or_b32 v19, v19, v3
    v_ashrrev_i32 v3, 31, v20
    v_or_b32 v3, 0x80000000, v3
    v_xor_b32 v20, v20, v3
    v_and_b32 v20, 0xffff0000, v20
    v_sub_u32 v3, 65279, v2
    v_or_b32 v20, v20, v3
    v_ashrrev_i32 v3, 31, v21
    v_or_b32 v3, 0x80000000, v3
    v_xor_b32 v21, v21, v3
    v_and_b32 v21, 0xffff0000, v21
    v_sub_u32 v3, 65278, v2
    v_or_b32 v21, v21, v3
    v_ashrrev_i32 v3, 31, v22
    v_or_b32 v3, 0x80000000, v3
    v_xor_b32 v22, v22, v3
    v_and_b32 v22, 0xffff0000, v22
    v_sub_u32 v3, 65277, v2
    v_or_b32 v22, v22, v3
    v_ashrrev_i32 v3, 31, v23
    v_or_b32 v3, 0x80000000, v3
    v_xor_b32 v23, v23, v3
    v_and_b32 v23, 0xffff0000, v23
    v_sub_u32 v3, 65276, v2
    v_or_b32 v23, v23, v3
    v_ashrrev_i32 v3, 31, v24
    v_or_b32 v3, 0x80000000, v3
    v_xor_b32 v24, v24, v3
    v_and_b32 v24, 0xffff0000, v24
    v_sub_u32 v3, 65023, v2
    v_or_b32 v24, v24, v3
    v_ashrrev_i32 v3, 31, v25
    v_or_b32 v3, 0x80000000, v3
    v_xor_b32 v25, v25, v3
    v_and_b32 v25, 0xffff0000, v25
    v_sub_u32 v3, 65022, v2
    v_or_b32 v25, v25, v3
    v_ashrrev_i32 v3, 31, v26
    v_or_b32 v3, 0x80000000, v3
    v_xor_b32 v26, v26, v3
    v_and_b32 v26, 0xffff0000, v26
    v_sub_u32 v3, 65021, v2
    v_or_b32 v26, v26, v3
    v_ashrrev_i32 v3, 31, v27
    v_or_b32 v3, 0x80000000, v3
    v_xor_b32 v27, v27, v3
    v_and_b32 v27, 0xffff0000, v27
    v_sub_u32 v3, 65020, v2
    v_or_b32 v27, v27, v3
    v_ashrrev_i32 v3, 31, v28
    v_or_b32 v3, 0x80000000, v3
    v_xor_b32 v28, v28, v3
    v_and_b32 v28, 0xffff0000, v28
    v_sub_u32 v3, 64767, v2
    v_or_b32 v28, v28, v3
    v_ashrrev_i32 v3, 31, v29
    v_or_b32 v3, 0x80000000, v3
    v_xor_b32 v29, v29, v3
    v_and_b32 v29, 0xffff0000, v29
    v_sub_u32 v3, 64766, v2
    v_or_b32 v29, v29, v3
    v_ashrrev_i32 v3, 31, v30
    v_or_b32 v3, 0x80000000, v3
    v_xor_b32 v30, v30, v3
    v_and_b32 v30, 0xffff0000, v30
    v_sub_u32 v3, 64765, v2
    v_or_b32 v30, v30, v3
    v_ashrrev_i32 v3, 31, v31
    v_or_b32 v3, 0x80000000, v3
    v_xor_b32 v31, v31, v3
    v_and_b32 v31, 0xffff0000, v31
    v_sub_u32 v3, 64764, v2
    v_or_b32 v31, v31, v3
    v_ashrrev_i32 v3, 31, v32
    v_or_b32 v3, 0x80000000, v3
    v_xor_b32 v32, v32, v3
    v_and_b32 v32, 0xffff0000, v32
    v_sub_u32 v3, 64511, v2
    v_or_b32 v32, v32, v3
    v_ashrrev_i32 v3, 31, v33
    v_or_b32 v3, 0x80000000, v3
    v_xor_b32 v33, v33, v3
    v_and_b32 v33, 0xffff0000, v33
    v_sub_u32 v3, 64510, v2
    v_or_b32 v33, v33, v3
    v_ashrrev_i32 v3, 31, v34
    v_or_b32 v3, 0x80000000, v3
    v_xor_b32 v34, v34, v3
    v_and_b32 v34, 0xffff0000, v34
    v_sub_u32 v3, 64509, v2
    v_or_b32 v34, v34, v3
    v_ashrrev_i32 v3, 31, v35
    v_or_b32 v3, 0x80000000, v3
    v_xor_b32 v35, v35, v3
    v_and_b32 v35, 0xffff0000, v35
    v_sub_u32 v3, 64508, v2
    v_or_b32 v35, v35, v3
    v_ashrrev_i32 v3, 31, v36
    v_or_b32 v3, 0x80000000, v3
    v_xor_b32 v36, v36, v3
    v_and_b32 v36, 0xffff0000, v36
    v_sub_u32 v3, 64255, v2
    v_or_b32 v36, v36, v3
    v_ashrrev_i32 v3, 31, v37
    v_or_b32 v3, 0x80000000, v3
    v_xor_b32 v37, v37, v3
    v_and_b32 v37, 0xffff0000, v37
    v_sub_u32 v3, 64254, v2
    v_or_b32 v37, v37, v3
    v_ashrrev_i32 v3, 31, v38
    v_or_b32 v3, 0x80000000, v3
    v_xor_b32 v38, v38, v3
    v_and_b32 v38, 0xffff0000, v38
    v_sub_u32 v3, 64253, v2
    v_or_b32 v38, v38, v3
    v_ashrrev_i32 v3, 31, v39
    v_or_b32 v3, 0x80000000, v3
    v_xor_b32 v39, v39, v3
    v_and_b32 v39, 0xffff0000, v39
    v_sub_u32 v3, 64252, v2
    v_or_b32 v39, v39, v3
    v_ashrrev_i32 v3, 31, v40
    v_or_b32 v3, 0x80000000, v3
    v_xor_b32 v40, v40, v3
    v_and_b32 v40, 0xffff0000, v40
    v_sub_u32 v3, 63999, v2
    v_or_b32 v40, v40, v3
    v_ashrrev_i32 v3, 31, v41
    v_or_b32 v3, 0x80000000, v3
    v_xor_b32 v41, v41, v3
    v_and_b32 v41, 0xffff0000, v41
    v_sub_u32 v3, 63998, v2
    v_or_b32 v41, v41, v3
    v_ashrrev_i32 v3, 31, v42
    v_or_b32 v3, 0x80000000, v3
    v_xor_b32 v42, v42, v3
    v_and_b32 v42, 0xffff0000, v42
    v_sub_u32 v3, 63997, v2
    v_or_b32 v42, v42, v3
    v_ashrrev_i32 v3, 31, v43
    v_or_b32 v3, 0x80000000, v3
    v_xor_b32 v43, v43, v3
    v_and_b32 v43, 0xffff0000, v43
    v_sub_u32 v3, 63996, v2
    v_or_b32 v43, v43, v3
    v_ashrrev_i32 v3, 31, v44
    v_or_b32 v3, 0x80000000, v3
    v_xor_b32 v44, v44, v3
    v_and_b32 v44, 0xffff0000, v44
    v_sub_u32 v3, 63743, v2
    v_or_b32 v44, v44, v3
    v_ashrrev_i32 v3, 31, v45
    v_or_b32 v3, 0x80000000, v3
    v_xor_b32 v45, v45, v3
    v_and_b32 v45, 0xffff0000, v45
    v_sub_u32 v3, 63742, v2
    v_or_b32 v45, v45, v3
    v_ashrrev_i32 v3, 31, v46
    v_or_b32 v3, 0x80000000, v3
    v_xor_b32 v46, v46, v3
    v_and_b32 v46, 0xffff0000, v46
    v_sub_u32 v3, 63741, v2
    v_or_b32 v46, v46, v3
    v_ashrrev_i32 v3, 31, v47
    v_or_b32 v3, 0x80000000, v3
    v_xor_b32 v47, v47, v3
    v_and_b32 v47, 0xffff0000, v47
    v_sub_u32 v3, 63740, v2
    v_or_b32 v47, v47, v3
    v_max3_u32 v4, v16, v17, v18
    v_max3_u32 v4, v4, v19, v20
    v_max3_u32 v4, v4, v21, v22
    v_max3_u32 v4, v4, v23, v24
    v_max3_u32 v4, v4, v25, v26
    v_max3_u32 v4, v4, v27, v28
    v_max3_u32 v4, v4, v29, v30
    v_max3_u32 v4, v4, v31, v32
    v_max3_u32 v4, v4, v33, v34
    v_max3_u32 v4, v4, v35, v36
    v_max3_u32 v4, v4, v37, v38
    v_max3_u32 v4, v4, v39, v40
    v_max3_u32 v4, v4, v41, v42
    v_max3_u32 v4, v4, v43, v44
    v_max3_u32 v4, v4, v45, v46
    v_max_u32 v4, v4, v47
    s_nop 1
    v_max_u32_dpp v4, v4, v4 quad_perm:[1,0,3,2] row_mask:0xf bank_mask:0xf
    s_nop 1
    v_max_u32_dpp v4, v4, v4 quad_perm:[2,3,0,1] row_mask:0xf bank_mask:0xf
    s_nop 1
    v_max_u32_dpp v4, v4, v4 row_half_mirror row_mask:0xf bank_mask:0xf
    s_nop 1
    v_max_u32_dpp v4, v4, v4 row_mirror row_mask:0xf bank_mask:0xf
    v_mov_b32 v5, v4
    s_nop 1
    v_permlane16_swap_b32 v4, v5
    v_max_u32 v4, v4, v5
    v_mov_b32 v5, v4
    s_nop 1
    v_permlane32_swap_b32 v4, v5
    v_max_u32 v4, v4, v5
    v_mov_b32 v56, v4
    v_cmp_eq_u32 vcc, v4, v16
    s_nop 1
    v_cndmask_b32 v16, v16, 0, vcc
    v_cmp_eq_u32 vcc, v4, v17
    s_nop 1
    v_cndmask_b32 v17, v17, 0, vcc
    v_cmp_eq_u32 vcc, v4, v18
    s_nop 1
    v_cndmask_b32 v18, v18, 0, vcc
    v_cmp_eq_u32 vcc, v4, v19
    s_nop 1
    v_cndmask_b32 v19, v19, 0, vcc
    v_cmp_eq_u32 vcc, v4, v20
    s_nop 1
    v_cndmask_b32 v20, v20, 0, vcc
    v_cmp_eq_u32 vcc, v4, v21
    s_nop 1
    v_cndmask_b32 v21, v21, 0, vcc
    v_cmp_eq_u32 vcc, v4, v22
    s_nop 1
    v_cndmask_b32 v22, v22, 0, vcc
    v_cmp_eq_u32 vcc, v4, v23
    s_nop 1
    v_cndmask_b32 v23, v23, 0, vcc
    v_cmp_eq_u32 vcc, v4, v24
    s_nop 1
    v_cndmask_b32 v24, v24, 0, vcc
    v_cmp_eq_u32 vcc, v4, v25
    s_nop 1
    v_cndmask_b32 v25, v25, 0, vcc
    v_cmp_eq_u32 vcc, v4, v26
    s_nop 1
    v_cndmask_b32 v26, v26, 0, vcc
    v_cmp_eq_u32 vcc, v4, v27
    s_nop 1
    v_cndmask_b32 v27, v27, 0, vcc
    v_cmp_eq_u32 vcc, v4, v28
    s_nop 1
    v_cndmask_b32 v28, v28, 0, vcc
    v_cmp_eq_u32 vcc, v4, v29
    s_nop 1
    v_cndmask_b32 v29, v29, 0, vcc
    v_cmp_eq_u32 vcc, v4, v30
    s_nop 1
    v_cndmask_b32 v30, v30, 0, vcc
    v_cmp_eq_u32 vcc, v4, v31
    s_nop 1
    v_cndmask_b32 v31, v31, 0, vcc
    v_cmp_eq_u32 vcc, v4, v32
    s_nop 1
    v_cndmask_b32 v32, v32, 0, vcc
    v_cmp_eq_u32 vcc, v4, v33
    s_nop 1
    v_cndmask_b32 v33, v33, 0, vcc
    v_cmp_eq_u32 vcc, v4, v34
    s_nop 1
    v_cndmask_b32 v34, v34, 0, vcc
    v_cmp_eq_u32 vcc, v4, v35
    s_nop 1
    v_cndmask_b32 v35, v35, 0, vcc
    v_cmp_eq_u32 vcc, v4, v36
    s_nop 1
    v_cndmask_b32 v36, v36, 0, vcc
    v_cmp_eq_u32 vcc, v4, v37
    s_nop 1
    v_cndmask_b32 v37, v37, 0, vcc
    v_cmp_eq_u32 vcc, v4, v38
    s_nop 1
    v_cndmask_b32 v38, v38, 0, vcc
    v_cmp_eq_u32 vcc, v4, v39
    s_nop 1
    v_cndmask_b32 v39, v39, 0, vcc
    v_cmp_eq_u32 vcc, v4, v40
    s_nop 1
    v_cndmask_b32 v40, v40, 0, vcc
    v_cmp_eq_u32 vcc, v4, v41
    s_nop 1
    v_cndmask_b32 v41, v41, 0, vcc
    v_cmp_eq_u32 vcc, v4, v42
    s_nop 1
    v_cndmask_b32 v42, v42, 0, vcc
    v_cmp_eq_u32 vcc, v4, v43
    s_nop 1
    v_cndmask_b32 v43, v43, 0, vcc
    v_cmp_eq_u32 vcc, v4, v44
    s_nop 1
    v_cndmask_b32 v44, v44, 0, vcc
    v_cmp_eq_u32 vcc, v4, v45
    s_nop 1
    v_cndmask_b32 v45, v45, 0, vcc
    v_cmp_eq_u32 vcc, v4, v46
    s_nop 1
    v_cndmask_b32 v46, v46, 0, vcc
    v_cmp_eq_u32 vcc, v4, v47
    s_nop 1
    v_cndmask_b32 v47, v47, 0, vcc
    v_max3_u32 v4, v16, v17, v18
    v_max3_u32 v4, v4, v19, v20
    v_max3_u32 v4, v4, v21, v22
    v_max3_u32 v4, v4, v23, v24
    v_max3_u32 v4, v4, v25, v26
    v_max3_u32 v4, v4, v27, v28
    v_max3_u32 v4, v4, v29, v30
    v_max3_u32 v4, v4, v31, v32
    v_max3_u32 v4, v4, v33, v34
    v_max3_u32 v4, v4, v35, v36
    v_max3_u32 v4, v4, v37, v38
    v_max3_u32 v4, v4, v39, v40
    v_max3_u32 v4, v4, v41, v42
    v_max3_u32 v4, v4, v43, v44
    v_max3_u32 v4, v4, v45, v46
    v_max_u32 v4, v4, v47
    s_nop 1
    v_max_u32_dpp v4, v4, v4 quad_perm:[1,0,3,2] row_mask:0xf bank_mask:0xf
    s_nop 1
    v_max_u32_dpp v4, v4, v4 quad_perm:[2,3,0,1] row_mask:0xf bank_mask:0xf
    s_nop 1
    v_max_u32_dpp v4, v4, v4 row_half_mirror row_mask:0xf bank_mask:0xf
    s_nop 1
    v_max_u32_dpp v4, v4, v4 row_mirror row_mask:0xf bank_mask:0xf
    v_mov_b32 v5, v4
    s_nop 1
    v_permlane16_swap_b32 v4, v5
    v_max_u32 v4, v4, v5
    v_mov_b32 v5, v4
    s_nop 1
    v_permlane32_swap_b32 v4, v5
    v_max_u32 v4, v4, v5
    v_mov_b32 v57, v4
    v_cmp_eq_u32 vcc, v4, v16
    s_nop 1
    v_cndmask_b32 v16, v16, 0, vcc
    v_cmp_eq_u32 vcc, v4, v17
    s_nop 1
    v_cndmask_b32 v17, v17, 0, vcc
    v_cmp_eq_u32 vcc, v4, v18
    s_nop 1
    v_cndmask_b32 v18, v18, 0, vcc
    v_cmp_eq_u32 vcc, v4, v19
    s_nop 1
    v_cndmask_b32 v19, v19, 0, vcc
    v_cmp_eq_u32 vcc, v4, v20
    s_nop 1
    v_cndmask_b32 v20, v20, 0, vcc
    v_cmp_eq_u32 vcc, v4, v21
    s_nop 1
    v_cndmask_b32 v21, v21, 0, vcc
    v_cmp_eq_u32 vcc, v4, v22
    s_nop 1
    v_cndmask_b32 v22, v22, 0, vcc
    v_cmp_eq_u32 vcc, v4, v23
    s_nop 1
    v_cndmask_b32 v23, v23, 0, vcc
    v_cmp_eq_u32 vcc, v4, v24
    s_nop 1
    v_cndmask_b32 v24, v24, 0, vcc
    v_cmp_eq_u32 vcc, v4, v25
    s_nop 1
    v_cndmask_b32 v25, v25, 0, vcc
    v_cmp_eq_u32 vcc, v4, v26
    s_nop 1
    v_cndmask_b32 v26, v26, 0, vcc
    v_cmp_eq_u32 vcc, v4, v27
    s_nop 1
    v_cndmask_b32 v27, v27, 0, vcc
    v_cmp_eq_u32 vcc, v4, v28
    s_nop 1
    v_cndmask_b32 v28, v28, 0, vcc
    v_cmp_eq_u32 vcc, v4, v29
    s_nop 1
    v_cndmask_b32 v29, v29, 0, vcc
    v_cmp_eq_u32 vcc, v4, v30
    s_nop 1
    v_cndmask_b32 v30, v30, 0, vcc
    v_cmp_eq_u32 vcc, v4, v31
    s_nop 1
    v_cndmask_b32 v31, v31, 0, vcc
    v_cmp_eq_u32 vcc, v4, v32
    s_nop 1
    v_cndmask_b32 v32, v32, 0, vcc
    v_cmp_eq_u32 vcc, v4, v33
    s_nop 1
    v_cndmask_b32 v33, v33, 0, vcc
    v_cmp_eq_u32 vcc, v4, v34
    s_nop 1
    v_cndmask_b32 v34, v34, 0, vcc
    v_cmp_eq_u32 vcc, v4, v35
    s_nop 1
    v_cndmask_b32 v35, v35, 0, vcc
    v_cmp_eq_u32 vcc, v4, v36
    s_nop 1
    v_cndmask_b32 v36, v36, 0, vcc
    v_cmp_eq_u32 vcc, v4, v37
    s_nop 1
    v_cndmask_b32 v37, v37, 0, vcc
    v_cmp_eq_u32 vcc, v4, v38
    s_nop 1
    v_cndmask_b32 v38, v38, 0, vcc
    v_cmp_eq_u32 vcc, v4, v39
    s_nop 1
    v_cndmask_b32 v39, v39, 0, vcc
    v_cmp_eq_u32 vcc, v4, v40
    s_nop 1
    v_cndmask_b32 v40, v40, 0, vcc
    v_cmp_eq_u32 vcc, v4, v41
    s_nop 1
    v_cndmask_b32 v41, v41, 0, vcc
    v_cmp_eq_u32 vcc, v4, v42
    s_nop 1
    v_cndmask_b32 v42, v42, 0, vcc
    v_cmp_eq_u32 vcc, v4, v43
    s_nop 1
    v_cndmask_b32 v43, v43, 0, vcc
    v_cmp_eq_u32 vcc, v4, v44
    s_nop 1
    v_cndmask_b32 v44, v44, 0, vcc
    v_cmp_eq_u32 vcc, v4, v45
    s_nop 1
    v_cndmask_b32 v45, v45, 0, vcc
    v_cmp_eq_u32 vcc, v4, v46
    s_nop 1
    v_cndmask_b32 v46, v46, 0, vcc
    v_cmp_eq_u32 vcc, v4, v47
    s_nop 1
    v_cndmask_b32 v47, v47, 0, vcc
    v_max3_u32 v4, v16, v17, v18
    v_max3_u32 v4, v4, v19, v20
    v_max3_u32 v4, v4, v21, v22
    v_max3_u32 v4, v4, v23, v24
    v_max3_u32 v4, v4, v25, v26
    v_max3_u32 v4, v4, v27, v28
    v_max3_u32 v4, v4, v29, v30
    v_max3_u32 v4, v4, v31, v32
    v_max3_u32 v4, v4, v33, v34
    v_max3_u32 v4, v4, v35, v36
    v_max3_u32 v4, v4, v37, v38
    v_max3_u32 v4, v4, v39, v40
    v_max3_u32 v4, v4, v41, v42
    v_max3_u32 v4, v4, v43, v44
    v_max3_u32 v4, v4, v45, v46
    v_max_u32 v4, v4, v47
    s_nop 1
    v_max_u32_dpp v4, v4, v4 quad_perm:[1,0,3,2] row_mask:0xf bank_mask:0xf
    s_nop 1
    v_max_u32_dpp v4, v4, v4 quad_perm:[2,3,0,1] row_mask:0xf bank_mask:0xf
    s_nop 1
    v_max_u32_dpp v4, v4, v4 row_half_mirror row_mask:0xf bank_mask:0xf
    s_nop 1
    v_max_u32_dpp v4, v4, v4 row_mirror row_mask:0xf bank_mask:0xf
    v_mov_b32 v5, v4
    s_nop 1
    v_permlane16_swap_b32 v4, v5
    v_max_u32 v4, v4, v5
    v_mov_b32 v5, v4
    s_nop 1
    v_permlane32_swap_b32 v4, v5
    v_max_u32 v4, v4, v5
    v_mov_b32 v58, v4
    v_cmp_eq_u32 vcc, v4, v16
    s_nop 1
    v_cndmask_b32 v16, v16, 0, vcc
    v_cmp_eq_u32 vcc, v4, v17
    s_nop 1
    v_cndmask_b32 v17, v17, 0, vcc
    v_cmp_eq_u32 vcc, v4, v18
    s_nop 1
    v_cndmask_b32 v18, v18, 0, vcc
    v_cmp_eq_u32 vcc, v4, v19
    s_nop 1
    v_cndmask_b32 v19, v19, 0, vcc
    v_cmp_eq_u32 vcc, v4, v20
    s_nop 1
    v_cndmask_b32 v20, v20, 0, vcc
    v_cmp_eq_u32 vcc, v4, v21
    s_nop 1
    v_cndmask_b32 v21, v21, 0, vcc
    v_cmp_eq_u32 vcc, v4, v22
    s_nop 1
    v_cndmask_b32 v22, v22, 0, vcc
    v_cmp_eq_u32 vcc, v4, v23
    s_nop 1
    v_cndmask_b32 v23, v23, 0, vcc
    v_cmp_eq_u32 vcc, v4, v24
    s_nop 1
    v_cndmask_b32 v24, v24, 0, vcc
    v_cmp_eq_u32 vcc, v4, v25
    s_nop 1
    v_cndmask_b32 v25, v25, 0, vcc
    v_cmp_eq_u32 vcc, v4, v26
    s_nop 1
    v_cndmask_b32 v26, v26, 0, vcc
    v_cmp_eq_u32 vcc, v4, v27
    s_nop 1
    v_cndmask_b32 v27, v27, 0, vcc
    v_cmp_eq_u32 vcc, v4, v28
    s_nop 1
    v_cndmask_b32 v28, v28, 0, vcc
    v_cmp_eq_u32 vcc, v4, v29
    s_nop 1
    v_cndmask_b32 v29, v29, 0, vcc
    v_cmp_eq_u32 vcc, v4, v30
    s_nop 1
    v_cndmask_b32 v30, v30, 0, vcc
    v_cmp_eq_u32 vcc, v4, v31
    s_nop 1
    v_cndmask_b32 v31, v31, 0, vcc
    v_cmp_eq_u32 vcc, v4, v32
    s_nop 1
    v_cndmask_b32 v32, v32, 0, vcc
    v_cmp_eq_u32 vcc, v4, v33
    s_nop 1
    v_cndmask_b32 v33, v33, 0, vcc
    v_cmp_eq_u32 vcc, v4, v34
    s_nop 1
    v_cndmask_b32 v34, v34, 0, vcc
    v_cmp_eq_u32 vcc, v4, v35
    s_nop 1
    v_cndmask_b32 v35, v35, 0, vcc
    v_cmp_eq_u32 vcc, v4, v36
    s_nop 1
    v_cndmask_b32 v36, v36, 0, vcc
    v_cmp_eq_u32 vcc, v4, v37
    s_nop 1
    v_cndmask_b32 v37, v37, 0, vcc
    v_cmp_eq_u32 vcc, v4, v38
    s_nop 1
    v_cndmask_b32 v38, v38, 0, vcc
    v_cmp_eq_u32 vcc, v4, v39
    s_nop 1
    v_cndmask_b32 v39, v39, 0, vcc
    v_cmp_eq_u32 vcc, v4, v40
    s_nop 1
    v_cndmask_b32 v40, v40, 0, vcc
    v_cmp_eq_u32 vcc, v4, v41
    s_nop 1
    v_cndmask_b32 v41, v41, 0, vcc
    v_cmp_eq_u32 vcc, v4, v42
    s_nop 1
    v_cndmask_b32 v42, v42, 0, vcc
    v_cmp_eq_u32 vcc, v4, v43
    s_nop 1
    v_cndmask_b32 v43, v43, 0, vcc
    v_cmp_eq_u32 vcc, v4, v44
    s_nop 1
    v_cndmask_b32 v44, v44, 0, vcc
    v_cmp_eq_u32 vcc, v4, v45
    s_nop 1
    v_cndmask_b32 v45, v45, 0, vcc
    v_cmp_eq_u32 vcc, v4, v46
    s_nop 1
    v_cndmask_b32 v46, v46, 0, vcc
    v_cmp_eq_u32 vcc, v4, v47
    s_nop 1
    v_cndmask_b32 v47, v47, 0, vcc
    v_max3_u32 v4, v16, v17, v18
    v_max3_u32 v4, v4, v19, v20
    v_max3_u32 v4, v4, v21, v22
    v_max3_u32 v4, v4, v23, v24
    v_max3_u32 v4, v4, v25, v26
    v_max3_u32 v4, v4, v27, v28
    v_max3_u32 v4, v4, v29, v30
    v_max3_u32 v4, v4, v31, v32
    v_max3_u32 v4, v4, v33, v34
    v_max3_u32 v4, v4, v35, v36
    v_max3_u32 v4, v4, v37, v38
    v_max3_u32 v4, v4, v39, v40
    v_max3_u32 v4, v4, v41, v42
    v_max3_u32 v4, v4, v43, v44
    v_max3_u32 v4, v4, v45, v46
    v_max_u32 v4, v4, v47
    s_nop 1
    v_max_u32_dpp v4, v4, v4 quad_perm:[1,0,3,2] row_mask:0xf bank_mask:0xf
    s_nop 1
    v_max_u32_dpp v4, v4, v4 quad_perm:[2,3,0,1] row_mask:0xf bank_mask:0xf
    s_nop 1
    v_max_u32_dpp v4, v4, v4 row_half_mirror row_mask:0xf bank_mask:0xf
    s_nop 1
    v_max_u32_dpp v4, v4, v4 row_mirror row_mask:0xf bank_mask:0xf
    v_mov_b32 v5, v4
    s_nop 1
    v_permlane16_swap_b32 v4, v5
    v_max_u32 v4, v4, v5
    v_mov_b32 v5, v4
    s_nop 1
    v_permlane32_swap_b32 v4, v5
    v_max_u32 v4, v4, v5
    v_mov_b32 v59, v4
    v_cmp_eq_u32 vcc, v4, v16
    s_nop 1
    v_cndmask_b32 v16, v16, 0, vcc
    v_cmp_eq_u32 vcc, v4, v17
    s_nop 1
    v_cndmask_b32 v17, v17, 0, vcc
    v_cmp_eq_u32 vcc, v4, v18
    s_nop 1
    v_cndmask_b32 v18, v18, 0, vcc
    v_cmp_eq_u32 vcc, v4, v19
    s_nop 1
    v_cndmask_b32 v19, v19, 0, vcc
    v_cmp_eq_u32 vcc, v4, v20
    s_nop 1
    v_cndmask_b32 v20, v20, 0, vcc
    v_cmp_eq_u32 vcc, v4, v21
    s_nop 1
    v_cndmask_b32 v21, v21, 0, vcc
    v_cmp_eq_u32 vcc, v4, v22
    s_nop 1
    v_cndmask_b32 v22, v22, 0, vcc
    v_cmp_eq_u32 vcc, v4, v23
    s_nop 1
    v_cndmask_b32 v23, v23, 0, vcc
    v_cmp_eq_u32 vcc, v4, v24
    s_nop 1
    v_cndmask_b32 v24, v24, 0, vcc
    v_cmp_eq_u32 vcc, v4, v25
    s_nop 1
    v_cndmask_b32 v25, v25, 0, vcc
    v_cmp_eq_u32 vcc, v4, v26
    s_nop 1
    v_cndmask_b32 v26, v26, 0, vcc
    v_cmp_eq_u32 vcc, v4, v27
    s_nop 1
    v_cndmask_b32 v27, v27, 0, vcc
    v_cmp_eq_u32 vcc, v4, v28
    s_nop 1
    v_cndmask_b32 v28, v28, 0, vcc
    v_cmp_eq_u32 vcc, v4, v29
    s_nop 1
    v_cndmask_b32 v29, v29, 0, vcc
    v_cmp_eq_u32 vcc, v4, v30
    s_nop 1
    v_cndmask_b32 v30, v30, 0, vcc
    v_cmp_eq_u32 vcc, v4, v31
    s_nop 1
    v_cndmask_b32 v31, v31, 0, vcc
    v_cmp_eq_u32 vcc, v4, v32
    s_nop 1
    v_cndmask_b32 v32, v32, 0, vcc
    v_cmp_eq_u32 vcc, v4, v33
    s_nop 1
    v_cndmask_b32 v33, v33, 0, vcc
    v_cmp_eq_u32 vcc, v4, v34
    s_nop 1
    v_cndmask_b32 v34, v34, 0, vcc
    v_cmp_eq_u32 vcc, v4, v35
    s_nop 1
    v_cndmask_b32 v35, v35, 0, vcc
    v_cmp_eq_u32 vcc, v4, v36
    s_nop 1
    v_cndmask_b32 v36, v36, 0, vcc
    v_cmp_eq_u32 vcc, v4, v37
    s_nop 1
    v_cndmask_b32 v37, v37, 0, vcc
    v_cmp_eq_u32 vcc, v4, v38
    s_nop 1
    v_cndmask_b32 v38, v38, 0, vcc
    v_cmp_eq_u32 vcc, v4, v39
    s_nop 1
    v_cndmask_b32 v39, v39, 0, vcc
    v_cmp_eq_u32 vcc, v4, v40
    s_nop 1
    v_cndmask_b32 v40, v40, 0, vcc
    v_cmp_eq_u32 vcc, v4, v41
    s_nop 1
    v_cndmask_b32 v41, v41, 0, vcc
    v_cmp_eq_u32 vcc, v4, v42
    s_nop 1
    v_cndmask_b32 v42, v42, 0, vcc
    v_cmp_eq_u32 vcc, v4, v43
    s_nop 1
    v_cndmask_b32 v43, v43, 0, vcc
    v_cmp_eq_u32 vcc, v4, v44
    s_nop 1
    v_cndmask_b32 v44, v44, 0, vcc
    v_cmp_eq_u32 vcc, v4, v45
    s_nop 1
    v_cndmask_b32 v45, v45, 0, vcc
    v_cmp_eq_u32 vcc, v4, v46
    s_nop 1
    v_cndmask_b32 v46, v46, 0, vcc
    v_cmp_eq_u32 vcc, v4, v47
    s_nop 1
    v_cndmask_b32 v47, v47, 0, vcc
    v_max3_u32 v4, v16, v17, v18
    v_max3_u32 v4, v4, v19, v20
    v_max3_u32 v4, v4, v21, v22
    v_max3_u32 v4, v4, v23, v24
    v_max3_u32 v4, v4, v25, v26
    v_max3_u32 v4, v4, v27, v28
    v_max3_u32 v4, v4, v29, v30
    v_max3_u32 v4, v4, v31, v32
    v_max3_u32 v4, v4, v33, v34
    v_max3_u32 v4, v4, v35, v36
    v_max3_u32 v4, v4, v37, v38
    v_max3_u32 v4, v4, v39, v40
    v_max3_u32 v4, v4, v41, v42
    v_max3_u32 v4, v4, v43, v44
    v_max3_u32 v4, v4, v45, v46
    v_max_u32 v4, v4, v47
    s_nop 1
    v_max_u32_dpp v4, v4, v4 quad_perm:[1,0,3,2] row_mask:0xf bank_mask:0xf
    s_nop 1
    v_max_u32_dpp v4, v4, v4 quad_perm:[2,3,0,1] row_mask:0xf bank_mask:0xf
    s_nop 1
    v_max_u32_dpp v4, v4, v4 row_half_mirror row_mask:0xf bank_mask:0xf
    s_nop 1
    v_max_u32_dpp v4, v4, v4 row_mirror row_mask:0xf bank_mask:0xf
    v_mov_b32 v5, v4
    s_nop 1
    v_permlane16_swap_b32 v4, v5
    v_max_u32 v4, v4, v5
    v_mov_b32 v5, v4
    s_nop 1
    v_permlane32_swap_b32 v4, v5
    v_max_u32 v4, v4, v5
    v_mov_b32 v60, v4
    v_cmp_eq_u32 vcc, v4, v16
    s_nop 1
    v_cndmask_b32 v16, v16, 0, vcc
    v_cmp_eq_u32 vcc, v4, v17
    s_nop 1
    v_cndmask_b32 v17, v17, 0, vcc
    v_cmp_eq_u32 vcc, v4, v18
    s_nop 1
    v_cndmask_b32 v18, v18, 0, vcc
    v_cmp_eq_u32 vcc, v4, v19
    s_nop 1
    v_cndmask_b32 v19, v19, 0, vcc
    v_cmp_eq_u32 vcc, v4, v20
    s_nop 1
    v_cndmask_b32 v20, v20, 0, vcc
    v_cmp_eq_u32 vcc, v4, v21
    s_nop 1
    v_cndmask_b32 v21, v21, 0, vcc
    v_cmp_eq_u32 vcc, v4, v22
    s_nop 1
    v_cndmask_b32 v22, v22, 0, vcc
    v_cmp_eq_u32 vcc, v4, v23
    s_nop 1
    v_cndmask_b32 v23, v23, 0, vcc
    v_cmp_eq_u32 vcc, v4, v24
    s_nop 1
    v_cndmask_b32 v24, v24, 0, vcc
    v_cmp_eq_u32 vcc, v4, v25
    s_nop 1
    v_cndmask_b32 v25, v25, 0, vcc
    v_cmp_eq_u32 vcc, v4, v26
    s_nop 1
    v_cndmask_b32 v26, v26, 0, vcc
    v_cmp_eq_u32 vcc, v4, v27
    s_nop 1
    v_cndmask_b32 v27, v27, 0, vcc
    v_cmp_eq_u32 vcc, v4, v28
    s_nop 1
    v_cndmask_b32 v28, v28, 0, vcc
    v_cmp_eq_u32 vcc, v4, v29
    s_nop 1
    v_cndmask_b32 v29, v29, 0, vcc
    v_cmp_eq_u32 vcc, v4, v30
    s_nop 1
    v_cndmask_b32 v30, v30, 0, vcc
    v_cmp_eq_u32 vcc, v4, v31
    s_nop 1
    v_cndmask_b32 v31, v31, 0, vcc
    v_cmp_eq_u32 vcc, v4, v32
    s_nop 1
    v_cndmask_b32 v32, v32, 0, vcc
    v_cmp_eq_u32 vcc, v4, v33
    s_nop 1
    v_cndmask_b32 v33, v33, 0, vcc
    v_cmp_eq_u32 vcc, v4, v34
    s_nop 1
    v_cndmask_b32 v34, v34, 0, vcc
    v_cmp_eq_u32 vcc, v4, v35
    s_nop 1
    v_cndmask_b32 v35, v35, 0, vcc
    v_cmp_eq_u32 vcc, v4, v36
    s_nop 1
    v_cndmask_b32 v36, v36, 0, vcc
    v_cmp_eq_u32 vcc, v4, v37
    s_nop 1
    v_cndmask_b32 v37, v37, 0, vcc
    v_cmp_eq_u32 vcc, v4, v38
    s_nop 1
    v_cndmask_b32 v38, v38, 0, vcc
    v_cmp_eq_u32 vcc, v4, v39
    s_nop 1
    v_cndmask_b32 v39, v39, 0, vcc
    v_cmp_eq_u32 vcc, v4, v40
    s_nop 1
    v_cndmask_b32 v40, v40, 0, vcc
    v_cmp_eq_u32 vcc, v4, v41
    s_nop 1
    v_cndmask_b32 v41, v41, 0, vcc
    v_cmp_eq_u32 vcc, v4, v42
    s_nop 1
    v_cndmask_b32 v42, v42, 0, vcc
    v_cmp_eq_u32 vcc, v4, v43
    s_nop 1
    v_cndmask_b32 v43, v43, 0, vcc
    v_cmp_eq_u32 vcc, v4, v44
    s_nop 1
    v_cndmask_b32 v44, v44, 0, vcc
    v_cmp_eq_u32 vcc, v4, v45
    s_nop 1
    v_cndmask_b32 v45, v45, 0, vcc
    v_cmp_eq_u32 vcc, v4, v46
    s_nop 1
    v_cndmask_b32 v46, v46, 0, vcc
    v_cmp_eq_u32 vcc, v4, v47
    s_nop 1
    v_cndmask_b32 v47, v47, 0, vcc
    v_max3_u32 v4, v16, v17, v18
    v_max3_u32 v4, v4, v19, v20
    v_max3_u32 v4, v4, v21, v22
    v_max3_u32 v4, v4, v23, v24
    v_max3_u32 v4, v4, v25, v26
    v_max3_u32 v4, v4, v27, v28
    v_max3_u32 v4, v4, v29, v30
    v_max3_u32 v4, v4, v31, v32
    v_max3_u32 v4, v4, v33, v34
    v_max3_u32 v4, v4, v35, v36
    v_max3_u32 v4, v4, v37, v38
    v_max3_u32 v4, v4, v39, v40
    v_max3_u32 v4, v4, v41, v42
    v_max3_u32 v4, v4, v43, v44
    v_max3_u32 v4, v4, v45, v46
    v_max_u32 v4, v4, v47
    s_nop 1
    v_max_u32_dpp v4, v4, v4 quad_perm:[1,0,3,2] row_mask:0xf bank_mask:0xf
    s_nop 1
    v_max_u32_dpp v4, v4, v4 quad_perm:[2,3,0,1] row_mask:0xf bank_mask:0xf
    s_nop 1
    v_max_u32_dpp v4, v4, v4 row_half_mirror row_mask:0xf bank_mask:0xf
    s_nop 1
    v_max_u32_dpp v4, v4, v4 row_mirror row_mask:0xf bank_mask:0xf
    v_mov_b32 v5, v4
    s_nop 1
    v_permlane16_swap_b32 v4, v5
    v_max_u32 v4, v4, v5
    v_mov_b32 v5, v4
    s_nop 1
    v_permlane32_swap_b32 v4, v5
    v_max_u32 v4, v4, v5
    v_mov_b32 v61, v4
    v_cmp_eq_u32 vcc, v4, v16
    s_nop 1
    v_cndmask_b32 v16, v16, 0, vcc
    v_cmp_eq_u32 vcc, v4, v17
    s_nop 1
    v_cndmask_b32 v17, v17, 0, vcc
    v_cmp_eq_u32 vcc, v4, v18
    s_nop 1
    v_cndmask_b32 v18, v18, 0, vcc
    v_cmp_eq_u32 vcc, v4, v19
    s_nop 1
    v_cndmask_b32 v19, v19, 0, vcc
    v_cmp_eq_u32 vcc, v4, v20
    s_nop 1
    v_cndmask_b32 v20, v20, 0, vcc
    v_cmp_eq_u32 vcc, v4, v21
    s_nop 1
    v_cndmask_b32 v21, v21, 0, vcc
    v_cmp_eq_u32 vcc, v4, v22
    s_nop 1
    v_cndmask_b32 v22, v22, 0, vcc
    v_cmp_eq_u32 vcc, v4, v23
    s_nop 1
    v_cndmask_b32 v23, v23, 0, vcc
    v_cmp_eq_u32 vcc, v4, v24
    s_nop 1
    v_cndmask_b32 v24, v24, 0, vcc
    v_cmp_eq_u32 vcc, v4, v25
    s_nop 1
    v_cndmask_b32 v25, v25, 0, vcc
    v_cmp_eq_u32 vcc, v4, v26
    s_nop 1
    v_cndmask_b32 v26, v26, 0, vcc
    v_cmp_eq_u32 vcc, v4, v27
    s_nop 1
    v_cndmask_b32 v27, v27, 0, vcc
    v_cmp_eq_u32 vcc, v4, v28
    s_nop 1
    v_cndmask_b32 v28, v28, 0, vcc
    v_cmp_eq_u32 vcc, v4, v29
    s_nop 1
    v_cndmask_b32 v29, v29, 0, vcc
    v_cmp_eq_u32 vcc, v4, v30
    s_nop 1
    v_cndmask_b32 v30, v30, 0, vcc
    v_cmp_eq_u32 vcc, v4, v31
    s_nop 1
    v_cndmask_b32 v31, v31, 0, vcc
    v_cmp_eq_u32 vcc, v4, v32
    s_nop 1
    v_cndmask_b32 v32, v32, 0, vcc
    v_cmp_eq_u32 vcc, v4, v33
    s_nop 1
    v_cndmask_b32 v33, v33, 0, vcc
    v_cmp_eq_u32 vcc, v4, v34
    s_nop 1
    v_cndmask_b32 v34, v34, 0, vcc
    v_cmp_eq_u32 vcc, v4, v35
    s_nop 1
    v_cndmask_b32 v35, v35, 0, vcc
    v_cmp_eq_u32 vcc, v4, v36
    s_nop 1
    v_cndmask_b32 v36, v36, 0, vcc
    v_cmp_eq_u32 vcc, v4, v37
    s_nop 1
    v_cndmask_b32 v37, v37, 0, vcc
    v_cmp_eq_u32 vcc, v4, v38
    s_nop 1
    v_cndmask_b32 v38, v38, 0, vcc
    v_cmp_eq_u32 vcc, v4, v39
    s_nop 1
    v_cndmask_b32 v39, v39, 0, vcc
    v_cmp_eq_u32 vcc, v4, v40
    s_nop 1
    v_cndmask_b32 v40, v40, 0, vcc
    v_cmp_eq_u32 vcc, v4, v41
    s_nop 1
    v_cndmask_b32 v41, v41, 0, vcc
    v_cmp_eq_u32 vcc, v4, v42
    s_nop 1
    v_cndmask_b32 v42, v42, 0, vcc
    v_cmp_eq_u32 vcc, v4, v43
    s_nop 1
    v_cndmask_b32 v43, v43, 0, vcc
    v_cmp_eq_u32 vcc, v4, v44
    s_nop 1
    v_cndmask_b32 v44, v44, 0, vcc
    v_cmp_eq_u32 vcc, v4, v45
    s_nop 1
    v_cndmask_b32 v45, v45, 0, vcc
    v_cmp_eq_u32 vcc, v4, v46
    s_nop 1
    v_cndmask_b32 v46, v46, 0, vcc
    v_cmp_eq_u32 vcc, v4, v47
    s_nop 1
    v_cndmask_b32 v47, v47, 0, vcc
    v_max3_u32 v4, v16, v17, v18
    v_max3_u32 v4, v4, v19, v20
    v_max3_u32 v4, v4, v21, v22
    v_max3_u32 v4, v4, v23, v24
    v_max3_u32 v4, v4, v25, v26
    v_max3_u32 v4, v4, v27, v28
    v_max3_u32 v4, v4, v29, v30
    v_max3_u32 v4, v4, v31, v32
    v_max3_u32 v4, v4, v33, v34
    v_max3_u32 v4, v4, v35, v36
    v_max3_u32 v4, v4, v37, v38
    v_max3_u32 v4, v4, v39, v40
    v_max3_u32 v4, v4, v41, v42
    v_max3_u32 v4, v4, v43, v44
    v_max3_u32 v4, v4, v45, v46
    v_max_u32 v4, v4, v47
    s_nop 1
    v_max_u32_dpp v4, v4, v4 quad_perm:[1,0,3,2] row_mask:0xf bank_mask:0xf
    s_nop 1
    v_max_u32_dpp v4, v4, v4 quad_perm:[2,3,0,1] row_mask:0xf bank_mask:0xf
    s_nop 1
    v_max_u32_dpp v4, v4, v4 row_half_mirror row_mask:0xf bank_mask:0xf
    s_nop 1
    v_max_u32_dpp v4, v4, v4 row_mirror row_mask:0xf bank_mask:0xf
    v_mov_b32 v5, v4
    s_nop 1
    v_permlane16_swap_b32 v4, v5
    v_max_u32 v4, v4, v5
    v_mov_b32 v5, v4
    s_nop 1
    v_permlane32_swap_b32 v4, v5
    v_max_u32 v4, v4, v5
    v_mov_b32 v62, v4
    v_cmp_eq_u32 vcc, v4, v16
    s_nop 1
    v_cndmask_b32 v16, v16, 0, vcc
    v_cmp_eq_u32 vcc, v4, v17
    s_nop 1
    v_cndmask_b32 v17, v17, 0, vcc
    v_cmp_eq_u32 vcc, v4, v18
    s_nop 1
    v_cndmask_b32 v18, v18, 0, vcc
    v_cmp_eq_u32 vcc, v4, v19
    s_nop 1
    v_cndmask_b32 v19, v19, 0, vcc
    v_cmp_eq_u32 vcc, v4, v20
    s_nop 1
    v_cndmask_b32 v20, v20, 0, vcc
    v_cmp_eq_u32 vcc, v4, v21
    s_nop 1
    v_cndmask_b32 v21, v21, 0, vcc
    v_cmp_eq_u32 vcc, v4, v22
    s_nop 1
    v_cndmask_b32 v22, v22, 0, vcc
    v_cmp_eq_u32 vcc, v4, v23
    s_nop 1
    v_cndmask_b32 v23, v23, 0, vcc
    v_cmp_eq_u32 vcc, v4, v24
    s_nop 1
    v_cndmask_b32 v24, v24, 0, vcc
    v_cmp_eq_u32 vcc, v4, v25
    s_nop 1
    v_cndmask_b32 v25, v25, 0, vcc
    v_cmp_eq_u32 vcc, v4, v26
    s_nop 1
    v_cndmask_b32 v26, v26, 0, vcc
    v_cmp_eq_u32 vcc, v4, v27
    s_nop 1
    v_cndmask_b32 v27, v27, 0, vcc
    v_cmp_eq_u32 vcc, v4, v28
    s_nop 1
    v_cndmask_b32 v28, v28, 0, vcc
    v_cmp_eq_u32 vcc, v4, v29
    s_nop 1
    v_cndmask_b32 v29, v29, 0, vcc
    v_cmp_eq_u32 vcc, v4, v30
    s_nop 1
    v_cndmask_b32 v30, v30, 0, vcc
    v_cmp_eq_u32 vcc, v4, v31
    s_nop 1
    v_cndmask_b32 v31, v31, 0, vcc
    v_cmp_eq_u32 vcc, v4, v32
    s_nop 1
    v_cndmask_b32 v32, v32, 0, vcc
    v_cmp_eq_u32 vcc, v4, v33
    s_nop 1
    v_cndmask_b32 v33, v33, 0, vcc
    v_cmp_eq_u32 vcc, v4, v34
    s_nop 1
    v_cndmask_b32 v34, v34, 0, vcc
    v_cmp_eq_u32 vcc, v4, v35
    s_nop 1
    v_cndmask_b32 v35, v35, 0, vcc
    v_cmp_eq_u32 vcc, v4, v36
    s_nop 1
    v_cndmask_b32 v36, v36, 0, vcc
    v_cmp_eq_u32 vcc, v4, v37
    s_nop 1
    v_cndmask_b32 v37, v37, 0, vcc
    v_cmp_eq_u32 vcc, v4, v38
    s_nop 1
    v_cndmask_b32 v38, v38, 0, vcc
    v_cmp_eq_u32 vcc, v4, v39
    s_nop 1
    v_cndmask_b32 v39, v39, 0, vcc
    v_cmp_eq_u32 vcc, v4, v40
    s_nop 1
    v_cndmask_b32 v40, v40, 0, vcc
    v_cmp_eq_u32 vcc, v4, v41
    s_nop 1
    v_cndmask_b32 v41, v41, 0, vcc
    v_cmp_eq_u32 vcc, v4, v42
    s_nop 1
    v_cndmask_b32 v42, v42, 0, vcc
    v_cmp_eq_u32 vcc, v4, v43
    s_nop 1
    v_cndmask_b32 v43, v43, 0, vcc
    v_cmp_eq_u32 vcc, v4, v44
    s_nop 1
    v_cndmask_b32 v44, v44, 0, vcc
    v_cmp_eq_u32 vcc, v4, v45
    s_nop 1
    v_cndmask_b32 v45, v45, 0, vcc
    v_cmp_eq_u32 vcc, v4, v46
    s_nop 1
    v_cndmask_b32 v46, v46, 0, vcc
    v_cmp_eq_u32 vcc, v4, v47
    s_nop 1
    v_cndmask_b32 v47, v47, 0, vcc
    v_max3_u32 v4, v16, v17, v18
    v_max3_u32 v4, v4, v19, v20
    v_max3_u32 v4, v4, v21, v22
    v_max3_u32 v4, v4, v23, v24
    v_max3_u32 v4, v4, v25, v26
    v_max3_u32 v4, v4, v27, v28
    v_max3_u32 v4, v4, v29, v30
    v_max3_u32 v4, v4, v31, v32
    v_max3_u32 v4, v4, v33, v34
    v_max3_u32 v4, v4, v35, v36
    v_max3_u32 v4, v4, v37, v38
    v_max3_u32 v4, v4, v39, v40
    v_max3_u32 v4, v4, v41, v42
    v_max3_u32 v4, v4, v43, v44
    v_max3_u32 v4, v4, v45, v46
    v_max_u32 v4, v4, v47
    s_nop 1
    v_max_u32_dpp v4, v4, v4 quad_perm:[1,0,3,2] row_mask:0xf bank_mask:0xf
    s_nop 1
    v_max_u32_dpp v4, v4, v4 quad_perm:[2,3,0,1] row_mask:0xf bank_mask:0xf
    s_nop 1
    v_max_u32_dpp v4, v4, v4 row_half_mirror row_mask:0xf bank_mask:0xf
    s_nop 1
    v_max_u32_dpp v4, v4, v4 row_mirror row_mask:0xf bank_mask:0xf
    v_mov_b32 v5, v4
    s_nop 1
    v_permlane16_swap_b32 v4, v5
    v_max_u32 v4, v4, v5
    v_mov_b32 v5, v4
    s_nop 1
    v_permlane32_swap_b32 v4, v5
    v_max_u32 v4, v4, v5
    v_mov_b32 v63, v4
    v_mov_b32 v4, v56
    v_cmp_eq_u32 vcc, 1, v0
    s_nop 1
    v_cndmask_b32 v4, v4, v57, vcc
    v_cmp_eq_u32 vcc, 2, v0
    s_nop 1
    v_cndmask_b32 v4, v4, v58, vcc
    v_cmp_eq_u32 vcc, 3, v0
    s_nop 1
    v_cndmask_b32 v4, v4, v59, vcc
    v_cmp_eq_u32 vcc, 4, v0
    s_nop 1
    v_cndmask_b32 v4, v4, v60, vcc
    v_cmp_eq_u32 vcc, 5, v0
    s_nop 1
    v_cndmask_b32 v4, v4, v61, vcc
    v_cmp_eq_u32 vcc, 6, v0
    s_nop 1
    v_cndmask_b32 v4, v4, v62, vcc
    v_cmp_eq_u32 vcc, 7, v0
    s_nop 1
    v_cndmask_b32 v4, v4, v63, vcc
    v_and_b32 v5, 0xffff, v4
    v_sub_u32 v5, 0xffff, v5
    v_and_b32 v4, 0xffff0000, v4
    v_ashrrev_i32 v3, 31, v4
    v_not_b32 v3, v3
    v_or_b32 v3, 0x80000000, v3
    v_xor_b32 v4, v4, v3
    v_and_b32 v4, 0xffff0000, v4
    v_mul_f32 v4, 0xbfb8aa3b, v4
    v_exp_f32 v4, v4
    s_nop 0
    v_add_f32 v4, 1.0, v4
    v_rcp_f32 v4, v4
    s_nop 0
    v_cvt_pk_bf16_f32 v4, v4, v4
    v_lshlrev_b32 v4, 16, v4
    v_lshlrev_b32 v6, 2, v0
    s_mov_b32 s64, 0x5400000
    s_mov_b64 exec, 0xff
    buffer_store_dword v5, v6, s[4:7], s64 offen sc1
    buffer_store_dword v4, v6, s[4:7], s64 offen offset:32 sc1
    s_mov_b64 exec, -1
    s_waitcnt vmcnt(0)
    v_mov_b32 v7, 1
    v_mov_b32 v8, 0
    s_mov_b32 s64, 0x298000
    s_mov_b64 exec, 1
    buffer_atomic_add v7, v8, s[4:7], s64 offen sc1
    s_mov_b64 exec, -1
    v_mbcnt_lo_u32_b32 v0, -1, 0
    v_mbcnt_hi_u32_b32 v0, -1, v0
NOSEL_114:
    v_lshlrev_b32 v1, 4, v0
    v_lshrrev_b32 v6, 3, v0
    v_mul_u32_u24 v2, 1280, v6
    v_and_b32 v7, 7, v0
    v_xor_b32 v7, v7, v6
    v_lshl_add_u32 v2, v7, 4, v2
    v_bfe_u32 v6, v0, 3, 1
    v_lshlrev_b32 v9, 10, v6
    v_and_b32 v6, 7, v0
    v_lshl_add_u32 v9, v6, 7, v9
    v_lshrrev_b32 v7, 4, v0
    v_xor_b32 v7, v7, v6
    v_lshl_add_u32 v3, v7, 4, v9
    v_xor_b32 v7, 4, v7
    v_lshl_add_u32 v4, v7, 4, v9
    v_add_u32 v6, 0x10000, v3
    v_add_u32 v9, 0x10000, v4
    s_barrier
    s_mul_i32 s20, s12, 163840
    s_mul_i32 s64, s14, 40960
    s_add_u32 s20, s20, s64
    s_add_u32 s20, s20, 0x0
    s_lshl_b32 s21, s14, 12
    s_add_u32 m0, s21, 0
    s_add_u32 s64, s20, 0x0
    buffer_load_dwordx4 v2, s[4:7], s64 offen lds
    s_add_u32 m0, s21, 1024
    s_add_u32 s64, s20, 0x2800
    buffer_load_dwordx4 v2, s[4:7], s64 offen lds
    s_add_u32 m0, s21, 2048
    s_add_u32 s64, s20, 0x5000
    buffer_load_dwordx4 v2, s[4:7], s64 offen lds
    s_add_u32 m0, s21, 3072
    s_add_u32 s64, s20, 0x7800
    buffer_load_dwordx4 v2, s[4:7], s64 offen lds
    s_add_u32 m0, s21, 16384
    s_add_u32 s64, s20, 0x80
    buffer_load_dwordx4 v2, s[4:7], s64 offen lds
    s_add_u32 m0, s21, 17408
    s_add_u32 s64, s20, 0x2880
    buffer_load_dwordx4 v2, s[4:7], s64 offen lds
    s_add_u32 m0, s21, 18432
    s_add_u32 s64, s20, 0x5080
    buffer_load_dwordx4 v2, s[4:7], s64 offen lds
    s_add_u32 m0, s21, 19456
    s_add_u32 s64, s20, 0x7880
    buffer_load_dwordx4 v2, s[4:7], s64 offen lds
    s_add_u32 m0, s21, 32768
    s_add_u32 s64, s20, 0x100
    buffer_load_dwordx4 v2, s[4:7], s64 offen lds
    s_add_u32 m0, s21, 33792
    s_add_u32 s64, s20, 0x2900
    buffer_load_dwordx4 v2, s[4:7], s64 offen lds
    s_add_u32 m0, s21, 34816
    s_add_u32 s64, s20, 0x5100
    buffer_load_dwordx4 v2, s[4:7], s64 offen lds
    s_add_u32 m0, s21, 35840
    s_add_u32 s64, s20, 0x7900
    buffer_load_dwordx4 v2, s[4:7], s64 offen lds
    s_add_u32 m0, s21, 49152
    s_add_u32 s64, s20, 0x180
    buffer_load_dwordx4 v2, s[4:7], s64 offen lds
    s_add_u32 m0, s21, 50176
    s_add_u32 s64, s20, 0x2980
    buffer_load_dwordx4 v2, s[4:7], s64 offen lds
    s_add_u32 m0, s21, 51200
    s_add_u32 s64, s20, 0x5180
    buffer_load_dwordx4 v2, s[4:7], s64 offen lds
    s_add_u32 m0, s21, 52224
    s_add_u32 s64, s20, 0x7980
    buffer_load_dwordx4 v2, s[4:7], s64 offen lds
    s_mov_b32 s64, 0x40000000
    buffer_store_dword v7, v1, s[4:7], s64 offen
    buffer_store_dword v7, v1, s[4:7], s64 offen
    buffer_store_dword v7, v1, s[4:7], s64 offen
    buffer_store_dword v7, v1, s[4:7], s64 offen
    buffer_store_dword v7, v1, s[4:7], s64 offen
    buffer_store_dword v7, v1, s[4:7], s64 offen
    buffer_store_dword v7, v1, s[4:7], s64 offen
    buffer_store_dword v7, v1, s[4:7], s64 offen
    s_waitcnt vmcnt(20)
    s_barrier
    ds_read_b128 a[0:3], v3 offset:0
    ds_read_b128 a[4:7], v3 offset:2048
    ds_read_b128 a[8:11], v3 offset:4096
    ds_read_b128 a[12:15], v3 offset:6144
    ds_read_b128 a[16:19], v3 offset:8192
    ds_read_b128 a[20:23], v3 offset:10240
    ds_read_b128 a[24:27], v3 offset:12288
    ds_read_b128 a[28:31], v3 offset:14336
    s_mov_b32 s19, 0
    s_mov_b32 s22, s16
    s_mov_b32 s23, 0x40000000
G_T_LOOP:
    s_waitcnt lgkmcnt(4)
    v_mfma_f32_16x16x32_bf16 v[16:19], v[96:99], a[0:3], 0
    v_mfma_f32_16x16x32_bf16 v[20:23], v[100:103], a[0:3], 0
    ds_read_b128 a[32:35], v4 offset:0
    v_mfma_f32_16x16x32_bf16 v[24:27], v[96:99], a[4:7], 0
    v_mfma_f32_16x16x32_bf16 v[28:31], v[100:103], a[4:7], 0
    ds_read_b128 a[36:39], v4 offset:2048
    v_mfma_f32_16x16x32_bf16 v[32:35], v[96:99], a[8:11], 0
    v_mfma_f32_16x16x32_bf16 v[36:39], v[100:103], a[8:11], 0
    ds_read_b128 a[40:43], v4 offset:4096
    v_mfma_f32_16x16x32_bf16 v[40:43], v[96:99], a[12:15], 0
    v_mfma_f32_16x16x32_bf16 v[44:47], v[100:103], a[12:15], 0
    ds_read_b128 a[44:47], v4 offset:6144
    s_waitcnt lgkmcnt(4)
    v_mfma_f32_16x16x32_bf16 v[48:51], v[96:99], a[16:19], 0
    v_mfma_f32_16x16x32_bf16 v[52:55], v[100:103], a[16:19], 0
    ds_read_b128 a[48:51], v4 offset:8192
    v_mfma_f32_16x16x32_bf16 v[56:59], v[96:99], a[20:23], 0
    v_mfma_f32_16x16x32_bf16 v[60:63], v[100:103], a[20:23], 0
    ds_read_b128 a[52:55], v4 offset:10240
    v_mfma_f32_16x16x32_bf16 v[64:67], v[96:99], a[24:27], 0
    v_mfma_f32_16x16x32_bf16 v[68:71], v[100:103], a[24:27], 0
    ds_read_b128 a[56:59], v4 offset:12288
    v_mfma_f32_16x16x32_bf16 v[72:75], v[96:99], a[28:31], 0
    v_mfma_f32_16x16x32_bf16 v[76:79], v[100:103], a[28:31], 0
    ds_read_b128 a[60:63], v4 offset:14336
    s_waitcnt vmcnt(16)
    s_barrier
    s_waitcnt lgkmcnt(4)
    v_mfma_f32_16x16x32_bf16 v[16:19], v[104:107], a[32:35], v[16:19]
    v_mfma_f32_16x16x32_bf16 v[20:23], v[108:111], a[32:35], v[20:23]
    ds_read_b128 a[0:3], v3 offset:16384
    s_add_u32 m0, s21, 65536
    v_mfma_f32_16x16x32_bf16 v[24:27], v[104:107], a[36:39], v[24:27]
    v_mfma_f32_16x16x32_bf16 v[28:31], v[108:111], a[36:39], v[28:31]
    ds_read_b128 a[4:7], v3 offset:18432
    s_add_u32 s64, s20, 0x200
    buffer_load_dwordx4 v2, s[4:7], s64 offen lds
    v_mfma_f32_16x16x32_bf16 v[32:35], v[104:107], a[40:43], v[32:35]
    v_mfma_f32_16x16x32_bf16 v[36:39], v[108:111], a[40:43], v[36:39]
    ds_read_b128 a[8:11], v3 offset:20480
    s_add_u32 m0, s21, 66560
    v_mfma_f32_16x16x32_bf16 v[40:43], v[104:107], a[44:47], v[40:43]
    v_mfma_f32_16x16x32_bf16 v[44:47], v[108:111], a[44:47], v[44:47]
    ds_read_b128 a[12:15], v3 offset:22528
    s_add_u32 s64, s20, 0x2a00
    buffer_load_dwordx4 v2, s[4:7], s64 offen lds
    s_waitcnt lgkmcnt(4)
    v_mfma_f32_16x16x32_bf16 v[48:51], v[104:107], a[48:51], v[48:51]
    v_mfma_f32_16x16x32_bf16 v[52:55], v[108:111], a[48:51], v[52:55]
    ds_read_b128 a[16:19], v3 offset:24576
    s_add_u32 m0, s21, 67584
    v_mfma_f32_16x16x32_bf16 v[56:59], v[104:107], a[52:55], v[56:59]
    v_mfma_f32_16x16x32_bf16 v[60:63], v[108:111], a[52:55], v[60:63]
    ds_read_b128 a[20:23], v3 offset:26624
    s_add_u32 s64, s20, 0x5200
    buffer_load_dwordx4 v2, s[4:7], s64 offen lds
    v_mfma_f32_16x16x32_bf16 v[64:67], v[104:107], a[56:59], v[64:67]
    v_mfma_f32_16x16x32_bf16 v[68:71], v[108:111], a[56:59], v[68:71]
    ds_read_b128 a[24:27], v3 offset:28672
    s_add_u32 m0, s21, 68608
    v_mfma_f32_16x16x32_bf16 v[72:75], v[104:107], a[60:63], v[72:75]
    v_mfma_f32_16x16x32_bf16 v[76:79], v[108:111], a[60:63], v[76:79]
    ds_read_b128 a[28:31], v3 offset:30720
    s_add_u32 s64, s20, 0x7a00
    buffer_load_dwordx4 v2, s[4:7], s64 offen lds
    s_waitcnt lgkmcnt(4)
    v_mfma_f32_16x16x32_bf16 v[16:19], v[112:115], a[0:3], v[16:19]
    v_mfma_f32_16x16x32_bf16 v[20:23], v[116:119], a[0:3], v[20:23]
    ds_read_b128 a[32:35], v4 offset:16384
    v_mfma_f32_16x16x32_bf16 v[24:27], v[112:115], a[4:7], v[24:27]
    v_mfma_f32_16x16x32_bf16 v[28:31], v[116:119], a[4:7], v[28:31]
    ds_read_b128 a[36:39], v4 offset:18432
    v_mfma_f32_16x16x32_bf16 v[32:35], v[112:115], a[8:11], v[32:35]
    v_mfma_f32_16x16x32_bf16 v[36:39], v[116:119], a[8:11], v[36:39]
    ds_read_b128 a[40:43], v4 offset:20480
    v_mfma_f32_16x16x32_bf16 v[40:43], v[112:115], a[12:15], v[40:43]
    v_mfma_f32_16x16x32_bf16 v[44:47], v[116:119], a[12:15], v[44:47]
    ds_read_b128 a[44:47], v4 offset:22528
    s_waitcnt lgkmcnt(4)
    v_mfma_f32_16x16x32_bf16 v[48:51], v[112:115], a[16:19], v[48:51]
    v_mfma_f32_16x16x32_bf16 v[52:55], v[116:119], a[16:19], v[52:55]
    ds_read_b128 a[48:51], v4 offset:24576
    v_mfma_f32_16x16x32_bf16 v[56:59], v[112:115], a[20:23], v[56:59]
    v_mfma_f32_16x16x32_bf16 v[60:63], v[116:119], a[20:23], v[60:63]
    ds_read_b128 a[52:55], v4 offset:26624
    v_mfma_f32_16x16x32_bf16 v[64:67], v[112:115], a[24:27], v[64:67]
    v_mfma_f32_16x16x32_bf16 v[68:71], v[116:119], a[24:27], v[68:71]
    ds_read_b128 a[56:59], v4 offset:28672
    v_mfma_f32_16x16x32_bf16 v[72:75], v[112:115], a[28:31], v[72:75]
    v_mfma_f32_16x16x32_bf16 v[76:79], v[116:119], a[28:31], v[76:79]
    ds_read_b128 a[60:63], v4 offset:30720
    s_waitcnt vmcnt(16)
    s_barrier
    s_waitcnt lgkmcnt(4)
    v_mfma_f32_16x16x32_bf16 v[16:19], v[120:123], a[32:35], v[16:19]
    v_mfma_f32_16x16x32_bf16 v[20:23], v[124:127], a[32:35], v[20:23]
    ds_read_b128 a[0:3], v3 offset:32768
    s_add_u32 m0, s21, 0
    v_mfma_f32_16x16x32_bf16 v[24:27], v[120:123], a[36:39], v[24:27]
    v_mfma_f32_16x16x32_bf16 v[28:31], v[124:127], a[36:39], v[28:31]
    ds_read_b128 a[4:7], v3 offset:34816
    s_add_u32 s64, s20, 0x280
    buffer_load_dwordx4 v2, s[4:7], s64 offen lds
    v_mfma_f32_16x16x32_bf16 v[32:35], v[120:123], a[40:43], v[32:35]
    v_mfma_f32_16x16x32_bf16 v[36:39], v[124:127], a[40:43], v[36:39]
    ds_read_b128 a[8:11], v3 offset:36864
    s_add_u32 m0, s21, 1024
    v_mfma_f32_16x16x32_bf16 v[40:43], v[120:123], a[44:47], v[40:43]
    v_mfma_f32_16x16x32_bf16 v[44:47], v[124:127], a[44:47], v[44:47]
    ds_read_b128 a[12:15], v3 offset:38912
    s_add_u32 s64, s20, 0x2a80
    buffer_load_dwordx4 v2, s[4:7], s64 offen lds
    s_waitcnt lgkmcnt(4)
    v_mfma_f32_16x16x32_bf16 v[48:51], v[120:123], a[48:51], v[48:51]
    v_mfma_f32_16x16x32_bf16 v[52:55], v[124:127], a[48:51], v[52:55]
    ds_read_b128 a[16:19], v3 offset:40960
    s_add_u32 m0, s21, 2048
    v_mfma_f32_16x16x32_bf16 v[56:59], v[120:123], a[52:55], v[56:59]
    v_mfma_f32_16x16x32_bf16 v[60:63], v[124:127], a[52:55], v[60:63]
    ds_read_b128 a[20:23], v3 offset:43008
    s_add_u32 s64, s20, 0x5280
    buffer_load_dwordx4 v2, s[4:7], s64 offen lds
    v_mfma_f32_16x16x32_bf16 v[64:67], v[120:123], a[56:59], v[64:67]
    v_mfma_f32_16x16x32_bf16 v[68:71], v[124:127], a[56:59], v[68:71]
    ds_read_b128 a[24:27], v3 offset:45056
    s_add_u32 m0, s21, 3072
    v_mfma_f32_16x16x32_bf16 v[72:75], v[120:123], a[60:63], v[72:75]
    v_mfma_f32_16x16x32_bf16 v[76:79], v[124:127], a[60:63], v[76:79]
    ds_read_b128 a[28:31], v3 offset:47104
    s_add_u32 s64, s20, 0x7a80
    buffer_load_dwordx4 v2, s[4:7], s64 offen lds
    s_waitcnt lgkmcnt(4)
    v_mfma_f32_16x16x32_bf16 v[16:19], v[128:131], a[0:3], v[16:19]
    v_mfma_f32_16x16x32_bf16 v[20:23], v[132:135], a[0:3], v[20:23]
    ds_read_b128 a[32:35], v4 offset:32768
    v_mfma_f32_16x16x32_bf16 v[24:27], v[128:131], a[4:7], v[24:27]
    v_mfma_f32_16x16x32_bf16 v[28:31], v[132:135], a[4:7], v[28:31]
    ds_read_b128 a[36:39], v4 offset:34816
    v_mfma_f32_16x16x32_bf16 v[32:35], v[128:131], a[8:11], v[32:35]
    v_mfma_f32_16x16x32_bf16 v[36:39], v[132:135], a[8:11], v[36:39]
    ds_read_b128 a[40:43], v4 offset:36864
    v_mfma_f32_16x16x32_bf16 v[40:43], v[128:131], a[12:15], v[40:43]
    v_mfma_f32_16x16x32_bf16 v[44:47], v[132:135], a[12:15], v[44:47]
    ds_read_b128 a[44:47], v4 offset:38912
    s_waitcnt lgkmcnt(4)
    v_mfma_f32_16x16x32_bf16 v[48:51], v[128:131], a[16:19], v[48:51]
    v_mfma_f32_16x16x32_bf16 v[52:55], v[132:135], a[16:19], v[52:55]
    ds_read_b128 a[48:51], v4 offset:40960
    v_mfma_f32_16x16x32_bf16 v[56:59], v[128:131], a[20:23], v[56:59]
    v_mfma_f32_16x16x32_bf16 v[60:63], v[132:135], a[20:23], v[60:63]
    ds_read_b128 a[52:55], v4 offset:43008
    v_mfma_f32_16x16x32_bf16 v[64:67], v[128:131], a[24:27], v[64:67]
    v_mfma_f32_16x16x32_bf16 v[68:71], v[132:135], a[24:27], v[68:71]
    ds_read_b128 a[56:59], v4 offset:45056
    v_mfma_f32_16x16x32_bf16 v[72:75], v[128:131], a[28:31], v[72:75]
    v_mfma_f32_16x16x32_bf16 v[76:79], v[132:135], a[28:31], v[76:79]
    ds_read_b128 a[60:63], v4 offset:47104
    s_waitcnt vmcnt(16)
    s_barrier
    s_waitcnt lgkmcnt(4)
    v_mfma_f32_16x16x32_bf16 v[16:19], v[136:139], a[32:35], v[16:19]
    v_mfma_f32_16x16x32_bf16 v[20:23], v[140:143], a[32:35], v[20:23]
    ds_read_b128 a[0:3], v3 offset:49152
    s_add_u32 m0, s21, 16384
    v_mfma_f32_16x16x32_bf16 v[24:27], v[136:139], a[36:39], v[24:27]
    v_mfma_f32_16x16x32_bf16 v[28:31], v[140:143], a[36:39], v[28:31]
    ds_read_b128 a[4:7], v3 offset:51200
    s_add_u32 s64, s20, 0x300
    buffer_load_dwordx4 v2, s[4:7], s64 offen lds
    v_mfma_f32_16x16x32_bf16 v[32:35], v[136:139], a[40:43], v[32:35]
    v_mfma_f32_16x16x32_bf16 v[36:39], v[140:143], a[40:43], v[36:39]
    ds_read_b128 a[8:11], v3 offset:53248
    s_add_u32 m0, s21, 17408
    v_mfma_f32_16x16x32_bf16 v[40:43], v[136:139], a[44:47], v[40:43]
    v_mfma_f32_16x16x32_bf16 v[44:47], v[140:143], a[44:47], v[44:47]
    ds_read_b128 a[12:15], v3 offset:55296
    s_add_u32 s64, s20, 0x2b00
    buffer_load_dwordx4 v2, s[4:7], s64 offen lds
    s_waitcnt lgkmcnt(4)
    v_mfma_f32_16x16x32_bf16 v[48:51], v[136:139], a[48:51], v[48:51]
    v_mfma_f32_16x16x32_bf16 v[52:55], v[140:143], a[48:51], v[52:55]
    ds_read_b128 a[16:19], v3 offset:57344
    s_add_u32 m0, s21, 18432
    v_mfma_f32_16x16x32_bf16 v[56:59], v[136:139], a[52:55], v[56:59]
    v_mfma_f32_16x16x32_bf16 v[60:63], v[140:143], a[52:55], v[60:63]
    ds_read_b128 a[20:23], v3 offset:59392
    s_add_u32 s64, s20, 0x5300
    buffer_load_dwordx4 v2, s[4:7], s64 offen lds
    v_mfma_f32_16x16x32_bf16 v[64:67], v[136:139], a[56:59], v[64:67]
    v_mfma_f32_16x16x32_bf16 v[68:71], v[140:143], a[56:59], v[68:71]
    ds_read_b128 a[24:27], v3 offset:61440
    s_add_u32 m0, s21, 19456
    v_mfma_f32_16x16x32_bf16 v[72:75], v[136:139], a[60:63], v[72:75]
    v_mfma_f32_16x16x32_bf16 v[76:79], v[140:143], a[60:63], v[76:79]
    ds_read_b128 a[28:31], v3 offset:63488
    s_add_u32 s64, s20, 0x7b00
    buffer_load_dwordx4 v2, s[4:7], s64 offen lds
    s_waitcnt lgkmcnt(4)
    v_mfma_f32_16x16x32_bf16 v[16:19], v[144:147], a[0:3], v[16:19]
    v_mfma_f32_16x16x32_bf16 v[20:23], v[148:151], a[0:3], v[20:23]
    ds_read_b128 a[32:35], v4 offset:49152
    v_mfma_f32_16x16x32_bf16 v[24:27], v[144:147], a[4:7], v[24:27]
    v_mfma_f32_16x16x32_bf16 v[28:31], v[148:151], a[4:7], v[28:31]
    ds_read_b128 a[36:39], v4 offset:51200
    v_mfma_f32_16x16x32_bf16 v[32:35], v[144:147], a[8:11], v[32:35]
    v_mfma_f32_16x16x32_bf16 v[36:39], v[148:151], a[8:11], v[36:39]
    ds_read_b128 a[40:43], v4 offset:53248
    v_mfma_f32_16x16x32_bf16 v[40:43], v[144:147], a[12:15], v[40:43]
    v_mfma_f32_16x16x32_bf16 v[44:47], v[148:151], a[12:15], v[44:47]
    ds_read_b128 a[44:47], v4 offset:55296
    s_waitcnt lgkmcnt(4)
    v_mfma_f32_16x16x32_bf16 v[48:51], v[144:147], a[16:19], v[48:51]
    v_mfma_f32_16x16x32_bf16 v[52:55], v[148:151], a[16:19], v[52:55]
    ds_read_b128 a[48:51], v4 offset:57344
    v_mfma_f32_16x16x32_bf16 v[56:59], v[144:147], a[20:23], v[56:59]
    v_mfma_f32_16x16x32_bf16 v[60:63], v[148:151], a[20:23], v[60:63]
    ds_read_b128 a[52:55], v4 offset:59392
    v_mfma_f32_16x16x32_bf16 v[64:67], v[144:147], a[24:27], v[64:67]
    v_mfma_f32_16x16x32_bf16 v[68:71], v[148:151], a[24:27], v[68:71]
    ds_read_b128 a[56:59], v4 offset:61440
    v_mfma_f32_16x16x32_bf16 v[72:75], v[144:147], a[28:31], v[72:75]
    v_mfma_f32_16x16x32_bf16 v[76:79], v[148:151], a[28:31], v[76:79]
    ds_read_b128 a[60:63], v4 offset:63488
    s_waitcnt vmcnt(8)
    s_barrier
    s_cmp_lg_u32 s14, 0
    s_cbranch_scc1 GF_115
    v_mov_b32 v7, 1
    v_mov_b32 v8, 0
    s_mov_b64 exec, 1
    buffer_store_dword v7, v8, s[4:7], s23 offen sc1
    s_mov_b64 exec, -1
GF_115:
    s_waitcnt lgkmcnt(4)
    v_mfma_f32_16x16x32_bf16 v[16:19], v[152:155], a[32:35], v[16:19]
    v_mfma_f32_16x16x32_bf16 v[20:23], v[156:159], a[32:35], v[20:23]
    ds_read_b128 a[0:3], v6 offset:0
    s_add_u32 m0, s21, 32768
    v_mfma_f32_16x16x32_bf16 v[24:27], v[152:155], a[36:39], v[24:27]
    v_mfma_f32_16x16x32_bf16 v[28:31], v[156:159], a[36:39], v[28:31]
    ds_read_b128 a[4:7], v6 offset:2048
    s_add_u32 s64, s20, 0x380
    buffer_load_dwordx4 v2, s[4:7], s64 offen lds
    v_mfma_f32_16x16x32_bf16 v[32:35], v[152:155], a[40:43], v[32:35]
    v_mfma_f32_16x16x32_bf16 v[36:39], v[156:159], a[40:43], v[36:39]
    ds_read_b128 a[8:11], v6 offset:4096
    s_add_u32 m0, s21, 33792
    v_mfma_f32_16x16x32_bf16 v[40:43], v[152:155], a[44:47], v[40:43]
    v_mfma_f32_16x16x32_bf16 v[44:47], v[156:159], a[44:47], v[44:47]
    ds_read_b128 a[12:15], v6 offset:6144
    s_add_u32 s64, s20, 0x2b80
    buffer_load_dwordx4 v2, s[4:7], s64 offen lds
    s_waitcnt lgkmcnt(4)
    v_mfma_f32_16x16x32_bf16 v[48:51], v[152:155], a[48:51], v[48:51]
    v_mfma_f32_16x16x32_bf16 v[52:55], v[156:159], a[48:51], v[52:55]
    ds_read_b128 a[16:19], v6 offset:8192
    s_add_u32 m0, s21, 34816
    v_mfma_f32_16x16x32_bf16 v[56:59], v[152:155], a[52:55], v[56:59]
    v_mfma_f32_16x16x32_bf16 v[60:63], v[156:159], a[52:55], v[60:63]
    ds_read_b128 a[20:23], v6 offset:10240
    s_add_u32 s64, s20, 0x5380
    buffer_load_dwordx4 v2, s[4:7], s64 offen lds
    v_mfma_f32_16x16x32_bf16 v[64:67], v[152:155], a[56:59], v[64:67]
    v_mfma_f32_16x16x32_bf16 v[68:71], v[156:159], a[56:59], v[68:71]
    ds_read_b128 a[24:27], v6 offset:12288
    s_add_u32 m0, s21, 35840
    v_mfma_f32_16x16x32_bf16 v[72:75], v[152:155], a[60:63], v[72:75]
    v_mfma_f32_16x16x32_bf16 v[76:79], v[156:159], a[60:63], v[76:79]
    ds_read_b128 a[28:31], v6 offset:14336
    s_add_u32 s64, s20, 0x7b80
    buffer_load_dwordx4 v2, s[4:7], s64 offen lds
    s_waitcnt lgkmcnt(4)
    v_mfma_f32_16x16x32_bf16 v[16:19], v[160:163], a[0:3], v[16:19]
    v_mfma_f32_16x16x32_bf16 v[20:23], v[164:167], a[0:3], v[20:23]
    ds_read_b128 a[32:35], v9 offset:0
    v_mfma_f32_16x16x32_bf16 v[24:27], v[160:163], a[4:7], v[24:27]
    v_mfma_f32_16x16x32_bf16 v[28:31], v[164:167], a[4:7], v[28:31]
    ds_read_b128 a[36:39], v9 offset:2048
    v_mfma_f32_16x16x32_bf16 v[32:35], v[160:163], a[8:11], v[32:35]
    v_mfma_f32_16x16x32_bf16 v[36:39], v[164:167], a[8:11], v[36:39]
    ds_read_b128 a[40:43], v9 offset:4096
    v_mfma_f32_16x16x32_bf16 v[40:43], v[160:163], a[12:15], v[40:43]
    v_mfma_f32_16x16x32_bf16 v[44:47], v[164:167], a[12:15], v[44:47]
    ds_read_b128 a[44:47], v9 offset:6144
    s_waitcnt lgkmcnt(4)
    v_mfma_f32_16x16x32_bf16 v[48:51], v[160:163], a[16:19], v[48:51]
    v_mfma_f32_16x16x32_bf16 v[52:55], v[164:167], a[16:19], v[52:55]
    ds_read_b128 a[48:51], v9 offset:8192
    v_mfma_f32_16x16x32_bf16 v[56:59], v[160:163], a[20:23], v[56:59]
    v_mfma_f32_16x16x32_bf16 v[60:63], v[164:167], a[20:23], v[60:63]
    ds_read_b128 a[52:55], v9 offset:10240
    v_mfma_f32_16x16x32_bf16 v[64:67], v[160:163], a[24:27], v[64:67]
    v_mfma_f32_16x16x32_bf16 v[68:71], v[164:167], a[24:27], v[68:71]
    ds_read_b128 a[56:59], v9 offset:12288
    v_mfma_f32_16x16x32_bf16 v[72:75], v[160:163], a[28:31], v[72:75]
    v_mfma_f32_16x16x32_bf16 v[76:79], v[164:167], a[28:31], v[76:79]
    ds_read_b128 a[60:63], v9 offset:14336
    s_waitcnt vmcnt(8)
    s_barrier
    s_waitcnt lgkmcnt(4)
    v_mfma_f32_16x16x32_bf16 v[16:19], v[168:171], a[32:35], v[16:19]
    v_mfma_f32_16x16x32_bf16 v[20:23], v[172:175], a[32:35], v[20:23]
    ds_read_b128 a[0:3], v3 offset:0
    s_add_u32 m0, s21, 49152
    v_mfma_f32_16x16x32_bf16 v[24:27], v[168:171], a[36:39], v[24:27]
    v_mfma_f32_16x16x32_bf16 v[28:31], v[172:175], a[36:39], v[28:31]
    ds_read_b128 a[4:7], v3 offset:2048
    s_add_u32 s64, s20, 0x400
    buffer_load_dwordx4 v2, s[4:7], s64 offen lds
    v_mfma_f32_16x16x32_bf16 v[32:35], v[168:171], a[40:43], v[32:35]
    v_mfma_f32_16x16x32_bf16 v[36:39], v[172:175], a[40:43], v[36:39]
    ds_read_b128 a[8:11], v3 offset:4096
    s_add_u32 m0, s21, 50176
    v_mfma_f32_16x16x32_bf16 v[40:43], v[168:171], a[44:47], v[40:43]
    v_mfma_f32_16x16x32_bf16 v[44:47], v[172:175], a[44:47], v[44:47]
    ds_read_b128 a[12:15], v3 offset:6144
    s_add_u32 s64, s20, 0x2c00
    buffer_load_dwordx4 v2, s[4:7], s64 offen lds
    s_waitcnt lgkmcnt(4)
    v_mfma_f32_16x16x32_bf16 v[48:51], v[168:171], a[48:51], v[48:51]
    v_mfma_f32_16x16x32_bf16 v[52:55], v[172:175], a[48:51], v[52:55]
    ds_read_b128 a[16:19], v3 offset:8192
    s_add_u32 m0, s21, 51200
    v_mfma_f32_16x16x32_bf16 v[56:59], v[168:171], a[52:55], v[56:59]
    v_mfma_f32_16x16x32_bf16 v[60:63], v[172:175], a[52:55], v[60:63]
    ds_read_b128 a[20:23], v3 offset:10240
    s_add_u32 s64, s20, 0x5400
    buffer_load_dwordx4 v2, s[4:7], s64 offen lds
    v_mfma_f32_16x16x32_bf16 v[64:67], v[168:171], a[56:59], v[64:67]
    v_mfma_f32_16x16x32_bf16 v[68:71], v[172:175], a[56:59], v[68:71]
    ds_read_b128 a[24:27], v3 offset:12288
    s_add_u32 m0, s21, 52224
    v_mfma_f32_16x16x32_bf16 v[72:75], v[168:171], a[60:63], v[72:75]
    v_mfma_f32_16x16x32_bf16 v[76:79], v[172:175], a[60:63], v[76:79]
    ds_read_b128 a[28:31], v3 offset:14336
    s_add_u32 s64, s20, 0x7c00
    buffer_load_dwordx4 v2, s[4:7], s64 offen lds
    s_waitcnt lgkmcnt(4)
    v_mfma_f32_16x16x32_bf16 v[16:19], v[176:179], a[0:3], v[16:19]
    v_mfma_f32_16x16x32_bf16 v[20:23], v[180:183], a[0:3], v[20:23]
    ds_read_b128 a[32:35], v4 offset:0
    v_mfma_f32_16x16x32_bf16 v[24:27], v[176:179], a[4:7], v[24:27]
    v_mfma_f32_16x16x32_bf16 v[28:31], v[180:183], a[4:7], v[28:31]
    ds_read_b128 a[36:39], v4 offset:2048
    v_mfma_f32_16x16x32_bf16 v[32:35], v[176:179], a[8:11], v[32:35]
    v_mfma_f32_16x16x32_bf16 v[36:39], v[180:183], a[8:11], v[36:39]
    ds_read_b128 a[40:43], v4 offset:4096
    v_mfma_f32_16x16x32_bf16 v[40:43], v[176:179], a[12:15], v[40:43]
    v_mfma_f32_16x16x32_bf16 v[44:47], v[180:183], a[12:15], v[44:47]
    ds_read_b128 a[44:47], v4 offset:6144
    s_waitcnt lgkmcnt(4)
    v_mfma_f32_16x16x32_bf16 v[48:51], v[176:179], a[16:19], v[48:51]
    v_mfma_f32_16x16x32_bf16 v[52:55], v[180:183], a[16:19], v[52:55]
    ds_read_b128 a[48:51], v4 offset:8192
    v_mfma_f32_16x16x32_bf16 v[56:59], v[176:179], a[20:23], v[56:59]
    v_mfma_f32_16x16x32_bf16 v[60:63], v[180:183], a[20:23], v[60:63]
    ds_read_b128 a[52:55], v4 offset:10240
    v_mfma_f32_16x16x32_bf16 v[64:67], v[176:179], a[24:27], v[64:67]
    v_mfma_f32_16x16x32_bf16 v[68:71], v[180:183], a[24:27], v[68:71]
    ds_read_b128 a[56:59], v4 offset:12288
    v_mfma_f32_16x16x32_bf16 v[72:75], v[176:179], a[28:31], v[72:75]
    v_mfma_f32_16x16x32_bf16 v[76:79], v[180:183], a[28:31], v[76:79]
    ds_read_b128 a[60:63], v4 offset:14336
    s_waitcnt vmcnt(8)
    s_barrier
    s_waitcnt lgkmcnt(4)
    v_mfma_f32_16x16x32_bf16 v[16:19], v[184:187], a[32:35], v[16:19]
    v_mfma_f32_16x16x32_bf16 v[20:23], v[188:191], a[32:35], v[20:23]
    ds_read_b128 a[0:3], v3 offset:16384
    s_add_u32 m0, s21, 65536
    v_mfma_f32_16x16x32_bf16 v[24:27], v[184:187], a[36:39], v[24:27]
    v_mfma_f32_16x16x32_bf16 v[28:31], v[188:191], a[36:39], v[28:31]
    ds_read_b128 a[4:7], v3 offset:18432
    s_add_u32 s64, s20, 0x480
    buffer_load_dwordx4 v2, s[4:7], s64 offen lds
    v_mfma_f32_16x16x32_bf16 v[32:35], v[184:187], a[40:43], v[32:35]
    v_mfma_f32_16x16x32_bf16 v[36:39], v[188:191], a[40:43], v[36:39]
    ds_read_b128 a[8:11], v3 offset:20480
    s_add_u32 m0, s21, 66560
    v_mfma_f32_16x16x32_bf16 v[40:43], v[184:187], a[44:47], v[40:43]
    v_mfma_f32_16x16x32_bf16 v[44:47], v[188:191], a[44:47], v[44:47]
    ds_read_b128 a[12:15], v3 offset:22528
    s_add_u32 s64, s20, 0x2c80
    buffer_load_dwordx4 v2, s[4:7], s64 offen lds
    s_waitcnt lgkmcnt(4)
    v_mfma_f32_16x16x32_bf16 v[48:51], v[184:187], a[48:51], v[48:51]
    v_mfma_f32_16x16x32_bf16 v[52:55], v[188:191], a[48:51], v[52:55]
    ds_read_b128 a[16:19], v3 offset:24576
    s_add_u32 m0, s21, 67584
    v_mfma_f32_16x16x32_bf16 v[56:59], v[184:187], a[52:55], v[56:59]
    v_mfma_f32_16x16x32_bf16 v[60:63], v[188:191], a[52:55], v[60:63]
    ds_read_b128 a[20:23], v3 offset:26624
    s_add_u32 s64, s20, 0x5480
    buffer_load_dwordx4 v2, s[4:7], s64 offen lds
    v_mfma_f32_16x16x32_bf16 v[64:67], v[184:187], a[56:59], v[64:67]
    v_mfma_f32_16x16x32_bf16 v[68:71], v[188:191], a[56:59], v[68:71]
    ds_read_b128 a[24:27], v3 offset:28672
    s_add_u32 m0, s21, 68608
    v_mfma_f32_16x16x32_bf16 v[72:75], v[184:187], a[60:63], v[72:75]
    v_mfma_f32_16x16x32_bf16 v[76:79], v[188:191], a[60:63], v[76:79]
    ds_read_b128 a[28:31], v3 offset:30720
    s_add_u32 s64, s20, 0x7c80
    buffer_load_dwordx4 v2, s[4:7], s64 offen lds
    s_waitcnt lgkmcnt(4)
    v_mfma_f32_16x16x32_bf16 v[16:19], v[192:195], a[0:3], v[16:19]
    v_mfma_f32_16x16x32_bf16 v[20:23], v[196:199], a[0:3], v[20:23]
    ds_read_b128 a[32:35], v4 offset:16384
    v_mfma_f32_16x16x32_bf16 v[24:27], v[192:195], a[4:7], v[24:27]
    v_mfma_f32_16x16x32_bf16 v[28:31], v[196:199], a[4:7], v[28:31]
    ds_read_b128 a[36:39], v4 offset:18432
    v_mfma_f32_16x16x32_bf16 v[32:35], v[192:195], a[8:11], v[32:35]
    v_mfma_f32_16x16x32_bf16 v[36:39], v[196:199], a[8:11], v[36:39]
    ds_read_b128 a[40:43], v4 offset:20480
    v_mfma_f32_16x16x32_bf16 v[40:43], v[192:195], a[12:15], v[40:43]
    v_mfma_f32_16x16x32_bf16 v[44:47], v[196:199], a[12:15], v[44:47]
    ds_read_b128 a[44:47], v4 offset:22528
    s_waitcnt lgkmcnt(4)
    v_mfma_f32_16x16x32_bf16 v[48:51], v[192:195], a[16:19], v[48:51]
    v_mfma_f32_16x16x32_bf16 v[52:55], v[196:199], a[16:19], v[52:55]
    ds_read_b128 a[48:51], v4 offset:24576
    v_mfma_f32_16x16x32_bf16 v[56:59], v[192:195], a[20:23], v[56:59]
    v_mfma_f32_16x16x32_bf16 v[60:63], v[196:199], a[20:23], v[60:63]
    ds_read_b128 a[52:55], v4 offset:26624
    v_mfma_f32_16x16x32_bf16 v[64:67], v[192:195], a[24:27], v[64:67]
    v_mfma_f32_16x16x32_bf16 v[68:71], v[196:199], a[24:27], v[68:71]
    ds_read_b128 a[56:59], v4 offset:28672
    v_mfma_f32_16x16x32_bf16 v[72:75], v[192:195], a[28:31], v[72:75]
    v_mfma_f32_16x16x32_bf16 v[76:79], v[196:199], a[28:31], v[76:79]
    ds_read_b128 a[60:63], v4 offset:30720
    s_waitcnt vmcnt(8)
    s_barrier
    s_waitcnt lgkmcnt(4)
    v_mfma_f32_16x16x32_bf16 v[16:19], v[200:203], a[32:35], v[16:19]
    v_mfma_f32_16x16x32_bf16 v[20:23], v[204:207], a[32:35], v[20:23]
    ds_read_b128 a[0:3], v3 offset:32768
    s_add_u32 m0, s21, 0
    v_mfma_f32_16x16x32_bf16 v[24:27], v[200:203], a[36:39], v[24:27]
    v_mfma_f32_16x16x32_bf16 v[28:31], v[204:207], a[36:39], v[28:31]
    ds_read_b128 a[4:7], v3 offset:34816
    s_add_u32 s64, s20, 0x50000
    buffer_load_dwordx4 v2, s[4:7], s64 offen lds
    v_mfma_f32_16x16x32_bf16 v[32:35], v[200:203], a[40:43], v[32:35]
    v_mfma_f32_16x16x32_bf16 v[36:39], v[204:207], a[40:43], v[36:39]
    ds_read_b128 a[8:11], v3 offset:36864
    s_add_u32 m0, s21, 1024
    v_mfma_f32_16x16x32_bf16 v[40:43], v[200:203], a[44:47], v[40:43]
    v_mfma_f32_16x16x32_bf16 v[44:47], v[204:207], a[44:47], v[44:47]
    ds_read_b128 a[12:15], v3 offset:38912
    s_add_u32 s64, s20, 0x52800
    buffer_load_dwordx4 v2, s[4:7], s64 offen lds
    s_waitcnt lgkmcnt(4)
    v_mfma_f32_16x16x32_bf16 v[48:51], v[200:203], a[48:51], v[48:51]
    v_mfma_f32_16x16x32_bf16 v[52:55], v[204:207], a[48:51], v[52:55]
    ds_read_b128 a[16:19], v3 offset:40960
    s_add_u32 m0, s21, 2048
    v_mfma_f32_16x16x32_bf16 v[56:59], v[200:203], a[52:55], v[56:59]
    v_mfma_f32_16x16x32_bf16 v[60:63], v[204:207], a[52:55], v[60:63]
    ds_read_b128 a[20:23], v3 offset:43008
    s_add_u32 s64, s20, 0x55000
    buffer_load_dwordx4 v2, s[4:7], s64 offen lds
    v_mfma_f32_16x16x32_bf16 v[64:67], v[200:203], a[56:59], v[64:67]
    v_mfma_f32_16x16x32_bf16 v[68:71], v[204:207], a[56:59], v[68:71]
    ds_read_b128 a[24:27], v3 offset:45056
    s_add_u32 m0, s21, 3072
    v_mfma_f32_16x16x32_bf16 v[72:75], v[200:203], a[60:63], v[72:75]
    v_mfma_f32_16x16x32_bf16 v[76:79], v[204:207], a[60:63], v[76:79]
    ds_read_b128 a[28:31], v3 offset:47104
    s_add_u32 s64, s20, 0x57800
    buffer_load_dwordx4 v2, s[4:7], s64 offen lds
    s_waitcnt lgkmcnt(4)
    v_mfma_f32_16x16x32_bf16 v[16:19], v[208:211], a[0:3], v[16:19]
    v_mfma_f32_16x16x32_bf16 v[20:23], v[212:215], a[0:3], v[20:23]
    ds_read_b128 a[32:35], v4 offset:32768
    v_mfma_f32_16x16x32_bf16 v[24:27], v[208:211], a[4:7], v[24:27]
    v_mfma_f32_16x16x32_bf16 v[28:31], v[212:215], a[4:7], v[28:31]
    ds_read_b128 a[36:39], v4 offset:34816
    v_mfma_f32_16x16x32_bf16 v[32:35], v[208:211], a[8:11], v[32:35]
    v_mfma_f32_16x16x32_bf16 v[36:39], v[212:215], a[8:11], v[36:39]
    ds_read_b128 a[40:43], v4 offset:36864
    v_mfma_f32_16x16x32_bf16 v[40:43], v[208:211], a[12:15], v[40:43]
    v_mfma_f32_16x16x32_bf16 v[44:47], v[212:215], a[12:15], v[44:47]
    ds_read_b128 a[44:47], v4 offset:38912
    s_waitcnt lgkmcnt(4)
    v_mfma_f32_16x16x32_bf16 v[48:51], v[208:211], a[16:19], v[48:51]
    v_mfma_f32_16x16x32_bf16 v[52:55], v[212:215], a[16:19], v[52:55]
    ds_read_b128 a[48:51], v4 offset:40960
    v_mfma_f32_16x16x32_bf16 v[56:59], v[208:211], a[20:23], v[56:59]
    v_mfma_f32_16x16x32_bf16 v[60:63], v[212:215], a[20:23], v[60:63]
    ds_read_b128 a[52:55], v4 offset:43008
    v_mfma_f32_16x16x32_bf16 v[64:67], v[208:211], a[24:27], v[64:67]
    v_mfma_f32_16x16x32_bf16 v[68:71], v[212:215], a[24:27], v[68:71]
    ds_read_b128 a[56:59], v4 offset:45056
    v_mfma_f32_16x16x32_bf16 v[72:75], v[208:211], a[28:31], v[72:75]
    v_mfma_f32_16x16x32_bf16 v[76:79], v[212:215], a[28:31], v[76:79]
    ds_read_b128 a[60:63], v4 offset:47104
    s_waitcnt vmcnt(8)
    s_barrier
    s_waitcnt lgkmcnt(4)
    v_mfma_f32_16x16x32_bf16 v[16:19], v[216:219], a[32:35], v[16:19]
    v_mfma_f32_16x16x32_bf16 v[20:23], v[220:223], a[32:35], v[20:23]
    ds_read_b128 a[0:3], v3 offset:49152
    s_add_u32 m0, s21, 16384
    v_mfma_f32_16x16x32_bf16 v[24:27], v[216:219], a[36:39], v[24:27]
    v_mfma_f32_16x16x32_bf16 v[28:31], v[220:223], a[36:39], v[28:31]
    ds_read_b128 a[4:7], v3 offset:51200
    s_add_u32 s64, s20, 0x50080
    buffer_load_dwordx4 v2, s[4:7], s64 offen lds
    v_mfma_f32_16x16x32_bf16 v[32:35], v[216:219], a[40:43], v[32:35]
    v_mfma_f32_16x16x32_bf16 v[36:39], v[220:223], a[40:43], v[36:39]
    ds_read_b128 a[8:11], v3 offset:53248
    s_add_u32 m0, s21, 17408
    v_mfma_f32_16x16x32_bf16 v[40:43], v[216:219], a[44:47], v[40:43]
    v_mfma_f32_16x16x32_bf16 v[44:47], v[220:223], a[44:47], v[44:47]
    ds_read_b128 a[12:15], v3 offset:55296
    s_add_u32 s64, s20, 0x52880
    buffer_load_dwordx4 v2, s[4:7], s64 offen lds
    s_waitcnt lgkmcnt(4)
    v_mfma_f32_16x16x32_bf16 v[48:51], v[216:219], a[48:51], v[48:51]
    v_mfma_f32_16x16x32_bf16 v[52:55], v[220:223], a[48:51], v[52:55]
    ds_read_b128 a[16:19], v3 offset:57344
    s_add_u32 m0, s21, 18432
    v_mfma_f32_16x16x32_bf16 v[56:59], v[216:219], a[52:55], v[56:59]
    v_mfma_f32_16x16x32_bf16 v[60:63], v[220:223], a[52:55], v[60:63]
    ds_read_b128 a[20:23], v3 offset:59392
    s_add_u32 s64, s20, 0x55080
    buffer_load_dwordx4 v2, s[4:7], s64 offen lds
    v_mfma_f32_16x16x32_bf16 v[64:67], v[216:219], a[56:59], v[64:67]
    v_mfma_f32_16x16x32_bf16 v[68:71], v[220:223], a[56:59], v[68:71]
    ds_read_b128 a[24:27], v3 offset:61440
    s_add_u32 m0, s21, 19456
    v_mfma_f32_16x16x32_bf16 v[72:75], v[216:219], a[60:63], v[72:75]
    v_mfma_f32_16x16x32_bf16 v[76:79], v[220:223], a[60:63], v[76:79]
    ds_read_b128 a[28:31], v3 offset:63488
    s_add_u32 s64, s20, 0x57880
    buffer_load_dwordx4 v2, s[4:7], s64 offen lds
    s_waitcnt lgkmcnt(4)
    v_mfma_f32_16x16x32_bf16 v[16:19], v[224:227], a[0:3], v[16:19]
    v_mfma_f32_16x16x32_bf16 v[20:23], v[228:231], a[0:3], v[20:23]
    ds_read_b128 a[32:35], v4 offset:49152
    v_mfma_f32_16x16x32_bf16 v[24:27], v[224:227], a[4:7], v[24:27]
    v_mfma_f32_16x16x32_bf16 v[28:31], v[228:231], a[4:7], v[28:31]
    ds_read_b128 a[36:39], v4 offset:51200
    v_mfma_f32_16x16x32_bf16 v[32:35], v[224:227], a[8:11], v[32:35]
    v_mfma_f32_16x16x32_bf16 v[36:39], v[228:231], a[8:11], v[36:39]
    ds_read_b128 a[40:43], v4 offset:53248
    v_mfma_f32_16x16x32_bf16 v[40:43], v[224:227], a[12:15], v[40:43]
    v_mfma_f32_16x16x32_bf16 v[44:47], v[228:231], a[12:15], v[44:47]
    ds_read_b128 a[44:47], v4 offset:55296
    s_waitcnt lgkmcnt(4)
    v_mfma_f32_16x16x32_bf16 v[48:51], v[224:227], a[16:19], v[48:51]
    v_mfma_f32_16x16x32_bf16 v[52:55], v[228:231], a[16:19], v[52:55]
    ds_read_b128 a[48:51], v4 offset:57344
    v_mfma_f32_16x16x32_bf16 v[56:59], v[224:227], a[20:23], v[56:59]
    v_mfma_f32_16x16x32_bf16 v[60:63], v[228:231], a[20:23], v[60:63]
    ds_read_b128 a[52:55], v4 offset:59392
    v_mfma_f32_16x16x32_bf16 v[64:67], v[224:227], a[24:27], v[64:67]
    v_mfma_f32_16x16x32_bf16 v[68:71], v[228:231], a[24:27], v[68:71]
    ds_read_b128 a[56:59], v4 offset:61440
    v_mfma_f32_16x16x32_bf16 v[72:75], v[224:227], a[28:31], v[72:75]
    v_mfma_f32_16x16x32_bf16 v[76:79], v[228:231], a[28:31], v[76:79]
    ds_read_b128 a[60:63], v4 offset:63488
    s_waitcnt vmcnt(8)
    s_barrier
    s_waitcnt lgkmcnt(4)
    v_mfma_f32_16x16x32_bf16 v[16:19], v[232:235], a[32:35], v[16:19]
    v_mfma_f32_16x16x32_bf16 v[20:23], v[236:239], a[32:35], v[20:23]
    ds_read_b128 a[0:3], v6 offset:0
    s_add_u32 m0, s21, 32768
    v_mfma_f32_16x16x32_bf16 v[24:27], v[232:235], a[36:39], v[24:27]
    v_mfma_f32_16x16x32_bf16 v[28:31], v[236:239], a[36:39], v[28:31]
    ds_read_b128 a[4:7], v6 offset:2048
    s_add_u32 s64, s20, 0x50100
    buffer_load_dwordx4 v2, s[4:7], s64 offen lds
    v_mfma_f32_16x16x32_bf16 v[32:35], v[232:235], a[40:43], v[32:35]
    v_mfma_f32_16x16x32_bf16 v[36:39], v[236:239], a[40:43], v[36:39]
    ds_read_b128 a[8:11], v6 offset:4096
    s_add_u32 m0, s21, 33792
    v_mfma_f32_16x16x32_bf16 v[40:43], v[232:235], a[44:47], v[40:43]
    v_mfma_f32_16x16x32_bf16 v[44:47], v[236:239], a[44:47], v[44:47]
    ds_read_b128 a[12:15], v6 offset:6144
    s_add_u32 s64, s20, 0x52900
    buffer_load_dwordx4 v2, s[4:7], s64 offen lds
    s_waitcnt lgkmcnt(4)
    v_mfma_f32_16x16x32_bf16 v[48:51], v[232:235], a[48:51], v[48:51]
    v_mfma_f32_16x16x32_bf16 v[52:55], v[236:239], a[48:51], v[52:55]
    ds_read_b128 a[16:19], v6 offset:8192
    s_add_u32 m0, s21, 34816
    v_mfma_f32_16x16x32_bf16 v[56:59], v[232:235], a[52:55], v[56:59]
    v_mfma_f32_16x16x32_bf16 v[60:63], v[236:239], a[52:55], v[60:63]
    ds_read_b128 a[20:23], v6 offset:10240
    s_add_u32 s64, s20, 0x55100
    buffer_load_dwordx4 v2, s[4:7], s64 offen lds
    v_mfma_f32_16x16x32_bf16 v[64:67], v[232:235], a[56:59], v[64:67]
    v_mfma_f32_16x16x32_bf16 v[68:71], v[236:239], a[56:59], v[68:71]
    ds_read_b128 a[24:27], v6 offset:12288
    s_add_u32 m0, s21, 35840
    v_mfma_f32_16x16x32_bf16 v[72:75], v[232:235], a[60:63], v[72:75]
    v_mfma_f32_16x16x32_bf16 v[76:79], v[236:239], a[60:63], v[76:79]
    ds_read_b128 a[28:31], v6 offset:14336
    s_add_u32 s64, s20, 0x57900
    buffer_load_dwordx4 v2, s[4:7], s64 offen lds
    s_waitcnt lgkmcnt(4)
    v_mfma_f32_16x16x32_bf16 v[16:19], v[240:243], a[0:3], v[16:19]
    v_mfma_f32_16x16x32_bf16 v[20:23], v[244:247], a[0:3], v[20:23]
    ds_read_b128 a[32:35], v9 offset:0
    v_mfma_f32_16x16x32_bf16 v[24:27], v[240:243], a[4:7], v[24:27]
    v_mfma_f32_16x16x32_bf16 v[28:31], v[244:247], a[4:7], v[28:31]
    ds_read_b128 a[36:39], v9 offset:2048
    v_mfma_f32_16x16x32_bf16 v[32:35], v[240:243], a[8:11], v[32:35]
    v_mfma_f32_16x16x32_bf16 v[36:39], v[244:247], a[8:11], v[36:39]
    ds_read_b128 a[40:43], v9 offset:4096
    v_mfma_f32_16x16x32_bf16 v[40:43], v[240:243], a[12:15], v[40:43]
    v_mfma_f32_16x16x32_bf16 v[44:47], v[244:247], a[12:15], v[44:47]
    ds_read_b128 a[44:47], v9 offset:6144
    s_waitcnt lgkmcnt(4)
    v_mfma_f32_16x16x32_bf16 v[48:51], v[240:243], a[16:19], v[48:51]
    v_mfma_f32_16x16x32_bf16 v[52:55], v[244:247], a[16:19], v[52:55]
    ds_read_b128 a[48:51], v9 offset:8192
    v_mfma_f32_16x16x32_bf16 v[56:59], v[240:243], a[20:23], v[56:59]
    v_mfma_f32_16x16x32_bf16 v[60:63], v[244:247], a[20:23], v[60:63]
    ds_read_b128 a[52:55], v9 offset:10240
    v_mfma_f32_16x16x32_bf16 v[64:67], v[240:243], a[24:27], v[64:67]
    v_mfma_f32_16x16x32_bf16 v[68:71], v[244:247], a[24:27], v[68:71]
    ds_read_b128 a[56:59], v9 offset:12288
    v_mfma_f32_16x16x32_bf16 v[72:75], v[240:243], a[28:31], v[72:75]
    v_mfma_f32_16x16x32_bf16 v[76:79], v[244:247], a[28:31], v[76:79]
    ds_read_b128 a[60:63], v9 offset:14336
    s_waitcnt vmcnt(8)
    s_barrier
    s_waitcnt lgkmcnt(4)
    v_mfma_f32_16x16x32_bf16 v[16:19], v[248:251], a[32:35], v[16:19]
    v_mfma_f32_16x16x32_bf16 v[20:23], v[252:255], a[32:35], v[20:23]
    ds_read_b128 a[0:3], v3 offset:0
    s_add_u32 m0, s21, 49152
    v_mfma_f32_16x16x32_bf16 v[24:27], v[248:251], a[36:39], v[24:27]
    v_mfma_f32_16x16x32_bf16 v[28:31], v[252:255], a[36:39], v[28:31]
    ds_read_b128 a[4:7], v3 offset:2048
    s_add_u32 s64, s20, 0x50180
    buffer_load_dwordx4 v2, s[4:7], s64 offen lds
    v_mfma_f32_16x16x32_bf16 v[32:35], v[248:251], a[40:43], v[32:35]
    v_mfma_f32_16x16x32_bf16 v[36:39], v[252:255], a[40:43], v[36:39]
    ds_read_b128 a[8:11], v3 offset:4096
    s_add_u32 m0, s21, 50176
    v_mfma_f32_16x16x32_bf16 v[40:43], v[248:251], a[44:47], v[40:43]
    v_mfma_f32_16x16x32_bf16 v[44:47], v[252:255], a[44:47], v[44:47]
    ds_read_b128 a[12:15], v3 offset:6144
    s_add_u32 s64, s20, 0x52980
    buffer_load_dwordx4 v2, s[4:7], s64 offen lds
    s_waitcnt lgkmcnt(4)
    v_mfma_f32_16x16x32_bf16 v[48:51], v[248:251], a[48:51], v[48:51]
    v_mfma_f32_16x16x32_bf16 v[52:55], v[252:255], a[48:51], v[52:55]
    ds_read_b128 a[16:19], v3 offset:8192
    s_add_u32 m0, s21, 51200
    v_mfma_f32_16x16x32_bf16 v[56:59], v[248:251], a[52:55], v[56:59]
    v_mfma_f32_16x16x32_bf16 v[60:63], v[252:255], a[52:55], v[60:63]
    ds_read_b128 a[20:23], v3 offset:10240
    s_add_u32 s64, s20, 0x55180
    buffer_load_dwordx4 v2, s[4:7], s64 offen lds
    v_mfma_f32_16x16x32_bf16 v[64:67], v[248:251], a[56:59], v[64:67]
    v_mfma_f32_16x16x32_bf16 v[68:71], v[252:255], a[56:59], v[68:71]
    ds_read_b128 a[24:27], v3 offset:12288
    s_add_u32 m0, s21, 52224
    v_mfma_f32_16x16x32_bf16 v[72:75], v[248:251], a[60:63], v[72:75]
    v_mfma_f32_16x16x32_bf16 v[76:79], v[252:255], a[60:63], v[76:79]
    ds_read_b128 a[28:31], v3 offset:14336
    s_add_u32 s64, s20, 0x57980
    buffer_load_dwordx4 v2, s[4:7], s64 offen lds
    s_nop 5
    s_mul_i32 s65, s17, 0
    s_add_u32 s65, s65, s22
    s_add_u32 s64, s65, 0
    v_cvt_pk_bf16_f32 v80, v16, v17
    v_cvt_pk_bf16_f32 v81, v18, v19
    v_cvt_pk_bf16_f32 v82, v20, v21
    v_cvt_pk_bf16_f32 v83, v22, v23
    buffer_store_dwordx4 v[80:83], v1, s[4:7], s64 offen sc1
    s_add_u32 s64, s65, 4096
    v_cvt_pk_bf16_f32 v84, v24, v25
    v_cvt_pk_bf16_f32 v85, v26, v27
    v_cvt_pk_bf16_f32 v86, v28, v29
    v_cvt_pk_bf16_f32 v87, v30, v31
    buffer_store_dwordx4 v[84:87], v1, s[4:7], s64 offen sc1
    s_mul_i32 s65, s17, 1
    s_add_u32 s65, s65, s22
    s_add_u32 s64, s65, 0
    v_cvt_pk_bf16_f32 v88, v32, v33
    v_cvt_pk_bf16_f32 v89, v34, v35
    v_cvt_pk_bf16_f32 v90, v36, v37
    v_cvt_pk_bf16_f32 v91, v38, v39
    buffer_store_dwordx4 v[88:91], v1, s[4:7], s64 offen sc1
    s_add_u32 s64, s65, 4096
    v_cvt_pk_bf16_f32 v92, v40, v41
    v_cvt_pk_bf16_f32 v93, v42, v43
    v_cvt_pk_bf16_f32 v94, v44, v45
    v_cvt_pk_bf16_f32 v95, v46, v47
    buffer_store_dwordx4 v[92:95], v1, s[4:7], s64 offen sc1
    s_mul_i32 s65, s17, 2
    s_add_u32 s65, s65, s22
    s_add_u32 s64, s65, 0
    v_cvt_pk_bf16_f32 v80, v48, v49
    v_cvt_pk_bf16_f32 v81, v50, v51
    v_cvt_pk_bf16_f32 v82, v52, v53
    v_cvt_pk_bf16_f32 v83, v54, v55
    buffer_store_dwordx4 v[80:83], v1, s[4:7], s64 offen sc1
    s_add_u32 s64, s65, 4096
    v_cvt_pk_bf16_f32 v84, v56, v57
    v_cvt_pk_bf16_f32 v85, v58, v59
    v_cvt_pk_bf16_f32 v86, v60, v61
    v_cvt_pk_bf16_f32 v87, v62, v63
    buffer_store_dwordx4 v[84:87], v1, s[4:7], s64 offen sc1
    s_mul_i32 s65, s17, 3
    s_add_u32 s65, s65, s22
    s_add_u32 s64, s65, 0
    v_cvt_pk_bf16_f32 v88, v64, v65
    v_cvt_pk_bf16_f32 v89, v66, v67
    v_cvt_pk_bf16_f32 v90, v68, v69
    v_cvt_pk_bf16_f32 v91, v70, v71
    buffer_store_dwordx4 v[88:91], v1, s[4:7], s64 offen sc1
    s_add_u32 s64, s65, 4096
    v_cvt_pk_bf16_f32 v92, v72, v73
    v_cvt_pk_bf16_f32 v93, v74, v75
    v_cvt_pk_bf16_f32 v94, v76, v77
    v_cvt_pk_bf16_f32 v95, v78, v79
    buffer_store_dwordx4 v[92:95], v1, s[4:7], s64 offen sc1
    s_lshl_b32 s64, s19, 1
    s_add_u32 s64, s64, s12
    s_lshl_b32 s64, s64, 9
    s_add_u32 s23, s18, s64
    s_lshl_b32 s64, s17, 3
    s_add_u32 s22, s22, s64
    s_add_u32 s19, s19, 1
    s_add_u32 s20, s20, 0x50000
    s_cmp_lg_u32 s19, 1
    s_cbranch_scc1 GE0_116
    s_waitcnt vmcnt(0)
    s_barrier
    s_cmp_lg_u32 s14, 0
    s_cbranch_scc1 GF_117
    v_mov_b32 v7, 1
    v_mov_b32 v8, 0
    s_mov_b64 exec, 1
    buffer_store_dword v7, v8, s[4:7], s23 offen sc1
    s_mov_b64 exec, -1
GF_117:
GE0_116:
    s_cmp_lt_u32 s19, 8
    s_cbranch_scc1 G_T_LOOP
    s_waitcnt vmcnt(0) lgkmcnt(0)
    s_barrier
    s_cmp_lg_u32 s14, 0
    s_cbranch_scc1 GF_118
    v_mov_b32 v7, 1
    v_mov_b32 v8, 0
    s_mov_b64 exec, 1
    buffer_store_dword v7, v8, s[4:7], s23 offen sc1
    s_mov_b64 exec, -1
GF_118:
    s_cmp_eq_u32 s3, 2
    s_cbranch_scc1 H_Q
    s_cmp_eq_u32 s12, 1
    s_cbranch_scc1 H_OUT
    s_lshl_b32 s88, s3, 5
    s_add_u32 s88, s88, s13
    s_mov_b32 s29, 0
    v_lshlrev_b32 v1, 4, v0
    s_mov_b32 s65, 0
CW_119:
    buffer_load_dwordx2 v[8:9], off, s[60:63], 0 offset:132 sc1
    s_add_u32 s65, s65, 1
    s_waitcnt vmcnt(0)
    v_readfirstlane_b32 s66, v8
    v_readfirstlane_b32 s67, v9
    s_min_u32 s64, s66, s67
    s_cmp_lg_u32 s64, 0
    s_cbranch_scc1 CWD_120
    s_cmp_gt_u32 s65, 65536
    s_cbranch_scc1 CWD_120
    s_sleep 4
    s_branch CW_119
CWD_120:
    s_sub_u32 s66, s66, 1
    s_and_b32 s66, s66, 3
    s_sub_u32 s67, s67, 1
    s_and_b32 s67, s67, 3
    s_mov_b32 s64, s66
    s_mov_b32 s65, s67
    s_and_b32 s64, s64, 3
    s_lshl_b32 s64, s64, 13
    s_and_b32 s65, s65, 3
    s_lshl_b32 s65, s65, 13
    s_add_u32 s25, s64, 0x6000000
    s_add_u32 s30, s65, 0x6200000
    v_bfe_u32 v4, v0, 3, 1
    v_mul_u32_u24 v2, 0x8000, v4
    v_lshrrev_b32 v4, 5, v0
    v_lshl_add_u32 v2, v4, 8, v2
    v_bfe_u32 v4, v0, 4, 1
    v_lshl_add_u32 v2, v4, 7, v2
    v_and_b32 v4, 7, v0
    v_lshl_add_u32 v2, v4, 4, v2
    v_bfe_u32 v4, v0, 3, 1
    v_lshlrev_b32 v3, 16, v4
    v_lshrrev_b32 v4, 4, v0
    v_lshl_add_u32 v3, v4, 7, v3
    v_and_b32 v4, 7, v0
    v_lshl_add_u32 v3, v4, 4, v3
    s_lshl_b32 s26, s13, 11
    s_lshl_b32 s64, s14, 9
    s_add_u32 s26, s26, s64
    s_add_u32 s26, s26, 0x640000
    s_lshl_b32 s27, s13, 3
    s_add_u32 s27, s27, 0x294000
    s_mov_b32 s28, 0x29a000
    s_mov_b32 s24, 0
    v_lshlrev_b32 v6, 7, v0
MKT_LOOP:
    s_cmp_lg_u32 s24, 10
    s_cbranch_scc1 MKH_121
    v_mov_b32 v10, v2
    v_mov_b32 v11, v3
    s_cmp_ge_u32 s88, 60
    s_cbranch_scc1 NOWO_122
    s_mov_b32 s89, s13
    s_mul_hi_u32 s65, s88, 0xccccccd
    s_mul_i32 s65, s65, 20
    s_sub_u32 s13, s88, s65
    s_load_dwordx2 s[44:45], s[0:1], 40
    s_mov_b32 s46, 0x500000
    s_mov_b32 s47, 0x00020000
    s_waitcnt lgkmcnt(0)
    s_mul_i32 s21, s14, 36864
    v_lshrrev_b32 v7, 2, v0
    v_mul_u32_u24 v4, 1280, v7
    v_bfe_u32 v7, v0, 4, 1
    v_lshlrev_b32 v7, 1, v7
    v_and_b32 v8, 3, v0
    v_xor_b32 v7, v7, v8
    v_lshl_add_u32 v4, v7, 4, v4
    v_lshrrev_b32 v7, 4, v0
    v_lshlrev_b32 v2, 8, v7
    v_bfe_u32 v7, v0, 2, 2
    v_lshl_add_u32 v2, v7, 6, v2
    v_and_b32 v7, 3, v0
    v_lshl_add_u32 v2, v7, 3, v2
    v_add_u32 v2, s21, v2
    v_bfe_u32 v7, v0, 4, 1
    v_lshlrev_b32 v7, 5, v7
    v_sub_u32 v3, 32, v7
    v_add_u32 v3, v3, v2
    v_add_u32 v2, v2, v7
    s_mul_i32 s65, s14, 1310720
    s_lshl_b32 s66, s13, 6
    s_add_u32 s65, s65, s66
    s_add_u32 m0, s21, 0
    s_add_u32 s64, s65, 0x0
    buffer_load_dwordx4 v4, s[44:47], s64 offen lds
    s_add_u32 m0, s21, 1024
    s_add_u32 s64, s65, 0x5000
    buffer_load_dwordx4 v4, s[44:47], s64 offen lds
    s_add_u32 m0, s21, 2048
    s_add_u32 s64, s65, 0xa000
    buffer_load_dwordx4 v4, s[44:47], s64 offen lds
    s_add_u32 m0, s21, 3072
    s_add_u32 s64, s65, 0xf000
    buffer_load_dwordx4 v4, s[44:47], s64 offen lds
    s_add_u32 m0, s21, 4096
    s_add_u32 s64, s65, 0x14000
    buffer_load_dwordx4 v4, s[44:47], s64 offen lds
    s_add_u32 m0, s21, 5120
    s_add_u32 s64, s65, 0x19000
    buffer_load_dwordx4 v4, s[44:47], s64 offen lds
    s_add_u32 m0, s21, 6144
    s_add_u32 s64, s65, 0x1e000
    buffer_load_dwordx4 v4, s[44:47], s64 offen lds
    s_add_u32 m0, s21, 7168
    s_add_u32 s64, s65, 0x23000
    buffer_load_dwordx4 v4, s[44:47], s64 offen lds
    s_add_u32 m0, s21, 8192
    s_add_u32 s64, s65, 0x28000
    buffer_load_dwordx4 v4, s[44:47], s64 offen lds
    s_add_u32 m0, s21, 9216
    s_add_u32 s64, s65, 0x2d000
    buffer_load_dwordx4 v4, s[44:47], s64 offen lds
    s_add_u32 m0, s21, 10240
    s_add_u32 s64, s65, 0x32000
    buffer_load_dwordx4 v4, s[44:47], s64 offen lds
    s_add_u32 m0, s21, 11264
    s_add_u32 s64, s65, 0x37000
    buffer_load_dwordx4 v4, s[44:47], s64 offen lds
    s_add_u32 m0, s21, 12288
    s_add_u32 s64, s65, 0x3c000
    buffer_load_dwordx4 v4, s[44:47], s64 offen lds
    s_add_u32 m0, s21, 13312
    s_add_u32 s64, s65, 0x41000
    buffer_load_dwordx4 v4, s[44:47], s64 offen lds
    s_add_u32 m0, s21, 14336
    s_add_u32 s64, s65, 0x46000
    buffer_load_dwordx4 v4, s[44:47], s64 offen lds
    s_add_u32 m0, s21, 15360
    s_add_u32 s64, s65, 0x4b000
    buffer_load_dwordx4 v4, s[44:47], s64 offen lds
    s_add_u32 m0, s21, 16384
    s_add_u32 s64, s65, 0x50000
    buffer_load_dwordx4 v4, s[44:47], s64 offen lds
    s_add_u32 m0, s21, 17408
    s_add_u32 s64, s65, 0x55000
    buffer_load_dwordx4 v4, s[44:47], s64 offen lds
    s_add_u32 m0, s21, 18432
    s_add_u32 s64, s65, 0x5a000
    buffer_load_dwordx4 v4, s[44:47], s64 offen lds
    s_add_u32 m0, s21, 19456
    s_add_u32 s64, s65, 0x5f000
    buffer_load_dwordx4 v4, s[44:47], s64 offen lds
    s_add_u32 m0, s21, 20480
    s_add_u32 s64, s65, 0x64000
    buffer_load_dwordx4 v4, s[44:47], s64 offen lds
    s_add_u32 m0, s21, 21504
    s_add_u32 s64, s65, 0x69000
    buffer_load_dwordx4 v4, s[44:47], s64 offen lds
    s_add_u32 m0, s21, 22528
    s_add_u32 s64, s65, 0x6e000
    buffer_load_dwordx4 v4, s[44:47], s64 offen lds
    s_add_u32 m0, s21, 23552
    s_add_u32 s64, s65, 0x73000
    buffer_load_dwordx4 v4, s[44:47], s64 offen lds
    s_add_u32 m0, s21, 24576
    s_add_u32 s64, s65, 0x78000
    buffer_load_dwordx4 v4, s[44:47], s64 offen lds
    s_add_u32 m0, s21, 25600
    s_add_u32 s64, s65, 0x7d000
    buffer_load_dwordx4 v4, s[44:47], s64 offen lds
    s_add_u32 m0, s21, 26624
    s_add_u32 s64, s65, 0x82000
    buffer_load_dwordx4 v4, s[44:47], s64 offen lds
    s_add_u32 m0, s21, 27648
    s_add_u32 s64, s65, 0x87000
    buffer_load_dwordx4 v4, s[44:47], s64 offen lds
    s_add_u32 m0, s21, 28672
    s_add_u32 s64, s65, 0x8c000
    buffer_load_dwordx4 v4, s[44:47], s64 offen lds
    s_add_u32 m0, s21, 29696
    s_add_u32 s64, s65, 0x91000
    buffer_load_dwordx4 v4, s[44:47], s64 offen lds
    s_add_u32 m0, s21, 30720
    s_add_u32 s64, s65, 0x96000
    buffer_load_dwordx4 v4, s[44:47], s64 offen lds
    s_add_u32 m0, s21, 31744
    s_add_u32 s64, s65, 0x9b000
    buffer_load_dwordx4 v4, s[44:47], s64 offen lds
    s_add_u32 m0, s21, 32768
    s_add_u32 s64, s65, 0xa0000
    buffer_load_dwordx4 v4, s[44:47], s64 offen lds
    s_add_u32 m0, s21, 33792
    s_add_u32 s64, s65, 0xa5000
    buffer_load_dwordx4 v4, s[44:47], s64 offen lds
    s_add_u32 m0, s21, 34816
    s_add_u32 s64, s65, 0xaa000
    buffer_load_dwordx4 v4, s[44:47], s64 offen lds
    s_add_u32 m0, s21, 35840
    s_add_u32 s64, s65, 0xaf000
    buffer_load_dwordx4 v4, s[44:47], s64 offen lds
    s_waitcnt vmcnt(32)
    ds_read_b64_tr_b16 a[0:1], v2 offset:0
    ds_read_b64_tr_b16 a[2:3], v2 offset:1024
    ds_read_b64_tr_b16 a[4:5], v3 offset:0
    ds_read_b64_tr_b16 a[6:7], v3 offset:1024
    ds_read_b64_tr_b16 a[8:9], v2 offset:2048
    ds_read_b64_tr_b16 a[10:11], v2 offset:3072
    ds_read_b64_tr_b16 a[12:13], v3 offset:2048
    ds_read_b64_tr_b16 a[14:15], v3 offset:3072
    s_waitcnt lgkmcnt(0)
    s_add_u32 m0, s21, 0
    s_add_u32 s64, s65, 0xb4000
    buffer_load_dwordx4 v4, s[44:47], s64 offen lds
    s_add_u32 m0, s21, 1024
    s_add_u32 s64, s65, 0xb9000
    buffer_load_dwordx4 v4, s[44:47], s64 offen lds
    s_add_u32 m0, s21, 2048
    s_add_u32 s64, s65, 0xbe000
    buffer_load_dwordx4 v4, s[44:47], s64 offen lds
    s_add_u32 m0, s21, 3072
    s_add_u32 s64, s65, 0xc3000
    buffer_load_dwordx4 v4, s[44:47], s64 offen lds
    s_waitcnt vmcnt(32)
    ds_read_b64_tr_b16 a[16:17], v2 offset:4096
    ds_read_b64_tr_b16 a[18:19], v2 offset:5120
    ds_read_b64_tr_b16 a[20:21], v3 offset:4096
    ds_read_b64_tr_b16 a[22:23], v3 offset:5120
    ds_read_b64_tr_b16 a[24:25], v2 offset:6144
    ds_read_b64_tr_b16 a[26:27], v2 offset:7168
    ds_read_b64_tr_b16 a[28:29], v3 offset:6144
    ds_read_b64_tr_b16 a[30:31], v3 offset:7168
    s_waitcnt lgkmcnt(0)
    s_add_u32 m0, s21, 4096
    s_add_u32 s64, s65, 0xc8000
    buffer_load_dwordx4 v4, s[44:47], s64 offen lds
    s_add_u32 m0, s21, 5120
    s_add_u32 s64, s65, 0xcd000
    buffer_load_dwordx4 v4, s[44:47], s64 offen lds
    s_add_u32 m0, s21, 6144
    s_add_u32 s64, s65, 0xd2000
    buffer_load_dwordx4 v4, s[44:47], s64 offen lds
    s_add_u32 m0, s21, 7168
    s_add_u32 s64, s65, 0xd7000
    buffer_load_dwordx4 v4, s[44:47], s64 offen lds
    s_waitcnt vmcnt(32)
    ds_read_b64_tr_b16 a[32:33], v2 offset:8192
    ds_read_b64_tr_b16 a[34:35], v2 offset:9216
    ds_read_b64_tr_b16 a[36:37], v3 offset:8192
    ds_read_b64_tr_b16 a[38:39], v3 offset:9216
    ds_read_b64_tr_b16 a[40:41], v2 offset:10240
    ds_read_b64_tr_b16 a[42:43], v2 offset:11264
    ds_read_b64_tr_b16 a[44:45], v3 offset:10240
    ds_read_b64_tr_b16 a[46:47], v3 offset:11264
    s_waitcnt lgkmcnt(0)
    s_add_u32 m0, s21, 8192
    s_add_u32 s64, s65, 0xdc000
    buffer_load_dwordx4 v4, s[44:47], s64 offen lds
    s_add_u32 m0, s21, 9216
    s_add_u32 s64, s65, 0xe1000
    buffer_load_dwordx4 v4, s[44:47], s64 offen lds
    s_add_u32 m0, s21, 10240
    s_add_u32 s64, s65, 0xe6000
    buffer_load_dwordx4 v4, s[44:47], s64 offen lds
    s_add_u32 m0, s21, 11264
    s_add_u32 s64, s65, 0xeb000
    buffer_load_dwordx4 v4, s[44:47], s64 offen lds
    s_waitcnt vmcnt(32)
    ds_read_b64_tr_b16 a[48:49], v2 offset:12288
    ds_read_b64_tr_b16 a[50:51], v2 offset:13312
    ds_read_b64_tr_b16 a[52:53], v3 offset:12288
    ds_read_b64_tr_b16 a[54:55], v3 offset:13312
    ds_read_b64_tr_b16 a[56:57], v2 offset:14336
    ds_read_b64_tr_b16 a[58:59], v2 offset:15360
    ds_read_b64_tr_b16 a[60:61], v3 offset:14336
    ds_read_b64_tr_b16 a[62:63], v3 offset:15360
    s_waitcnt lgkmcnt(0)
    s_add_u32 m0, s21, 12288
    s_add_u32 s64, s65, 0xf0000
    buffer_load_dwordx4 v4, s[44:47], s64 offen lds
    s_add_u32 m0, s21, 13312
    s_add_u32 s64, s65, 0xf5000
    buffer_load_dwordx4 v4, s[44:47], s64 offen lds
    s_add_u32 m0, s21, 14336
    s_add_u32 s64, s65, 0xfa000
    buffer_load_dwordx4 v4, s[44:47], s64 offen lds
    s_add_u32 m0, s21, 15360
    s_add_u32 s64, s65, 0xff000
    buffer_load_dwordx4 v4, s[44:47], s64 offen lds
    s_waitcnt vmcnt(32)
    ds_read_b64_tr_b16 a[64:65], v2 offset:16384
    ds_read_b64_tr_b16 a[66:67], v2 offset:17408
    ds_read_b64_tr_b16 a[68:69], v3 offset:16384
    ds_read_b64_tr_b16 a[70:71], v3 offset:17408
    ds_read_b64_tr_b16 a[72:73], v2 offset:18432
    ds_read_b64_tr_b16 a[74:75], v2 offset:19456
    ds_read_b64_tr_b16 a[76:77], v3 offset:18432
    ds_read_b64_tr_b16 a[78:79], v3 offset:19456
    s_waitcnt lgkmcnt(0)
    s_add_u32 m0, s21, 16384
    s_add_u32 s64, s65, 0x104000
    buffer_load_dwordx4 v4, s[44:47], s64 offen lds
    s_add_u32 m0, s21, 17408
    s_add_u32 s64, s65, 0x109000
    buffer_load_dwordx4 v4, s[44:47], s64 offen lds
    s_add_u32 m0, s21, 18432
    s_add_u32 s64, s65, 0x10e000
    buffer_load_dwordx4 v4, s[44:47], s64 offen lds
    s_add_u32 m0, s21, 19456
    s_add_u32 s64, s65, 0x113000
    buffer_load_dwordx4 v4, s[44:47], s64 offen lds
    s_waitcnt vmcnt(32)
    ds_read_b64_tr_b16 a[80:81], v2 offset:20480
    ds_read_b64_tr_b16 a[82:83], v2 offset:21504
    ds_read_b64_tr_b16 a[84:85], v3 offset:20480
    ds_read_b64_tr_b16 a[86:87], v3 offset:21504
    ds_read_b64_tr_b16 a[88:89], v2 offset:22528
    ds_read_b64_tr_b16 a[90:91], v2 offset:23552
    ds_read_b64_tr_b16 a[92:93], v3 offset:22528
    ds_read_b64_tr_b16 a[94:95], v3 offset:23552
    s_waitcnt lgkmcnt(0)
    s_add_u32 m0, s21, 20480
    s_add_u32 s64, s65, 0x118000
    buffer_load_dwordx4 v4, s[44:47], s64 offen lds
    s_add_u32 m0, s21, 21504
    s_add_u32 s64, s65, 0x11d000
    buffer_load_dwordx4 v4, s[44:47], s64 offen lds
    s_add_u32 m0, s21, 22528
    s_add_u32 s64, s65, 0x122000
    buffer_load_dwordx4 v4, s[44:47], s64 offen lds
    s_add_u32 m0, s21, 23552
    s_add_u32 s64, s65, 0x127000
    buffer_load_dwordx4 v4, s[44:47], s64 offen lds
    s_waitcnt vmcnt(32)
    ds_read_b64_tr_b16 a[96:97], v2 offset:24576
    ds_read_b64_tr_b16 a[98:99], v2 offset:25600
    ds_read_b64_tr_b16 a[100:101], v3 offset:24576
    ds_read_b64_tr_b16 a[102:103], v3 offset:25600
    ds_read_b64_tr_b16 a[104:105], v2 offset:26624
    ds_read_b64_tr_b16 a[106:107], v2 offset:27648
    ds_read_b64_tr_b16 a[108:109], v3 offset:26624
    ds_read_b64_tr_b16 a[110:111], v3 offset:27648
    s_waitcnt lgkmcnt(0)
    s_add_u32 m0, s21, 24576
    s_add_u32 s64, s65, 0x12c000
    buffer_load_dwordx4 v4, s[44:47], s64 offen lds
    s_add_u32 m0, s21, 25600
    s_add_u32 s64, s65, 0x131000
    buffer_load_dwordx4 v4, s[44:47], s64 offen lds
    s_add_u32 m0, s21, 26624
    s_add_u32 s64, s65, 0x136000
    buffer_load_dwordx4 v4, s[44:47], s64 offen lds
    s_add_u32 m0, s21, 27648
    s_add_u32 s64, s65, 0x13b000
    buffer_load_dwordx4 v4, s[44:47], s64 offen lds
    s_waitcnt vmcnt(32)
    ds_read_b64_tr_b16 a[112:113], v2 offset:28672
    ds_read_b64_tr_b16 a[114:115], v2 offset:29696
    ds_read_b64_tr_b16 a[116:117], v3 offset:28672
    ds_read_b64_tr_b16 a[118:119], v3 offset:29696
    ds_read_b64_tr_b16 a[120:121], v2 offset:30720
    ds_read_b64_tr_b16 a[122:123], v2 offset:31744
    ds_read_b64_tr_b16 a[124:125], v3 offset:30720
    ds_read_b64_tr_b16 a[126:127], v3 offset:31744
    s_waitcnt lgkmcnt(0)
    s_waitcnt vmcnt(28)
    ds_read_b64_tr_b16 a[128:129], v2 offset:32768
    ds_read_b64_tr_b16 a[130:131], v2 offset:33792
    ds_read_b64_tr_b16 a[132:133], v3 offset:32768
    ds_read_b64_tr_b16 a[134:135], v3 offset:33792
    ds_read_b64_tr_b16 a[136:137], v2 offset:34816
    ds_read_b64_tr_b16 a[138:139], v2 offset:35840
    ds_read_b64_tr_b16 a[140:141], v3 offset:34816
    ds_read_b64_tr_b16 a[142:143], v3 offset:35840
    s_waitcnt lgkmcnt(0)
    s_waitcnt vmcnt(24)
    ds_read_b64_tr_b16 a[144:145], v2 offset:0
    ds_read_b64_tr_b16 a[146:147], v2 offset:1024
    ds_read_b64_tr_b16 a[148:149], v3 offset:0
    ds_read_b64_tr_b16 a[150:151], v3 offset:1024
    ds_read_b64_tr_b16 a[152:153], v2 offset:2048
    ds_read_b64_tr_b16 a[154:155], v2 offset:3072
    ds_read_b64_tr_b16 a[156:157], v3 offset:2048
    ds_read_b64_tr_b16 a[158:159], v3 offset:3072
    s_waitcnt lgkmcnt(0)
    s_waitcnt vmcnt(20)
    ds_read_b64_tr_b16 a[160:161], v2 offset:4096
    ds_read_b64_tr_b16 a[162:163], v2 offset:5120
    ds_read_b64_tr_b16 a[164:165], v3 offset:4096
    ds_read_b64_tr_b16 a[166:167], v3 offset:5120
    ds_read_b64_tr_b16 a[168:169], v2 offset:6144
    ds_read_b64_tr_b16 a[170:171], v2 offset:7168
    ds_read_b64_tr_b16 a[172:173], v3 offset:6144
    ds_read_b64_tr_b16 a[174:175], v3 offset:7168
    s_waitcnt lgkmcnt(0)
    s_waitcnt vmcnt(16)
    ds_read_b64_tr_b16 a[176:177], v2 offset:8192
    ds_read_b64_tr_b16 a[178:179], v2 offset:9216
    ds_read_b64_tr_b16 a[180:181], v3 offset:8192
    ds_read_b64_tr_b16 a[182:183], v3 offset:9216
    ds_read_b64_tr_b16 a[184:185], v2 offset:10240
    ds_read_b64_tr_b16 a[186:187], v2 offset:11264
    ds_read_b64_tr_b16 a[188:189], v3 offset:10240
    ds_read_b64_tr_b16 a[190:191], v3 offset:11264
    s_waitcnt lgkmcnt(0)
    s_waitcnt vmcnt(12)
    ds_read_b64_tr_b16 a[192:193], v2 offset:12288
    ds_read_b64_tr_b16 a[194:195], v2 offset:13312
    ds_read_b64_tr_b16 a[196:197], v3 offset:12288
    ds_read_b64_tr_b16 a[198:199], v3 offset:13312
    ds_read_b64_tr_b16 a[200:201], v2 offset:14336
    ds_read_b64_tr_b16 a[202:203], v2 offset:15360
    ds_read_b64_tr_b16 a[204:205], v3 offset:14336
    ds_read_b64_tr_b16 a[206:207], v3 offset:15360
    s_waitcnt lgkmcnt(0)
    s_waitcnt vmcnt(8)
    ds_read_b64_tr_b16 a[208:209], v2 offset:16384
    ds_read_b64_tr_b16 a[210:211], v2 offset:17408
    ds_read_b64_tr_b16 a[212:213], v3 offset:16384
    ds_read_b64_tr_b16 a[214:215], v3 offset:17408
    ds_read_b64_tr_b16 a[216:217], v2 offset:18432
    ds_read_b64_tr_b16 a[218:219], v2 offset:19456
    ds_read_b64_tr_b16 a[220:221], v3 offset:18432
    ds_read_b64_tr_b16 a[222:223], v3 offset:19456
    s_waitcnt lgkmcnt(0)
    s_waitcnt vmcnt(4)
    ds_read_b64_tr_b16 a[224:225], v2 offset:20480
    ds_read_b64_tr_b16 a[226:227], v2 offset:21504
    ds_read_b64_tr_b16 a[228:229], v3 offset:20480
    ds_read_b64_tr_b16 a[230:231], v3 offset:21504
    ds_read_b64_tr_b16 a[232:233], v2 offset:22528
    ds_read_b64_tr_b16 a[234:235], v2 offset:23552
    ds_read_b64_tr_b16 a[236:237], v3 offset:22528
    ds_read_b64_tr_b16 a[238:239], v3 offset:23552
    s_waitcnt lgkmcnt(0)
    s_waitcnt vmcnt(0)
    ds_read_b64_tr_b16 a[240:241], v2 offset:24576
    ds_read_b64_tr_b16 a[242:243], v2 offset:25600
    ds_read_b64_tr_b16 a[244:245], v3 offset:24576
    ds_read_b64_tr_b16 a[246:247], v3 offset:25600
    ds_read_b64_tr_b16 a[248:249], v2 offset:26624
    ds_read_b64_tr_b16 a[250:251], v2 offset:27648
    ds_read_b64_tr_b16 a[252:253], v3 offset:26624
    ds_read_b64_tr_b16 a[254:255], v3 offset:27648
    s_waitcnt lgkmcnt(0)
    s_mov_b32 s13, s89
NOWO_122:
    v_mov_b32 v2, v10
    v_mov_b32 v3, v11
MKH_121:
    s_cmp_lg_u32 s24, 31
    s_mov_b64 exec, 0xf
    s_cbranch_scc1 MKL_123
    s_mov_b64 exec, -1
    v_bfe_u32 v4, v0, 3, 1
    v_mul_u32_u24 v4, 0x8000, v4
    v_sub_u32 v2, v2, v4
    s_mov_b64 exec, 3
MKL_123:
MKT_M_124:
    buffer_load_dword v5, v6, s[4:7], s28 offen sc1
    s_add_u32 s29, s29, 1
    s_waitcnt vmcnt(0)
    v_cmp_eq_u32 vcc, 0, v5
    s_cbranch_vccz MKT_MD_125
    s_cmp_gt_u32 s29, 262144
    s_cbranch_scc1 MKT_MD_125
    s_sleep 1
    s_branch MKT_M_124
MKT_MD_125:
    s_mov_b64 exec, -1
MKR_126:
    s_add_u32 s64, s25, 0x0
    buffer_load_dwordx4 v[16:19], v2, s[4:7], s64 offen sc1
    s_add_u32 s64, s25, 0x200
    buffer_load_dwordx4 v[20:23], v2, s[4:7], s64 offen sc1
    s_add_u32 s64, s25, 0x400
    buffer_load_dwordx4 v[24:27], v2, s[4:7], s64 offen sc1
    s_add_u32 s64, s25, 0x600
    buffer_load_dwordx4 v[28:31], v2, s[4:7], s64 offen sc1
    s_add_u32 s64, s25, 0x800
    buffer_load_dwordx4 v[32:35], v2, s[4:7], s64 offen sc1
    s_add_u32 s64, s25, 0xa00
    buffer_load_dwordx4 v[36:39], v2, s[4:7], s64 offen sc1
    s_add_u32 s64, s25, 0xc00
    buffer_load_dwordx4 v[40:43], v2, s[4:7], s64 offen sc1
    s_add_u32 s64, s25, 0xe00
    buffer_load_dwordx4 v[44:47], v2, s[4:7], s64 offen sc1
    s_add_u32 s64, s25, 0x1000
    buffer_load_dwordx4 v[48:51], v2, s[4:7], s64 offen sc1
    s_add_u32 s64, s25, 0x1200
    buffer_load_dwordx4 v[52:55], v2, s[4:7], s64 offen sc1
    s_add_u32 s64, s30, 0x0
    buffer_load_dwordx4 v[56:59], v2, s[4:7], s64 offen sc1
    s_add_u32 s64, s30, 0x200
    buffer_load_dwordx4 v[60:63], v2, s[4:7], s64 offen sc1
    s_add_u32 s64, s30, 0x400
    buffer_load_dwordx4 v[64:67], v2, s[4:7], s64 offen sc1
    s_add_u32 s64, s30, 0x600
    buffer_load_dwordx4 v[68:71], v2, s[4:7], s64 offen sc1
    s_add_u32 s64, s30, 0x800
    buffer_load_dwordx4 v[72:75], v2, s[4:7], s64 offen sc1
    s_add_u32 s64, s30, 0xa00
    buffer_load_dwordx4 v[76:79], v2, s[4:7], s64 offen sc1
    s_add_u32 s64, s30, 0xc00
    buffer_load_dwordx4 v[80:83], v2, s[4:7], s64 offen sc1
    s_add_u32 s64, s30, 0xe00
    buffer_load_dwordx4 v[84:87], v2, s[4:7], s64 offen sc1
    s_add_u32 s64, s30, 0x1000
    buffer_load_dwordx4 v[88:91], v2, s[4:7], s64 offen sc1
    s_add_u32 s64, s30, 0x1200
    buffer_load_dwordx4 v[92:95], v2, s[4:7], s64 offen sc1
    s_add_u32 s29, s29, 1
    s_waitcnt vmcnt(0)
    v_max3_u32 v4, v19, v23, v27
    v_max3_u32 v4, v4, v31, v35
    v_max3_u32 v4, v4, v39, v43
    v_max3_u32 v4, v4, v47, v51
    v_max3_u32 v4, v4, v55, v59
    v_max3_u32 v4, v4, v63, v67
    v_max3_u32 v4, v4, v71, v75
    v_max3_u32 v4, v4, v79, v83
    v_max3_u32 v4, v4, v87, v91
    v_max_u32 v4, v4, v95
    v_cmp_eq_u32 vcc, -1, v4
    s_cbranch_vccz MKO_127
    s_cmp_gt_u32 s29, 262144
    s_cbranch_scc0 MKR_126
MKO_127:
    v_mfma_f32_16x16x32_bf16 v[8:11], v[96:99], v[16:19], 0
    v_mfma_f32_16x16x32_bf16 v[12:15], v[100:103], v[16:19], 0
    v_mfma_f32_16x16x32_bf16 v[8:11], v[104:107], v[20:23], v[8:11]
    v_mfma_f32_16x16x32_bf16 v[12:15], v[108:111], v[20:23], v[12:15]
    v_mfma_f32_16x16x32_bf16 v[8:11], v[112:115], v[24:27], v[8:11]
    v_mfma_f32_16x16x32_bf16 v[12:15], v[116:119], v[24:27], v[12:15]
    v_mfma_f32_16x16x32_bf16 v[8:11], v[120:123], v[28:31], v[8:11]
    v_mfma_f32_16x16x32_bf16 v[12:15], v[124:127], v[28:31], v[12:15]
    v_mfma_f32_16x16x32_bf16 v[8:11], v[128:131], v[32:35], v[8:11]
    v_mfma_f32_16x16x32_bf16 v[12:15], v[132:135], v[32:35], v[12:15]
    v_mfma_f32_16x16x32_bf16 v[8:11], v[136:139], v[36:39], v[8:11]
    v_mfma_f32_16x16x32_bf16 v[12:15], v[140:143], v[36:39], v[12:15]
    v_mfma_f32_16x16x32_bf16 v[8:11], v[144:147], v[40:43], v[8:11]
    v_mfma_f32_16x16x32_bf16 v[12:15], v[148:151], v[40:43], v[12:15]
    v_mfma_f32_16x16x32_bf16 v[8:11], v[152:155], v[44:47], v[8:11]
    v_mfma_f32_16x16x32_bf16 v[12:15], v[156:159], v[44:47], v[12:15]
    v_mfma_f32_16x16x32_bf16 v[8:11], v[160:163], v[48:51], v[8:11]
    v_mfma_f32_16x16x32_bf16 v[12:15], v[164:167], v[48:51], v[12:15]
    v_mfma_f32_16x16x32_bf16 v[8:11], v[168:171], v[52:55], v[8:11]
    v_mfma_f32_16x16x32_bf16 v[12:15], v[172:175], v[52:55], v[12:15]
    v_mfma_f32_16x16x32_bf16 v[8:11], v[176:179], v[56:59], v[8:11]
    v_mfma_f32_16x16x32_bf16 v[12:15], v[180:183], v[56:59], v[12:15]
    v_mfma_f32_16x16x32_bf16 v[8:11], v[184:187], v[60:63], v[8:11]
    v_mfma_f32_16x16x32_bf16 v[12:15], v[188:191], v[60:63], v[12:15]
    v_mfma_f32_16x16x32_bf16 v[8:11], v[192:195], v[64:67], v[8:11]
    v_mfma_f32_16x16x32_bf16 v[12:15], v[196:199], v[64:67], v[12:15]
    v_mfma_f32_16x16x32_bf16 v[8:11], v[200:203], v[68:71], v[8:11]
    v_mfma_f32_16x16x32_bf16 v[12:15], v[204:207], v[68:71], v[12:15]
    v_mfma_f32_16x16x32_bf16 v[8:11], v[208:211], v[72:75], v[8:11]
    v_mfma_f32_16x16x32_bf16 v[12:15], v[212:215], v[72:75], v[12:15]
    v_mfma_f32_16x16x32_bf16 v[8:11], v[216:219], v[76:79], v[8:11]
    v_mfma_f32_16x16x32_bf16 v[12:15], v[220:223], v[76:79], v[12:15]
    v_mfma_f32_16x16x32_bf16 v[8:11], v[224:227], v[80:83], v[8:11]
    v_mfma_f32_16x16x32_bf16 v[12:15], v[228:231], v[80:83], v[12:15]
    v_mfma_f32_16x16x32_bf16 v[8:11], v[232:235], v[84:87], v[8:11]
    v_mfma_f32_16x16x32_bf16 v[12:15], v[236:239], v[84:87], v[12:15]
    v_mfma_f32_16x16x32_bf16 v[8:11], v[240:243], v[88:91], v[8:11]
    v_mfma_f32_16x16x32_bf16 v[12:15], v[244:247], v[88:91], v[12:15]
    v_mfma_f32_16x16x32_bf16 v[8:11], v[248:251], v[92:95], v[8:11]
    v_mfma_f32_16x16x32_bf16 v[12:15], v[252:255], v[92:95], v[12:15]
    s_nop 7
    v_cvt_pk_bf16_f32 v16, v8, v9
    v_cvt_pk_bf16_f32 v17, v10, v11
    v_cvt_pk_bf16_f32 v18, v12, v13
    v_cvt_pk_bf16_f32 v19, v14, v15
    buffer_store_dwordx4 v[16:19], v3, s[4:7], s26 offen sc1
    s_waitcnt vmcnt(0)
    s_barrier
    s_cmp_lg_u32 s14, 0
    s_cbranch_scc1 GF_128
    v_mov_b32 v7, 1
    v_mov_b32 v8, 0
    s_mov_b64 exec, 1
    buffer_store_dword v7, v8, s[4:7], s27 offen sc1
    s_mov_b64 exec, -1
GF_128:
    s_add_u32 s25, s25, 0x10000
    s_add_u32 s30, s30, 0x10000
    s_add_u32 s26, s26, 0x20000
    s_add_u32 s27, s27, 256
    s_add_u32 s28, s28, 512
    s_add_u32 s24, s24, 1
    s_cmp_lt_u32 s24, 32
    s_cbranch_scc1 MKT_LOOP
    s_cmp_ge_u32 s88, 60
    s_cbranch_scc1 M_EXIT
    s_branch H_EXTRA
G_N:
    s_lshl_b32 s65, s13, 8
    s_lshl_b32 s66, s14, 6
    s_add_u32 s20, s65, s66
    s_mul_i32 s21, s14, 36864
    v_lshrrev_b32 v6, 2, v0
    v_mul_u32_u24 v5, 8192, v6
    v_lshrrev_b32 v6, 5, v0
    v_lshlrev_b32 v6, 1, v6
    v_and_b32 v7, 3, v0
    v_xor_b32 v6, v6, v7
    v_lshl_add_u32 v5, v6, 4, v5
    v_lshrrev_b32 v6, 5, v0
    v_lshlrev_b32 v3, 10, v6
    v_bfe_u32 v6, v0, 2, 2
    v_lshl_add_u32 v3, v6, 6, v3
    v_and_b32 v6, 3, v0
    v_lshl_add_u32 v3, v6, 3, v3
    v_bfe_u32 v6, v0, 4, 1
    v_lshl_add_u32 v3, v6, 9, v3
    v_add_u32 v3, s21, v3
    v_lshlrev_b32 v6, 5, v6
    v_sub_u32 v4, 32, v6
    v_add_u32 v4, v4, v3
    v_add_u32 v3, v3, v6
    s_waitcnt vmcnt(0)
    ds_read_b64_tr_b16 v[96:97], v3 offset:0
    ds_read_b64_tr_b16 v[98:99], v3 offset:256
    ds_read_b64_tr_b16 v[100:101], v4 offset:0
    ds_read_b64_tr_b16 v[102:103], v4 offset:256
    ds_read_b64_tr_b16 v[104:105], v3 offset:2048
    ds_read_b64_tr_b16 v[106:107], v3 offset:2304
    ds_read_b64_tr_b16 v[108:109], v4 offset:2048
    ds_read_b64_tr_b16 v[110:111], v4 offset:2304
    s_waitcnt lgkmcnt(0)
    s_add_u32 m0, s21, 0
    s_add_u32 s64, s20, 0x480000
    buffer_load_dwordx4 v5, s[44:47], s64 offen lds
    s_add_u32 m0, s21, 1024
    s_add_u32 s64, s20, 0x4a0000
    buffer_load_dwordx4 v5, s[44:47], s64 offen lds
    s_add_u32 m0, s21, 2048
    s_add_u32 s64, s20, 0x4c0000
    buffer_load_dwordx4 v5, s[44:47], s64 offen lds
    s_add_u32 m0, s21, 3072
    s_add_u32 s64, s20, 0x4e0000
    buffer_load_dwordx4 v5, s[44:47], s64 offen lds
    ds_read_b64_tr_b16 v[112:113], v3 offset:4096
    ds_read_b64_tr_b16 v[114:115], v3 offset:4352
    ds_read_b64_tr_b16 v[116:117], v4 offset:4096
    ds_read_b64_tr_b16 v[118:119], v4 offset:4352
    ds_read_b64_tr_b16 v[120:121], v3 offset:6144
    ds_read_b64_tr_b16 v[122:123], v3 offset:6400
    ds_read_b64_tr_b16 v[124:125], v4 offset:6144
    ds_read_b64_tr_b16 v[126:127], v4 offset:6400
    s_waitcnt lgkmcnt(0)
    ds_read_b64_tr_b16 v[128:129], v3 offset:8192
    ds_read_b64_tr_b16 v[130:131], v3 offset:8448
    ds_read_b64_tr_b16 v[132:133], v4 offset:8192
    ds_read_b64_tr_b16 v[134:135], v4 offset:8448
    ds_read_b64_tr_b16 v[136:137], v3 offset:10240
    ds_read_b64_tr_b16 v[138:139], v3 offset:10496
    ds_read_b64_tr_b16 v[140:141], v4 offset:10240
    ds_read_b64_tr_b16 v[142:143], v4 offset:10496
    s_waitcnt lgkmcnt(0)
    ds_read_b64_tr_b16 v[144:145], v3 offset:12288
    ds_read_b64_tr_b16 v[146:147], v3 offset:12544
    ds_read_b64_tr_b16 v[148:149], v4 offset:12288
    ds_read_b64_tr_b16 v[150:151], v4 offset:12544
    ds_read_b64_tr_b16 v[152:153], v3 offset:14336
    ds_read_b64_tr_b16 v[154:155], v3 offset:14592
    ds_read_b64_tr_b16 v[156:157], v4 offset:14336
    ds_read_b64_tr_b16 v[158:159], v4 offset:14592
    s_waitcnt lgkmcnt(0)
    ds_read_b64_tr_b16 v[160:161], v3 offset:16384
    ds_read_b64_tr_b16 v[162:163], v3 offset:16640
    ds_read_b64_tr_b16 v[164:165], v4 offset:16384
    ds_read_b64_tr_b16 v[166:167], v4 offset:16640
    ds_read_b64_tr_b16 v[168:169], v3 offset:18432
    ds_read_b64_tr_b16 v[170:171], v3 offset:18688
    ds_read_b64_tr_b16 v[172:173], v4 offset:18432
    ds_read_b64_tr_b16 v[174:175], v4 offset:18688
    s_waitcnt lgkmcnt(0)
    ds_read_b64_tr_b16 v[176:177], v3 offset:20480
    ds_read_b64_tr_b16 v[178:179], v3 offset:20736
    ds_read_b64_tr_b16 v[180:181], v4 offset:20480
    ds_read_b64_tr_b16 v[182:183], v4 offset:20736
    ds_read_b64_tr_b16 v[184:185], v3 offset:22528
    ds_read_b64_tr_b16 v[186:187], v3 offset:22784
    ds_read_b64_tr_b16 v[188:189], v4 offset:22528
    ds_read_b64_tr_b16 v[190:191], v4 offset:22784
    s_waitcnt lgkmcnt(0)
    ds_read_b64_tr_b16 v[192:193], v3 offset:24576
    ds_read_b64_tr_b16 v[194:195], v3 offset:24832
    ds_read_b64_tr_b16 v[196:197], v4 offset:24576
    ds_read_b64_tr_b16 v[198:199], v4 offset:24832
    ds_read_b64_tr_b16 v[200:201], v3 offset:26624
    ds_read_b64_tr_b16 v[202:203], v3 offset:26880
    ds_read_b64_tr_b16 v[204:205], v4 offset:26624
    ds_read_b64_tr_b16 v[206:207], v4 offset:26880
    s_waitcnt lgkmcnt(0)
    ds_read_b64_tr_b16 v[208:209], v3 offset:28672
    ds_read_b64_tr_b16 v[210:211], v3 offset:28928
    ds_read_b64_tr_b16 v[212:213], v4 offset:28672
    ds_read_b64_tr_b16 v[214:215], v4 offset:28928
    ds_read_b64_tr_b16 v[216:217], v3 offset:30720
    ds_read_b64_tr_b16 v[218:219], v3 offset:30976
    ds_read_b64_tr_b16 v[220:221], v4 offset:30720
    ds_read_b64_tr_b16 v[222:223], v4 offset:30976
    s_waitcnt lgkmcnt(0)
    ds_read_b64_tr_b16 v[224:225], v3 offset:32768
    ds_read_b64_tr_b16 v[226:227], v3 offset:33024
    ds_read_b64_tr_b16 v[228:229], v4 offset:32768
    ds_read_b64_tr_b16 v[230:231], v4 offset:33024
    ds_read_b64_tr_b16 v[232:233], v3 offset:34816
    ds_read_b64_tr_b16 v[234:235], v3 offset:35072
    ds_read_b64_tr_b16 v[236:237], v4 offset:34816
    ds_read_b64_tr_b16 v[238:239], v4 offset:35072
    s_waitcnt lgkmcnt(0)
    s_waitcnt vmcnt(0)
    ds_read_b64_tr_b16 v[240:241], v3 offset:0
    ds_read_b64_tr_b16 v[242:243], v3 offset:256
    ds_read_b64_tr_b16 v[244:245], v4 offset:0
    ds_read_b64_tr_b16 v[246:247], v4 offset:256
    ds_read_b64_tr_b16 v[248:249], v3 offset:2048
    ds_read_b64_tr_b16 v[250:251], v3 offset:2304
    ds_read_b64_tr_b16 v[252:253], v4 offset:2048
    ds_read_b64_tr_b16 v[254:255], v4 offset:2304
    s_waitcnt lgkmcnt(0)
    s_cmp_lg_u32 s97, 0
    s_cbranch_scc1 CM_129
    v_mbcnt_lo_u32_b32 v0, -1, 0
    v_mbcnt_hi_u32_b32 v0, -1, v0
    v_mul_u32_u24 v8, 32, v0
    s_mov_b32 s64, 0x0
    s_mov_b32 s65, 0
    s_mov_b64 exec, 0xff
TK_130:
    buffer_load_dword v9, v8, s[60:63], s64 offen sc1
    s_add_u32 s65, s65, 1
    s_waitcnt vmcnt(0)
    s_mov_b32 s66, 0
    v_readlane_b32 s67, v9, 0
    s_add_u32 s66, s66, s67
    v_readlane_b32 s67, v9, 1
    s_add_u32 s66, s66, s67
    v_readlane_b32 s67, v9, 2
    s_add_u32 s66, s66, s67
    v_readlane_b32 s67, v9, 3
    s_add_u32 s66, s66, s67
    v_readlane_b32 s67, v9, 4
    s_add_u32 s66, s66, s67
    v_readlane_b32 s67, v9, 5
    s_add_u32 s66, s66, s67
    v_readlane_b32 s67, v9, 6
    s_add_u32 s66, s66, s67
    v_readlane_b32 s67, v9, 7
    s_add_u32 s66, s66, s67
    s_cmp_ge_u32 s66, 256
    s_cbranch_scc1 TKD_131
    s_cmp_gt_u32 s65, 262144
    s_cbranch_scc0 TK_130
TKD_131:
    v_cmp_ne_u32 vcc, 32, v9
    s_mov_b64 exec, -1
    s_cbranch_vccnz M_SLOW
CM_129:
    s_mov_b32 s65, 0
GI_132:
    buffer_load_dword v8, off, s[60:63], s95 sc1
    s_add_u32 s65, s65, 1
    s_waitcnt vmcnt(0)
    v_readfirstlane_b32 s64, v8
    s_cmp_ge_u32 s64, 192
    s_cbranch_scc1 GID_133
    s_cmp_gt_u32 s65, 65536
    s_cbranch_scc1 GID_133
    s_sleep 4
    s_branch GI_132
GID_133:
    v_mbcnt_lo_u32_b32 v0, -1, 0
    v_mbcnt_hi_u32_b32 v0, -1, v0
    s_waitcnt vmcnt(0)
    s_barrier
    s_cmp_lg_u32 s14, 0
    s_cbranch_scc1 INE_134
    s_cmp_lg_u32 s96, 10
    s_cbranch_scc1 ING_135
    v_mov_b32 v44, 1
    v_lshlrev_b32 v6, 7, v0
    s_mov_b32 s65, 0x29a000
    s_mov_b64 exec, 3
    buffer_store_dword v44, v6, s[4:7], s65 offen sc1
    s_mov_b64 exec, -1
    s_waitcnt vmcnt(0)
ING_135:
    v_mov_b32 v8, 1
    s_mov_b32 s65, 0x290800
    s_mov_b64 exec, 1
    buffer_atomic_add v8, off, s[4:7], s65 sc1
    s_mov_b64 exec, -1
INE_134:
    v_lshlrev_b32 v1, 4, v0
    v_lshrrev_b32 v6, 3, v0
    v_mul_u32_u24 v2, 1280, v6
    v_and_b32 v7, 7, v0
    v_xor_b32 v7, v7, v6
    v_lshl_add_u32 v2, v7, 4, v2
    v_bfe_u32 v6, v0, 3, 1
    v_lshlrev_b32 v9, 10, v6
    v_and_b32 v6, 7, v0
    v_lshl_add_u32 v9, v6, 7, v9
    v_lshrrev_b32 v7, 4, v0
    v_xor_b32 v7, v7, v6
    v_lshl_add_u32 v3, v7, 4, v9
    v_xor_b32 v7, 4, v7
    v_lshl_add_u32 v4, v7, 4, v9
    v_add_u32 v6, 0x10000, v3
    v_add_u32 v9, 0x10000, v4
    s_barrier
    s_mul_i32 s20, s12, 163840
    s_mul_i32 s64, s14, 40960
    s_add_u32 s20, s20, s64
    s_add_u32 s20, s20, 0x0
    s_lshl_b32 s21, s14, 12
    s_add_u32 m0, s21, 0
    s_add_u32 s64, s20, 0x0
    buffer_load_dwordx4 v2, s[4:7], s64 offen lds
    s_add_u32 m0, s21, 1024
    s_add_u32 s64, s20, 0x2800
    buffer_load_dwordx4 v2, s[4:7], s64 offen lds
    s_add_u32 m0, s21, 2048
    s_add_u32 s64, s20, 0x5000
    buffer_load_dwordx4 v2, s[4:7], s64 offen lds
    s_add_u32 m0, s21, 3072
    s_add_u32 s64, s20, 0x7800
    buffer_load_dwordx4 v2, s[4:7], s64 offen lds
    s_add_u32 m0, s21, 16384
    s_add_u32 s64, s20, 0x80
    buffer_load_dwordx4 v2, s[4:7], s64 offen lds
    s_add_u32 m0, s21, 17408
    s_add_u32 s64, s20, 0x2880
    buffer_load_dwordx4 v2, s[4:7], s64 offen lds
    s_add_u32 m0, s21, 18432
    s_add_u32 s64, s20, 0x5080
    buffer_load_dwordx4 v2, s[4:7], s64 offen lds
    s_add_u32 m0, s21, 19456
    s_add_u32 s64, s20, 0x7880
    buffer_load_dwordx4 v2, s[4:7], s64 offen lds
    s_add_u32 m0, s21, 32768
    s_add_u32 s64, s20, 0x100
    buffer_load_dwordx4 v2, s[4:7], s64 offen lds
    s_add_u32 m0, s21, 33792
    s_add_u32 s64, s20, 0x2900
    buffer_load_dwordx4 v2, s[4:7], s64 offen lds
    s_add_u32 m0, s21, 34816
    s_add_u32 s64, s20, 0x5100
    buffer_load_dwordx4 v2, s[4:7], s64 offen lds
    s_add_u32 m0, s21, 35840
    s_add_u32 s64, s20, 0x7900
    buffer_load_dwordx4 v2, s[4:7], s64 offen lds
    s_add_u32 m0, s21, 49152
    s_add_u32 s64, s20, 0x180
    buffer_load_dwordx4 v2, s[4:7], s64 offen lds
    s_add_u32 m0, s21, 50176
    s_add_u32 s64, s20, 0x2980
    buffer_load_dwordx4 v2, s[4:7], s64 offen lds
    s_add_u32 m0, s21, 51200
    s_add_u32 s64, s20, 0x5180
    buffer_load_dwordx4 v2, s[4:7], s64 offen lds
    s_add_u32 m0, s21, 52224
    s_add_u32 s64, s20, 0x7980
    buffer_load_dwordx4 v2, s[4:7], s64 offen lds
    s_mov_b32 s64, 0x40000000
    buffer_store_dword v7, v1, s[4:7], s64 offen
    buffer_store_dword v7, v1, s[4:7], s64 offen
    buffer_store_dword v7, v1, s[4:7], s64 offen
    buffer_store_dword v7, v1, s[4:7], s64 offen
    buffer_store_dword v7, v1, s[4:7], s64 offen
    buffer_store_dword v7, v1, s[4:7], s64 offen
    buffer_store_dword v7, v1, s[4:7], s64 offen
    buffer_store_dword v7, v1, s[4:7], s64 offen
    s_waitcnt vmcnt(20)
    s_barrier
    ds_read_b128 a[0:3], v3 offset:0
    ds_read_b128 a[4:7], v3 offset:2048
    ds_read_b128 a[8:11], v3 offset:4096
    ds_read_b128 a[12:15], v3 offset:6144
    ds_read_b128 a[16:19], v3 offset:8192
    ds_read_b128 a[20:23], v3 offset:10240
    ds_read_b128 a[24:27], v3 offset:12288
    ds_read_b128 a[28:31], v3 offset:14336
    s_mov_b32 s19, 0
    s_mov_b32 s22, s16
    s_mov_b32 s23, 0x40000000
G_N_LOOP:
    s_waitcnt lgkmcnt(4)
    v_mfma_f32_16x16x32_bf16 v[16:19], a[0:3], v[96:99], 0
    v_mfma_f32_16x16x32_bf16 v[20:23], a[0:3], v[100:103], 0
    ds_read_b128 a[32:35], v4 offset:0
    v_mfma_f32_16x16x32_bf16 v[24:27], a[4:7], v[96:99], 0
    v_mfma_f32_16x16x32_bf16 v[28:31], a[4:7], v[100:103], 0
    ds_read_b128 a[36:39], v4 offset:2048
    v_mfma_f32_16x16x32_bf16 v[32:35], a[8:11], v[96:99], 0
    v_mfma_f32_16x16x32_bf16 v[36:39], a[8:11], v[100:103], 0
    ds_read_b128 a[40:43], v4 offset:4096
    v_mfma_f32_16x16x32_bf16 v[40:43], a[12:15], v[96:99], 0
    v_mfma_f32_16x16x32_bf16 v[44:47], a[12:15], v[100:103], 0
    ds_read_b128 a[44:47], v4 offset:6144
    s_waitcnt lgkmcnt(4)
    v_mfma_f32_16x16x32_bf16 v[48:51], a[16:19], v[96:99], 0
    v_mfma_f32_16x16x32_bf16 v[52:55], a[16:19], v[100:103], 0
    ds_read_b128 a[48:51], v4 offset:8192
    v_mfma_f32_16x16x32_bf16 v[56:59], a[20:23], v[96:99], 0
    v_mfma_f32_16x16x32_bf16 v[60:63], a[20:23], v[100:103], 0
    ds_read_b128 a[52:55], v4 offset:10240
    v_mfma_f32_16x16x32_bf16 v[64:67], a[24:27], v[96:99], 0
    v_mfma_f32_16x16x32_bf16 v[68:71], a[24:27], v[100:103], 0
    ds_read_b128 a[56:59], v4 offset:12288
    v_mfma_f32_16x16x32_bf16 v[72:75], a[28:31], v[96:99], 0
    v_mfma_f32_16x16x32_bf16 v[76:79], a[28:31], v[100:103], 0
    ds_read_b128 a[60:63], v4 offset:14336
    s_waitcnt vmcnt(16)
    s_barrier
    s_waitcnt lgkmcnt(4)
    v_mfma_f32_16x16x32_bf16 v[16:19], a[32:35], v[104:107], v[16:19]
    v_mfma_f32_16x16x32_bf16 v[20:23], a[32:35], v[108:111], v[20:23]
    ds_read_b128 a[0:3], v3 offset:16384
    s_add_u32 m0, s21, 65536
    v_mfma_f32_16x16x32_bf16 v[24:27], a[36:39], v[104:107], v[24:27]
    v_mfma_f32_16x16x32_bf16 v[28:31], a[36:39], v[108:111], v[28:31]
    ds_read_b128 a[4:7], v3 offset:18432
    s_add_u32 s64, s20, 0x200
    buffer_load_dwordx4 v2, s[4:7], s64 offen lds
    v_mfma_f32_16x16x32_bf16 v[32:35], a[40:43], v[104:107], v[32:35]
    v_mfma_f32_16x16x32_bf16 v[36:39], a[40:43], v[108:111], v[36:39]
    ds_read_b128 a[8:11], v3 offset:20480
    s_add_u32 m0, s21, 66560
    v_mfma_f32_16x16x32_bf16 v[40:43], a[44:47], v[104:107], v[40:43]
    v_mfma_f32_16x16x32_bf16 v[44:47], a[44:47], v[108:111], v[44:47]
    ds_read_b128 a[12:15], v3 offset:22528
    s_add_u32 s64, s20, 0x2a00
    buffer_load_dwordx4 v2, s[4:7], s64 offen lds
    s_waitcnt lgkmcnt(4)
    v_mfma_f32_16x16x32_bf16 v[48:51], a[48:51], v[104:107], v[48:51]
    v_mfma_f32_16x16x32_bf16 v[52:55], a[48:51], v[108:111], v[52:55]
    ds_read_b128 a[16:19], v3 offset:24576
    s_add_u32 m0, s21, 67584
    v_mfma_f32_16x16x32_bf16 v[56:59], a[52:55], v[104:107], v[56:59]
    v_mfma_f32_16x16x32_bf16 v[60:63], a[52:55], v[108:111], v[60:63]
    ds_read_b128 a[20:23], v3 offset:26624
    s_add_u32 s64, s20, 0x5200
    buffer_load_dwordx4 v2, s[4:7], s64 offen lds
    v_mfma_f32_16x16x32_bf16 v[64:67], a[56:59], v[104:107], v[64:67]
    v_mfma_f32_16x16x32_bf16 v[68:71], a[56:59], v[108:111], v[68:71]
    ds_read_b128 a[24:27], v3 offset:28672
    s_add_u32 m0, s21, 68608
    v_mfma_f32_16x16x32_bf16 v[72:75], a[60:63], v[104:107], v[72:75]
    v_mfma_f32_16x16x32_bf16 v[76:79], a[60:63], v[108:111], v[76:79]
    ds_read_b128 a[28:31], v3 offset:30720
    s_add_u32 s64, s20, 0x7a00
    buffer_load_dwordx4 v2, s[4:7], s64 offen lds
    s_waitcnt lgkmcnt(4)
    v_mfma_f32_16x16x32_bf16 v[16:19], a[0:3], v[112:115], v[16:19]
    v_mfma_f32_16x16x32_bf16 v[20:23], a[0:3], v[116:119], v[20:23]
    ds_read_b128 a[32:35], v4 offset:16384
    v_mfma_f32_16x16x32_bf16 v[24:27], a[4:7], v[112:115], v[24:27]
    v_mfma_f32_16x16x32_bf16 v[28:31], a[4:7], v[116:119], v[28:31]
    ds_read_b128 a[36:39], v4 offset:18432
    v_mfma_f32_16x16x32_bf16 v[32:35], a[8:11], v[112:115], v[32:35]
    v_mfma_f32_16x16x32_bf16 v[36:39], a[8:11], v[116:119], v[36:39]
    ds_read_b128 a[40:43], v4 offset:20480
    v_mfma_f32_16x16x32_bf16 v[40:43], a[12:15], v[112:115], v[40:43]
    v_mfma_f32_16x16x32_bf16 v[44:47], a[12:15], v[116:119], v[44:47]
    ds_read_b128 a[44:47], v4 offset:22528
    s_waitcnt lgkmcnt(4)
    v_mfma_f32_16x16x32_bf16 v[48:51], a[16:19], v[112:115], v[48:51]
    v_mfma_f32_16x16x32_bf16 v[52:55], a[16:19], v[116:119], v[52:55]
    ds_read_b128 a[48:51], v4 offset:24576
    v_mfma_f32_16x16x32_bf16 v[56:59], a[20:23], v[112:115], v[56:59]
    v_mfma_f32_16x16x32_bf16 v[60:63], a[20:23], v[116:119], v[60:63]
    ds_read_b128 a[52:55], v4 offset:26624
    v_mfma_f32_16x16x32_bf16 v[64:67], a[24:27], v[112:115], v[64:67]
    v_mfma_f32_16x16x32_bf16 v[68:71], a[24:27], v[116:119], v[68:71]
    ds_read_b128 a[56:59], v4 offset:28672
    v_mfma_f32_16x16x32_bf16 v[72:75], a[28:31], v[112:115], v[72:75]
    v_mfma_f32_16x16x32_bf16 v[76:79], a[28:31], v[116:119], v[76:79]
    ds_read_b128 a[60:63], v4 offset:30720
    s_waitcnt vmcnt(16)
    s_barrier
    s_waitcnt lgkmcnt(4)
    v_mfma_f32_16x16x32_bf16 v[16:19], a[32:35], v[120:123], v[16:19]
    v_mfma_f32_16x16x32_bf16 v[20:23], a[32:35], v[124:127], v[20:23]
    ds_read_b128 a[0:3], v3 offset:32768
    s_add_u32 m0, s21, 0
    v_mfma_f32_16x16x32_bf16 v[24:27], a[36:39], v[120:123], v[24:27]
    v_mfma_f32_16x16x32_bf16 v[28:31], a[36:39], v[124:127], v[28:31]
    ds_read_b128 a[4:7], v3 offset:34816
    s_add_u32 s64, s20, 0x280
    buffer_load_dwordx4 v2, s[4:7], s64 offen lds
    v_mfma_f32_16x16x32_bf16 v[32:35], a[40:43], v[120:123], v[32:35]
    v_mfma_f32_16x16x32_bf16 v[36:39], a[40:43], v[124:127], v[36:39]
    ds_read_b128 a[8:11], v3 offset:36864
    s_add_u32 m0, s21, 1024
    v_mfma_f32_16x16x32_bf16 v[40:43], a[44:47], v[120:123], v[40:43]
    v_mfma_f32_16x16x32_bf16 v[44:47], a[44:47], v[124:127], v[44:47]
    ds_read_b128 a[12:15], v3 offset:38912
    s_add_u32 s64, s20, 0x2a80
    buffer_load_dwordx4 v2, s[4:7], s64 offen lds
    s_waitcnt lgkmcnt(4)
    v_mfma_f32_16x16x32_bf16 v[48:51], a[48:51], v[120:123], v[48:51]
    v_mfma_f32_16x16x32_bf16 v[52:55], a[48:51], v[124:127], v[52:55]
    ds_read_b128 a[16:19], v3 offset:40960
    s_add_u32 m0, s21, 2048
    v_mfma_f32_16x16x32_bf16 v[56:59], a[52:55], v[120:123], v[56:59]
    v_mfma_f32_16x16x32_bf16 v[60:63], a[52:55], v[124:127], v[60:63]
    ds_read_b128 a[20:23], v3 offset:43008
    s_add_u32 s64, s20, 0x5280
    buffer_load_dwordx4 v2, s[4:7], s64 offen lds
    v_mfma_f32_16x16x32_bf16 v[64:67], a[56:59], v[120:123], v[64:67]
    v_mfma_f32_16x16x32_bf16 v[68:71], a[56:59], v[124:127], v[68:71]
    ds_read_b128 a[24:27], v3 offset:45056
    s_add_u32 m0, s21, 3072
    v_mfma_f32_16x16x32_bf16 v[72:75], a[60:63], v[120:123], v[72:75]
    v_mfma_f32_16x16x32_bf16 v[76:79], a[60:63], v[124:127], v[76:79]
    ds_read_b128 a[28:31], v3 offset:47104
    s_add_u32 s64, s20, 0x7a80
    buffer_load_dwordx4 v2, s[4:7], s64 offen lds
    s_waitcnt lgkmcnt(4)
    v_mfma_f32_16x16x32_bf16 v[16:19], a[0:3], v[128:131], v[16:19]
    v_mfma_f32_16x16x32_bf16 v[20:23], a[0:3], v[132:135], v[20:23]
    ds_read_b128 a[32:35], v4 offset:32768
    v_mfma_f32_16x16x32_bf16 v[24:27], a[4:7], v[128:131], v[24:27]
    v_mfma_f32_16x16x32_bf16 v[28:31], a[4:7], v[132:135], v[28:31]
    ds_read_b128 a[36:39], v4 offset:34816
    v_mfma_f32_16x16x32_bf16 v[32:35], a[8:11], v[128:131], v[32:35]
    v_mfma_f32_16x16x32_bf16 v[36:39], a[8:11], v[132:135], v[36:39]
    ds_read_b128 a[40:43], v4 offset:36864
    v_mfma_f32_16x16x32_bf16 v[40:43], a[12:15], v[128:131], v[40:43]
    v_mfma_f32_16x16x32_bf16 v[44:47], a[12:15], v[132:135], v[44:47]
    ds_read_b128 a[44:47], v4 offset:38912
    s_waitcnt lgkmcnt(4)
    v_mfma_f32_16x16x32_bf16 v[48:51], a[16:19], v[128:131], v[48:51]
    v_mfma_f32_16x16x32_bf16 v[52:55], a[16:19], v[132:135], v[52:55]
    ds_read_b128 a[48:51], v4 offset:40960
    v_mfma_f32_16x16x32_bf16 v[56:59], a[20:23], v[128:131], v[56:59]
    v_mfma_f32_16x16x32_bf16 v[60:63], a[20:23], v[132:135], v[60:63]
    ds_read_b128 a[52:55], v4 offset:43008
    v_mfma_f32_16x16x32_bf16 v[64:67], a[24:27], v[128:131], v[64:67]
    v_mfma_f32_16x16x32_bf16 v[68:71], a[24:27], v[132:135], v[68:71]
    ds_read_b128 a[56:59], v4 offset:45056
    v_mfma_f32_16x16x32_bf16 v[72:75], a[28:31], v[128:131], v[72:75]
    v_mfma_f32_16x16x32_bf16 v[76:79], a[28:31], v[132:135], v[76:79]
    ds_read_b128 a[60:63], v4 offset:47104
    s_waitcnt vmcnt(16)
    s_barrier
    s_waitcnt lgkmcnt(4)
    v_mfma_f32_16x16x32_bf16 v[16:19], a[32:35], v[136:139], v[16:19]
    v_mfma_f32_16x16x32_bf16 v[20:23], a[32:35], v[140:143], v[20:23]
    ds_read_b128 a[0:3], v3 offset:49152
    s_add_u32 m0, s21, 16384
    v_mfma_f32_16x16x32_bf16 v[24:27], a[36:39], v[136:139], v[24:27]
    v_mfma_f32_16x16x32_bf16 v[28:31], a[36:39], v[140:143], v[28:31]
    ds_read_b128 a[4:7], v3 offset:51200
    s_add_u32 s64, s20, 0x300
    buffer_load_dwordx4 v2, s[4:7], s64 offen lds
    v_mfma_f32_16x16x32_bf16 v[32:35], a[40:43], v[136:139], v[32:35]
    v_mfma_f32_16x16x32_bf16 v[36:39], a[40:43], v[140:143], v[36:39]
    ds_read_b128 a[8:11], v3 offset:53248
    s_add_u32 m0, s21, 17408
    v_mfma_f32_16x16x32_bf16 v[40:43], a[44:47], v[136:139], v[40:43]
    v_mfma_f32_16x16x32_bf16 v[44:47], a[44:47], v[140:143], v[44:47]
    ds_read_b128 a[12:15], v3 offset:55296
    s_add_u32 s64, s20, 0x2b00
    buffer_load_dwordx4 v2, s[4:7], s64 offen lds
    s_waitcnt lgkmcnt(4)
    v_mfma_f32_16x16x32_bf16 v[48:51], a[48:51], v[136:139], v[48:51]
    v_mfma_f32_16x16x32_bf16 v[52:55], a[48:51], v[140:143], v[52:55]
    ds_read_b128 a[16:19], v3 offset:57344
    s_add_u32 m0, s21, 18432
    v_mfma_f32_16x16x32_bf16 v[56:59], a[52:55], v[136:139], v[56:59]
    v_mfma_f32_16x16x32_bf16 v[60:63], a[52:55], v[140:143], v[60:63]
    ds_read_b128 a[20:23], v3 offset:59392
    s_add_u32 s64, s20, 0x5300
    buffer_load_dwordx4 v2, s[4:7], s64 offen lds
    v_mfma_f32_16x16x32_bf16 v[64:67], a[56:59], v[136:139], v[64:67]
    v_mfma_f32_16x16x32_bf16 v[68:71], a[56:59], v[140:143], v[68:71]
    ds_read_b128 a[24:27], v3 offset:61440
    s_add_u32 m0, s21, 19456
    v_mfma_f32_16x16x32_bf16 v[72:75], a[60:63], v[136:139], v[72:75]
    v_mfma_f32_16x16x32_bf16 v[76:79], a[60:63], v[140:143], v[76:79]
    ds_read_b128 a[28:31], v3 offset:63488
    s_add_u32 s64, s20, 0x7b00
    buffer_load_dwordx4 v2, s[4:7], s64 offen lds
    s_waitcnt lgkmcnt(4)
    v_mfma_f32_16x16x32_bf16 v[16:19], a[0:3], v[144:147], v[16:19]
    v_mfma_f32_16x16x32_bf16 v[20:23], a[0:3], v[148:151], v[20:23]
    ds_read_b128 a[32:35], v4 offset:49152
    v_mfma_f32_16x16x32_bf16 v[24:27], a[4:7], v[144:147], v[24:27]
    v_mfma_f32_16x16x32_bf16 v[28:31], a[4:7], v[148:151], v[28:31]
    ds_read_b128 a[36:39], v4 offset:51200
    v_mfma_f32_16x16x32_bf16 v[32:35], a[8:11], v[144:147], v[32:35]
    v_mfma_f32_16x16x32_bf16 v[36:39], a[8:11], v[148:151], v[36:39]
    ds_read_b128 a[40:43], v4 offset:53248
    v_mfma_f32_16x16x32_bf16 v[40:43], a[12:15], v[144:147], v[40:43]
    v_mfma_f32_16x16x32_bf16 v[44:47], a[12:15], v[148:151], v[44:47]
    ds_read_b128 a[44:47], v4 offset:55296
    s_waitcnt lgkmcnt(4)
    v_mfma_f32_16x16x32_bf16 v[48:51], a[16:19], v[144:147], v[48:51]
    v_mfma_f32_16x16x32_bf16 v[52:55], a[16:19], v[148:151], v[52:55]
    ds_read_b128 a[48:51], v4 offset:57344
    v_mfma_f32_16x16x32_bf16 v[56:59], a[20:23], v[144:147], v[56:59]
    v_mfma_f32_16x16x32_bf16 v[60:63], a[20:23], v[148:151], v[60:63]
    ds_read_b128 a[52:55], v4 offset:59392
    v_mfma_f32_16x16x32_bf16 v[64:67], a[24:27], v[144:147], v[64:67]
    v_mfma_f32_16x16x32_bf16 v[68:71], a[24:27], v[148:151], v[68:71]
    ds_read_b128 a[56:59], v4 offset:61440
    v_mfma_f32_16x16x32_bf16 v[72:75], a[28:31], v[144:147], v[72:75]
    v_mfma_f32_16x16x32_bf16 v[76:79], a[28:31], v[148:151], v[76:79]
    ds_read_b128 a[60:63], v4 offset:63488
    s_waitcnt vmcnt(8)
    s_barrier
    s_cmp_lg_u32 s14, 0
    s_cbranch_scc1 GF_136
    v_mov_b32 v7, 1
    v_mov_b32 v8, 0
    s_mov_b64 exec, 1
    buffer_store_dword v7, v8, s[4:7], s23 offen sc1
    s_mov_b64 exec, -1
GF_136:
    s_waitcnt lgkmcnt(4)
    v_mfma_f32_16x16x32_bf16 v[16:19], a[32:35], v[152:155], v[16:19]
    v_mfma_f32_16x16x32_bf16 v[20:23], a[32:35], v[156:159], v[20:23]
    ds_read_b128 a[0:3], v6 offset:0
    s_add_u32 m0, s21, 32768
    v_mfma_f32_16x16x32_bf16 v[24:27], a[36:39], v[152:155], v[24:27]
    v_mfma_f32_16x16x32_bf16 v[28:31], a[36:39], v[156:159], v[28:31]
    ds_read_b128 a[4:7], v6 offset:2048
    s_add_u32 s64, s20, 0x380
    buffer_load_dwordx4 v2, s[4:7], s64 offen lds
    v_mfma_f32_16x16x32_bf16 v[32:35], a[40:43], v[152:155], v[32:35]
    v_mfma_f32_16x16x32_bf16 v[36:39], a[40:43], v[156:159], v[36:39]
    ds_read_b128 a[8:11], v6 offset:4096
    s_add_u32 m0, s21, 33792
    v_mfma_f32_16x16x32_bf16 v[40:43], a[44:47], v[152:155], v[40:43]
    v_mfma_f32_16x16x32_bf16 v[44:47], a[44:47], v[156:159], v[44:47]
    ds_read_b128 a[12:15], v6 offset:6144
    s_add_u32 s64, s20, 0x2b80
    buffer_load_dwordx4 v2, s[4:7], s64 offen lds
    s_waitcnt lgkmcnt(4)
    v_mfma_f32_16x16x32_bf16 v[48:51], a[48:51], v[152:155], v[48:51]
    v_mfma_f32_16x16x32_bf16 v[52:55], a[48:51], v[156:159], v[52:55]
    ds_read_b128 a[16:19], v6 offset:8192
    s_add_u32 m0, s21, 34816
    v_mfma_f32_16x16x32_bf16 v[56:59], a[52:55], v[152:155], v[56:59]
    v_mfma_f32_16x16x32_bf16 v[60:63], a[52:55], v[156:159], v[60:63]
    ds_read_b128 a[20:23], v6 offset:10240
    s_add_u32 s64, s20, 0x5380
    buffer_load_dwordx4 v2, s[4:7], s64 offen lds
    v_mfma_f32_16x16x32_bf16 v[64:67], a[56:59], v[152:155], v[64:67]
    v_mfma_f32_16x16x32_bf16 v[68:71], a[56:59], v[156:159], v[68:71]
    ds_read_b128 a[24:27], v6 offset:12288
    s_add_u32 m0, s21, 35840
    v_mfma_f32_16x16x32_bf16 v[72:75], a[60:63], v[152:155], v[72:75]
    v_mfma_f32_16x16x32_bf16 v[76:79], a[60:63], v[156:159], v[76:79]
    ds_read_b128 a[28:31], v6 offset:14336
    s_add_u32 s64, s20, 0x7b80
    buffer_load_dwordx4 v2, s[4:7], s64 offen lds
    s_waitcnt lgkmcnt(4)
    v_mfma_f32_16x16x32_bf16 v[16:19], a[0:3], v[160:163], v[16:19]
    v_mfma_f32_16x16x32_bf16 v[20:23], a[0:3], v[164:167], v[20:23]
    ds_read_b128 a[32:35], v9 offset:0
    v_mfma_f32_16x16x32_bf16 v[24:27], a[4:7], v[160:163], v[24:27]
    v_mfma_f32_16x16x32_bf16 v[28:31], a[4:7], v[164:167], v[28:31]
    ds_read_b128 a[36:39], v9 offset:2048
    v_mfma_f32_16x16x32_bf16 v[32:35], a[8:11], v[160:163], v[32:35]
    v_mfma_f32_16x16x32_bf16 v[36:39], a[8:11], v[164:167], v[36:39]
    ds_read_b128 a[40:43], v9 offset:4096
    v_mfma_f32_16x16x32_bf16 v[40:43], a[12:15], v[160:163], v[40:43]
    v_mfma_f32_16x16x32_bf16 v[44:47], a[12:15], v[164:167], v[44:47]
    ds_read_b128 a[44:47], v9 offset:6144
    s_waitcnt lgkmcnt(4)
    v_mfma_f32_16x16x32_bf16 v[48:51], a[16:19], v[160:163], v[48:51]
    v_mfma_f32_16x16x32_bf16 v[52:55], a[16:19], v[164:167], v[52:55]
    ds_read_b128 a[48:51], v9 offset:8192
    v_mfma_f32_16x16x32_bf16 v[56:59], a[20:23], v[160:163], v[56:59]
    v_mfma_f32_16x16x32_bf16 v[60:63], a[20:23], v[164:167], v[60:63]
    ds_read_b128 a[52:55], v9 offset:10240
    v_mfma_f32_16x16x32_bf16 v[64:67], a[24:27], v[160:163], v[64:67]
    v_mfma_f32_16x16x32_bf16 v[68:71], a[24:27], v[164:167], v[68:71]
    ds_read_b128 a[56:59], v9 offset:12288
    v_mfma_f32_16x16x32_bf16 v[72:75], a[28:31], v[160:163], v[72:75]
    v_mfma_f32_16x16x32_bf16 v[76:79], a[28:31], v[164:167], v[76:79]
    ds_read_b128 a[60:63], v9 offset:14336
    s_waitcnt vmcnt(8)
    s_barrier
    s_waitcnt lgkmcnt(4)
    v_mfma_f32_16x16x32_bf16 v[16:19], a[32:35], v[168:171], v[16:19]
    v_mfma_f32_16x16x32_bf16 v[20:23], a[32:35], v[172:175], v[20:23]
    ds_read_b128 a[0:3], v3 offset:0
    s_add_u32 m0, s21, 49152
    v_mfma_f32_16x16x32_bf16 v[24:27], a[36:39], v[168:171], v[24:27]
    v_mfma_f32_16x16x32_bf16 v[28:31], a[36:39], v[172:175], v[28:31]
    ds_read_b128 a[4:7], v3 offset:2048
    s_add_u32 s64, s20, 0x400
    buffer_load_dwordx4 v2, s[4:7], s64 offen lds
    v_mfma_f32_16x16x32_bf16 v[32:35], a[40:43], v[168:171], v[32:35]
    v_mfma_f32_16x16x32_bf16 v[36:39], a[40:43], v[172:175], v[36:39]
    ds_read_b128 a[8:11], v3 offset:4096
    s_add_u32 m0, s21, 50176
    v_mfma_f32_16x16x32_bf16 v[40:43], a[44:47], v[168:171], v[40:43]
    v_mfma_f32_16x16x32_bf16 v[44:47], a[44:47], v[172:175], v[44:47]
    ds_read_b128 a[12:15], v3 offset:6144
    s_add_u32 s64, s20, 0x2c00
    buffer_load_dwordx4 v2, s[4:7], s64 offen lds
    s_waitcnt lgkmcnt(4)
    v_mfma_f32_16x16x32_bf16 v[48:51], a[48:51], v[168:171], v[48:51]
    v_mfma_f32_16x16x32_bf16 v[52:55], a[48:51], v[172:175], v[52:55]
    ds_read_b128 a[16:19], v3 offset:8192
    s_add_u32 m0, s21, 51200
    v_mfma_f32_16x16x32_bf16 v[56:59], a[52:55], v[168:171], v[56:59]
    v_mfma_f32_16x16x32_bf16 v[60:63], a[52:55], v[172:175], v[60:63]
    ds_read_b128 a[20:23], v3 offset:10240
    s_add_u32 s64, s20, 0x5400
    buffer_load_dwordx4 v2, s[4:7], s64 offen lds
    v_mfma_f32_16x16x32_bf16 v[64:67], a[56:59], v[168:171], v[64:67]
    v_mfma_f32_16x16x32_bf16 v[68:71], a[56:59], v[172:175], v[68:71]
    ds_read_b128 a[24:27], v3 offset:12288
    s_add_u32 m0, s21, 52224
    v_mfma_f32_16x16x32_bf16 v[72:75], a[60:63], v[168:171], v[72:75]
    v_mfma_f32_16x16x32_bf16 v[76:79], a[60:63], v[172:175], v[76:79]
    ds_read_b128 a[28:31], v3 offset:14336
    s_add_u32 s64, s20, 0x7c00
    buffer_load_dwordx4 v2, s[4:7], s64 offen lds
    s_waitcnt lgkmcnt(4)
    v_mfma_f32_16x16x32_bf16 v[16:19], a[0:3], v[176:179], v[16:19]
    v_mfma_f32_16x16x32_bf16 v[20:23], a[0:3], v[180:183], v[20:23]
    ds_read_b128 a[32:35], v4 offset:0
    v_mfma_f32_16x16x32_bf16 v[24:27], a[4:7], v[176:179], v[24:27]
    v_mfma_f32_16x16x32_bf16 v[28:31], a[4:7], v[180:183], v[28:31]
    ds_read_b128 a[36:39], v4 offset:2048
    v_mfma_f32_16x16x32_bf16 v[32:35], a[8:11], v[176:179], v[32:35]
    v_mfma_f32_16x16x32_bf16 v[36:39], a[8:11], v[180:183], v[36:39]
    ds_read_b128 a[40:43], v4 offset:4096
    v_mfma_f32_16x16x32_bf16 v[40:43], a[12:15], v[176:179], v[40:43]
    v_mfma_f32_16x16x32_bf16 v[44:47], a[12:15], v[180:183], v[44:47]
    ds_read_b128 a[44:47], v4 offset:6144
    s_waitcnt lgkmcnt(4)
    v_mfma_f32_16x16x32_bf16 v[48:51], a[16:19], v[176:179], v[48:51]
    v_mfma_f32_16x16x32_bf16 v[52:55], a[16:19], v[180:183], v[52:55]
    ds_read_b128 a[48:51], v4 offset:8192
    v_mfma_f32_16x16x32_bf16 v[56:59], a[20:23], v[176:179], v[56:59]
    v_mfma_f32_16x16x32_bf16 v[60:63], a[20:23], v[180:183], v[60:63]
    ds_read_b128 a[52:55], v4 offset:10240
    v_mfma_f32_16x16x32_bf16 v[64:67], a[24:27], v[176:179], v[64:67]
    v_mfma_f32_16x16x32_bf16 v[68:71], a[24:27], v[180:183], v[68:71]
    ds_read_b128 a[56:59], v4 offset:12288
    v_mfma_f32_16x16x32_bf16 v[72:75], a[28:31], v[176:179], v[72:75]
    v_mfma_f32_16x16x32_bf16 v[76:79], a[28:31], v[180:183], v[76:79]
    ds_read_b128 a[60:63], v4 offset:14336
    s_waitcnt vmcnt(8)
    s_barrier
    s_waitcnt lgkmcnt(4)
    v_mfma_f32_16x16x32_bf16 v[16:19], a[32:35], v[184:187], v[16:19]
    v_mfma_f32_16x16x32_bf16 v[20:23], a[32:35], v[188:191], v[20:23]
    ds_read_b128 a[0:3], v3 offset:16384
    s_add_u32 m0, s21, 65536
    v_mfma_f32_16x16x32_bf16 v[24:27], a[36:39], v[184:187], v[24:27]
    v_mfma_f32_16x16x32_bf16 v[28:31], a[36:39], v[188:191], v[28:31]
    ds_read_b128 a[4:7], v3 offset:18432
    s_add_u32 s64, s20, 0x480
    buffer_load_dwordx4 v2, s[4:7], s64 offen lds
    v_mfma_f32_16x16x32_bf16 v[32:35], a[40:43], v[184:187], v[32:35]
    v_mfma_f32_16x16x32_bf16 v[36:39], a[40:43], v[188:191], v[36:39]
    ds_read_b128 a[8:11], v3 offset:20480
    s_add_u32 m0, s21, 66560
    v_mfma_f32_16x16x32_bf16 v[40:43], a[44:47], v[184:187], v[40:43]
    v_mfma_f32_16x16x32_bf16 v[44:47], a[44:47], v[188:191], v[44:47]
    ds_read_b128 a[12:15], v3 offset:22528
    s_add_u32 s64, s20, 0x2c80
    buffer_load_dwordx4 v2, s[4:7], s64 offen lds
    s_waitcnt lgkmcnt(4)
    v_mfma_f32_16x16x32_bf16 v[48:51], a[48:51], v[184:187], v[48:51]
    v_mfma_f32_16x16x32_bf16 v[52:55], a[48:51], v[188:191], v[52:55]
    ds_read_b128 a[16:19], v3 offset:24576
    s_add_u32 m0, s21, 67584
    v_mfma_f32_16x16x32_bf16 v[56:59], a[52:55], v[184:187], v[56:59]
    v_mfma_f32_16x16x32_bf16 v[60:63], a[52:55], v[188:191], v[60:63]
    ds_read_b128 a[20:23], v3 offset:26624
    s_add_u32 s64, s20, 0x5480
    buffer_load_dwordx4 v2, s[4:7], s64 offen lds
    v_mfma_f32_16x16x32_bf16 v[64:67], a[56:59], v[184:187], v[64:67]
    v_mfma_f32_16x16x32_bf16 v[68:71], a[56:59], v[188:191], v[68:71]
    ds_read_b128 a[24:27], v3 offset:28672
    s_add_u32 m0, s21, 68608
    v_mfma_f32_16x16x32_bf16 v[72:75], a[60:63], v[184:187], v[72:75]
    v_mfma_f32_16x16x32_bf16 v[76:79], a[60:63], v[188:191], v[76:79]
    ds_read_b128 a[28:31], v3 offset:30720
    s_add_u32 s64, s20, 0x7c80
    buffer_load_dwordx4 v2, s[4:7], s64 offen lds
    s_waitcnt lgkmcnt(4)
    v_mfma_f32_16x16x32_bf16 v[16:19], a[0:3], v[192:195], v[16:19]
    v_mfma_f32_16x16x32_bf16 v[20:23], a[0:3], v[196:199], v[20:23]
    ds_read_b128 a[32:35], v4 offset:16384
    v_mfma_f32_16x16x32_bf16 v[24:27], a[4:7], v[192:195], v[24:27]
    v_mfma_f32_16x16x32_bf16 v[28:31], a[4:7], v[196:199], v[28:31]
    ds_read_b128 a[36:39], v4 offset:18432
    v_mfma_f32_16x16x32_bf16 v[32:35], a[8:11], v[192:195], v[32:35]
    v_mfma_f32_16x16x32_bf16 v[36:39], a[8:11], v[196:199], v[36:39]
    ds_read_b128 a[40:43], v4 offset:20480
    v_mfma_f32_16x16x32_bf16 v[40:43], a[12:15], v[192:195], v[40:43]
    v_mfma_f32_16x16x32_bf16 v[44:47], a[12:15], v[196:199], v[44:47]
    ds_read_b128 a[44:47], v4 offset:22528
    s_waitcnt lgkmcnt(4)
    v_mfma_f32_16x16x32_bf16 v[48:51], a[16:19], v[192:195], v[48:51]
    v_mfma_f32_16x16x32_bf16 v[52:55], a[16:19], v[196:199], v[52:55]
    ds_read_b128 a[48:51], v4 offset:24576
    v_mfma_f32_16x16x32_bf16 v[56:59], a[20:23], v[192:195], v[56:59]
    v_mfma_f32_16x16x32_bf16 v[60:63], a[20:23], v[196:199], v[60:63]
    ds_read_b128 a[52:55], v4 offset:26624
    v_mfma_f32_16x16x32_bf16 v[64:67], a[24:27], v[192:195], v[64:67]
    v_mfma_f32_16x16x32_bf16 v[68:71], a[24:27], v[196:199], v[68:71]
    ds_read_b128 a[56:59], v4 offset:28672
    v_mfma_f32_16x16x32_bf16 v[72:75], a[28:31], v[192:195], v[72:75]
    v_mfma_f32_16x16x32_bf16 v[76:79], a[28:31], v[196:199], v[76:79]
    ds_read_b128 a[60:63], v4 offset:30720
    s_waitcnt vmcnt(8)
    s_barrier
    s_waitcnt lgkmcnt(4)
    v_mfma_f32_16x16x32_bf16 v[16:19], a[32:35], v[200:203], v[16:19]
    v_mfma_f32_16x16x32_bf16 v[20:23], a[32:35], v[204:207], v[20:23]
    ds_read_b128 a[0:3], v3 offset:32768
    s_add_u32 m0, s21, 0
    v_mfma_f32_16x16x32_bf16 v[24:27], a[36:39], v[200:203], v[24:27]
    v_mfma_f32_16x16x32_bf16 v[28:31], a[36:39], v[204:207], v[28:31]
    ds_read_b128 a[4:7], v3 offset:34816
    s_add_u32 s64, s20, 0x50000
    buffer_load_dwordx4 v2, s[4:7], s64 offen lds
    v_mfma_f32_16x16x32_bf16 v[32:35], a[40:43], v[200:203], v[32:35]
    v_mfma_f32_16x16x32_bf16 v[36:39], a[40:43], v[204:207], v[36:39]
    ds_read_b128 a[8:11], v3 offset:36864
    s_add_u32 m0, s21, 1024
    v_mfma_f32_16x16x32_bf16 v[40:43], a[44:47], v[200:203], v[40:43]
    v_mfma_f32_16x16x32_bf16 v[44:47], a[44:47], v[204:207], v[44:47]
    ds_read_b128 a[12:15], v3 offset:38912
    s_add_u32 s64, s20, 0x52800
    buffer_load_dwordx4 v2, s[4:7], s64 offen lds
    s_waitcnt lgkmcnt(4)
    v_mfma_f32_16x16x32_bf16 v[48:51], a[48:51], v[200:203], v[48:51]
    v_mfma_f32_16x16x32_bf16 v[52:55], a[48:51], v[204:207], v[52:55]
    ds_read_b128 a[16:19], v3 offset:40960
    s_add_u32 m0, s21, 2048
    v_mfma_f32_16x16x32_bf16 v[56:59], a[52:55], v[200:203], v[56:59]
    v_mfma_f32_16x16x32_bf16 v[60:63], a[52:55], v[204:207], v[60:63]
    ds_read_b128 a[20:23], v3 offset:43008
    s_add_u32 s64, s20, 0x55000
    buffer_load_dwordx4 v2, s[4:7], s64 offen lds
    v_mfma_f32_16x16x32_bf16 v[64:67], a[56:59], v[200:203], v[64:67]
    v_mfma_f32_16x16x32_bf16 v[68:71], a[56:59], v[204:207], v[68:71]
    ds_read_b128 a[24:27], v3 offset:45056
    s_add_u32 m0, s21, 3072
    v_mfma_f32_16x16x32_bf16 v[72:75], a[60:63], v[200:203], v[72:75]
    v_mfma_f32_16x16x32_bf16 v[76:79], a[60:63], v[204:207], v[76:79]
    ds_read_b128 a[28:31], v3 offset:47104
    s_add_u32 s64, s20, 0x57800
    buffer_load_dwordx4 v2, s[4:7], s64 offen lds
    s_waitcnt lgkmcnt(4)
    v_mfma_f32_16x16x32_bf16 v[16:19], a[0:3], v[208:211], v[16:19]
    v_mfma_f32_16x16x32_bf16 v[20:23], a[0:3], v[212:215], v[20:23]
    ds_read_b128 a[32:35], v4 offset:32768
    v_mfma_f32_16x16x32_bf16 v[24:27], a[4:7], v[208:211], v[24:27]
    v_mfma_f32_16x16x32_bf16 v[28:31], a[4:7], v[212:215], v[28:31]
    ds_read_b128 a[36:39], v4 offset:34816
    v_mfma_f32_16x16x32_bf16 v[32:35], a[8:11], v[208:211], v[32:35]
    v_mfma_f32_16x16x32_bf16 v[36:39], a[8:11], v[212:215], v[36:39]
    ds_read_b128 a[40:43], v4 offset:36864
    v_mfma_f32_16x16x32_bf16 v[40:43], a[12:15], v[208:211], v[40:43]
    v_mfma_f32_16x16x32_bf16 v[44:47], a[12:15], v[212:215], v[44:47]
    ds_read_b128 a[44:47], v4 offset:38912
    s_waitcnt lgkmcnt(4)
    v_mfma_f32_16x16x32_bf16 v[48:51], a[16:19], v[208:211], v[48:51]
    v_mfma_f32_16x16x32_bf16 v[52:55], a[16:19], v[212:215], v[52:55]
    ds_read_b128 a[48:51], v4 offset:40960
    v_mfma_f32_16x16x32_bf16 v[56:59], a[20:23], v[208:211], v[56:59]
    v_mfma_f32_16x16x32_bf16 v[60:63], a[20:23], v[212:215], v[60:63]
    ds_read_b128 a[52:55], v4 offset:43008
    v_mfma_f32_16x16x32_bf16 v[64:67], a[24:27], v[208:211], v[64:67]
    v_mfma_f32_16x16x32_bf16 v[68:71], a[24:27], v[212:215], v[68:71]
    ds_read_b128 a[56:59], v4 offset:45056
    v_mfma_f32_16x16x32_bf16 v[72:75], a[28:31], v[208:211], v[72:75]
    v_mfma_f32_16x16x32_bf16 v[76:79], a[28:31], v[212:215], v[76:79]
    ds_read_b128 a[60:63], v4 offset:47104
    s_waitcnt vmcnt(8)
    s_barrier
    s_waitcnt lgkmcnt(4)
    v_mfma_f32_16x16x32_bf16 v[16:19], a[32:35], v[216:219], v[16:19]
    v_mfma_f32_16x16x32_bf16 v[20:23], a[32:35], v[220:223], v[20:23]
    ds_read_b128 a[0:3], v3 offset:49152
    s_add_u32 m0, s21, 16384
    v_mfma_f32_16x16x32_bf16 v[24:27], a[36:39], v[216:219], v[24:27]
    v_mfma_f32_16x16x32_bf16 v[28:31], a[36:39], v[220:223], v[28:31]
    ds_read_b128 a[4:7], v3 offset:51200
    s_add_u32 s64, s20, 0x50080
    buffer_load_dwordx4 v2, s[4:7], s64 offen lds
    v_mfma_f32_16x16x32_bf16 v[32:35], a[40:43], v[216:219], v[32:35]
    v_mfma_f32_16x16x32_bf16 v[36:39], a[40:43], v[220:223], v[36:39]
    ds_read_b128 a[8:11], v3 offset:53248
    s_add_u32 m0, s21, 17408
    v_mfma_f32_16x16x32_bf16 v[40:43], a[44:47], v[216:219], v[40:43]
    v_mfma_f32_16x16x32_bf16 v[44:47], a[44:47], v[220:223], v[44:47]
    ds_read_b128 a[12:15], v3 offset:55296
    s_add_u32 s64, s20, 0x52880
    buffer_load_dwordx4 v2, s[4:7], s64 offen lds
    s_waitcnt lgkmcnt(4)
    v_mfma_f32_16x16x32_bf16 v[48:51], a[48:51], v[216:219], v[48:51]
    v_mfma_f32_16x16x32_bf16 v[52:55], a[48:51], v[220:223], v[52:55]
    ds_read_b128 a[16:19], v3 offset:57344
    s_add_u32 m0, s21, 18432
    v_mfma_f32_16x16x32_bf16 v[56:59], a[52:55], v[216:219], v[56:59]
    v_mfma_f32_16x16x32_bf16 v[60:63], a[52:55], v[220:223], v[60:63]
    ds_read_b128 a[20:23], v3 offset:59392
    s_add_u32 s64, s20, 0x55080
    buffer_load_dwordx4 v2, s[4:7], s64 offen lds
    v_mfma_f32_16x16x32_bf16 v[64:67], a[56:59], v[216:219], v[64:67]
    v_mfma_f32_16x16x32_bf16 v[68:71], a[56:59], v[220:223], v[68:71]
    ds_read_b128 a[24:27], v3 offset:61440
    s_add_u32 m0, s21, 19456
    v_mfma_f32_16x16x32_bf16 v[72:75], a[60:63], v[216:219], v[72:75]
    v_mfma_f32_16x16x32_bf16 v[76:79], a[60:63], v[220:223], v[76:79]
    ds_read_b128 a[28:31], v3 offset:63488
    s_add_u32 s64, s20, 0x57880
    buffer_load_dwordx4 v2, s[4:7], s64 offen lds
    s_waitcnt lgkmcnt(4)
    v_mfma_f32_16x16x32_bf16 v[16:19], a[0:3], v[224:227], v[16:19]
    v_mfma_f32_16x16x32_bf16 v[20:23], a[0:3], v[228:231], v[20:23]
    ds_read_b128 a[32:35], v4 offset:49152
    v_mfma_f32_16x16x32_bf16 v[24:27], a[4:7], v[224:227], v[24:27]
    v_mfma_f32_16x16x32_bf16 v[28:31], a[4:7], v[228:231], v[28:31]
    ds_read_b128 a[36:39], v4 offset:51200
    v_mfma_f32_16x16x32_bf16 v[32:35], a[8:11], v[224:227], v[32:35]
    v_mfma_f32_16x16x32_bf16 v[36:39], a[8:11], v[228:231], v[36:39]
    ds_read_b128 a[40:43], v4 offset:53248
    v_mfma_f32_16x16x32_bf16 v[40:43], a[12:15], v[224:227], v[40:43]
    v_mfma_f32_16x16x32_bf16 v[44:47], a[12:15], v[228:231], v[44:47]
    ds_read_b128 a[44:47], v4 offset:55296
    s_waitcnt lgkmcnt(4)
    v_mfma_f32_16x16x32_bf16 v[48:51], a[16:19], v[224:227], v[48:51]
    v_mfma_f32_16x16x32_bf16 v[52:55], a[16:19], v[228:231], v[52:55]
    ds_read_b128 a[48:51], v4 offset:57344
    v_mfma_f32_16x16x32_bf16 v[56:59], a[20:23], v[224:227], v[56:59]
    v_mfma_f32_16x16x32_bf16 v[60:63], a[20:23], v[228:231], v[60:63]
    ds_read_b128 a[52:55], v4 offset:59392
    v_mfma_f32_16x16x32_bf16 v[64:67], a[24:27], v[224:227], v[64:67]
    v_mfma_f32_16x16x32_bf16 v[68:71], a[24:27], v[228:231], v[68:71]
    ds_read_b128 a[56:59], v4 offset:61440
    v_mfma_f32_16x16x32_bf16 v[72:75], a[28:31], v[224:227], v[72:75]
    v_mfma_f32_16x16x32_bf16 v[76:79], a[28:31], v[228:231], v[76:79]
    ds_read_b128 a[60:63], v4 offset:63488
    s_waitcnt vmcnt(8)
    s_barrier
    s_waitcnt lgkmcnt(4)
    v_mfma_f32_16x16x32_bf16 v[16:19], a[32:35], v[232:235], v[16:19]
    v_mfma_f32_16x16x32_bf16 v[20:23], a[32:35], v[236:239], v[20:23]
    ds_read_b128 a[0:3], v6 offset:0
    s_add_u32 m0, s21, 32768
    v_mfma_f32_16x16x32_bf16 v[24:27], a[36:39], v[232:235], v[24:27]
    v_mfma_f32_16x16x32_bf16 v[28:31], a[36:39], v[236:239], v[28:31]
    ds_read_b128 a[4:7], v6 offset:2048
    s_add_u32 s64, s20, 0x50100
    buffer_load_dwordx4 v2, s[4:7], s64 offen lds
    v_mfma_f32_16x16x32_bf16 v[32:35], a[40:43], v[232:235], v[32:35]
    v_mfma_f32_16x16x32_bf16 v[36:39], a[40:43], v[236:239], v[36:39]
    ds_read_b128 a[8:11], v6 offset:4096
    s_add_u32 m0, s21, 33792
    v_mfma_f32_16x16x32_bf16 v[40:43], a[44:47], v[232:235], v[40:43]
    v_mfma_f32_16x16x32_bf16 v[44:47], a[44:47], v[236:239], v[44:47]
    ds_read_b128 a[12:15], v6 offset:6144
    s_add_u32 s64, s20, 0x52900
    buffer_load_dwordx4 v2, s[4:7], s64 offen lds
    s_waitcnt lgkmcnt(4)
    v_mfma_f32_16x16x32_bf16 v[48:51], a[48:51], v[232:235], v[48:51]
    v_mfma_f32_16x16x32_bf16 v[52:55], a[48:51], v[236:239], v[52:55]
    ds_read_b128 a[16:19], v6 offset:8192
    s_add_u32 m0, s21, 34816
    v_mfma_f32_16x16x32_bf16 v[56:59], a[52:55], v[232:235], v[56:59]
    v_mfma_f32_16x16x32_bf16 v[60:63], a[52:55], v[236:239], v[60:63]
    ds_read_b128 a[20:23], v6 offset:10240
    s_add_u32 s64, s20, 0x55100
    buffer_load_dwordx4 v2, s[4:7], s64 offen lds
    v_mfma_f32_16x16x32_bf16 v[64:67], a[56:59], v[232:235], v[64:67]
    v_mfma_f32_16x16x32_bf16 v[68:71], a[56:59], v[236:239], v[68:71]
    ds_read_b128 a[24:27], v6 offset:12288
    s_add_u32 m0, s21, 35840
    v_mfma_f32_16x16x32_bf16 v[72:75], a[60:63], v[232:235], v[72:75]
    v_mfma_f32_16x16x32_bf16 v[76:79], a[60:63], v[236:239], v[76:79]
    ds_read_b128 a[28:31], v6 offset:14336
    s_add_u32 s64, s20, 0x57900
    buffer_load_dwordx4 v2, s[4:7], s64 offen lds
    s_waitcnt lgkmcnt(4)
    v_mfma_f32_16x16x32_bf16 v[16:19], a[0:3], v[240:243], v[16:19]
    v_mfma_f32_16x16x32_bf16 v[20:23], a[0:3], v[244:247], v[20:23]
    ds_read_b128 a[32:35], v9 offset:0
    v_mfma_f32_16x16x32_bf16 v[24:27], a[4:7], v[240:243], v[24:27]
    v_mfma_f32_16x16x32_bf16 v[28:31], a[4:7], v[244:247], v[28:31]
    ds_read_b128 a[36:39], v9 offset:2048
    v_mfma_f32_16x16x32_bf16 v[32:35], a[8:11], v[240:243], v[32:35]
    v_mfma_f32_16x16x32_bf16 v[36:39], a[8:11], v[244:247], v[36:39]
    ds_read_b128 a[40:43], v9 offset:4096
    v_mfma_f32_16x16x32_bf16 v[40:43], a[12:15], v[240:243], v[40:43]
    v_mfma_f32_16x16x32_bf16 v[44:47], a[12:15], v[244:247], v[44:47]
    ds_read_b128 a[44:47], v9 offset:6144
    s_waitcnt lgkmcnt(4)
    v_mfma_f32_16x16x32_bf16 v[48:51], a[16:19], v[240:243], v[48:51]
    v_mfma_f32_16x16x32_bf16 v[52:55], a[16:19], v[244:247], v[52:55]
    ds_read_b128 a[48:51], v9 offset:8192
    v_mfma_f32_16x16x32_bf16 v[56:59], a[20:23], v[240:243], v[56:59]
    v_mfma_f32_16x16x32_bf16 v[60:63], a[20:23], v[244:247], v[60:63]
    ds_read_b128 a[52:55], v9 offset:10240
    v_mfma_f32_16x16x32_bf16 v[64:67], a[24:27], v[240:243], v[64:67]
    v_mfma_f32_16x16x32_bf16 v[68:71], a[24:27], v[244:247], v[68:71]
    ds_read_b128 a[56:59], v9 offset:12288
    v_mfma_f32_16x16x32_bf16 v[72:75], a[28:31], v[240:243], v[72:75]
    v_mfma_f32_16x16x32_bf16 v[76:79], a[28:31], v[244:247], v[76:79]
    ds_read_b128 a[60:63], v9 offset:14336
    s_waitcnt vmcnt(8)
    s_barrier
    s_waitcnt lgkmcnt(4)
    v_mfma_f32_16x16x32_bf16 v[16:19], a[32:35], v[248:251], v[16:19]
    v_mfma_f32_16x16x32_bf16 v[20:23], a[32:35], v[252:255], v[20:23]
    ds_read_b128 a[0:3], v3 offset:0
    s_add_u32 m0, s21, 49152
    v_mfma_f32_16x16x32_bf16 v[24:27], a[36:39], v[248:251], v[24:27]
    v_mfma_f32_16x16x32_bf16 v[28:31], a[36:39], v[252:255], v[28:31]
    ds_read_b128 a[4:7], v3 offset:2048
    s_add_u32 s64, s20, 0x50180
    buffer_load_dwordx4 v2, s[4:7], s64 offen lds
    v_mfma_f32_16x16x32_bf16 v[32:35], a[40:43], v[248:251], v[32:35]
    v_mfma_f32_16x16x32_bf16 v[36:39], a[40:43], v[252:255], v[36:39]
    ds_read_b128 a[8:11], v3 offset:4096
    s_add_u32 m0, s21, 50176
    v_mfma_f32_16x16x32_bf16 v[40:43], a[44:47], v[248:251], v[40:43]
    v_mfma_f32_16x16x32_bf16 v[44:47], a[44:47], v[252:255], v[44:47]
    ds_read_b128 a[12:15], v3 offset:6144
    s_add_u32 s64, s20, 0x52980
    buffer_load_dwordx4 v2, s[4:7], s64 offen lds
    s_waitcnt lgkmcnt(4)
    v_mfma_f32_16x16x32_bf16 v[48:51], a[48:51], v[248:251], v[48:51]
    v_mfma_f32_16x16x32_bf16 v[52:55], a[48:51], v[252:255], v[52:55]
    ds_read_b128 a[16:19], v3 offset:8192
    s_add_u32 m0, s21, 51200
    v_mfma_f32_16x16x32_bf16 v[56:59], a[52:55], v[248:251], v[56:59]
    v_mfma_f32_16x16x32_bf16 v[60:63], a[52:55], v[252:255], v[60:63]
    ds_read_b128 a[20:23], v3 offset:10240
    s_add_u32 s64, s20, 0x55180
    buffer_load_dwordx4 v2, s[4:7], s64 offen lds
    v_mfma_f32_16x16x32_bf16 v[64:67], a[56:59], v[248:251], v[64:67]
    v_mfma_f32_16x16x32_bf16 v[68:71], a[56:59], v[252:255], v[68:71]
    ds_read_b128 a[24:27], v3 offset:12288
    s_add_u32 m0, s21, 52224
    v_mfma_f32_16x16x32_bf16 v[72:75], a[60:63], v[248:251], v[72:75]
    v_mfma_f32_16x16x32_bf16 v[76:79], a[60:63], v[252:255], v[76:79]
    ds_read_b128 a[28:31], v3 offset:14336
    s_add_u32 s64, s20, 0x57980
    buffer_load_dwordx4 v2, s[4:7], s64 offen lds
    s_nop 5
    s_mul_i32 s65, s17, 0
    s_add_u32 s65, s65, s22
    s_add_u32 s64, s65, 0
    v_cvt_pk_bf16_f32 v80, v16, v17
    v_cvt_pk_bf16_f32 v81, v18, v19
    v_cvt_pk_bf16_f32 v82, v24, v25
    v_cvt_pk_bf16_f32 v83, v26, v27
    buffer_store_dwordx4 v[80:83], v1, s[4:7], s64 offen sc1
    s_add_u32 s64, s65, 1024
    v_cvt_pk_bf16_f32 v84, v20, v21
    v_cvt_pk_bf16_f32 v85, v22, v23
    v_cvt_pk_bf16_f32 v86, v28, v29
    v_cvt_pk_bf16_f32 v87, v30, v31
    buffer_store_dwordx4 v[84:87], v1, s[4:7], s64 offen sc1
    s_mul_i32 s65, s17, 1
    s_add_u32 s65, s65, s22
    s_add_u32 s64, s65, 0
    v_cvt_pk_bf16_f32 v88, v32, v33
    v_cvt_pk_bf16_f32 v89, v34, v35
    v_cvt_pk_bf16_f32 v90, v40, v41
    v_cvt_pk_bf16_f32 v91, v42, v43
    buffer_store_dwordx4 v[88:91], v1, s[4:7], s64 offen sc1
    s_add_u32 s64, s65, 1024
    v_cvt_pk_bf16_f32 v92, v36, v37
    v_cvt_pk_bf16_f32 v93, v38, v39
    v_cvt_pk_bf16_f32 v94, v44, v45
    v_cvt_pk_bf16_f32 v95, v46, v47
    buffer_store_dwordx4 v[92:95], v1, s[4:7], s64 offen sc1
    s_mul_i32 s65, s17, 2
    s_add_u32 s65, s65, s22
    s_add_u32 s64, s65, 0
    v_cvt_pk_bf16_f32 v80, v48, v49
    v_cvt_pk_bf16_f32 v81, v50, v51
    v_cvt_pk_bf16_f32 v82, v56, v57
    v_cvt_pk_bf16_f32 v83, v58, v59
    buffer_store_dwordx4 v[80:83], v1, s[4:7], s64 offen sc1
    s_add_u32 s64, s65, 1024
    v_cvt_pk_bf16_f32 v84, v52, v53
    v_cvt_pk_bf16_f32 v85, v54, v55
    v_cvt_pk_bf16_f32 v86, v60, v61
    v_cvt_pk_bf16_f32 v87, v62, v63
    buffer_store_dwordx4 v[84:87], v1, s[4:7], s64 offen sc1
    s_mul_i32 s65, s17, 3
    s_add_u32 s65, s65, s22
    s_add_u32 s64, s65, 0
    v_cvt_pk_bf16_f32 v88, v64, v65
    v_cvt_pk_bf16_f32 v89, v66, v67
    v_cvt_pk_bf16_f32 v90, v72, v73
    v_cvt_pk_bf16_f32 v91, v74, v75
    buffer_store_dwordx4 v[88:91], v1, s[4:7], s64 offen sc1
    s_add_u32 s64, s65, 1024
    v_cvt_pk_bf16_f32 v92, v68, v69
    v_cvt_pk_bf16_f32 v93, v70, v71
    v_cvt_pk_bf16_f32 v94, v76, v77
    v_cvt_pk_bf16_f32 v95, v78, v79
    buffer_store_dwordx4 v[92:95], v1, s[4:7], s64 offen sc1
    s_lshl_b32 s64, s19, 1
    s_add_u32 s64, s64, s12
    s_lshl_b32 s64, s64, 9
    s_add_u32 s23, s18, s64
    s_lshl_b32 s64, s17, 3
    s_add_u32 s22, s22, s64
    s_add_u32 s19, s19, 1
    s_add_u32 s20, s20, 0x50000
    s_cmp_lg_u32 s19, 1
    s_cbranch_scc1 GE0_137
    s_waitcnt vmcnt(0)
    s_barrier
    s_cmp_lg_u32 s14, 0
    s_cbranch_scc1 GF_138
    v_mov_b32 v7, 1
    v_mov_b32 v8, 0
    s_mov_b64 exec, 1
    buffer_store_dword v7, v8, s[4:7], s23 offen sc1
    s_mov_b64 exec, -1
GF_138:
GE0_137:
    s_cmp_lt_u32 s19, 8
    s_cbranch_scc1 G_N_LOOP
    s_waitcnt vmcnt(0) lgkmcnt(0)
    s_barrier
    s_cmp_lg_u32 s14, 0
    s_cbranch_scc1 GF_139
    v_mov_b32 v7, 1
    v_mov_b32 v8, 0
    s_mov_b64 exec, 1
    buffer_store_dword v7, v8, s[4:7], s23 offen sc1
    s_mov_b64 exec, -1
GF_139:
    s_cmp_eq_u32 s12, 1
    s_cbranch_scc1 H_OUT
    s_lshl_b32 s88, s3, 5
    s_add_u32 s88, s88, s13
    s_mov_b32 s29, 0
    v_lshlrev_b32 v1, 4, v0
    s_mov_b32 s65, 0
CW_140:
    buffer_load_dwordx2 v[8:9], off, s[60:63], 0 offset:132 sc1
    s_add_u32 s65, s65, 1
    s_waitcnt vmcnt(0)
    v_readfirstlane_b32 s66, v8
    v_readfirstlane_b32 s67, v9
    s_min_u32 s64, s66, s67
    s_cmp_lg_u32 s64, 0
    s_cbranch_scc1 CWD_141
    s_cmp_gt_u32 s65, 65536
    s_cbranch_scc1 CWD_141
    s_sleep 4
    s_branch CW_140
CWD_141:
    s_sub_u32 s66, s66, 1
    s_and_b32 s66, s66, 3
    s_sub_u32 s67, s67, 1
    s_and_b32 s67, s67, 3
    s_mov_b32 s64, s66
    s_mov_b32 s65, s67
    s_and_b32 s64, s64, 3
    s_lshl_b32 s64, s64, 13
    s_and_b32 s65, s65, 3
    s_lshl_b32 s65, s65, 13
    s_add_u32 s25, s64, 0x6000000
    s_add_u32 s30, s65, 0x6200000
    v_bfe_u32 v4, v0, 3, 1
    v_mul_u32_u24 v2, 0x8000, v4
    v_lshrrev_b32 v4, 5, v0
    v_lshl_add_u32 v2, v4, 8, v2
    v_bfe_u32 v4, v0, 4, 1
    v_lshl_add_u32 v2, v4, 7, v2
    v_and_b32 v4, 7, v0
    v_lshl_add_u32 v2, v4, 4, v2
    v_lshrrev_b32 v4, 5, v0
    v_lshlrev_b32 v3, 16, v4
    v_bfe_u32 v4, v0, 4, 1
    v_lshl_add_u32 v3, v4, 7, v3
    v_and_b32 v4, 15, v0
    v_lshl_add_u32 v3, v4, 3, v3
    s_lshl_b32 s26, s13, 11
    s_lshl_b32 s64, s14, 9
    s_add_u32 s26, s26, s64
    s_add_u32 s26, s26, 0xa40000
    s_lshl_b32 s27, s13, 3
    s_add_u32 s27, s27, 0x294004
    s_mov_b32 s28, 0x29a000
    s_mov_b32 s24, 0
    v_lshlrev_b32 v6, 7, v0
MKN_LOOP:
    s_cmp_lg_u32 s24, 10
    s_cbranch_scc1 MKH_142
    v_mov_b32 v10, v2
    v_mov_b32 v11, v3
    s_cmp_ge_u32 s88, 60
    s_cbranch_scc1 NOWO_143
    s_mov_b32 s89, s13
    s_mul_hi_u32 s65, s88, 0xccccccd
    s_mul_i32 s65, s65, 20
    s_sub_u32 s13, s88, s65
    s_load_dwordx2 s[44:45], s[0:1], 40
    s_mov_b32 s46, 0x500000
    s_mov_b32 s47, 0x00020000
    s_waitcnt lgkmcnt(0)
    s_mul_i32 s21, s14, 36864
    v_lshrrev_b32 v7, 2, v0
    v_mul_u32_u24 v4, 1280, v7
    v_bfe_u32 v7, v0, 4, 1
    v_lshlrev_b32 v7, 1, v7
    v_and_b32 v8, 3, v0
    v_xor_b32 v7, v7, v8
    v_lshl_add_u32 v4, v7, 4, v4
    v_lshrrev_b32 v7, 4, v0
    v_lshlrev_b32 v2, 8, v7
    v_bfe_u32 v7, v0, 2, 2
    v_lshl_add_u32 v2, v7, 6, v2
    v_and_b32 v7, 3, v0
    v_lshl_add_u32 v2, v7, 3, v2
    v_add_u32 v2, s21, v2
    v_bfe_u32 v7, v0, 4, 1
    v_lshlrev_b32 v7, 5, v7
    v_sub_u32 v3, 32, v7
    v_add_u32 v3, v3, v2
    v_add_u32 v2, v2, v7
    s_mul_i32 s65, s14, 1310720
    s_lshl_b32 s66, s13, 6
    s_add_u32 s65, s65, s66
    s_add_u32 m0, s21, 0
    s_add_u32 s64, s65, 0x0
    buffer_load_dwordx4 v4, s[44:47], s64 offen lds
    s_add_u32 m0, s21, 1024
    s_add_u32 s64, s65, 0x5000
    buffer_load_dwordx4 v4, s[44:47], s64 offen lds
    s_add_u32 m0, s21, 2048
    s_add_u32 s64, s65, 0xa000
    buffer_load_dwordx4 v4, s[44:47], s64 offen lds
    s_add_u32 m0, s21, 3072
    s_add_u32 s64, s65, 0xf000
    buffer_load_dwordx4 v4, s[44:47], s64 offen lds
    s_add_u32 m0, s21, 4096
    s_add_u32 s64, s65, 0x14000
    buffer_load_dwordx4 v4, s[44:47], s64 offen lds
    s_add_u32 m0, s21, 5120
    s_add_u32 s64, s65, 0x19000
    buffer_load_dwordx4 v4, s[44:47], s64 offen lds
    s_add_u32 m0, s21, 6144
    s_add_u32 s64, s65, 0x1e000
    buffer_load_dwordx4 v4, s[44:47], s64 offen lds
    s_add_u32 m0, s21, 7168
    s_add_u32 s64, s65, 0x23000
    buffer_load_dwordx4 v4, s[44:47], s64 offen lds
    s_add_u32 m0, s21, 8192
    s_add_u32 s64, s65, 0x28000
    buffer_load_dwordx4 v4, s[44:47], s64 offen lds
    s_add_u32 m0, s21, 9216
    s_add_u32 s64, s65, 0x2d000
    buffer_load_dwordx4 v4, s[44:47], s64 offen lds
    s_add_u32 m0, s21, 10240
    s_add_u32 s64, s65, 0x32000
    buffer_load_dwordx4 v4, s[44:47], s64 offen lds
    s_add_u32 m0, s21, 11264
    s_add_u32 s64, s65, 0x37000
    buffer_load_dwordx4 v4, s[44:47], s64 offen lds
    s_add_u32 m0, s21, 12288
    s_add_u32 s64, s65, 0x3c000
    buffer_load_dwordx4 v4, s[44:47], s64 offen lds
    s_add_u32 m0, s21, 13312
    s_add_u32 s64, s65, 0x41000
    buffer_load_dwordx4 v4, s[44:47], s64 offen lds
    s_add_u32 m0, s21, 14336
    s_add_u32 s64, s65, 0x46000
    buffer_load_dwordx4 v4, s[44:47], s64 offen lds
    s_add_u32 m0, s21, 15360
    s_add_u32 s64, s65, 0x4b000
    buffer_load_dwordx4 v4, s[44:47], s64 offen lds
    s_add_u32 m0, s21, 16384
    s_add_u32 s64, s65, 0x50000
    buffer_load_dwordx4 v4, s[44:47], s64 offen lds
    s_add_u32 m0, s21, 17408
    s_add_u32 s64, s65, 0x55000
    buffer_load_dwordx4 v4, s[44:47], s64 offen lds
    s_add_u32 m0, s21, 18432
    s_add_u32 s64, s65, 0x5a000
    buffer_load_dwordx4 v4, s[44:47], s64 offen lds
    s_add_u32 m0, s21, 19456
    s_add_u32 s64, s65, 0x5f000
    buffer_load_dwordx4 v4, s[44:47], s64 offen lds
    s_add_u32 m0, s21, 20480
    s_add_u32 s64, s65, 0x64000
    buffer_load_dwordx4 v4, s[44:47], s64 offen lds
    s_add_u32 m0, s21, 21504
    s_add_u32 s64, s65, 0x69000
    buffer_load_dwordx4 v4, s[44:47], s64 offen lds
    s_add_u32 m0, s21, 22528
    s_add_u32 s64, s65, 0x6e000
    buffer_load_dwordx4 v4, s[44:47], s64 offen lds
    s_add_u32 m0, s21, 23552
    s_add_u32 s64, s65, 0x73000
    buffer_load_dwordx4 v4, s[44:47], s64 offen lds
    s_add_u32 m0, s21, 24576
    s_add_u32 s64, s65, 0x78000
    buffer_load_dwordx4 v4, s[44:47], s64 offen lds
    s_add_u32 m0, s21, 25600
    s_add_u32 s64, s65, 0x7d000
    buffer_load_dwordx4 v4, s[44:47], s64 offen lds
    s_add_u32 m0, s21, 26624
    s_add_u32 s64, s65, 0x82000
    buffer_load_dwordx4 v4, s[44:47], s64 offen lds
    s_add_u32 m0, s21, 27648
    s_add_u32 s64, s65, 0x87000
    buffer_load_dwordx4 v4, s[44:47], s64 offen lds
    s_add_u32 m0, s21, 28672
    s_add_u32 s64, s65, 0x8c000
    buffer_load_dwordx4 v4, s[44:47], s64 offen lds
    s_add_u32 m0, s21, 29696
    s_add_u32 s64, s65, 0x91000
    buffer_load_dwordx4 v4, s[44:47], s64 offen lds
    s_add_u32 m0, s21, 30720
    s_add_u32 s64, s65, 0x96000
    buffer_load_dwordx4 v4, s[44:47], s64 offen lds
    s_add_u32 m0, s21, 31744
    s_add_u32 s64, s65, 0x9b000
    buffer_load_dwordx4 v4, s[44:47], s64 offen lds
    s_add_u32 m0, s21, 32768
    s_add_u32 s64, s65, 0xa0000
    buffer_load_dwordx4 v4, s[44:47], s64 offen lds
    s_add_u32 m0, s21, 33792
    s_add_u32 s64, s65, 0xa5000
    buffer_load_dwordx4 v4, s[44:47], s64 offen lds
    s_add_u32 m0, s21, 34816
    s_add_u32 s64, s65, 0xaa000
    buffer_load_dwordx4 v4, s[44:47], s64 offen lds
    s_add_u32 m0, s21, 35840
    s_add_u32 s64, s65, 0xaf000
    buffer_load_dwordx4 v4, s[44:47], s64 offen lds
    s_waitcnt vmcnt(32)
    ds_read_b64_tr_b16 a[0:1], v2 offset:0
    ds_read_b64_tr_b16 a[2:3], v2 offset:1024
    ds_read_b64_tr_b16 a[4:5], v3 offset:0
    ds_read_b64_tr_b16 a[6:7], v3 offset:1024
    ds_read_b64_tr_b16 a[8:9], v2 offset:2048
    ds_read_b64_tr_b16 a[10:11], v2 offset:3072
    ds_read_b64_tr_b16 a[12:13], v3 offset:2048
    ds_read_b64_tr_b16 a[14:15], v3 offset:3072
    s_waitcnt lgkmcnt(0)
    s_add_u32 m0, s21, 0
    s_add_u32 s64, s65, 0xb4000
    buffer_load_dwordx4 v4, s[44:47], s64 offen lds
    s_add_u32 m0, s21, 1024
    s_add_u32 s64, s65, 0xb9000
    buffer_load_dwordx4 v4, s[44:47], s64 offen lds
    s_add_u32 m0, s21, 2048
    s_add_u32 s64, s65, 0xbe000
    buffer_load_dwordx4 v4, s[44:47], s64 offen lds
    s_add_u32 m0, s21, 3072
    s_add_u32 s64, s65, 0xc3000
    buffer_load_dwordx4 v4, s[44:47], s64 offen lds
    s_waitcnt vmcnt(32)
    ds_read_b64_tr_b16 a[16:17], v2 offset:4096
    ds_read_b64_tr_b16 a[18:19], v2 offset:5120
    ds_read_b64_tr_b16 a[20:21], v3 offset:4096
    ds_read_b64_tr_b16 a[22:23], v3 offset:5120
    ds_read_b64_tr_b16 a[24:25], v2 offset:6144
    ds_read_b64_tr_b16 a[26:27], v2 offset:7168
    ds_read_b64_tr_b16 a[28:29], v3 offset:6144
    ds_read_b64_tr_b16 a[30:31], v3 offset:7168
    s_waitcnt lgkmcnt(0)
    s_add_u32 m0, s21, 4096
    s_add_u32 s64, s65, 0xc8000
    buffer_load_dwordx4 v4, s[44:47], s64 offen lds
    s_add_u32 m0, s21, 5120
    s_add_u32 s64, s65, 0xcd000
    buffer_load_dwordx4 v4, s[44:47], s64 offen lds
    s_add_u32 m0, s21, 6144
    s_add_u32 s64, s65, 0xd2000
    buffer_load_dwordx4 v4, s[44:47], s64 offen lds
    s_add_u32 m0, s21, 7168
    s_add_u32 s64, s65, 0xd7000
    buffer_load_dwordx4 v4, s[44:47], s64 offen lds
    s_waitcnt vmcnt(32)
    ds_read_b64_tr_b16 a[32:33], v2 offset:8192
    ds_read_b64_tr_b16 a[34:35], v2 offset:9216
    ds_read_b64_tr_b16 a[36:37], v3 offset:8192
    ds_read_b64_tr_b16 a[38:39], v3 offset:9216
    ds_read_b64_tr_b16 a[40:41], v2 offset:10240
    ds_read_b64_tr_b16 a[42:43], v2 offset:11264
    ds_read_b64_tr_b16 a[44:45], v3 offset:10240
    ds_read_b64_tr_b16 a[46:47], v3 offset:11264
    s_waitcnt lgkmcnt(0)
    s_add_u32 m0, s21, 8192
    s_add_u32 s64, s65, 0xdc000
    buffer_load_dwordx4 v4, s[44:47], s64 offen lds
    s_add_u32 m0, s21, 9216
    s_add_u32 s64, s65, 0xe1000
    buffer_load_dwordx4 v4, s[44:47], s64 offen lds
    s_add_u32 m0, s21, 10240
    s_add_u32 s64, s65, 0xe6000
    buffer_load_dwordx4 v4, s[44:47], s64 offen lds
    s_add_u32 m0, s21, 11264
    s_add_u32 s64, s65, 0xeb000
    buffer_load_dwordx4 v4, s[44:47], s64 offen lds
    s_waitcnt vmcnt(32)
    ds_read_b64_tr_b16 a[48:49], v2 offset:12288
    ds_read_b64_tr_b16 a[50:51], v2 offset:13312
    ds_read_b64_tr_b16 a[52:53], v3 offset:12288
    ds_read_b64_tr_b16 a[54:55], v3 offset:13312
    ds_read_b64_tr_b16 a[56:57], v2 offset:14336
    ds_read_b64_tr_b16 a[58:59], v2 offset:15360
    ds_read_b64_tr_b16 a[60:61], v3 offset:14336
    ds_read_b64_tr_b16 a[62:63], v3 offset:15360
    s_waitcnt lgkmcnt(0)
    s_add_u32 m0, s21, 12288
    s_add_u32 s64, s65, 0xf0000
    buffer_load_dwordx4 v4, s[44:47], s64 offen lds
    s_add_u32 m0, s21, 13312
    s_add_u32 s64, s65, 0xf5000
    buffer_load_dwordx4 v4, s[44:47], s64 offen lds
    s_add_u32 m0, s21, 14336
    s_add_u32 s64, s65, 0xfa000
    buffer_load_dwordx4 v4, s[44:47], s64 offen lds
    s_add_u32 m0, s21, 15360
    s_add_u32 s64, s65, 0xff000
    buffer_load_dwordx4 v4, s[44:47], s64 offen lds
    s_waitcnt vmcnt(32)
    ds_read_b64_tr_b16 a[64:65], v2 offset:16384
    ds_read_b64_tr_b16 a[66:67], v2 offset:17408
    ds_read_b64_tr_b16 a[68:69], v3 offset:16384
    ds_read_b64_tr_b16 a[70:71], v3 offset:17408
    ds_read_b64_tr_b16 a[72:73], v2 offset:18432
    ds_read_b64_tr_b16 a[74:75], v2 offset:19456
    ds_read_b64_tr_b16 a[76:77], v3 offset:18432
    ds_read_b64_tr_b16 a[78:79], v3 offset:19456
    s_waitcnt lgkmcnt(0)
    s_add_u32 m0, s21, 16384
    s_add_u32 s64, s65, 0x104000
    buffer_load_dwordx4 v4, s[44:47], s64 offen lds
    s_add_u32 m0, s21, 17408
    s_add_u32 s64, s65, 0x109000
    buffer_load_dwordx4 v4, s[44:47], s64 offen lds
    s_add_u32 m0, s21, 18432
    s_add_u32 s64, s65, 0x10e000
    buffer_load_dwordx4 v4, s[44:47], s64 offen lds
    s_add_u32 m0, s21, 19456
    s_add_u32 s64, s65, 0x113000
    buffer_load_dwordx4 v4, s[44:47], s64 offen lds
    s_waitcnt vmcnt(32)
    ds_read_b64_tr_b16 a[80:81], v2 offset:20480
    ds_read_b64_tr_b16 a[82:83], v2 offset:21504
    ds_read_b64_tr_b16 a[84:85], v3 offset:20480
    ds_read_b64_tr_b16 a[86:87], v3 offset:21504
    ds_read_b64_tr_b16 a[88:89], v2 offset:22528
    ds_read_b64_tr_b16 a[90:91], v2 offset:23552
    ds_read_b64_tr_b16 a[92:93], v3 offset:22528
    ds_read_b64_tr_b16 a[94:95], v3 offset:23552
    s_waitcnt lgkmcnt(0)
    s_add_u32 m0, s21, 20480
    s_add_u32 s64, s65, 0x118000
    buffer_load_dwordx4 v4, s[44:47], s64 offen lds
    s_add_u32 m0, s21, 21504
    s_add_u32 s64, s65, 0x11d000
    buffer_load_dwordx4 v4, s[44:47], s64 offen lds
    s_add_u32 m0, s21, 22528
    s_add_u32 s64, s65, 0x122000
    buffer_load_dwordx4 v4, s[44:47], s64 offen lds
    s_add_u32 m0, s21, 23552
    s_add_u32 s64, s65, 0x127000
    buffer_load_dwordx4 v4, s[44:47], s64 offen lds
    s_waitcnt vmcnt(32)
    ds_read_b64_tr_b16 a[96:97], v2 offset:24576
    ds_read_b64_tr_b16 a[98:99], v2 offset:25600
    ds_read_b64_tr_b16 a[100:101], v3 offset:24576
    ds_read_b64_tr_b16 a[102:103], v3 offset:25600
    ds_read_b64_tr_b16 a[104:105], v2 offset:26624
    ds_read_b64_tr_b16 a[106:107], v2 offset:27648
    ds_read_b64_tr_b16 a[108:109], v3 offset:26624
    ds_read_b64_tr_b16 a[110:111], v3 offset:27648
    s_waitcnt lgkmcnt(0)
    s_add_u32 m0, s21, 24576
    s_add_u32 s64, s65, 0x12c000
    buffer_load_dwordx4 v4, s[44:47], s64 offen lds
    s_add_u32 m0, s21, 25600
    s_add_u32 s64, s65, 0x131000
    buffer_load_dwordx4 v4, s[44:47], s64 offen lds
    s_add_u32 m0, s21, 26624
    s_add_u32 s64, s65, 0x136000
    buffer_load_dwordx4 v4, s[44:47], s64 offen lds
    s_add_u32 m0, s21, 27648
    s_add_u32 s64, s65, 0x13b000
    buffer_load_dwordx4 v4, s[44:47], s64 offen lds
    s_waitcnt vmcnt(32)
    ds_read_b64_tr_b16 a[112:113], v2 offset:28672
    ds_read_b64_tr_b16 a[114:115], v2 offset:29696
    ds_read_b64_tr_b16 a[116:117], v3 offset:28672
    ds_read_b64_tr_b16 a[118:119], v3 offset:29696
    ds_read_b64_tr_b16 a[120:121], v2 offset:30720
    ds_read_b64_tr_b16 a[122:123], v2 offset:31744
    ds_read_b64_tr_b16 a[124:125], v3 offset:30720
    ds_read_b64_tr_b16 a[126:127], v3 offset:31744
    s_waitcnt lgkmcnt(0)
    s_waitcnt vmcnt(28)
    ds_read_b64_tr_b16 a[128:129], v2 offset:32768
    ds_read_b64_tr_b16 a[130:131], v2 offset:33792
    ds_read_b64_tr_b16 a[132:133], v3 offset:32768
    ds_read_b64_tr_b16 a[134:135], v3 offset:33792
    ds_read_b64_tr_b16 a[136:137], v2 offset:34816
    ds_read_b64_tr_b16 a[138:139], v2 offset:35840
    ds_read_b64_tr_b16 a[140:141], v3 offset:34816
    ds_read_b64_tr_b16 a[142:143], v3 offset:35840
    s_waitcnt lgkmcnt(0)
    s_waitcnt vmcnt(24)
    ds_read_b64_tr_b16 a[144:145], v2 offset:0
    ds_read_b64_tr_b16 a[146:147], v2 offset:1024
    ds_read_b64_tr_b16 a[148:149], v3 offset:0
    ds_read_b64_tr_b16 a[150:151], v3 offset:1024
    ds_read_b64_tr_b16 a[152:153], v2 offset:2048
    ds_read_b64_tr_b16 a[154:155], v2 offset:3072
    ds_read_b64_tr_b16 a[156:157], v3 offset:2048
    ds_read_b64_tr_b16 a[158:159], v3 offset:3072
    s_waitcnt lgkmcnt(0)
    s_waitcnt vmcnt(20)
    ds_read_b64_tr_b16 a[160:161], v2 offset:4096
    ds_read_b64_tr_b16 a[162:163], v2 offset:5120
    ds_read_b64_tr_b16 a[164:165], v3 offset:4096
    ds_read_b64_tr_b16 a[166:167], v3 offset:5120
    ds_read_b64_tr_b16 a[168:169], v2 offset:6144
    ds_read_b64_tr_b16 a[170:171], v2 offset:7168
    ds_read_b64_tr_b16 a[172:173], v3 offset:6144
    ds_read_b64_tr_b16 a[174:175], v3 offset:7168
    s_waitcnt lgkmcnt(0)
    s_waitcnt vmcnt(16)
    ds_read_b64_tr_b16 a[176:177], v2 offset:8192
    ds_read_b64_tr_b16 a[178:179], v2 offset:9216
    ds_read_b64_tr_b16 a[180:181], v3 offset:8192
    ds_read_b64_tr_b16 a[182:183], v3 offset:9216
    ds_read_b64_tr_b16 a[184:185], v2 offset:10240
    ds_read_b64_tr_b16 a[186:187], v2 offset:11264
    ds_read_b64_tr_b16 a[188:189], v3 offset:10240
    ds_read_b64_tr_b16 a[190:191], v3 offset:11264
    s_waitcnt lgkmcnt(0)
    s_waitcnt vmcnt(12)
    ds_read_b64_tr_b16 a[192:193], v2 offset:12288
    ds_read_b64_tr_b16 a[194:195], v2 offset:13312
    ds_read_b64_tr_b16 a[196:197], v3 offset:12288
    ds_read_b64_tr_b16 a[198:199], v3 offset:13312
    ds_read_b64_tr_b16 a[200:201], v2 offset:14336
    ds_read_b64_tr_b16 a[202:203], v2 offset:15360
    ds_read_b64_tr_b16 a[204:205], v3 offset:14336
    ds_read_b64_tr_b16 a[206:207], v3 offset:15360
    s_waitcnt lgkmcnt(0)
    s_waitcnt vmcnt(8)
    ds_read_b64_tr_b16 a[208:209], v2 offset:16384
    ds_read_b64_tr_b16 a[210:211], v2 offset:17408
    ds_read_b64_tr_b16 a[212:213], v3 offset:16384
    ds_read_b64_tr_b16 a[214:215], v3 offset:17408
    ds_read_b64_tr_b16 a[216:217], v2 offset:18432
    ds_read_b64_tr_b16 a[218:219], v2 offset:19456
    ds_read_b64_tr_b16 a[220:221], v3 offset:18432
    ds_read_b64_tr_b16 a[222:223], v3 offset:19456
    s_waitcnt lgkmcnt(0)
    s_waitcnt vmcnt(4)
    ds_read_b64_tr_b16 a[224:225], v2 offset:20480
    ds_read_b64_tr_b16 a[226:227], v2 offset:21504
    ds_read_b64_tr_b16 a[228:229], v3 offset:20480
    ds_read_b64_tr_b16 a[230:231], v3 offset:21504
    ds_read_b64_tr_b16 a[232:233], v2 offset:22528
    ds_read_b64_tr_b16 a[234:235], v2 offset:23552
    ds_read_b64_tr_b16 a[236:237], v3 offset:22528
    ds_read_b64_tr_b16 a[238:239], v3 offset:23552
    s_waitcnt lgkmcnt(0)
    s_waitcnt vmcnt(0)
    ds_read_b64_tr_b16 a[240:241], v2 offset:24576
    ds_read_b64_tr_b16 a[242:243], v2 offset:25600
    ds_read_b64_tr_b16 a[244:245], v3 offset:24576
    ds_read_b64_tr_b16 a[246:247], v3 offset:25600
    ds_read_b64_tr_b16 a[248:249], v2 offset:26624
    ds_read_b64_tr_b16 a[250:251], v2 offset:27648
    ds_read_b64_tr_b16 a[252:253], v3 offset:26624
    ds_read_b64_tr_b16 a[254:255], v3 offset:27648
    s_waitcnt lgkmcnt(0)
    s_mov_b32 s13, s89
NOWO_143:
    v_mov_b32 v2, v10
    v_mov_b32 v3, v11
MKH_142:
    s_cmp_lg_u32 s24, 31
    s_mov_b64 exec, 0xf
    s_cbranch_scc1 MKL_144
    s_mov_b64 exec, -1
    v_bfe_u32 v4, v0, 3, 1
    v_mul_u32_u24 v4, 0x8000, v4
    v_sub_u32 v2, v2, v4
    s_mov_b64 exec, 3
MKL_144:
MKN_M_145:
    buffer_load_dword v5, v6, s[4:7], s28 offen sc1
    s_add_u32 s29, s29, 1
    s_waitcnt vmcnt(0)
    v_cmp_eq_u32 vcc, 0, v5
    s_cbranch_vccz MKN_MD_146
    s_cmp_gt_u32 s29, 262144
    s_cbranch_scc1 MKN_MD_146
    s_sleep 1
    s_branch MKN_M_145
MKN_MD_146:
    s_mov_b64 exec, -1
MKR_147:
    s_add_u32 s64, s25, 0x0
    buffer_load_dwordx4 v[16:19], v2, s[4:7], s64 offen sc1
    s_add_u32 s64, s25, 0x200
    buffer_load_dwordx4 v[20:23], v2, s[4:7], s64 offen sc1
    s_add_u32 s64, s25, 0x400
    buffer_load_dwordx4 v[24:27], v2, s[4:7], s64 offen sc1
    s_add_u32 s64, s25, 0x600
    buffer_load_dwordx4 v[28:31], v2, s[4:7], s64 offen sc1
    s_add_u32 s64, s25, 0x800
    buffer_load_dwordx4 v[32:35], v2, s[4:7], s64 offen sc1
    s_add_u32 s64, s25, 0xa00
    buffer_load_dwordx4 v[36:39], v2, s[4:7], s64 offen sc1
    s_add_u32 s64, s25, 0xc00
    buffer_load_dwordx4 v[40:43], v2, s[4:7], s64 offen sc1
    s_add_u32 s64, s25, 0xe00
    buffer_load_dwordx4 v[44:47], v2, s[4:7], s64 offen sc1
    s_add_u32 s64, s25, 0x1000
    buffer_load_dwordx4 v[48:51], v2, s[4:7], s64 offen sc1
    s_add_u32 s64, s25, 0x1200
    buffer_load_dwordx4 v[52:55], v2, s[4:7], s64 offen sc1
    s_add_u32 s64, s30, 0x0
    buffer_load_dwordx4 v[56:59], v2, s[4:7], s64 offen sc1
    s_add_u32 s64, s30, 0x200
    buffer_load_dwordx4 v[60:63], v2, s[4:7], s64 offen sc1
    s_add_u32 s64, s30, 0x400
    buffer_load_dwordx4 v[64:67], v2, s[4:7], s64 offen sc1
    s_add_u32 s64, s30, 0x600
    buffer_load_dwordx4 v[68:71], v2, s[4:7], s64 offen sc1
    s_add_u32 s64, s30, 0x800
    buffer_load_dwordx4 v[72:75], v2, s[4:7], s64 offen sc1
    s_add_u32 s64, s30, 0xa00
    buffer_load_dwordx4 v[76:79], v2, s[4:7], s64 offen sc1
    s_add_u32 s64, s30, 0xc00
    buffer_load_dwordx4 v[80:83], v2, s[4:7], s64 offen sc1
    s_add_u32 s64, s30, 0xe00
    buffer_load_dwordx4 v[84:87], v2, s[4:7], s64 offen sc1
    s_add_u32 s64, s30, 0x1000
    buffer_load_dwordx4 v[88:91], v2, s[4:7], s64 offen sc1
    s_add_u32 s64, s30, 0x1200
    buffer_load_dwordx4 v[92:95], v2, s[4:7], s64 offen sc1
    s_add_u32 s29, s29, 1
    s_waitcnt vmcnt(0)
    v_max3_u32 v4, v19, v23, v27
    v_max3_u32 v4, v4, v31, v35
    v_max3_u32 v4, v4, v39, v43
    v_max3_u32 v4, v4, v47, v51
    v_max3_u32 v4, v4, v55, v59
    v_max3_u32 v4, v4, v63, v67
    v_max3_u32 v4, v4, v71, v75
    v_max3_u32 v4, v4, v79, v83
    v_max3_u32 v4, v4, v87, v91
    v_max_u32 v4, v4, v95
    v_cmp_eq_u32 vcc, -1, v4
    s_cbranch_vccz MKO_148
    s_cmp_gt_u32 s29, 262144
    s_cbranch_scc0 MKR_147
MKO_148:
    v_mfma_f32_16x16x32_bf16 v[8:11], v[16:19], v[96:99], 0
    v_mfma_f32_16x16x32_bf16 v[12:15], v[16:19], v[100:103], 0
    v_mfma_f32_16x16x32_bf16 v[8:11], v[20:23], v[104:107], v[8:11]
    v_mfma_f32_16x16x32_bf16 v[12:15], v[20:23], v[108:111], v[12:15]
    v_mfma_f32_16x16x32_bf16 v[8:11], v[24:27], v[112:115], v[8:11]
    v_mfma_f32_16x16x32_bf16 v[12:15], v[24:27], v[116:119], v[12:15]
    v_mfma_f32_16x16x32_bf16 v[8:11], v[28:31], v[120:123], v[8:11]
    v_mfma_f32_16x16x32_bf16 v[12:15], v[28:31], v[124:127], v[12:15]
    v_mfma_f32_16x16x32_bf16 v[8:11], v[32:35], v[128:131], v[8:11]
    v_mfma_f32_16x16x32_bf16 v[12:15], v[32:35], v[132:135], v[12:15]
    v_mfma_f32_16x16x32_bf16 v[8:11], v[36:39], v[136:139], v[8:11]
    v_mfma_f32_16x16x32_bf16 v[12:15], v[36:39], v[140:143], v[12:15]
    v_mfma_f32_16x16x32_bf16 v[8:11], v[40:43], v[144:147], v[8:11]
    v_mfma_f32_16x16x32_bf16 v[12:15], v[40:43], v[148:151], v[12:15]
    v_mfma_f32_16x16x32_bf16 v[8:11], v[44:47], v[152:155], v[8:11]
    v_mfma_f32_16x16x32_bf16 v[12:15], v[44:47], v[156:159], v[12:15]
    v_mfma_f32_16x16x32_bf16 v[8:11], v[48:51], v[160:163], v[8:11]
    v_mfma_f32_16x16x32_bf16 v[12:15], v[48:51], v[164:167], v[12:15]
    v_mfma_f32_16x16x32_bf16 v[8:11], v[52:55], v[168:171], v[8:11]
    v_mfma_f32_16x16x32_bf16 v[12:15], v[52:55], v[172:175], v[12:15]
    v_mfma_f32_16x16x32_bf16 v[8:11], v[56:59], v[176:179], v[8:11]
    v_mfma_f32_16x16x32_bf16 v[12:15], v[56:59], v[180:183], v[12:15]
    v_mfma_f32_16x16x32_bf16 v[8:11], v[60:63], v[184:187], v[8:11]
    v_mfma_f32_16x16x32_bf16 v[12:15], v[60:63], v[188:191], v[12:15]
    v_mfma_f32_16x16x32_bf16 v[8:11], v[64:67], v[192:195], v[8:11]
    v_mfma_f32_16x16x32_bf16 v[12:15], v[64:67], v[196:199], v[12:15]
    v_mfma_f32_16x16x32_bf16 v[8:11], v[68:71], v[200:203], v[8:11]
    v_mfma_f32_16x16x32_bf16 v[12:15], v[68:71], v[204:207], v[12:15]
    v_mfma_f32_16x16x32_bf16 v[8:11], v[72:75], v[208:211], v[8:11]
    v_mfma_f32_16x16x32_bf16 v[12:15], v[72:75], v[212:215], v[12:15]
    v_mfma_f32_16x16x32_bf16 v[8:11], v[76:79], v[216:219], v[8:11]
    v_mfma_f32_16x16x32_bf16 v[12:15], v[76:79], v[220:223], v[12:15]
    v_mfma_f32_16x16x32_bf16 v[8:11], v[80:83], v[224:227], v[8:11]
    v_mfma_f32_16x16x32_bf16 v[12:15], v[80:83], v[228:231], v[12:15]
    v_mfma_f32_16x16x32_bf16 v[8:11], v[84:87], v[232:235], v[8:11]
    v_mfma_f32_16x16x32_bf16 v[12:15], v[84:87], v[236:239], v[12:15]
    v_mfma_f32_16x16x32_bf16 v[8:11], v[88:91], v[240:243], v[8:11]
    v_mfma_f32_16x16x32_bf16 v[12:15], v[88:91], v[244:247], v[12:15]
    v_mfma_f32_16x16x32_bf16 v[8:11], v[92:95], v[248:251], v[8:11]
    v_mfma_f32_16x16x32_bf16 v[12:15], v[92:95], v[252:255], v[12:15]
    s_nop 7
    v_cvt_pk_bf16_f32 v16, v8, v9
    v_cvt_pk_bf16_f32 v17, v10, v11
    v_cvt_pk_bf16_f32 v18, v12, v13
    v_cvt_pk_bf16_f32 v19, v14, v15
    buffer_store_dwordx2 v[16:17], v3, s[4:7], s26 offen sc1
    buffer_store_dwordx2 v[18:19], v3, s[4:7], s26 offen offset:256 sc1
    s_waitcnt vmcnt(0)
    s_barrier
    s_cmp_lg_u32 s14, 0
    s_cbranch_scc1 GF_149
    v_mov_b32 v7, 1
    v_mov_b32 v8, 0
    s_mov_b64 exec, 1
    buffer_store_dword v7, v8, s[4:7], s27 offen sc1
    s_mov_b64 exec, -1
GF_149:
    s_add_u32 s25, s25, 0x10000
    s_add_u32 s30, s30, 0x10000
    s_add_u32 s26, s26, 0x20000
    s_add_u32 s27, s27, 256
    s_add_u32 s28, s28, 512
    s_add_u32 s24, s24, 1
    s_cmp_lt_u32 s24, 32
    s_cbranch_scc1 MKN_LOOP
    s_cmp_ge_u32 s88, 60
    s_cbranch_scc1 M_EXIT
    s_branch H_EXTRA
H_OUT:
    s_lshl_b32 s64, s3, 5
    s_add_u32 s64, s64, s13
    s_cmp_ge_u32 s64, 60
    s_cbranch_scc1 M_EXIT
    s_mul_hi_u32 s12, s64, 0xccccccd
    s_mul_i32 s65, s12, 20
    s_sub_u32 s13, s64, s65
    s_load_dwordx2 s[44:45], s[0:1], 40
    s_mov_b32 s46, 0x500000
    s_mov_b32 s47, 0x00020000
    s_load_dwordx2 s[48:49], s[0:1], 0
    s_mov_b32 s50, 0x280000
    s_mov_b32 s51, 0x00020000
    s_load_dwordx2 s[52:53], s[0:1], 96
    s_mov_b32 s54, 0x280000
    s_mov_b32 s55, 0x00020000
    s_mov_b32 s36, -1
    s_mov_b32 s37, 0
    s_waitcnt lgkmcnt(0)
    s_mul_i32 s21, s14, 36864
    v_lshrrev_b32 v7, 2, v0
    v_mul_u32_u24 v4, 1280, v7
    v_bfe_u32 v7, v0, 4, 1
    v_lshlrev_b32 v7, 1, v7
    v_and_b32 v8, 3, v0
    v_xor_b32 v7, v7, v8
    v_lshl_add_u32 v4, v7, 4, v4
    v_lshrrev_b32 v7, 4, v0
    v_lshlrev_b32 v2, 8, v7
    v_bfe_u32 v7, v0, 2, 2
    v_lshl_add_u32 v2, v7, 6, v2
    v_and_b32 v7, 3, v0
    v_lshl_add_u32 v2, v7, 3, v2
    v_add_u32 v2, s21, v2
    v_bfe_u32 v7, v0, 4, 1
    v_lshlrev_b32 v7, 5, v7
    v_sub_u32 v3, 32, v7
    v_add_u32 v3, v3, v2
    v_add_u32 v2, v2, v7
    s_mul_i32 s65, s14, 1310720
    s_lshl_b32 s66, s13, 6
    s_add_u32 s65, s65, s66
    s_add_u32 m0, s21, 0
    s_add_u32 s64, s65, 0x0
    buffer_load_dwordx4 v4, s[44:47], s64 offen lds
    s_add_u32 m0, s21, 1024
    s_add_u32 s64, s65, 0x5000
    buffer_load_dwordx4 v4, s[44:47], s64 offen lds
    s_add_u32 m0, s21, 2048
    s_add_u32 s64, s65, 0xa000
    buffer_load_dwordx4 v4, s[44:47], s64 offen lds
    s_add_u32 m0, s21, 3072
    s_add_u32 s64, s65, 0xf000
    buffer_load_dwordx4 v4, s[44:47], s64 offen lds
    s_add_u32 m0, s21, 4096
    s_add_u32 s64, s65, 0x14000
    buffer_load_dwordx4 v4, s[44:47], s64 offen lds
    s_add_u32 m0, s21, 5120
    s_add_u32 s64, s65, 0x19000
    buffer_load_dwordx4 v4, s[44:47], s64 offen lds
    s_add_u32 m0, s21, 6144
    s_add_u32 s64, s65, 0x1e000
    buffer_load_dwordx4 v4, s[44:47], s64 offen lds
    s_add_u32 m0, s21, 7168
    s_add_u32 s64, s65, 0x23000
    buffer_load_dwordx4 v4, s[44:47], s64 offen lds
    s_add_u32 m0, s21, 8192
    s_add_u32 s64, s65, 0x28000
    buffer_load_dwordx4 v4, s[44:47], s64 offen lds
    s_add_u32 m0, s21, 9216
    s_add_u32 s64, s65, 0x2d000
    buffer_load_dwordx4 v4, s[44:47], s64 offen lds
    s_add_u32 m0, s21, 10240
    s_add_u32 s64, s65, 0x32000
    buffer_load_dwordx4 v4, s[44:47], s64 offen lds
    s_add_u32 m0, s21, 11264
    s_add_u32 s64, s65, 0x37000
    buffer_load_dwordx4 v4, s[44:47], s64 offen lds
    s_add_u32 m0, s21, 12288
    s_add_u32 s64, s65, 0x3c000
    buffer_load_dwordx4 v4, s[44:47], s64 offen lds
    s_add_u32 m0, s21, 13312
    s_add_u32 s64, s65, 0x41000
    buffer_load_dwordx4 v4, s[44:47], s64 offen lds
    s_add_u32 m0, s21, 14336
    s_add_u32 s64, s65, 0x46000
    buffer_load_dwordx4 v4, s[44:47], s64 offen lds
    s_add_u32 m0, s21, 15360
    s_add_u32 s64, s65, 0x4b000
    buffer_load_dwordx4 v4, s[44:47], s64 offen lds
    s_add_u32 m0, s21, 16384
    s_add_u32 s64, s65, 0x50000
    buffer_load_dwordx4 v4, s[44:47], s64 offen lds
    s_add_u32 m0, s21, 17408
    s_add_u32 s64, s65, 0x55000
    buffer_load_dwordx4 v4, s[44:47], s64 offen lds
    s_add_u32 m0, s21, 18432
    s_add_u32 s64, s65, 0x5a000
    buffer_load_dwordx4 v4, s[44:47], s64 offen lds
    s_add_u32 m0, s21, 19456
    s_add_u32 s64, s65, 0x5f000
    buffer_load_dwordx4 v4, s[44:47], s64 offen lds
    s_add_u32 m0, s21, 20480
    s_add_u32 s64, s65, 0x64000
    buffer_load_dwordx4 v4, s[44:47], s64 offen lds
    s_add_u32 m0, s21, 21504
    s_add_u32 s64, s65, 0x69000
    buffer_load_dwordx4 v4, s[44:47], s64 offen lds
    s_add_u32 m0, s21, 22528
    s_add_u32 s64, s65, 0x6e000
    buffer_load_dwordx4 v4, s[44:47], s64 offen lds
    s_add_u32 m0, s21, 23552
    s_add_u32 s64, s65, 0x73000
    buffer_load_dwordx4 v4, s[44:47], s64 offen lds
    s_add_u32 m0, s21, 24576
    s_add_u32 s64, s65, 0x78000
    buffer_load_dwordx4 v4, s[44:47], s64 offen lds
    s_add_u32 m0, s21, 25600
    s_add_u32 s64, s65, 0x7d000
    buffer_load_dwordx4 v4, s[44:47], s64 offen lds
    s_add_u32 m0, s21, 26624
    s_add_u32 s64, s65, 0x82000
    buffer_load_dwordx4 v4, s[44:47], s64 offen lds
    s_add_u32 m0, s21, 27648
    s_add_u32 s64, s65, 0x87000
    buffer_load_dwordx4 v4, s[44:47], s64 offen lds
    s_add_u32 m0, s21, 28672
    s_add_u32 s64, s65, 0x8c000
    buffer_load_dwordx4 v4, s[44:47], s64 offen lds
    s_add_u32 m0, s21, 29696
    s_add_u32 s64, s65, 0x91000
    buffer_load_dwordx4 v4, s[44:47], s64 offen lds
    s_add_u32 m0, s21, 30720
    s_add_u32 s64, s65, 0x96000
    buffer_load_dwordx4 v4, s[44:47], s64 offen lds
    s_add_u32 m0, s21, 31744
    s_add_u32 s64, s65, 0x9b000
    buffer_load_dwordx4 v4, s[44:47], s64 offen lds
    s_add_u32 m0, s21, 32768
    s_add_u32 s64, s65, 0xa0000
    buffer_load_dwordx4 v4, s[44:47], s64 offen lds
    s_add_u32 m0, s21, 33792
    s_add_u32 s64, s65, 0xa5000
    buffer_load_dwordx4 v4, s[44:47], s64 offen lds
    s_add_u32 m0, s21, 34816
    s_add_u32 s64, s65, 0xaa000
    buffer_load_dwordx4 v4, s[44:47], s64 offen lds
    s_add_u32 m0, s21, 35840
    s_add_u32 s64, s65, 0xaf000
    buffer_load_dwordx4 v4, s[44:47], s64 offen lds
    s_waitcnt vmcnt(32)
    ds_read_b64_tr_b16 a[0:1], v2 offset:0
    ds_read_b64_tr_b16 a[2:3], v2 offset:1024
    ds_read_b64_tr_b16 a[4:5], v3 offset:0
    ds_read_b64_tr_b16 a[6:7], v3 offset:1024
    ds_read_b64_tr_b16 a[8:9], v2 offset:2048
    ds_read_b64_tr_b16 a[10:11], v2 offset:3072
    ds_read_b64_tr_b16 a[12:13], v3 offset:2048
    ds_read_b64_tr_b16 a[14:15], v3 offset:3072
    s_waitcnt lgkmcnt(0)
    s_add_u32 m0, s21, 0
    s_add_u32 s64, s65, 0xb4000
    buffer_load_dwordx4 v4, s[44:47], s64 offen lds
    s_add_u32 m0, s21, 1024
    s_add_u32 s64, s65, 0xb9000
    buffer_load_dwordx4 v4, s[44:47], s64 offen lds
    s_add_u32 m0, s21, 2048
    s_add_u32 s64, s65, 0xbe000
    buffer_load_dwordx4 v4, s[44:47], s64 offen lds
    s_add_u32 m0, s21, 3072
    s_add_u32 s64, s65, 0xc3000
    buffer_load_dwordx4 v4, s[44:47], s64 offen lds
    s_waitcnt vmcnt(32)
    ds_read_b64_tr_b16 a[16:17], v2 offset:4096
    ds_read_b64_tr_b16 a[18:19], v2 offset:5120
    ds_read_b64_tr_b16 a[20:21], v3 offset:4096
    ds_read_b64_tr_b16 a[22:23], v3 offset:5120
    ds_read_b64_tr_b16 a[24:25], v2 offset:6144
    ds_read_b64_tr_b16 a[26:27], v2 offset:7168
    ds_read_b64_tr_b16 a[28:29], v3 offset:6144
    ds_read_b64_tr_b16 a[30:31], v3 offset:7168
    s_waitcnt lgkmcnt(0)
    s_add_u32 m0, s21, 4096
    s_add_u32 s64, s65, 0xc8000
    buffer_load_dwordx4 v4, s[44:47], s64 offen lds
    s_add_u32 m0, s21, 5120
    s_add_u32 s64, s65, 0xcd000
    buffer_load_dwordx4 v4, s[44:47], s64 offen lds
    s_add_u32 m0, s21, 6144
    s_add_u32 s64, s65, 0xd2000
    buffer_load_dwordx4 v4, s[44:47], s64 offen lds
    s_add_u32 m0, s21, 7168
    s_add_u32 s64, s65, 0xd7000
    buffer_load_dwordx4 v4, s[44:47], s64 offen lds
    s_waitcnt vmcnt(32)
    ds_read_b64_tr_b16 a[32:33], v2 offset:8192
    ds_read_b64_tr_b16 a[34:35], v2 offset:9216
    ds_read_b64_tr_b16 a[36:37], v3 offset:8192
    ds_read_b64_tr_b16 a[38:39], v3 offset:9216
    ds_read_b64_tr_b16 a[40:41], v2 offset:10240
    ds_read_b64_tr_b16 a[42:43], v2 offset:11264
    ds_read_b64_tr_b16 a[44:45], v3 offset:10240
    ds_read_b64_tr_b16 a[46:47], v3 offset:11264
    s_waitcnt lgkmcnt(0)
    s_add_u32 m0, s21, 8192
    s_add_u32 s64, s65, 0xdc000
    buffer_load_dwordx4 v4, s[44:47], s64 offen lds
    s_add_u32 m0, s21, 9216
    s_add_u32 s64, s65, 0xe1000
    buffer_load_dwordx4 v4, s[44:47], s64 offen lds
    s_add_u32 m0, s21, 10240
    s_add_u32 s64, s65, 0xe6000
    buffer_load_dwordx4 v4, s[44:47], s64 offen lds
    s_add_u32 m0, s21, 11264
    s_add_u32 s64, s65, 0xeb000
    buffer_load_dwordx4 v4, s[44:47], s64 offen lds
    s_waitcnt vmcnt(32)
    ds_read_b64_tr_b16 a[48:49], v2 offset:12288
    ds_read_b64_tr_b16 a[50:51], v2 offset:13312
    ds_read_b64_tr_b16 a[52:53], v3 offset:12288
    ds_read_b64_tr_b16 a[54:55], v3 offset:13312
    ds_read_b64_tr_b16 a[56:57], v2 offset:14336
    ds_read_b64_tr_b16 a[58:59], v2 offset:15360
    ds_read_b64_tr_b16 a[60:61], v3 offset:14336
    ds_read_b64_tr_b16 a[62:63], v3 offset:15360
    s_waitcnt lgkmcnt(0)
    s_add_u32 m0, s21, 12288
    s_add_u32 s64, s65, 0xf0000
    buffer_load_dwordx4 v4, s[44:47], s64 offen lds
    s_add_u32 m0, s21, 13312
    s_add_u32 s64, s65, 0xf5000
    buffer_load_dwordx4 v4, s[44:47], s64 offen lds
    s_add_u32 m0, s21, 14336
    s_add_u32 s64, s65, 0xfa000
    buffer_load_dwordx4 v4, s[44:47], s64 offen lds
    s_add_u32 m0, s21, 15360
    s_add_u32 s64, s65, 0xff000
    buffer_load_dwordx4 v4, s[44:47], s64 offen lds
    s_waitcnt vmcnt(32)
    ds_read_b64_tr_b16 a[64:65], v2 offset:16384
    ds_read_b64_tr_b16 a[66:67], v2 offset:17408
    ds_read_b64_tr_b16 a[68:69], v3 offset:16384
    ds_read_b64_tr_b16 a[70:71], v3 offset:17408
    ds_read_b64_tr_b16 a[72:73], v2 offset:18432
    ds_read_b64_tr_b16 a[74:75], v2 offset:19456
    ds_read_b64_tr_b16 a[76:77], v3 offset:18432
    ds_read_b64_tr_b16 a[78:79], v3 offset:19456
    s_waitcnt lgkmcnt(0)
    s_add_u32 m0, s21, 16384
    s_add_u32 s64, s65, 0x104000
    buffer_load_dwordx4 v4, s[44:47], s64 offen lds
    s_add_u32 m0, s21, 17408
    s_add_u32 s64, s65, 0x109000
    buffer_load_dwordx4 v4, s[44:47], s64 offen lds
    s_add_u32 m0, s21, 18432
    s_add_u32 s64, s65, 0x10e000
    buffer_load_dwordx4 v4, s[44:47], s64 offen lds
    s_add_u32 m0, s21, 19456
    s_add_u32 s64, s65, 0x113000
    buffer_load_dwordx4 v4, s[44:47], s64 offen lds
    s_waitcnt vmcnt(32)
    ds_read_b64_tr_b16 a[80:81], v2 offset:20480
    ds_read_b64_tr_b16 a[82:83], v2 offset:21504
    ds_read_b64_tr_b16 a[84:85], v3 offset:20480
    ds_read_b64_tr_b16 a[86:87], v3 offset:21504
    ds_read_b64_tr_b16 a[88:89], v2 offset:22528
    ds_read_b64_tr_b16 a[90:91], v2 offset:23552
    ds_read_b64_tr_b16 a[92:93], v3 offset:22528
    ds_read_b64_tr_b16 a[94:95], v3 offset:23552
    s_waitcnt lgkmcnt(0)
    s_add_u32 m0, s21, 20480
    s_add_u32 s64, s65, 0x118000
    buffer_load_dwordx4 v4, s[44:47], s64 offen lds
    s_add_u32 m0, s21, 21504
    s_add_u32 s64, s65, 0x11d000
    buffer_load_dwordx4 v4, s[44:47], s64 offen lds
    s_add_u32 m0, s21, 22528
    s_add_u32 s64, s65, 0x122000
    buffer_load_dwordx4 v4, s[44:47], s64 offen lds
    s_add_u32 m0, s21, 23552
    s_add_u32 s64, s65, 0x127000
    buffer_load_dwordx4 v4, s[44:47], s64 offen lds
    s_waitcnt vmcnt(32)
    ds_read_b64_tr_b16 a[96:97], v2 offset:24576
    ds_read_b64_tr_b16 a[98:99], v2 offset:25600
    ds_read_b64_tr_b16 a[100:101], v3 offset:24576
    ds_read_b64_tr_b16 a[102:103], v3 offset:25600
    ds_read_b64_tr_b16 a[104:105], v2 offset:26624
    ds_read_b64_tr_b16 a[106:107], v2 offset:27648
    ds_read_b64_tr_b16 a[108:109], v3 offset:26624
    ds_read_b64_tr_b16 a[110:111], v3 offset:27648
    s_waitcnt lgkmcnt(0)
    s_add_u32 m0, s21, 24576
    s_add_u32 s64, s65, 0x12c000
    buffer_load_dwordx4 v4, s[44:47], s64 offen lds
    s_add_u32 m0, s21, 25600
    s_add_u32 s64, s65, 0x131000
    buffer_load_dwordx4 v4, s[44:47], s64 offen lds
    s_add_u32 m0, s21, 26624
    s_add_u32 s64, s65, 0x136000
    buffer_load_dwordx4 v4, s[44:47], s64 offen lds
    s_add_u32 m0, s21, 27648
    s_add_u32 s64, s65, 0x13b000
    buffer_load_dwordx4 v4, s[44:47], s64 offen lds
    s_waitcnt vmcnt(32)
    ds_read_b64_tr_b16 a[112:113], v2 offset:28672
    ds_read_b64_tr_b16 a[114:115], v2 offset:29696
    ds_read_b64_tr_b16 a[116:117], v3 offset:28672
    ds_read_b64_tr_b16 a[118:119], v3 offset:29696
    ds_read_b64_tr_b16 a[120:121], v2 offset:30720
    ds_read_b64_tr_b16 a[122:123], v2 offset:31744
    ds_read_b64_tr_b16 a[124:125], v3 offset:30720
    ds_read_b64_tr_b16 a[126:127], v3 offset:31744
    s_waitcnt lgkmcnt(0)
    s_waitcnt vmcnt(28)
    ds_read_b64_tr_b16 a[128:129], v2 offset:32768
    ds_read_b64_tr_b16 a[130:131], v2 offset:33792
    ds_read_b64_tr_b16 a[132:133], v3 offset:32768
    ds_read_b64_tr_b16 a[134:135], v3 offset:33792
    ds_read_b64_tr_b16 a[136:137], v2 offset:34816
    ds_read_b64_tr_b16 a[138:139], v2 offset:35840
    ds_read_b64_tr_b16 a[140:141], v3 offset:34816
    ds_read_b64_tr_b16 a[142:143], v3 offset:35840
    s_waitcnt lgkmcnt(0)
    s_waitcnt vmcnt(24)
    ds_read_b64_tr_b16 a[144:145], v2 offset:0
    ds_read_b64_tr_b16 a[146:147], v2 offset:1024
    ds_read_b64_tr_b16 a[148:149], v3 offset:0
    ds_read_b64_tr_b16 a[150:151], v3 offset:1024
    ds_read_b64_tr_b16 a[152:153], v2 offset:2048
    ds_read_b64_tr_b16 a[154:155], v2 offset:3072
    ds_read_b64_tr_b16 a[156:157], v3 offset:2048
    ds_read_b64_tr_b16 a[158:159], v3 offset:3072
    s_waitcnt lgkmcnt(0)
    s_waitcnt vmcnt(20)
    ds_read_b64_tr_b16 a[160:161], v2 offset:4096
    ds_read_b64_tr_b16 a[162:163], v2 offset:5120
    ds_read_b64_tr_b16 a[164:165], v3 offset:4096
    ds_read_b64_tr_b16 a[166:167], v3 offset:5120
    ds_read_b64_tr_b16 a[168:169], v2 offset:6144
    ds_read_b64_tr_b16 a[170:171], v2 offset:7168
    ds_read_b64_tr_b16 a[172:173], v3 offset:6144
    ds_read_b64_tr_b16 a[174:175], v3 offset:7168
    s_waitcnt lgkmcnt(0)
    s_waitcnt vmcnt(16)
    ds_read_b64_tr_b16 a[176:177], v2 offset:8192
    ds_read_b64_tr_b16 a[178:179], v2 offset:9216
    ds_read_b64_tr_b16 a[180:181], v3 offset:8192
    ds_read_b64_tr_b16 a[182:183], v3 offset:9216
    ds_read_b64_tr_b16 a[184:185], v2 offset:10240
    ds_read_b64_tr_b16 a[186:187], v2 offset:11264
    ds_read_b64_tr_b16 a[188:189], v3 offset:10240
    ds_read_b64_tr_b16 a[190:191], v3 offset:11264
    s_waitcnt lgkmcnt(0)
    s_waitcnt vmcnt(12)
    ds_read_b64_tr_b16 a[192:193], v2 offset:12288
    ds_read_b64_tr_b16 a[194:195], v2 offset:13312
    ds_read_b64_tr_b16 a[196:197], v3 offset:12288
    ds_read_b64_tr_b16 a[198:199], v3 offset:13312
    ds_read_b64_tr_b16 a[200:201], v2 offset:14336
    ds_read_b64_tr_b16 a[202:203], v2 offset:15360
    ds_read_b64_tr_b16 a[204:205], v3 offset:14336
    ds_read_b64_tr_b16 a[206:207], v3 offset:15360
    s_waitcnt lgkmcnt(0)
    s_waitcnt vmcnt(8)
    ds_read_b64_tr_b16 a[208:209], v2 offset:16384
    ds_read_b64_tr_b16 a[210:211], v2 offset:17408
    ds_read_b64_tr_b16 a[212:213], v3 offset:16384
    ds_read_b64_tr_b16 a[214:215], v3 offset:17408
    ds_read_b64_tr_b16 a[216:217], v2 offset:18432
    ds_read_b64_tr_b16 a[218:219], v2 offset:19456
    ds_read_b64_tr_b16 a[220:221], v3 offset:18432
    ds_read_b64_tr_b16 a[222:223], v3 offset:19456
    s_waitcnt lgkmcnt(0)
    s_waitcnt vmcnt(4)
    ds_read_b64_tr_b16 a[224:225], v2 offset:20480
    ds_read_b64_tr_b16 a[226:227], v2 offset:21504
    ds_read_b64_tr_b16 a[228:229], v3 offset:20480
    ds_read_b64_tr_b16 a[230:231], v3 offset:21504
    ds_read_b64_tr_b16 a[232:233], v2 offset:22528
    ds_read_b64_tr_b16 a[234:235], v2 offset:23552
    ds_read_b64_tr_b16 a[236:237], v3 offset:22528
    ds_read_b64_tr_b16 a[238:239], v3 offset:23552
    s_waitcnt lgkmcnt(0)
    s_waitcnt vmcnt(0)
    ds_read_b64_tr_b16 a[240:241], v2 offset:24576
    ds_read_b64_tr_b16 a[242:243], v2 offset:25600
    ds_read_b64_tr_b16 a[244:245], v3 offset:24576
    ds_read_b64_tr_b16 a[246:247], v3 offset:25600
    ds_read_b64_tr_b16 a[248:249], v2 offset:26624
    ds_read_b64_tr_b16 a[250:251], v2 offset:27648
    ds_read_b64_tr_b16 a[252:253], v3 offset:26624
    ds_read_b64_tr_b16 a[254:255], v3 offset:27648
    s_waitcnt lgkmcnt(0)
    s_barrier
    s_mov_b32 s29, 0
    v_lshlrev_b32 v1, 4, v0
    v_mov_b32 v8, 0
    s_mov_b32 s64, 0x298000
OUS_150:
    buffer_load_dword v7, v8, s[4:7], s64 offen sc1
    s_add_u32 s29, s29, 1
    s_waitcnt vmcnt(0)
    v_cmp_gt_u32 vcc, 1, v7
    s_cbranch_vccz OUSD_151
    s_cmp_gt_u32 s29, 262144
    s_cbranch_scc1 OUSD_151
    s_sleep 8
    s_branch OUS_150
OUSD_151:
    v_lshlrev_b32 v6, 2, v0
    s_mov_b32 s64, 0x5400000
    buffer_load_dword v7, v6, s[4:7], s64 offen sc1
    s_waitcnt vmcnt(0)
    v_readlane_b32 s72, v7, 0
    v_readlane_b32 s73, v7, 1
    v_readlane_b32 s74, v7, 2
    v_readlane_b32 s75, v7, 3
    v_readlane_b32 s76, v7, 4
    v_readlane_b32 s77, v7, 5
    v_readlane_b32 s78, v7, 6
    v_readlane_b32 s79, v7, 7
    s_and_b32 s64, s14, 1
    s_lshl_b32 s64, s64, 4
    v_and_b32 v6, 15, v0
    v_add_u32 v6, s64, v6
    v_mov_b32 v9, v6
    v_mul_u32_u24 v5, 1280, v6
    v_lshrrev_b32 v6, 4, v0
    v_lshl_add_u32 v5, v6, 3, v5
    s_lshr_b32 s64, s14, 1
    s_lshl_b32 s64, s64, 5
    s_lshl_b32 s65, s13, 6
    s_add_u32 s64, s64, s65
    v_add_u32 v5, s64, v5
    v_lshlrev_b32 v6, 2, v0
    s_mov_b32 s80, 0x49249249
    s_mov_b32 s81, 0x92492492
    s_lshl_b64 s[80:81], s[80:81], s12
    s_bitset0_b64 s[80:81], 63
    s_bitset0_b64 s[80:81], 62
    s_mov_b64 s[82:83], 0
    s_lshr_b32 s64, s72, 5
    s_bitset1_b64 s[82:83], s64
    s_lshr_b32 s64, s73, 5
    s_bitset1_b64 s[82:83], s64
    s_lshr_b32 s64, s74, 5
    s_bitset1_b64 s[82:83], s64
    s_lshr_b32 s64, s75, 5
    s_bitset1_b64 s[82:83], s64
    s_lshr_b32 s64, s76, 5
    s_bitset1_b64 s[82:83], s64
    s_lshr_b32 s64, s77, 5
    s_bitset1_b64 s[82:83], s64
    s_lshr_b32 s64, s78, 5
    s_bitset1_b64 s[82:83], s64
    s_lshr_b32 s64, s79, 5
    s_bitset1_b64 s[82:83], s64
OU_LOOP:
    s_cmp_eq_u64 s[80:81], 0
    s_cbranch_scc1 OU_END
    s_andn2_b64 s[84:85], s[80:81], s[82:83]
    s_cbranch_scc0 OU_WM
    s_ff1_i32_b64 s24, s[84:85]
    s_branch OU_GO
OU_WM:
    v_mov_b32 v8, 0
    s_mov_b32 s64, 0x298100
OUW_152:
    buffer_load_dword v7, v8, s[4:7], s64 offen sc1
    s_add_u32 s29, s29, 1
    s_waitcnt vmcnt(0)
    v_cmp_gt_u32 vcc, 40, v7
    s_cbranch_vccz OUWD_153
    s_cmp_gt_u32 s29, 262144
    s_cbranch_scc1 OUWD_153
    s_sleep 8
    s_branch OUW_152
OUWD_153:
    s_mov_b64 s[82:83], 0
    s_branch OU_LOOP
OU_GO:
    s_bitset0_b64 s[80:81], s24
    s_lshr_b32 s86, s14, 1
    s_mul_i32 s67, s24, 40960
    buffer_load_dwordx2 v[160:161], v5, s[48:51], s67 offen
    s_add_u32 s64, s67, 0x0
    buffer_load_dwordx2 v[162:163], v5, s[4:7], s64 offen
    s_mov_b32 s64, 0x298100
    buffer_load_dword v12, off, s[4:7], s64 sc1
    s_lshl_b32 s64, s24, 7
    s_add_u32 s64, s64, 0x296000
    s_mov_b64 exec, s[36:37]
OU_F_154:
    buffer_load_dword v7, v6, s[4:7], s64 offen sc1
    s_add_u32 s29, s29, 1
    s_waitcnt vmcnt(0)
    v_cmp_eq_u32 vcc, 0, v7
    s_cbranch_vccz OU_FD_155
    s_cmp_gt_u32 s29, 262144
    s_cbranch_scc1 OU_FD_155
    s_sleep 1
    s_branch OU_F_154
OU_FD_155:
    s_mov_b64 exec, -1
    s_lshl_b32 s25, s24, 18
    s_lshl_b32 s64, s14, 15
    s_add_u32 s25, s25, s64
    s_add_u32 s25, s25, 0x4400000
    s_add_u32 s64, s25, 0x0
    buffer_load_dwordx4 v[16:19], v1, s[4:7], s64 offen
    s_add_u32 s64, s25, 0x20000
    buffer_load_dwordx4 v[20:23], v1, s[4:7], s64 offen
    s_add_u32 s64, s25, 0x400
    buffer_load_dwordx4 v[24:27], v1, s[4:7], s64 offen
    s_add_u32 s64, s25, 0x20400
    buffer_load_dwordx4 v[28:31], v1, s[4:7], s64 offen
    s_add_u32 s64, s25, 0x800
    buffer_load_dwordx4 v[32:35], v1, s[4:7], s64 offen
    s_add_u32 s64, s25, 0x20800
    buffer_load_dwordx4 v[36:39], v1, s[4:7], s64 offen
    s_add_u32 s64, s25, 0xc00
    buffer_load_dwordx4 v[40:43], v1, s[4:7], s64 offen
    s_add_u32 s64, s25, 0x20c00
    buffer_load_dwordx4 v[44:47], v1, s[4:7], s64 offen
    s_add_u32 s64, s25, 0x1000
    buffer_load_dwordx4 v[48:51], v1, s[4:7], s64 offen
    s_add_u32 s64, s25, 0x21000
    buffer_load_dwordx4 v[52:55], v1, s[4:7], s64 offen
    s_add_u32 s64, s25, 0x1400
    buffer_load_dwordx4 v[56:59], v1, s[4:7], s64 offen
    s_add_u32 s64, s25, 0x21400
    buffer_load_dwordx4 v[60:63], v1, s[4:7], s64 offen
    s_add_u32 s64, s25, 0x1800
    buffer_load_dwordx4 v[64:67], v1, s[4:7], s64 offen
    s_add_u32 s64, s25, 0x21800
    buffer_load_dwordx4 v[68:71], v1, s[4:7], s64 offen
    s_add_u32 s64, s25, 0x1c00
    buffer_load_dwordx4 v[72:75], v1, s[4:7], s64 offen
    s_add_u32 s64, s25, 0x21c00
    buffer_load_dwordx4 v[76:79], v1, s[4:7], s64 offen
    s_add_u32 s64, s25, 0x2000
    buffer_load_dwordx4 v[80:83], v1, s[4:7], s64 offen
    s_add_u32 s64, s25, 0x22000
    buffer_load_dwordx4 v[84:87], v1, s[4:7], s64 offen
    s_add_u32 s64, s25, 0x2400
    buffer_load_dwordx4 v[88:91], v1, s[4:7], s64 offen
    s_add_u32 s64, s25, 0x22400
    buffer_load_dwordx4 v[92:95], v1, s[4:7], s64 offen
    s_add_u32 s64, s25, 0x2800
    buffer_load_dwordx4 v[96:99], v1, s[4:7], s64 offen
    s_add_u32 s64, s25, 0x22800
    buffer_load_dwordx4 v[100:103], v1, s[4:7], s64 offen
    s_add_u32 s64, s25, 0x2c00
    buffer_load_dwordx4 v[104:107], v1, s[4:7], s64 offen
    s_add_u32 s64, s25, 0x22c00
    buffer_load_dwordx4 v[108:111], v1, s[4:7], s64 offen
    s_add_u32 s64, s25, 0x3000
    buffer_load_dwordx4 v[112:115], v1, s[4:7], s64 offen
    s_add_u32 s64, s25, 0x23000
    buffer_load_dwordx4 v[116:119], v1, s[4:7], s64 offen
    s_add_u32 s64, s25, 0x3400
    buffer_load_dwordx4 v[120:123], v1, s[4:7], s64 offen
    s_add_u32 s64, s25, 0x23400
    buffer_load_dwordx4 v[124:127], v1, s[4:7], s64 offen
    s_add_u32 s64, s25, 0x3800
    buffer_load_dwordx4 v[128:131], v1, s[4:7], s64 offen
    s_add_u32 s64, s25, 0x23800
    buffer_load_dwordx4 v[132:135], v1, s[4:7], s64 offen
    s_add_u32 s64, s25, 0x3c00
    buffer_load_dwordx4 v[136:139], v1, s[4:7], s64 offen
    s_add_u32 s64, s25, 0x23c00
    buffer_load_dwordx4 v[140:143], v1, s[4:7], s64 offen
    s_waitcnt vmcnt(30)
    v_mfma_f32_16x16x32_bf16 v[144:147], a[0:3], v[16:19], 0
    v_mfma_f32_16x16x32_bf16 v[148:151], a[0:3], v[20:23], 0
    v_mfma_f32_16x16x32_bf16 v[152:155], a[4:7], v[16:19], 0
    v_mfma_f32_16x16x32_bf16 v[156:159], a[4:7], v[20:23], 0
    s_add_u32 s64, s25, 0x4000
    buffer_load_dwordx4 v[16:19], v1, s[4:7], s64 offen
    s_add_u32 s64, s25, 0x24000
    buffer_load_dwordx4 v[20:23], v1, s[4:7], s64 offen
    s_waitcnt vmcnt(30)
    v_mfma_f32_16x16x32_bf16 v[144:147], a[8:11], v[24:27], v[144:147]
    v_mfma_f32_16x16x32_bf16 v[148:151], a[8:11], v[28:31], v[148:151]
    v_mfma_f32_16x16x32_bf16 v[152:155], a[12:15], v[24:27], v[152:155]
    v_mfma_f32_16x16x32_bf16 v[156:159], a[12:15], v[28:31], v[156:159]
    s_add_u32 s64, s25, 0x4400
    buffer_load_dwordx4 v[24:27], v1, s[4:7], s64 offen
    s_add_u32 s64, s25, 0x24400
    buffer_load_dwordx4 v[28:31], v1, s[4:7], s64 offen
    s_waitcnt vmcnt(30)
    v_mfma_f32_16x16x32_bf16 v[144:147], a[16:19], v[32:35], v[144:147]
    v_mfma_f32_16x16x32_bf16 v[148:151], a[16:19], v[36:39], v[148:151]
    v_mfma_f32_16x16x32_bf16 v[152:155], a[20:23], v[32:35], v[152:155]
    v_mfma_f32_16x16x32_bf16 v[156:159], a[20:23], v[36:39], v[156:159]
    s_add_u32 s64, s25, 0x4800
    buffer_load_dwordx4 v[32:35], v1, s[4:7], s64 offen
    s_add_u32 s64, s25, 0x24800
    buffer_load_dwordx4 v[36:39], v1, s[4:7], s64 offen
    s_waitcnt vmcnt(30)
    v_mfma_f32_16x16x32_bf16 v[144:147], a[24:27], v[40:43], v[144:147]
    v_mfma_f32_16x16x32_bf16 v[148:151], a[24:27], v[44:47], v[148:151]
    v_mfma_f32_16x16x32_bf16 v[152:155], a[28:31], v[40:43], v[152:155]
    v_mfma_f32_16x16x32_bf16 v[156:159], a[28:31], v[44:47], v[156:159]
    s_add_u32 s64, s25, 0x4c00
    buffer_load_dwordx4 v[40:43], v1, s[4:7], s64 offen
    s_add_u32 s64, s25, 0x24c00
    buffer_load_dwordx4 v[44:47], v1, s[4:7], s64 offen
    s_waitcnt vmcnt(30)
    v_mfma_f32_16x16x32_bf16 v[144:147], a[32:35], v[48:51], v[144:147]
    v_mfma_f32_16x16x32_bf16 v[148:151], a[32:35], v[52:55], v[148:151]
    v_mfma_f32_16x16x32_bf16 v[152:155], a[36:39], v[48:51], v[152:155]
    v_mfma_f32_16x16x32_bf16 v[156:159], a[36:39], v[52:55], v[156:159]
    s_add_u32 s64, s25, 0x5000
    buffer_load_dwordx4 v[48:51], v1, s[4:7], s64 offen
    s_add_u32 s64, s25, 0x25000
    buffer_load_dwordx4 v[52:55], v1, s[4:7], s64 offen
    s_waitcnt vmcnt(30)
    v_mfma_f32_16x16x32_bf16 v[144:147], a[40:43], v[56:59], v[144:147]
    v_mfma_f32_16x16x32_bf16 v[148:151], a[40:43], v[60:63], v[148:151]
    v_mfma_f32_16x16x32_bf16 v[152:155], a[44:47], v[56:59], v[152:155]
    v_mfma_f32_16x16x32_bf16 v[156:159], a[44:47], v[60:63], v[156:159]
    s_add_u32 s64, s25, 0x5400
    buffer_load_dwordx4 v[56:59], v1, s[4:7], s64 offen
    s_add_u32 s64, s25, 0x25400
    buffer_load_dwordx4 v[60:63], v1, s[4:7], s64 offen
    s_waitcnt vmcnt(30)
    v_mfma_f32_16x16x32_bf16 v[144:147], a[48:51], v[64:67], v[144:147]
    v_mfma_f32_16x16x32_bf16 v[148:151], a[48:51], v[68:71], v[148:151]
    v_mfma_f32_16x16x32_bf16 v[152:155], a[52:55], v[64:67], v[152:155]
    v_mfma_f32_16x16x32_bf16 v[156:159], a[52:55], v[68:71], v[156:159]
    s_add_u32 s64, s25, 0x5800
    buffer_load_dwordx4 v[64:67], v1, s[4:7], s64 offen
    s_add_u32 s64, s25, 0x25800
    buffer_load_dwordx4 v[68:71], v1, s[4:7], s64 offen
    s_waitcnt vmcnt(30)
    v_mfma_f32_16x16x32_bf16 v[144:147], a[56:59], v[72:75], v[144:147]
    v_mfma_f32_16x16x32_bf16 v[148:151], a[56:59], v[76:79], v[148:151]
    v_mfma_f32_16x16x32_bf16 v[152:155], a[60:63], v[72:75], v[152:155]
    v_mfma_f32_16x16x32_bf16 v[156:159], a[60:63], v[76:79], v[156:159]
    s_add_u32 s64, s25, 0x5c00
    buffer_load_dwordx4 v[72:75], v1, s[4:7], s64 offen
    s_add_u32 s64, s25, 0x25c00
    buffer_load_dwordx4 v[76:79], v1, s[4:7], s64 offen
    s_waitcnt vmcnt(30)
    v_mfma_f32_16x16x32_bf16 v[144:147], a[64:67], v[80:83], v[144:147]
    v_mfma_f32_16x16x32_bf16 v[148:151], a[64:67], v[84:87], v[148:151]
    v_mfma_f32_16x16x32_bf16 v[152:155], a[68:71], v[80:83], v[152:155]
    v_mfma_f32_16x16x32_bf16 v[156:159], a[68:71], v[84:87], v[156:159]
    s_add_u32 s64, s25, 0x6000
    buffer_load_dwordx4 v[80:83], v1, s[4:7], s64 offen
    s_add_u32 s64, s25, 0x26000
    buffer_load_dwordx4 v[84:87], v1, s[4:7], s64 offen
    s_waitcnt vmcnt(30)
    v_mfma_f32_16x16x32_bf16 v[144:147], a[72:75], v[88:91], v[144:147]
    v_mfma_f32_16x16x32_bf16 v[148:151], a[72:75], v[92:95], v[148:151]
    v_mfma_f32_16x16x32_bf16 v[152:155], a[76:79], v[88:91], v[152:155]
    v_mfma_f32_16x16x32_bf16 v[156:159], a[76:79], v[92:95], v[156:159]
    s_add_u32 s64, s25, 0x6400
    buffer_load_dwordx4 v[88:91], v1, s[4:7], s64 offen
    s_add_u32 s64, s25, 0x26400
    buffer_load_dwordx4 v[92:95], v1, s[4:7], s64 offen
    s_waitcnt vmcnt(30)
    v_mfma_f32_16x16x32_bf16 v[144:147], a[80:83], v[96:99], v[144:147]
    v_mfma_f32_16x16x32_bf16 v[148:151], a[80:83], v[100:103], v[148:151]
    v_mfma_f32_16x16x32_bf16 v[152:155], a[84:87], v[96:99], v[152:155]
    v_mfma_f32_16x16x32_bf16 v[156:159], a[84:87], v[100:103], v[156:159]
    s_add_u32 s64, s25, 0x6800
    buffer_load_dwordx4 v[96:99], v1, s[4:7], s64 offen
    s_add_u32 s64, s25, 0x26800
    buffer_load_dwordx4 v[100:103], v1, s[4:7], s64 offen
    s_waitcnt vmcnt(30)
    v_mfma_f32_16x16x32_bf16 v[144:147], a[88:91], v[104:107], v[144:147]
    v_mfma_f32_16x16x32_bf16 v[148:151], a[88:91], v[108:111], v[148:151]
    v_mfma_f32_16x16x32_bf16 v[152:155], a[92:95], v[104:107], v[152:155]
    v_mfma_f32_16x16x32_bf16 v[156:159], a[92:95], v[108:111], v[156:159]
    s_add_u32 s64, s25, 0x6c00
    buffer_load_dwordx4 v[104:107], v1, s[4:7], s64 offen
    s_add_u32 s64, s25, 0x26c00
    buffer_load_dwordx4 v[108:111], v1, s[4:7], s64 offen
    s_waitcnt vmcnt(30)
    v_mfma_f32_16x16x32_bf16 v[144:147], a[96:99], v[112:115], v[144:147]
    v_mfma_f32_16x16x32_bf16 v[148:151], a[96:99], v[116:119], v[148:151]
    v_mfma_f32_16x16x32_bf16 v[152:155], a[100:103], v[112:115], v[152:155]
    v_mfma_f32_16x16x32_bf16 v[156:159], a[100:103], v[116:119], v[156:159]
    s_add_u32 s64, s25, 0x7000
    buffer_load_dwordx4 v[112:115], v1, s[4:7], s64 offen
    s_add_u32 s64, s25, 0x27000
    buffer_load_dwordx4 v[116:119], v1, s[4:7], s64 offen
    s_waitcnt vmcnt(30)
    v_mfma_f32_16x16x32_bf16 v[144:147], a[104:107], v[120:123], v[144:147]
    v_mfma_f32_16x16x32_bf16 v[148:151], a[104:107], v[124:127], v[148:151]
    v_mfma_f32_16x16x32_bf16 v[152:155], a[108:111], v[120:123], v[152:155]
    v_mfma_f32_16x16x32_bf16 v[156:159], a[108:111], v[124:127], v[156:159]
    s_add_u32 s64, s25, 0x7400
    buffer_load_dwordx4 v[120:123], v1, s[4:7], s64 offen
    s_add_u32 s64, s25, 0x27400
    buffer_load_dwordx4 v[124:127], v1, s[4:7], s64 offen
    s_waitcnt vmcnt(30)
    v_mfma_f32_16x16x32_bf16 v[144:147], a[112:115], v[128:131], v[144:147]
    v_mfma_f32_16x16x32_bf16 v[148:151], a[112:115], v[132:135], v[148:151]
    v_mfma_f32_16x16x32_bf16 v[152:155], a[116:119], v[128:131], v[152:155]
    v_mfma_f32_16x16x32_bf16 v[156:159], a[116:119], v[132:135], v[156:159]
    s_add_u32 s64, s25, 0x7800
    buffer_load_dwordx4 v[128:131], v1, s[4:7], s64 offen
    s_add_u32 s64, s25, 0x27800
    buffer_load_dwordx4 v[132:135], v1, s[4:7], s64 offen
    s_waitcnt vmcnt(30)
    v_mfma_f32_16x16x32_bf16 v[144:147], a[120:123], v[136:139], v[144:147]
    v_mfma_f32_16x16x32_bf16 v[148:151], a[120:123], v[140:143], v[148:151]
    v_mfma_f32_16x16x32_bf16 v[152:155], a[124:127], v[136:139], v[152:155]
    v_mfma_f32_16x16x32_bf16 v[156:159], a[124:127], v[140:143], v[156:159]
    s_add_u32 s64, s25, 0x7c00
    buffer_load_dwordx4 v[136:139], v1, s[4:7], s64 offen
    s_add_u32 s64, s25, 0x27c00
    buffer_load_dwordx4 v[140:143], v1, s[4:7], s64 offen
    s_waitcnt vmcnt(30)
    v_mfma_f32_16x16x32_bf16 v[144:147], a[128:131], v[16:19], v[144:147]
    v_mfma_f32_16x16x32_bf16 v[148:151], a[128:131], v[20:23], v[148:151]
    v_mfma_f32_16x16x32_bf16 v[152:155], a[132:135], v[16:19], v[152:155]
    v_mfma_f32_16x16x32_bf16 v[156:159], a[132:135], v[20:23], v[156:159]
    s_waitcnt vmcnt(28)
    v_mfma_f32_16x16x32_bf16 v[144:147], a[136:139], v[24:27], v[144:147]
    v_mfma_f32_16x16x32_bf16 v[148:151], a[136:139], v[28:31], v[148:151]
    v_mfma_f32_16x16x32_bf16 v[152:155], a[140:143], v[24:27], v[152:155]
    v_mfma_f32_16x16x32_bf16 v[156:159], a[140:143], v[28:31], v[156:159]
    s_waitcnt vmcnt(26)
    v_mfma_f32_16x16x32_bf16 v[144:147], a[144:147], v[32:35], v[144:147]
    v_mfma_f32_16x16x32_bf16 v[148:151], a[144:147], v[36:39], v[148:151]
    v_mfma_f32_16x16x32_bf16 v[152:155], a[148:151], v[32:35], v[152:155]
    v_mfma_f32_16x16x32_bf16 v[156:159], a[148:151], v[36:39], v[156:159]
    s_waitcnt vmcnt(24)
    v_mfma_f32_16x16x32_bf16 v[144:147], a[152:155], v[40:43], v[144:147]
    v_mfma_f32_16x16x32_bf16 v[148:151], a[152:155], v[44:47], v[148:151]
    v_mfma_f32_16x16x32_bf16 v[152:155], a[156:159], v[40:43], v[152:155]
    v_mfma_f32_16x16x32_bf16 v[156:159], a[156:159], v[44:47], v[156:159]
    s_waitcnt vmcnt(22)
    v_mfma_f32_16x16x32_bf16 v[144:147], a[160:163], v[48:51], v[144:147]
    v_mfma_f32_16x16x32_bf16 v[148:151], a[160:163], v[52:55], v[148:151]
    v_mfma_f32_16x16x32_bf16 v[152:155], a[164:167], v[48:51], v[152:155]
    v_mfma_f32_16x16x32_bf16 v[156:159], a[164:167], v[52:55], v[156:159]
    s_waitcnt vmcnt(20)
    v_mfma_f32_16x16x32_bf16 v[144:147], a[168:171], v[56:59], v[144:147]
    v_mfma_f32_16x16x32_bf16 v[148:151], a[168:171], v[60:63], v[148:151]
    v_mfma_f32_16x16x32_bf16 v[152:155], a[172:175], v[56:59], v[152:155]
    v_mfma_f32_16x16x32_bf16 v[156:159], a[172:175], v[60:63], v[156:159]
    s_waitcnt vmcnt(18)
    v_mfma_f32_16x16x32_bf16 v[144:147], a[176:179], v[64:67], v[144:147]
    v_mfma_f32_16x16x32_bf16 v[148:151], a[176:179], v[68:71], v[148:151]
    v_mfma_f32_16x16x32_bf16 v[152:155], a[180:183], v[64:67], v[152:155]
    v_mfma_f32_16x16x32_bf16 v[156:159], a[180:183], v[68:71], v[156:159]
    s_waitcnt vmcnt(16)
    v_mfma_f32_16x16x32_bf16 v[144:147], a[184:187], v[72:75], v[144:147]
    v_mfma_f32_16x16x32_bf16 v[148:151], a[184:187], v[76:79], v[148:151]
    v_mfma_f32_16x16x32_bf16 v[152:155], a[188:191], v[72:75], v[152:155]
    v_mfma_f32_16x16x32_bf16 v[156:159], a[188:191], v[76:79], v[156:159]
    s_waitcnt vmcnt(14)
    v_mfma_f32_16x16x32_bf16 v[144:147], a[192:195], v[80:83], v[144:147]
    v_mfma_f32_16x16x32_bf16 v[148:151], a[192:195], v[84:87], v[148:151]
    v_mfma_f32_16x16x32_bf16 v[152:155], a[196:199], v[80:83], v[152:155]
    v_mfma_f32_16x16x32_bf16 v[156:159], a[196:199], v[84:87], v[156:159]
    s_waitcnt vmcnt(12)
    v_mfma_f32_16x16x32_bf16 v[144:147], a[200:203], v[88:91], v[144:147]
    v_mfma_f32_16x16x32_bf16 v[148:151], a[200:203], v[92:95], v[148:151]
    v_mfma_f32_16x16x32_bf16 v[152:155], a[204:207], v[88:91], v[152:155]
    v_mfma_f32_16x16x32_bf16 v[156:159], a[204:207], v[92:95], v[156:159]
    s_waitcnt vmcnt(10)
    v_mfma_f32_16x16x32_bf16 v[144:147], a[208:211], v[96:99], v[144:147]
    v_mfma_f32_16x16x32_bf16 v[148:151], a[208:211], v[100:103], v[148:151]
    v_mfma_f32_16x16x32_bf16 v[152:155], a[212:215], v[96:99], v[152:155]
    v_mfma_f32_16x16x32_bf16 v[156:159], a[212:215], v[100:103], v[156:159]
    s_waitcnt vmcnt(8)
    v_mfma_f32_16x16x32_bf16 v[144:147], a[216:219], v[104:107], v[144:147]
    v_mfma_f32_16x16x32_bf16 v[148:151], a[216:219], v[108:111], v[148:151]
    v_mfma_f32_16x16x32_bf16 v[152:155], a[220:223], v[104:107], v[152:155]
    v_mfma_f32_16x16x32_bf16 v[156:159], a[220:223], v[108:111], v[156:159]
    s_waitcnt vmcnt(6)
    v_mfma_f32_16x16x32_bf16 v[144:147], a[224:227], v[112:115], v[144:147]
    v_mfma_f32_16x16x32_bf16 v[148:151], a[224:227], v[116:119], v[148:151]
    v_mfma_f32_16x16x32_bf16 v[152:155], a[228:231], v[112:115], v[152:155]
    v_mfma_f32_16x16x32_bf16 v[156:159], a[228:231], v[116:119], v[156:159]
    s_waitcnt vmcnt(4)
    v_mfma_f32_16x16x32_bf16 v[144:147], a[232:235], v[120:123], v[144:147]
    v_mfma_f32_16x16x32_bf16 v[148:151], a[232:235], v[124:127], v[148:151]
    v_mfma_f32_16x16x32_bf16 v[152:155], a[236:239], v[120:123], v[152:155]
    v_mfma_f32_16x16x32_bf16 v[156:159], a[236:239], v[124:127], v[156:159]
    s_waitcnt vmcnt(2)
    v_mfma_f32_16x16x32_bf16 v[144:147], a[240:243], v[128:131], v[144:147]
    v_mfma_f32_16x16x32_bf16 v[148:151], a[240:243], v[132:135], v[148:151]
    v_mfma_f32_16x16x32_bf16 v[152:155], a[244:247], v[128:131], v[152:155]
    v_mfma_f32_16x16x32_bf16 v[156:159], a[244:247], v[132:135], v[156:159]
    s_waitcnt vmcnt(0)
    v_mfma_f32_16x16x32_bf16 v[144:147], a[248:251], v[136:139], v[144:147]
    v_mfma_f32_16x16x32_bf16 v[148:151], a[248:251], v[140:143], v[148:151]
    v_mfma_f32_16x16x32_bf16 v[152:155], a[252:255], v[136:139], v[152:155]
    v_mfma_f32_16x16x32_bf16 v[156:159], a[252:255], v[140:143], v[156:159]
    s_lshl_b32 s64, s14, 12
    v_add_u32 v7, s64, v1
    s_barrier
    s_nop 3
    ds_write_b128 v7, v[144:147] offset:0
    ds_write_b128 v7, v[148:151] offset:1024
    ds_write_b128 v7, v[152:155] offset:2048
    ds_write_b128 v7, v[156:159] offset:3072
    v_mov_b32 v13, 16384
    s_cmp_lg_u32 s14, 0
    s_cbranch_scc1 OW0_156
    ds_write_b32 v13, v12
OW0_156:
    s_waitcnt lgkmcnt(0)
    s_barrier
    ds_read_b32 v12, v13
    s_waitcnt lgkmcnt(0)
    v_readfirstlane_b32 s64, v12
    s_cmp_lt_u32 s64, 40
    s_cselect_b64 s[82:83], s[82:83], 0
    s_lshl_b32 s64, s14, 10
    v_add_u32 v7, s64, v1
    ds_read_b128 v[16:19], v7 offset:0
    ds_read_b128 v[20:23], v7 offset:4096
    ds_read_b128 v[24:27], v7 offset:8192
    ds_read_b128 v[28:31], v7 offset:12288
    s_waitcnt lgkmcnt(0)
    v_add_f32 v16, v16, v20
    v_add_f32 v24, v24, v28
    v_add_f32 v16, v16, v24
    v_add_f32 v17, v17, v21
    v_add_f32 v25, v25, v29
    v_add_f32 v17, v17, v25
    v_add_f32 v18, v18, v22
    v_add_f32 v26, v26, v30
    v_add_f32 v18, v18, v26
    v_add_f32 v19, v19, v23
    v_add_f32 v27, v27, v31
    v_add_f32 v19, v19, v27
    v_cvt_pk_bf16_f32 v16, v16, v16
    v_lshlrev_b32 v16, 16, v16
    v_cvt_pk_bf16_f32 v17, v17, v17
    v_lshlrev_b32 v17, 16, v17
    v_cvt_pk_bf16_f32 v18, v18, v18
    v_lshlrev_b32 v18, 16, v18
    v_cvt_pk_bf16_f32 v19, v19, v19
    v_lshlrev_b32 v19, 16, v19
    v_lshlrev_b32 v20, 16, v162
    v_and_b32 v21, 0xffff0000, v162
    v_lshlrev_b32 v24, 16, v160
    v_and_b32 v25, 0xffff0000, v160
    v_lshlrev_b32 v22, 16, v163
    v_and_b32 v23, 0xffff0000, v163
    v_lshlrev_b32 v26, 16, v161
    v_and_b32 v27, 0xffff0000, v161
    s_lshl_b32 s64, s24, 5
    v_add_u32 v8, s64, v9
    v_mov_b32 v10, -1
    v_cmp_eq_u32 vcc, s72, v8
    s_nop 1
    v_cndmask_b32 v10, v10, 0, vcc
    v_cmp_eq_u32 vcc, s73, v8
    s_nop 1
    v_cndmask_b32 v10, v10, 1, vcc
    v_cmp_eq_u32 vcc, s74, v8
    s_nop 1
    v_cndmask_b32 v10, v10, 2, vcc
    v_cmp_eq_u32 vcc, s75, v8
    s_nop 1
    v_cndmask_b32 v10, v10, 3, vcc
    v_cmp_eq_u32 vcc, s76, v8
    s_nop 1
    v_cndmask_b32 v10, v10, 4, vcc
    v_cmp_eq_u32 vcc, s77, v8
    s_nop 1
    v_cndmask_b32 v10, v10, 5, vcc
    v_cmp_eq_u32 vcc, s78, v8
    s_nop 1
    v_cndmask_b32 v10, v10, 6, vcc
    v_cmp_eq_u32 vcc, s79, v8
    s_nop 1
    v_cndmask_b32 v10, v10, 7, vcc
    v_cmp_le_i32 vcc, 0, v10
    s_and_saveexec_b64 s[68:69], vcc
    s_cbranch_execz NOUPD_158
    v_mul_u32_u24 v10, 2560, v10
    v_lshrrev_b32 v11, 4, v0
    v_lshl_add_u32 v10, v11, 4, v10
    s_lshl_b32 s64, s86, 6
    s_lshl_b32 s65, s13, 7
    s_add_u32 s64, s64, s65
    s_add_u32 s64, s64, 0x5410000
    buffer_load_dwordx4 v[164:167], v10, s[4:7], s64 offen sc1
    s_waitcnt vmcnt(0)
    v_add_f32 v20, v20, v164
    v_cvt_pk_bf16_f32 v20, v20, v20
    v_lshlrev_b32 v20, 16, v20
    v_add_f32 v21, v21, v165
    v_cvt_pk_bf16_f32 v21, v21, v21
    v_lshlrev_b32 v21, 16, v21
    v_add_f32 v22, v22, v166
    v_cvt_pk_bf16_f32 v22, v22, v22
    v_lshlrev_b32 v22, 16, v22
    v_add_f32 v23, v23, v167
    v_cvt_pk_bf16_f32 v23, v23, v23
    v_lshlrev_b32 v23, 16, v23
NOUPD_158:
    s_mov_b64 exec, -1
    v_mul_f32 v28, 0xbfb8aa3b, v20
    v_exp_f32 v28, v28
    s_nop 0
    v_add_f32 v28, 1.0, v28
    v_rcp_f32 v28, v28
    s_nop 0
    v_mul_f32 v28, v28, v20
    v_cvt_pk_bf16_f32 v28, v28, v28
    v_lshlrev_b32 v28, 16, v28
    v_mul_f32 v28, v28, v16
    v_cvt_pk_bf16_f32 v28, v28, v28
    v_lshlrev_b32 v28, 16, v28
    v_add_f32 v28, v28, v24
    v_mul_f32 v29, 0xbfb8aa3b, v21
    v_exp_f32 v29, v29
    s_nop 0
    v_add_f32 v29, 1.0, v29
    v_rcp_f32 v29, v29
    s_nop 0
    v_mul_f32 v29, v29, v21
    v_cvt_pk_bf16_f32 v29, v29, v29
    v_lshlrev_b32 v29, 16, v29
    v_mul_f32 v29, v29, v17
    v_cvt_pk_bf16_f32 v29, v29, v29
    v_lshlrev_b32 v29, 16, v29
    v_add_f32 v29, v29, v25
    v_mul_f32 v30, 0xbfb8aa3b, v22
    v_exp_f32 v30, v30
    s_nop 0
    v_add_f32 v30, 1.0, v30
    v_rcp_f32 v30, v30
    s_nop 0
    v_mul_f32 v30, v30, v22
    v_cvt_pk_bf16_f32 v30, v30, v30
    v_lshlrev_b32 v30, 16, v30
    v_mul_f32 v30, v30, v18
    v_cvt_pk_bf16_f32 v30, v30, v30
    v_lshlrev_b32 v30, 16, v30
    v_add_f32 v30, v30, v26
    v_mul_f32 v31, 0xbfb8aa3b, v23
    v_exp_f32 v31, v31
    s_nop 0
    v_add_f32 v31, 1.0, v31
    v_rcp_f32 v31, v31
    s_nop 0
    v_mul_f32 v31, v31, v23
    v_cvt_pk_bf16_f32 v31, v31, v31
    v_lshlrev_b32 v31, 16, v31
    v_mul_f32 v31, v31, v19
    v_cvt_pk_bf16_f32 v31, v31, v31
    v_lshlrev_b32 v31, 16, v31
    v_add_f32 v31, v31, v27
    v_cvt_pk_bf16_f32 v164, v28, v29
    v_cvt_pk_bf16_f32 v165, v30, v31
    buffer_store_dwordx2 v[164:165], v5, s[52:55], s67 offen
OTD_157:
    s_branch OU_LOOP
OU_END:
    s_cmp_lg_u32 s12, 2
    s_cbranch_scc1 OU_X
    v_mov_b32 v8, 0
    s_mov_b32 s64, 0x298100
OUW_159:
    buffer_load_dword v7, v8, s[4:7], s64 offen sc1
    s_add_u32 s29, s29, 1
    s_waitcnt vmcnt(0)
    v_cmp_gt_u32 vcc, 40, v7
    s_cbranch_vccz OUWD_160
    s_cmp_gt_u32 s29, 262144
    s_cbranch_scc1 OUWD_160
    s_sleep 8
    s_branch OUW_159
OUWD_160:
    s_mov_b32 s24, 62
    s_mov_b32 s87, 0
    s_and_b32 s86, s14, 1
    s_lshl_b32 s64, s87, 4
    v_and_b32 v6, 15, v0
    v_add_u32 v6, s64, v6
    v_mov_b32 v9, v6
    v_mul_u32_u24 v5, 1280, v6
    v_lshrrev_b32 v6, 4, v0
    v_lshl_add_u32 v5, v6, 3, v5
    s_and_b32 s64, s14, 1
    s_lshl_b32 s64, s64, 5
    s_lshl_b32 s65, s13, 6
    s_add_u32 s64, s64, s65
    v_add_u32 v5, s64, v5
    v_lshlrev_b32 v6, 2, v0
    s_mul_i32 s67, s24, 40960
    buffer_load_dwordx2 v[160:161], v5, s[48:51], s67 offen
    s_add_u32 s64, s67, 0x0
    buffer_load_dwordx2 v[162:163], v5, s[4:7], s64 offen
    s_lshl_b32 s64, s24, 7
    s_add_u32 s64, s64, 0x296000
    s_mov_b64 exec, s[36:37]
OUH_F_161:
    buffer_load_dword v7, v6, s[4:7], s64 offen sc1
    s_add_u32 s29, s29, 1
    s_waitcnt vmcnt(0)
    v_cmp_eq_u32 vcc, 0, v7
    s_cbranch_vccz OUH_FD_162
    s_cmp_gt_u32 s29, 262144
    s_cbranch_scc1 OUH_FD_162
    s_sleep 1
    s_branch OUH_F_161
OUH_FD_162:
    s_mov_b64 exec, -1
    s_lshl_b32 s25, s24, 18
    s_lshl_b32 s64, s14, 15
    s_add_u32 s25, s25, s64
    s_add_u32 s25, s25, 0x4400000
    s_lshl_b32 s64, s87, 17
    s_add_u32 s25, s25, s64
    s_add_u32 s64, s25, 0x0
    buffer_load_dwordx4 v[16:19], v1, s[4:7], s64 offen
    s_add_u32 s64, s25, 0x400
    buffer_load_dwordx4 v[20:23], v1, s[4:7], s64 offen
    s_add_u32 s64, s25, 0x800
    buffer_load_dwordx4 v[24:27], v1, s[4:7], s64 offen
    s_add_u32 s64, s25, 0xc00
    buffer_load_dwordx4 v[28:31], v1, s[4:7], s64 offen
    s_add_u32 s64, s25, 0x1000
    buffer_load_dwordx4 v[32:35], v1, s[4:7], s64 offen
    s_add_u32 s64, s25, 0x1400
    buffer_load_dwordx4 v[36:39], v1, s[4:7], s64 offen
    s_add_u32 s64, s25, 0x1800
    buffer_load_dwordx4 v[40:43], v1, s[4:7], s64 offen
    s_add_u32 s64, s25, 0x1c00
    buffer_load_dwordx4 v[44:47], v1, s[4:7], s64 offen
    s_add_u32 s64, s25, 0x2000
    buffer_load_dwordx4 v[48:51], v1, s[4:7], s64 offen
    s_add_u32 s64, s25, 0x2400
    buffer_load_dwordx4 v[52:55], v1, s[4:7], s64 offen
    s_add_u32 s64, s25, 0x2800
    buffer_load_dwordx4 v[56:59], v1, s[4:7], s64 offen
    s_add_u32 s64, s25, 0x2c00
    buffer_load_dwordx4 v[60:63], v1, s[4:7], s64 offen
    s_add_u32 s64, s25, 0x3000
    buffer_load_dwordx4 v[64:67], v1, s[4:7], s64 offen
    s_add_u32 s64, s25, 0x3400
    buffer_load_dwordx4 v[68:71], v1, s[4:7], s64 offen
    s_add_u32 s64, s25, 0x3800
    buffer_load_dwordx4 v[72:75], v1, s[4:7], s64 offen
    s_add_u32 s64, s25, 0x3c00
    buffer_load_dwordx4 v[76:79], v1, s[4:7], s64 offen
    s_add_u32 s64, s25, 0x4000
    buffer_load_dwordx4 v[80:83], v1, s[4:7], s64 offen
    s_add_u32 s64, s25, 0x4400
    buffer_load_dwordx4 v[84:87], v1, s[4:7], s64 offen
    s_add_u32 s64, s25, 0x4800
    buffer_load_dwordx4 v[88:91], v1, s[4:7], s64 offen
    s_add_u32 s64, s25, 0x4c00
    buffer_load_dwordx4 v[92:95], v1, s[4:7], s64 offen
    s_add_u32 s64, s25, 0x5000
    buffer_load_dwordx4 v[96:99], v1, s[4:7], s64 offen
    s_add_u32 s64, s25, 0x5400
    buffer_load_dwordx4 v[100:103], v1, s[4:7], s64 offen
    s_add_u32 s64, s25, 0x5800
    buffer_load_dwordx4 v[104:107], v1, s[4:7], s64 offen
    s_add_u32 s64, s25, 0x5c00
    buffer_load_dwordx4 v[108:111], v1, s[4:7], s64 offen
    s_add_u32 s64, s25, 0x6000
    buffer_load_dwordx4 v[112:115], v1, s[4:7], s64 offen
    s_add_u32 s64, s25, 0x6400
    buffer_load_dwordx4 v[116:119], v1, s[4:7], s64 offen
    s_add_u32 s64, s25, 0x6800
    buffer_load_dwordx4 v[120:123], v1, s[4:7], s64 offen
    s_add_u32 s64, s25, 0x6c00
    buffer_load_dwordx4 v[124:127], v1, s[4:7], s64 offen
    s_add_u32 s64, s25, 0x7000
    buffer_load_dwordx4 v[128:131], v1, s[4:7], s64 offen
    s_add_u32 s64, s25, 0x7400
    buffer_load_dwordx4 v[132:135], v1, s[4:7], s64 offen
    s_add_u32 s64, s25, 0x7800
    buffer_load_dwordx4 v[136:139], v1, s[4:7], s64 offen
    s_add_u32 s64, s25, 0x7c00
    buffer_load_dwordx4 v[140:143], v1, s[4:7], s64 offen
    s_waitcnt vmcnt(31)
    v_mfma_f32_16x16x32_bf16 v[144:147], a[0:3], v[16:19], 0
    v_mfma_f32_16x16x32_bf16 v[148:151], a[4:7], v[16:19], 0
    s_waitcnt vmcnt(30)
    v_mfma_f32_16x16x32_bf16 v[144:147], a[8:11], v[20:23], v[144:147]
    v_mfma_f32_16x16x32_bf16 v[148:151], a[12:15], v[20:23], v[148:151]
    s_waitcnt vmcnt(29)
    v_mfma_f32_16x16x32_bf16 v[144:147], a[16:19], v[24:27], v[144:147]
    v_mfma_f32_16x16x32_bf16 v[148:151], a[20:23], v[24:27], v[148:151]
    s_waitcnt vmcnt(28)
    v_mfma_f32_16x16x32_bf16 v[144:147], a[24:27], v[28:31], v[144:147]
    v_mfma_f32_16x16x32_bf16 v[148:151], a[28:31], v[28:31], v[148:151]
    s_waitcnt vmcnt(27)
    v_mfma_f32_16x16x32_bf16 v[144:147], a[32:35], v[32:35], v[144:147]
    v_mfma_f32_16x16x32_bf16 v[148:151], a[36:39], v[32:35], v[148:151]
    s_waitcnt vmcnt(26)
    v_mfma_f32_16x16x32_bf16 v[144:147], a[40:43], v[36:39], v[144:147]
    v_mfma_f32_16x16x32_bf16 v[148:151], a[44:47], v[36:39], v[148:151]
    s_waitcnt vmcnt(25)
    v_mfma_f32_16x16x32_bf16 v[144:147], a[48:51], v[40:43], v[144:147]
    v_mfma_f32_16x16x32_bf16 v[148:151], a[52:55], v[40:43], v[148:151]
    s_waitcnt vmcnt(24)
    v_mfma_f32_16x16x32_bf16 v[144:147], a[56:59], v[44:47], v[144:147]
    v_mfma_f32_16x16x32_bf16 v[148:151], a[60:63], v[44:47], v[148:151]
    s_waitcnt vmcnt(23)
    v_mfma_f32_16x16x32_bf16 v[144:147], a[64:67], v[48:51], v[144:147]
    v_mfma_f32_16x16x32_bf16 v[148:151], a[68:71], v[48:51], v[148:151]
    s_waitcnt vmcnt(22)
    v_mfma_f32_16x16x32_bf16 v[144:147], a[72:75], v[52:55], v[144:147]
    v_mfma_f32_16x16x32_bf16 v[148:151], a[76:79], v[52:55], v[148:151]
    s_waitcnt vmcnt(21)
    v_mfma_f32_16x16x32_bf16 v[144:147], a[80:83], v[56:59], v[144:147]
    v_mfma_f32_16x16x32_bf16 v[148:151], a[84:87], v[56:59], v[148:151]
    s_waitcnt vmcnt(20)
    v_mfma_f32_16x16x32_bf16 v[144:147], a[88:91], v[60:63], v[144:147]
    v_mfma_f32_16x16x32_bf16 v[148:151], a[92:95], v[60:63], v[148:151]
    s_waitcnt vmcnt(19)
    v_mfma_f32_16x16x32_bf16 v[144:147], a[96:99], v[64:67], v[144:147]
    v_mfma_f32_16x16x32_bf16 v[148:151], a[100:103], v[64:67], v[148:151]
    s_waitcnt vmcnt(18)
    v_mfma_f32_16x16x32_bf16 v[144:147], a[104:107], v[68:71], v[144:147]
    v_mfma_f32_16x16x32_bf16 v[148:151], a[108:111], v[68:71], v[148:151]
    s_waitcnt vmcnt(17)
    v_mfma_f32_16x16x32_bf16 v[144:147], a[112:115], v[72:75], v[144:147]
    v_mfma_f32_16x16x32_bf16 v[148:151], a[116:119], v[72:75], v[148:151]
    s_waitcnt vmcnt(16)
    v_mfma_f32_16x16x32_bf16 v[144:147], a[120:123], v[76:79], v[144:147]
    v_mfma_f32_16x16x32_bf16 v[148:151], a[124:127], v[76:79], v[148:151]
    s_waitcnt vmcnt(15)
    v_mfma_f32_16x16x32_bf16 v[144:147], a[128:131], v[80:83], v[144:147]
    v_mfma_f32_16x16x32_bf16 v[148:151], a[132:135], v[80:83], v[148:151]
    s_waitcnt vmcnt(14)
    v_mfma_f32_16x16x32_bf16 v[144:147], a[136:139], v[84:87], v[144:147]
    v_mfma_f32_16x16x32_bf16 v[148:151], a[140:143], v[84:87], v[148:151]
    s_waitcnt vmcnt(13)
    v_mfma_f32_16x16x32_bf16 v[144:147], a[144:147], v[88:91], v[144:147]
    v_mfma_f32_16x16x32_bf16 v[148:151], a[148:151], v[88:91], v[148:151]
    s_waitcnt vmcnt(12)
    v_mfma_f32_16x16x32_bf16 v[144:147], a[152:155], v[92:95], v[144:147]
    v_mfma_f32_16x16x32_bf16 v[148:151], a[156:159], v[92:95], v[148:151]
    s_waitcnt vmcnt(11)
    v_mfma_f32_16x16x32_bf16 v[144:147], a[160:163], v[96:99], v[144:147]
    v_mfma_f32_16x16x32_bf16 v[148:151], a[164:167], v[96:99], v[148:151]
    s_waitcnt vmcnt(10)
    v_mfma_f32_16x16x32_bf16 v[144:147], a[168:171], v[100:103], v[144:147]
    v_mfma_f32_16x16x32_bf16 v[148:151], a[172:175], v[100:103], v[148:151]
    s_waitcnt vmcnt(9)
    v_mfma_f32_16x16x32_bf16 v[144:147], a[176:179], v[104:107], v[144:147]
    v_mfma_f32_16x16x32_bf16 v[148:151], a[180:183], v[104:107], v[148:151]
    s_waitcnt vmcnt(8)
    v_mfma_f32_16x16x32_bf16 v[144:147], a[184:187], v[108:111], v[144:147]
    v_mfma_f32_16x16x32_bf16 v[148:151], a[188:191], v[108:111], v[148:151]
    s_waitcnt vmcnt(7)
    v_mfma_f32_16x16x32_bf16 v[144:147], a[192:195], v[112:115], v[144:147]
    v_mfma_f32_16x16x32_bf16 v[148:151], a[196:199], v[112:115], v[148:151]
    s_waitcnt vmcnt(6)
    v_mfma_f32_16x16x32_bf16 v[144:147], a[200:203], v[116:119], v[144:147]
    v_mfma_f32_16x16x32_bf16 v[148:151], a[204:207], v[116:119], v[148:151]
    s_waitcnt vmcnt(5)
    v_mfma_f32_16x16x32_bf16 v[144:147], a[208:211], v[120:123], v[144:147]
    v_mfma_f32_16x16x32_bf16 v[148:151], a[212:215], v[120:123], v[148:151]
    s_waitcnt vmcnt(4)
    v_mfma_f32_16x16x32_bf16 v[144:147], a[216:219], v[124:127], v[144:147]
    v_mfma_f32_16x16x32_bf16 v[148:151], a[220:223], v[124:127], v[148:151]
    s_waitcnt vmcnt(3)
    v_mfma_f32_16x16x32_bf16 v[144:147], a[224:227], v[128:131], v[144:147]
    v_mfma_f32_16x16x32_bf16 v[148:151], a[228:231], v[128:131], v[148:151]
    s_waitcnt vmcnt(2)
    v_mfma_f32_16x16x32_bf16 v[144:147], a[232:235], v[132:135], v[144:147]
    v_mfma_f32_16x16x32_bf16 v[148:151], a[236:239], v[132:135], v[148:151]
    s_waitcnt vmcnt(1)
    v_mfma_f32_16x16x32_bf16 v[144:147], a[240:243], v[136:139], v[144:147]
    v_mfma_f32_16x16x32_bf16 v[148:151], a[244:247], v[136:139], v[148:151]
    s_waitcnt vmcnt(0)
    v_mfma_f32_16x16x32_bf16 v[144:147], a[248:251], v[140:143], v[144:147]
    v_mfma_f32_16x16x32_bf16 v[148:151], a[252:255], v[140:143], v[148:151]
    s_lshl_b32 s64, s14, 12
    v_add_u32 v7, s64, v1
    s_barrier
    s_nop 3
    ds_write_b128 v7, v[144:147] offset:0
    ds_write_b128 v7, v[148:151] offset:1024
    s_waitcnt lgkmcnt(0)
    s_barrier
    s_cmp_ge_u32 s14, 2
    s_cbranch_scc1 OTD_163
    s_lshl_b32 s64, s14, 10
    v_add_u32 v7, s64, v1
    ds_read_b128 v[16:19], v7 offset:0
    ds_read_b128 v[20:23], v7 offset:4096
    ds_read_b128 v[24:27], v7 offset:8192
    ds_read_b128 v[28:31], v7 offset:12288
    s_waitcnt lgkmcnt(0)
    v_add_f32 v16, v16, v20
    v_add_f32 v24, v24, v28
    v_add_f32 v16, v16, v24
    v_add_f32 v17, v17, v21
    v_add_f32 v25, v25, v29
    v_add_f32 v17, v17, v25
    v_add_f32 v18, v18, v22
    v_add_f32 v26, v26, v30
    v_add_f32 v18, v18, v26
    v_add_f32 v19, v19, v23
    v_add_f32 v27, v27, v31
    v_add_f32 v19, v19, v27
    v_cvt_pk_bf16_f32 v16, v16, v16
    v_lshlrev_b32 v16, 16, v16
    v_cvt_pk_bf16_f32 v17, v17, v17
    v_lshlrev_b32 v17, 16, v17
    v_cvt_pk_bf16_f32 v18, v18, v18
    v_lshlrev_b32 v18, 16, v18
    v_cvt_pk_bf16_f32 v19, v19, v19
    v_lshlrev_b32 v19, 16, v19
    v_lshlrev_b32 v20, 16, v162
    v_and_b32 v21, 0xffff0000, v162
    v_lshlrev_b32 v24, 16, v160
    v_and_b32 v25, 0xffff0000, v160
    v_lshlrev_b32 v22, 16, v163
    v_and_b32 v23, 0xffff0000, v163
    v_lshlrev_b32 v26, 16, v161
    v_and_b32 v27, 0xffff0000, v161
    s_lshl_b32 s64, s24, 5
    v_add_u32 v8, s64, v9
    v_mov_b32 v10, -1
    v_cmp_eq_u32 vcc, s72, v8
    s_nop 1
    v_cndmask_b32 v10, v10, 0, vcc
    v_cmp_eq_u32 vcc, s73, v8
    s_nop 1
    v_cndmask_b32 v10, v10, 1, vcc
    v_cmp_eq_u32 vcc, s74, v8
    s_nop 1
    v_cndmask_b32 v10, v10, 2, vcc
    v_cmp_eq_u32 vcc, s75, v8
    s_nop 1
    v_cndmask_b32 v10, v10, 3, vcc
    v_cmp_eq_u32 vcc, s76, v8
    s_nop 1
    v_cndmask_b32 v10, v10, 4, vcc
    v_cmp_eq_u32 vcc, s77, v8
    s_nop 1
    v_cndmask_b32 v10, v10, 5, vcc
    v_cmp_eq_u32 vcc, s78, v8
    s_nop 1
    v_cndmask_b32 v10, v10, 6, vcc
    v_cmp_eq_u32 vcc, s79, v8
    s_nop 1
    v_cndmask_b32 v10, v10, 7, vcc
    v_cmp_le_i32 vcc, 0, v10
    s_and_saveexec_b64 s[68:69], vcc
    s_cbranch_execz NOUPD_164
    v_mul_u32_u24 v10, 2560, v10
    v_lshrrev_b32 v11, 4, v0
    v_lshl_add_u32 v10, v11, 4, v10
    s_lshl_b32 s64, s86, 6
    s_lshl_b32 s65, s13, 7
    s_add_u32 s64, s64, s65
    s_add_u32 s64, s64, 0x5410000
    buffer_load_dwordx4 v[164:167], v10, s[4:7], s64 offen sc1
    s_waitcnt vmcnt(0)
    v_add_f32 v20, v20, v164
    v_cvt_pk_bf16_f32 v20, v20, v20
    v_lshlrev_b32 v20, 16, v20
    v_add_f32 v21, v21, v165
    v_cvt_pk_bf16_f32 v21, v21, v21
    v_lshlrev_b32 v21, 16, v21
    v_add_f32 v22, v22, v166
    v_cvt_pk_bf16_f32 v22, v22, v22
    v_lshlrev_b32 v22, 16, v22
    v_add_f32 v23, v23, v167
    v_cvt_pk_bf16_f32 v23, v23, v23
    v_lshlrev_b32 v23, 16, v23
NOUPD_164:
    s_mov_b64 exec, -1
    v_mul_f32 v28, 0xbfb8aa3b, v20
    v_exp_f32 v28, v28
    s_nop 0
    v_add_f32 v28, 1.0, v28
    v_rcp_f32 v28, v28
    s_nop 0
    v_mul_f32 v28, v28, v20
    v_cvt_pk_bf16_f32 v28, v28, v28
    v_lshlrev_b32 v28, 16, v28
    v_mul_f32 v28, v28, v16
    v_cvt_pk_bf16_f32 v28, v28, v28
    v_lshlrev_b32 v28, 16, v28
    v_add_f32 v28, v28, v24
    v_mul_f32 v29, 0xbfb8aa3b, v21
    v_exp_f32 v29, v29
    s_nop 0
    v_add_f32 v29, 1.0, v29
    v_rcp_f32 v29, v29
    s_nop 0
    v_mul_f32 v29, v29, v21
    v_cvt_pk_bf16_f32 v29, v29, v29
    v_lshlrev_b32 v29, 16, v29
    v_mul_f32 v29, v29, v17
    v_cvt_pk_bf16_f32 v29, v29, v29
    v_lshlrev_b32 v29, 16, v29
    v_add_f32 v29, v29, v25
    v_mul_f32 v30, 0xbfb8aa3b, v22
    v_exp_f32 v30, v30
    s_nop 0
    v_add_f32 v30, 1.0, v30
    v_rcp_f32 v30, v30
    s_nop 0
    v_mul_f32 v30, v30, v22
    v_cvt_pk_bf16_f32 v30, v30, v30
    v_lshlrev_b32 v30, 16, v30
    v_mul_f32 v30, v30, v18
    v_cvt_pk_bf16_f32 v30, v30, v30
    v_lshlrev_b32 v30, 16, v30
    v_add_f32 v30, v30, v26
    v_mul_f32 v31, 0xbfb8aa3b, v23
    v_exp_f32 v31, v31
    s_nop 0
    v_add_f32 v31, 1.0, v31
    v_rcp_f32 v31, v31
    s_nop 0
    v_mul_f32 v31, v31, v23
    v_cvt_pk_bf16_f32 v31, v31, v31
    v_lshlrev_b32 v31, 16, v31
    v_mul_f32 v31, v31, v19
    v_cvt_pk_bf16_f32 v31, v31, v31
    v_lshlrev_b32 v31, 16, v31
    v_add_f32 v31, v31, v27
    v_cvt_pk_bf16_f32 v164, v28, v29
    v_cvt_pk_bf16_f32 v165, v30, v31
    buffer_store_dwordx2 v[164:165], v5, s[52:55], s67 offen
OTD_163:
OU_X:
    s_branch M_EXIT
H_EXTRA:
    s_mul_hi_u32 s12, s88, 0xccccccd
    s_mul_i32 s65, s12, 20
    s_sub_u32 s13, s88, s65
    s_add_u32 s12, s12, 3
    s_load_dwordx2 s[48:49], s[0:1], 0
    s_mov_b32 s50, 0x280000
    s_mov_b32 s51, 0x00020000
    s_load_dwordx2 s[52:53], s[0:1], 96
    s_mov_b32 s54, 0x280000
    s_mov_b32 s55, 0x00020000
    s_mov_b32 s36, -1
    s_mov_b32 s37, 0
    s_waitcnt lgkmcnt(0)
    v_mbcnt_lo_u32_b32 v0, -1, 0
    v_mbcnt_hi_u32_b32 v0, -1, v0
    s_mov_b32 s29, 0
    v_lshlrev_b32 v1, 4, v0
    v_lshlrev_b32 v6, 2, v0
    v_mov_b32 v8, 0
    s_mov_b32 s64, 0x298100
OXW_165:
    buffer_load_dword v7, v8, s[4:7], s64 offen sc1
    s_add_u32 s29, s29, 1
    s_waitcnt vmcnt(0)
    v_cmp_gt_u32 vcc, 40, v7
    s_cbranch_vccz OXWD_166
    s_cmp_gt_u32 s29, 262144
    s_cbranch_scc1 OXWD_166
    s_sleep 8
    s_branch OXW_165
OXWD_166:
    v_lshlrev_b32 v6, 2, v0
    s_mov_b32 s64, 0x5400000
    buffer_load_dword v7, v6, s[4:7], s64 offen sc1
    s_waitcnt vmcnt(0)
    v_readlane_b32 s72, v7, 0
    v_readlane_b32 s73, v7, 1
    v_readlane_b32 s74, v7, 2
    v_readlane_b32 s75, v7, 3
    v_readlane_b32 s76, v7, 4
    v_readlane_b32 s77, v7, 5
    v_readlane_b32 s78, v7, 6
    v_readlane_b32 s79, v7, 7
    s_cmp_eq_u32 s12, 3
    s_cselect_b32 s24, 62, 63
    s_cmp_eq_u32 s12, 4
    s_cselect_b32 s87, 0, 1
    s_and_b32 s86, s14, 1
    s_lshl_b32 s64, s87, 4
    v_and_b32 v6, 15, v0
    v_add_u32 v6, s64, v6
    v_mov_b32 v9, v6
    v_mul_u32_u24 v5, 1280, v6
    v_lshrrev_b32 v6, 4, v0
    v_lshl_add_u32 v5, v6, 3, v5
    s_and_b32 s64, s14, 1
    s_lshl_b32 s64, s64, 5
    s_lshl_b32 s65, s13, 6
    s_add_u32 s64, s64, s65
    v_add_u32 v5, s64, v5
    v_lshlrev_b32 v6, 2, v0
    s_mul_i32 s67, s24, 40960
    buffer_load_dwordx2 v[160:161], v5, s[48:51], s67 offen
    s_add_u32 s64, s67, 0x0
    buffer_load_dwordx2 v[162:163], v5, s[4:7], s64 offen
    s_lshl_b32 s64, s24, 7
    s_add_u32 s64, s64, 0x296000
    s_mov_b64 exec, s[36:37]
OX_F_167:
    buffer_load_dword v7, v6, s[4:7], s64 offen sc1
    s_add_u32 s29, s29, 1
    s_waitcnt vmcnt(0)
    v_cmp_eq_u32 vcc, 0, v7
    s_cbranch_vccz OX_FD_168
    s_cmp_gt_u32 s29, 262144
    s_cbranch_scc1 OX_FD_168
    s_sleep 1
    s_branch OX_F_167
OX_FD_168:
    s_mov_b64 exec, -1
    s_lshl_b32 s25, s24, 18
    s_lshl_b32 s64, s14, 15
    s_add_u32 s25, s25, s64
    s_add_u32 s25, s25, 0x4400000
    s_lshl_b32 s64, s87, 17
    s_add_u32 s25, s25, s64
    s_add_u32 s64, s25, 0x0
    buffer_load_dwordx4 v[16:19], v1, s[4:7], s64 offen
    s_add_u32 s64, s25, 0x400
    buffer_load_dwordx4 v[20:23], v1, s[4:7], s64 offen
    s_add_u32 s64, s25, 0x800
    buffer_load_dwordx4 v[24:27], v1, s[4:7], s64 offen
    s_add_u32 s64, s25, 0xc00
    buffer_load_dwordx4 v[28:31], v1, s[4:7], s64 offen
    s_add_u32 s64, s25, 0x1000
    buffer_load_dwordx4 v[32:35], v1, s[4:7], s64 offen
    s_add_u32 s64, s25, 0x1400
    buffer_load_dwordx4 v[36:39], v1, s[4:7], s64 offen
    s_add_u32 s64, s25, 0x1800
    buffer_load_dwordx4 v[40:43], v1, s[4:7], s64 offen
    s_add_u32 s64, s25, 0x1c00
    buffer_load_dwordx4 v[44:47], v1, s[4:7], s64 offen
    s_add_u32 s64, s25, 0x2000
    buffer_load_dwordx4 v[48:51], v1, s[4:7], s64 offen
    s_add_u32 s64, s25, 0x2400
    buffer_load_dwordx4 v[52:55], v1, s[4:7], s64 offen
    s_add_u32 s64, s25, 0x2800
    buffer_load_dwordx4 v[56:59], v1, s[4:7], s64 offen
    s_add_u32 s64, s25, 0x2c00
    buffer_load_dwordx4 v[60:63], v1, s[4:7], s64 offen
    s_add_u32 s64, s25, 0x3000
    buffer_load_dwordx4 v[64:67], v1, s[4:7], s64 offen
    s_add_u32 s64, s25, 0x3400
    buffer_load_dwordx4 v[68:71], v1, s[4:7], s64 offen
    s_add_u32 s64, s25, 0x3800
    buffer_load_dwordx4 v[72:75], v1, s[4:7], s64 offen
    s_add_u32 s64, s25, 0x3c00
    buffer_load_dwordx4 v[76:79], v1, s[4:7], s64 offen
    s_add_u32 s64, s25, 0x4000
    buffer_load_dwordx4 v[80:83], v1, s[4:7], s64 offen
    s_add_u32 s64, s25, 0x4400
    buffer_load_dwordx4 v[84:87], v1, s[4:7], s64 offen
    s_add_u32 s64, s25, 0x4800
    buffer_load_dwordx4 v[88:91], v1, s[4:7], s64 offen
    s_add_u32 s64, s25, 0x4c00
    buffer_load_dwordx4 v[92:95], v1, s[4:7], s64 offen
    s_add_u32 s64, s25, 0x5000
    buffer_load_dwordx4 v[96:99], v1, s[4:7], s64 offen
    s_add_u32 s64, s25, 0x5400
    buffer_load_dwordx4 v[100:103], v1, s[4:7], s64 offen
    s_add_u32 s64, s25, 0x5800
    buffer_load_dwordx4 v[104:107], v1, s[4:7], s64 offen
    s_add_u32 s64, s25, 0x5c00
    buffer_load_dwordx4 v[108:111], v1, s[4:7], s64 offen
    s_add_u32 s64, s25, 0x6000
    buffer_load_dwordx4 v[112:115], v1, s[4:7], s64 offen
    s_add_u32 s64, s25, 0x6400
    buffer_load_dwordx4 v[116:119], v1, s[4:7], s64 offen
    s_add_u32 s64, s25, 0x6800
    buffer_load_dwordx4 v[120:123], v1, s[4:7], s64 offen
    s_add_u32 s64, s25, 0x6c00
    buffer_load_dwordx4 v[124:127], v1, s[4:7], s64 offen
    s_add_u32 s64, s25, 0x7000
    buffer_load_dwordx4 v[128:131], v1, s[4:7], s64 offen
    s_add_u32 s64, s25, 0x7400
    buffer_load_dwordx4 v[132:135], v1, s[4:7], s64 offen
    s_add_u32 s64, s25, 0x7800
    buffer_load_dwordx4 v[136:139], v1, s[4:7], s64 offen
    s_add_u32 s64, s25, 0x7c00
    buffer_load_dwordx4 v[140:143], v1, s[4:7], s64 offen
    s_waitcnt vmcnt(31)
    v_mfma_f32_16x16x32_bf16 v[144:147], a[0:3], v[16:19], 0
    v_mfma_f32_16x16x32_bf16 v[148:151], a[4:7], v[16:19], 0
    s_waitcnt vmcnt(30)
    v_mfma_f32_16x16x32_bf16 v[144:147], a[8:11], v[20:23], v[144:147]
    v_mfma_f32_16x16x32_bf16 v[148:151], a[12:15], v[20:23], v[148:151]
    s_waitcnt vmcnt(29)
    v_mfma_f32_16x16x32_bf16 v[144:147], a[16:19], v[24:27], v[144:147]
    v_mfma_f32_16x16x32_bf16 v[148:151], a[20:23], v[24:27], v[148:151]
    s_waitcnt vmcnt(28)
    v_mfma_f32_16x16x32_bf16 v[144:147], a[24:27], v[28:31], v[144:147]
    v_mfma_f32_16x16x32_bf16 v[148:151], a[28:31], v[28:31], v[148:151]
    s_waitcnt vmcnt(27)
    v_mfma_f32_16x16x32_bf16 v[144:147], a[32:35], v[32:35], v[144:147]
    v_mfma_f32_16x16x32_bf16 v[148:151], a[36:39], v[32:35], v[148:151]
    s_waitcnt vmcnt(26)
    v_mfma_f32_16x16x32_bf16 v[144:147], a[40:43], v[36:39], v[144:147]
    v_mfma_f32_16x16x32_bf16 v[148:151], a[44:47], v[36:39], v[148:151]
    s_waitcnt vmcnt(25)
    v_mfma_f32_16x16x32_bf16 v[144:147], a[48:51], v[40:43], v[144:147]
    v_mfma_f32_16x16x32_bf16 v[148:151], a[52:55], v[40:43], v[148:151]
    s_waitcnt vmcnt(24)
    v_mfma_f32_16x16x32_bf16 v[144:147], a[56:59], v[44:47], v[144:147]
    v_mfma_f32_16x16x32_bf16 v[148:151], a[60:63], v[44:47], v[148:151]
    s_waitcnt vmcnt(23)
    v_mfma_f32_16x16x32_bf16 v[144:147], a[64:67], v[48:51], v[144:147]
    v_mfma_f32_16x16x32_bf16 v[148:151], a[68:71], v[48:51], v[148:151]
    s_waitcnt vmcnt(22)
    v_mfma_f32_16x16x32_bf16 v[144:147], a[72:75], v[52:55], v[144:147]
    v_mfma_f32_16x16x32_bf16 v[148:151], a[76:79], v[52:55], v[148:151]
    s_waitcnt vmcnt(21)
    v_mfma_f32_16x16x32_bf16 v[144:147], a[80:83], v[56:59], v[144:147]
    v_mfma_f32_16x16x32_bf16 v[148:151], a[84:87], v[56:59], v[148:151]
    s_waitcnt vmcnt(20)
    v_mfma_f32_16x16x32_bf16 v[144:147], a[88:91], v[60:63], v[144:147]
    v_mfma_f32_16x16x32_bf16 v[148:151], a[92:95], v[60:63], v[148:151]
    s_waitcnt vmcnt(19)
    v_mfma_f32_16x16x32_bf16 v[144:147], a[96:99], v[64:67], v[144:147]
    v_mfma_f32_16x16x32_bf16 v[148:151], a[100:103], v[64:67], v[148:151]
    s_waitcnt vmcnt(18)
    v_mfma_f32_16x16x32_bf16 v[144:147], a[104:107], v[68:71], v[144:147]
    v_mfma_f32_16x16x32_bf16 v[148:151], a[108:111], v[68:71], v[148:151]
    s_waitcnt vmcnt(17)
    v_mfma_f32_16x16x32_bf16 v[144:147], a[112:115], v[72:75], v[144:147]
    v_mfma_f32_16x16x32_bf16 v[148:151], a[116:119], v[72:75], v[148:151]
    s_waitcnt vmcnt(16)
    v_mfma_f32_16x16x32_bf16 v[144:147], a[120:123], v[76:79], v[144:147]
    v_mfma_f32_16x16x32_bf16 v[148:151], a[124:127], v[76:79], v[148:151]
    s_waitcnt vmcnt(15)
    v_mfma_f32_16x16x32_bf16 v[144:147], a[128:131], v[80:83], v[144:147]
    v_mfma_f32_16x16x32_bf16 v[148:151], a[132:135], v[80:83], v[148:151]
    s_waitcnt vmcnt(14)
    v_mfma_f32_16x16x32_bf16 v[144:147], a[136:139], v[84:87], v[144:147]
    v_mfma_f32_16x16x32_bf16 v[148:151], a[140:143], v[84:87], v[148:151]
    s_waitcnt vmcnt(13)
    v_mfma_f32_16x16x32_bf16 v[144:147], a[144:147], v[88:91], v[144:147]
    v_mfma_f32_16x16x32_bf16 v[148:151], a[148:151], v[88:91], v[148:151]
    s_waitcnt vmcnt(12)
    v_mfma_f32_16x16x32_bf16 v[144:147], a[152:155], v[92:95], v[144:147]
    v_mfma_f32_16x16x32_bf16 v[148:151], a[156:159], v[92:95], v[148:151]
    s_waitcnt vmcnt(11)
    v_mfma_f32_16x16x32_bf16 v[144:147], a[160:163], v[96:99], v[144:147]
    v_mfma_f32_16x16x32_bf16 v[148:151], a[164:167], v[96:99], v[148:151]
    s_waitcnt vmcnt(10)
    v_mfma_f32_16x16x32_bf16 v[144:147], a[168:171], v[100:103], v[144:147]
    v_mfma_f32_16x16x32_bf16 v[148:151], a[172:175], v[100:103], v[148:151]
    s_waitcnt vmcnt(9)
    v_mfma_f32_16x16x32_bf16 v[144:147], a[176:179], v[104:107], v[144:147]
    v_mfma_f32_16x16x32_bf16 v[148:151], a[180:183], v[104:107], v[148:151]
    s_waitcnt vmcnt(8)
    v_mfma_f32_16x16x32_bf16 v[144:147], a[184:187], v[108:111], v[144:147]
    v_mfma_f32_16x16x32_bf16 v[148:151], a[188:191], v[108:111], v[148:151]
    s_waitcnt vmcnt(7)
    v_mfma_f32_16x16x32_bf16 v[144:147], a[192:195], v[112:115], v[144:147]
    v_mfma_f32_16x16x32_bf16 v[148:151], a[196:199], v[112:115], v[148:151]
    s_waitcnt vmcnt(6)
    v_mfma_f32_16x16x32_bf16 v[144:147], a[200:203], v[116:119], v[144:147]
    v_mfma_f32_16x16x32_bf16 v[148:151], a[204:207], v[116:119], v[148:151]
    s_waitcnt vmcnt(5)
    v_mfma_f32_16x16x32_bf16 v[144:147], a[208:211], v[120:123], v[144:147]
    v_mfma_f32_16x16x32_bf16 v[148:151], a[212:215], v[120:123], v[148:151]
    s_waitcnt vmcnt(4)
    v_mfma_f32_16x16x32_bf16 v[144:147], a[216:219], v[124:127], v[144:147]
    v_mfma_f32_16x16x32_bf16 v[148:151], a[220:223], v[124:127], v[148:151]
    s_waitcnt vmcnt(3)
    v_mfma_f32_16x16x32_bf16 v[144:147], a[224:227], v[128:131], v[144:147]
    v_mfma_f32_16x16x32_bf16 v[148:151], a[228:231], v[128:131], v[148:151]
    s_waitcnt vmcnt(2)
    v_mfma_f32_16x16x32_bf16 v[144:147], a[232:235], v[132:135], v[144:147]
    v_mfma_f32_16x16x32_bf16 v[148:151], a[236:239], v[132:135], v[148:151]
    s_waitcnt vmcnt(1)
    v_mfma_f32_16x16x32_bf16 v[144:147], a[240:243], v[136:139], v[144:147]
    v_mfma_f32_16x16x32_bf16 v[148:151], a[244:247], v[136:139], v[148:151]
    s_waitcnt vmcnt(0)
    v_mfma_f32_16x16x32_bf16 v[144:147], a[248:251], v[140:143], v[144:147]
    v_mfma_f32_16x16x32_bf16 v[148:151], a[252:255], v[140:143], v[148:151]
    s_lshl_b32 s64, s14, 12
    v_add_u32 v7, s64, v1
    s_barrier
    s_nop 3
    ds_write_b128 v7, v[144:147] offset:0
    ds_write_b128 v7, v[148:151] offset:1024
    s_waitcnt lgkmcnt(0)
    s_barrier
    s_cmp_ge_u32 s14, 2
    s_cbranch_scc1 OTD_169
    s_lshl_b32 s64, s14, 10
    v_add_u32 v7, s64, v1
    ds_read_b128 v[16:19], v7 offset:0
    ds_read_b128 v[20:23], v7 offset:4096
    ds_read_b128 v[24:27], v7 offset:8192
    ds_read_b128 v[28:31], v7 offset:12288
    s_waitcnt lgkmcnt(0)
    v_add_f32 v16, v16, v20
    v_add_f32 v24, v24, v28
    v_add_f32 v16, v16, v24
    v_add_f32 v17, v17, v21
    v_add_f32 v25, v25, v29
    v_add_f32 v17, v17, v25
    v_add_f32 v18, v18, v22
    v_add_f32 v26, v26, v30
    v_add_f32 v18, v18, v26
    v_add_f32 v19, v19, v23
    v_add_f32 v27, v27, v31
    v_add_f32 v19, v19, v27
    v_cvt_pk_bf16_f32 v16, v16, v16
    v_lshlrev_b32 v16, 16, v16
    v_cvt_pk_bf16_f32 v17, v17, v17
    v_lshlrev_b32 v17, 16, v17
    v_cvt_pk_bf16_f32 v18, v18, v18
    v_lshlrev_b32 v18, 16, v18
    v_cvt_pk_bf16_f32 v19, v19, v19
    v_lshlrev_b32 v19, 16, v19
    v_lshlrev_b32 v20, 16, v162
    v_and_b32 v21, 0xffff0000, v162
    v_lshlrev_b32 v24, 16, v160
    v_and_b32 v25, 0xffff0000, v160
    v_lshlrev_b32 v22, 16, v163
    v_and_b32 v23, 0xffff0000, v163
    v_lshlrev_b32 v26, 16, v161
    v_and_b32 v27, 0xffff0000, v161
    s_lshl_b32 s64, s24, 5
    v_add_u32 v8, s64, v9
    v_mov_b32 v10, -1
    v_cmp_eq_u32 vcc, s72, v8
    s_nop 1
    v_cndmask_b32 v10, v10, 0, vcc
    v_cmp_eq_u32 vcc, s73, v8
    s_nop 1
    v_cndmask_b32 v10, v10, 1, vcc
    v_cmp_eq_u32 vcc, s74, v8
    s_nop 1
    v_cndmask_b32 v10, v10, 2, vcc
    v_cmp_eq_u32 vcc, s75, v8
    s_nop 1
    v_cndmask_b32 v10, v10, 3, vcc
    v_cmp_eq_u32 vcc, s76, v8
    s_nop 1
    v_cndmask_b32 v10, v10, 4, vcc
    v_cmp_eq_u32 vcc, s77, v8
    s_nop 1
    v_cndmask_b32 v10, v10, 5, vcc
    v_cmp_eq_u32 vcc, s78, v8
    s_nop 1
    v_cndmask_b32 v10, v10, 6, vcc
    v_cmp_eq_u32 vcc, s79, v8
    s_nop 1
    v_cndmask_b32 v10, v10, 7, vcc
    v_cmp_le_i32 vcc, 0, v10
    s_and_saveexec_b64 s[68:69], vcc
    s_cbranch_execz NOUPD_170
    v_mul_u32_u24 v10, 2560, v10
    v_lshrrev_b32 v11, 4, v0
    v_lshl_add_u32 v10, v11, 4, v10
    s_lshl_b32 s64, s86, 6
    s_lshl_b32 s65, s13, 7
    s_add_u32 s64, s64, s65
    s_add_u32 s64, s64, 0x5410000
    buffer_load_dwordx4 v[164:167], v10, s[4:7], s64 offen sc1
    s_waitcnt vmcnt(0)
    v_add_f32 v20, v20, v164
    v_cvt_pk_bf16_f32 v20, v20, v20
    v_lshlrev_b32 v20, 16, v20
    v_add_f32 v21, v21, v165
    v_cvt_pk_bf16_f32 v21, v21, v21
    v_lshlrev_b32 v21, 16, v21
    v_add_f32 v22, v22, v166
    v_cvt_pk_bf16_f32 v22, v22, v22
    v_lshlrev_b32 v22, 16, v22
    v_add_f32 v23, v23, v167
    v_cvt_pk_bf16_f32 v23, v23, v23
    v_lshlrev_b32 v23, 16, v23
NOUPD_170:
    s_mov_b64 exec, -1
    v_mul_f32 v28, 0xbfb8aa3b, v20
    v_exp_f32 v28, v28
    s_nop 0
    v_add_f32 v28, 1.0, v28
    v_rcp_f32 v28, v28
    s_nop 0
    v_mul_f32 v28, v28, v20
    v_cvt_pk_bf16_f32 v28, v28, v28
    v_lshlrev_b32 v28, 16, v28
    v_mul_f32 v28, v28, v16
    v_cvt_pk_bf16_f32 v28, v28, v28
    v_lshlrev_b32 v28, 16, v28
    v_add_f32 v28, v28, v24
    v_mul_f32 v29, 0xbfb8aa3b, v21
    v_exp_f32 v29, v29
    s_nop 0
    v_add_f32 v29, 1.0, v29
    v_rcp_f32 v29, v29
    s_nop 0
    v_mul_f32 v29, v29, v21
    v_cvt_pk_bf16_f32 v29, v29, v29
    v_lshlrev_b32 v29, 16, v29
    v_mul_f32 v29, v29, v17
    v_cvt_pk_bf16_f32 v29, v29, v29
    v_lshlrev_b32 v29, 16, v29
    v_add_f32 v29, v29, v25
    v_mul_f32 v30, 0xbfb8aa3b, v22
    v_exp_f32 v30, v30
    s_nop 0
    v_add_f32 v30, 1.0, v30
    v_rcp_f32 v30, v30
    s_nop 0
    v_mul_f32 v30, v30, v22
    v_cvt_pk_bf16_f32 v30, v30, v30
    v_lshlrev_b32 v30, 16, v30
    v_mul_f32 v30, v30, v18
    v_cvt_pk_bf16_f32 v30, v30, v30
    v_lshlrev_b32 v30, 16, v30
    v_add_f32 v30, v30, v26
    v_mul_f32 v31, 0xbfb8aa3b, v23
    v_exp_f32 v31, v31
    s_nop 0
    v_add_f32 v31, 1.0, v31
    v_rcp_f32 v31, v31
    s_nop 0
    v_mul_f32 v31, v31, v23
    v_cvt_pk_bf16_f32 v31, v31, v31
    v_lshlrev_b32 v31, 16, v31
    v_mul_f32 v31, v31, v19
    v_cvt_pk_bf16_f32 v31, v31, v31
    v_lshlrev_b32 v31, 16, v31
    v_add_f32 v31, v31, v27
    v_cvt_pk_bf16_f32 v164, v28, v29
    v_cvt_pk_bf16_f32 v165, v30, v31
    buffer_store_dwordx2 v[164:165], v5, s[52:55], s67 offen
OTD_169:
    s_branch M_EXIT
H_Q:
    s_mov_b32 s29, 0
    v_lshlrev_b32 v1, 4, v0
    v_lshrrev_b32 v5, 4, v0
    v_lshlrev_b32 v2, 7, v5
    v_and_b32 v5, 7, v0
    v_lshl_add_u32 v2, v5, 4, v2
    v_bfe_u32 v5, v0, 4, 1
    v_lshlrev_b32 v3, 7, v5
    v_and_b32 v5, 15, v0
    v_lshl_add_u32 v3, v5, 3, v3
    s_mov_b32 s34, 0x3e0293ee
    s_mov_b32 s35, 0x3e0293ee
    s_mov_b32 s36, -1
    s_mov_b32 s37, 0
    v_lshrrev_b32 v5, 4, v0
    v_lshlrev_b32 v5, 2, v5
    v_and_b32 v6, 15, v0
    v_add_u32 v7, 0, v5
    v_cmp_le_u32 s[38:39], v7, v6
    v_add_u32 v7, 1, v5
    v_cmp_le_u32 s[40:41], v7, v6
    v_add_u32 v7, 2, v5
    v_cmp_le_u32 s[42:43], v7, v6
    v_add_u32 v7, 3, v5
    v_cmp_le_u32 s[44:45], v7, v6
    v_mov_b32 v248, 0x3f803f80
    v_mov_b32 v249, 0x3f803f80
    v_mov_b32 v250, 0x3f803f80
    v_mov_b32 v251, 0x3f803f80
    s_lshl_b32 s24, s12, 2
    s_add_u32 s24, s24, s14
    s_mov_b32 s25, 0
AT0_LOOP:
    s_cmp_eq_u32 s24, 63
    s_cbranch_scc1 AT0_END
    s_lshl_b32 s64, s24, 5
    s_add_u32 s64, s64, s13
    s_lshl_b32 s26, s64, 13
    s_add_u32 s26, s26, 0x3400000
    s_lshl_b32 s27, s64, 14
    s_add_u32 s27, s27, 0x1400000
    s_lshl_b32 s65, s64, 11
    s_add_u32 s30, s65, 0x640000
    s_add_u32 s31, s65, 0xa40000
    s_lshl_b32 s33, s64, 2
    s_add_u32 s33, s33, 0x296000
    s_lshl_b32 s32, s24, 18
    s_lshl_b32 s65, s13, 12
    s_add_u32 s32, s32, s65
    s_add_u32 s32, s32, 0x4400000
    s_lshr_b32 s65, s24, 2
    s_lshl_b32 s65, s65, 9
    s_lshl_b32 s66, s13, 4
    s_add_u32 s65, s65, s66
    s_add_u32 s65, s65, 0x291000
    s_lshr_b32 s66, s24, 1
    s_lshl_b32 s66, s66, 8
    s_lshl_b32 s64, s13, 3
    s_add_u32 s66, s66, s64
    s_add_u32 s66, s66, 0x293ff4
    v_lshlrev_b32 v5, 2, v0
    v_mov_b32 v6, s65
    v_mov_b32 v7, s66
    v_cmp_gt_u32 vcc, 3, v0
    s_nop 1
    v_cndmask_b32 v6, v7, v6, vcc
    v_add_u32 v4, v5, v6
    s_mov_b32 s64, 0
    s_mov_b64 exec, 7
AT0_F_171:
    buffer_load_dword v5, v4, s[4:7], s64 offen sc1
    s_add_u32 s29, s29, 1
    s_waitcnt vmcnt(0)
    v_cmp_eq_u32 vcc, 0, v5
    s_cbranch_vccz AT0_FD_172
    s_cmp_gt_u32 s29, 262144
    s_cbranch_scc1 AT0_FD_172
    s_sleep 1
    s_branch AT0_F_171
AT0_FD_172:
    s_mov_b64 exec, -1
    buffer_load_dwordx4 v[16:19], v1, s[4:7], s26 offen offset:0
    buffer_load_dwordx4 v[20:23], v1, s[4:7], s26 offen offset:1024
    buffer_load_dwordx4 v[24:27], v1, s[4:7], s26 offen offset:2048
    buffer_load_dwordx4 v[28:31], v1, s[4:7], s26 offen offset:3072
    s_add_u32 s26, s26, 4096
    buffer_load_dwordx4 v[32:35], v1, s[4:7], s26 offen offset:0
    buffer_load_dwordx4 v[36:39], v1, s[4:7], s26 offen offset:1024
    buffer_load_dwordx4 v[40:43], v1, s[4:7], s26 offen offset:2048
    buffer_load_dwordx4 v[44:47], v1, s[4:7], s26 offen offset:3072
    buffer_load_dwordx4 v[48:51], v1, s[4:7], s27 offen offset:0
    buffer_load_dwordx4 v[52:55], v1, s[4:7], s27 offen offset:1024
    buffer_load_dwordx4 v[56:59], v1, s[4:7], s27 offen offset:2048
    buffer_load_dwordx4 v[60:63], v1, s[4:7], s27 offen offset:3072
    s_add_u32 s27, s27, 4096
    buffer_load_dwordx4 v[64:67], v1, s[4:7], s27 offen offset:0
    buffer_load_dwordx4 v[68:71], v1, s[4:7], s27 offen offset:1024
    buffer_load_dwordx4 v[72:75], v1, s[4:7], s27 offen offset:2048
    buffer_load_dwordx4 v[76:79], v1, s[4:7], s27 offen offset:3072
    s_add_u32 s27, s27, 4096
    buffer_load_dwordx4 v[80:83], v1, s[4:7], s27 offen offset:0
    buffer_load_dwordx4 v[84:87], v1, s[4:7], s27 offen offset:1024
    buffer_load_dwordx4 v[88:91], v1, s[4:7], s27 offen offset:2048
    buffer_load_dwordx4 v[92:95], v1, s[4:7], s27 offen offset:3072
    s_add_u32 s27, s27, 4096
    buffer_load_dwordx4 v[96:99], v1, s[4:7], s27 offen offset:0
    buffer_load_dwordx4 v[100:103], v1, s[4:7], s27 offen offset:1024
    buffer_load_dwordx4 v[104:107], v1, s[4:7], s27 offen offset:2048
    buffer_load_dwordx4 v[108:111], v1, s[4:7], s27 offen offset:3072
    s_mov_b64 exec, 0x18
AT0_G_173:
    buffer_load_dword v5, v4, s[4:7], s64 offen sc1
    s_add_u32 s29, s29, 1
    s_waitcnt vmcnt(0)
    v_cmp_eq_u32 vcc, 0, v5
    s_cbranch_vccz AT0_GD_174
    s_cmp_gt_u32 s29, 262144
    s_cbranch_scc1 AT0_GD_174
    s_sleep 1
    s_branch AT0_G_173
AT0_GD_174:
    s_mov_b64 exec, -1
    buffer_load_dwordx4 v[112:115], v2, s[4:7], s30 offen offset:0
    buffer_load_dwordx4 v[116:119], v2, s[4:7], s30 offen offset:512
    buffer_load_dwordx4 v[120:123], v2, s[4:7], s30 offen offset:1024
    buffer_load_dwordx4 v[124:127], v2, s[4:7], s30 offen offset:1536
    buffer_load_dwordx2 v[128:129], v3, s[4:7], s31 offen offset:0
    buffer_load_dwordx2 v[130:131], v3, s[4:7], s31 offen offset:256
    buffer_load_dwordx2 v[132:133], v3, s[4:7], s31 offen offset:512
    buffer_load_dwordx2 v[134:135], v3, s[4:7], s31 offen offset:768
    buffer_load_dwordx2 v[136:137], v3, s[4:7], s31 offen offset:1024
    buffer_load_dwordx2 v[138:139], v3, s[4:7], s31 offen offset:1280
    buffer_load_dwordx2 v[140:141], v3, s[4:7], s31 offen offset:1536
    buffer_load_dwordx2 v[142:143], v3, s[4:7], s31 offen offset:1792
    v_mfma_f32_16x16x32_bf16 v[148:151], v[48:51], v[16:19], 0
    v_mfma_f32_16x16x32_bf16 v[156:159], v[48:51], v[32:35], 0
    v_mfma_f32_16x16x32_bf16 v[160:163], v[64:67], v[32:35], 0
    v_mfma_f32_16x16x32_bf16 v[148:151], v[52:55], v[20:23], v[148:151]
    v_mfma_f32_16x16x32_bf16 v[156:159], v[52:55], v[36:39], v[156:159]
    v_mfma_f32_16x16x32_bf16 v[160:163], v[68:71], v[36:39], v[160:163]
    v_mfma_f32_16x16x32_bf16 v[148:151], v[56:59], v[24:27], v[148:151]
    v_mfma_f32_16x16x32_bf16 v[156:159], v[56:59], v[40:43], v[156:159]
    v_mfma_f32_16x16x32_bf16 v[160:163], v[72:75], v[40:43], v[160:163]
    v_mfma_f32_16x16x32_bf16 v[148:151], v[60:63], v[28:31], v[148:151]
    v_mfma_f32_16x16x32_bf16 v[156:159], v[60:63], v[44:47], v[156:159]
    v_mfma_f32_16x16x32_bf16 v[160:163], v[76:79], v[44:47], v[160:163]
    s_waitcnt vmcnt(8)
    v_mfma_f32_16x16x32_bf16 v[144:147], v[112:115], v[16:19], 0
    v_mfma_f32_16x16x32_bf16 v[152:155], v[112:115], v[32:35], 0
    v_mfma_f32_16x16x32_bf16 v[144:147], v[116:119], v[20:23], v[144:147]
    v_mfma_f32_16x16x32_bf16 v[152:155], v[116:119], v[36:39], v[152:155]
    v_mfma_f32_16x16x32_bf16 v[144:147], v[120:123], v[24:27], v[144:147]
    v_mfma_f32_16x16x32_bf16 v[152:155], v[120:123], v[40:43], v[152:155]
    v_mfma_f32_16x16x32_bf16 v[144:147], v[124:127], v[28:31], v[144:147]
    v_mfma_f32_16x16x32_bf16 v[152:155], v[124:127], v[44:47], v[152:155]
    v_mov_b32 v11, 0xff800000
    s_nop 7
    v_cndmask_b32 v148, v11, v148, s[38:39]
    v_cndmask_b32 v160, v11, v160, s[38:39]
    v_cndmask_b32 v144, v11, v144, s[36:37]
    v_cndmask_b32 v152, v11, v152, s[36:37]
    v_cndmask_b32 v149, v11, v149, s[40:41]
    v_cndmask_b32 v161, v11, v161, s[40:41]
    v_cndmask_b32 v145, v11, v145, s[36:37]
    v_cndmask_b32 v153, v11, v153, s[36:37]
    v_cndmask_b32 v150, v11, v150, s[42:43]
    v_cndmask_b32 v162, v11, v162, s[42:43]
    v_cndmask_b32 v146, v11, v146, s[36:37]
    v_cndmask_b32 v154, v11, v154, s[36:37]
    v_cndmask_b32 v151, v11, v151, s[44:45]
    v_cndmask_b32 v163, v11, v163, s[44:45]
    v_cndmask_b32 v147, v11, v147, s[36:37]
    v_cndmask_b32 v155, v11, v155, s[36:37]
    v_max3_f32 v8, v144, v145, v146
    v_max3_f32 v8, v8, v147, v148
    v_max3_f32 v8, v8, v149, v150
    v_max_f32 v8, v8, v151
    v_mov_b32 v9, v8
    s_nop 1
    v_permlane16_swap_b32 v8, v9
    v_max_f32 v8, v8, v9
    v_mov_b32 v9, v8
    s_nop 1
    v_permlane32_swap_b32 v8, v9
    v_max_f32 v8, v8, v9
    v_mul_f32 v8, s34, v8
    v_fma_f32 v144, v144, s34, -v8
    v_fma_f32 v145, v145, s34, -v8
    v_fma_f32 v146, v146, s34, -v8
    v_fma_f32 v147, v147, s34, -v8
    v_fma_f32 v148, v148, s34, -v8
    v_fma_f32 v149, v149, s34, -v8
    v_fma_f32 v150, v150, s34, -v8
    v_fma_f32 v151, v151, s34, -v8
    v_exp_f32 v144, v144
    v_exp_f32 v145, v145
    v_exp_f32 v146, v146
    v_exp_f32 v147, v147
    v_exp_f32 v148, v148
    v_exp_f32 v149, v149
    v_exp_f32 v150, v150
    v_exp_f32 v151, v151
    s_nop 0
    v_cvt_pk_bf16_f32 v164, v148, v149
    v_cvt_pk_bf16_f32 v165, v150, v151
    v_mov_b32 v166, 0
    v_mov_b32 v167, 0
    v_cvt_pk_bf16_f32 v168, v144, v145
    v_cvt_pk_bf16_f32 v169, v146, v147
    v_max3_f32 v8, v152, v153, v154
    v_max3_f32 v8, v8, v155, v156
    v_max3_f32 v8, v8, v157, v158
    v_max3_f32 v8, v8, v159, v160
    v_max3_f32 v8, v8, v161, v162
    v_max_f32 v8, v8, v163
    v_mov_b32 v9, v8
    s_nop 1
    v_permlane16_swap_b32 v8, v9
    v_max_f32 v8, v8, v9
    v_mov_b32 v9, v8
    s_nop 1
    v_permlane32_swap_b32 v8, v9
    v_max_f32 v8, v8, v9
    v_mul_f32 v8, s34, v8
    v_fma_f32 v152, v152, s34, -v8
    v_fma_f32 v153, v153, s34, -v8
    v_fma_f32 v154, v154, s34, -v8
    v_fma_f32 v155, v155, s34, -v8
    v_fma_f32 v156, v156, s34, -v8
    v_fma_f32 v157, v157, s34, -v8
    v_fma_f32 v158, v158, s34, -v8
    v_fma_f32 v159, v159, s34, -v8
    v_fma_f32 v160, v160, s34, -v8
    v_fma_f32 v161, v161, s34, -v8
    v_fma_f32 v162, v162, s34, -v8
    v_fma_f32 v163, v163, s34, -v8
    v_exp_f32 v152, v152
    v_exp_f32 v153, v153
    v_exp_f32 v154, v154
    v_exp_f32 v155, v155
    v_exp_f32 v156, v156
    v_exp_f32 v157, v157
    v_exp_f32 v158, v158
    v_exp_f32 v159, v159
    v_exp_f32 v160, v160
    v_exp_f32 v161, v161
    v_exp_f32 v162, v162
    v_exp_f32 v163, v163
    s_nop 0
    v_cvt_pk_bf16_f32 v170, v156, v157
    v_cvt_pk_bf16_f32 v171, v158, v159
    v_cvt_pk_bf16_f32 v172, v160, v161
    v_cvt_pk_bf16_f32 v173, v162, v163
    v_cvt_pk_bf16_f32 v174, v152, v153
    v_cvt_pk_bf16_f32 v175, v154, v155
    s_waitcnt vmcnt(0)
    v_mfma_f32_16x16x32_bf16 v[240:243], v[248:251], v[164:167], 0
    v_mfma_f32_16x16x32_bf16 v[244:247], v[248:251], v[170:173], 0
    v_mfma_f32_16x16x32_bf16 v[176:179], v[80:83], v[164:167], 0
    v_mfma_f32_16x16x32_bf16 v[180:183], v[80:83], v[170:173], 0
    v_mfma_f32_16x16x32_bf16 v[184:187], v[84:87], v[164:167], 0
    v_mfma_f32_16x16x32_bf16 v[188:191], v[84:87], v[170:173], 0
    v_mfma_f32_16x16x32_bf16 v[192:195], v[88:91], v[164:167], 0
    v_mfma_f32_16x16x32_bf16 v[196:199], v[88:91], v[170:173], 0
    v_mfma_f32_16x16x32_bf16 v[200:203], v[92:95], v[164:167], 0
    v_mfma_f32_16x16x32_bf16 v[204:207], v[92:95], v[170:173], 0
    v_mfma_f32_16x16x32_bf16 v[208:211], v[96:99], v[164:167], 0
    v_mfma_f32_16x16x32_bf16 v[212:215], v[96:99], v[170:173], 0
    v_mfma_f32_16x16x32_bf16 v[216:219], v[100:103], v[164:167], 0
    v_mfma_f32_16x16x32_bf16 v[220:223], v[100:103], v[170:173], 0
    v_mfma_f32_16x16x32_bf16 v[224:227], v[104:107], v[164:167], 0
    v_mfma_f32_16x16x32_bf16 v[228:231], v[104:107], v[170:173], 0
    v_mfma_f32_16x16x32_bf16 v[232:235], v[108:111], v[164:167], 0
    v_mfma_f32_16x16x32_bf16 v[236:239], v[108:111], v[170:173], 0
    v_mfma_f32_16x16x16_bf16 v[240:243], v[248:249], v[168:169], v[240:243]
    v_mfma_f32_16x16x16_bf16 v[244:247], v[248:249], v[174:175], v[244:247]
    v_mfma_f32_16x16x16_bf16 v[176:179], v[128:129], v[168:169], v[176:179]
    v_mfma_f32_16x16x16_bf16 v[180:183], v[128:129], v[174:175], v[180:183]
    v_mfma_f32_16x16x16_bf16 v[184:187], v[130:131], v[168:169], v[184:187]
    v_mfma_f32_16x16x16_bf16 v[188:191], v[130:131], v[174:175], v[188:191]
    v_mfma_f32_16x16x16_bf16 v[192:195], v[132:133], v[168:169], v[192:195]
    v_mfma_f32_16x16x16_bf16 v[196:199], v[132:133], v[174:175], v[196:199]
    v_mfma_f32_16x16x16_bf16 v[200:203], v[134:135], v[168:169], v[200:203]
    v_mfma_f32_16x16x16_bf16 v[204:207], v[134:135], v[174:175], v[204:207]
    v_mfma_f32_16x16x16_bf16 v[208:211], v[136:137], v[168:169], v[208:211]
    v_mfma_f32_16x16x16_bf16 v[212:215], v[136:137], v[174:175], v[212:215]
    v_mfma_f32_16x16x16_bf16 v[216:219], v[138:139], v[168:169], v[216:219]
    v_mfma_f32_16x16x16_bf16 v[220:223], v[138:139], v[174:175], v[220:223]
    v_mfma_f32_16x16x16_bf16 v[224:227], v[140:141], v[168:169], v[224:227]
    v_mfma_f32_16x16x16_bf16 v[228:231], v[140:141], v[174:175], v[228:231]
    v_mfma_f32_16x16x16_bf16 v[232:235], v[142:143], v[168:169], v[232:235]
    v_mfma_f32_16x16x16_bf16 v[236:239], v[142:143], v[174:175], v[236:239]
    v_rcp_f32 v8, v240
    v_rcp_f32 v9, v244
    s_nop 7
    v_mul_f32 v176, v176, v8
    v_mul_f32 v177, v177, v8
    v_mul_f32 v178, v178, v8
    v_mul_f32 v179, v179, v8
    v_cvt_pk_bf16_f32 v16, v176, v177
    v_cvt_pk_bf16_f32 v17, v178, v179
    v_mul_f32 v184, v184, v8
    v_mul_f32 v185, v185, v8
    v_mul_f32 v186, v186, v8
    v_mul_f32 v187, v187, v8
    v_cvt_pk_bf16_f32 v18, v184, v185
    v_cvt_pk_bf16_f32 v19, v186, v187
    s_add_u32 s64, s32, 0x0
    buffer_store_dwordx4 v[16:19], v1, s[4:7], s64 offen offset:0 sc1
    v_mul_f32 v192, v192, v8
    v_mul_f32 v193, v193, v8
    v_mul_f32 v194, v194, v8
    v_mul_f32 v195, v195, v8
    v_cvt_pk_bf16_f32 v20, v192, v193
    v_cvt_pk_bf16_f32 v21, v194, v195
    v_mul_f32 v200, v200, v8
    v_mul_f32 v201, v201, v8
    v_mul_f32 v202, v202, v8
    v_mul_f32 v203, v203, v8
    v_cvt_pk_bf16_f32 v22, v200, v201
    v_cvt_pk_bf16_f32 v23, v202, v203
    s_add_u32 s64, s32, 0x0
    buffer_store_dwordx4 v[20:23], v1, s[4:7], s64 offen offset:1024 sc1
    v_mul_f32 v208, v208, v8
    v_mul_f32 v209, v209, v8
    v_mul_f32 v210, v210, v8
    v_mul_f32 v211, v211, v8
    v_cvt_pk_bf16_f32 v24, v208, v209
    v_cvt_pk_bf16_f32 v25, v210, v211
    v_mul_f32 v216, v216, v8
    v_mul_f32 v217, v217, v8
    v_mul_f32 v218, v218, v8
    v_mul_f32 v219, v219, v8
    v_cvt_pk_bf16_f32 v26, v216, v217
    v_cvt_pk_bf16_f32 v27, v218, v219
    s_add_u32 s64, s32, 0x0
    buffer_store_dwordx4 v[24:27], v1, s[4:7], s64 offen offset:2048 sc1
    v_mul_f32 v224, v224, v8
    v_mul_f32 v225, v225, v8
    v_mul_f32 v226, v226, v8
    v_mul_f32 v227, v227, v8
    v_cvt_pk_bf16_f32 v28, v224, v225
    v_cvt_pk_bf16_f32 v29, v226, v227
    v_mul_f32 v232, v232, v8
    v_mul_f32 v233, v233, v8
    v_mul_f32 v234, v234, v8
    v_mul_f32 v235, v235, v8
    v_cvt_pk_bf16_f32 v30, v232, v233
    v_cvt_pk_bf16_f32 v31, v234, v235
    s_add_u32 s64, s32, 0x0
    buffer_store_dwordx4 v[28:31], v1, s[4:7], s64 offen offset:3072 sc1
    v_mul_f32 v180, v180, v9
    v_mul_f32 v181, v181, v9
    v_mul_f32 v182, v182, v9
    v_mul_f32 v183, v183, v9
    v_cvt_pk_bf16_f32 v32, v180, v181
    v_cvt_pk_bf16_f32 v33, v182, v183
    v_mul_f32 v188, v188, v9
    v_mul_f32 v189, v189, v9
    v_mul_f32 v190, v190, v9
    v_mul_f32 v191, v191, v9
    v_cvt_pk_bf16_f32 v34, v188, v189
    v_cvt_pk_bf16_f32 v35, v190, v191
    s_add_u32 s64, s32, 0x20000
    buffer_store_dwordx4 v[32:35], v1, s[4:7], s64 offen offset:0 sc1
    v_mul_f32 v196, v196, v9
    v_mul_f32 v197, v197, v9
    v_mul_f32 v198, v198, v9
    v_mul_f32 v199, v199, v9
    v_cvt_pk_bf16_f32 v36, v196, v197
    v_cvt_pk_bf16_f32 v37, v198, v199
    v_mul_f32 v204, v204, v9
    v_mul_f32 v205, v205, v9
    v_mul_f32 v206, v206, v9
    v_mul_f32 v207, v207, v9
    v_cvt_pk_bf16_f32 v38, v204, v205
    v_cvt_pk_bf16_f32 v39, v206, v207
    s_add_u32 s64, s32, 0x20000
    buffer_store_dwordx4 v[36:39], v1, s[4:7], s64 offen offset:1024 sc1
    v_mul_f32 v212, v212, v9
    v_mul_f32 v213, v213, v9
    v_mul_f32 v214, v214, v9
    v_mul_f32 v215, v215, v9
    v_cvt_pk_bf16_f32 v40, v212, v213
    v_cvt_pk_bf16_f32 v41, v214, v215
    v_mul_f32 v220, v220, v9
    v_mul_f32 v221, v221, v9
    v_mul_f32 v222, v222, v9
    v_mul_f32 v223, v223, v9
    v_cvt_pk_bf16_f32 v42, v220, v221
    v_cvt_pk_bf16_f32 v43, v222, v223
    s_add_u32 s64, s32, 0x20000
    buffer_store_dwordx4 v[40:43], v1, s[4:7], s64 offen offset:2048 sc1
    v_mul_f32 v228, v228, v9
    v_mul_f32 v229, v229, v9
    v_mul_f32 v230, v230, v9
    v_mul_f32 v231, v231, v9
    v_cvt_pk_bf16_f32 v44, v228, v229
    v_cvt_pk_bf16_f32 v45, v230, v231
    v_mul_f32 v236, v236, v9
    v_mul_f32 v237, v237, v9
    v_mul_f32 v238, v238, v9
    v_mul_f32 v239, v239, v9
    v_cvt_pk_bf16_f32 v46, v236, v237
    v_cvt_pk_bf16_f32 v47, v238, v239
    s_add_u32 s64, s32, 0x20000
    buffer_store_dwordx4 v[44:47], v1, s[4:7], s64 offen offset:3072 sc1
    s_waitcnt vmcnt(0)
    v_mov_b32 v7, 1
    v_mov_b32 v8, 0
    s_mov_b64 exec, 1
    buffer_store_dword v7, v8, s[4:7], s33 offen sc1
    s_mov_b64 exec, -1
    s_add_u32 s24, s24, 8
    s_add_u32 s25, s25, 1
    s_cmp_lt_u32 s25, 1
    s_cbranch_scc1 AT0_LOOP
AT0_END:
    s_lshl_b32 s70, s13, 1
    s_add_u32 s70, s70, s12
    s_load_dwordx2 s[44:45], s[0:1], 72
    s_mov_b32 s46, 0x21c000
    s_mov_b32 s47, 0x00020000
    s_load_dwordx2 s[48:49], s[0:1], 80
    s_mov_b32 s50, 0x21c000
    s_mov_b32 s51, 0x00020000
    s_load_dwordx2 s[52:53], s[0:1], 88
    s_mov_b32 s54, 0x21c000
    s_mov_b32 s55, 0x00020000
    s_mov_b32 s29, 0
    s_waitcnt lgkmcnt(0)
    v_mbcnt_lo_u32_b32 v0, -1, 0
    v_mbcnt_hi_u32_b32 v0, -1, v0
    s_lshl_b32 s24, s70, 2
    s_add_u32 s24, s24, s14
    s_cmp_ge_u32 s24, 108
    s_cbranch_scc1 H_A1
    v_mov_b32 v8, 0
    s_mov_b32 s64, 0x298000
F1W_175:
    buffer_load_dword v7, v8, s[4:7], s64 offen sc1
    s_add_u32 s29, s29, 1
    s_waitcnt vmcnt(0)
    v_cmp_gt_u32 vcc, 1, v7
    s_cbranch_vccz F1WD_176
    s_cmp_gt_u32 s29, 262144
    s_cbranch_scc1 F1WD_176
    s_sleep 8
    s_branch F1W_175
F1WD_176:
    s_mul_i32 s25, s14, 40960
    v_lshrrev_b32 v7, 1, v0
    v_mul_u32_u24 v2, 3456, v7
    v_and_b32 v7, 1, v0
    v_lshl_add_u32 v2, v7, 4, v2
    v_lshrrev_b32 v7, 4, v0
    v_lshlrev_b32 v3, 8, v7
    v_bfe_u32 v7, v0, 2, 2
    v_lshl_add_u32 v3, v7, 5, v3
    v_and_b32 v7, 3, v0
    v_lshl_add_u32 v3, v7, 3, v3
    v_add_u32 v3, s25, v3
    v_and_b32 v7, 7, v0
    v_lshlrev_b32 v7, 2, v7
    s_mov_b32 s64, 0x5400000
    buffer_load_dword v4, v7, s[4:7], s64 offen sc1
    s_waitcnt vmcnt(0)
    v_mul_u32_u24 v4, 1280, v4
    v_lshrrev_b32 v7, 4, v0
    v_lshl_add_u32 v4, v7, 4, v4
    s_mov_b32 s65, 0x0
    buffer_load_dwordx4 v[16:19], v4, s[4:7], s65 offen offset:0 sc1
    buffer_load_dwordx4 v[20:23], v4, s[4:7], s65 offen offset:64 sc1
    buffer_load_dwordx4 v[24:27], v4, s[4:7], s65 offen offset:128 sc1
    buffer_load_dwordx4 v[28:31], v4, s[4:7], s65 offen offset:192 sc1
    buffer_load_dwordx4 v[32:35], v4, s[4:7], s65 offen offset:256 sc1
    buffer_load_dwordx4 v[36:39], v4, s[4:7], s65 offen offset:320 sc1
    buffer_load_dwordx4 v[40:43], v4, s[4:7], s65 offen offset:384 sc1
    buffer_load_dwordx4 v[44:47], v4, s[4:7], s65 offen offset:448 sc1
    buffer_load_dwordx4 v[48:51], v4, s[4:7], s65 offen offset:512 sc1
    buffer_load_dwordx4 v[52:55], v4, s[4:7], s65 offen offset:576 sc1
    buffer_load_dwordx4 v[56:59], v4, s[4:7], s65 offen offset:640 sc1
    buffer_load_dwordx4 v[60:63], v4, s[4:7], s65 offen offset:704 sc1
    buffer_load_dwordx4 v[64:67], v4, s[4:7], s65 offen offset:768 sc1
    buffer_load_dwordx4 v[68:71], v4, s[4:7], s65 offen offset:832 sc1
    buffer_load_dwordx4 v[72:75], v4, s[4:7], s65 offen offset:896 sc1
    buffer_load_dwordx4 v[76:79], v4, s[4:7], s65 offen offset:960 sc1
    buffer_load_dwordx4 v[80:83], v4, s[4:7], s65 offen offset:1024 sc1
    buffer_load_dwordx4 v[84:87], v4, s[4:7], s65 offen offset:1088 sc1
    buffer_load_dwordx4 v[88:91], v4, s[4:7], s65 offen offset:1152 sc1
    buffer_load_dwordx4 v[92:95], v4, s[4:7], s65 offen offset:1216 sc1
    s_lshl_b32 s26, s24, 5
    s_add_u32 m0, s25, 0
    s_add_u32 s64, s26, 0x0
    buffer_load_dwordx4 v2, s[44:47], s64 offen lds
    s_add_u32 m0, s25, 1024
    s_add_u32 s64, s26, 0x1b000
    buffer_load_dwordx4 v2, s[44:47], s64 offen lds
    s_add_u32 m0, s25, 2048
    s_add_u32 s64, s26, 0x36000
    buffer_load_dwordx4 v2, s[44:47], s64 offen lds
    s_add_u32 m0, s25, 3072
    s_add_u32 s64, s26, 0x51000
    buffer_load_dwordx4 v2, s[44:47], s64 offen lds
    s_add_u32 m0, s25, 4096
    s_add_u32 s64, s26, 0x6c000
    buffer_load_dwordx4 v2, s[44:47], s64 offen lds
    s_add_u32 m0, s25, 5120
    s_add_u32 s64, s26, 0x87000
    buffer_load_dwordx4 v2, s[44:47], s64 offen lds
    s_add_u32 m0, s25, 6144
    s_add_u32 s64, s26, 0xa2000
    buffer_load_dwordx4 v2, s[44:47], s64 offen lds
    s_add_u32 m0, s25, 7168
    s_add_u32 s64, s26, 0xbd000
    buffer_load_dwordx4 v2, s[44:47], s64 offen lds
    s_add_u32 m0, s25, 8192
    s_add_u32 s64, s26, 0xd8000
    buffer_load_dwordx4 v2, s[44:47], s64 offen lds
    s_add_u32 m0, s25, 9216
    s_add_u32 s64, s26, 0xf3000
    buffer_load_dwordx4 v2, s[44:47], s64 offen lds
    s_add_u32 m0, s25, 10240
    s_add_u32 s64, s26, 0x10e000
    buffer_load_dwordx4 v2, s[44:47], s64 offen lds
    s_add_u32 m0, s25, 11264
    s_add_u32 s64, s26, 0x129000
    buffer_load_dwordx4 v2, s[44:47], s64 offen lds
    s_add_u32 m0, s25, 12288
    s_add_u32 s64, s26, 0x144000
    buffer_load_dwordx4 v2, s[44:47], s64 offen lds
    s_add_u32 m0, s25, 13312
    s_add_u32 s64, s26, 0x15f000
    buffer_load_dwordx4 v2, s[44:47], s64 offen lds
    s_add_u32 m0, s25, 14336
    s_add_u32 s64, s26, 0x17a000
    buffer_load_dwordx4 v2, s[44:47], s64 offen lds
    s_add_u32 m0, s25, 15360
    s_add_u32 s64, s26, 0x195000
    buffer_load_dwordx4 v2, s[44:47], s64 offen lds
    s_add_u32 m0, s25, 16384
    s_add_u32 s64, s26, 0x1b0000
    buffer_load_dwordx4 v2, s[44:47], s64 offen lds
    s_add_u32 m0, s25, 17408
    s_add_u32 s64, s26, 0x1cb000
    buffer_load_dwordx4 v2, s[44:47], s64 offen lds
    s_add_u32 m0, s25, 18432
    s_add_u32 s64, s26, 0x1e6000
    buffer_load_dwordx4 v2, s[44:47], s64 offen lds
    s_add_u32 m0, s25, 19456
    s_add_u32 s64, s26, 0x201000
    buffer_load_dwordx4 v2, s[44:47], s64 offen lds
    s_waitcnt vmcnt(0)
    ds_read_b64_tr_b16 v[96:97], v3 offset:0
    ds_read_b64_tr_b16 v[98:99], v3 offset:128
    ds_read_b64_tr_b16 v[100:101], v3 offset:1024
    ds_read_b64_tr_b16 v[102:103], v3 offset:1152
    ds_read_b64_tr_b16 v[104:105], v3 offset:2048
    ds_read_b64_tr_b16 v[106:107], v3 offset:2176
    ds_read_b64_tr_b16 v[108:109], v3 offset:3072
    ds_read_b64_tr_b16 v[110:111], v3 offset:3200
    ds_read_b64_tr_b16 v[112:113], v3 offset:4096
    ds_read_b64_tr_b16 v[114:115], v3 offset:4224
    ds_read_b64_tr_b16 v[116:117], v3 offset:5120
    ds_read_b64_tr_b16 v[118:119], v3 offset:5248
    s_waitcnt lgkmcnt(4)
    ds_read_b64_tr_b16 v[120:121], v3 offset:6144
    ds_read_b64_tr_b16 v[122:123], v3 offset:6272
    ds_read_b64_tr_b16 v[124:125], v3 offset:7168
    ds_read_b64_tr_b16 v[126:127], v3 offset:7296
    ds_read_b64_tr_b16 v[128:129], v3 offset:8192
    ds_read_b64_tr_b16 v[130:131], v3 offset:8320
    ds_read_b64_tr_b16 v[132:133], v3 offset:9216
    ds_read_b64_tr_b16 v[134:135], v3 offset:9344
    ds_read_b64_tr_b16 v[136:137], v3 offset:10240
    ds_read_b64_tr_b16 v[138:139], v3 offset:10368
    ds_read_b64_tr_b16 v[140:141], v3 offset:11264
    ds_read_b64_tr_b16 v[142:143], v3 offset:11392
    s_waitcnt lgkmcnt(4)
    ds_read_b64_tr_b16 v[144:145], v3 offset:12288
    ds_read_b64_tr_b16 v[146:147], v3 offset:12416
    ds_read_b64_tr_b16 v[148:149], v3 offset:13312
    ds_read_b64_tr_b16 v[150:151], v3 offset:13440
    ds_read_b64_tr_b16 v[152:153], v3 offset:14336
    ds_read_b64_tr_b16 v[154:155], v3 offset:14464
    ds_read_b64_tr_b16 v[156:157], v3 offset:15360
    ds_read_b64_tr_b16 v[158:159], v3 offset:15488
    ds_read_b64_tr_b16 v[160:161], v3 offset:16384
    ds_read_b64_tr_b16 v[162:163], v3 offset:16512
    ds_read_b64_tr_b16 v[164:165], v3 offset:17408
    ds_read_b64_tr_b16 v[166:167], v3 offset:17536
    s_waitcnt lgkmcnt(4)
    ds_read_b64_tr_b16 v[168:169], v3 offset:18432
    ds_read_b64_tr_b16 v[170:171], v3 offset:18560
    ds_read_b64_tr_b16 v[172:173], v3 offset:19456
    ds_read_b64_tr_b16 v[174:175], v3 offset:19584
    s_waitcnt lgkmcnt(0)
    s_add_u32 s25, s25, 20480
    v_add_u32 v3, 20480, v3
    s_add_u32 m0, s25, 0
    s_add_u32 s64, s26, 0x0
    buffer_load_dwordx4 v2, s[48:51], s64 offen lds
    s_add_u32 m0, s25, 1024
    s_add_u32 s64, s26, 0x1b000
    buffer_load_dwordx4 v2, s[48:51], s64 offen lds
    s_add_u32 m0, s25, 2048
    s_add_u32 s64, s26, 0x36000
    buffer_load_dwordx4 v2, s[48:51], s64 offen lds
    s_add_u32 m0, s25, 3072
    s_add_u32 s64, s26, 0x51000
    buffer_load_dwordx4 v2, s[48:51], s64 offen lds
    s_add_u32 m0, s25, 4096
    s_add_u32 s64, s26, 0x6c000
    buffer_load_dwordx4 v2, s[48:51], s64 offen lds
    s_add_u32 m0, s25, 5120
    s_add_u32 s64, s26, 0x87000
    buffer_load_dwordx4 v2, s[48:51], s64 offen lds
    s_add_u32 m0, s25, 6144
    s_add_u32 s64, s26, 0xa2000
    buffer_load_dwordx4 v2, s[48:51], s64 offen lds
    s_add_u32 m0, s25, 7168
    s_add_u32 s64, s26, 0xbd000
    buffer_load_dwordx4 v2, s[48:51], s64 offen lds
    s_add_u32 m0, s25, 8192
    s_add_u32 s64, s26, 0xd8000
    buffer_load_dwordx4 v2, s[48:51], s64 offen lds
    s_add_u32 m0, s25, 9216
    s_add_u32 s64, s26, 0xf3000
    buffer_load_dwordx4 v2, s[48:51], s64 offen lds
    s_add_u32 m0, s25, 10240
    s_add_u32 s64, s26, 0x10e000
    buffer_load_dwordx4 v2, s[48:51], s64 offen lds
    s_add_u32 m0, s25, 11264
    s_add_u32 s64, s26, 0x129000
    buffer_load_dwordx4 v2, s[48:51], s64 offen lds
    s_add_u32 m0, s25, 12288
    s_add_u32 s64, s26, 0x144000
    buffer_load_dwordx4 v2, s[48:51], s64 offen lds
    s_add_u32 m0, s25, 13312
    s_add_u32 s64, s26, 0x15f000
    buffer_load_dwordx4 v2, s[48:51], s64 offen lds
    s_add_u32 m0, s25, 14336
    s_add_u32 s64, s26, 0x17a000
    buffer_load_dwordx4 v2, s[48:51], s64 offen lds
    s_add_u32 m0, s25, 15360
    s_add_u32 s64, s26, 0x195000
    buffer_load_dwordx4 v2, s[48:51], s64 offen lds
    s_add_u32 m0, s25, 16384
    s_add_u32 s64, s26, 0x1b0000
    buffer_load_dwordx4 v2, s[48:51], s64 offen lds
    s_add_u32 m0, s25, 17408
    s_add_u32 s64, s26, 0x1cb000
    buffer_load_dwordx4 v2, s[48:51], s64 offen lds
    s_add_u32 m0, s25, 18432
    s_add_u32 s64, s26, 0x1e6000
    buffer_load_dwordx4 v2, s[48:51], s64 offen lds
    s_add_u32 m0, s25, 19456
    s_add_u32 s64, s26, 0x201000
    buffer_load_dwordx4 v2, s[48:51], s64 offen lds
    s_waitcnt vmcnt(0)
    ds_read_b64_tr_b16 v[176:177], v3 offset:0
    ds_read_b64_tr_b16 v[178:179], v3 offset:128
    ds_read_b64_tr_b16 v[180:181], v3 offset:1024
    ds_read_b64_tr_b16 v[182:183], v3 offset:1152
    ds_read_b64_tr_b16 v[184:185], v3 offset:2048
    ds_read_b64_tr_b16 v[186:187], v3 offset:2176
    ds_read_b64_tr_b16 v[188:189], v3 offset:3072
    ds_read_b64_tr_b16 v[190:191], v3 offset:3200
    ds_read_b64_tr_b16 v[192:193], v3 offset:4096
    ds_read_b64_tr_b16 v[194:195], v3 offset:4224
    ds_read_b64_tr_b16 v[196:197], v3 offset:5120
    ds_read_b64_tr_b16 v[198:199], v3 offset:5248
    s_waitcnt lgkmcnt(4)
    ds_read_b64_tr_b16 v[200:201], v3 offset:6144
    ds_read_b64_tr_b16 v[202:203], v3 offset:6272
    ds_read_b64_tr_b16 v[204:205], v3 offset:7168
    ds_read_b64_tr_b16 v[206:207], v3 offset:7296
    ds_read_b64_tr_b16 v[208:209], v3 offset:8192
    ds_read_b64_tr_b16 v[210:211], v3 offset:8320
    ds_read_b64_tr_b16 v[212:213], v3 offset:9216
    ds_read_b64_tr_b16 v[214:215], v3 offset:9344
    ds_read_b64_tr_b16 v[216:217], v3 offset:10240
    ds_read_b64_tr_b16 v[218:219], v3 offset:10368
    ds_read_b64_tr_b16 v[220:221], v3 offset:11264
    ds_read_b64_tr_b16 v[222:223], v3 offset:11392
    s_waitcnt lgkmcnt(4)
    ds_read_b64_tr_b16 v[224:225], v3 offset:12288
    ds_read_b64_tr_b16 v[226:227], v3 offset:12416
    ds_read_b64_tr_b16 v[228:229], v3 offset:13312
    ds_read_b64_tr_b16 v[230:231], v3 offset:13440
    ds_read_b64_tr_b16 v[232:233], v3 offset:14336
    ds_read_b64_tr_b16 v[234:235], v3 offset:14464
    ds_read_b64_tr_b16 v[236:237], v3 offset:15360
    ds_read_b64_tr_b16 v[238:239], v3 offset:15488
    ds_read_b64_tr_b16 v[240:241], v3 offset:16384
    ds_read_b64_tr_b16 v[242:243], v3 offset:16512
    ds_read_b64_tr_b16 v[244:245], v3 offset:17408
    ds_read_b64_tr_b16 v[246:247], v3 offset:17536
    s_waitcnt lgkmcnt(4)
    ds_read_b64_tr_b16 v[248:249], v3 offset:18432
    ds_read_b64_tr_b16 v[250:251], v3 offset:18560
    ds_read_b64_tr_b16 v[252:253], v3 offset:19456
    ds_read_b64_tr_b16 v[254:255], v3 offset:19584
    s_waitcnt lgkmcnt(0)
    v_mfma_f32_16x16x32_bf16 v[8:11], v[96:99], v[16:19], 0
    v_mfma_f32_16x16x32_bf16 v[12:15], v[176:179], v[16:19], 0
    v_mfma_f32_16x16x32_bf16 v[8:11], v[100:103], v[20:23], v[8:11]
    v_mfma_f32_16x16x32_bf16 v[12:15], v[180:183], v[20:23], v[12:15]
    v_mfma_f32_16x16x32_bf16 v[8:11], v[104:107], v[24:27], v[8:11]
    v_mfma_f32_16x16x32_bf16 v[12:15], v[184:187], v[24:27], v[12:15]
    v_mfma_f32_16x16x32_bf16 v[8:11], v[108:111], v[28:31], v[8:11]
    v_mfma_f32_16x16x32_bf16 v[12:15], v[188:191], v[28:31], v[12:15]
    v_mfma_f32_16x16x32_bf16 v[8:11], v[112:115], v[32:35], v[8:11]
    v_mfma_f32_16x16x32_bf16 v[12:15], v[192:195], v[32:35], v[12:15]
    v_mfma_f32_16x16x32_bf16 v[8:11], v[116:119], v[36:39], v[8:11]
    v_mfma_f32_16x16x32_bf16 v[12:15], v[196:199], v[36:39], v[12:15]
    v_mfma_f32_16x16x32_bf16 v[8:11], v[120:123], v[40:43], v[8:11]
    v_mfma_f32_16x16x32_bf16 v[12:15], v[200:203], v[40:43], v[12:15]
    v_mfma_f32_16x16x32_bf16 v[8:11], v[124:127], v[44:47], v[8:11]
    v_mfma_f32_16x16x32_bf16 v[12:15], v[204:207], v[44:47], v[12:15]
    v_mfma_f32_16x16x32_bf16 v[8:11], v[128:131], v[48:51], v[8:11]
    v_mfma_f32_16x16x32_bf16 v[12:15], v[208:211], v[48:51], v[12:15]
    v_mfma_f32_16x16x32_bf16 v[8:11], v[132:135], v[52:55], v[8:11]
    v_mfma_f32_16x16x32_bf16 v[12:15], v[212:215], v[52:55], v[12:15]
    v_mfma_f32_16x16x32_bf16 v[8:11], v[136:139], v[56:59], v[8:11]
    v_mfma_f32_16x16x32_bf16 v[12:15], v[216:219], v[56:59], v[12:15]
    v_mfma_f32_16x16x32_bf16 v[8:11], v[140:143], v[60:63], v[8:11]
    v_mfma_f32_16x16x32_bf16 v[12:15], v[220:223], v[60:63], v[12:15]
    v_mfma_f32_16x16x32_bf16 v[8:11], v[144:147], v[64:67], v[8:11]
    v_mfma_f32_16x16x32_bf16 v[12:15], v[224:227], v[64:67], v[12:15]
    v_mfma_f32_16x16x32_bf16 v[8:11], v[148:151], v[68:71], v[8:11]
    v_mfma_f32_16x16x32_bf16 v[12:15], v[228:231], v[68:71], v[12:15]
    v_mfma_f32_16x16x32_bf16 v[8:11], v[152:155], v[72:75], v[8:11]
    v_mfma_f32_16x16x32_bf16 v[12:15], v[232:235], v[72:75], v[12:15]
    v_mfma_f32_16x16x32_bf16 v[8:11], v[156:159], v[76:79], v[8:11]
    v_mfma_f32_16x16x32_bf16 v[12:15], v[236:239], v[76:79], v[12:15]
    v_mfma_f32_16x16x32_bf16 v[8:11], v[160:163], v[80:83], v[8:11]
    v_mfma_f32_16x16x32_bf16 v[12:15], v[240:243], v[80:83], v[12:15]
    v_mfma_f32_16x16x32_bf16 v[8:11], v[164:167], v[84:87], v[8:11]
    v_mfma_f32_16x16x32_bf16 v[12:15], v[244:247], v[84:87], v[12:15]
    v_mfma_f32_16x16x32_bf16 v[8:11], v[168:171], v[88:91], v[8:11]
    v_mfma_f32_16x16x32_bf16 v[12:15], v[248:251], v[88:91], v[12:15]
    v_mfma_f32_16x16x32_bf16 v[8:11], v[172:175], v[92:95], v[8:11]
    v_mfma_f32_16x16x32_bf16 v[12:15], v[252:255], v[92:95], v[12:15]
    s_nop 7
    v_cvt_pk_bf16_f32 v8, v8, v8
    v_lshlrev_b32 v8, 16, v8
    v_cvt_pk_bf16_f32 v12, v12, v12
    v_lshlrev_b32 v12, 16, v12
    v_mul_f32 v16, 0xbfb8aa3b, v8
    v_exp_f32 v16, v16
    s_nop 0
    v_add_f32 v16, 1.0, v16
    v_rcp_f32 v16, v16
    s_nop 0
    v_mul_f32 v8, v8, v16
    v_cvt_pk_bf16_f32 v8, v8, v8
    v_lshlrev_b32 v8, 16, v8
    v_mul_f32 v8, v8, v12
    v_cvt_pk_bf16_f32 v9, v9, v9
    v_lshlrev_b32 v9, 16, v9
    v_cvt_pk_bf16_f32 v13, v13, v13
    v_lshlrev_b32 v13, 16, v13
    v_mul_f32 v17, 0xbfb8aa3b, v9
    v_exp_f32 v17, v17
    s_nop 0
    v_add_f32 v17, 1.0, v17
    v_rcp_f32 v17, v17
    s_nop 0
    v_mul_f32 v9, v9, v17
    v_cvt_pk_bf16_f32 v9, v9, v9
    v_lshlrev_b32 v9, 16, v9
    v_mul_f32 v9, v9, v13
    v_cvt_pk_bf16_f32 v10, v10, v10
    v_lshlrev_b32 v10, 16, v10
    v_cvt_pk_bf16_f32 v14, v14, v14
    v_lshlrev_b32 v14, 16, v14
    v_mul_f32 v18, 0xbfb8aa3b, v10
    v_exp_f32 v18, v18
    s_nop 0
    v_add_f32 v18, 1.0, v18
    v_rcp_f32 v18, v18
    s_nop 0
    v_mul_f32 v10, v10, v18
    v_cvt_pk_bf16_f32 v10, v10, v10
    v_lshlrev_b32 v10, 16, v10
    v_mul_f32 v10, v10, v14
    v_cvt_pk_bf16_f32 v11, v11, v11
    v_lshlrev_b32 v11, 16, v11
    v_cvt_pk_bf16_f32 v15, v15, v15
    v_lshlrev_b32 v15, 16, v15
    v_mul_f32 v19, 0xbfb8aa3b, v11
    v_exp_f32 v19, v19
    s_nop 0
    v_add_f32 v19, 1.0, v19
    v_rcp_f32 v19, v19
    s_nop 0
    v_mul_f32 v11, v11, v19
    v_cvt_pk_bf16_f32 v11, v11, v11
    v_lshlrev_b32 v11, 16, v11
    v_mul_f32 v11, v11, v15
    v_cvt_pk_bf16_f32 v16, v8, v9
    v_cvt_pk_bf16_f32 v17, v10, v11
    s_lshr_b32 s65, s24, 1
    s_lshl_b32 s65, s65, 10
    s_and_b32 s66, s24, 1
    s_lshl_b32 s66, s66, 3
    s_add_u32 s65, s65, s66
    s_add_u32 s65, s65, 0x5401000
    v_lshlrev_b32 v4, 4, v0
    buffer_store_dwordx2 v[16:17], v4, s[4:7], s65 offen sc1
    s_waitcnt vmcnt(0)
    v_mov_b32 v7, 1
    v_mov_b32 v8, 0
    s_mov_b32 s64, 0x298080
    s_mov_b64 exec, 1
    buffer_atomic_add v7, v8, s[4:7], s64 offen sc1
    s_mov_b64 exec, -1
H_A1:
    v_mbcnt_lo_u32_b32 v0, -1, 0
    v_mbcnt_hi_u32_b32 v0, -1, v0
    s_mov_b32 s29, 0
    v_lshlrev_b32 v1, 4, v0
    v_lshrrev_b32 v5, 4, v0
    v_lshlrev_b32 v2, 7, v5
    v_and_b32 v5, 7, v0
    v_lshl_add_u32 v2, v5, 4, v2
    v_bfe_u32 v5, v0, 4, 1
    v_lshlrev_b32 v3, 7, v5
    v_and_b32 v5, 15, v0
    v_lshl_add_u32 v3, v5, 3, v3
    s_mov_b32 s34, 0x3e0293ee
    s_mov_b32 s35, 0x3e0293ee
    s_mov_b32 s36, -1
    s_mov_b32 s37, 0
    v_lshrrev_b32 v5, 4, v0
    v_lshlrev_b32 v5, 2, v5
    v_and_b32 v6, 15, v0
    v_add_u32 v7, 0, v5
    v_cmp_le_u32 s[38:39], v7, v6
    v_add_u32 v7, 1, v5
    v_cmp_le_u32 s[40:41], v7, v6
    v_add_u32 v7, 2, v5
    v_cmp_le_u32 s[42:43], v7, v6
    v_add_u32 v7, 3, v5
    v_cmp_le_u32 s[44:45], v7, v6
    v_mov_b32 v248, 0x3f803f80
    v_mov_b32 v249, 0x3f803f80
    v_mov_b32 v250, 0x3f803f80
    v_mov_b32 v251, 0x3f803f80
    s_lshl_b32 s24, s12, 2
    s_add_u32 s24, s24, s14
    s_add_u32 s24, s24, 8
    s_mov_b32 s25, 1
AT1_LOOP:
    s_cmp_eq_u32 s24, 63
    s_cbranch_scc1 AT1_END
    s_lshl_b32 s64, s24, 5
    s_add_u32 s64, s64, s13
    s_lshl_b32 s26, s64, 13
    s_add_u32 s26, s26, 0x3400000
    s_lshl_b32 s27, s64, 14
    s_add_u32 s27, s27, 0x1400000
    s_lshl_b32 s65, s64, 11
    s_add_u32 s30, s65, 0x640000
    s_add_u32 s31, s65, 0xa40000
    s_lshl_b32 s33, s64, 2
    s_add_u32 s33, s33, 0x296000
    s_lshl_b32 s32, s24, 18
    s_lshl_b32 s65, s13, 12
    s_add_u32 s32, s32, s65
    s_add_u32 s32, s32, 0x4400000
    s_lshr_b32 s65, s24, 2
    s_lshl_b32 s65, s65, 9
    s_lshl_b32 s66, s13, 4
    s_add_u32 s65, s65, s66
    s_add_u32 s65, s65, 0x291000
    s_lshr_b32 s66, s24, 1
    s_lshl_b32 s66, s66, 8
    s_lshl_b32 s64, s13, 3
    s_add_u32 s66, s66, s64
    s_add_u32 s66, s66, 0x293ff4
    v_lshlrev_b32 v5, 2, v0
    v_mov_b32 v6, s65
    v_mov_b32 v7, s66
    v_cmp_gt_u32 vcc, 3, v0
    s_nop 1
    v_cndmask_b32 v6, v7, v6, vcc
    v_add_u32 v4, v5, v6
    s_mov_b32 s64, 0
    s_mov_b64 exec, 7
AT1_F_177:
    buffer_load_dword v5, v4, s[4:7], s64 offen sc1
    s_add_u32 s29, s29, 1
    s_waitcnt vmcnt(0)
    v_cmp_eq_u32 vcc, 0, v5
    s_cbranch_vccz AT1_FD_178
    s_cmp_gt_u32 s29, 262144
    s_cbranch_scc1 AT1_FD_178
    s_sleep 1
    s_branch AT1_F_177
AT1_FD_178:
    s_mov_b64 exec, -1
    buffer_load_dwordx4 v[16:19], v1, s[4:7], s26 offen offset:0
    buffer_load_dwordx4 v[20:23], v1, s[4:7], s26 offen offset:1024
    buffer_load_dwordx4 v[24:27], v1, s[4:7], s26 offen offset:2048
    buffer_load_dwordx4 v[28:31], v1, s[4:7], s26 offen offset:3072
    s_add_u32 s26, s26, 4096
    buffer_load_dwordx4 v[32:35], v1, s[4:7], s26 offen offset:0
    buffer_load_dwordx4 v[36:39], v1, s[4:7], s26 offen offset:1024
    buffer_load_dwordx4 v[40:43], v1, s[4:7], s26 offen offset:2048
    buffer_load_dwordx4 v[44:47], v1, s[4:7], s26 offen offset:3072
    buffer_load_dwordx4 v[48:51], v1, s[4:7], s27 offen offset:0
    buffer_load_dwordx4 v[52:55], v1, s[4:7], s27 offen offset:1024
    buffer_load_dwordx4 v[56:59], v1, s[4:7], s27 offen offset:2048
    buffer_load_dwordx4 v[60:63], v1, s[4:7], s27 offen offset:3072
    s_add_u32 s27, s27, 4096
    buffer_load_dwordx4 v[64:67], v1, s[4:7], s27 offen offset:0
    buffer_load_dwordx4 v[68:71], v1, s[4:7], s27 offen offset:1024
    buffer_load_dwordx4 v[72:75], v1, s[4:7], s27 offen offset:2048
    buffer_load_dwordx4 v[76:79], v1, s[4:7], s27 offen offset:3072
    s_add_u32 s27, s27, 4096
    buffer_load_dwordx4 v[80:83], v1, s[4:7], s27 offen offset:0
    buffer_load_dwordx4 v[84:87], v1, s[4:7], s27 offen offset:1024
    buffer_load_dwordx4 v[88:91], v1, s[4:7], s27 offen offset:2048
    buffer_load_dwordx4 v[92:95], v1, s[4:7], s27 offen offset:3072
    s_add_u32 s27, s27, 4096
    buffer_load_dwordx4 v[96:99], v1, s[4:7], s27 offen offset:0
    buffer_load_dwordx4 v[100:103], v1, s[4:7], s27 offen offset:1024
    buffer_load_dwordx4 v[104:107], v1, s[4:7], s27 offen offset:2048
    buffer_load_dwordx4 v[108:111], v1, s[4:7], s27 offen offset:3072
    s_mov_b64 exec, 0x18
AT1_G_179:
    buffer_load_dword v5, v4, s[4:7], s64 offen sc1
    s_add_u32 s29, s29, 1
    s_waitcnt vmcnt(0)
    v_cmp_eq_u32 vcc, 0, v5
    s_cbranch_vccz AT1_GD_180
    s_cmp_gt_u32 s29, 262144
    s_cbranch_scc1 AT1_GD_180
    s_sleep 1
    s_branch AT1_G_179
AT1_GD_180:
    s_mov_b64 exec, -1
    buffer_load_dwordx4 v[112:115], v2, s[4:7], s30 offen offset:0
    buffer_load_dwordx4 v[116:119], v2, s[4:7], s30 offen offset:512
    buffer_load_dwordx4 v[120:123], v2, s[4:7], s30 offen offset:1024
    buffer_load_dwordx4 v[124:127], v2, s[4:7], s30 offen offset:1536
    buffer_load_dwordx2 v[128:129], v3, s[4:7], s31 offen offset:0
    buffer_load_dwordx2 v[130:131], v3, s[4:7], s31 offen offset:256
    buffer_load_dwordx2 v[132:133], v3, s[4:7], s31 offen offset:512
    buffer_load_dwordx2 v[134:135], v3, s[4:7], s31 offen offset:768
    buffer_load_dwordx2 v[136:137], v3, s[4:7], s31 offen offset:1024
    buffer_load_dwordx2 v[138:139], v3, s[4:7], s31 offen offset:1280
    buffer_load_dwordx2 v[140:141], v3, s[4:7], s31 offen offset:1536
    buffer_load_dwordx2 v[142:143], v3, s[4:7], s31 offen offset:1792
    v_mfma_f32_16x16x32_bf16 v[148:151], v[48:51], v[16:19], 0
    v_mfma_f32_16x16x32_bf16 v[156:159], v[48:51], v[32:35], 0
    v_mfma_f32_16x16x32_bf16 v[160:163], v[64:67], v[32:35], 0
    v_mfma_f32_16x16x32_bf16 v[148:151], v[52:55], v[20:23], v[148:151]
    v_mfma_f32_16x16x32_bf16 v[156:159], v[52:55], v[36:39], v[156:159]
    v_mfma_f32_16x16x32_bf16 v[160:163], v[68:71], v[36:39], v[160:163]
    v_mfma_f32_16x16x32_bf16 v[148:151], v[56:59], v[24:27], v[148:151]
    v_mfma_f32_16x16x32_bf16 v[156:159], v[56:59], v[40:43], v[156:159]
    v_mfma_f32_16x16x32_bf16 v[160:163], v[72:75], v[40:43], v[160:163]
    v_mfma_f32_16x16x32_bf16 v[148:151], v[60:63], v[28:31], v[148:151]
    v_mfma_f32_16x16x32_bf16 v[156:159], v[60:63], v[44:47], v[156:159]
    v_mfma_f32_16x16x32_bf16 v[160:163], v[76:79], v[44:47], v[160:163]
    s_waitcnt vmcnt(8)
    v_mfma_f32_16x16x32_bf16 v[144:147], v[112:115], v[16:19], 0
    v_mfma_f32_16x16x32_bf16 v[152:155], v[112:115], v[32:35], 0
    v_mfma_f32_16x16x32_bf16 v[144:147], v[116:119], v[20:23], v[144:147]
    v_mfma_f32_16x16x32_bf16 v[152:155], v[116:119], v[36:39], v[152:155]
    v_mfma_f32_16x16x32_bf16 v[144:147], v[120:123], v[24:27], v[144:147]
    v_mfma_f32_16x16x32_bf16 v[152:155], v[120:123], v[40:43], v[152:155]
    v_mfma_f32_16x16x32_bf16 v[144:147], v[124:127], v[28:31], v[144:147]
    v_mfma_f32_16x16x32_bf16 v[152:155], v[124:127], v[44:47], v[152:155]
    v_mov_b32 v11, 0xff800000
    s_nop 7
    v_cndmask_b32 v148, v11, v148, s[38:39]
    v_cndmask_b32 v160, v11, v160, s[38:39]
    v_cndmask_b32 v144, v11, v144, s[36:37]
    v_cndmask_b32 v152, v11, v152, s[36:37]
    v_cndmask_b32 v149, v11, v149, s[40:41]
    v_cndmask_b32 v161, v11, v161, s[40:41]
    v_cndmask_b32 v145, v11, v145, s[36:37]
    v_cndmask_b32 v153, v11, v153, s[36:37]
    v_cndmask_b32 v150, v11, v150, s[42:43]
    v_cndmask_b32 v162, v11, v162, s[42:43]
    v_cndmask_b32 v146, v11, v146, s[36:37]
    v_cndmask_b32 v154, v11, v154, s[36:37]
    v_cndmask_b32 v151, v11, v151, s[44:45]
    v_cndmask_b32 v163, v11, v163, s[44:45]
    v_cndmask_b32 v147, v11, v147, s[36:37]
    v_cndmask_b32 v155, v11, v155, s[36:37]
    v_max3_f32 v8, v144, v145, v146
    v_max3_f32 v8, v8, v147, v148
    v_max3_f32 v8, v8, v149, v150
    v_max_f32 v8, v8, v151
    v_mov_b32 v9, v8
    s_nop 1
    v_permlane16_swap_b32 v8, v9
    v_max_f32 v8, v8, v9
    v_mov_b32 v9, v8
    s_nop 1
    v_permlane32_swap_b32 v8, v9
    v_max_f32 v8, v8, v9
    v_mul_f32 v8, s34, v8
    v_fma_f32 v144, v144, s34, -v8
    v_fma_f32 v145, v145, s34, -v8
    v_fma_f32 v146, v146, s34, -v8
    v_fma_f32 v147, v147, s34, -v8
    v_fma_f32 v148, v148, s34, -v8
    v_fma_f32 v149, v149, s34, -v8
    v_fma_f32 v150, v150, s34, -v8
    v_fma_f32 v151, v151, s34, -v8
    v_exp_f32 v144, v144
    v_exp_f32 v145, v145
    v_exp_f32 v146, v146
    v_exp_f32 v147, v147
    v_exp_f32 v148, v148
    v_exp_f32 v149, v149
    v_exp_f32 v150, v150
    v_exp_f32 v151, v151
    s_nop 0
    v_cvt_pk_bf16_f32 v164, v148, v149
    v_cvt_pk_bf16_f32 v165, v150, v151
    v_mov_b32 v166, 0
    v_mov_b32 v167, 0
    v_cvt_pk_bf16_f32 v168, v144, v145
    v_cvt_pk_bf16_f32 v169, v146, v147
    v_max3_f32 v8, v152, v153, v154
    v_max3_f32 v8, v8, v155, v156
    v_max3_f32 v8, v8, v157, v158
    v_max3_f32 v8, v8, v159, v160
    v_max3_f32 v8, v8, v161, v162
    v_max_f32 v8, v8, v163
    v_mov_b32 v9, v8
    s_nop 1
    v_permlane16_swap_b32 v8, v9
    v_max_f32 v8, v8, v9
    v_mov_b32 v9, v8
    s_nop 1
    v_permlane32_swap_b32 v8, v9
    v_max_f32 v8, v8, v9
    v_mul_f32 v8, s34, v8
    v_fma_f32 v152, v152, s34, -v8
    v_fma_f32 v153, v153, s34, -v8
    v_fma_f32 v154, v154, s34, -v8
    v_fma_f32 v155, v155, s34, -v8
    v_fma_f32 v156, v156, s34, -v8
    v_fma_f32 v157, v157, s34, -v8
    v_fma_f32 v158, v158, s34, -v8
    v_fma_f32 v159, v159, s34, -v8
    v_fma_f32 v160, v160, s34, -v8
    v_fma_f32 v161, v161, s34, -v8
    v_fma_f32 v162, v162, s34, -v8
    v_fma_f32 v163, v163, s34, -v8
    v_exp_f32 v152, v152
    v_exp_f32 v153, v153
    v_exp_f32 v154, v154
    v_exp_f32 v155, v155
    v_exp_f32 v156, v156
    v_exp_f32 v157, v157
    v_exp_f32 v158, v158
    v_exp_f32 v159, v159
    v_exp_f32 v160, v160
    v_exp_f32 v161, v161
    v_exp_f32 v162, v162
    v_exp_f32 v163, v163
    s_nop 0
    v_cvt_pk_bf16_f32 v170, v156, v157
    v_cvt_pk_bf16_f32 v171, v158, v159
    v_cvt_pk_bf16_f32 v172, v160, v161
    v_cvt_pk_bf16_f32 v173, v162, v163
    v_cvt_pk_bf16_f32 v174, v152, v153
    v_cvt_pk_bf16_f32 v175, v154, v155
    s_waitcnt vmcnt(0)
    v_mfma_f32_16x16x32_bf16 v[240:243], v[248:251], v[164:167], 0
    v_mfma_f32_16x16x32_bf16 v[244:247], v[248:251], v[170:173], 0
    v_mfma_f32_16x16x32_bf16 v[176:179], v[80:83], v[164:167], 0
    v_mfma_f32_16x16x32_bf16 v[180:183], v[80:83], v[170:173], 0
    v_mfma_f32_16x16x32_bf16 v[184:187], v[84:87], v[164:167], 0
    v_mfma_f32_16x16x32_bf16 v[188:191], v[84:87], v[170:173], 0
    v_mfma_f32_16x16x32_bf16 v[192:195], v[88:91], v[164:167], 0
    v_mfma_f32_16x16x32_bf16 v[196:199], v[88:91], v[170:173], 0
    v_mfma_f32_16x16x32_bf16 v[200:203], v[92:95], v[164:167], 0
    v_mfma_f32_16x16x32_bf16 v[204:207], v[92:95], v[170:173], 0
    v_mfma_f32_16x16x32_bf16 v[208:211], v[96:99], v[164:167], 0
    v_mfma_f32_16x16x32_bf16 v[212:215], v[96:99], v[170:173], 0
    v_mfma_f32_16x16x32_bf16 v[216:219], v[100:103], v[164:167], 0
    v_mfma_f32_16x16x32_bf16 v[220:223], v[100:103], v[170:173], 0
    v_mfma_f32_16x16x32_bf16 v[224:227], v[104:107], v[164:167], 0
    v_mfma_f32_16x16x32_bf16 v[228:231], v[104:107], v[170:173], 0
    v_mfma_f32_16x16x32_bf16 v[232:235], v[108:111], v[164:167], 0
    v_mfma_f32_16x16x32_bf16 v[236:239], v[108:111], v[170:173], 0
    v_mfma_f32_16x16x16_bf16 v[240:243], v[248:249], v[168:169], v[240:243]
    v_mfma_f32_16x16x16_bf16 v[244:247], v[248:249], v[174:175], v[244:247]
    v_mfma_f32_16x16x16_bf16 v[176:179], v[128:129], v[168:169], v[176:179]
    v_mfma_f32_16x16x16_bf16 v[180:183], v[128:129], v[174:175], v[180:183]
    v_mfma_f32_16x16x16_bf16 v[184:187], v[130:131], v[168:169], v[184:187]
    v_mfma_f32_16x16x16_bf16 v[188:191], v[130:131], v[174:175], v[188:191]
    v_mfma_f32_16x16x16_bf16 v[192:195], v[132:133], v[168:169], v[192:195]
    v_mfma_f32_16x16x16_bf16 v[196:199], v[132:133], v[174:175], v[196:199]
    v_mfma_f32_16x16x16_bf16 v[200:203], v[134:135], v[168:169], v[200:203]
    v_mfma_f32_16x16x16_bf16 v[204:207], v[134:135], v[174:175], v[204:207]
    v_mfma_f32_16x16x16_bf16 v[208:211], v[136:137], v[168:169], v[208:211]
    v_mfma_f32_16x16x16_bf16 v[212:215], v[136:137], v[174:175], v[212:215]
    v_mfma_f32_16x16x16_bf16 v[216:219], v[138:139], v[168:169], v[216:219]
    v_mfma_f32_16x16x16_bf16 v[220:223], v[138:139], v[174:175], v[220:223]
    v_mfma_f32_16x16x16_bf16 v[224:227], v[140:141], v[168:169], v[224:227]
    v_mfma_f32_16x16x16_bf16 v[228:231], v[140:141], v[174:175], v[228:231]
    v_mfma_f32_16x16x16_bf16 v[232:235], v[142:143], v[168:169], v[232:235]
    v_mfma_f32_16x16x16_bf16 v[236:239], v[142:143], v[174:175], v[236:239]
    v_rcp_f32 v8, v240
    v_rcp_f32 v9, v244
    s_nop 7
    v_mul_f32 v176, v176, v8
    v_mul_f32 v177, v177, v8
    v_mul_f32 v178, v178, v8
    v_mul_f32 v179, v179, v8
    v_cvt_pk_bf16_f32 v16, v176, v177
    v_cvt_pk_bf16_f32 v17, v178, v179
    v_mul_f32 v184, v184, v8
    v_mul_f32 v185, v185, v8
    v_mul_f32 v186, v186, v8
    v_mul_f32 v187, v187, v8
    v_cvt_pk_bf16_f32 v18, v184, v185
    v_cvt_pk_bf16_f32 v19, v186, v187
    s_add_u32 s64, s32, 0x0
    buffer_store_dwordx4 v[16:19], v1, s[4:7], s64 offen offset:0 sc1
    v_mul_f32 v192, v192, v8
    v_mul_f32 v193, v193, v8
    v_mul_f32 v194, v194, v8
    v_mul_f32 v195, v195, v8
    v_cvt_pk_bf16_f32 v20, v192, v193
    v_cvt_pk_bf16_f32 v21, v194, v195
    v_mul_f32 v200, v200, v8
    v_mul_f32 v201, v201, v8
    v_mul_f32 v202, v202, v8
    v_mul_f32 v203, v203, v8
    v_cvt_pk_bf16_f32 v22, v200, v201
    v_cvt_pk_bf16_f32 v23, v202, v203
    s_add_u32 s64, s32, 0x0
    buffer_store_dwordx4 v[20:23], v1, s[4:7], s64 offen offset:1024 sc1
    v_mul_f32 v208, v208, v8
    v_mul_f32 v209, v209, v8
    v_mul_f32 v210, v210, v8
    v_mul_f32 v211, v211, v8
    v_cvt_pk_bf16_f32 v24, v208, v209
    v_cvt_pk_bf16_f32 v25, v210, v211
    v_mul_f32 v216, v216, v8
    v_mul_f32 v217, v217, v8
    v_mul_f32 v218, v218, v8
    v_mul_f32 v219, v219, v8
    v_cvt_pk_bf16_f32 v26, v216, v217
    v_cvt_pk_bf16_f32 v27, v218, v219
    s_add_u32 s64, s32, 0x0
    buffer_store_dwordx4 v[24:27], v1, s[4:7], s64 offen offset:2048 sc1
    v_mul_f32 v224, v224, v8
    v_mul_f32 v225, v225, v8
    v_mul_f32 v226, v226, v8
    v_mul_f32 v227, v227, v8
    v_cvt_pk_bf16_f32 v28, v224, v225
    v_cvt_pk_bf16_f32 v29, v226, v227
    v_mul_f32 v232, v232, v8
    v_mul_f32 v233, v233, v8
    v_mul_f32 v234, v234, v8
    v_mul_f32 v235, v235, v8
    v_cvt_pk_bf16_f32 v30, v232, v233
    v_cvt_pk_bf16_f32 v31, v234, v235
    s_add_u32 s64, s32, 0x0
    buffer_store_dwordx4 v[28:31], v1, s[4:7], s64 offen offset:3072 sc1
    v_mul_f32 v180, v180, v9
    v_mul_f32 v181, v181, v9
    v_mul_f32 v182, v182, v9
    v_mul_f32 v183, v183, v9
    v_cvt_pk_bf16_f32 v32, v180, v181
    v_cvt_pk_bf16_f32 v33, v182, v183
    v_mul_f32 v188, v188, v9
    v_mul_f32 v189, v189, v9
    v_mul_f32 v190, v190, v9
    v_mul_f32 v191, v191, v9
    v_cvt_pk_bf16_f32 v34, v188, v189
    v_cvt_pk_bf16_f32 v35, v190, v191
    s_add_u32 s64, s32, 0x20000
    buffer_store_dwordx4 v[32:35], v1, s[4:7], s64 offen offset:0 sc1
    v_mul_f32 v196, v196, v9
    v_mul_f32 v197, v197, v9
    v_mul_f32 v198, v198, v9
    v_mul_f32 v199, v199, v9
    v_cvt_pk_bf16_f32 v36, v196, v197
    v_cvt_pk_bf16_f32 v37, v198, v199
    v_mul_f32 v204, v204, v9
    v_mul_f32 v205, v205, v9
    v_mul_f32 v206, v206, v9
    v_mul_f32 v207, v207, v9
    v_cvt_pk_bf16_f32 v38, v204, v205
    v_cvt_pk_bf16_f32 v39, v206, v207
    s_add_u32 s64, s32, 0x20000
    buffer_store_dwordx4 v[36:39], v1, s[4:7], s64 offen offset:1024 sc1
    v_mul_f32 v212, v212, v9
    v_mul_f32 v213, v213, v9
    v_mul_f32 v214, v214, v9
    v_mul_f32 v215, v215, v9
    v_cvt_pk_bf16_f32 v40, v212, v213
    v_cvt_pk_bf16_f32 v41, v214, v215
    v_mul_f32 v220, v220, v9
    v_mul_f32 v221, v221, v9
    v_mul_f32 v222, v222, v9
    v_mul_f32 v223, v223, v9
    v_cvt_pk_bf16_f32 v42, v220, v221
    v_cvt_pk_bf16_f32 v43, v222, v223
    s_add_u32 s64, s32, 0x20000
    buffer_store_dwordx4 v[40:43], v1, s[4:7], s64 offen offset:2048 sc1
    v_mul_f32 v228, v228, v9
    v_mul_f32 v229, v229, v9
    v_mul_f32 v230, v230, v9
    v_mul_f32 v231, v231, v9
    v_cvt_pk_bf16_f32 v44, v228, v229
    v_cvt_pk_bf16_f32 v45, v230, v231
    v_mul_f32 v236, v236, v9
    v_mul_f32 v237, v237, v9
    v_mul_f32 v238, v238, v9
    v_mul_f32 v239, v239, v9
    v_cvt_pk_bf16_f32 v46, v236, v237
    v_cvt_pk_bf16_f32 v47, v238, v239
    s_add_u32 s64, s32, 0x20000
    buffer_store_dwordx4 v[44:47], v1, s[4:7], s64 offen offset:3072 sc1
    s_waitcnt vmcnt(0)
    v_mov_b32 v7, 1
    v_mov_b32 v8, 0
    s_mov_b64 exec, 1
    buffer_store_dword v7, v8, s[4:7], s33 offen sc1
    s_mov_b64 exec, -1
    s_add_u32 s24, s24, 8
    s_add_u32 s25, s25, 1
    s_cmp_lt_u32 s25, 2
    s_cbranch_scc1 AT1_LOOP
AT1_END:
    s_lshl_b32 s70, s13, 1
    s_add_u32 s70, s70, s12
    s_load_dwordx2 s[44:45], s[0:1], 72
    s_mov_b32 s46, 0x21c000
    s_mov_b32 s47, 0x00020000
    s_load_dwordx2 s[48:49], s[0:1], 80
    s_mov_b32 s50, 0x21c000
    s_mov_b32 s51, 0x00020000
    s_load_dwordx2 s[52:53], s[0:1], 88
    s_mov_b32 s54, 0x21c000
    s_mov_b32 s55, 0x00020000
    s_mov_b32 s29, 0
    s_waitcnt lgkmcnt(0)
    v_mbcnt_lo_u32_b32 v0, -1, 0
    v_mbcnt_hi_u32_b32 v0, -1, v0
    s_cmp_lg_u32 s14, 0
    s_cbranch_scc1 H_ATT
    s_cmp_ge_u32 s70, 40
    s_cbranch_scc1 H_ATT
    s_mov_b32 s24, s70
    v_mov_b32 v8, 0
    s_mov_b32 s64, 0x298080
F2W_181:
    buffer_load_dword v7, v8, s[4:7], s64 offen sc1
    s_add_u32 s29, s29, 1
    s_waitcnt vmcnt(0)
    v_mov_b32 v9, 108
    v_cmp_gt_u32 vcc, v9, v7
    s_cbranch_vccz F2WD_182
    s_cmp_gt_u32 s29, 262144
    s_cbranch_scc1 F2WD_182
    s_sleep 8
    s_branch F2W_181
F2WD_182:
    s_mov_b32 s25, 0
    v_lshrrev_b32 v7, 1, v0
    v_mul_u32_u24 v2, 1280, v7
    v_and_b32 v7, 1, v0
    v_lshl_add_u32 v2, v7, 4, v2
    v_lshrrev_b32 v7, 4, v0
    v_lshlrev_b32 v3, 7, v7
    v_bfe_u32 v7, v0, 2, 2
    v_lshl_add_u32 v3, v7, 5, v3
    v_and_b32 v7, 3, v0
    v_lshl_add_u32 v3, v7, 3, v3
    v_add_u32 v3, s25, v3
    v_lshlrev_b32 v4, 4, v0
    s_mov_b32 s65, 0x5401000
    buffer_load_dwordx4 v[16:19], v4, s[4:7], s65 offen offset:0 sc1
    buffer_load_dwordx4 v[20:23], v4, s[4:7], s65 offen offset:1024 sc1
    buffer_load_dwordx4 v[24:27], v4, s[4:7], s65 offen offset:2048 sc1
    buffer_load_dwordx4 v[28:31], v4, s[4:7], s65 offen offset:3072 sc1
    s_add_u32 s65, s65, 4096
    buffer_load_dwordx4 v[32:35], v4, s[4:7], s65 offen offset:0 sc1
    buffer_load_dwordx4 v[36:39], v4, s[4:7], s65 offen offset:1024 sc1
    buffer_load_dwordx4 v[40:43], v4, s[4:7], s65 offen offset:2048 sc1
    buffer_load_dwordx4 v[44:47], v4, s[4:7], s65 offen offset:3072 sc1
    s_add_u32 s65, s65, 4096
    buffer_load_dwordx4 v[48:51], v4, s[4:7], s65 offen offset:0 sc1
    buffer_load_dwordx4 v[52:55], v4, s[4:7], s65 offen offset:1024 sc1
    buffer_load_dwordx4 v[56:59], v4, s[4:7], s65 offen offset:2048 sc1
    buffer_load_dwordx4 v[60:63], v4, s[4:7], s65 offen offset:3072 sc1
    s_add_u32 s65, s65, 4096
    buffer_load_dwordx4 v[64:67], v4, s[4:7], s65 offen offset:0 sc1
    buffer_load_dwordx4 v[68:71], v4, s[4:7], s65 offen offset:1024 sc1
    buffer_load_dwordx4 v[72:75], v4, s[4:7], s65 offen offset:2048 sc1
    buffer_load_dwordx4 v[76:79], v4, s[4:7], s65 offen offset:3072 sc1
    s_add_u32 s65, s65, 4096
    buffer_load_dwordx4 v[80:83], v4, s[4:7], s65 offen offset:0 sc1
    buffer_load_dwordx4 v[84:87], v4, s[4:7], s65 offen offset:1024 sc1
    buffer_load_dwordx4 v[88:91], v4, s[4:7], s65 offen offset:2048 sc1
    buffer_load_dwordx4 v[92:95], v4, s[4:7], s65 offen offset:3072 sc1
    s_add_u32 s65, s65, 4096
    buffer_load_dwordx4 v[96:99], v4, s[4:7], s65 offen offset:0 sc1
    buffer_load_dwordx4 v[100:103], v4, s[4:7], s65 offen offset:1024 sc1
    buffer_load_dwordx4 v[104:107], v4, s[4:7], s65 offen offset:2048 sc1
    buffer_load_dwordx4 v[108:111], v4, s[4:7], s65 offen offset:3072 sc1
    s_add_u32 s65, s65, 4096
    buffer_load_dwordx4 v[112:115], v4, s[4:7], s65 offen offset:0 sc1
    buffer_load_dwordx4 v[116:119], v4, s[4:7], s65 offen offset:1024 sc1
    buffer_load_dwordx4 v[120:123], v4, s[4:7], s65 offen offset:2048 sc1
    buffer_load_dwordx4 v[124:127], v4, s[4:7], s65 offen offset:3072 sc1
    s_add_u32 s65, s65, 4096
    buffer_load_dwordx4 v[128:131], v4, s[4:7], s65 offen offset:0 sc1
    buffer_load_dwordx4 v[132:135], v4, s[4:7], s65 offen offset:1024 sc1
    buffer_load_dwordx4 v[136:139], v4, s[4:7], s65 offen offset:2048 sc1
    buffer_load_dwordx4 v[140:143], v4, s[4:7], s65 offen offset:3072 sc1
    s_add_u32 s65, s65, 4096
    buffer_load_dwordx4 v[144:147], v4, s[4:7], s65 offen offset:0 sc1
    buffer_load_dwordx4 v[148:151], v4, s[4:7], s65 offen offset:1024 sc1
    buffer_load_dwordx4 v[152:155], v4, s[4:7], s65 offen offset:2048 sc1
    buffer_load_dwordx4 v[156:159], v4, s[4:7], s65 offen offset:3072 sc1
    s_add_u32 s65, s65, 4096
    buffer_load_dwordx4 v[160:163], v4, s[4:7], s65 offen offset:0 sc1
    buffer_load_dwordx4 v[164:167], v4, s[4:7], s65 offen offset:1024 sc1
    buffer_load_dwordx4 v[168:171], v4, s[4:7], s65 offen offset:2048 sc1
    buffer_load_dwordx4 v[172:175], v4, s[4:7], s65 offen offset:3072 sc1
    s_add_u32 s65, s65, 4096
    buffer_load_dwordx4 v[176:179], v4, s[4:7], s65 offen offset:0 sc1
    s_waitcnt vmcnt(20)
    buffer_load_dwordx4 v[180:183], v4, s[4:7], s65 offen offset:1024 sc1
    buffer_load_dwordx4 v[184:187], v4, s[4:7], s65 offen offset:2048 sc1
    buffer_load_dwordx4 v[188:191], v4, s[4:7], s65 offen offset:3072 sc1
    s_add_u32 s65, s65, 4096
    buffer_load_dwordx4 v[192:195], v4, s[4:7], s65 offen offset:0 sc1
    buffer_load_dwordx4 v[196:199], v4, s[4:7], s65 offen offset:1024 sc1
    buffer_load_dwordx4 v[200:203], v4, s[4:7], s65 offen offset:2048 sc1
    buffer_load_dwordx4 v[204:207], v4, s[4:7], s65 offen offset:3072 sc1
    s_add_u32 s65, s65, 4096
    buffer_load_dwordx4 v[208:211], v4, s[4:7], s65 offen offset:0 sc1
    buffer_load_dwordx4 v[212:215], v4, s[4:7], s65 offen offset:1024 sc1
    buffer_load_dwordx4 v[216:219], v4, s[4:7], s65 offen offset:2048 sc1
    buffer_load_dwordx4 v[220:223], v4, s[4:7], s65 offen offset:3072 sc1
    s_add_u32 s65, s65, 4096
    buffer_load_dwordx4 v[224:227], v4, s[4:7], s65 offen offset:0 sc1
    buffer_load_dwordx4 v[228:231], v4, s[4:7], s65 offen offset:1024 sc1
    s_waitcnt vmcnt(0)
    s_lshl_b32 s26, s24, 5
    s_add_u32 m0, s25, 0
    s_add_u32 s64, s26, 0x0
    buffer_load_dwordx4 v2, s[52:55], s64 offen lds
    s_add_u32 m0, s25, 1024
    s_add_u32 s64, s26, 0xa000
    buffer_load_dwordx4 v2, s[52:55], s64 offen lds
    s_add_u32 m0, s25, 2048
    s_add_u32 s64, s26, 0x14000
    buffer_load_dwordx4 v2, s[52:55], s64 offen lds
    s_add_u32 m0, s25, 3072
    s_add_u32 s64, s26, 0x1e000
    buffer_load_dwordx4 v2, s[52:55], s64 offen lds
    s_add_u32 m0, s25, 4096
    s_add_u32 s64, s26, 0x28000
    buffer_load_dwordx4 v2, s[52:55], s64 offen lds
    s_add_u32 m0, s25, 5120
    s_add_u32 s64, s26, 0x32000
    buffer_load_dwordx4 v2, s[52:55], s64 offen lds
    s_add_u32 m0, s25, 6144
    s_add_u32 s64, s26, 0x3c000
    buffer_load_dwordx4 v2, s[52:55], s64 offen lds
    s_add_u32 m0, s25, 7168
    s_add_u32 s64, s26, 0x46000
    buffer_load_dwordx4 v2, s[52:55], s64 offen lds
    s_add_u32 m0, s25, 8192
    s_add_u32 s64, s26, 0x50000
    buffer_load_dwordx4 v2, s[52:55], s64 offen lds
    s_add_u32 m0, s25, 9216
    s_add_u32 s64, s26, 0x5a000
    buffer_load_dwordx4 v2, s[52:55], s64 offen lds
    s_add_u32 m0, s25, 10240
    s_add_u32 s64, s26, 0x64000
    buffer_load_dwordx4 v2, s[52:55], s64 offen lds
    s_add_u32 m0, s25, 11264
    s_add_u32 s64, s26, 0x6e000
    buffer_load_dwordx4 v2, s[52:55], s64 offen lds
    s_add_u32 m0, s25, 12288
    s_add_u32 s64, s26, 0x78000
    buffer_load_dwordx4 v2, s[52:55], s64 offen lds
    s_add_u32 m0, s25, 13312
    s_add_u32 s64, s26, 0x82000
    buffer_load_dwordx4 v2, s[52:55], s64 offen lds
    s_add_u32 m0, s25, 14336
    s_add_u32 s64, s26, 0x8c000
    buffer_load_dwordx4 v2, s[52:55], s64 offen lds
    s_add_u32 m0, s25, 15360
    s_add_u32 s64, s26, 0x96000
    buffer_load_dwordx4 v2, s[52:55], s64 offen lds
    s_add_u32 m0, s25, 16384
    s_add_u32 s64, s26, 0xa0000
    buffer_load_dwordx4 v2, s[52:55], s64 offen lds
    s_add_u32 m0, s25, 17408
    s_add_u32 s64, s26, 0xaa000
    buffer_load_dwordx4 v2, s[52:55], s64 offen lds
    s_add_u32 m0, s25, 18432
    s_add_u32 s64, s26, 0xb4000
    buffer_load_dwordx4 v2, s[52:55], s64 offen lds
    s_add_u32 m0, s25, 19456
    s_add_u32 s64, s26, 0xbe000
    buffer_load_dwordx4 v2, s[52:55], s64 offen lds
    s_add_u32 m0, s25, 20480
    s_add_u32 s64, s26, 0xc8000
    buffer_load_dwordx4 v2, s[52:55], s64 offen lds
    s_add_u32 m0, s25, 21504
    s_add_u32 s64, s26, 0xd2000
    buffer_load_dwordx4 v2, s[52:55], s64 offen lds
    s_add_u32 m0, s25, 22528
    s_add_u32 s64, s26, 0xdc000
    buffer_load_dwordx4 v2, s[52:55], s64 offen lds
    s_add_u32 m0, s25, 23552
    s_add_u32 s64, s26, 0xe6000
    buffer_load_dwordx4 v2, s[52:55], s64 offen lds
    s_add_u32 m0, s25, 24576
    s_add_u32 s64, s26, 0xf0000
    buffer_load_dwordx4 v2, s[52:55], s64 offen lds
    s_add_u32 m0, s25, 25600
    s_add_u32 s64, s26, 0xfa000
    buffer_load_dwordx4 v2, s[52:55], s64 offen lds
    s_add_u32 m0, s25, 26624
    s_add_u32 s64, s26, 0x104000
    buffer_load_dwordx4 v2, s[52:55], s64 offen lds
    s_add_u32 m0, s25, 27648
    s_add_u32 s64, s26, 0x10e000
    buffer_load_dwordx4 v2, s[52:55], s64 offen lds
    s_add_u32 m0, s25, 28672
    s_add_u32 s64, s26, 0x118000
    buffer_load_dwordx4 v2, s[52:55], s64 offen lds
    s_add_u32 m0, s25, 29696
    s_add_u32 s64, s26, 0x122000
    buffer_load_dwordx4 v2, s[52:55], s64 offen lds
    s_add_u32 m0, s25, 30720
    s_add_u32 s64, s26, 0x12c000
    buffer_load_dwordx4 v2, s[52:55], s64 offen lds
    s_add_u32 m0, s25, 31744
    s_add_u32 s64, s26, 0x136000
    buffer_load_dwordx4 v2, s[52:55], s64 offen lds
    s_add_u32 m0, s25, 32768
    s_add_u32 s64, s26, 0x140000
    buffer_load_dwordx4 v2, s[52:55], s64 offen lds
    s_add_u32 m0, s25, 33792
    s_add_u32 s64, s26, 0x14a000
    buffer_load_dwordx4 v2, s[52:55], s64 offen lds
    s_add_u32 m0, s25, 34816
    s_add_u32 s64, s26, 0x154000
    buffer_load_dwordx4 v2, s[52:55], s64 offen lds
    s_add_u32 m0, s25, 35840
    s_add_u32 s64, s26, 0x15e000
    buffer_load_dwordx4 v2, s[52:55], s64 offen lds
    s_add_u32 m0, s25, 36864
    s_add_u32 s64, s26, 0x168000
    buffer_load_dwordx4 v2, s[52:55], s64 offen lds
    s_add_u32 m0, s25, 37888
    s_add_u32 s64, s26, 0x172000
    buffer_load_dwordx4 v2, s[52:55], s64 offen lds
    s_add_u32 m0, s25, 38912
    s_add_u32 s64, s26, 0x17c000
    buffer_load_dwordx4 v2, s[52:55], s64 offen lds
    s_add_u32 m0, s25, 39936
    s_add_u32 s64, s26, 0x186000
    buffer_load_dwordx4 v2, s[52:55], s64 offen lds
    s_add_u32 m0, s25, 40960
    s_add_u32 s64, s26, 0x190000
    buffer_load_dwordx4 v2, s[52:55], s64 offen lds
    s_waitcnt vmcnt(20)
    s_add_u32 m0, s25, 41984
    s_add_u32 s64, s26, 0x19a000
    buffer_load_dwordx4 v2, s[52:55], s64 offen lds
    s_add_u32 m0, s25, 43008
    s_add_u32 s64, s26, 0x1a4000
    buffer_load_dwordx4 v2, s[52:55], s64 offen lds
    s_add_u32 m0, s25, 44032
    s_add_u32 s64, s26, 0x1ae000
    buffer_load_dwordx4 v2, s[52:55], s64 offen lds
    s_add_u32 m0, s25, 45056
    s_add_u32 s64, s26, 0x1b8000
    buffer_load_dwordx4 v2, s[52:55], s64 offen lds
    s_add_u32 m0, s25, 46080
    s_add_u32 s64, s26, 0x1c2000
    buffer_load_dwordx4 v2, s[52:55], s64 offen lds
    s_add_u32 m0, s25, 47104
    s_add_u32 s64, s26, 0x1cc000
    buffer_load_dwordx4 v2, s[52:55], s64 offen lds
    s_add_u32 m0, s25, 48128
    s_add_u32 s64, s26, 0x1d6000
    buffer_load_dwordx4 v2, s[52:55], s64 offen lds
    s_add_u32 m0, s25, 49152
    s_add_u32 s64, s26, 0x1e0000
    buffer_load_dwordx4 v2, s[52:55], s64 offen lds
    s_add_u32 m0, s25, 50176
    s_add_u32 s64, s26, 0x1ea000
    buffer_load_dwordx4 v2, s[52:55], s64 offen lds
    s_add_u32 m0, s25, 51200
    s_add_u32 s64, s26, 0x1f4000
    buffer_load_dwordx4 v2, s[52:55], s64 offen lds
    s_add_u32 m0, s25, 52224
    s_add_u32 s64, s26, 0x1fe000
    buffer_load_dwordx4 v2, s[52:55], s64 offen lds
    s_add_u32 m0, s25, 53248
    s_add_u32 s64, s26, 0x208000
    buffer_load_dwordx4 v2, s[52:55], s64 offen lds
    s_add_u32 m0, s25, 54272
    s_add_u32 s64, s26, 0x212000
    buffer_load_dwordx4 v2, s[52:55], s64 offen lds
    s_waitcnt vmcnt(0)
    ds_read_b64_tr_b16 v[232:233], v3 offset:0
    ds_read_b64_tr_b16 v[234:235], v3 offset:512
    s_waitcnt lgkmcnt(0)
    v_mfma_f32_16x16x32_bf16 v[8:11], v[232:235], v[16:19], 0
    ds_read_b64_tr_b16 v[236:237], v3 offset:1024
    ds_read_b64_tr_b16 v[238:239], v3 offset:1536
    s_waitcnt lgkmcnt(0)
    v_mfma_f32_16x16x32_bf16 v[8:11], v[236:239], v[20:23], v[8:11]
    ds_read_b64_tr_b16 v[240:241], v3 offset:2048
    ds_read_b64_tr_b16 v[242:243], v3 offset:2560
    s_waitcnt lgkmcnt(0)
    v_mfma_f32_16x16x32_bf16 v[8:11], v[240:243], v[24:27], v[8:11]
    ds_read_b64_tr_b16 v[244:245], v3 offset:3072
    ds_read_b64_tr_b16 v[246:247], v3 offset:3584
    s_waitcnt lgkmcnt(0)
    v_mfma_f32_16x16x32_bf16 v[8:11], v[244:247], v[28:31], v[8:11]
    ds_read_b64_tr_b16 v[232:233], v3 offset:4096
    ds_read_b64_tr_b16 v[234:235], v3 offset:4608
    s_waitcnt lgkmcnt(0)
    v_mfma_f32_16x16x32_bf16 v[8:11], v[232:235], v[32:35], v[8:11]
    ds_read_b64_tr_b16 v[236:237], v3 offset:5120
    ds_read_b64_tr_b16 v[238:239], v3 offset:5632
    s_waitcnt lgkmcnt(0)
    v_mfma_f32_16x16x32_bf16 v[8:11], v[236:239], v[36:39], v[8:11]
    ds_read_b64_tr_b16 v[240:241], v3 offset:6144
    ds_read_b64_tr_b16 v[242:243], v3 offset:6656
    s_waitcnt lgkmcnt(0)
    v_mfma_f32_16x16x32_bf16 v[8:11], v[240:243], v[40:43], v[8:11]
    ds_read_b64_tr_b16 v[244:245], v3 offset:7168
    ds_read_b64_tr_b16 v[246:247], v3 offset:7680
    s_waitcnt lgkmcnt(0)
    v_mfma_f32_16x16x32_bf16 v[8:11], v[244:247], v[44:47], v[8:11]
    ds_read_b64_tr_b16 v[232:233], v3 offset:8192
    ds_read_b64_tr_b16 v[234:235], v3 offset:8704
    s_waitcnt lgkmcnt(0)
    v_mfma_f32_16x16x32_bf16 v[8:11], v[232:235], v[48:51], v[8:11]
    ds_read_b64_tr_b16 v[236:237], v3 offset:9216
    ds_read_b64_tr_b16 v[238:239], v3 offset:9728
    s_waitcnt lgkmcnt(0)
    v_mfma_f32_16x16x32_bf16 v[8:11], v[236:239], v[52:55], v[8:11]
    ds_read_b64_tr_b16 v[240:241], v3 offset:10240
    ds_read_b64_tr_b16 v[242:243], v3 offset:10752
    s_waitcnt lgkmcnt(0)
    v_mfma_f32_16x16x32_bf16 v[8:11], v[240:243], v[56:59], v[8:11]
    ds_read_b64_tr_b16 v[244:245], v3 offset:11264
    ds_read_b64_tr_b16 v[246:247], v3 offset:11776
    s_waitcnt lgkmcnt(0)
    v_mfma_f32_16x16x32_bf16 v[8:11], v[244:247], v[60:63], v[8:11]
    ds_read_b64_tr_b16 v[232:233], v3 offset:12288
    ds_read_b64_tr_b16 v[234:235], v3 offset:12800
    s_waitcnt lgkmcnt(0)
    v_mfma_f32_16x16x32_bf16 v[8:11], v[232:235], v[64:67], v[8:11]
    ds_read_b64_tr_b16 v[236:237], v3 offset:13312
    ds_read_b64_tr_b16 v[238:239], v3 offset:13824
    s_waitcnt lgkmcnt(0)
    v_mfma_f32_16x16x32_bf16 v[8:11], v[236:239], v[68:71], v[8:11]
    ds_read_b64_tr_b16 v[240:241], v3 offset:14336
    ds_read_b64_tr_b16 v[242:243], v3 offset:14848
    s_waitcnt lgkmcnt(0)
    v_mfma_f32_16x16x32_bf16 v[8:11], v[240:243], v[72:75], v[8:11]
    ds_read_b64_tr_b16 v[244:245], v3 offset:15360
    ds_read_b64_tr_b16 v[246:247], v3 offset:15872
    s_waitcnt lgkmcnt(0)
    v_mfma_f32_16x16x32_bf16 v[8:11], v[244:247], v[76:79], v[8:11]
    ds_read_b64_tr_b16 v[232:233], v3 offset:16384
    ds_read_b64_tr_b16 v[234:235], v3 offset:16896
    s_waitcnt lgkmcnt(0)
    v_mfma_f32_16x16x32_bf16 v[8:11], v[232:235], v[80:83], v[8:11]
    ds_read_b64_tr_b16 v[236:237], v3 offset:17408
    ds_read_b64_tr_b16 v[238:239], v3 offset:17920
    s_waitcnt lgkmcnt(0)
    v_mfma_f32_16x16x32_bf16 v[8:11], v[236:239], v[84:87], v[8:11]
    ds_read_b64_tr_b16 v[240:241], v3 offset:18432
    ds_read_b64_tr_b16 v[242:243], v3 offset:18944
    s_waitcnt lgkmcnt(0)
    v_mfma_f32_16x16x32_bf16 v[8:11], v[240:243], v[88:91], v[8:11]
    ds_read_b64_tr_b16 v[244:245], v3 offset:19456
    ds_read_b64_tr_b16 v[246:247], v3 offset:19968
    s_waitcnt lgkmcnt(0)
    v_mfma_f32_16x16x32_bf16 v[8:11], v[244:247], v[92:95], v[8:11]
    ds_read_b64_tr_b16 v[232:233], v3 offset:20480
    ds_read_b64_tr_b16 v[234:235], v3 offset:20992
    s_waitcnt lgkmcnt(0)
    v_mfma_f32_16x16x32_bf16 v[8:11], v[232:235], v[96:99], v[8:11]
    ds_read_b64_tr_b16 v[236:237], v3 offset:21504
    ds_read_b64_tr_b16 v[238:239], v3 offset:22016
    s_waitcnt lgkmcnt(0)
    v_mfma_f32_16x16x32_bf16 v[8:11], v[236:239], v[100:103], v[8:11]
    ds_read_b64_tr_b16 v[240:241], v3 offset:22528
    ds_read_b64_tr_b16 v[242:243], v3 offset:23040
    s_waitcnt lgkmcnt(0)
    v_mfma_f32_16x16x32_bf16 v[8:11], v[240:243], v[104:107], v[8:11]
    ds_read_b64_tr_b16 v[244:245], v3 offset:23552
    ds_read_b64_tr_b16 v[246:247], v3 offset:24064
    s_waitcnt lgkmcnt(0)
    v_mfma_f32_16x16x32_bf16 v[8:11], v[244:247], v[108:111], v[8:11]
    ds_read_b64_tr_b16 v[232:233], v3 offset:24576
    ds_read_b64_tr_b16 v[234:235], v3 offset:25088
    s_waitcnt lgkmcnt(0)
    v_mfma_f32_16x16x32_bf16 v[8:11], v[232:235], v[112:115], v[8:11]
    ds_read_b64_tr_b16 v[236:237], v3 offset:25600
    ds_read_b64_tr_b16 v[238:239], v3 offset:26112
    s_waitcnt lgkmcnt(0)
    v_mfma_f32_16x16x32_bf16 v[8:11], v[236:239], v[116:119], v[8:11]
    ds_read_b64_tr_b16 v[240:241], v3 offset:26624
    ds_read_b64_tr_b16 v[242:243], v3 offset:27136
    s_waitcnt lgkmcnt(0)
    v_mfma_f32_16x16x32_bf16 v[8:11], v[240:243], v[120:123], v[8:11]
    ds_read_b64_tr_b16 v[244:245], v3 offset:27648
    ds_read_b64_tr_b16 v[246:247], v3 offset:28160
    s_waitcnt lgkmcnt(0)
    v_mfma_f32_16x16x32_bf16 v[8:11], v[244:247], v[124:127], v[8:11]
    ds_read_b64_tr_b16 v[232:233], v3 offset:28672
    ds_read_b64_tr_b16 v[234:235], v3 offset:29184
    s_waitcnt lgkmcnt(0)
    v_mfma_f32_16x16x32_bf16 v[8:11], v[232:235], v[128:131], v[8:11]
    ds_read_b64_tr_b16 v[236:237], v3 offset:29696
    ds_read_b64_tr_b16 v[238:239], v3 offset:30208
    s_waitcnt lgkmcnt(0)
    v_mfma_f32_16x16x32_bf16 v[8:11], v[236:239], v[132:135], v[8:11]
    ds_read_b64_tr_b16 v[240:241], v3 offset:30720
    ds_read_b64_tr_b16 v[242:243], v3 offset:31232
    s_waitcnt lgkmcnt(0)
    v_mfma_f32_16x16x32_bf16 v[8:11], v[240:243], v[136:139], v[8:11]
    ds_read_b64_tr_b16 v[244:245], v3 offset:31744
    ds_read_b64_tr_b16 v[246:247], v3 offset:32256
    s_waitcnt lgkmcnt(0)
    v_mfma_f32_16x16x32_bf16 v[8:11], v[244:247], v[140:143], v[8:11]
    ds_read_b64_tr_b16 v[232:233], v3 offset:32768
    ds_read_b64_tr_b16 v[234:235], v3 offset:33280
    s_waitcnt lgkmcnt(0)
    v_mfma_f32_16x16x32_bf16 v[8:11], v[232:235], v[144:147], v[8:11]
    ds_read_b64_tr_b16 v[236:237], v3 offset:33792
    ds_read_b64_tr_b16 v[238:239], v3 offset:34304
    s_waitcnt lgkmcnt(0)
    v_mfma_f32_16x16x32_bf16 v[8:11], v[236:239], v[148:151], v[8:11]
    ds_read_b64_tr_b16 v[240:241], v3 offset:34816
    ds_read_b64_tr_b16 v[242:243], v3 offset:35328
    s_waitcnt lgkmcnt(0)
    v_mfma_f32_16x16x32_bf16 v[8:11], v[240:243], v[152:155], v[8:11]
    ds_read_b64_tr_b16 v[244:245], v3 offset:35840
    ds_read_b64_tr_b16 v[246:247], v3 offset:36352
    s_waitcnt lgkmcnt(0)
    v_mfma_f32_16x16x32_bf16 v[8:11], v[244:247], v[156:159], v[8:11]
    ds_read_b64_tr_b16 v[232:233], v3 offset:36864
    ds_read_b64_tr_b16 v[234:235], v3 offset:37376
    s_waitcnt lgkmcnt(0)
    v_mfma_f32_16x16x32_bf16 v[8:11], v[232:235], v[160:163], v[8:11]
    ds_read_b64_tr_b16 v[236:237], v3 offset:37888
    ds_read_b64_tr_b16 v[238:239], v3 offset:38400
    s_waitcnt lgkmcnt(0)
    v_mfma_f32_16x16x32_bf16 v[8:11], v[236:239], v[164:167], v[8:11]
    ds_read_b64_tr_b16 v[240:241], v3 offset:38912
    ds_read_b64_tr_b16 v[242:243], v3 offset:39424
    s_waitcnt lgkmcnt(0)
    v_mfma_f32_16x16x32_bf16 v[8:11], v[240:243], v[168:171], v[8:11]
    ds_read_b64_tr_b16 v[244:245], v3 offset:39936
    ds_read_b64_tr_b16 v[246:247], v3 offset:40448
    s_waitcnt lgkmcnt(0)
    v_mfma_f32_16x16x32_bf16 v[8:11], v[244:247], v[172:175], v[8:11]
    ds_read_b64_tr_b16 v[232:233], v3 offset:40960
    ds_read_b64_tr_b16 v[234:235], v3 offset:41472
    s_waitcnt lgkmcnt(0)
    v_mfma_f32_16x16x32_bf16 v[8:11], v[232:235], v[176:179], v[8:11]
    ds_read_b64_tr_b16 v[236:237], v3 offset:41984
    ds_read_b64_tr_b16 v[238:239], v3 offset:42496
    s_waitcnt lgkmcnt(0)
    v_mfma_f32_16x16x32_bf16 v[8:11], v[236:239], v[180:183], v[8:11]
    ds_read_b64_tr_b16 v[240:241], v3 offset:43008
    ds_read_b64_tr_b16 v[242:243], v3 offset:43520
    s_waitcnt lgkmcnt(0)
    v_mfma_f32_16x16x32_bf16 v[8:11], v[240:243], v[184:187], v[8:11]
    ds_read_b64_tr_b16 v[244:245], v3 offset:44032
    ds_read_b64_tr_b16 v[246:247], v3 offset:44544
    s_waitcnt lgkmcnt(0)
    v_mfma_f32_16x16x32_bf16 v[8:11], v[244:247], v[188:191], v[8:11]
    ds_read_b64_tr_b16 v[232:233], v3 offset:45056
    ds_read_b64_tr_b16 v[234:235], v3 offset:45568
    s_waitcnt lgkmcnt(0)
    v_mfma_f32_16x16x32_bf16 v[8:11], v[232:235], v[192:195], v[8:11]
    ds_read_b64_tr_b16 v[236:237], v3 offset:46080
    ds_read_b64_tr_b16 v[238:239], v3 offset:46592
    s_waitcnt lgkmcnt(0)
    v_mfma_f32_16x16x32_bf16 v[8:11], v[236:239], v[196:199], v[8:11]
    ds_read_b64_tr_b16 v[240:241], v3 offset:47104
    ds_read_b64_tr_b16 v[242:243], v3 offset:47616
    s_waitcnt lgkmcnt(0)
    v_mfma_f32_16x16x32_bf16 v[8:11], v[240:243], v[200:203], v[8:11]
    ds_read_b64_tr_b16 v[244:245], v3 offset:48128
    ds_read_b64_tr_b16 v[246:247], v3 offset:48640
    s_waitcnt lgkmcnt(0)
    v_mfma_f32_16x16x32_bf16 v[8:11], v[244:247], v[204:207], v[8:11]
    ds_read_b64_tr_b16 v[232:233], v3 offset:49152
    ds_read_b64_tr_b16 v[234:235], v3 offset:49664
    s_waitcnt lgkmcnt(0)
    v_mfma_f32_16x16x32_bf16 v[8:11], v[232:235], v[208:211], v[8:11]
    ds_read_b64_tr_b16 v[236:237], v3 offset:50176
    ds_read_b64_tr_b16 v[238:239], v3 offset:50688
    s_waitcnt lgkmcnt(0)
    v_mfma_f32_16x16x32_bf16 v[8:11], v[236:239], v[212:215], v[8:11]
    ds_read_b64_tr_b16 v[240:241], v3 offset:51200
    ds_read_b64_tr_b16 v[242:243], v3 offset:51712
    s_waitcnt lgkmcnt(0)
    v_mfma_f32_16x16x32_bf16 v[8:11], v[240:243], v[216:219], v[8:11]
    ds_read_b64_tr_b16 v[244:245], v3 offset:52224
    ds_read_b64_tr_b16 v[246:247], v3 offset:52736
    s_waitcnt lgkmcnt(0)
    v_mfma_f32_16x16x32_bf16 v[8:11], v[244:247], v[220:223], v[8:11]
    ds_read_b64_tr_b16 v[232:233], v3 offset:53248
    ds_read_b64_tr_b16 v[234:235], v3 offset:53760
    s_waitcnt lgkmcnt(0)
    v_mfma_f32_16x16x32_bf16 v[8:11], v[232:235], v[224:227], v[8:11]
    ds_read_b64_tr_b16 v[236:237], v3 offset:54272
    ds_read_b64_tr_b16 v[238:239], v3 offset:54784
    s_waitcnt lgkmcnt(0)
    v_mfma_f32_16x16x32_bf16 v[8:11], v[236:239], v[228:231], v[8:11]
    v_and_b32 v7, 7, v0
    v_lshlrev_b32 v7, 2, v7
    s_mov_b32 s64, 0x5400020
    buffer_load_dword v12, v7, s[4:7], s64 offen sc1
    s_waitcnt vmcnt(0)
    s_nop 7
    v_cvt_pk_bf16_f32 v8, v8, v8
    v_lshlrev_b32 v8, 16, v8
    v_mul_f32 v8, v8, v12
    v_cvt_pk_bf16_f32 v8, v8, v8
    v_lshlrev_b32 v8, 16, v8
    v_cvt_pk_bf16_f32 v9, v9, v9
    v_lshlrev_b32 v9, 16, v9
    v_mul_f32 v9, v9, v12
    v_cvt_pk_bf16_f32 v9, v9, v9
    v_lshlrev_b32 v9, 16, v9
    v_cvt_pk_bf16_f32 v10, v10, v10
    v_lshlrev_b32 v10, 16, v10
    v_mul_f32 v10, v10, v12
    v_cvt_pk_bf16_f32 v10, v10, v10
    v_lshlrev_b32 v10, 16, v10
    v_cvt_pk_bf16_f32 v11, v11, v11
    v_lshlrev_b32 v11, 16, v11
    v_mul_f32 v11, v11, v12
    v_cvt_pk_bf16_f32 v11, v11, v11
    v_lshlrev_b32 v11, 16, v11
    v_and_b32 v7, 7, v0
    v_mul_u32_u24 v7, 2560, v7
    v_lshrrev_b32 v13, 4, v0
    v_lshl_add_u32 v7, v13, 4, v7
    s_lshl_b32 s64, s24, 6
    s_add_u32 s64, s64, 0x5410000
    s_mov_b32 s68, 0x00ff00ff
    s_mov_b32 s69, 0x00ff00ff
    s_mov_b64 exec, s[68:69]
    buffer_store_dwordx4 v[8:11], v7, s[4:7], s64 offen sc1
    s_mov_b64 exec, -1
    s_waitcnt vmcnt(0)
    v_mov_b32 v7, 1
    v_mov_b32 v8, 0
    s_mov_b32 s64, 0x298100
    s_mov_b64 exec, 1
    buffer_atomic_add v7, v8, s[4:7], s64 offen sc1
    s_mov_b64 exec, -1
H_ATT:
    v_mbcnt_lo_u32_b32 v0, -1, 0
    v_mbcnt_hi_u32_b32 v0, -1, v0
    s_mov_b32 s29, 0
    v_lshlrev_b32 v1, 4, v0
    v_lshrrev_b32 v5, 4, v0
    v_lshlrev_b32 v2, 7, v5
    v_and_b32 v5, 7, v0
    v_lshl_add_u32 v2, v5, 4, v2
    v_bfe_u32 v5, v0, 4, 1
    v_lshlrev_b32 v3, 7, v5
    v_and_b32 v5, 15, v0
    v_lshl_add_u32 v3, v5, 3, v3
    s_mov_b32 s34, 0x3e0293ee
    s_mov_b32 s35, 0x3e0293ee
    s_mov_b32 s36, -1
    s_mov_b32 s37, 0
    v_lshrrev_b32 v5, 4, v0
    v_lshlrev_b32 v5, 2, v5
    v_and_b32 v6, 15, v0
    v_add_u32 v7, 0, v5
    v_cmp_le_u32 s[38:39], v7, v6
    v_add_u32 v7, 1, v5
    v_cmp_le_u32 s[40:41], v7, v6
    v_add_u32 v7, 2, v5
    v_cmp_le_u32 s[42:43], v7, v6
    v_add_u32 v7, 3, v5
    v_cmp_le_u32 s[44:45], v7, v6
    v_mov_b32 v248, 0x3f803f80
    v_mov_b32 v249, 0x3f803f80
    v_mov_b32 v250, 0x3f803f80
    v_mov_b32 v251, 0x3f803f80
    s_lshl_b32 s24, s12, 2
    s_add_u32 s24, s24, s14
    s_add_u32 s24, s24, 16
    s_mov_b32 s25, 2
AT2_LOOP:
    s_cmp_eq_u32 s24, 63
    s_cbranch_scc1 AT2_END
    s_lshl_b32 s64, s24, 5
    s_add_u32 s64, s64, s13
    s_lshl_b32 s26, s64, 13
    s_add_u32 s26, s26, 0x3400000
    s_lshl_b32 s27, s64, 14
    s_add_u32 s27, s27, 0x1400000
    s_lshl_b32 s65, s64, 11
    s_add_u32 s30, s65, 0x640000
    s_add_u32 s31, s65, 0xa40000
    s_lshl_b32 s33, s64, 2
    s_add_u32 s33, s33, 0x296000
    s_lshl_b32 s32, s24, 18
    s_lshl_b32 s65, s13, 12
    s_add_u32 s32, s32, s65
    s_add_u32 s32, s32, 0x4400000
    s_lshr_b32 s65, s24, 2
    s_lshl_b32 s65, s65, 9
    s_lshl_b32 s66, s13, 4
    s_add_u32 s65, s65, s66
    s_add_u32 s65, s65, 0x291000
    s_lshr_b32 s66, s24, 1
    s_lshl_b32 s66, s66, 8
    s_lshl_b32 s64, s13, 3
    s_add_u32 s66, s66, s64
    s_add_u32 s66, s66, 0x293ff4
    v_lshlrev_b32 v5, 2, v0
    v_mov_b32 v6, s65
    v_mov_b32 v7, s66
    v_cmp_gt_u32 vcc, 3, v0
    s_nop 1
    v_cndmask_b32 v6, v7, v6, vcc
    v_add_u32 v4, v5, v6
    s_mov_b32 s64, 0
    s_mov_b64 exec, 7
AT2_F_183:
    buffer_load_dword v5, v4, s[4:7], s64 offen sc1
    s_add_u32 s29, s29, 1
    s_waitcnt vmcnt(0)
    v_cmp_eq_u32 vcc, 0, v5
    s_cbranch_vccz AT2_FD_184
    s_cmp_gt_u32 s29, 262144
    s_cbranch_scc1 AT2_FD_184
    s_sleep 1
    s_branch AT2_F_183
AT2_FD_184:
    s_mov_b64 exec, -1
    buffer_load_dwordx4 v[16:19], v1, s[4:7], s26 offen offset:0
    buffer_load_dwordx4 v[20:23], v1, s[4:7], s26 offen offset:1024
    buffer_load_dwordx4 v[24:27], v1, s[4:7], s26 offen offset:2048
    buffer_load_dwordx4 v[28:31], v1, s[4:7], s26 offen offset:3072
    s_add_u32 s26, s26, 4096
    buffer_load_dwordx4 v[32:35], v1, s[4:7], s26 offen offset:0
    buffer_load_dwordx4 v[36:39], v1, s[4:7], s26 offen offset:1024
    buffer_load_dwordx4 v[40:43], v1, s[4:7], s26 offen offset:2048
    buffer_load_dwordx4 v[44:47], v1, s[4:7], s26 offen offset:3072
    buffer_load_dwordx4 v[48:51], v1, s[4:7], s27 offen offset:0
    buffer_load_dwordx4 v[52:55], v1, s[4:7], s27 offen offset:1024
    buffer_load_dwordx4 v[56:59], v1, s[4:7], s27 offen offset:2048
    buffer_load_dwordx4 v[60:63], v1, s[4:7], s27 offen offset:3072
    s_add_u32 s27, s27, 4096
    buffer_load_dwordx4 v[64:67], v1, s[4:7], s27 offen offset:0
    buffer_load_dwordx4 v[68:71], v1, s[4:7], s27 offen offset:1024
    buffer_load_dwordx4 v[72:75], v1, s[4:7], s27 offen offset:2048
    buffer_load_dwordx4 v[76:79], v1, s[4:7], s27 offen offset:3072
    s_add_u32 s27, s27, 4096
    buffer_load_dwordx4 v[80:83], v1, s[4:7], s27 offen offset:0
    buffer_load_dwordx4 v[84:87], v1, s[4:7], s27 offen offset:1024
    buffer_load_dwordx4 v[88:91], v1, s[4:7], s27 offen offset:2048
    buffer_load_dwordx4 v[92:95], v1, s[4:7], s27 offen offset:3072
    s_add_u32 s27, s27, 4096
    buffer_load_dwordx4 v[96:99], v1, s[4:7], s27 offen offset:0
    buffer_load_dwordx4 v[100:103], v1, s[4:7], s27 offen offset:1024
    buffer_load_dwordx4 v[104:107], v1, s[4:7], s27 offen offset:2048
    buffer_load_dwordx4 v[108:111], v1, s[4:7], s27 offen offset:3072
    s_mov_b64 exec, 0x18
AT2_G_185:
    buffer_load_dword v5, v4, s[4:7], s64 offen sc1
    s_add_u32 s29, s29, 1
    s_waitcnt vmcnt(0)
    v_cmp_eq_u32 vcc, 0, v5
    s_cbranch_vccz AT2_GD_186
    s_cmp_gt_u32 s29, 262144
    s_cbranch_scc1 AT2_GD_186
    s_sleep 1
    s_branch AT2_G_185
AT2_GD_186:
    s_mov_b64 exec, -1
    buffer_load_dwordx4 v[112:115], v2, s[4:7], s30 offen offset:0
    buffer_load_dwordx4 v[116:119], v2, s[4:7], s30 offen offset:512
    buffer_load_dwordx4 v[120:123], v2, s[4:7], s30 offen offset:1024
    buffer_load_dwordx4 v[124:127], v2, s[4:7], s30 offen offset:1536
    buffer_load_dwordx2 v[128:129], v3, s[4:7], s31 offen offset:0
    buffer_load_dwordx2 v[130:131], v3, s[4:7], s31 offen offset:256
    buffer_load_dwordx2 v[132:133], v3, s[4:7], s31 offen offset:512
    buffer_load_dwordx2 v[134:135], v3, s[4:7], s31 offen offset:768
    buffer_load_dwordx2 v[136:137], v3, s[4:7], s31 offen offset:1024
    buffer_load_dwordx2 v[138:139], v3, s[4:7], s31 offen offset:1280
    buffer_load_dwordx2 v[140:141], v3, s[4:7], s31 offen offset:1536
    buffer_load_dwordx2 v[142:143], v3, s[4:7], s31 offen offset:1792
    v_mfma_f32_16x16x32_bf16 v[148:151], v[48:51], v[16:19], 0
    v_mfma_f32_16x16x32_bf16 v[156:159], v[48:51], v[32:35], 0
    v_mfma_f32_16x16x32_bf16 v[160:163], v[64:67], v[32:35], 0
    v_mfma_f32_16x16x32_bf16 v[148:151], v[52:55], v[20:23], v[148:151]
    v_mfma_f32_16x16x32_bf16 v[156:159], v[52:55], v[36:39], v[156:159]
    v_mfma_f32_16x16x32_bf16 v[160:163], v[68:71], v[36:39], v[160:163]
    v_mfma_f32_16x16x32_bf16 v[148:151], v[56:59], v[24:27], v[148:151]
    v_mfma_f32_16x16x32_bf16 v[156:159], v[56:59], v[40:43], v[156:159]
    v_mfma_f32_16x16x32_bf16 v[160:163], v[72:75], v[40:43], v[160:163]
    v_mfma_f32_16x16x32_bf16 v[148:151], v[60:63], v[28:31], v[148:151]
    v_mfma_f32_16x16x32_bf16 v[156:159], v[60:63], v[44:47], v[156:159]
    v_mfma_f32_16x16x32_bf16 v[160:163], v[76:79], v[44:47], v[160:163]
    s_waitcnt vmcnt(8)
    v_mfma_f32_16x16x32_bf16 v[144:147], v[112:115], v[16:19], 0
    v_mfma_f32_16x16x32_bf16 v[152:155], v[112:115], v[32:35], 0
    v_mfma_f32_16x16x32_bf16 v[144:147], v[116:119], v[20:23], v[144:147]
    v_mfma_f32_16x16x32_bf16 v[152:155], v[116:119], v[36:39], v[152:155]
    v_mfma_f32_16x16x32_bf16 v[144:147], v[120:123], v[24:27], v[144:147]
    v_mfma_f32_16x16x32_bf16 v[152:155], v[120:123], v[40:43], v[152:155]
    v_mfma_f32_16x16x32_bf16 v[144:147], v[124:127], v[28:31], v[144:147]
    v_mfma_f32_16x16x32_bf16 v[152:155], v[124:127], v[44:47], v[152:155]
    v_mov_b32 v11, 0xff800000
    s_nop 7
    v_cndmask_b32 v148, v11, v148, s[38:39]
    v_cndmask_b32 v160, v11, v160, s[38:39]
    v_cndmask_b32 v144, v11, v144, s[36:37]
    v_cndmask_b32 v152, v11, v152, s[36:37]
    v_cndmask_b32 v149, v11, v149, s[40:41]
    v_cndmask_b32 v161, v11, v161, s[40:41]
    v_cndmask_b32 v145, v11, v145, s[36:37]
    v_cndmask_b32 v153, v11, v153, s[36:37]
    v_cndmask_b32 v150, v11, v150, s[42:43]
    v_cndmask_b32 v162, v11, v162, s[42:43]
    v_cndmask_b32 v146, v11, v146, s[36:37]
    v_cndmask_b32 v154, v11, v154, s[36:37]
    v_cndmask_b32 v151, v11, v151, s[44:45]
    v_cndmask_b32 v163, v11, v163, s[44:45]
    v_cndmask_b32 v147, v11, v147, s[36:37]
    v_cndmask_b32 v155, v11, v155, s[36:37]
    v_max3_f32 v8, v144, v145, v146
    v_max3_f32 v8, v8, v147, v148
    v_max3_f32 v8, v8, v149, v150
    v_max_f32 v8, v8, v151
    v_mov_b32 v9, v8
    s_nop 1
    v_permlane16_swap_b32 v8, v9
    v_max_f32 v8, v8, v9
    v_mov_b32 v9, v8
    s_nop 1
    v_permlane32_swap_b32 v8, v9
    v_max_f32 v8, v8, v9
    v_mul_f32 v8, s34, v8
    v_fma_f32 v144, v144, s34, -v8
    v_fma_f32 v145, v145, s34, -v8
    v_fma_f32 v146, v146, s34, -v8
    v_fma_f32 v147, v147, s34, -v8
    v_fma_f32 v148, v148, s34, -v8
    v_fma_f32 v149, v149, s34, -v8
    v_fma_f32 v150, v150, s34, -v8
    v_fma_f32 v151, v151, s34, -v8
    v_exp_f32 v144, v144
    v_exp_f32 v145, v145
    v_exp_f32 v146, v146
    v_exp_f32 v147, v147
    v_exp_f32 v148, v148
    v_exp_f32 v149, v149
    v_exp_f32 v150, v150
    v_exp_f32 v151, v151
    s_nop 0
    v_cvt_pk_bf16_f32 v164, v148, v149
    v_cvt_pk_bf16_f32 v165, v150, v151
    v_mov_b32 v166, 0
    v_mov_b32 v167, 0
    v_cvt_pk_bf16_f32 v168, v144, v145
    v_cvt_pk_bf16_f32 v169, v146, v147
    v_max3_f32 v8, v152, v153, v154
    v_max3_f32 v8, v8, v155, v156
    v_max3_f32 v8, v8, v157, v158
    v_max3_f32 v8, v8, v159, v160
    v_max3_f32 v8, v8, v161, v162
    v_max_f32 v8, v8, v163
    v_mov_b32 v9, v8
    s_nop 1
    v_permlane16_swap_b32 v8, v9
    v_max_f32 v8, v8, v9
    v_mov_b32 v9, v8
    s_nop 1
    v_permlane32_swap_b32 v8, v9
    v_max_f32 v8, v8, v9
    v_mul_f32 v8, s34, v8
    v_fma_f32 v152, v152, s34, -v8
    v_fma_f32 v153, v153, s34, -v8
    v_fma_f32 v154, v154, s34, -v8
    v_fma_f32 v155, v155, s34, -v8
    v_fma_f32 v156, v156, s34, -v8
    v_fma_f32 v157, v157, s34, -v8
    v_fma_f32 v158, v158, s34, -v8
    v_fma_f32 v159, v159, s34, -v8
    v_fma_f32 v160, v160, s34, -v8
    v_fma_f32 v161, v161, s34, -v8
    v_fma_f32 v162, v162, s34, -v8
    v_fma_f32 v163, v163, s34, -v8
    v_exp_f32 v152, v152
    v_exp_f32 v153, v153
    v_exp_f32 v154, v154
    v_exp_f32 v155, v155
    v_exp_f32 v156, v156
    v_exp_f32 v157, v157
    v_exp_f32 v158, v158
    v_exp_f32 v159, v159
    v_exp_f32 v160, v160
    v_exp_f32 v161, v161
    v_exp_f32 v162, v162
    v_exp_f32 v163, v163
    s_nop 0
    v_cvt_pk_bf16_f32 v170, v156, v157
    v_cvt_pk_bf16_f32 v171, v158, v159
    v_cvt_pk_bf16_f32 v172, v160, v161
    v_cvt_pk_bf16_f32 v173, v162, v163
    v_cvt_pk_bf16_f32 v174, v152, v153
    v_cvt_pk_bf16_f32 v175, v154, v155
    s_waitcnt vmcnt(0)
    v_mfma_f32_16x16x32_bf16 v[240:243], v[248:251], v[164:167], 0
    v_mfma_f32_16x16x32_bf16 v[244:247], v[248:251], v[170:173], 0
    v_mfma_f32_16x16x32_bf16 v[176:179], v[80:83], v[164:167], 0
    v_mfma_f32_16x16x32_bf16 v[180:183], v[80:83], v[170:173], 0
    v_mfma_f32_16x16x32_bf16 v[184:187], v[84:87], v[164:167], 0
    v_mfma_f32_16x16x32_bf16 v[188:191], v[84:87], v[170:173], 0
    v_mfma_f32_16x16x32_bf16 v[192:195], v[88:91], v[164:167], 0
    v_mfma_f32_16x16x32_bf16 v[196:199], v[88:91], v[170:173], 0
    v_mfma_f32_16x16x32_bf16 v[200:203], v[92:95], v[164:167], 0
    v_mfma_f32_16x16x32_bf16 v[204:207], v[92:95], v[170:173], 0
    v_mfma_f32_16x16x32_bf16 v[208:211], v[96:99], v[164:167], 0
    v_mfma_f32_16x16x32_bf16 v[212:215], v[96:99], v[170:173], 0
    v_mfma_f32_16x16x32_bf16 v[216:219], v[100:103], v[164:167], 0
    v_mfma_f32_16x16x32_bf16 v[220:223], v[100:103], v[170:173], 0
    v_mfma_f32_16x16x32_bf16 v[224:227], v[104:107], v[164:167], 0
    v_mfma_f32_16x16x32_bf16 v[228:231], v[104:107], v[170:173], 0
    v_mfma_f32_16x16x32_bf16 v[232:235], v[108:111], v[164:167], 0
    v_mfma_f32_16x16x32_bf16 v[236:239], v[108:111], v[170:173], 0
    v_mfma_f32_16x16x16_bf16 v[240:243], v[248:249], v[168:169], v[240:243]
    v_mfma_f32_16x16x16_bf16 v[244:247], v[248:249], v[174:175], v[244:247]
    v_mfma_f32_16x16x16_bf16 v[176:179], v[128:129], v[168:169], v[176:179]
    v_mfma_f32_16x16x16_bf16 v[180:183], v[128:129], v[174:175], v[180:183]
    v_mfma_f32_16x16x16_bf16 v[184:187], v[130:131], v[168:169], v[184:187]
    v_mfma_f32_16x16x16_bf16 v[188:191], v[130:131], v[174:175], v[188:191]
    v_mfma_f32_16x16x16_bf16 v[192:195], v[132:133], v[168:169], v[192:195]
    v_mfma_f32_16x16x16_bf16 v[196:199], v[132:133], v[174:175], v[196:199]
    v_mfma_f32_16x16x16_bf16 v[200:203], v[134:135], v[168:169], v[200:203]
    v_mfma_f32_16x16x16_bf16 v[204:207], v[134:135], v[174:175], v[204:207]
    v_mfma_f32_16x16x16_bf16 v[208:211], v[136:137], v[168:169], v[208:211]
    v_mfma_f32_16x16x16_bf16 v[212:215], v[136:137], v[174:175], v[212:215]
    v_mfma_f32_16x16x16_bf16 v[216:219], v[138:139], v[168:169], v[216:219]
    v_mfma_f32_16x16x16_bf16 v[220:223], v[138:139], v[174:175], v[220:223]
    v_mfma_f32_16x16x16_bf16 v[224:227], v[140:141], v[168:169], v[224:227]
    v_mfma_f32_16x16x16_bf16 v[228:231], v[140:141], v[174:175], v[228:231]
    v_mfma_f32_16x16x16_bf16 v[232:235], v[142:143], v[168:169], v[232:235]
    v_mfma_f32_16x16x16_bf16 v[236:239], v[142:143], v[174:175], v[236:239]
    v_rcp_f32 v8, v240
    v_rcp_f32 v9, v244
    s_nop 7
    v_mul_f32 v176, v176, v8
    v_mul_f32 v177, v177, v8
    v_mul_f32 v178, v178, v8
    v_mul_f32 v179, v179, v8
    v_cvt_pk_bf16_f32 v16, v176, v177
    v_cvt_pk_bf16_f32 v17, v178, v179
    v_mul_f32 v184, v184, v8
    v_mul_f32 v185, v185, v8
    v_mul_f32 v186, v186, v8
    v_mul_f32 v187, v187, v8
    v_cvt_pk_bf16_f32 v18, v184, v185
    v_cvt_pk_bf16_f32 v19, v186, v187
    s_add_u32 s64, s32, 0x0
    buffer_store_dwordx4 v[16:19], v1, s[4:7], s64 offen offset:0 sc1
    v_mul_f32 v192, v192, v8
    v_mul_f32 v193, v193, v8
    v_mul_f32 v194, v194, v8
    v_mul_f32 v195, v195, v8
    v_cvt_pk_bf16_f32 v20, v192, v193
    v_cvt_pk_bf16_f32 v21, v194, v195
    v_mul_f32 v200, v200, v8
    v_mul_f32 v201, v201, v8
    v_mul_f32 v202, v202, v8
    v_mul_f32 v203, v203, v8
    v_cvt_pk_bf16_f32 v22, v200, v201
    v_cvt_pk_bf16_f32 v23, v202, v203
    s_add_u32 s64, s32, 0x0
    buffer_store_dwordx4 v[20:23], v1, s[4:7], s64 offen offset:1024 sc1
    v_mul_f32 v208, v208, v8
    v_mul_f32 v209, v209, v8
    v_mul_f32 v210, v210, v8
    v_mul_f32 v211, v211, v8
    v_cvt_pk_bf16_f32 v24, v208, v209
    v_cvt_pk_bf16_f32 v25, v210, v211
    v_mul_f32 v216, v216, v8
    v_mul_f32 v217, v217, v8
    v_mul_f32 v218, v218, v8
    v_mul_f32 v219, v219, v8
    v_cvt_pk_bf16_f32 v26, v216, v217
    v_cvt_pk_bf16_f32 v27, v218, v219
    s_add_u32 s64, s32, 0x0
    buffer_store_dwordx4 v[24:27], v1, s[4:7], s64 offen offset:2048 sc1
    v_mul_f32 v224, v224, v8
    v_mul_f32 v225, v225, v8
    v_mul_f32 v226, v226, v8
    v_mul_f32 v227, v227, v8
    v_cvt_pk_bf16_f32 v28, v224, v225
    v_cvt_pk_bf16_f32 v29, v226, v227
    v_mul_f32 v232, v232, v8
    v_mul_f32 v233, v233, v8
    v_mul_f32 v234, v234, v8
    v_mul_f32 v235, v235, v8
    v_cvt_pk_bf16_f32 v30, v232, v233
    v_cvt_pk_bf16_f32 v31, v234, v235
    s_add_u32 s64, s32, 0x0
    buffer_store_dwordx4 v[28:31], v1, s[4:7], s64 offen offset:3072 sc1
    v_mul_f32 v180, v180, v9
    v_mul_f32 v181, v181, v9
    v_mul_f32 v182, v182, v9
    v_mul_f32 v183, v183, v9
    v_cvt_pk_bf16_f32 v32, v180, v181
    v_cvt_pk_bf16_f32 v33, v182, v183
    v_mul_f32 v188, v188, v9
    v_mul_f32 v189, v189, v9
    v_mul_f32 v190, v190, v9
    v_mul_f32 v191, v191, v9
    v_cvt_pk_bf16_f32 v34, v188, v189
    v_cvt_pk_bf16_f32 v35, v190, v191
    s_add_u32 s64, s32, 0x20000
    buffer_store_dwordx4 v[32:35], v1, s[4:7], s64 offen offset:0 sc1
    v_mul_f32 v196, v196, v9
    v_mul_f32 v197, v197, v9
    v_mul_f32 v198, v198, v9
    v_mul_f32 v199, v199, v9
    v_cvt_pk_bf16_f32 v36, v196, v197
    v_cvt_pk_bf16_f32 v37, v198, v199
    v_mul_f32 v204, v204, v9
    v_mul_f32 v205, v205, v9
    v_mul_f32 v206, v206, v9
    v_mul_f32 v207, v207, v9
    v_cvt_pk_bf16_f32 v38, v204, v205
    v_cvt_pk_bf16_f32 v39, v206, v207
    s_add_u32 s64, s32, 0x20000
    buffer_store_dwordx4 v[36:39], v1, s[4:7], s64 offen offset:1024 sc1
    v_mul_f32 v212, v212, v9
    v_mul_f32 v213, v213, v9
    v_mul_f32 v214, v214, v9
    v_mul_f32 v215, v215, v9
    v_cvt_pk_bf16_f32 v40, v212, v213
    v_cvt_pk_bf16_f32 v41, v214, v215
    v_mul_f32 v220, v220, v9
    v_mul_f32 v221, v221, v9
    v_mul_f32 v222, v222, v9
    v_mul_f32 v223, v223, v9
    v_cvt_pk_bf16_f32 v42, v220, v221
    v_cvt_pk_bf16_f32 v43, v222, v223
    s_add_u32 s64, s32, 0x20000
    buffer_store_dwordx4 v[40:43], v1, s[4:7], s64 offen offset:2048 sc1
    v_mul_f32 v228, v228, v9
    v_mul_f32 v229, v229, v9
    v_mul_f32 v230, v230, v9
    v_mul_f32 v231, v231, v9
    v_cvt_pk_bf16_f32 v44, v228, v229
    v_cvt_pk_bf16_f32 v45, v230, v231
    v_mul_f32 v236, v236, v9
    v_mul_f32 v237, v237, v9
    v_mul_f32 v238, v238, v9
    v_mul_f32 v239, v239, v9
    v_cvt_pk_bf16_f32 v46, v236, v237
    v_cvt_pk_bf16_f32 v47, v238, v239
    s_add_u32 s64, s32, 0x20000
    buffer_store_dwordx4 v[44:47], v1, s[4:7], s64 offen offset:3072 sc1
    s_waitcnt vmcnt(0)
    v_mov_b32 v7, 1
    v_mov_b32 v8, 0
    s_mov_b64 exec, 1
    buffer_store_dword v7, v8, s[4:7], s33 offen sc1
    s_mov_b64 exec, -1
    s_add_u32 s24, s24, 8
    s_add_u32 s25, s25, 1
    s_cmp_lt_u32 s25, 8
    s_cbranch_scc1 AT2_LOOP
AT2_END:
M_EXIT:
    s_endpgm
.section .rodata,"a"
.p2align 6
.amdhsa_kernel main_kernel
  .amdhsa_next_free_vgpr 512
  .amdhsa_next_free_sgpr 102
  .amdhsa_accum_offset 256
  .amdhsa_group_segment_fixed_size 0
  .amdhsa_kernarg_size 120
  .amdhsa_user_sgpr_count 2
  .amdhsa_user_sgpr_kernarg_segment_ptr 1
  .amdhsa_system_sgpr_workgroup_id_x 1
.end_amdhsa_kernel
```

```asm
; @launch kernel=main_kernel grid=(256,1,1) block=(256,1,1) lds=163840
.amdgcn_target "amdgcn-amd-amdhsa--gfx950"
.text
.globl main_kernel
.p2align 8
.type main_kernel,@function
main_kernel:
    s_cmp_ge_u32 s2, 256
    s_cbranch_scc1 M_EXIT
    s_load_dwordx2 s[4:5], s[0:1], 112
    s_mov_b32 s6, 0x10000000
    s_mov_b32 s7, 0x00020000
    s_load_dwordx2 s[60:61], s[0:1], 104
    s_mov_b32 s62, 256
    s_mov_b32 s63, 0x00020000
    s_load_dwordx2 s[44:45], s[0:1], 16
    s_mov_b32 s46, 0x500000
    s_mov_b32 s47, 0x00020000
    s_load_dwordx2 s[48:49], s[0:1], 24
    s_mov_b32 s50, 0x500000
    s_mov_b32 s51, 0x00020000
    s_load_dwordx2 s[52:53], s[0:1], 32
    s_mov_b32 s54, 0x500000
    s_mov_b32 s55, 0x00020000
    s_load_dwordx2 s[56:57], s[0:1], 40
    s_mov_b32 s58, 0x500000
    s_mov_b32 s59, 0x00020000
    v_lshrrev_b32 v1, 6, v0
    v_and_b32 v0, 63, v0
    s_nop 0
    v_readfirstlane_b32 s14, v1
    s_getreg_b32 s98, hwreg(HW_REG_XCC_ID)
    s_and_b32 s98, s98, 7
    s_mov_b32 s97, 0
    s_mov_b32 s95, 4
    s_waitcnt lgkmcnt(0)
    s_cmp_lg_u32 s14, 0
    s_cbranch_scc1 NOMEAS_1
    s_and_b32 s64, s2, 0xfffffffd
    s_cmp_lg_u32 s64, 1
    s_cbranch_scc1 NOMEAS_1
    s_lshr_b32 s70, s2, 1
    s_mov_b32 s72, s60
    s_mov_b32 s73, s61
    s_mov_b32 s74, s62
    s_mov_b32 s75, s63
    s_lshl_b32 s60, s70, 21
    s_add_u32 s60, s60, 0x6001800
    v_mov_b32 v60, 0
    v_mov_b32 v61, -1
    s_mov_b32 s66, 0x7fffffff
    s_mov_b32 s67, 0x7fffffff
    s_mov_b32 s68, 0x7fffffff
    s_mov_b32 s69, 0x7fffffff
    s_mov_b64 exec, 1
    s_add_u32 s61, s60, 0
    s_memtime s[62:63]
    s_waitcnt lgkmcnt(0)
    buffer_store_dword v61, v60, s[4:7], s61 offen offset:0 sc1
    s_waitcnt vmcnt(0)
    s_memtime s[64:65]
    s_waitcnt lgkmcnt(0)
    s_sub_u32 s62, s64, s62
    s_min_u32 s66, s66, s62
    s_add_u32 s61, s60, 8192
    s_memtime s[62:63]
    s_waitcnt lgkmcnt(0)
    buffer_store_dword v61, v60, s[4:7], s61 offen offset:0 sc1
    s_waitcnt vmcnt(0)
    s_memtime s[64:65]
    s_waitcnt lgkmcnt(0)
    s_sub_u32 s62, s64, s62
    s_min_u32 s67, s67, s62
    s_add_u32 s61, s60, 16384
    s_memtime s[62:63]
    s_waitcnt lgkmcnt(0)
    buffer_store_dword v61, v60, s[4:7], s61 offen offset:0 sc1
    s_waitcnt vmcnt(0)
    s_memtime s[64:65]
    s_waitcnt lgkmcnt(0)
    s_sub_u32 s62, s64, s62
    s_min_u32 s68, s68, s62
    s_add_u32 s61, s60, 24576
    s_memtime s[62:63]
    s_waitcnt lgkmcnt(0)
    buffer_store_dword v61, v60, s[4:7], s61 offen offset:0 sc1
    s_waitcnt vmcnt(0)
    s_memtime s[64:65]
    s_waitcnt lgkmcnt(0)
    s_sub_u32 s62, s64, s62
    s_min_u32 s69, s69, s62
    s_add_u32 s61, s60, 0
    s_memtime s[62:63]
    s_waitcnt lgkmcnt(0)
    buffer_store_dword v61, v60, s[4:7], s61 offen offset:128 sc1
    s_waitcnt vmcnt(0)
    s_memtime s[64:65]
    s_waitcnt lgkmcnt(0)
    s_sub_u32 s62, s64, s62
    s_min_u32 s66, s66, s62
    s_add_u32 s61, s60, 8192
    s_memtime s[62:63]
    s_waitcnt lgkmcnt(0)
    buffer_store_dword v61, v60, s[4:7], s61 offen offset:128 sc1
    s_waitcnt vmcnt(0)
    s_memtime s[64:65]
    s_waitcnt lgkmcnt(0)
    s_sub_u32 s62, s64, s62
    s_min_u32 s67, s67, s62
    s_add_u32 s61, s60, 16384
    s_memtime s[62:63]
    s_waitcnt lgkmcnt(0)
    buffer_store_dword v61, v60, s[4:7], s61 offen offset:128 sc1
    s_waitcnt vmcnt(0)
    s_memtime s[64:65]
    s_waitcnt lgkmcnt(0)
    s_sub_u32 s62, s64, s62
    s_min_u32 s68, s68, s62
    s_add_u32 s61, s60, 24576
    s_memtime s[62:63]
    s_waitcnt lgkmcnt(0)
    buffer_store_dword v61, v60, s[4:7], s61 offen offset:128 sc1
    s_waitcnt vmcnt(0)
    s_memtime s[64:65]
    s_waitcnt lgkmcnt(0)
    s_sub_u32 s62, s64, s62
    s_min_u32 s69, s69, s62
    s_mov_b64 exec, -1
    s_mov_b32 s60, 0
    s_mov_b32 s61, s66
    s_cmp_lt_u32 s67, s61
    s_cselect_b32 s60, 1, s60
    s_min_u32 s61, s61, s67
    s_cmp_lt_u32 s68, s61
    s_cselect_b32 s60, 2, s60
    s_min_u32 s61, s61, s68
    s_cmp_lt_u32 s69, s61
    s_cselect_b32 s60, 3, s60
    s_min_u32 s61, s61, s69
    s_and_b32 s61, s98, 1
    s_lshl_b32 s61, s61, 1
    s_lshr_b32 s62, s98, 2
    s_add_u32 s61, s61, s62
    s_xor_b32 s60, s60, s61
    s_add_u32 s71, s60, 1
    s_mov_b32 s60, s72
    s_mov_b32 s61, s73
    s_mov_b32 s62, s74
    s_mov_b32 s63, s75
    s_lshl_b32 s70, s70, 2
    s_add_u32 s70, s70, 132
    v_mov_b32 v61, s71
    s_mov_b64 exec, 1
    buffer_store_dword v61, off, s[60:63], s70 sc1
    s_mov_b64 exec, -1
NOMEAS_1:
    s_cmp_lg_u32 s14, 0
    s_cbranch_scc1 M_TICKW
    s_mul_i32 s64, s98, 32
    s_add_u32 s64, s64, 0x0
    v_mov_b32 v1, 0
    v_mov_b32 v2, 1
    s_mov_b64 exec, 1
    buffer_atomic_add v2, v1, s[60:63], s64 offen sc0
    s_mov_b64 exec, -1
    s_getpc_b64 s[76:77]
M_PCREF:
    s_cmp_eq_u32 s98, 0
    s_cselect_b32 s80, 1, 0
    s_cmp_eq_u32 s98, 2
    s_cselect_b32 s80, 1, s80
    s_cmp_eq_u32 s80, 1
    s_mov_b32 s82, M_REC-M_PCREF
    s_mov_b32 s83, M_HELP-M_PCREF
    s_cselect_b32 s81, s82, s83
    s_mov_b32 s82, M_HELP-M_REC
    s_mov_b32 s83, M_EXIT-M_HELP
    s_cselect_b32 s78, s82, s83
    s_add_u32 s76, s76, s81
    s_addc_u32 s77, s77, 0
    s_and_b32 s77, s77, 0xffff
    s_mov_b32 s79, 0x00020000
    s_lshr_b32 s81, s2, 3
    s_and_b32 s81, s81, 3
    s_lshl_b32 s81, s81, 12
    v_mbcnt_lo_u32_b32 v3, -1, 0
    v_mbcnt_hi_u32_b32 v3, -1, v3
    v_lshlrev_b32 v3, 6, v3
    s_mov_b32 m0, 1024
    s_nop 0
    buffer_load_dword v3, s[76:79], s81 offen lds
    s_add_u32 s81, s81, 16384
    buffer_load_dword v3, s[76:79], s81 offen lds
    s_add_u32 s81, s81, 16384
    buffer_load_dword v3, s[76:79], s81 offen lds
    s_add_u32 s81, s81, 16384
    buffer_load_dword v3, s[76:79], s81 offen lds
    s_add_u32 s81, s81, 16384
    buffer_load_dword v3, s[76:79], s81 offen lds
    s_add_u32 s81, s81, 16384
    s_mov_b64 exec, 1
    s_waitcnt vmcnt(5)
    ds_write_b32 v1, v2
    s_waitcnt lgkmcnt(0)
    s_mov_b64 exec, -1
M_TICKW:
    s_barrier
    v_mov_b32 v1, 0
    ds_read_b32 v2, v1
    s_waitcnt lgkmcnt(0)
    v_readfirstlane_b32 s99, v2
    s_barrier
    s_cmp_ge_u32 s99, 32
    s_cbranch_scc1 M_SLOW0
    s_mov_b32 s12, s98
    s_cmp_eq_u32 s12, 0
    s_cbranch_scc1 XOK_2
    s_cmp_eq_u32 s12, 2
    s_cbranch_scc0 M_FH
    s_mov_b32 s12, 1
XOK_2:
    s_mov_b32 s13, s99
    s_branch M_REC
M_FH:
    s_sub_u32 s96, s98, 1
    s_cmp_gt_u32 s98, 2
    s_cselect_b32 s64, 1, 0
    s_sub_u32 s96, s96, s64
    s_lshl_b32 s96, s96, 5
    s_add_u32 s96, s96, s99
    s_branch M_HELP
M_SLOW0:
    v_mbcnt_lo_u32_b32 v0, -1, 0
    v_mbcnt_hi_u32_b32 v0, -1, v0
    v_mul_u32_u24 v8, 32, v0
    s_mov_b32 s64, 0x0
    s_mov_b32 s65, 0
    s_mov_b64 exec, 0xff
TK_3:
    buffer_load_dword v9, v8, s[60:63], s64 offen sc1
    s_add_u32 s65, s65, 1
    s_waitcnt vmcnt(0)
    s_mov_b32 s66, 0
    v_readlane_b32 s67, v9, 0
    s_add_u32 s66, s66, s67
    v_readlane_b32 s67, v9, 1
    s_add_u32 s66, s66, s67
    v_readlane_b32 s67, v9, 2
    s_add_u32 s66, s66, s67
    v_readlane_b32 s67, v9, 3
    s_add_u32 s66, s66, s67
    v_readlane_b32 s67, v9, 4
    s_add_u32 s66, s66, s67
    v_readlane_b32 s67, v9, 5
    s_add_u32 s66, s66, s67
    v_readlane_b32 s67, v9, 6
    s_add_u32 s66, s66, s67
    v_readlane_b32 s67, v9, 7
    s_add_u32 s66, s66, s67
    s_cmp_ge_u32 s66, 256
    s_cbranch_scc1 TKD_4
    s_cmp_gt_u32 s65, 262144
    s_cbranch_scc0 TK_3
TKD_4:
    v_cmp_ne_u32 vcc, 32, v9
    s_mov_b64 exec, -1
M_SLOW:
    s_waitcnt vmcnt(0) lgkmcnt(0)
    s_barrier
    s_cmp_lg_u32 s14, 0
    s_cbranch_scc1 M_SLOWB
    v_mov_b32 v8, 1
    s_mov_b64 exec, 1
    buffer_atomic_add v8, off, s[60:63], 12 sc1
    s_mov_b64 exec, -1
M_SLOWB:
    s_mov_b32 s95, 12
    s_mov_b32 s65, 0
SB_5:
    buffer_load_dword v8, off, s[60:63], s95 sc1
    s_add_u32 s65, s65, 1
    s_waitcnt vmcnt(0)
    v_readfirstlane_b32 s64, v8
    s_cmp_ge_u32 s64, 256
    s_cbranch_scc1 SBD_6
    s_cmp_gt_u32 s65, 65536
    s_cbranch_scc1 SBD_6
    s_sleep 4
    s_branch SB_5
SBD_6:
    s_mov_b32 s95, 8
    s_mov_b32 s97, 1
    s_cmp_lt_u32 s2, 64
    s_cbranch_scc0 M_SH
    s_load_dwordx2 s[44:45], s[0:1], 16
    s_mov_b32 s46, 0x500000
    s_mov_b32 s47, 0x00020000
    s_load_dwordx2 s[48:49], s[0:1], 24
    s_mov_b32 s50, 0x500000
    s_mov_b32 s51, 0x00020000
    s_load_dwordx2 s[52:53], s[0:1], 32
    s_mov_b32 s54, 0x500000
    s_mov_b32 s55, 0x00020000
    s_load_dwordx2 s[56:57], s[0:1], 40
    s_mov_b32 s58, 0x500000
    s_mov_b32 s59, 0x00020000
    s_waitcnt lgkmcnt(0)
    s_lshr_b32 s12, s2, 5
    s_and_b32 s13, s2, 31
    s_branch M_REC
M_SH:
    s_sub_u32 s96, s2, 64
    s_branch M_HELP
M_REC:
    v_mbcnt_lo_u32_b32 v0, -1, 0
    v_mbcnt_hi_u32_b32 v0, -1, v0
    v_and_b32 v0, 63, v0
    s_mul_i32 s40, s14, 36864
    s_add_u32 s40, s40, 16384
    v_lshrrev_b32 v95, 4, v0
    v_lshlrev_b32 v8, 13, v95
    v_and_b32 v95, 1, v95
    v_lshlrev_b32 v95, 1, v95
    v_and_b32 v9, 15, v0
    v_xor_b32 v9, v9, v95
    v_xor_b32 v95, 0, v9
    v_lshl_add_u32 v76, v95, 4, v8
    v_xor_b32 v95, 4, v9
    v_lshl_add_u32 v77, v95, 4, v8
    v_xor_b32 v95, 8, v9
    v_lshl_add_u32 v78, v95, 4, v8
    v_xor_b32 v95, 12, v9
    v_lshl_add_u32 v79, v95, 4, v8
    s_lshl_b32 s64, s13, 8
    s_lshl_b32 s65, s14, 17
    s_add_u32 s64, s64, s65
    s_mul_i32 s65, s12, 2621440
    s_add_u32 s71, s64, s65
    s_sub_u32 s65, 2621440, s65
    s_add_u32 s72, s64, s65
    s_add_u32 m0, s40, 0
    s_add_u32 s64, s71, 0x0
    buffer_load_dwordx4 v76, s[44:47], s64 offen lds
    s_add_u32 m0, s40, 1024
    s_add_u32 s64, s71, 0x8000
    buffer_load_dwordx4 v77, s[44:47], s64 offen lds
    s_add_u32 m0, s40, 2048
    s_add_u32 s64, s71, 0x10000
    buffer_load_dwordx4 v78, s[44:47], s64 offen lds
    s_add_u32 m0, s40, 3072
    s_add_u32 s64, s71, 0x18000
    buffer_load_dwordx4 v79, s[44:47], s64 offen lds
    s_add_u32 m0, s40, 4096
    s_add_u32 s64, s71, 0x80000
    buffer_load_dwordx4 v76, s[44:47], s64 offen lds
    s_add_u32 m0, s40, 5120
    s_add_u32 s64, s71, 0x88000
    buffer_load_dwordx4 v77, s[44:47], s64 offen lds
    s_add_u32 m0, s40, 6144
    s_add_u32 s64, s71, 0x90000
    buffer_load_dwordx4 v78, s[44:47], s64 offen lds
    s_add_u32 m0, s40, 7168
    s_add_u32 s64, s71, 0x98000
    buffer_load_dwordx4 v79, s[44:47], s64 offen lds
    s_add_u32 m0, s40, 8192
    s_add_u32 s64, s71, 0x100000
    buffer_load_dwordx4 v76, s[44:47], s64 offen lds
    s_add_u32 m0, s40, 9216
    s_add_u32 s64, s71, 0x108000
    buffer_load_dwordx4 v77, s[44:47], s64 offen lds
    s_add_u32 m0, s40, 10240
    s_add_u32 s64, s71, 0x110000
    buffer_load_dwordx4 v78, s[44:47], s64 offen lds
    s_add_u32 m0, s40, 11264
    s_add_u32 s64, s71, 0x118000
    buffer_load_dwordx4 v79, s[44:47], s64 offen lds
    s_add_u32 m0, s40, 12288
    s_add_u32 s64, s71, 0x180000
    buffer_load_dwordx4 v76, s[44:47], s64 offen lds
    s_add_u32 m0, s40, 13312
    s_add_u32 s64, s71, 0x188000
    buffer_load_dwordx4 v77, s[44:47], s64 offen lds
    s_add_u32 m0, s40, 14336
    s_add_u32 s64, s71, 0x190000
    buffer_load_dwordx4 v78, s[44:47], s64 offen lds
    s_add_u32 m0, s40, 15360
    s_add_u32 s64, s71, 0x198000
    buffer_load_dwordx4 v79, s[44:47], s64 offen lds
    s_add_u32 m0, s40, 16384
    s_add_u32 s64, s71, 0x200000
    buffer_load_dwordx4 v76, s[44:47], s64 offen lds
    s_add_u32 m0, s40, 17408
    s_add_u32 s64, s71, 0x208000
    buffer_load_dwordx4 v77, s[44:47], s64 offen lds
    s_add_u32 m0, s40, 18432
    s_add_u32 s64, s71, 0x210000
    buffer_load_dwordx4 v78, s[44:47], s64 offen lds
    s_add_u32 m0, s40, 19456
    s_add_u32 s64, s71, 0x218000
    buffer_load_dwordx4 v79, s[44:47], s64 offen lds
    s_add_u32 m0, s40, 20480
    s_add_u32 s64, s72, 0x0
    buffer_load_dwordx4 v76, s[44:47], s64 offen lds
    s_add_u32 m0, s40, 21504
    s_add_u32 s64, s72, 0x8000
    buffer_load_dwordx4 v77, s[44:47], s64 offen lds
    s_add_u32 m0, s40, 22528
    s_add_u32 s64, s72, 0x10000
    buffer_load_dwordx4 v78, s[44:47], s64 offen lds
    s_add_u32 m0, s40, 23552
    s_add_u32 s64, s72, 0x18000
    buffer_load_dwordx4 v79, s[44:47], s64 offen lds
    s_add_u32 m0, s40, 24576
    s_add_u32 s64, s72, 0x80000
    buffer_load_dwordx4 v76, s[44:47], s64 offen lds
    s_add_u32 m0, s40, 25600
    s_add_u32 s64, s72, 0x88000
    buffer_load_dwordx4 v77, s[44:47], s64 offen lds
    s_add_u32 m0, s40, 26624
    s_add_u32 s64, s72, 0x90000
    buffer_load_dwordx4 v78, s[44:47], s64 offen lds
    s_add_u32 m0, s40, 27648
    s_add_u32 s64, s72, 0x98000
    buffer_load_dwordx4 v79, s[44:47], s64 offen lds
    s_add_u32 m0, s40, 28672
    s_add_u32 s64, s72, 0x100000
    buffer_load_dwordx4 v76, s[44:47], s64 offen lds
    s_add_u32 m0, s40, 29696
    s_add_u32 s64, s72, 0x108000
    buffer_load_dwordx4 v77, s[44:47], s64 offen lds
    s_add_u32 m0, s40, 30720
    s_add_u32 s64, s72, 0x110000
    buffer_load_dwordx4 v78, s[44:47], s64 offen lds
    s_add_u32 m0, s40, 31744
    s_add_u32 s64, s72, 0x118000
    buffer_load_dwordx4 v79, s[44:47], s64 offen lds
    v_lshrrev_b32 v95, 5, v0
    v_mul_u32_u24 v8, 36864, v95
    v_bfe_u32 v95, v0, 3, 1
    v_lshl_add_u32 v8, v95, 11, v8
    v_lshlrev_b32 v9, 3, v95
    v_bfe_u32 v95, v0, 4, 1
    v_lshl_add_u32 v8, v95, 10, v8
    v_lshl_add_u32 v9, v95, 2, v9
    v_bfe_u32 v95, v0, 2, 1
    v_lshl_add_u32 v8, v95, 8, v8
    v_lshl_add_u32 v9, v95, 1, v9
    v_and_b32 v95, 1, v0
    v_lshl_add_u32 v8, v95, 3, v8
    v_add_u32 v8, 16384, v8
    v_bfe_u32 v95, v0, 1, 1
    s_lshl_b32 s64, s14, 2
    v_add_u32 v10, s64, v95
    v_add_u32 v95, 0, v10
    v_xor_b32 v95, v95, v9
    v_lshl_add_u32 v72, v95, 4, v8
    v_add_u32 v73, 73728, v72
    v_add_u32 v95, 2, v10
    v_xor_b32 v95, v95, v9
    v_lshl_add_u32 v74, v95, 4, v8
    v_add_u32 v75, 73728, v74
    v_bfe_u32 v95, v0, 2, 1
    v_mov_b32 v8, v95
    v_bfe_u32 v95, v0, 3, 1
    v_lshl_add_u32 v8, v95, 2, v8
    v_bfe_u32 v95, v0, 4, 1
    v_lshl_add_u32 v8, v95, 1, v8
    v_bfe_u32 v95, v0, 5, 1
    v_lshl_add_u32 v8, v95, 3, v8
    v_mul_u32_u24 v8, 1280, v8
    v_and_b32 v95, 3, v0
    v_lshl_add_u32 v89, v95, 4, v8
    v_lshrrev_b32 v95, 1, v0
    v_mul_u32_u24 v8, 1280, v95
    v_and_b32 v95, 1, v0
    v_lshl_add_u32 v90, v95, 4, v8
    v_lshrrev_b32 v95, 5, v0
    v_lshlrev_b32 v93, 9, v95
    v_bfe_u32 v95, v0, 4, 1
    v_lshl_add_u32 v93, v95, 7, v93
    v_bfe_u32 v95, v0, 2, 1
    v_lshl_add_u32 v93, v95, 6, v93
    v_bfe_u32 v95, v0, 3, 1
    v_lshl_add_u32 v93, v95, 5, v93
    v_and_b32 v95, 3, v0
    v_lshl_add_u32 v93, v95, 3, v93
    v_add_u32 v93, s40, v93
    v_lshrrev_b32 v95, 4, v0
    v_lshlrev_b32 v94, 8, v95
    v_bfe_u32 v95, v0, 2, 2
    v_lshl_add_u32 v94, v95, 5, v94
    v_and_b32 v95, 3, v0
    v_lshl_add_u32 v94, v95, 3, v94
    v_add_u32 v94, s40, v94
    s_mul_i32 s39, s13, 163840
    s_mul_i32 s64, s12, 640
    s_add_u32 s39, s39, s64
    s_lshl_b32 s64, s14, 5
    s_add_u32 s41, s39, s64
    s_add_u32 s41, s41, 0x200
    s_lshl_b32 s64, s14, 6
    s_add_u32 s39, s39, s64
    v_and_b32 v0, 63, v0
    v_lshlrev_b32 v1, 4, v0
    s_mul_i32 s64, s14, 36864
    s_add_u32 s64, s64, 16384
    v_add_u32 v2, s64, v1
    v_bfe_u32 v8, v0, 4, 1
    v_mul_u32_u24 v8, 1152, v8
    v_lshrrev_b32 v9, 5, v0
    v_lshlrev_b32 v9, 4, v9
    v_and_b32 v10, 15, v0
    v_add_u32 v9, v9, v10
    s_lshl_b32 s64, s14, 5
    v_add_u32 v9, s64, v9
    v_lshl_add_u32 v8, v9, 3, v8
    v_add_u32 v3, 8192, v8
    v_and_b32 v8, 1, v0
    v_mul_u32_u24 v8, 1152, v8
    v_lshrrev_b32 v9, 4, v0
    v_lshlrev_b32 v9, 2, v9
    v_bfe_u32 v10, v0, 2, 2
    v_add_u32 v9, v9, v10
    v_lshl_add_u32 v8, v9, 3, v8
    v_add_u32 v4, 8192, v8
    v_and_b32 v8, 7, v0
    v_mul_u32_u24 v8, 288, v8
    v_bfe_u32 v9, v0, 3, 1
    v_lshl_add_u32 v8, v9, 5, v8
    v_lshrrev_b32 v9, 4, v0
    v_lshl_add_u32 v8, v9, 3, v8
    s_lshl_b32 s64, s14, 6
    s_add_u32 s64, s64, 12800
    v_add_u32 v5, s64, v8
    s_mov_b32 s32, 0x00ff00ff
    s_mov_b32 s33, 0x00ff00ff
    s_mov_b32 s34, -1
    s_mov_b32 s35, 0
    s_mov_b32 s36, 0x00010001
    s_mov_b32 s37, 0x00010001
    v_mov_b32 v8, 0xeeee
    v_mov_b32 v9, 0x4444
    v_cndmask_b32 v6, v8, v9, s[32:33]
    v_lshrrev_b32 v8, 5, v0
    v_lshlrev_b32 v8, 13, v8
    v_bfe_u32 v9, v0, 3, 1
    v_lshl_add_u32 v8, v9, 12, v8
    v_and_b32 v9, 7, v0
    v_lshl_add_u32 v8, v9, 4, v8
    v_bfe_u32 v9, v0, 4, 1
    v_lshl_add_u32 v7, v9, 3, v8
    s_mov_b32 s10, 0x3e0293ee
    s_mov_b32 s11, 0x3e0293ee
    s_cmp_eq_u32 s14, 0
    s_cselect_b32 s42, 1, 0
    s_cmp_ge_u32 s13, 24
    s_cselect_b32 s65, 1, 0
    s_cmp_eq_u32 s14, 1
    s_cselect_b32 s65, s65, 0
    s_or_b32 s42, s42, s65
    s_lshl_b32 s65, s65, 3
    s_add_u32 s64, s13, s65
    s_cmp_eq_u32 s64, 39
    s_cselect_b32 s22, s42, 0
    s_mul_i32 s24, s12, 163840
    s_add_u32 s24, s24, 0x300000
    s_lshl_b32 s67, s13, 7
    s_add_u32 s26, s24, s67
    s_lshl_b32 s67, s14, 14
    s_add_u32 s23, s26, s67
    s_add_u32 s25, s23, 0x10000
    s_lshl_b32 s67, s14, 13
    s_add_u32 s26, s26, s67
    s_add_u32 s26, s26, 0x20000
    s_lshl_b32 s67, s64, 12
    s_add_u32 s24, s24, s67
    s_lshl_b32 s64, s64, 7
    s_lshl_b32 s65, s12, 13
    s_add_u32 s17, s65, 0x5900000
    s_add_u32 s18, s17, s64
    s_lshl_b32 s65, s12, 21
    s_add_u32 s66, s65, 0x6000000
    s_add_u32 s21, s66, s64
    s_xor_b32 s65, s65, 0x200000
    s_add_u32 s20, s65, 0x5ff8000
    s_and_b32 s64, s13, 1
    s_cmp_eq_u32 s64, s12
    s_cselect_b32 s43, 1, 0
    s_mov_b32 s43, 0
    s_lshl_b32 s64, s13, 4
    s_add_u32 s69, s64, 0x291000
    s_lshl_b32 s64, s13, 2
    s_add_u32 s70, s64, 0x294000
    s_lshl_b32 s64, s13, 14
    s_lshl_b32 s73, s14, 11
    s_lshl_b32 s65, s14, 12
    s_add_u32 s65, s65, s64
    s_add_u32 s3, s65, 0x1500000
    s_add_u32 s64, s64, s73
    s_add_u32 s28, s64, 0x1400000
    s_add_u32 s29, s64, 0x1402000
    s_lshl_b32 s64, s13, 11
    s_add_u32 s30, s64, 0x640000
    s_lshl_b32 s64, s13, 12
    s_lshl_b32 s65, s14, 10
    s_add_u32 s64, s64, s65
    s_add_u32 s31, s64, 0xa40000
    s_waitcnt vmcnt(28)
    s_barrier
    s_add_u32 m0, s40, 32768
    s_add_u32 s64, s72, 0x180000
    buffer_load_dwordx4 v76, s[44:47], s64 offen lds
    s_add_u32 m0, s40, 33792
    s_add_u32 s64, s72, 0x188000
    buffer_load_dwordx4 v77, s[44:47], s64 offen lds
    s_add_u32 m0, s40, 34816
    s_add_u32 s64, s72, 0x190000
    buffer_load_dwordx4 v78, s[44:47], s64 offen lds
    s_add_u32 m0, s40, 35840
    s_add_u32 s64, s72, 0x198000
    buffer_load_dwordx4 v79, s[44:47], s64 offen lds
    ds_read_b64_tr_b16 v[96:97], v72 offset:0
    ds_read_b64_tr_b16 v[98:99], v72 offset:512
    ds_read_b64_tr_b16 v[100:101], v73 offset:0
    ds_read_b64_tr_b16 v[102:103], v73 offset:512
    ds_read_b64_tr_b16 v[104:105], v74 offset:0
    ds_read_b64_tr_b16 v[106:107], v74 offset:512
    ds_read_b64_tr_b16 v[108:109], v75 offset:0
    ds_read_b64_tr_b16 v[110:111], v75 offset:512
    s_waitcnt lgkmcnt(0)
    s_waitcnt vmcnt(28)
    s_barrier
    s_add_u32 m0, s40, 0
    s_add_u32 s64, s72, 0x200000
    buffer_load_dwordx4 v76, s[44:47], s64 offen lds
    s_add_u32 m0, s40, 1024
    s_add_u32 s64, s72, 0x208000
    buffer_load_dwordx4 v77, s[44:47], s64 offen lds
    s_add_u32 m0, s40, 2048
    s_add_u32 s64, s72, 0x210000
    buffer_load_dwordx4 v78, s[44:47], s64 offen lds
    s_add_u32 m0, s40, 3072
    s_add_u32 s64, s72, 0x218000
    buffer_load_dwordx4 v79, s[44:47], s64 offen lds
    ds_read_b64_tr_b16 v[112:113], v72 offset:4096
    ds_read_b64_tr_b16 v[114:115], v72 offset:4608
    ds_read_b64_tr_b16 v[116:117], v73 offset:4096
    ds_read_b64_tr_b16 v[118:119], v73 offset:4608
    ds_read_b64_tr_b16 v[120:121], v74 offset:4096
    ds_read_b64_tr_b16 v[122:123], v74 offset:4608
    ds_read_b64_tr_b16 v[124:125], v75 offset:4096
    ds_read_b64_tr_b16 v[126:127], v75 offset:4608
    s_waitcnt lgkmcnt(0)
    s_waitcnt vmcnt(28)
    s_barrier
    s_add_u32 m0, s40, 4096
    s_add_u32 s64, s72, 0x200000
    buffer_load_dwordx4 v76, s[48:51], s64 offen lds
    s_add_u32 m0, s40, 5120
    s_add_u32 s64, s72, 0x208000
    buffer_load_dwordx4 v77, s[48:51], s64 offen lds
    s_add_u32 m0, s40, 6144
    s_add_u32 s64, s72, 0x210000
    buffer_load_dwordx4 v78, s[48:51], s64 offen lds
    s_add_u32 m0, s40, 7168
    s_add_u32 s64, s72, 0x218000
    buffer_load_dwordx4 v79, s[48:51], s64 offen lds
    ds_read_b64_tr_b16 v[128:129], v72 offset:8192
    ds_read_b64_tr_b16 v[130:131], v72 offset:8704
    ds_read_b64_tr_b16 v[132:133], v73 offset:8192
    ds_read_b64_tr_b16 v[134:135], v73 offset:8704
    ds_read_b64_tr_b16 v[136:137], v74 offset:8192
    ds_read_b64_tr_b16 v[138:139], v74 offset:8704
    ds_read_b64_tr_b16 v[140:141], v75 offset:8192
    ds_read_b64_tr_b16 v[142:143], v75 offset:8704
    s_waitcnt lgkmcnt(0)
    s_waitcnt vmcnt(28)
    s_barrier
    s_add_u32 m0, s40, 8192
    s_add_u32 s64, s71, 0x0
    buffer_load_dwordx4 v76, s[52:55], s64 offen lds
    s_add_u32 m0, s40, 9216
    s_add_u32 s64, s71, 0x8000
    buffer_load_dwordx4 v77, s[52:55], s64 offen lds
    s_add_u32 m0, s40, 10240
    s_add_u32 s64, s71, 0x10000
    buffer_load_dwordx4 v78, s[52:55], s64 offen lds
    s_add_u32 m0, s40, 11264
    s_add_u32 s64, s71, 0x18000
    buffer_load_dwordx4 v79, s[52:55], s64 offen lds
    ds_read_b64_tr_b16 v[144:145], v72 offset:12288
    ds_read_b64_tr_b16 v[146:147], v72 offset:12800
    ds_read_b64_tr_b16 v[148:149], v73 offset:12288
    ds_read_b64_tr_b16 v[150:151], v73 offset:12800
    ds_read_b64_tr_b16 v[152:153], v74 offset:12288
    ds_read_b64_tr_b16 v[154:155], v74 offset:12800
    ds_read_b64_tr_b16 v[156:157], v75 offset:12288
    ds_read_b64_tr_b16 v[158:159], v75 offset:12800
    s_waitcnt lgkmcnt(0)
    s_waitcnt vmcnt(28)
    s_barrier
    s_add_u32 m0, s40, 12288
    s_add_u32 s64, s71, 0x80000
    buffer_load_dwordx4 v76, s[52:55], s64 offen lds
    s_add_u32 m0, s40, 13312
    s_add_u32 s64, s71, 0x88000
    buffer_load_dwordx4 v77, s[52:55], s64 offen lds
    s_add_u32 m0, s40, 14336
    s_add_u32 s64, s71, 0x90000
    buffer_load_dwordx4 v78, s[52:55], s64 offen lds
    s_add_u32 m0, s40, 15360
    s_add_u32 s64, s71, 0x98000
    buffer_load_dwordx4 v79, s[52:55], s64 offen lds
    ds_read_b64_tr_b16 v[160:161], v72 offset:16384
    ds_read_b64_tr_b16 v[162:163], v72 offset:16896
    ds_read_b64_tr_b16 v[164:165], v73 offset:16384
    ds_read_b64_tr_b16 v[166:167], v73 offset:16896
    ds_read_b64_tr_b16 v[168:169], v74 offset:16384
    ds_read_b64_tr_b16 v[170:171], v74 offset:16896
    ds_read_b64_tr_b16 v[172:173], v75 offset:16384
    ds_read_b64_tr_b16 v[174:175], v75 offset:16896
    s_waitcnt lgkmcnt(0)
    s_waitcnt vmcnt(28)
    s_barrier
    s_add_u32 m0, s40, 16384
    s_add_u32 s64, s71, 0x100000
    buffer_load_dwordx4 v76, s[52:55], s64 offen lds
    s_add_u32 m0, s40, 17408
    s_add_u32 s64, s71, 0x108000
    buffer_load_dwordx4 v77, s[52:55], s64 offen lds
    s_add_u32 m0, s40, 18432
    s_add_u32 s64, s71, 0x110000
    buffer_load_dwordx4 v78, s[52:55], s64 offen lds
    s_add_u32 m0, s40, 19456
    s_add_u32 s64, s71, 0x118000
    buffer_load_dwordx4 v79, s[52:55], s64 offen lds
    ds_read_b64_tr_b16 v[176:177], v72 offset:20480
    ds_read_b64_tr_b16 v[178:179], v72 offset:20992
    ds_read_b64_tr_b16 v[180:181], v73 offset:20480
    ds_read_b64_tr_b16 v[182:183], v73 offset:20992
    ds_read_b64_tr_b16 v[184:185], v74 offset:20480
    ds_read_b64_tr_b16 v[186:187], v74 offset:20992
    ds_read_b64_tr_b16 v[188:189], v75 offset:20480
    ds_read_b64_tr_b16 v[190:191], v75 offset:20992
    s_waitcnt lgkmcnt(0)
    s_waitcnt vmcnt(28)
    s_barrier
    s_add_u32 m0, s40, 20480
    s_add_u32 s64, s71, 0x180000
    buffer_load_dwordx4 v76, s[52:55], s64 offen lds
    s_add_u32 m0, s40, 21504
    s_add_u32 s64, s71, 0x188000
    buffer_load_dwordx4 v77, s[52:55], s64 offen lds
    s_add_u32 m0, s40, 22528
    s_add_u32 s64, s71, 0x190000
    buffer_load_dwordx4 v78, s[52:55], s64 offen lds
    s_add_u32 m0, s40, 23552
    s_add_u32 s64, s71, 0x198000
    buffer_load_dwordx4 v79, s[52:55], s64 offen lds
    ds_read_b64_tr_b16 v[192:193], v72 offset:24576
    ds_read_b64_tr_b16 v[194:195], v72 offset:25088
    ds_read_b64_tr_b16 v[196:197], v73 offset:24576
    ds_read_b64_tr_b16 v[198:199], v73 offset:25088
    ds_read_b64_tr_b16 v[200:201], v74 offset:24576
    ds_read_b64_tr_b16 v[202:203], v74 offset:25088
    ds_read_b64_tr_b16 v[204:205], v75 offset:24576
    ds_read_b64_tr_b16 v[206:207], v75 offset:25088
    s_waitcnt lgkmcnt(0)
    s_waitcnt vmcnt(28)
    s_barrier
    s_add_u32 m0, s40, 24576
    s_add_u32 s64, s71, 0x200000
    buffer_load_dwordx4 v76, s[52:55], s64 offen lds
    s_add_u32 m0, s40, 25600
    s_add_u32 s64, s71, 0x208000
    buffer_load_dwordx4 v77, s[52:55], s64 offen lds
    s_add_u32 m0, s40, 26624
    s_add_u32 s64, s71, 0x210000
    buffer_load_dwordx4 v78, s[52:55], s64 offen lds
    s_add_u32 m0, s40, 27648
    s_add_u32 s64, s71, 0x218000
    buffer_load_dwordx4 v79, s[52:55], s64 offen lds
    ds_read_b64_tr_b16 v[208:209], v72 offset:28672
    ds_read_b64_tr_b16 v[210:211], v72 offset:29184
    ds_read_b64_tr_b16 v[212:213], v73 offset:28672
    ds_read_b64_tr_b16 v[214:215], v73 offset:29184
    ds_read_b64_tr_b16 v[216:217], v74 offset:28672
    ds_read_b64_tr_b16 v[218:219], v74 offset:29184
    ds_read_b64_tr_b16 v[220:221], v75 offset:28672
    ds_read_b64_tr_b16 v[222:223], v75 offset:29184
    s_waitcnt lgkmcnt(0)
    s_waitcnt vmcnt(28)
    s_barrier
    s_add_u32 m0, s40, 28672
    s_add_u32 s64, s72, 0x0
    buffer_load_dwordx4 v76, s[52:55], s64 offen lds
    s_add_u32 m0, s40, 29696
    s_add_u32 s64, s72, 0x8000
    buffer_load_dwordx4 v77, s[52:55], s64 offen lds
    s_add_u32 m0, s40, 30720
    s_add_u32 s64, s72, 0x10000
    buffer_load_dwordx4 v78, s[52:55], s64 offen lds
    s_add_u32 m0, s40, 31744
    s_add_u32 s64, s72, 0x18000
    buffer_load_dwordx4 v79, s[52:55], s64 offen lds
    ds_read_b64_tr_b16 v[224:225], v72 offset:32768
    ds_read_b64_tr_b16 v[226:227], v72 offset:33280
    ds_read_b64_tr_b16 v[228:229], v73 offset:32768
    ds_read_b64_tr_b16 v[230:231], v73 offset:33280
    ds_read_b64_tr_b16 v[232:233], v74 offset:32768
    ds_read_b64_tr_b16 v[234:235], v74 offset:33280
    ds_read_b64_tr_b16 v[236:237], v75 offset:32768
    ds_read_b64_tr_b16 v[238:239], v75 offset:33280
    s_waitcnt lgkmcnt(0)
    s_waitcnt vmcnt(28)
    s_barrier
    s_add_u32 m0, s40, 32768
    s_add_u32 s64, s72, 0x80000
    buffer_load_dwordx4 v76, s[52:55], s64 offen lds
    s_add_u32 m0, s40, 33792
    s_add_u32 s64, s72, 0x88000
    buffer_load_dwordx4 v77, s[52:55], s64 offen lds
    s_add_u32 m0, s40, 34816
    s_add_u32 s64, s72, 0x90000
    buffer_load_dwordx4 v78, s[52:55], s64 offen lds
    s_add_u32 m0, s40, 35840
    s_add_u32 s64, s72, 0x98000
    buffer_load_dwordx4 v79, s[52:55], s64 offen lds
    ds_read_b64_tr_b16 v[240:241], v72 offset:0
    ds_read_b64_tr_b16 v[242:243], v72 offset:512
    ds_read_b64_tr_b16 v[244:245], v73 offset:0
    ds_read_b64_tr_b16 v[246:247], v73 offset:512
    ds_read_b64_tr_b16 v[248:249], v74 offset:0
    ds_read_b64_tr_b16 v[250:251], v74 offset:512
    ds_read_b64_tr_b16 v[252:253], v75 offset:0
    ds_read_b64_tr_b16 v[254:255], v75 offset:512
    s_waitcnt lgkmcnt(0)
    s_waitcnt vmcnt(28)
    s_barrier
    s_add_u32 m0, s40, 0
    s_add_u32 s64, s72, 0x100000
    buffer_load_dwordx4 v76, s[52:55], s64 offen lds
    s_add_u32 m0, s40, 1024
    s_add_u32 s64, s72, 0x108000
    buffer_load_dwordx4 v77, s[52:55], s64 offen lds
    s_add_u32 m0, s40, 2048
    s_add_u32 s64, s72, 0x110000
    buffer_load_dwordx4 v78, s[52:55], s64 offen lds
    s_add_u32 m0, s40, 3072
    s_add_u32 s64, s72, 0x118000
    buffer_load_dwordx4 v79, s[52:55], s64 offen lds
    ds_read_b64_tr_b16 a[240:241], v72 offset:4096
    ds_read_b64_tr_b16 a[242:243], v72 offset:4608
    ds_read_b64_tr_b16 a[244:245], v73 offset:4096
    ds_read_b64_tr_b16 a[246:247], v73 offset:4608
    ds_read_b64_tr_b16 a[248:249], v74 offset:4096
    ds_read_b64_tr_b16 a[250:251], v74 offset:4608
    ds_read_b64_tr_b16 a[252:253], v75 offset:4096
    ds_read_b64_tr_b16 a[254:255], v75 offset:4608
    s_waitcnt lgkmcnt(0)
    s_waitcnt vmcnt(28)
    s_barrier
    s_add_u32 m0, s40, 4096
    s_add_u32 s64, s72, 0x180000
    buffer_load_dwordx4 v76, s[52:55], s64 offen lds
    s_add_u32 m0, s40, 5120
    s_add_u32 s64, s72, 0x188000
    buffer_load_dwordx4 v77, s[52:55], s64 offen lds
    s_add_u32 m0, s40, 6144
    s_add_u32 s64, s72, 0x190000
    buffer_load_dwordx4 v78, s[52:55], s64 offen lds
    s_add_u32 m0, s40, 7168
    s_add_u32 s64, s72, 0x198000
    buffer_load_dwordx4 v79, s[52:55], s64 offen lds
    ds_read_b64_tr_b16 a[0:1], v72 offset:8192
    ds_read_b64_tr_b16 a[2:3], v72 offset:8704
    ds_read_b64_tr_b16 a[4:5], v73 offset:8192
    ds_read_b64_tr_b16 a[6:7], v73 offset:8704
    ds_read_b64_tr_b16 a[8:9], v74 offset:8192
    ds_read_b64_tr_b16 a[10:11], v74 offset:8704
    ds_read_b64_tr_b16 a[12:13], v75 offset:8192
    ds_read_b64_tr_b16 a[14:15], v75 offset:8704
    s_waitcnt lgkmcnt(0)
    s_waitcnt vmcnt(28)
    s_barrier
    s_add_u32 m0, s40, 8192
    s_add_u32 s64, s72, 0x200000
    buffer_load_dwordx4 v76, s[52:55], s64 offen lds
    s_add_u32 m0, s40, 9216
    s_add_u32 s64, s72, 0x208000
    buffer_load_dwordx4 v77, s[52:55], s64 offen lds
    s_add_u32 m0, s40, 10240
    s_add_u32 s64, s72, 0x210000
    buffer_load_dwordx4 v78, s[52:55], s64 offen lds
    s_add_u32 m0, s40, 11264
    s_add_u32 s64, s72, 0x218000
    buffer_load_dwordx4 v79, s[52:55], s64 offen lds
    ds_read_b64_tr_b16 a[16:17], v72 offset:12288
    ds_read_b64_tr_b16 a[18:19], v72 offset:12800
    ds_read_b64_tr_b16 a[20:21], v73 offset:12288
    ds_read_b64_tr_b16 a[22:23], v73 offset:12800
    ds_read_b64_tr_b16 a[24:25], v74 offset:12288
    ds_read_b64_tr_b16 a[26:27], v74 offset:12800
    ds_read_b64_tr_b16 a[28:29], v75 offset:12288
    ds_read_b64_tr_b16 a[30:31], v75 offset:12800
    s_waitcnt lgkmcnt(0)
    s_waitcnt vmcnt(28)
    s_barrier
    s_add_u32 m0, s40, 12288
    s_add_u32 s64, s39, 0x0
    buffer_load_dwordx4 v89, s[56:59], s64 offen lds
    s_add_u32 m0, s40, 13312
    s_add_u32 s64, s39, 0x5000
    buffer_load_dwordx4 v89, s[56:59], s64 offen lds
    s_add_u32 m0, s40, 14336
    s_add_u32 s64, s39, 0xa000
    buffer_load_dwordx4 v89, s[56:59], s64 offen lds
    s_add_u32 m0, s40, 15360
    s_add_u32 s64, s39, 0xf000
    buffer_load_dwordx4 v89, s[56:59], s64 offen lds
    ds_read_b64_tr_b16 a[32:33], v72 offset:16384
    ds_read_b64_tr_b16 a[34:35], v72 offset:16896
    ds_read_b64_tr_b16 a[36:37], v73 offset:16384
    ds_read_b64_tr_b16 a[38:39], v73 offset:16896
    ds_read_b64_tr_b16 a[40:41], v74 offset:16384
    ds_read_b64_tr_b16 a[42:43], v74 offset:16896
    ds_read_b64_tr_b16 a[44:45], v75 offset:16384
    ds_read_b64_tr_b16 a[46:47], v75 offset:16896
    s_waitcnt lgkmcnt(0)
    s_waitcnt vmcnt(28)
    s_barrier
    s_add_u32 m0, s40, 16384
    s_add_u32 s64, s39, 0x14000
    buffer_load_dwordx4 v89, s[56:59], s64 offen lds
    s_add_u32 m0, s40, 17408
    s_add_u32 s64, s39, 0x19000
    buffer_load_dwordx4 v89, s[56:59], s64 offen lds
    s_add_u32 m0, s40, 18432
    s_add_u32 s64, s39, 0x1e000
    buffer_load_dwordx4 v89, s[56:59], s64 offen lds
    s_add_u32 m0, s40, 19456
    s_add_u32 s64, s39, 0x23000
    buffer_load_dwordx4 v89, s[56:59], s64 offen lds
    ds_read_b64_tr_b16 a[48:49], v72 offset:20480
    ds_read_b64_tr_b16 a[50:51], v72 offset:20992
    ds_read_b64_tr_b16 a[52:53], v73 offset:20480
    ds_read_b64_tr_b16 a[54:55], v73 offset:20992
    ds_read_b64_tr_b16 a[56:57], v74 offset:20480
    ds_read_b64_tr_b16 a[58:59], v74 offset:20992
    ds_read_b64_tr_b16 a[60:61], v75 offset:20480
    ds_read_b64_tr_b16 a[62:63], v75 offset:20992
    s_waitcnt lgkmcnt(0)
    s_waitcnt vmcnt(28)
    s_barrier
    s_add_u32 m0, s40, 20480
    s_add_u32 s64, s39, 0x100
    buffer_load_dwordx4 v89, s[56:59], s64 offen lds
    s_add_u32 m0, s40, 21504
    s_add_u32 s64, s39, 0x5100
    buffer_load_dwordx4 v89, s[56:59], s64 offen lds
    s_add_u32 m0, s40, 22528
    s_add_u32 s64, s39, 0xa100
    buffer_load_dwordx4 v89, s[56:59], s64 offen lds
    s_add_u32 m0, s40, 23552
    s_add_u32 s64, s39, 0xf100
    buffer_load_dwordx4 v89, s[56:59], s64 offen lds
    ds_read_b64_tr_b16 a[64:65], v72 offset:24576
    ds_read_b64_tr_b16 a[66:67], v72 offset:25088
    ds_read_b64_tr_b16 a[68:69], v73 offset:24576
    ds_read_b64_tr_b16 a[70:71], v73 offset:25088
    ds_read_b64_tr_b16 a[72:73], v74 offset:24576
    ds_read_b64_tr_b16 a[74:75], v74 offset:25088
    ds_read_b64_tr_b16 a[76:77], v75 offset:24576
    ds_read_b64_tr_b16 a[78:79], v75 offset:25088
    s_waitcnt lgkmcnt(0)
    s_waitcnt vmcnt(28)
    s_barrier
    s_add_u32 m0, s40, 24576
    s_add_u32 s64, s39, 0x14100
    buffer_load_dwordx4 v89, s[56:59], s64 offen lds
    s_add_u32 m0, s40, 25600
    s_add_u32 s64, s39, 0x19100
    buffer_load_dwordx4 v89, s[56:59], s64 offen lds
    s_add_u32 m0, s40, 26624
    s_add_u32 s64, s39, 0x1e100
    buffer_load_dwordx4 v89, s[56:59], s64 offen lds
    s_add_u32 m0, s40, 27648
    s_add_u32 s64, s39, 0x23100
    buffer_load_dwordx4 v89, s[56:59], s64 offen lds
    ds_read_b64_tr_b16 a[80:81], v72 offset:28672
    ds_read_b64_tr_b16 a[82:83], v72 offset:29184
    ds_read_b64_tr_b16 a[84:85], v73 offset:28672
    ds_read_b64_tr_b16 a[86:87], v73 offset:29184
    ds_read_b64_tr_b16 a[88:89], v74 offset:28672
    ds_read_b64_tr_b16 a[90:91], v74 offset:29184
    ds_read_b64_tr_b16 a[92:93], v75 offset:28672
    ds_read_b64_tr_b16 a[94:95], v75 offset:29184
    s_waitcnt lgkmcnt(0)
    s_waitcnt vmcnt(28)
    s_barrier
    s_add_u32 m0, s40, 28672
    s_add_u32 s64, s41, 0x0
    buffer_load_dwordx4 v90, s[56:59], s64 offen lds
    s_add_u32 m0, s40, 29696
    s_add_u32 s64, s41, 0xa000
    buffer_load_dwordx4 v90, s[56:59], s64 offen lds
    s_add_u32 m0, s40, 30720
    s_add_u32 s64, s41, 0x14000
    buffer_load_dwordx4 v90, s[56:59], s64 offen lds
    s_add_u32 m0, s40, 31744
    s_add_u32 s64, s41, 0x1e000
    buffer_load_dwordx4 v90, s[56:59], s64 offen lds
    ds_read_b64_tr_b16 a[96:97], v72 offset:32768
    ds_read_b64_tr_b16 a[98:99], v72 offset:33280
    ds_read_b64_tr_b16 a[100:101], v73 offset:32768
    ds_read_b64_tr_b16 a[102:103], v73 offset:33280
    ds_read_b64_tr_b16 a[104:105], v74 offset:32768
    ds_read_b64_tr_b16 a[106:107], v74 offset:33280
    ds_read_b64_tr_b16 a[108:109], v75 offset:32768
    ds_read_b64_tr_b16 a[110:111], v75 offset:33280
    s_waitcnt lgkmcnt(0)
    s_waitcnt vmcnt(28)
    s_barrier
    s_add_u32 m0, s40, 32768
    s_add_u32 s64, s72, 0x180000
    buffer_load_dwordx4 v76, s[48:51], s64 offen lds
    s_add_u32 m0, s40, 33792
    s_add_u32 s64, s72, 0x188000
    buffer_load_dwordx4 v77, s[48:51], s64 offen lds
    s_add_u32 m0, s40, 34816
    s_add_u32 s64, s72, 0x190000
    buffer_load_dwordx4 v78, s[48:51], s64 offen lds
    s_add_u32 m0, s40, 35840
    s_add_u32 s64, s72, 0x198000
    buffer_load_dwordx4 v79, s[48:51], s64 offen lds
    v_lshlrev_b32 v80, 2, v0
    buffer_load_dword v81, v80, s[60:63], 0 offen sc1
    ds_read_b64_tr_b16 a[112:113], v72 offset:0
    ds_read_b64_tr_b16 a[114:115], v72 offset:512
    ds_read_b64_tr_b16 a[116:117], v73 offset:0
    ds_read_b64_tr_b16 a[118:119], v73 offset:512
    ds_read_b64_tr_b16 a[120:121], v74 offset:0
    ds_read_b64_tr_b16 a[122:123], v74 offset:512
    ds_read_b64_tr_b16 a[124:125], v75 offset:0
    ds_read_b64_tr_b16 a[126:127], v75 offset:512
    s_waitcnt lgkmcnt(0)
    s_waitcnt vmcnt(29)
    s_barrier
    s_add_u32 m0, s40, 0
    s_add_u32 s64, s71, 0x0
    buffer_load_dwordx4 v76, s[48:51], s64 offen lds
    s_add_u32 m0, s40, 1024
    s_add_u32 s64, s71, 0x8000
    buffer_load_dwordx4 v77, s[48:51], s64 offen lds
    s_add_u32 m0, s40, 2048
    s_add_u32 s64, s71, 0x10000
    buffer_load_dwordx4 v78, s[48:51], s64 offen lds
    s_add_u32 m0, s40, 3072
    s_add_u32 s64, s71, 0x18000
    buffer_load_dwordx4 v79, s[48:51], s64 offen lds
    ds_read_b64_tr_b16 a[128:129], v72 offset:4096
    ds_read_b64_tr_b16 a[130:131], v72 offset:4608
    ds_read_b64_tr_b16 a[132:133], v73 offset:4096
    ds_read_b64_tr_b16 a[134:135], v73 offset:4608
    ds_read_b64_tr_b16 a[136:137], v74 offset:4096
    ds_read_b64_tr_b16 a[138:139], v74 offset:4608
    ds_read_b64_tr_b16 a[140:141], v75 offset:4096
    ds_read_b64_tr_b16 a[142:143], v75 offset:4608
    s_waitcnt lgkmcnt(0)
    s_waitcnt vmcnt(29)
    s_barrier
    s_add_u32 m0, s40, 4096
    s_add_u32 s64, s71, 0x80000
    buffer_load_dwordx4 v76, s[48:51], s64 offen lds
    s_add_u32 m0, s40, 5120
    s_add_u32 s64, s71, 0x88000
    buffer_load_dwordx4 v77, s[48:51], s64 offen lds
    s_add_u32 m0, s40, 6144
    s_add_u32 s64, s71, 0x90000
    buffer_load_dwordx4 v78, s[48:51], s64 offen lds
    s_add_u32 m0, s40, 7168
    s_add_u32 s64, s71, 0x98000
    buffer_load_dwordx4 v79, s[48:51], s64 offen lds
    ds_read_b64_tr_b16 a[144:145], v72 offset:8192
    ds_read_b64_tr_b16 a[146:147], v72 offset:8704
    ds_read_b64_tr_b16 a[148:149], v73 offset:8192
    ds_read_b64_tr_b16 a[150:151], v73 offset:8704
    ds_read_b64_tr_b16 a[152:153], v74 offset:8192
    ds_read_b64_tr_b16 a[154:155], v74 offset:8704
    ds_read_b64_tr_b16 a[156:157], v75 offset:8192
    ds_read_b64_tr_b16 a[158:159], v75 offset:8704
    s_waitcnt lgkmcnt(0)
    s_waitcnt vmcnt(29)
    s_barrier
    s_add_u32 m0, s40, 8192
    s_add_u32 s64, s71, 0x100000
    buffer_load_dwordx4 v76, s[48:51], s64 offen lds
    s_add_u32 m0, s40, 9216
    s_add_u32 s64, s71, 0x108000
    buffer_load_dwordx4 v77, s[48:51], s64 offen lds
    s_add_u32 m0, s40, 10240
    s_add_u32 s64, s71, 0x110000
    buffer_load_dwordx4 v78, s[48:51], s64 offen lds
    s_add_u32 m0, s40, 11264
    s_add_u32 s64, s71, 0x118000
    buffer_load_dwordx4 v79, s[48:51], s64 offen lds
    ds_read_b64_tr_b16 a[160:161], v93 offset:12288
    ds_read_b64_tr_b16 a[162:163], v93 offset:12544
    ds_read_b64_tr_b16 a[164:165], v93 offset:13312
    ds_read_b64_tr_b16 a[166:167], v93 offset:13568
    ds_read_b64_tr_b16 a[168:169], v93 offset:14336
    ds_read_b64_tr_b16 a[170:171], v93 offset:14592
    ds_read_b64_tr_b16 a[172:173], v93 offset:15360
    ds_read_b64_tr_b16 a[174:175], v93 offset:15616
    s_waitcnt lgkmcnt(0)
    s_waitcnt vmcnt(29)
    s_barrier
    s_add_u32 m0, s40, 12288
    s_add_u32 s64, s71, 0x180000
    buffer_load_dwordx4 v76, s[48:51], s64 offen lds
    s_add_u32 m0, s40, 13312
    s_add_u32 s64, s71, 0x188000
    buffer_load_dwordx4 v77, s[48:51], s64 offen lds
    s_add_u32 m0, s40, 14336
    s_add_u32 s64, s71, 0x190000
    buffer_load_dwordx4 v78, s[48:51], s64 offen lds
    s_add_u32 m0, s40, 15360
    s_add_u32 s64, s71, 0x198000
    buffer_load_dwordx4 v79, s[48:51], s64 offen lds
    ds_read_b64_tr_b16 a[176:177], v93 offset:16384
    ds_read_b64_tr_b16 a[178:179], v93 offset:16640
    ds_read_b64_tr_b16 a[180:181], v93 offset:17408
    ds_read_b64_tr_b16 a[182:183], v93 offset:17664
    ds_read_b64_tr_b16 a[184:185], v93 offset:18432
    ds_read_b64_tr_b16 a[186:187], v93 offset:18688
    ds_read_b64_tr_b16 a[188:189], v93 offset:19456
    ds_read_b64_tr_b16 a[190:191], v93 offset:19712
    s_waitcnt lgkmcnt(0)
    s_waitcnt vmcnt(29)
    s_barrier
    s_add_u32 m0, s40, 16384
    s_add_u32 s64, s71, 0x200000
    buffer_load_dwordx4 v76, s[48:51], s64 offen lds
    s_add_u32 m0, s40, 17408
    s_add_u32 s64, s71, 0x208000
    buffer_load_dwordx4 v77, s[48:51], s64 offen lds
    s_add_u32 m0, s40, 18432
    s_add_u32 s64, s71, 0x210000
    buffer_load_dwordx4 v78, s[48:51], s64 offen lds
    s_add_u32 m0, s40, 19456
    s_add_u32 s64, s71, 0x218000
    buffer_load_dwordx4 v79, s[48:51], s64 offen lds
    ds_read_b64_tr_b16 a[192:193], v93 offset:20480
    ds_read_b64_tr_b16 a[194:195], v93 offset:20736
    ds_read_b64_tr_b16 a[196:197], v93 offset:21504
    ds_read_b64_tr_b16 a[198:199], v93 offset:21760
    ds_read_b64_tr_b16 a[200:201], v93 offset:22528
    ds_read_b64_tr_b16 a[202:203], v93 offset:22784
    ds_read_b64_tr_b16 a[204:205], v93 offset:23552
    ds_read_b64_tr_b16 a[206:207], v93 offset:23808
    s_waitcnt lgkmcnt(0)
    s_waitcnt vmcnt(29)
    s_barrier
    s_add_u32 m0, s40, 20480
    s_add_u32 s64, s72, 0x0
    buffer_load_dwordx4 v76, s[48:51], s64 offen lds
    s_add_u32 m0, s40, 21504
    s_add_u32 s64, s72, 0x8000
    buffer_load_dwordx4 v77, s[48:51], s64 offen lds
    s_add_u32 m0, s40, 22528
    s_add_u32 s64, s72, 0x10000
    buffer_load_dwordx4 v78, s[48:51], s64 offen lds
    s_add_u32 m0, s40, 23552
    s_add_u32 s64, s72, 0x18000
    buffer_load_dwordx4 v79, s[48:51], s64 offen lds
    ds_read_b64_tr_b16 a[208:209], v93 offset:24576
    ds_read_b64_tr_b16 a[210:211], v93 offset:24832
    ds_read_b64_tr_b16 a[212:213], v93 offset:25600
    ds_read_b64_tr_b16 a[214:215], v93 offset:25856
    ds_read_b64_tr_b16 a[216:217], v93 offset:26624
    ds_read_b64_tr_b16 a[218:219], v93 offset:26880
    ds_read_b64_tr_b16 a[220:221], v93 offset:27648
    ds_read_b64_tr_b16 a[222:223], v93 offset:27904
    s_waitcnt lgkmcnt(0)
    s_waitcnt vmcnt(29)
    s_barrier
    s_add_u32 m0, s40, 24576
    s_add_u32 s64, s72, 0x80000
    buffer_load_dwordx4 v76, s[48:51], s64 offen lds
    s_add_u32 m0, s40, 25600
    s_add_u32 s64, s72, 0x88000
    buffer_load_dwordx4 v77, s[48:51], s64 offen lds
    s_add_u32 m0, s40, 26624
    s_add_u32 s64, s72, 0x90000
    buffer_load_dwordx4 v78, s[48:51], s64 offen lds
    s_add_u32 m0, s40, 27648
    s_add_u32 s64, s72, 0x98000
    buffer_load_dwordx4 v79, s[48:51], s64 offen lds
    ds_read_b64_tr_b16 a[224:225], v94 offset:28672
    ds_read_b64_tr_b16 a[226:227], v94 offset:28800
    ds_read_b64_tr_b16 a[228:229], v94 offset:29696
    ds_read_b64_tr_b16 a[230:231], v94 offset:29824
    ds_read_b64_tr_b16 a[232:233], v94 offset:30720
    ds_read_b64_tr_b16 a[234:235], v94 offset:30848
    ds_read_b64_tr_b16 a[236:237], v94 offset:31744
    ds_read_b64_tr_b16 a[238:239], v94 offset:31872
    s_waitcnt lgkmcnt(0)
    s_waitcnt vmcnt(29)
    s_barrier
    s_add_u32 m0, s40, 28672
    s_add_u32 s64, s72, 0x100000
    buffer_load_dwordx4 v76, s[48:51], s64 offen lds
    s_add_u32 m0, s40, 29696
    s_add_u32 s64, s72, 0x108000
    buffer_load_dwordx4 v77, s[48:51], s64 offen lds
    s_add_u32 m0, s40, 30720
    s_add_u32 s64, s72, 0x110000
    buffer_load_dwordx4 v78, s[48:51], s64 offen lds
    s_add_u32 m0, s40, 31744
    s_add_u32 s64, s72, 0x118000
    buffer_load_dwordx4 v79, s[48:51], s64 offen lds
    s_mov_b32 s65, 0x290800
    buffer_load_dword v84, off, s[4:7], s65 sc1
    buffer_load_dwordx2 v[82:83], off, s[4:7], s69 sc1
    ds_read_b64_tr_b16 v[12:13], v72 offset:32768
    ds_read_b64_tr_b16 v[14:15], v72 offset:33280
    ds_read_b64_tr_b16 v[16:17], v73 offset:32768
    ds_read_b64_tr_b16 v[18:19], v73 offset:33280
    ds_read_b64_tr_b16 v[20:21], v74 offset:32768
    ds_read_b64_tr_b16 v[22:23], v74 offset:33280
    ds_read_b64_tr_b16 v[24:25], v75 offset:32768
    ds_read_b64_tr_b16 v[26:27], v75 offset:33280
    s_waitcnt lgkmcnt(0)
    s_barrier
    ds_write_b128 v2, v[12:15] offset:32768
    ds_write_b128 v2, v[16:19] offset:33792
    ds_write_b128 v2, v[20:23] offset:34816
    ds_write_b128 v2, v[24:27] offset:35840
    s_waitcnt lgkmcnt(0)
    s_waitcnt vmcnt(30)
    s_barrier
    ds_read_b64_tr_b16 v[12:13], v72 offset:0
    ds_read_b64_tr_b16 v[14:15], v72 offset:512
    ds_read_b64_tr_b16 v[16:17], v73 offset:0
    ds_read_b64_tr_b16 v[18:19], v73 offset:512
    ds_read_b64_tr_b16 v[20:21], v74 offset:0
    ds_read_b64_tr_b16 v[22:23], v74 offset:512
    ds_read_b64_tr_b16 v[24:25], v75 offset:0
    ds_read_b64_tr_b16 v[26:27], v75 offset:512
    s_waitcnt lgkmcnt(0)
    s_barrier
    ds_write_b128 v2, v[12:15] offset:0
    ds_write_b128 v2, v[16:19] offset:1024
    ds_write_b128 v2, v[20:23] offset:2048
    ds_write_b128 v2, v[24:27] offset:3072
    s_waitcnt lgkmcnt(0)
    s_waitcnt vmcnt(26)
    s_barrier
    ds_read_b64_tr_b16 v[12:13], v72 offset:4096
    ds_read_b64_tr_b16 v[14:15], v72 offset:4608
    ds_read_b64_tr_b16 v[16:17], v73 offset:4096
    ds_read_b64_tr_b16 v[18:19], v73 offset:4608
    ds_read_b64_tr_b16 v[20:21], v74 offset:4096
    ds_read_b64_tr_b16 v[22:23], v74 offset:4608
    ds_read_b64_tr_b16 v[24:25], v75 offset:4096
    ds_read_b64_tr_b16 v[26:27], v75 offset:4608
    s_waitcnt lgkmcnt(0)
    s_barrier
    ds_write_b128 v2, v[12:15] offset:4096
    ds_write_b128 v2, v[16:19] offset:5120
    ds_write_b128 v2, v[20:23] offset:6144
    ds_write_b128 v2, v[24:27] offset:7168
    s_waitcnt lgkmcnt(0)
    s_waitcnt vmcnt(22)
    s_barrier
    ds_read_b64_tr_b16 v[12:13], v72 offset:8192
    ds_read_b64_tr_b16 v[14:15], v72 offset:8704
    ds_read_b64_tr_b16 v[16:17], v73 offset:8192
    ds_read_b64_tr_b16 v[18:19], v73 offset:8704
    ds_read_b64_tr_b16 v[20:21], v74 offset:8192
    ds_read_b64_tr_b16 v[22:23], v74 offset:8704
    ds_read_b64_tr_b16 v[24:25], v75 offset:8192
    ds_read_b64_tr_b16 v[26:27], v75 offset:8704
    s_waitcnt lgkmcnt(0)
    s_barrier
    ds_write_b128 v2, v[12:15] offset:8192
    ds_write_b128 v2, v[16:19] offset:9216
    ds_write_b128 v2, v[20:23] offset:10240
    ds_write_b128 v2, v[24:27] offset:11264
    s_waitcnt lgkmcnt(0)
    s_waitcnt vmcnt(18)
    s_barrier
    ds_read_b64_tr_b16 v[12:13], v72 offset:12288
    ds_read_b64_tr_b16 v[14:15], v72 offset:12800
    ds_read_b64_tr_b16 v[16:17], v73 offset:12288
    ds_read_b64_tr_b16 v[18:19], v73 offset:12800
    ds_read_b64_tr_b16 v[20:21], v74 offset:12288
    ds_read_b64_tr_b16 v[22:23], v74 offset:12800
    ds_read_b64_tr_b16 v[24:25], v75 offset:12288
    ds_read_b64_tr_b16 v[26:27], v75 offset:12800
    s_waitcnt lgkmcnt(0)
    s_barrier
    ds_write_b128 v2, v[12:15] offset:12288
    ds_write_b128 v2, v[16:19] offset:13312
    ds_write_b128 v2, v[20:23] offset:14336
    ds_write_b128 v2, v[24:27] offset:15360
    s_waitcnt lgkmcnt(0)
    s_waitcnt vmcnt(14)
    s_barrier
    ds_read_b64_tr_b16 v[12:13], v72 offset:16384
    ds_read_b64_tr_b16 v[14:15], v72 offset:16896
    ds_read_b64_tr_b16 v[16:17], v73 offset:16384
    ds_read_b64_tr_b16 v[18:19], v73 offset:16896
    ds_read_b64_tr_b16 v[20:21], v74 offset:16384
    ds_read_b64_tr_b16 v[22:23], v74 offset:16896
    ds_read_b64_tr_b16 v[24:25], v75 offset:16384
    ds_read_b64_tr_b16 v[26:27], v75 offset:16896
    s_waitcnt lgkmcnt(0)
    s_barrier
    ds_write_b128 v2, v[12:15] offset:16384
    ds_write_b128 v2, v[16:19] offset:17408
    ds_write_b128 v2, v[20:23] offset:18432
    ds_write_b128 v2, v[24:27] offset:19456
    s_waitcnt lgkmcnt(0)
    s_waitcnt vmcnt(10)
    s_barrier
    ds_read_b64_tr_b16 v[12:13], v72 offset:20480
    ds_read_b64_tr_b16 v[14:15], v72 offset:20992
    ds_read_b64_tr_b16 v[16:17], v73 offset:20480
    ds_read_b64_tr_b16 v[18:19], v73 offset:20992
    ds_read_b64_tr_b16 v[20:21], v74 offset:20480
    ds_read_b64_tr_b16 v[22:23], v74 offset:20992
    ds_read_b64_tr_b16 v[24:25], v75 offset:20480
    ds_read_b64_tr_b16 v[26:27], v75 offset:20992
    s_waitcnt lgkmcnt(0)
    s_barrier
    ds_write_b128 v2, v[12:15] offset:20480
    ds_write_b128 v2, v[16:19] offset:21504
    ds_write_b128 v2, v[20:23] offset:22528
    ds_write_b128 v2, v[24:27] offset:23552
    s_waitcnt lgkmcnt(0)
    s_waitcnt vmcnt(6)
    s_barrier
    ds_read_b64_tr_b16 v[12:13], v72 offset:24576
    ds_read_b64_tr_b16 v[14:15], v72 offset:25088
    ds_read_b64_tr_b16 v[16:17], v73 offset:24576
    ds_read_b64_tr_b16 v[18:19], v73 offset:25088
    ds_read_b64_tr_b16 v[20:21], v74 offset:24576
    ds_read_b64_tr_b16 v[22:23], v74 offset:25088
    ds_read_b64_tr_b16 v[24:25], v75 offset:24576
    ds_read_b64_tr_b16 v[26:27], v75 offset:25088
    s_waitcnt lgkmcnt(0)
    s_barrier
    ds_write_b128 v2, v[12:15] offset:24576
    ds_write_b128 v2, v[16:19] offset:25600
    ds_write_b128 v2, v[20:23] offset:26624
    ds_write_b128 v2, v[24:27] offset:27648
    s_waitcnt lgkmcnt(0)
    s_waitcnt vmcnt(2)
    s_barrier
    ds_read_b64_tr_b16 v[12:13], v72 offset:28672
    ds_read_b64_tr_b16 v[14:15], v72 offset:29184
    ds_read_b64_tr_b16 v[16:17], v73 offset:28672
    ds_read_b64_tr_b16 v[18:19], v73 offset:29184
    ds_read_b64_tr_b16 v[20:21], v74 offset:28672
    ds_read_b64_tr_b16 v[22:23], v74 offset:29184
    ds_read_b64_tr_b16 v[24:25], v75 offset:28672
    ds_read_b64_tr_b16 v[26:27], v75 offset:29184
    s_waitcnt lgkmcnt(0)
    s_barrier
    ds_write_b128 v2, v[12:15] offset:28672
    ds_write_b128 v2, v[16:19] offset:29696
    ds_write_b128 v2, v[20:23] offset:30720
    ds_write_b128 v2, v[24:27] offset:31744
    s_waitcnt lgkmcnt(0)
    s_waitcnt vmcnt(0)
    s_cmp_lg_u32 s97, 0
    s_cbranch_scc1 NOTEARLY_8
    v_cmp_ne_u32 vcc, 32, v81
    v_readlane_b32 s64, v81, 1
    v_readlane_b32 s66, v81, 33
    v_readlane_b32 s67, v81, 34
    s_and_b32 s65, vcc_lo, 0x01010101
    s_cbranch_scc1 NOTEARLY_8
    s_and_b32 s65, vcc_hi, 0x01010101
    s_cbranch_scc1 NOTEARLY_8
    s_cmp_lt_u32 s64, 192
    s_cbranch_scc1 NOTEARLY_8
    v_readfirstlane_b32 s64, v84
    s_cmp_lt_u32 s64, 192
    s_cbranch_scc1 NOTEARLY_8
    s_min_u32 s65, s66, s67
    s_cmp_eq_u32 s65, 0
    s_cbranch_scc1 NOTEARLY_8
    s_sub_u32 s66, s66, 1
    s_sub_u32 s67, s67, 1
    s_branch EARLY_7
NOTEARLY_8:
    s_cmp_lg_u32 s97, 0
    s_cbranch_scc1 CM_9
    v_mbcnt_lo_u32_b32 v0, -1, 0
    v_mbcnt_hi_u32_b32 v0, -1, v0
    v_mul_u32_u24 v8, 32, v0
    s_mov_b32 s64, 0x0
    s_mov_b32 s65, 0
    s_mov_b64 exec, 0xff
TK_10:
    buffer_load_dword v9, v8, s[60:63], s64 offen sc1
    s_add_u32 s65, s65, 1
    s_waitcnt vmcnt(0)
    s_mov_b32 s66, 0
    v_readlane_b32 s67, v9, 0
    s_add_u32 s66, s66, s67
    v_readlane_b32 s67, v9, 1
    s_add_u32 s66, s66, s67
    v_readlane_b32 s67, v9, 2
    s_add_u32 s66, s66, s67
    v_readlane_b32 s67, v9, 3
    s_add_u32 s66, s66, s67
    v_readlane_b32 s67, v9, 4
    s_add_u32 s66, s66, s67
    v_readlane_b32 s67, v9, 5
    s_add_u32 s66, s66, s67
    v_readlane_b32 s67, v9, 6
    s_add_u32 s66, s66, s67
    v_readlane_b32 s67, v9, 7
    s_add_u32 s66, s66, s67
    s_cmp_ge_u32 s66, 256
    s_cbranch_scc1 TKD_11
    s_cmp_gt_u32 s65, 262144
    s_cbranch_scc0 TK_10
TKD_11:
    v_cmp_ne_u32 vcc, 32, v9
    s_mov_b64 exec, -1
    s_cbranch_vccnz M_SLOW
CM_9:
    s_mov_b32 s65, 0
RI_12:
    buffer_load_dword v8, off, s[60:63], s95 sc1
    s_add_u32 s65, s65, 1
    s_waitcnt vmcnt(0)
    v_readfirstlane_b32 s64, v8
    s_cmp_ge_u32 s64, 192
    s_cbranch_scc1 RID_13
    s_cmp_gt_u32 s65, 65536
    s_cbranch_scc1 RID_13
    s_sleep 4
    s_branch RI_12
RID_13:
    s_mov_b32 s65, 0
    s_mov_b32 s66, 0x290800
RB_14:
    buffer_load_dword v8, off, s[4:7], s66 sc1
    s_add_u32 s65, s65, 1
    s_waitcnt vmcnt(0)
    v_readfirstlane_b32 s64, v8
    s_cmp_ge_u32 s64, 192
    s_cbranch_scc1 RBD_15
    s_cmp_gt_u32 s65, 65536
    s_cbranch_scc1 RBD_15
    s_sleep 8
    s_branch RB_14
RBD_15:
    s_mov_b32 s65, 0
CW_16:
    buffer_load_dwordx2 v[8:9], off, s[60:63], 0 offset:132 sc1
    s_add_u32 s65, s65, 1
    s_waitcnt vmcnt(0)
    v_readfirstlane_b32 s66, v8
    v_readfirstlane_b32 s67, v9
    s_min_u32 s64, s66, s67
    s_cmp_lg_u32 s64, 0
    s_cbranch_scc1 CWD_17
    s_cmp_gt_u32 s65, 65536
    s_cbranch_scc1 CWD_17
    s_sleep 4
    s_branch CW_16
CWD_17:
    s_sub_u32 s66, s66, 1
    s_and_b32 s66, s66, 3
    s_sub_u32 s67, s67, 1
    s_and_b32 s67, s67, 3
EARLY_7:
    s_mov_b32 s56, s66
    s_mov_b32 s57, s67
    s_mov_b32 s38, 0x3f80
    s_mov_b32 s53, 0
    s_cmp_eq_u32 s14, 2
    s_cselect_b32 s52, 1024, 0
    s_cmp_eq_u32 s14, 3
    s_cselect_b32 s58, 0, 1
    s_mov_b32 s59, 0
    s_cmp_eq_u32 s12, 0
    s_cselect_b32 s55, 2, 0
    s_mov_b32 s44, 0x3030303
    s_mov_b32 s45, 0x3030303
    s_mov_b32 s46, 0xc0c0c0c
    s_mov_b32 s47, 0xc0c0c0c
    s_mov_b32 s48, 0x30303030
    s_mov_b32 s49, 0x30303030
    s_mov_b32 s50, 0xc0c0c0c0
    s_mov_b32 s51, 0xc0c0c0c0
    v_and_b32 v8, 7, v0
    v_mul_u32_u24 v8, 288, v8
    v_lshrrev_b32 v9, 4, v0
    v_lshl_add_u32 v8, v9, 4, v8
    v_add_u32 v0, 12800, v8
    s_mov_b32 s68, 0
    s_mov_b32 s40, 0
    s_mov_b32 s64, s56
    s_mov_b32 s65, s57
    s_cmp_eq_u32 s12, 0
    s_cselect_b32 s66, s65, s64
    s_cselect_b32 s64, s64, s65
    s_and_b32 s64, s64, 3
    s_lshl_b32 s64, s64, 13
    s_and_b32 s66, s66, 3
    s_lshl_b32 s66, s66, 13
    s_add_u32 s21, s21, s64
    s_add_u32 s20, s20, s66
    s_cmp_eq_u32 s42, 0
    s_cselect_b32 s18, 0x40000000, s18
    s_cselect_b32 s21, 0x40000000, s21
    s_lshl_b32 s65, s12, 7
    s_add_u32 s65, s65, 0x29a000
    s_cmp_eq_u32 s22, 0
    s_cselect_b32 s22, 0x40000000, s65
    s_lshl_b32 s64, s13, 2
    s_add_u32 s64, s64, s14
    s_cmp_ge_u32 s64, 40
    s_cselect_b32 s65, 40, 0
    s_sub_u32 s64, s64, s65
    s_cmp_ge_u32 s64, 40
    s_cselect_b32 s65, 40, 0
    s_sub_u32 s64, s64, s65
    s_cmp_ge_u32 s64, 40
    s_cselect_b32 s65, 40, 0
    s_sub_u32 s64, s64, s65
    s_lshl_b32 s27, s64, 7
    s_add_u32 s19, s27, 0x4000
    v_and_b32 v82, v82, v83
    v_cmp_eq_u32 vcc, 0, v82
    s_cmp_lg_u32 s97, 0
    s_cselect_b64 vcc, -1, vcc
    s_cbranch_vccz KVOK_18
    v_mov_b32 v29, 0
FSPIN_19:
    buffer_load_dwordx2 v[12:13], v29, s[4:7], s69 offen sc1
    s_add_u32 s68, s68, 1
    s_waitcnt vmcnt(0)
    v_and_b32 v12, v12, v13
    v_cmp_eq_u32 vcc, 0, v12
    s_cbranch_vccz FDONE_20
    s_cmp_gt_u32 s68, 262144
    s_cbranch_scc0 FSPIN_19
FDONE_20:
KVOK_18:
    s_barrier
    s_mov_b32 m0, s73
    s_nop 0
    buffer_load_dwordx4 v1, s[4:7], s28 offen lds
    buffer_load_dwordx4 v1, s[4:7], s28 offen offset:1024 lds
    s_mov_b32 m0, 16128
    v_lshlrev_b32 v12, 2, v1
    s_add_u32 s65, s3, 0xfff80000
    buffer_load_dword v12, s[4:7], s65 offen lds
    s_mov_b32 s15, 0
    s_mov_b32 s16, 0
    s_add_u32 s66, s17, s52
    buffer_load_dwordx4 v[12:15], v1, s[4:7], s66 offen sc1
    buffer_load_dwordx4 v[16:19], v1, s[4:7], s17 offen offset:2048 sc1
    v_add_u32 v29, s52, v1
    s_waitcnt vmcnt(0)
    ds_write_b128 v29, v[12:15] offset:12800
    ds_write_b128 v1, v[16:19] offset:15104
    s_waitcnt lgkmcnt(0)
    v_mov_b64 v[32:33], 0
    v_mov_b64 v[34:35], 0
    v_mov_b64 v[36:37], 0
    v_mov_b64 v[38:39], 0
    v_mov_b64 v[40:41], 0
    v_mov_b64 v[42:43], 0
    v_mov_b64 v[44:45], 0
    v_mov_b64 v[46:47], 0
    v_mov_b64 v[48:49], 0
    v_mov_b64 v[50:51], 0
    v_mov_b64 v[52:53], 0
    v_mov_b64 v[54:55], 0
    v_mov_b32 v9, 0x40000000
    ds_read_b128 v[56:59], v2 offset:0
    ds_read_b128 v[60:63], v2 offset:1024
    ds_read_b128 v[64:67], v2 offset:2048
    ds_read_b128 v[68:71], v2 offset:3072
    s_cmp_eq_u32 s97, 0
    s_cbranch_scc1 REC_LOOP
    s_branch REC_LOOP_S
REC_POLL_S:
    s_cmp_eq_u32 s59, 0
    s_cbranch_scc1 NOFLG_21
    s_waitcnt vmcnt(0)
    v_lshrrev_b32 v29, 2, v1
    ds_read_b32 v12, v29 offset:15104
    s_add_u32 s64, s15, 2
    s_lshr_b32 s65, s64, 1
    s_add_u32 s67, s65, 1
    s_waitcnt lgkmcnt(0)
    v_cmp_ne_u32 vcc, 0, v12
    v_readlane_b32 s65, v12, s65
    v_readlane_b32 s67, v12, s67
    s_cmp_eq_u32 vcc_lo, -1
    s_cselect_b32 s58, 1, 0
    s_and_b32 s65, s65, s67
    s_cbranch_scc1 NOFLG_21
    s_lshl_b32 s64, s64, 7
    s_add_u32 s64, s64, s69
    v_mov_b32 v29, 0
FSPIN_23:
    buffer_load_dwordx2 v[12:13], v29, s[4:7], s64 offen sc1
    s_add_u32 s68, s68, 1
    s_waitcnt vmcnt(0)
    v_and_b32 v12, v12, v13
    v_cmp_eq_u32 vcc, 0, v12
    s_cbranch_vccz FDONE_24
    s_cmp_gt_u32 s68, 262144
    s_cbranch_scc0 FSPIN_23
FDONE_24:
NOFLG_21:
    s_add_u32 s64, s15, 3
    s_and_b32 s64, s64, 0x43
    s_or_b32 s64, s64, s58
    s_cmp_eq_u32 s64, 0
    s_cselect_b32 s59, 1, 0
    s_cmp_eq_u32 s15, 63
    s_cselect_b32 s59, s55, s59
    s_add_u32 s66, s17, s52
    v_add_u32 v10, s52, v1
    s_xor_b32 s16, s16, 1
    v_mov_b64 v[32:33], 0
    v_mov_b64 v[34:35], 0
    v_mov_b64 v[36:37], 0
    v_mov_b64 v[38:39], 0
    v_mov_b64 v[40:41], 0
    v_mov_b64 v[42:43], 0
    v_mov_b64 v[44:45], 0
    v_mov_b64 v[46:47], 0
    v_mov_b64 v[48:49], 0
    v_mov_b64 v[50:51], 0
    v_mov_b64 v[52:53], 0
    v_mov_b64 v[54:55], 0
    ds_read_b128 v[56:59], v2 offset:0
    ds_read_b128 v[60:63], v2 offset:1024
    ds_read_b128 v[64:67], v2 offset:2048
    ds_read_b128 v[68:71], v2 offset:3072
    s_barrier
    s_nop 14
    buffer_load_dwordx4 v[20:23], v1, s[4:7], s66 offen offset:0 sc1
    s_nop 7
    buffer_load_dwordx4 v[24:27], v1, s[4:7], s66 offen offset:0 sc1
    s_nop 7
    buffer_load_dwordx4 v[28:31], v1, s[4:7], s66 offen offset:0 sc1
IPOLL_26:
    s_waitcnt vmcnt(2)
    ds_write_b128 v10, v[20:23] offset:12800
    v_max3_u32 v11, v20, v21, v22
    v_max_u32 v11, v11, v23
    v_cmp_eq_u32 vcc, -1, v11
    s_cbranch_vccz IOK_25
    buffer_load_dwordx4 v[20:23], v1, s[4:7], s66 offen offset:0 sc1
    s_waitcnt vmcnt(2)
    ds_write_b128 v10, v[24:27] offset:12800
    v_max3_u32 v11, v24, v25, v26
    v_max_u32 v11, v11, v27
    v_cmp_eq_u32 vcc, -1, v11
    s_cbranch_vccz IOK_25
    buffer_load_dwordx4 v[24:27], v1, s[4:7], s66 offen offset:0 sc1
    s_waitcnt vmcnt(2)
    ds_write_b128 v10, v[28:31] offset:12800
    v_max3_u32 v11, v28, v29, v30
    v_max_u32 v11, v11, v31
    v_cmp_eq_u32 vcc, -1, v11
    s_add_u32 s68, s68, 1
    s_add_u32 s53, s53, 1
    s_cmp_gt_u32 s68, 262144
    s_cbranch_scc1 IOK_25
    s_cbranch_vccz IOK_25
    buffer_load_dwordx4 v[28:31], v1, s[4:7], s66 offen offset:0 sc1
    s_branch IPOLL_26
IOK_25:
    s_waitcnt lgkmcnt(0)
REC_LOOP_S:
    s_barrier
    ds_read_b128 v[12:15], v1 offset:12800
    ds_read_b128 v[16:19], v1 offset:13824
    buffer_load_dwordx4 v[20:23], v1, s[4:7], s17 offen offset:2048
    ds_read_b128 v[72:75], v2 offset:4096
    ds_read_b128 v[76:79], v2 offset:5120
    ds_read_b128 v[80:83], v2 offset:6144
    ds_read_b128 v[84:87], v2 offset:7168
    s_add_u32 s74, s17, 0x1000
    s_add_u32 s20, s20, 0x8000
    s_add_u32 s75, s20, 0x1000
    s_mov_b32 m0, 16128
    s_add_u32 s65, s20, s27
    s_waitcnt lgkmcnt(5)
    v_smfmac_f32_16x16x64_bf16 v[32:35], v[12:15], v[96:103], v6
    buffer_load_dwordx4 v[24:27], v1, s[4:7], s17 offen offset:3072
    v_smfmac_f32_16x16x64_bf16 v[36:39], v[12:15], v[104:111], v6
    v_smfmac_f32_16x16x64_bf16 v[40:43], v[12:15], v[56:63], v6
    buffer_load_dwordx4 v[28:31], v1, s[4:7], s74 offen offset:0
    ds_read_b128 v[56:59], v2 offset:8192
    ds_read_b128 v[60:63], v2 offset:9216
    v_smfmac_f32_16x16x64_bf16 v[44:47], v[12:15], v[64:71], v6
    ds_read_b128 v[64:67], v2 offset:10240
    ds_read_b128 v[68:71], v2 offset:11264
    s_waitcnt lgkmcnt(8)
    v_smfmac_f32_16x16x64_bf16 v[48:51], v[12:15], a[0:7], v6
    v_smfmac_f32_16x16x64_bf16 v[52:55], v[12:15], a[8:15], v6
    buffer_load_dwordx4 v[12:15], v1, s[4:7], s20 offen offset:0
    buffer_load_dword off, s[4:7], s65 lds
    v_smfmac_f32_16x16x64_bf16 v[32:35], v[16:19], v[112:119], v6
    v_smfmac_f32_16x16x64_bf16 v[36:39], v[16:19], v[120:127], v6
    s_waitcnt lgkmcnt(4)
    v_smfmac_f32_16x16x64_bf16 v[40:43], v[16:19], v[72:79], v6
    ds_read_b128 v[72:75], v2 offset:12288
    ds_read_b128 v[76:79], v2 offset:13312
    v_smfmac_f32_16x16x64_bf16 v[44:47], v[16:19], v[80:87], v6
    ds_read_b128 v[80:83], v2 offset:14336
    ds_read_b128 v[84:87], v2 offset:15360
    s_waitcnt vmcnt(4)
    v_cmp_eq_u32 vcc, -1, v23
    v_smfmac_f32_16x16x64_bf16 v[48:51], v[16:19], a[16:23], v6
    v_smfmac_f32_16x16x64_bf16 v[52:55], v[16:19], a[24:31], v6
    s_cbranch_vccnz RETRY_27
BACK_28:
    buffer_load_dwordx4 v[16:19], v1, s[4:7], s20 offen offset:1024
    v_smfmac_f32_16x16x64_bf16 v[32:35], v[20:23], v[128:135], v6
    v_smfmac_f32_16x16x64_bf16 v[36:39], v[20:23], v[136:143], v6
    s_waitcnt lgkmcnt(4)
    v_smfmac_f32_16x16x64_bf16 v[40:43], v[20:23], v[56:63], v6
    ds_read_b128 v[56:59], v2 offset:16384
    ds_read_b128 v[60:63], v2 offset:17408
    v_smfmac_f32_16x16x64_bf16 v[44:47], v[20:23], v[64:71], v6
    ds_read_b128 v[64:67], v2 offset:18432
    ds_read_b128 v[68:71], v2 offset:19456
    s_waitcnt vmcnt(4)
    v_cmp_eq_u32 vcc, -1, v27
    v_smfmac_f32_16x16x64_bf16 v[48:51], v[20:23], a[32:39], v6
    v_smfmac_f32_16x16x64_bf16 v[52:55], v[20:23], a[40:47], v6
    s_cbranch_vccnz RETRY_29
BACK_30:
    buffer_load_dwordx4 v[20:23], v1, s[4:7], s20 offen offset:2048
    v_smfmac_f32_16x16x64_bf16 v[32:35], v[24:27], v[144:151], v6
    v_smfmac_f32_16x16x64_bf16 v[36:39], v[24:27], v[152:159], v6
    s_waitcnt lgkmcnt(4)
    v_smfmac_f32_16x16x64_bf16 v[40:43], v[24:27], v[72:79], v6
    ds_read_b128 v[72:75], v2 offset:20480
    ds_read_b128 v[76:79], v2 offset:21504
    v_smfmac_f32_16x16x64_bf16 v[44:47], v[24:27], v[80:87], v6
    ds_read_b128 v[80:83], v2 offset:22528
    ds_read_b128 v[84:87], v2 offset:23552
    s_waitcnt vmcnt(4)
    v_cmp_eq_u32 vcc, -1, v31
    v_smfmac_f32_16x16x64_bf16 v[48:51], v[24:27], a[48:55], v6
    v_smfmac_f32_16x16x64_bf16 v[52:55], v[24:27], a[56:63], v6
    s_cbranch_vccnz RETRY_31
BACK_32:
    buffer_load_dwordx4 v[24:27], v1, s[4:7], s20 offen offset:3072
    v_smfmac_f32_16x16x64_bf16 v[32:35], v[28:31], v[160:167], v6
    v_smfmac_f32_16x16x64_bf16 v[36:39], v[28:31], v[168:175], v6
    s_waitcnt lgkmcnt(4)
    v_smfmac_f32_16x16x64_bf16 v[40:43], v[28:31], v[56:63], v6
    ds_read_b128 v[56:59], v2 offset:24576
    ds_read_b128 v[60:63], v2 offset:25600
    v_smfmac_f32_16x16x64_bf16 v[44:47], v[28:31], v[64:71], v6
    ds_read_b128 v[64:67], v2 offset:26624
    ds_read_b128 v[68:71], v2 offset:27648
    s_waitcnt vmcnt(4)
    v_cmp_eq_u32 vcc, -1, v15
    v_smfmac_f32_16x16x64_bf16 v[48:51], v[28:31], a[64:71], v6
    v_smfmac_f32_16x16x64_bf16 v[52:55], v[28:31], a[72:79], v6
    s_cbranch_vccnz RETRY_33
BACK_34:
    buffer_load_dwordx4 v[28:31], v1, s[4:7], s75 offen offset:0
    v_smfmac_f32_16x16x64_bf16 v[32:35], v[12:15], v[176:183], v6
    s_waitcnt vmcnt(3)
    v_cmp_eq_u32 vcc, -1, v19
    v_smfmac_f32_16x16x64_bf16 v[36:39], v[12:15], v[184:191], v6
    s_waitcnt lgkmcnt(4)
    v_smfmac_f32_16x16x64_bf16 v[40:43], v[12:15], v[72:79], v6
    ds_read_b128 v[72:75], v2 offset:28672
    ds_read_b128 v[76:79], v2 offset:29696
    v_smfmac_f32_16x16x64_bf16 v[44:47], v[12:15], v[80:87], v6
    ds_read_b128 v[80:83], v2 offset:30720
    ds_read_b128 v[84:87], v2 offset:31744
    buffer_load_dwordx4 v[88:91], v1, s[4:7], s29 offen offset:0
    s_cbranch_vccnz RETRY_35
BACK_36:
    v_smfmac_f32_16x16x64_bf16 v[32:35], v[16:19], v[192:199], v6
    s_waitcnt vmcnt(3)
    v_cmp_eq_u32 vcc, -1, v23
    v_smfmac_f32_16x16x64_bf16 v[36:39], v[16:19], v[200:207], v6
    s_waitcnt lgkmcnt(4)
    v_smfmac_f32_16x16x64_bf16 v[40:43], v[16:19], v[56:63], v6
    ds_read_b128 v[56:59], v2 offset:32768
    ds_read_b128 v[60:63], v2 offset:33792
    v_smfmac_f32_16x16x64_bf16 v[44:47], v[16:19], v[64:71], v6
    ds_read_b128 v[64:67], v2 offset:34816
    ds_read_b128 v[68:71], v2 offset:35840
    s_cbranch_vccnz RETRY_37
BACK_38:
    v_smfmac_f32_16x16x64_bf16 v[32:35], v[20:23], v[208:215], v6
    s_waitcnt vmcnt(2)
    v_cmp_eq_u32 vcc, -1, v27
    v_smfmac_f32_16x16x64_bf16 v[36:39], v[20:23], v[216:223], v6
    s_waitcnt lgkmcnt(4)
    v_smfmac_f32_16x16x64_bf16 v[40:43], v[20:23], v[72:79], v6
    ds_read_b128 v[72:75], v1 offset:0
    ds_read_b128 v[76:79], v1 offset:4096
    v_smfmac_f32_16x16x64_bf16 v[44:47], v[20:23], v[80:87], v6
    ds_read_b128 v[80:83], v1 offset:1024
    ds_read_b128 v[84:87], v1 offset:5120
    buffer_load_dwordx4 v[92:95], v1, s[4:7], s29 offen offset:1024
    s_cbranch_vccnz RETRY_39
BACK_40:
    v_smfmac_f32_16x16x64_bf16 v[32:35], v[24:27], v[224:231], v6
    s_waitcnt vmcnt(2)
    v_cmp_eq_u32 vcc, -1, v31
    v_smfmac_f32_16x16x64_bf16 v[36:39], v[24:27], v[232:239], v6
    s_waitcnt lgkmcnt(4)
    v_smfmac_f32_16x16x64_bf16 v[40:43], v[24:27], v[56:63], v6
    ds_read_b128 v[56:59], v1 offset:2048
    ds_read_b128 v[60:63], v1 offset:6144
    v_smfmac_f32_16x16x64_bf16 v[44:47], v[24:27], v[64:71], v6
    ds_read_b128 v[64:67], v1 offset:3072
    ds_read_b128 v[68:71], v1 offset:7168
    s_cbranch_vccnz RETRY_41
BACK_42:
    v_smfmac_f32_16x16x64_bf16 v[32:35], v[28:31], v[240:247], v6
    v_smfmac_f32_16x16x64_bf16 v[36:39], v[28:31], v[248:255], v6
    v_smfmac_f32_16x16x64_bf16 v[40:43], v[28:31], a[240:247], v6
    v_smfmac_f32_16x16x64_bf16 v[44:47], v[28:31], a[248:255], v6
    v_lshlrev_b32 v8, 2, v1
    s_add_u32 s65, s17, s19
    buffer_load_dword v8, s[4:7], s3 offen lds
    buffer_load_dword off, s[4:7], s65 sc1 lds
    buffer_store_dword v6, off, s[4:7], s22 sc1
    s_add_u32 s22, s22, 256
    s_cmp_eq_u32 s59, 0
    s_cbranch_scc1 KVLOOK_43
    s_cmp_eq_u32 s59, 1
    s_cbranch_scc1 KVL1_44
    s_lshl_b32 s64, s13, 13
    s_add_u32 s64, s64, 0x43c0000
    buffer_load_dwordx4 v[96:99], v1, s[4:7], s64 offen offset:0
    buffer_load_dwordx4 v[100:103], v1, s[4:7], s64 offen offset:1024
    buffer_load_dwordx4 v[104:107], v1, s[4:7], s64 offen offset:2048
    buffer_load_dwordx4 v[108:111], v1, s[4:7], s64 offen offset:3072
    s_add_u32 s64, s64, 0x1000
    buffer_load_dwordx4 v[112:115], v1, s[4:7], s64 offen offset:0
    buffer_load_dwordx4 v[116:119], v1, s[4:7], s64 offen offset:1024
    buffer_load_dwordx4 v[120:123], v1, s[4:7], s64 offen offset:2048
    buffer_load_dwordx4 v[124:127], v1, s[4:7], s64 offen offset:3072
    s_branch KVLOOK_43
KVL1_44:
    v_lshrrev_b32 v9, 5, v1
    v_lshlrev_b32 v9, 9, v9
    v_bfe_u32 v10, v1, 4, 1
    v_lshl_add_u32 v9, v10, 2, v9
    s_mov_b32 m0, 15104
    s_mov_b64 exec, s[34:35]
    buffer_load_dword v9, s[4:7], s69 offen sc1 lds
    s_mov_b64 exec, -1
    s_mov_b32 m0, 16128
KVLOOK_43:
    v_permlane32_swap_b32 v32, v36
    v_permlane32_swap_b32 v33, v37
    v_permlane32_swap_b32 v34, v38
    v_permlane32_swap_b32 v35, v39
    v_pk_add_f32 v[32:33], v[32:33], v[36:37]
    v_pk_add_f32 v[34:35], v[34:35], v[38:39]
    v_cvt_pk_bf16_f32 v36, v32, v33
    v_cvt_pk_bf16_f32 v37, v34, v35
    ds_write_b64 v3, v[36:37] offset:0
    v_permlane32_swap_b32 v40, v44
    v_permlane32_swap_b32 v41, v45
    v_permlane32_swap_b32 v42, v46
    v_permlane32_swap_b32 v43, v47
    v_pk_add_f32 v[40:41], v[40:41], v[44:45]
    v_pk_add_f32 v[42:43], v[42:43], v[46:47]
    v_cvt_pk_bf16_f32 v44, v40, v41
    v_cvt_pk_bf16_f32 v45, v42, v43
    ds_write_b64 v3, v[44:45] offset:2304
    v_smfmac_f32_16x16x64_bf16 v[48:51], v[12:15], a[80:87], v6
    v_smfmac_f32_16x16x64_bf16 v[52:55], v[12:15], a[88:95], v6
    v_smfmac_f32_16x16x64_bf16 v[48:51], v[16:19], a[96:103], v6
    v_smfmac_f32_16x16x64_bf16 v[52:55], v[16:19], a[104:111], v6
    s_waitcnt lgkmcnt(0)
    s_barrier
    ds_read_b64_tr_b16 v[32:33], v4 offset:0
    ds_read_b64_tr_b16 v[34:35], v4 offset:128
    ds_read_b64_tr_b16 v[36:37], v4 offset:256
    ds_read_b64_tr_b16 v[38:39], v4 offset:384
    s_cmp_eq_u32 s15, 63
    s_cbranch_scc1 REC_FINAL
    v_smfmac_f32_16x16x64_bf16 v[48:51], v[20:23], a[112:119], v6
    v_smfmac_f32_16x16x64_bf16 v[52:55], v[20:23], a[120:127], v6
    ds_read_b64_tr_b16 v[40:41], v4 offset:512
    ds_read_b64_tr_b16 v[42:43], v4 offset:640
    ds_read_b64_tr_b16 v[44:45], v4 offset:768
    ds_read_b64_tr_b16 v[46:47], v4 offset:896
    v_smfmac_f32_16x16x64_bf16 v[48:51], v[24:27], a[128:135], v6
    v_smfmac_f32_16x16x64_bf16 v[52:55], v[24:27], a[136:143], v6
    s_waitcnt lgkmcnt(4)
    v_mfma_f32_16x16x32_bf16 v[8:11], v[72:75], v[32:35], 0
    ds_read_b64_tr_b16 v[12:13], v4 offset:2304
    ds_read_b64_tr_b16 v[14:15], v4 offset:2432
    v_mfma_f32_16x16x32_bf16 v[8:11], v[80:83], v[36:39], v[8:11]
    ds_read_b64_tr_b16 v[16:17], v4 offset:2560
    ds_read_b64_tr_b16 v[18:19], v4 offset:2688
    s_waitcnt lgkmcnt(4)
    v_mfma_f32_16x16x32_bf16 v[8:11], v[56:59], v[40:43], v[8:11]
    ds_read_b64_tr_b16 v[56:57], v4 offset:2816
    ds_read_b64_tr_b16 v[58:59], v4 offset:2944
    v_mfma_f32_16x16x32_bf16 v[8:11], v[64:67], v[44:47], v[8:11]
    ds_read_b64_tr_b16 v[64:65], v4 offset:3072
    ds_read_b64_tr_b16 v[66:67], v4 offset:3200
    v_mfma_f32_16x16x32_bf16 v[72:75], v[76:79], v[32:35], 0
    v_mfma_f32_16x16x32_bf16 v[72:75], v[84:87], v[36:39], v[72:75]
    v_mfma_f32_16x16x32_bf16 v[72:75], v[60:63], v[40:43], v[72:75]
    v_mfma_f32_16x16x32_bf16 v[72:75], v[68:71], v[44:47], v[72:75]
    s_waitcnt lgkmcnt(4)
    v_mfma_f32_16x16x32_bf16 v[80:83], v[12:15], v[32:35], 0
    v_mfma_f32_16x16x32_bf16 v[80:83], v[16:19], v[36:39], v[80:83]
    s_waitcnt lgkmcnt(0)
    v_mfma_f32_16x16x32_bf16 v[80:83], v[56:59], v[40:43], v[80:83]
    v_mfma_f32_16x16x32_bf16 v[80:83], v[64:67], v[44:47], v[80:83]
    v_smfmac_f32_16x16x64_bf16 v[48:51], v[28:31], a[144:151], v6
    v_smfmac_f32_16x16x64_bf16 v[52:55], v[28:31], a[152:159], v6
    v_mov_b32 v24, 0x3f803f80
    v_mov_b32 v25, 0x3f803f80
    v_mov_b32 v26, 0x3f803f80
    v_mov_b32 v27, 0x3f803f80
    v_max3_f32 v20, v8, v9, v10
    v_max3_f32 v21, v11, v72, v73
    v_max3_f32 v20, v20, v21, v74
    v_max3_f32 v21, v80, v81, v82
    v_max3_f32 v20, v20, v75, v83
    v_max_f32 v20, v20, v21
    v_mov_b32 v21, v20
    v_cvt_pk_bf16_f32 v48, v48, v49
    v_cvt_pk_bf16_f32 v49, v50, v51
    v_permlane16_swap_b32 v20, v21
    v_max_f32 v20, v20, v21
    v_mov_b32 v21, v20
    v_cvt_pk_bf16_f32 v50, v52, v53
    v_cvt_pk_bf16_f32 v51, v54, v55
    v_permlane32_swap_b32 v20, v21
    v_max_f32 v20, v20, v21
    v_mul_f32 v22, s10, v20
    v_pk_fma_f32 v[8:9], v[8:9], s[10:11], v[22:23] op_sel_hi:[1,1,0] neg_lo:[0,0,1] neg_hi:[0,0,1]
    v_pk_fma_f32 v[10:11], v[10:11], s[10:11], v[22:23] op_sel_hi:[1,1,0] neg_lo:[0,0,1] neg_hi:[0,0,1]
    v_pk_fma_f32 v[72:73], v[72:73], s[10:11], v[22:23] op_sel_hi:[1,1,0] neg_lo:[0,0,1] neg_hi:[0,0,1]
    v_pk_fma_f32 v[74:75], v[74:75], s[10:11], v[22:23] op_sel_hi:[1,1,0] neg_lo:[0,0,1] neg_hi:[0,0,1]
    v_pk_fma_f32 v[80:81], v[80:81], s[10:11], v[22:23] op_sel_hi:[1,1,0] neg_lo:[0,0,1] neg_hi:[0,0,1]
    v_pk_fma_f32 v[82:83], v[82:83], s[10:11], v[22:23] op_sel_hi:[1,1,0] neg_lo:[0,0,1] neg_hi:[0,0,1]
    v_exp_f32 v8, v8
    v_exp_f32 v9, v9
    v_exp_f32 v10, v10
    v_exp_f32 v11, v11
    v_exp_f32 v72, v72
    v_exp_f32 v73, v73
    v_exp_f32 v74, v74
    v_exp_f32 v75, v75
    v_cvt_pk_bf16_f32 v32, v8, v9
    v_cvt_pk_bf16_f32 v33, v10, v11
    v_exp_f32 v80, v80
    v_exp_f32 v81, v81
    v_exp_f32 v82, v82
    v_exp_f32 v83, v83
    v_cvt_pk_bf16_f32 v34, v72, v73
    v_cvt_pk_bf16_f32 v35, v74, v75
    v_cndmask_b32 v12, 0, v24, s[34:35]
    v_cndmask_b32 v13, 0, v24, s[34:35]
    s_waitcnt vmcnt(3)
    v_mfma_f32_16x16x32_bf16 v[8:11], v[24:27], v[32:35], 0
    v_cvt_pk_bf16_f32 v36, v80, v81
    v_mfma_f32_16x16x32_bf16 v[40:43], v[88:91], v[32:35], 0
    v_cvt_pk_bf16_f32 v37, v82, v83
    v_mfma_f32_16x16x32_bf16 v[44:47], v[92:95], v[32:35], 0
    v_mfma_f32_16x16x16_bf16 v[8:11], v[12:13], v[36:37], v[8:11]
    v_mov_b64 v[72:73], 0
    v_mfma_f32_16x16x16_bf16 v[40:43], v[48:49], v[36:37], v[40:43]
    v_mov_b64 v[74:75], 0
    v_mfma_f32_16x16x16_bf16 v[44:47], v[50:51], v[36:37], v[44:47]
    v_mov_b64 v[76:77], 0
    v_mov_b64 v[78:79], 0
    v_mov_b64 v[80:81], 0
    v_mov_b64 v[82:83], 0
    v_rcp_f32 v22, v8
    s_nop 2
    v_cndmask_b32 v40, v44, v40, s[32:33]
    v_cndmask_b32 v41, v45, v41, s[32:33]
    v_cndmask_b32 v42, v46, v42, s[32:33]
    v_cndmask_b32 v43, v47, v43, s[32:33]
    v_pk_mul_f32 v[40:41], v[40:41], v[22:23] op_sel_hi:[1,0]
    v_pk_mul_f32 v[42:43], v[42:43], v[22:23] op_sel_hi:[1,0]
    v_cvt_pk_bf16_f32 v44, v40, v41
    v_cvt_pk_bf16_f32 v45, v42, v43
    ds_write_b64 v5, v[44:45]
    s_mov_b32 m0, s73
    s_add_u32 s28, s28, 0x80000
    buffer_load_dwordx4 v1, s[4:7], s28 offen lds
    buffer_load_dwordx4 v1, s[4:7], s28 offen offset:1024 lds
    v_and_b32 v9, 0x70, v1
    v_bfe_u32 v29, v1, 8, 1
    v_lshl_add_u32 v9, v29, 3, v9
    v_bfe_u32 v29, v1, 9, 1
    v_lshl_add_u32 v9, v29, 2, v9
    v_mov_b32 v29, 0x40000000
    s_waitcnt lgkmcnt(0)
    s_barrier
    ds_read_b128 v[12:15], v0 offset:0
    ds_read_b128 v[16:19], v0 offset:64
    ds_read_b128 v[20:23], v0 offset:128
    ds_read_b128 v[24:27], v0 offset:192
    v_cndmask_b32 v9, v29, v9, s[32:33]
    v_and_b32 v29, 16, v1
    v_lshlrev_b32 v29, v29, s38
    v_cndmask_b32 v88, 0, v29, s[44:45]
    v_cndmask_b32 v89, 0, v29, s[46:47]
    v_cndmask_b32 v90, 0, v29, s[48:49]
    v_cndmask_b32 v91, 0, v29, s[50:51]
    s_waitcnt lgkmcnt(3)
    v_smfmac_f32_16x16x64_bf16 v[72:75], v[12:15], a[160:167], v6
    s_waitcnt lgkmcnt(2)
    v_smfmac_f32_16x16x64_bf16 v[72:75], v[16:19], a[168:175], v6
    s_waitcnt lgkmcnt(1)
    v_smfmac_f32_16x16x64_bf16 v[72:75], v[20:23], a[176:183], v6
    s_waitcnt lgkmcnt(0)
    v_smfmac_f32_16x16x64_bf16 v[72:75], v[24:27], a[184:191], v6
    v_smfmac_f32_16x16x64_bf16 v[76:79], v[12:15], a[192:199], v6
    v_smfmac_f32_16x16x64_bf16 v[76:79], v[16:19], a[200:207], v6
    v_cvt_pk_bf16_f32 v72, v72, v73
    v_smfmac_f32_16x16x64_bf16 v[76:79], v[20:23], a[208:215], v6
    v_cvt_pk_bf16_f32 v73, v74, v75
    v_smfmac_f32_16x16x64_bf16 v[76:79], v[24:27], a[216:223], v6
    v_and_or_b32 v72, v72, -2, s16
    v_mfma_f32_16x16x32_bf16 v[80:83], v[12:15], a[224:227], 0
    buffer_store_dwordx2 v[72:73], v7, s[4:7], s23 offen sc1
    v_mfma_f32_16x16x32_bf16 v[80:83], v[16:19], a[228:231], v[80:83]
    v_mfma_f32_16x16x32_bf16 v[80:83], v[20:23], a[232:235], v[80:83]
    v_cvt_pk_bf16_f32 v76, v76, v77
    v_cvt_pk_bf16_f32 v77, v78, v79
    v_mfma_f32_16x16x32_bf16 v[80:83], v[24:27], a[236:239], v[80:83]
    v_and_or_b32 v76, v76, -2, s16
    buffer_store_dwordx2 v[76:77], v7, s[4:7], s25 offen sc1
    s_add_u32 s17, s17, 0x4000
    s_add_u32 s3, s3, 0x80000
    s_add_u32 s29, s29, 0x80000
    s_add_u32 s18, s18, 0x4000
    s_add_u32 s21, s21, 0x8000
    s_add_u32 s15, s15, 1
    s_nop 0
    v_cvt_pk_bf16_f32 v80, v80, v81
    v_cvt_pk_bf16_f32 v81, v82, v83
    v_and_or_b32 v80, v80, -2, s16
    s_mov_b64 exec, s[34:35]
    buffer_store_dwordx2 v[80:81], v7, s[4:7], s26 offen sc1
    s_mov_b64 exec, -1
    s_cmp_lg_u32 s42, 0
    s_cbranch_scc1 OWN_46
    s_cmp_lt_u32 s14, 2
    s_cbranch_scc1 IDLE_45
    s_branch REC_POLL_S
OWN_46:
    s_nop 15
    s_nop 13
    buffer_load_dwordx4 v[12:15], v1, s[4:7], s24 offen offset:0 sc1
    buffer_load_dwordx4 v[16:19], v1, s[4:7], s24 offen offset:1024 sc1
    buffer_load_dwordx4 v[20:23], v1, s[4:7], s24 offen offset:2048 sc1
    buffer_load_dwordx4 v[24:27], v1, s[4:7], s24 offen offset:3072 sc1
    ds_read_b128 v[56:59], v2 offset:0
    ds_read_b128 v[60:63], v2 offset:1024
    ds_read_b128 v[64:67], v2 offset:2048
    ds_read_b128 v[68:71], v2 offset:3072
    v_mov_b64 v[32:33], 0
    v_mov_b64 v[34:35], 0
    v_mov_b64 v[36:37], 0
    v_mov_b64 v[38:39], 0
    v_mov_b64 v[40:41], 0
    v_mov_b64 v[42:43], 0
    v_mov_b64 v[44:45], 0
    v_mov_b64 v[46:47], 0
    buffer_load_dwordx4 v[72:75], v1, s[4:7], s24 offen offset:0 sc1
    buffer_load_dwordx4 v[76:79], v1, s[4:7], s24 offen offset:1024 sc1
    buffer_load_dwordx4 v[80:83], v1, s[4:7], s24 offen offset:2048 sc1
    buffer_load_dwordx4 v[84:87], v1, s[4:7], s24 offen offset:3072 sc1
    v_mov_b64 v[48:49], 0
    v_mov_b64 v[50:51], 0
    v_mov_b64 v[52:53], 0
    v_mov_b64 v[54:55], 0
OPOLL_48:
    s_waitcnt vmcnt(7)
    v_mfma_f32_16x16x32_bf16 v[92:95], v[12:15], v[88:91], 0
    v_bitop3_b32 v10, v12, v14, s16 bitop3:0x7e
    s_waitcnt vmcnt(6)
    v_mfma_f32_16x16x32_bf16 v[92:95], v[16:19], v[88:91], v[92:95]
    v_bitop3_b32 v11, v16, v18, s16 bitop3:0x7e
    s_waitcnt vmcnt(5)
    v_mfma_f32_16x16x32_bf16 v[92:95], v[20:23], v[88:91], v[92:95]
    v_bitop3_b32 v30, v20, v22, s16 bitop3:0x7e
    s_waitcnt vmcnt(4)
    v_mfma_f32_16x16x32_bf16 v[92:95], v[24:27], v[88:91], v[92:95]
    v_bitop3_b32 v31, v24, v26, s16 bitop3:0x7e
    v_or3_b32 v10, v10, v11, v30
    v_bitop3_b32 v10, v10, v31, 1 bitop3:0xa8
    v_cmp_ne_u32 vcc, 0, v10
    s_nop 3
    s_cbranch_vccz ODONE_47
    s_add_u32 s40, s40, 1
    buffer_load_dwordx4 v[12:15], v1, s[4:7], s24 offen offset:0 sc1
    buffer_load_dwordx4 v[16:19], v1, s[4:7], s24 offen offset:1024 sc1
    buffer_load_dwordx4 v[20:23], v1, s[4:7], s24 offen offset:2048 sc1
    buffer_load_dwordx4 v[24:27], v1, s[4:7], s24 offen offset:3072 sc1
    s_waitcnt vmcnt(7)
    v_mfma_f32_16x16x32_bf16 v[92:95], v[72:75], v[88:91], 0
    v_bitop3_b32 v10, v72, v74, s16 bitop3:0x7e
    s_waitcnt vmcnt(6)
    v_mfma_f32_16x16x32_bf16 v[92:95], v[76:79], v[88:91], v[92:95]
    v_bitop3_b32 v11, v76, v78, s16 bitop3:0x7e
    s_waitcnt vmcnt(5)
    v_mfma_f32_16x16x32_bf16 v[92:95], v[80:83], v[88:91], v[92:95]
    v_bitop3_b32 v30, v80, v82, s16 bitop3:0x7e
    s_waitcnt vmcnt(4)
    v_mfma_f32_16x16x32_bf16 v[92:95], v[84:87], v[88:91], v[92:95]
    v_bitop3_b32 v31, v84, v86, s16 bitop3:0x7e
    v_or3_b32 v10, v10, v11, v30
    v_bitop3_b32 v10, v10, v31, 1 bitop3:0xa8
    v_cmp_ne_u32 vcc, 0, v10
    s_add_u32 s68, s68, 1
    s_cmp_gt_u32 s68, 262144
    s_cbranch_scc1 ODONE_47
    s_nop 0
    s_cbranch_vccz ODONE_47
    s_add_u32 s40, s40, 1
    buffer_load_dwordx4 v[72:75], v1, s[4:7], s24 offen offset:0 sc1
    buffer_load_dwordx4 v[76:79], v1, s[4:7], s24 offen offset:1024 sc1
    buffer_load_dwordx4 v[80:83], v1, s[4:7], s24 offen offset:2048 sc1
    buffer_load_dwordx4 v[84:87], v1, s[4:7], s24 offen offset:3072 sc1
    s_branch OPOLL_48
ODONE_47:
    v_permlane32_swap_b32 v92, v94
    v_permlane32_swap_b32 v93, v95
    v_add_f32 v92, v92, v94
    v_add_f32 v93, v93, v95
    v_cvt_pk_bf16_f32 v8, v92, v93
    buffer_store_dword v8, v9, s[4:7], s18 offen sc1
    s_cmp_eq_u32 s15, 63
    s_cselect_b32 s59, s55, 0
    s_barrier
    s_nop 15
    s_nop 15
    s_nop 12
    buffer_store_dword v8, v9, s[4:7], s21 offen sc1
    s_cmp_lt_u32 s15, 61
    s_cbranch_scc1 EFLG_49
    buffer_store_dword v6, off, s[4:7], s22 sc1
EFLG_49:
    s_xor_b32 s16, s16, 1
    s_waitcnt vmcnt(2) lgkmcnt(0)
    s_branch REC_LOOP_S
IDLE_45:
    s_barrier
    s_cmp_eq_u32 s15, 63
    s_cselect_b32 s59, s55, 0
    v_mov_b64 v[32:33], 0
    v_mov_b64 v[34:35], 0
    v_mov_b64 v[36:37], 0
    v_mov_b64 v[38:39], 0
    v_mov_b64 v[40:41], 0
    v_mov_b64 v[42:43], 0
    v_mov_b64 v[44:45], 0
    v_mov_b64 v[46:47], 0
    v_mov_b64 v[48:49], 0
    v_mov_b64 v[50:51], 0
    v_mov_b64 v[52:53], 0
    v_mov_b64 v[54:55], 0
    ds_read_b128 v[56:59], v2 offset:0
    ds_read_b128 v[60:63], v2 offset:1024
    ds_read_b128 v[64:67], v2 offset:2048
    ds_read_b128 v[68:71], v2 offset:3072
    s_xor_b32 s16, s16, 1
    s_waitcnt vmcnt(0)
    s_branch REC_LOOP_S
REC_TAIL_S:
RETRY_27:
SPIN_50:
    buffer_load_dwordx4 v[20:23], v1, s[4:7], s17 offen offset:2048 sc1
    buffer_load_dwordx4 v[24:27], v1, s[4:7], s17 offen offset:3072 sc1
    buffer_load_dwordx4 v[28:31], v1, s[4:7], s74 offen offset:0 sc1
    s_add_u32 s68, s68, 1
    s_add_u32 s40, s40, 1024
    s_cmp_gt_u32 s68, 262144
    s_waitcnt vmcnt(0)
    s_cbranch_scc1 BACK_28
    v_cmp_eq_u32 vcc, -1, v23
    s_cbranch_vccnz SPIN_50
    s_branch BACK_28
RETRY_29:
SPIN_51:
    buffer_load_dwordx4 v[24:27], v1, s[4:7], s17 offen offset:3072 sc1
    buffer_load_dwordx4 v[28:31], v1, s[4:7], s74 offen offset:0 sc1
    s_add_u32 s68, s68, 1
    s_add_u32 s40, s40, 1024
    s_cmp_gt_u32 s68, 262144
    s_waitcnt vmcnt(0)
    s_cbranch_scc1 BACK_30
    v_cmp_eq_u32 vcc, -1, v27
    s_cbranch_vccnz SPIN_51
    s_branch BACK_30
RETRY_31:
SPIN_52:
    buffer_load_dwordx4 v[28:31], v1, s[4:7], s74 offen offset:0 sc1
    s_add_u32 s68, s68, 1
    s_add_u32 s40, s40, 1024
    s_cmp_gt_u32 s68, 262144
    s_waitcnt vmcnt(0)
    s_cbranch_scc1 BACK_32
    v_cmp_eq_u32 vcc, -1, v31
    s_cbranch_vccnz SPIN_52
    s_branch BACK_32
RETRY_33:
SPIN_53:
    buffer_load_dwordx4 v[12:15], v1, s[4:7], s20 offen offset:0 sc1
    buffer_load_dwordx4 v[16:19], v1, s[4:7], s20 offen offset:1024 sc1
    buffer_load_dwordx4 v[20:23], v1, s[4:7], s20 offen offset:2048 sc1
    buffer_load_dwordx4 v[24:27], v1, s[4:7], s20 offen offset:3072 sc1
    s_add_u32 s68, s68, 1
    s_add_u32 s40, s40, 1048576
    s_cmp_gt_u32 s68, 262144
    s_waitcnt vmcnt(0)
    s_cbranch_scc1 BACK_34
    v_cmp_eq_u32 vcc, -1, v15
    s_cbranch_vccnz SPIN_53
    s_branch BACK_34
RETRY_35:
SPIN_54:
    buffer_load_dwordx4 v[16:19], v1, s[4:7], s20 offen offset:1024 sc1
    buffer_load_dwordx4 v[20:23], v1, s[4:7], s20 offen offset:2048 sc1
    buffer_load_dwordx4 v[24:27], v1, s[4:7], s20 offen offset:3072 sc1
    buffer_load_dwordx4 v[28:31], v1, s[4:7], s75 offen offset:0 sc1
    s_add_u32 s68, s68, 1
    s_add_u32 s40, s40, 1048576
    s_cmp_gt_u32 s68, 262144
    s_waitcnt vmcnt(0)
    s_cbranch_scc1 BACK_36
    v_cmp_eq_u32 vcc, -1, v19
    s_cbranch_vccnz SPIN_54
    s_branch BACK_36
RETRY_37:
SPIN_55:
    buffer_load_dwordx4 v[20:23], v1, s[4:7], s20 offen offset:2048 sc1
    buffer_load_dwordx4 v[24:27], v1, s[4:7], s20 offen offset:3072 sc1
    buffer_load_dwordx4 v[28:31], v1, s[4:7], s75 offen offset:0 sc1
    s_add_u32 s68, s68, 1
    s_add_u32 s40, s40, 1048576
    s_cmp_gt_u32 s68, 262144
    s_waitcnt vmcnt(0)
    s_cbranch_scc1 BACK_38
    v_cmp_eq_u32 vcc, -1, v23
    s_cbranch_vccnz SPIN_55
    s_branch BACK_38
RETRY_39:
SPIN_56:
    buffer_load_dwordx4 v[24:27], v1, s[4:7], s20 offen offset:3072 sc1
    buffer_load_dwordx4 v[28:31], v1, s[4:7], s75 offen offset:0 sc1
    s_add_u32 s68, s68, 1
    s_add_u32 s40, s40, 1048576
    s_cmp_gt_u32 s68, 262144
    s_waitcnt vmcnt(0)
    s_cbranch_scc1 BACK_40
    v_cmp_eq_u32 vcc, -1, v27
    s_cbranch_vccnz SPIN_56
    s_branch BACK_40
RETRY_41:
SPIN_57:
    buffer_load_dwordx4 v[28:31], v1, s[4:7], s75 offen offset:0 sc1
    s_add_u32 s68, s68, 1
    s_add_u32 s40, s40, 1048576
    s_cmp_gt_u32 s68, 262144
    s_waitcnt vmcnt(0)
    s_cbranch_scc1 BACK_42
    v_cmp_eq_u32 vcc, -1, v31
    s_cbranch_vccnz SPIN_57
    s_branch BACK_42
REC_POLL:
    s_cmp_eq_u32 s59, 0
    s_cbranch_scc1 NOFLG_58
    s_waitcnt vmcnt(0)
    v_lshrrev_b32 v29, 2, v1
    ds_read_b32 v12, v29 offset:15104
    s_add_u32 s64, s15, 2
    s_lshr_b32 s65, s64, 1
    s_add_u32 s67, s65, 1
    s_waitcnt lgkmcnt(0)
    v_cmp_ne_u32 vcc, 0, v12
    v_readlane_b32 s65, v12, s65
    v_readlane_b32 s67, v12, s67
    s_cmp_eq_u32 vcc_lo, -1
    s_cselect_b32 s58, 1, 0
    s_and_b32 s65, s65, s67
    s_cbranch_scc1 NOFLG_58
    s_lshl_b32 s64, s64, 7
    s_add_u32 s64, s64, s69
    v_mov_b32 v29, 0
FSPIN_60:
    buffer_load_dwordx2 v[12:13], v29, s[4:7], s64 offen sc1
    s_add_u32 s68, s68, 1
    s_waitcnt vmcnt(0)
    v_and_b32 v12, v12, v13
    v_cmp_eq_u32 vcc, 0, v12
    s_cbranch_vccz FDONE_61
    s_cmp_gt_u32 s68, 262144
    s_cbranch_scc0 FSPIN_60
FDONE_61:
NOFLG_58:
    s_add_u32 s64, s15, 3
    s_and_b32 s64, s64, 0x43
    s_or_b32 s64, s64, s58
    s_cmp_eq_u32 s64, 0
    s_cselect_b32 s59, 1, 0
    s_cmp_eq_u32 s15, 63
    s_cselect_b32 s59, s55, s59
    s_add_u32 s66, s17, s52
    v_add_u32 v10, s52, v1
    s_xor_b32 s16, s16, 1
    v_mov_b64 v[32:33], 0
    v_mov_b64 v[34:35], 0
    v_mov_b64 v[36:37], 0
    v_mov_b64 v[38:39], 0
    v_mov_b64 v[40:41], 0
    v_mov_b64 v[42:43], 0
    v_mov_b64 v[44:45], 0
    v_mov_b64 v[46:47], 0
    v_mov_b64 v[48:49], 0
    v_mov_b64 v[50:51], 0
    v_mov_b64 v[52:53], 0
    v_mov_b64 v[54:55], 0
    ds_read_b128 v[56:59], v2 offset:0
    ds_read_b128 v[60:63], v2 offset:1024
    ds_read_b128 v[64:67], v2 offset:2048
    ds_read_b128 v[68:71], v2 offset:3072
    s_barrier
    s_nop 14
    buffer_load_dwordx4 v[20:23], v1, s[4:7], s66 offen offset:0 sc1
    s_nop 7
    buffer_load_dwordx4 v[24:27], v1, s[4:7], s66 offen offset:0 sc1
    s_nop 7
    buffer_load_dwordx4 v[28:31], v1, s[4:7], s66 offen offset:0 sc1
IPOLL_63:
    s_waitcnt vmcnt(2)
    ds_write_b128 v10, v[20:23] offset:12800
    v_max3_u32 v11, v20, v21, v22
    v_max_u32 v11, v11, v23
    v_cmp_eq_u32 vcc, -1, v11
    s_cbranch_vccz IOK_62
    buffer_load_dwordx4 v[20:23], v1, s[4:7], s66 offen offset:0 sc1
    s_waitcnt vmcnt(2)
    ds_write_b128 v10, v[24:27] offset:12800
    v_max3_u32 v11, v24, v25, v26
    v_max_u32 v11, v11, v27
    v_cmp_eq_u32 vcc, -1, v11
    s_cbranch_vccz IOK_62
    buffer_load_dwordx4 v[24:27], v1, s[4:7], s66 offen offset:0 sc1
    s_waitcnt vmcnt(2)
    ds_write_b128 v10, v[28:31] offset:12800
    v_max3_u32 v11, v28, v29, v30
    v_max_u32 v11, v11, v31
    v_cmp_eq_u32 vcc, -1, v11
    s_add_u32 s68, s68, 1
    s_add_u32 s53, s53, 1
    s_cmp_gt_u32 s68, 262144
    s_cbranch_scc1 IOK_62
    s_cbranch_vccz IOK_62
    buffer_load_dwordx4 v[28:31], v1, s[4:7], s66 offen offset:0 sc1
    s_branch IPOLL_63
IOK_62:
    s_waitcnt lgkmcnt(0)
REC_LOOP:
    s_barrier
    ds_read_b128 v[12:15], v1 offset:12800
    ds_read_b128 v[16:19], v1 offset:13824
    buffer_load_dwordx4 v[20:23], v1, s[4:7], s17 offen offset:2048
    ds_read_b128 v[72:75], v2 offset:4096
    ds_read_b128 v[76:79], v2 offset:5120
    ds_read_b128 v[80:83], v2 offset:6144
    ds_read_b128 v[84:87], v2 offset:7168
    s_add_u32 s74, s17, 0x1000
    s_add_u32 s20, s20, 0x8000
    s_add_u32 s75, s20, 0x1000
    s_mov_b32 m0, 16128
    s_add_u32 s65, s20, s27
    s_waitcnt lgkmcnt(5)
    v_smfmac_f32_16x16x64_bf16 v[32:35], v[12:15], v[96:103], v6
    buffer_load_dwordx4 v[24:27], v1, s[4:7], s17 offen offset:3072
    v_smfmac_f32_16x16x64_bf16 v[36:39], v[12:15], v[104:111], v6
    v_smfmac_f32_16x16x64_bf16 v[40:43], v[12:15], v[56:63], v6
    buffer_load_dwordx4 v[28:31], v1, s[4:7], s74 offen offset:0
    ds_read_b128 v[56:59], v2 offset:8192
    ds_read_b128 v[60:63], v2 offset:9216
    v_smfmac_f32_16x16x64_bf16 v[44:47], v[12:15], v[64:71], v6
    ds_read_b128 v[64:67], v2 offset:10240
    ds_read_b128 v[68:71], v2 offset:11264
    s_waitcnt lgkmcnt(8)
    v_smfmac_f32_16x16x64_bf16 v[48:51], v[12:15], a[0:7], v6
    v_smfmac_f32_16x16x64_bf16 v[52:55], v[12:15], a[8:15], v6
    buffer_load_dwordx4 v[12:15], v1, s[4:7], s20 offen offset:0
    buffer_load_dword off, s[4:7], s65 lds
    v_smfmac_f32_16x16x64_bf16 v[32:35], v[16:19], v[112:119], v6
    v_smfmac_f32_16x16x64_bf16 v[36:39], v[16:19], v[120:127], v6
    s_waitcnt lgkmcnt(4)
    v_smfmac_f32_16x16x64_bf16 v[40:43], v[16:19], v[72:79], v6
    ds_read_b128 v[72:75], v2 offset:12288
    ds_read_b128 v[76:79], v2 offset:13312
    v_smfmac_f32_16x16x64_bf16 v[44:47], v[16:19], v[80:87], v6
    ds_read_b128 v[80:83], v2 offset:14336
    ds_read_b128 v[84:87], v2 offset:15360
    s_waitcnt vmcnt(4)
    v_cmp_eq_u32 vcc, -1, v23
    v_smfmac_f32_16x16x64_bf16 v[48:51], v[16:19], a[16:23], v6
    v_smfmac_f32_16x16x64_bf16 v[52:55], v[16:19], a[24:31], v6
    s_cbranch_vccnz RETRY_64
BACK_65:
    buffer_load_dwordx4 v[16:19], v1, s[4:7], s20 offen offset:1024
    v_smfmac_f32_16x16x64_bf16 v[32:35], v[20:23], v[128:135], v6
    v_smfmac_f32_16x16x64_bf16 v[36:39], v[20:23], v[136:143], v6
    s_waitcnt lgkmcnt(4)
    v_smfmac_f32_16x16x64_bf16 v[40:43], v[20:23], v[56:63], v6
    ds_read_b128 v[56:59], v2 offset:16384
    ds_read_b128 v[60:63], v2 offset:17408
    v_smfmac_f32_16x16x64_bf16 v[44:47], v[20:23], v[64:71], v6
    ds_read_b128 v[64:67], v2 offset:18432
    ds_read_b128 v[68:71], v2 offset:19456
    s_waitcnt vmcnt(4)
    v_cmp_eq_u32 vcc, -1, v27
    v_smfmac_f32_16x16x64_bf16 v[48:51], v[20:23], a[32:39], v6
    v_smfmac_f32_16x16x64_bf16 v[52:55], v[20:23], a[40:47], v6
    s_cbranch_vccnz RETRY_66
BACK_67:
    buffer_load_dwordx4 v[20:23], v1, s[4:7], s20 offen offset:2048
    v_smfmac_f32_16x16x64_bf16 v[32:35], v[24:27], v[144:151], v6
    v_smfmac_f32_16x16x64_bf16 v[36:39], v[24:27], v[152:159], v6
    s_waitcnt lgkmcnt(4)
    v_smfmac_f32_16x16x64_bf16 v[40:43], v[24:27], v[72:79], v6
    ds_read_b128 v[72:75], v2 offset:20480
    ds_read_b128 v[76:79], v2 offset:21504
    v_smfmac_f32_16x16x64_bf16 v[44:47], v[24:27], v[80:87], v6
    ds_read_b128 v[80:83], v2 offset:22528
    ds_read_b128 v[84:87], v2 offset:23552
    s_waitcnt vmcnt(4)
    v_cmp_eq_u32 vcc, -1, v31
    v_smfmac_f32_16x16x64_bf16 v[48:51], v[24:27], a[48:55], v6
    v_smfmac_f32_16x16x64_bf16 v[52:55], v[24:27], a[56:63], v6
    s_cbranch_vccnz RETRY_68
BACK_69:
    buffer_load_dwordx4 v[24:27], v1, s[4:7], s20 offen offset:3072
    v_smfmac_f32_16x16x64_bf16 v[32:35], v[28:31], v[160:167], v6
    v_smfmac_f32_16x16x64_bf16 v[36:39], v[28:31], v[168:175], v6
    s_waitcnt lgkmcnt(4)
    v_smfmac_f32_16x16x64_bf16 v[40:43], v[28:31], v[56:63], v6
    ds_read_b128 v[56:59], v2 offset:24576
    ds_read_b128 v[60:63], v2 offset:25600
    v_smfmac_f32_16x16x64_bf16 v[44:47], v[28:31], v[64:71], v6
    ds_read_b128 v[64:67], v2 offset:26624
    ds_read_b128 v[68:71], v2 offset:27648
    s_waitcnt vmcnt(4)
    v_cmp_eq_u32 vcc, -1, v15
    v_smfmac_f32_16x16x64_bf16 v[48:51], v[28:31], a[64:71], v6
    v_smfmac_f32_16x16x64_bf16 v[52:55], v[28:31], a[72:79], v6
    s_cbranch_vccnz RETRY_70
BACK_71:
    buffer_load_dwordx4 v[28:31], v1, s[4:7], s75 offen offset:0
    v_smfmac_f32_16x16x64_bf16 v[32:35], v[12:15], v[176:183], v6
    s_waitcnt vmcnt(3)
    v_cmp_eq_u32 vcc, -1, v19
    v_smfmac_f32_16x16x64_bf16 v[36:39], v[12:15], v[184:191], v6
    s_waitcnt lgkmcnt(4)
    v_smfmac_f32_16x16x64_bf16 v[40:43], v[12:15], v[72:79], v6
    ds_read_b128 v[72:75], v2 offset:28672
    ds_read_b128 v[76:79], v2 offset:29696
    v_smfmac_f32_16x16x64_bf16 v[44:47], v[12:15], v[80:87], v6
    ds_read_b128 v[80:83], v2 offset:30720
    ds_read_b128 v[84:87], v2 offset:31744
    buffer_load_dwordx4 v[88:91], v1, s[4:7], s29 offen offset:0
    s_cbranch_vccnz RETRY_72
BACK_73:
    v_smfmac_f32_16x16x64_bf16 v[32:35], v[16:19], v[192:199], v6
    s_waitcnt vmcnt(3)
    v_cmp_eq_u32 vcc, -1, v23
    v_smfmac_f32_16x16x64_bf16 v[36:39], v[16:19], v[200:207], v6
    s_waitcnt lgkmcnt(4)
    v_smfmac_f32_16x16x64_bf16 v[40:43], v[16:19], v[56:63], v6
    ds_read_b128 v[56:59], v2 offset:32768
    ds_read_b128 v[60:63], v2 offset:33792
    v_smfmac_f32_16x16x64_bf16 v[44:47], v[16:19], v[64:71], v6
    ds_read_b128 v[64:67], v2 offset:34816
    ds_read_b128 v[68:71], v2 offset:35840
    s_cbranch_vccnz RETRY_74
BACK_75:
    v_smfmac_f32_16x16x64_bf16 v[32:35], v[20:23], v[208:215], v6
    s_waitcnt vmcnt(2)
    v_cmp_eq_u32 vcc, -1, v27
    v_smfmac_f32_16x16x64_bf16 v[36:39], v[20:23], v[216:223], v6
    s_waitcnt lgkmcnt(4)
    v_smfmac_f32_16x16x64_bf16 v[40:43], v[20:23], v[72:79], v6
    ds_read_b128 v[72:75], v1 offset:0
    ds_read_b128 v[76:79], v1 offset:4096
    v_smfmac_f32_16x16x64_bf16 v[44:47], v[20:23], v[80:87], v6
    ds_read_b128 v[80:83], v1 offset:1024
    ds_read_b128 v[84:87], v1 offset:5120
    buffer_load_dwordx4 v[92:95], v1, s[4:7], s29 offen offset:1024
    s_cbranch_vccnz RETRY_76
BACK_77:
    v_smfmac_f32_16x16x64_bf16 v[32:35], v[24:27], v[224:231], v6
    s_waitcnt vmcnt(2)
    v_cmp_eq_u32 vcc, -1, v31
    v_smfmac_f32_16x16x64_bf16 v[36:39], v[24:27], v[232:239], v6
    s_waitcnt lgkmcnt(4)
    v_smfmac_f32_16x16x64_bf16 v[40:43], v[24:27], v[56:63], v6
    ds_read_b128 v[56:59], v1 offset:2048
    ds_read_b128 v[60:63], v1 offset:6144
    v_smfmac_f32_16x16x64_bf16 v[44:47], v[24:27], v[64:71], v6
    ds_read_b128 v[64:67], v1 offset:3072
    ds_read_b128 v[68:71], v1 offset:7168
    s_cbranch_vccnz RETRY_78
BACK_79:
    v_smfmac_f32_16x16x64_bf16 v[32:35], v[28:31], v[240:247], v6
    v_smfmac_f32_16x16x64_bf16 v[36:39], v[28:31], v[248:255], v6
    v_smfmac_f32_16x16x64_bf16 v[40:43], v[28:31], a[240:247], v6
    v_smfmac_f32_16x16x64_bf16 v[44:47], v[28:31], a[248:255], v6
    v_lshlrev_b32 v8, 2, v1
    s_add_u32 s65, s17, s19
    buffer_load_dword v8, s[4:7], s3 offen lds
    buffer_load_dword off, s[4:7], s65 sc1 lds
    buffer_store_dword v6, off, s[4:7], s22 sc1
    s_add_u32 s22, s22, 256
    s_cmp_eq_u32 s59, 0
    s_cbranch_scc1 KVLOOK_80
    s_cmp_eq_u32 s59, 1
    s_cbranch_scc1 KVL1_81
    s_lshl_b32 s64, s13, 13
    s_add_u32 s64, s64, 0x43c0000
    buffer_load_dwordx4 v[96:99], v1, s[4:7], s64 offen offset:0
    buffer_load_dwordx4 v[100:103], v1, s[4:7], s64 offen offset:1024
    buffer_load_dwordx4 v[104:107], v1, s[4:7], s64 offen offset:2048
    buffer_load_dwordx4 v[108:111], v1, s[4:7], s64 offen offset:3072
    s_add_u32 s64, s64, 0x1000
    buffer_load_dwordx4 v[112:115], v1, s[4:7], s64 offen offset:0
    buffer_load_dwordx4 v[116:119], v1, s[4:7], s64 offen offset:1024
    buffer_load_dwordx4 v[120:123], v1, s[4:7], s64 offen offset:2048
    buffer_load_dwordx4 v[124:127], v1, s[4:7], s64 offen offset:3072
    s_branch KVLOOK_80
KVL1_81:
    v_lshrrev_b32 v9, 5, v1
    v_lshlrev_b32 v9, 9, v9
    v_bfe_u32 v10, v1, 4, 1
    v_lshl_add_u32 v9, v10, 2, v9
    s_mov_b32 m0, 15104
    s_mov_b64 exec, s[34:35]
    buffer_load_dword v9, s[4:7], s69 offen sc1 lds
    s_mov_b64 exec, -1
    s_mov_b32 m0, 16128
KVLOOK_80:
    v_permlane32_swap_b32 v32, v36
    v_permlane32_swap_b32 v33, v37
    v_permlane32_swap_b32 v34, v38
    v_permlane32_swap_b32 v35, v39
    v_pk_add_f32 v[32:33], v[32:33], v[36:37]
    v_pk_add_f32 v[34:35], v[34:35], v[38:39]
    v_cvt_pk_bf16_f32 v36, v32, v33
    v_cvt_pk_bf16_f32 v37, v34, v35
    ds_write_b64 v3, v[36:37] offset:0
    v_permlane32_swap_b32 v40, v44
    v_permlane32_swap_b32 v41, v45
    v_permlane32_swap_b32 v42, v46
    v_permlane32_swap_b32 v43, v47
    v_pk_add_f32 v[40:41], v[40:41], v[44:45]
    v_pk_add_f32 v[42:43], v[42:43], v[46:47]
    v_cvt_pk_bf16_f32 v44, v40, v41
    v_cvt_pk_bf16_f32 v45, v42, v43
    ds_write_b64 v3, v[44:45] offset:2304
    v_smfmac_f32_16x16x64_bf16 v[48:51], v[12:15], a[80:87], v6
    v_smfmac_f32_16x16x64_bf16 v[52:55], v[12:15], a[88:95], v6
    v_smfmac_f32_16x16x64_bf16 v[48:51], v[16:19], a[96:103], v6
    v_smfmac_f32_16x16x64_bf16 v[52:55], v[16:19], a[104:111], v6
    s_waitcnt lgkmcnt(0)
    s_barrier
    ds_read_b64_tr_b16 v[32:33], v4 offset:0
    ds_read_b64_tr_b16 v[34:35], v4 offset:128
    ds_read_b64_tr_b16 v[36:37], v4 offset:256
    ds_read_b64_tr_b16 v[38:39], v4 offset:384
    s_cmp_eq_u32 s15, 63
    s_cbranch_scc1 REC_FINAL
    v_smfmac_f32_16x16x64_bf16 v[48:51], v[20:23], a[112:119], v6
    v_smfmac_f32_16x16x64_bf16 v[52:55], v[20:23], a[120:127], v6
    ds_read_b64_tr_b16 v[40:41], v4 offset:512
    ds_read_b64_tr_b16 v[42:43], v4 offset:640
    ds_read_b64_tr_b16 v[44:45], v4 offset:768
    ds_read_b64_tr_b16 v[46:47], v4 offset:896
    v_smfmac_f32_16x16x64_bf16 v[48:51], v[24:27], a[128:135], v6
    v_smfmac_f32_16x16x64_bf16 v[52:55], v[24:27], a[136:143], v6
    s_waitcnt lgkmcnt(4)
    v_mfma_f32_16x16x32_bf16 v[8:11], v[72:75], v[32:35], 0
    ds_read_b64_tr_b16 v[12:13], v4 offset:2304
    ds_read_b64_tr_b16 v[14:15], v4 offset:2432
    v_mfma_f32_16x16x32_bf16 v[8:11], v[80:83], v[36:39], v[8:11]
    ds_read_b64_tr_b16 v[16:17], v4 offset:2560
    ds_read_b64_tr_b16 v[18:19], v4 offset:2688
    s_waitcnt lgkmcnt(4)
    v_mfma_f32_16x16x32_bf16 v[8:11], v[56:59], v[40:43], v[8:11]
    ds_read_b64_tr_b16 v[56:57], v4 offset:2816
    ds_read_b64_tr_b16 v[58:59], v4 offset:2944
    v_mfma_f32_16x16x32_bf16 v[8:11], v[64:67], v[44:47], v[8:11]
    ds_read_b64_tr_b16 v[64:65], v4 offset:3072
    ds_read_b64_tr_b16 v[66:67], v4 offset:3200
    v_mfma_f32_16x16x32_bf16 v[72:75], v[76:79], v[32:35], 0
    v_mfma_f32_16x16x32_bf16 v[72:75], v[84:87], v[36:39], v[72:75]
    v_mfma_f32_16x16x32_bf16 v[72:75], v[60:63], v[40:43], v[72:75]
    v_mfma_f32_16x16x32_bf16 v[72:75], v[68:71], v[44:47], v[72:75]
    s_waitcnt lgkmcnt(4)
    v_mfma_f32_16x16x32_bf16 v[80:83], v[12:15], v[32:35], 0
    v_mfma_f32_16x16x32_bf16 v[80:83], v[16:19], v[36:39], v[80:83]
    s_waitcnt lgkmcnt(0)
    v_mfma_f32_16x16x32_bf16 v[80:83], v[56:59], v[40:43], v[80:83]
    v_mfma_f32_16x16x32_bf16 v[80:83], v[64:67], v[44:47], v[80:83]
    v_smfmac_f32_16x16x64_bf16 v[48:51], v[28:31], a[144:151], v6
    v_smfmac_f32_16x16x64_bf16 v[52:55], v[28:31], a[152:159], v6
    v_mov_b32 v24, 0x3f803f80
    v_mov_b32 v25, 0x3f803f80
    v_mov_b32 v26, 0x3f803f80
    v_mov_b32 v27, 0x3f803f80
    v_max3_f32 v20, v8, v9, v10
    v_max3_f32 v21, v11, v72, v73
    v_max3_f32 v20, v20, v21, v74
    v_max3_f32 v21, v80, v81, v82
    v_max3_f32 v20, v20, v75, v83
    v_max_f32 v20, v20, v21
    v_mov_b32 v21, v20
    v_cvt_pk_bf16_f32 v48, v48, v49
    v_cvt_pk_bf16_f32 v49, v50, v51
    v_permlane16_swap_b32 v20, v21
    v_max_f32 v20, v20, v21
    v_mov_b32 v21, v20
    v_cvt_pk_bf16_f32 v50, v52, v53
    v_cvt_pk_bf16_f32 v51, v54, v55
    v_permlane32_swap_b32 v20, v21
    v_max_f32 v20, v20, v21
    v_mul_f32 v22, s10, v20
    v_pk_fma_f32 v[8:9], v[8:9], s[10:11], v[22:23] op_sel_hi:[1,1,0] neg_lo:[0,0,1] neg_hi:[0,0,1]
    v_pk_fma_f32 v[10:11], v[10:11], s[10:11], v[22:23] op_sel_hi:[1,1,0] neg_lo:[0,0,1] neg_hi:[0,0,1]
    v_pk_fma_f32 v[72:73], v[72:73], s[10:11], v[22:23] op_sel_hi:[1,1,0] neg_lo:[0,0,1] neg_hi:[0,0,1]
    v_pk_fma_f32 v[74:75], v[74:75], s[10:11], v[22:23] op_sel_hi:[1,1,0] neg_lo:[0,0,1] neg_hi:[0,0,1]
    v_pk_fma_f32 v[80:81], v[80:81], s[10:11], v[22:23] op_sel_hi:[1,1,0] neg_lo:[0,0,1] neg_hi:[0,0,1]
    v_pk_fma_f32 v[82:83], v[82:83], s[10:11], v[22:23] op_sel_hi:[1,1,0] neg_lo:[0,0,1] neg_hi:[0,0,1]
    v_exp_f32 v8, v8
    v_exp_f32 v9, v9
    v_exp_f32 v10, v10
    v_exp_f32 v11, v11
    v_exp_f32 v72, v72
    v_exp_f32 v73, v73
    v_exp_f32 v74, v74
    v_exp_f32 v75, v75
    v_cvt_pk_bf16_f32 v32, v8, v9
    v_cvt_pk_bf16_f32 v33, v10, v11
    v_exp_f32 v80, v80
    v_exp_f32 v81, v81
    v_exp_f32 v82, v82
    v_exp_f32 v83, v83
    v_cvt_pk_bf16_f32 v34, v72, v73
    v_cvt_pk_bf16_f32 v35, v74, v75
    v_cndmask_b32 v12, 0, v24, s[34:35]
    v_cndmask_b32 v13, 0, v24, s[34:35]
    s_waitcnt vmcnt(3)
    v_mfma_f32_16x16x32_bf16 v[8:11], v[24:27], v[32:35], 0
    v_cvt_pk_bf16_f32 v36, v80, v81
    v_mfma_f32_16x16x32_bf16 v[40:43], v[88:91], v[32:35], 0
    v_cvt_pk_bf16_f32 v37, v82, v83
    v_mfma_f32_16x16x32_bf16 v[44:47], v[92:95], v[32:35], 0
    v_mfma_f32_16x16x16_bf16 v[8:11], v[12:13], v[36:37], v[8:11]
    v_mov_b64 v[72:73], 0
    v_mfma_f32_16x16x16_bf16 v[40:43], v[48:49], v[36:37], v[40:43]
    v_mov_b64 v[74:75], 0
    v_mfma_f32_16x16x16_bf16 v[44:47], v[50:51], v[36:37], v[44:47]
    v_mov_b64 v[76:77], 0
    v_mov_b64 v[78:79], 0
    v_mov_b64 v[80:81], 0
    v_mov_b64 v[82:83], 0
    v_rcp_f32 v22, v8
    s_nop 2
    v_cndmask_b32 v40, v44, v40, s[32:33]
    v_cndmask_b32 v41, v45, v41, s[32:33]
    v_cndmask_b32 v42, v46, v42, s[32:33]
    v_cndmask_b32 v43, v47, v43, s[32:33]
    v_pk_mul_f32 v[40:41], v[40:41], v[22:23] op_sel_hi:[1,0]
    v_pk_mul_f32 v[42:43], v[42:43], v[22:23] op_sel_hi:[1,0]
    v_cvt_pk_bf16_f32 v44, v40, v41
    v_cvt_pk_bf16_f32 v45, v42, v43
    ds_write_b64 v5, v[44:45]
    s_mov_b32 m0, s73
    s_add_u32 s28, s28, 0x80000
    buffer_load_dwordx4 v1, s[4:7], s28 offen lds
    buffer_load_dwordx4 v1, s[4:7], s28 offen offset:1024 lds
    v_and_b32 v9, 0x70, v1
    v_bfe_u32 v29, v1, 8, 1
    v_lshl_add_u32 v9, v29, 3, v9
    v_bfe_u32 v29, v1, 9, 1
    v_lshl_add_u32 v9, v29, 2, v9
    v_mov_b32 v29, 0x40000000
    s_waitcnt lgkmcnt(0)
    s_barrier
    ds_read_b128 v[12:15], v0 offset:0
    ds_read_b128 v[16:19], v0 offset:64
    ds_read_b128 v[20:23], v0 offset:128
    ds_read_b128 v[24:27], v0 offset:192
    v_cndmask_b32 v9, v29, v9, s[32:33]
    v_and_b32 v29, 16, v1
    v_lshlrev_b32 v29, v29, s38
    v_cndmask_b32 v88, 0, v29, s[44:45]
    v_cndmask_b32 v89, 0, v29, s[46:47]
    v_cndmask_b32 v90, 0, v29, s[48:49]
    v_cndmask_b32 v91, 0, v29, s[50:51]
    s_waitcnt lgkmcnt(3)
    v_smfmac_f32_16x16x64_bf16 v[72:75], v[12:15], a[160:167], v6
    s_waitcnt lgkmcnt(2)
    v_smfmac_f32_16x16x64_bf16 v[72:75], v[16:19], a[168:175], v6
    s_waitcnt lgkmcnt(1)
    v_smfmac_f32_16x16x64_bf16 v[72:75], v[20:23], a[176:183], v6
    s_waitcnt lgkmcnt(0)
    v_smfmac_f32_16x16x64_bf16 v[72:75], v[24:27], a[184:191], v6
    v_smfmac_f32_16x16x64_bf16 v[76:79], v[12:15], a[192:199], v6
    v_smfmac_f32_16x16x64_bf16 v[76:79], v[16:19], a[200:207], v6
    v_cvt_pk_bf16_f32 v72, v72, v73
    v_smfmac_f32_16x16x64_bf16 v[76:79], v[20:23], a[208:215], v6
    v_cvt_pk_bf16_f32 v73, v74, v75
    v_smfmac_f32_16x16x64_bf16 v[76:79], v[24:27], a[216:223], v6
    v_and_or_b32 v72, v72, -2, s16
    v_mfma_f32_16x16x32_bf16 v[80:83], v[12:15], a[224:227], 0
    buffer_store_dwordx2 v[72:73], v7, s[4:7], s23 offen
    v_mfma_f32_16x16x32_bf16 v[80:83], v[16:19], a[228:231], v[80:83]
    v_mfma_f32_16x16x32_bf16 v[80:83], v[20:23], a[232:235], v[80:83]
    v_cvt_pk_bf16_f32 v76, v76, v77
    v_cvt_pk_bf16_f32 v77, v78, v79
    v_mfma_f32_16x16x32_bf16 v[80:83], v[24:27], a[236:239], v[80:83]
    v_and_or_b32 v76, v76, -2, s16
    buffer_store_dwordx2 v[76:77], v7, s[4:7], s25 offen
    s_add_u32 s17, s17, 0x4000
    s_add_u32 s3, s3, 0x80000
    s_add_u32 s29, s29, 0x80000
    s_add_u32 s18, s18, 0x4000
    s_add_u32 s21, s21, 0x8000
    s_add_u32 s15, s15, 1
    s_nop 0
    v_cvt_pk_bf16_f32 v80, v80, v81
    v_cvt_pk_bf16_f32 v81, v82, v83
    v_and_or_b32 v80, v80, -2, s16
    s_mov_b64 exec, s[34:35]
    buffer_store_dwordx2 v[80:81], v7, s[4:7], s26 offen
    s_mov_b64 exec, -1
    s_cmp_lg_u32 s42, 0
    s_cbranch_scc1 OWN_83
    s_cmp_lt_u32 s14, 2
    s_cbranch_scc1 IDLE_82
    s_branch REC_POLL
OWN_83:
    s_nop 15
    s_nop 13
    buffer_load_dwordx4 v[12:15], v1, s[4:7], s24 offen offset:0 sc1
    buffer_load_dwordx4 v[16:19], v1, s[4:7], s24 offen offset:1024 sc1
    buffer_load_dwordx4 v[20:23], v1, s[4:7], s24 offen offset:2048 sc1
    buffer_load_dwordx4 v[24:27], v1, s[4:7], s24 offen offset:3072 sc1
    ds_read_b128 v[56:59], v2 offset:0
    ds_read_b128 v[60:63], v2 offset:1024
    ds_read_b128 v[64:67], v2 offset:2048
    ds_read_b128 v[68:71], v2 offset:3072
    v_mov_b64 v[32:33], 0
    v_mov_b64 v[34:35], 0
    v_mov_b64 v[36:37], 0
    v_mov_b64 v[38:39], 0
    v_mov_b64 v[40:41], 0
    v_mov_b64 v[42:43], 0
    v_mov_b64 v[44:45], 0
    v_mov_b64 v[46:47], 0
    buffer_load_dwordx4 v[72:75], v1, s[4:7], s24 offen offset:0 sc1
    buffer_load_dwordx4 v[76:79], v1, s[4:7], s24 offen offset:1024 sc1
    buffer_load_dwordx4 v[80:83], v1, s[4:7], s24 offen offset:2048 sc1
    buffer_load_dwordx4 v[84:87], v1, s[4:7], s24 offen offset:3072 sc1
    v_mov_b64 v[48:49], 0
    v_mov_b64 v[50:51], 0
    v_mov_b64 v[52:53], 0
    v_mov_b64 v[54:55], 0
OPOLL_85:
    s_waitcnt vmcnt(7)
    v_mfma_f32_16x16x32_bf16 v[92:95], v[12:15], v[88:91], 0
    v_bitop3_b32 v10, v12, v14, s16 bitop3:0x7e
    s_waitcnt vmcnt(6)
    v_mfma_f32_16x16x32_bf16 v[92:95], v[16:19], v[88:91], v[92:95]
    v_bitop3_b32 v11, v16, v18, s16 bitop3:0x7e
    s_waitcnt vmcnt(5)
    v_mfma_f32_16x16x32_bf16 v[92:95], v[20:23], v[88:91], v[92:95]
    v_bitop3_b32 v30, v20, v22, s16 bitop3:0x7e
    s_waitcnt vmcnt(4)
    v_mfma_f32_16x16x32_bf16 v[92:95], v[24:27], v[88:91], v[92:95]
    v_bitop3_b32 v31, v24, v26, s16 bitop3:0x7e
    v_or3_b32 v10, v10, v11, v30
    v_bitop3_b32 v10, v10, v31, 1 bitop3:0xa8
    v_cmp_ne_u32 vcc, 0, v10
    s_nop 3
    s_cbranch_vccz ODONE_84
    s_add_u32 s40, s40, 1
    buffer_load_dwordx4 v[12:15], v1, s[4:7], s24 offen offset:0 sc1
    buffer_load_dwordx4 v[16:19], v1, s[4:7], s24 offen offset:1024 sc1
    buffer_load_dwordx4 v[20:23], v1, s[4:7], s24 offen offset:2048 sc1
    buffer_load_dwordx4 v[24:27], v1, s[4:7], s24 offen offset:3072 sc1
    s_waitcnt vmcnt(7)
    v_mfma_f32_16x16x32_bf16 v[92:95], v[72:75], v[88:91], 0
    v_bitop3_b32 v10, v72, v74, s16 bitop3:0x7e
    s_waitcnt vmcnt(6)
    v_mfma_f32_16x16x32_bf16 v[92:95], v[76:79], v[88:91], v[92:95]
    v_bitop3_b32 v11, v76, v78, s16 bitop3:0x7e
    s_waitcnt vmcnt(5)
    v_mfma_f32_16x16x32_bf16 v[92:95], v[80:83], v[88:91], v[92:95]
    v_bitop3_b32 v30, v80, v82, s16 bitop3:0x7e
    s_waitcnt vmcnt(4)
    v_mfma_f32_16x16x32_bf16 v[92:95], v[84:87], v[88:91], v[92:95]
    v_bitop3_b32 v31, v84, v86, s16 bitop3:0x7e
    v_or3_b32 v10, v10, v11, v30
    v_bitop3_b32 v10, v10, v31, 1 bitop3:0xa8
    v_cmp_ne_u32 vcc, 0, v10
    s_add_u32 s68, s68, 1
    s_cmp_gt_u32 s68, 262144
    s_cbranch_scc1 ODONE_84
    s_nop 0
    s_cbranch_vccz ODONE_84
    s_add_u32 s40, s40, 1
    buffer_load_dwordx4 v[72:75], v1, s[4:7], s24 offen offset:0 sc1
    buffer_load_dwordx4 v[76:79], v1, s[4:7], s24 offen offset:1024 sc1
    buffer_load_dwordx4 v[80:83], v1, s[4:7], s24 offen offset:2048 sc1
    buffer_load_dwordx4 v[84:87], v1, s[4:7], s24 offen offset:3072 sc1
    s_branch OPOLL_85
ODONE_84:
    v_permlane32_swap_b32 v92, v94
    v_permlane32_swap_b32 v93, v95
    v_add_f32 v92, v92, v94
    v_add_f32 v93, v93, v95
    v_cvt_pk_bf16_f32 v8, v92, v93
    buffer_store_dword v8, v9, s[4:7], s18 offen
    s_cmp_eq_u32 s15, 63
    s_cselect_b32 s59, s55, 0
    s_barrier
    s_nop 15
    s_nop 15
    s_nop 12
    buffer_store_dword v8, v9, s[4:7], s21 offen sc1
    s_cmp_lt_u32 s15, 61
    s_cbranch_scc1 EFLG_86
    buffer_store_dword v6, off, s[4:7], s22 sc1
EFLG_86:
    s_xor_b32 s16, s16, 1
    s_waitcnt vmcnt(2) lgkmcnt(0)
    s_branch REC_LOOP
IDLE_82:
    s_barrier
    s_cmp_eq_u32 s15, 63
    s_cselect_b32 s59, s55, 0
    v_mov_b64 v[32:33], 0
    v_mov_b64 v[34:35], 0
    v_mov_b64 v[36:37], 0
    v_mov_b64 v[38:39], 0
    v_mov_b64 v[40:41], 0
    v_mov_b64 v[42:43], 0
    v_mov_b64 v[44:45], 0
    v_mov_b64 v[46:47], 0
    v_mov_b64 v[48:49], 0
    v_mov_b64 v[50:51], 0
    v_mov_b64 v[52:53], 0
    v_mov_b64 v[54:55], 0
    ds_read_b128 v[56:59], v2 offset:0
    ds_read_b128 v[60:63], v2 offset:1024
    ds_read_b128 v[64:67], v2 offset:2048
    ds_read_b128 v[68:71], v2 offset:3072
    s_xor_b32 s16, s16, 1
    s_waitcnt vmcnt(0)
    s_branch REC_LOOP
REC_TAIL:
RETRY_64:
SPIN_87:
    buffer_load_dwordx4 v[20:23], v1, s[4:7], s17 offen offset:2048 sc1
    buffer_load_dwordx4 v[24:27], v1, s[4:7], s17 offen offset:3072 sc1
    buffer_load_dwordx4 v[28:31], v1, s[4:7], s74 offen offset:0 sc1
    s_add_u32 s68, s68, 1
    s_add_u32 s40, s40, 1024
    s_cmp_gt_u32 s68, 262144
    s_waitcnt vmcnt(0)
    s_cbranch_scc1 BACK_65
    v_cmp_eq_u32 vcc, -1, v23
    s_cbranch_vccnz SPIN_87
    s_branch BACK_65
RETRY_66:
SPIN_88:
    buffer_load_dwordx4 v[24:27], v1, s[4:7], s17 offen offset:3072 sc1
    buffer_load_dwordx4 v[28:31], v1, s[4:7], s74 offen offset:0 sc1
    s_add_u32 s68, s68, 1
    s_add_u32 s40, s40, 1024
    s_cmp_gt_u32 s68, 262144
    s_waitcnt vmcnt(0)
    s_cbranch_scc1 BACK_67
    v_cmp_eq_u32 vcc, -1, v27
    s_cbranch_vccnz SPIN_88
    s_branch BACK_67
RETRY_68:
SPIN_89:
    buffer_load_dwordx4 v[28:31], v1, s[4:7], s74 offen offset:0 sc1
    s_add_u32 s68, s68, 1
    s_add_u32 s40, s40, 1024
    s_cmp_gt_u32 s68, 262144
    s_waitcnt vmcnt(0)
    s_cbranch_scc1 BACK_69
    v_cmp_eq_u32 vcc, -1, v31
    s_cbranch_vccnz SPIN_89
    s_branch BACK_69
RETRY_70:
SPIN_90:
    buffer_load_dwordx4 v[12:15], v1, s[4:7], s20 offen offset:0 sc1
    buffer_load_dwordx4 v[16:19], v1, s[4:7], s20 offen offset:1024 sc1
    buffer_load_dwordx4 v[20:23], v1, s[4:7], s20 offen offset:2048 sc1
    buffer_load_dwordx4 v[24:27], v1, s[4:7], s20 offen offset:3072 sc1
    s_add_u32 s68, s68, 1
    s_add_u32 s40, s40, 1048576
    s_cmp_gt_u32 s68, 262144
    s_waitcnt vmcnt(0)
    s_cbranch_scc1 BACK_71
    v_cmp_eq_u32 vcc, -1, v15
    s_cbranch_vccnz SPIN_90
    s_branch BACK_71
RETRY_72:
SPIN_91:
    buffer_load_dwordx4 v[16:19], v1, s[4:7], s20 offen offset:1024 sc1
    buffer_load_dwordx4 v[20:23], v1, s[4:7], s20 offen offset:2048 sc1
    buffer_load_dwordx4 v[24:27], v1, s[4:7], s20 offen offset:3072 sc1
    buffer_load_dwordx4 v[28:31], v1, s[4:7], s75 offen offset:0 sc1
    s_add_u32 s68, s68, 1
    s_add_u32 s40, s40, 1048576
    s_cmp_gt_u32 s68, 262144
    s_waitcnt vmcnt(0)
    s_cbranch_scc1 BACK_73
    v_cmp_eq_u32 vcc, -1, v19
    s_cbranch_vccnz SPIN_91
    s_branch BACK_73
RETRY_74:
SPIN_92:
    buffer_load_dwordx4 v[20:23], v1, s[4:7], s20 offen offset:2048 sc1
    buffer_load_dwordx4 v[24:27], v1, s[4:7], s20 offen offset:3072 sc1
    buffer_load_dwordx4 v[28:31], v1, s[4:7], s75 offen offset:0 sc1
    s_add_u32 s68, s68, 1
    s_add_u32 s40, s40, 1048576
    s_cmp_gt_u32 s68, 262144
    s_waitcnt vmcnt(0)
    s_cbranch_scc1 BACK_75
    v_cmp_eq_u32 vcc, -1, v23
    s_cbranch_vccnz SPIN_92
    s_branch BACK_75
RETRY_76:
SPIN_93:
    buffer_load_dwordx4 v[24:27], v1, s[4:7], s20 offen offset:3072 sc1
    buffer_load_dwordx4 v[28:31], v1, s[4:7], s75 offen offset:0 sc1
    s_add_u32 s68, s68, 1
    s_add_u32 s40, s40, 1048576
    s_cmp_gt_u32 s68, 262144
    s_waitcnt vmcnt(0)
    s_cbranch_scc1 BACK_77
    v_cmp_eq_u32 vcc, -1, v27
    s_cbranch_vccnz SPIN_93
    s_branch BACK_77
RETRY_78:
SPIN_94:
    buffer_load_dwordx4 v[28:31], v1, s[4:7], s75 offen offset:0 sc1
    s_add_u32 s68, s68, 1
    s_add_u32 s40, s40, 1048576
    s_cmp_gt_u32 s68, 262144
    s_waitcnt vmcnt(0)
    s_cbranch_scc1 BACK_79
    v_cmp_eq_u32 vcc, -1, v31
    s_cbranch_vccnz SPIN_94
    s_branch BACK_79
REC_FINAL:
    s_cmp_lg_u32 s12, 0
    s_cbranch_scc1 REC_END
    s_waitcnt lgkmcnt(0)
    v_smfmac_f32_16x16x64_bf16 v[48:51], v[20:23], a[112:119], v6
    v_smfmac_f32_16x16x64_bf16 v[52:55], v[20:23], a[120:127], v6
    v_smfmac_f32_16x16x64_bf16 v[48:51], v[24:27], a[128:135], v6
    v_smfmac_f32_16x16x64_bf16 v[52:55], v[24:27], a[136:143], v6
    v_smfmac_f32_16x16x64_bf16 v[48:51], v[28:31], a[144:151], v6
    v_smfmac_f32_16x16x64_bf16 v[52:55], v[28:31], a[152:159], v6
    ds_read_b64_tr_b16 v[192:193], v4 offset:2304
    ds_read_b64_tr_b16 v[194:195], v4 offset:2432
    ds_read_b64_tr_b16 v[196:197], v4 offset:2560
    ds_read_b64_tr_b16 v[198:199], v4 offset:2688
    ds_read_b64_tr_b16 v[200:201], v4 offset:2816
    ds_read_b64_tr_b16 v[202:203], v4 offset:2944
    ds_read_b64_tr_b16 v[204:205], v4 offset:3072
    ds_read_b64_tr_b16 v[206:207], v4 offset:3200
    ds_read_b128 v[160:163], v1 offset:0
    ds_read_b128 v[164:167], v1 offset:1024
    ds_read_b128 v[168:171], v1 offset:2048
    ds_read_b128 v[172:175], v1 offset:3072
    ds_read_b128 v[176:179], v1 offset:4096
    ds_read_b128 v[180:183], v1 offset:5120
    ds_read_b128 v[184:187], v1 offset:6144
    ds_read_b128 v[188:191], v1 offset:7168
    v_mbcnt_lo_u32_b32 v0, -1, 0
    v_mbcnt_hi_u32_b32 v0, -1, v0
    s_mov_b32 s34, 0x3e0293ee
    s_mov_b32 s35, 0x3e0293ee
    s_mov_b32 s36, -1
    s_mov_b32 s37, 0
    v_lshrrev_b32 v5, 4, v0
    v_lshlrev_b32 v5, 2, v5
    v_and_b32 v6, 15, v0
    v_add_u32 v7, 0, v5
    v_cmp_le_u32 s[38:39], v7, v6
    v_add_u32 v7, 1, v5
    v_cmp_le_u32 s[40:41], v7, v6
    v_add_u32 v7, 2, v5
    v_cmp_le_u32 s[42:43], v7, v6
    v_add_u32 v7, 3, v5
    v_cmp_le_u32 s[44:45], v7, v6
    v_mov_b32 v252, 0x3f803f80
    v_mov_b32 v253, 0x3f803f80
    v_mov_b32 v254, 0x3f803f80
    v_mov_b32 v255, 0x3f803f80
    v_permlane32_swap_b32 v48, v52
    v_permlane32_swap_b32 v49, v53
    v_permlane32_swap_b32 v50, v54
    v_permlane32_swap_b32 v51, v55
    v_pk_add_f32 v[48:49], v[48:49], v[52:53]
    v_pk_add_f32 v[50:51], v[50:51], v[54:55]
    v_cvt_pk_bf16_f32 v208, v48, v49
    v_cvt_pk_bf16_f32 v209, v50, v51
    v_mov_b32 v210, v208
    v_mov_b32 v211, v209
    s_nop 1
    v_permlane32_swap_b32 v208, v210
    v_permlane32_swap_b32 v209, v211
    s_mov_b32 s24, 63
    s_lshl_b32 s64, s24, 5
    s_add_u32 s64, s64, s13
    s_lshl_b32 s33, s64, 2
    s_add_u32 s33, s33, 0x296000
    s_lshl_b32 s32, s24, 18
    s_lshl_b32 s65, s13, 12
    s_add_u32 s32, s32, s65
    s_add_u32 s32, s32, 0x4400000
    s_lshl_b32 s64, s14, 10
    s_add_u32 s32, s32, s64
    s_waitcnt vmcnt(0) lgkmcnt(0)
    v_mfma_f32_16x16x32_bf16 v[228:231], v[160:163], v[96:99], 0
    v_mfma_f32_16x16x32_bf16 v[236:239], v[160:163], v[112:115], 0
    v_mfma_f32_16x16x32_bf16 v[240:243], v[176:179], v[112:115], 0
    v_mfma_f32_16x16x32_bf16 v[228:231], v[164:167], v[100:103], v[228:231]
    v_mfma_f32_16x16x32_bf16 v[236:239], v[164:167], v[116:119], v[236:239]
    v_mfma_f32_16x16x32_bf16 v[240:243], v[180:183], v[116:119], v[240:243]
    v_mfma_f32_16x16x32_bf16 v[228:231], v[168:171], v[104:107], v[228:231]
    v_mfma_f32_16x16x32_bf16 v[236:239], v[168:171], v[120:123], v[236:239]
    v_mfma_f32_16x16x32_bf16 v[240:243], v[184:187], v[120:123], v[240:243]
    v_mfma_f32_16x16x32_bf16 v[228:231], v[172:175], v[108:111], v[228:231]
    v_mfma_f32_16x16x32_bf16 v[236:239], v[172:175], v[124:127], v[236:239]
    v_mfma_f32_16x16x32_bf16 v[240:243], v[188:191], v[124:127], v[240:243]
    v_mfma_f32_16x16x32_bf16 v[224:227], v[192:195], v[96:99], 0
    v_mfma_f32_16x16x32_bf16 v[232:235], v[192:195], v[112:115], 0
    v_mfma_f32_16x16x32_bf16 v[224:227], v[196:199], v[100:103], v[224:227]
    v_mfma_f32_16x16x32_bf16 v[232:235], v[196:199], v[116:119], v[232:235]
    v_mfma_f32_16x16x32_bf16 v[224:227], v[200:203], v[104:107], v[224:227]
    v_mfma_f32_16x16x32_bf16 v[232:235], v[200:203], v[120:123], v[232:235]
    v_mfma_f32_16x16x32_bf16 v[224:227], v[204:207], v[108:111], v[224:227]
    v_mfma_f32_16x16x32_bf16 v[232:235], v[204:207], v[124:127], v[232:235]
    v_mov_b32 v11, 0xff800000
    s_nop 7
    v_cndmask_b32 v228, v11, v228, s[38:39]
    v_cndmask_b32 v240, v11, v240, s[38:39]
    v_cndmask_b32 v224, v11, v224, s[36:37]
    v_cndmask_b32 v232, v11, v232, s[36:37]
    v_cndmask_b32 v229, v11, v229, s[40:41]
    v_cndmask_b32 v241, v11, v241, s[40:41]
    v_cndmask_b32 v225, v11, v225, s[36:37]
    v_cndmask_b32 v233, v11, v233, s[36:37]
    v_cndmask_b32 v230, v11, v230, s[42:43]
    v_cndmask_b32 v242, v11, v242, s[42:43]
    v_cndmask_b32 v226, v11, v226, s[36:37]
    v_cndmask_b32 v234, v11, v234, s[36:37]
    v_cndmask_b32 v231, v11, v231, s[44:45]
    v_cndmask_b32 v243, v11, v243, s[44:45]
    v_cndmask_b32 v227, v11, v227, s[36:37]
    v_cndmask_b32 v235, v11, v235, s[36:37]
    v_max3_f32 v8, v224, v225, v226
    v_max3_f32 v8, v8, v227, v228
    v_max3_f32 v8, v8, v229, v230
    v_max_f32 v8, v8, v231
    v_mov_b32 v9, v8
    s_nop 1
    v_permlane16_swap_b32 v8, v9
    v_max_f32 v8, v8, v9
    v_mov_b32 v9, v8
    s_nop 1
    v_permlane32_swap_b32 v8, v9
    v_max_f32 v8, v8, v9
    v_mul_f32 v8, s34, v8
    v_fma_f32 v224, v224, s34, -v8
    v_fma_f32 v225, v225, s34, -v8
    v_fma_f32 v226, v226, s34, -v8
    v_fma_f32 v227, v227, s34, -v8
    v_fma_f32 v228, v228, s34, -v8
    v_fma_f32 v229, v229, s34, -v8
    v_fma_f32 v230, v230, s34, -v8
    v_fma_f32 v231, v231, s34, -v8
    v_exp_f32 v224, v224
    v_exp_f32 v225, v225
    v_exp_f32 v226, v226
    v_exp_f32 v227, v227
    v_exp_f32 v228, v228
    v_exp_f32 v229, v229
    v_exp_f32 v230, v230
    v_exp_f32 v231, v231
    s_nop 0
    v_cvt_pk_bf16_f32 v16, v228, v229
    v_cvt_pk_bf16_f32 v17, v230, v231
    v_mov_b32 v18, 0
    v_mov_b32 v19, 0
    v_cvt_pk_bf16_f32 v20, v224, v225
    v_cvt_pk_bf16_f32 v21, v226, v227
    v_max3_f32 v8, v232, v233, v234
    v_max3_f32 v8, v8, v235, v236
    v_max3_f32 v8, v8, v237, v238
    v_max3_f32 v8, v8, v239, v240
    v_max3_f32 v8, v8, v241, v242
    v_max_f32 v8, v8, v243
    v_mov_b32 v9, v8
    s_nop 1
    v_permlane16_swap_b32 v8, v9
    v_max_f32 v8, v8, v9
    v_mov_b32 v9, v8
    s_nop 1
    v_permlane32_swap_b32 v8, v9
    v_max_f32 v8, v8, v9
    v_mul_f32 v8, s34, v8
    v_fma_f32 v232, v232, s34, -v8
    v_fma_f32 v233, v233, s34, -v8
    v_fma_f32 v234, v234, s34, -v8
    v_fma_f32 v235, v235, s34, -v8
    v_fma_f32 v236, v236, s34, -v8
    v_fma_f32 v237, v237, s34, -v8
    v_fma_f32 v238, v238, s34, -v8
    v_fma_f32 v239, v239, s34, -v8
    v_fma_f32 v240, v240, s34, -v8
    v_fma_f32 v241, v241, s34, -v8
    v_fma_f32 v242, v242, s34, -v8
    v_fma_f32 v243, v243, s34, -v8
    v_exp_f32 v232, v232
    v_exp_f32 v233, v233
    v_exp_f32 v234, v234
    v_exp_f32 v235, v235
    v_exp_f32 v236, v236
    v_exp_f32 v237, v237
    v_exp_f32 v238, v238
    v_exp_f32 v239, v239
    v_exp_f32 v240, v240
    v_exp_f32 v241, v241
    v_exp_f32 v242, v242
    v_exp_f32 v243, v243
    s_nop 0
    v_cvt_pk_bf16_f32 v22, v236, v237
    v_cvt_pk_bf16_f32 v23, v238, v239
    v_cvt_pk_bf16_f32 v24, v240, v241
    v_cvt_pk_bf16_f32 v25, v242, v243
    v_cvt_pk_bf16_f32 v26, v232, v233
    v_cvt_pk_bf16_f32 v27, v234, v235
    v_mfma_f32_16x16x32_bf16 v[244:247], v[252:255], v[16:19], 0
    v_mfma_f32_16x16x32_bf16 v[248:251], v[252:255], v[22:25], 0
    v_mfma_f32_16x16x32_bf16 v[32:35], v[88:91], v[16:19], 0
    v_mfma_f32_16x16x32_bf16 v[36:39], v[88:91], v[22:25], 0
    v_mfma_f32_16x16x32_bf16 v[40:43], v[92:95], v[16:19], 0
    v_mfma_f32_16x16x32_bf16 v[44:47], v[92:95], v[22:25], 0
    v_mfma_f32_16x16x16_bf16 v[244:247], v[252:253], v[20:21], v[244:247]
    v_mfma_f32_16x16x16_bf16 v[248:251], v[252:253], v[26:27], v[248:251]
    v_mfma_f32_16x16x16_bf16 v[32:35], v[208:209], v[20:21], v[32:35]
    v_mfma_f32_16x16x16_bf16 v[36:39], v[208:209], v[26:27], v[36:39]
    v_mfma_f32_16x16x16_bf16 v[40:43], v[210:211], v[20:21], v[40:43]
    v_mfma_f32_16x16x16_bf16 v[44:47], v[210:211], v[26:27], v[44:47]
    v_rcp_f32 v8, v244
    v_rcp_f32 v9, v248
    s_nop 7
    v_mul_f32 v32, v32, v8
    v_mul_f32 v33, v33, v8
    v_mul_f32 v34, v34, v8
    v_mul_f32 v35, v35, v8
    v_cvt_pk_bf16_f32 v96, v32, v33
    v_cvt_pk_bf16_f32 v97, v34, v35
    v_mul_f32 v40, v40, v8
    v_mul_f32 v41, v41, v8
    v_mul_f32 v42, v42, v8
    v_mul_f32 v43, v43, v8
    v_cvt_pk_bf16_f32 v98, v40, v41
    v_cvt_pk_bf16_f32 v99, v42, v43
    s_add_u32 s64, s32, 0x0
    buffer_store_dwordx4 v[96:99], v1, s[4:7], s64 offen offset:0 sc1
    v_mul_f32 v36, v36, v9
    v_mul_f32 v37, v37, v9
    v_mul_f32 v38, v38, v9
    v_mul_f32 v39, v39, v9
    v_cvt_pk_bf16_f32 v100, v36, v37
    v_cvt_pk_bf16_f32 v101, v38, v39
    v_mul_f32 v44, v44, v9
    v_mul_f32 v45, v45, v9
    v_mul_f32 v46, v46, v9
    v_mul_f32 v47, v47, v9
    v_cvt_pk_bf16_f32 v102, v44, v45
    v_cvt_pk_bf16_f32 v103, v46, v47
    s_add_u32 s64, s32, 0x20000
    buffer_store_dwordx4 v[100:103], v1, s[4:7], s64 offen offset:0 sc1
    s_waitcnt vmcnt(0)
    s_barrier
    s_cmp_lg_u32 s14, 0
    s_cbranch_scc1 REC_END
    v_mov_b32 v7, 1
    v_mov_b32 v8, 0
    s_mov_b64 exec, 1
    buffer_store_dword v7, v8, s[4:7], s33 offen sc1
    s_mov_b64 exec, -1
    s_branch REC_END
REC_END:
    s_branch M_EXIT
M_HELP:
    v_mbcnt_lo_u32_b32 v0, -1, 0
    v_mbcnt_hi_u32_b32 v0, -1, v0
    s_and_b32 s12, s96, 1
    s_lshr_b32 s3, s96, 1
    s_and_b32 s13, s3, 31
    s_lshr_b32 s3, s3, 5
    s_load_dwordx4 s[48:51], s[0:1], 16
    s_load_dwordx2 s[52:53], s[0:1], 32
    s_waitcnt lgkmcnt(0)
    s_mov_b32 s46, 5242880
    s_mov_b32 s47, 0x00020000
    s_cmp_eq_u32 s3, 1
    s_cselect_b32 s44, s52, s50
    s_cselect_b32 s45, s53, s51
    s_cmp_eq_u32 s3, 2
    s_cselect_b32 s44, s48, s44
    s_cselect_b32 s45, s49, s45
    s_load_dwordx2 s[16:17], s[0:1], 0
    s_mov_b32 s18, 2621440
    s_mov_b32 s19, 0x00020000
    s_load_dwordx2 s[20:21], s[0:1], 64
    s_mov_b32 s22, 1280
    s_mov_b32 s23, 0x00020000
    s_load_dwordx2 s[24:25], s[0:1], 8
    s_mov_b32 s26, 10240
    s_mov_b32 s27, 0x00020000
    s_lshl_b32 s28, s96, 2
    s_add_u32 s28, s28, s14
    s_mul_i32 s28, s28, 3
    v_lshlrev_b32 v3, 4, v0
    v_lshlrev_b32 v4, 2, v0
    s_waitcnt lgkmcnt(0)
    s_add_u32 s29, s28, 0
    s_mul_i32 s33, s29, 1280
    buffer_load_dwordx4 v[10:13], v3, s[16:19], s33 offen
    buffer_load_dword v14, v4, s[16:19], s33 offen offset:1024
    s_add_u32 s29, s28, 1
    s_mul_i32 s34, s29, 1280
    buffer_load_dwordx4 v[16:19], v3, s[16:19], s34 offen
    buffer_load_dword v20, v4, s[16:19], s34 offen offset:1024
    s_add_u32 s29, s28, 2
    s_mul_i32 s35, s29, 1280
    buffer_load_dwordx4 v[22:25], v3, s[16:19], s35 offen
    buffer_load_dword v26, v4, s[16:19], s35 offen offset:1024
    buffer_load_dwordx4 v[28:31], v3, s[20:23], 0 offen
    buffer_load_dword v32, v4, s[20:23], 0 offen offset:1024
    s_cmp_ge_u32 s96, 10
    s_cbranch_scc1 INM0_95
    v_and_b32 v5, 7, v0
    v_mul_u32_u24 v5, 1280, v5
    v_lshrrev_b32 v6, 4, v0
    v_lshl_add_u32 v5, v6, 5, v5
    v_bfe_u32 v6, v0, 3, 1
    v_lshl_add_u32 v5, v6, 4, v5
    s_lshl_b32 s29, s96, 7
    buffer_load_dwordx4 v[34:37], v5, s[24:27], s29 offen
INM0_95:
    s_waitcnt vmcnt(0)
    s_add_u32 s29, s28, 0
    s_cmp_ge_u32 s29, 2048
    s_cbranch_scc1 INR_96
    v_lshlrev_b32 v50, 16, v10
    v_and_b32 v60, 0xffff0000, v10
    v_lshlrev_b32 v51, 16, v11
    v_and_b32 v61, 0xffff0000, v11
    v_lshlrev_b32 v52, 16, v12
    v_and_b32 v62, 0xffff0000, v12
    v_lshlrev_b32 v53, 16, v13
    v_and_b32 v63, 0xffff0000, v13
    v_lshlrev_b32 v54, 16, v14
    v_and_b32 v64, 0xffff0000, v14
    v_add_f32 v70, v50, v60
    v_add_f32 v70, v70, v51
    v_add_f32 v70, v70, v61
    v_add_f32 v70, v70, v52
    v_add_f32 v70, v70, v62
    v_add_f32 v70, v70, v53
    v_add_f32 v70, v70, v63
    v_add_f32 v70, v70, v54
    v_add_f32 v70, v70, v64
    s_nop 1
    v_add_f32_dpp v70, v70, v70 quad_perm:[1,0,3,2] row_mask:0xf bank_mask:0xf
    s_nop 1
    v_add_f32_dpp v70, v70, v70 quad_perm:[2,3,0,1] row_mask:0xf bank_mask:0xf
    s_nop 1
    v_add_f32_dpp v70, v70, v70 row_half_mirror row_mask:0xf bank_mask:0xf
    s_nop 1
    v_add_f32_dpp v70, v70, v70 row_mirror row_mask:0xf bank_mask:0xf
    v_mov_b32 v71, v70
    s_nop 1
    v_permlane16_swap_b32 v70, v71
    v_add_f32 v70, v70, v71
    v_mov_b32 v71, v70
    s_nop 1
    v_permlane32_swap_b32 v70, v71
    v_add_f32 v70, v70, v71
    v_mul_f32 v72, 0x3acccccd, v70
    v_mov_b32 v73, 0
    v_sub_f32 v74, v50, v72
    v_fmac_f32 v73, v74, v74
    v_sub_f32 v74, v60, v72
    v_fmac_f32 v73, v74, v74
    v_sub_f32 v74, v51, v72
    v_fmac_f32 v73, v74, v74
    v_sub_f32 v74, v61, v72
    v_fmac_f32 v73, v74, v74
    v_sub_f32 v74, v52, v72
    v_fmac_f32 v73, v74, v74
    v_sub_f32 v74, v62, v72
    v_fmac_f32 v73, v74, v74
    v_sub_f32 v74, v53, v72
    v_fmac_f32 v73, v74, v74
    v_sub_f32 v74, v63, v72
    v_fmac_f32 v73, v74, v74
    v_sub_f32 v74, v54, v72
    v_fmac_f32 v73, v74, v74
    v_sub_f32 v74, v64, v72
    v_fmac_f32 v73, v74, v74
    s_nop 1
    v_add_f32_dpp v73, v73, v73 quad_perm:[1,0,3,2] row_mask:0xf bank_mask:0xf
    s_nop 1
    v_add_f32_dpp v73, v73, v73 quad_perm:[2,3,0,1] row_mask:0xf bank_mask:0xf
    s_nop 1
    v_add_f32_dpp v73, v73, v73 row_half_mirror row_mask:0xf bank_mask:0xf
    s_nop 1
    v_add_f32_dpp v73, v73, v73 row_mirror row_mask:0xf bank_mask:0xf
    v_mov_b32 v71, v73
    s_nop 1
    v_permlane16_swap_b32 v73, v71
    v_add_f32 v73, v73, v71
    v_mov_b32 v71, v73
    s_nop 1
    v_permlane32_swap_b32 v73, v71
    v_add_f32 v73, v73, v71
    v_mul_f32 v73, 0x3acccccd, v73
    v_cvt_pk_bf16_f32 v72, v72, v72
    v_lshlrev_b32 v72, 16, v72
    v_cvt_pk_bf16_f32 v73, v73, v73
    v_lshlrev_b32 v73, 16, v73
    v_add_f32 v73, 0x3727c5ac, v73
    v_cvt_pk_bf16_f32 v73, v73, v73
    v_lshlrev_b32 v73, 16, v73
    v_sqrt_f32 v73, v73
    s_nop 0
    v_cvt_pk_bf16_f32 v73, v73, v73
    v_lshlrev_b32 v73, 16, v73
    v_rcp_f32 v75, v73
    s_nop 0
    v_mov_b32 v76, 0
    v_sub_f32 v50, v50, v72
    v_cvt_pk_bf16_f32 v50, v50, v50
    v_lshlrev_b32 v50, 16, v50
    v_mul_f32 v74, v50, v75
    v_fma_f32 v77, -v74, v73, v50
    v_fma_f32 v50, v77, v75, v74
    v_sub_f32 v60, v60, v72
    v_cvt_pk_bf16_f32 v60, v60, v60
    v_lshlrev_b32 v60, 16, v60
    v_mul_f32 v74, v60, v75
    v_fma_f32 v77, -v74, v73, v60
    v_fma_f32 v60, v77, v75, v74
    v_cvt_pk_bf16_f32 v10, v50, v60
    v_lshlrev_b32 v74, 16, v10
    v_lshlrev_b32 v77, 16, v28
    v_fmac_f32 v76, v74, v77
    v_and_b32 v74, 0xffff0000, v10
    v_and_b32 v77, 0xffff0000, v28
    v_fmac_f32 v76, v74, v77
    v_sub_f32 v51, v51, v72
    v_cvt_pk_bf16_f32 v51, v51, v51
    v_lshlrev_b32 v51, 16, v51
    v_mul_f32 v74, v51, v75
    v_fma_f32 v77, -v74, v73, v51
    v_fma_f32 v51, v77, v75, v74
    v_sub_f32 v61, v61, v72
    v_cvt_pk_bf16_f32 v61, v61, v61
    v_lshlrev_b32 v61, 16, v61
    v_mul_f32 v74, v61, v75
    v_fma_f32 v77, -v74, v73, v61
    v_fma_f32 v61, v77, v75, v74
    v_cvt_pk_bf16_f32 v11, v51, v61
    v_lshlrev_b32 v74, 16, v11
    v_lshlrev_b32 v77, 16, v29
    v_fmac_f32 v76, v74, v77
    v_and_b32 v74, 0xffff0000, v11
    v_and_b32 v77, 0xffff0000, v29
    v_fmac_f32 v76, v74, v77
    v_sub_f32 v52, v52, v72
    v_cvt_pk_bf16_f32 v52, v52, v52
    v_lshlrev_b32 v52, 16, v52
    v_mul_f32 v74, v52, v75
    v_fma_f32 v77, -v74, v73, v52
    v_fma_f32 v52, v77, v75, v74
    v_sub_f32 v62, v62, v72
    v_cvt_pk_bf16_f32 v62, v62, v62
    v_lshlrev_b32 v62, 16, v62
    v_mul_f32 v74, v62, v75
    v_fma_f32 v77, -v74, v73, v62
    v_fma_f32 v62, v77, v75, v74
    v_cvt_pk_bf16_f32 v12, v52, v62
    v_lshlrev_b32 v74, 16, v12
    v_lshlrev_b32 v77, 16, v30
    v_fmac_f32 v76, v74, v77
    v_and_b32 v74, 0xffff0000, v12
    v_and_b32 v77, 0xffff0000, v30
    v_fmac_f32 v76, v74, v77
    v_sub_f32 v53, v53, v72
    v_cvt_pk_bf16_f32 v53, v53, v53
    v_lshlrev_b32 v53, 16, v53
    v_mul_f32 v74, v53, v75
    v_fma_f32 v77, -v74, v73, v53
    v_fma_f32 v53, v77, v75, v74
    v_sub_f32 v63, v63, v72
    v_cvt_pk_bf16_f32 v63, v63, v63
    v_lshlrev_b32 v63, 16, v63
    v_mul_f32 v74, v63, v75
    v_fma_f32 v77, -v74, v73, v63
    v_fma_f32 v63, v77, v75, v74
    v_cvt_pk_bf16_f32 v13, v53, v63
    v_lshlrev_b32 v74, 16, v13
    v_lshlrev_b32 v77, 16, v31
    v_fmac_f32 v76, v74, v77
    v_and_b32 v74, 0xffff0000, v13
    v_and_b32 v77, 0xffff0000, v31
    v_fmac_f32 v76, v74, v77
    v_sub_f32 v54, v54, v72
    v_cvt_pk_bf16_f32 v54, v54, v54
    v_lshlrev_b32 v54, 16, v54
    v_mul_f32 v74, v54, v75
    v_fma_f32 v77, -v74, v73, v54
    v_fma_f32 v54, v77, v75, v74
    v_sub_f32 v64, v64, v72
    v_cvt_pk_bf16_f32 v64, v64, v64
    v_lshlrev_b32 v64, 16, v64
    v_mul_f32 v74, v64, v75
    v_fma_f32 v77, -v74, v73, v64
    v_fma_f32 v64, v77, v75, v74
    v_cvt_pk_bf16_f32 v14, v54, v64
    v_lshlrev_b32 v74, 16, v14
    v_lshlrev_b32 v77, 16, v32
    v_fmac_f32 v76, v74, v77
    v_and_b32 v74, 0xffff0000, v14
    v_and_b32 v77, 0xffff0000, v32
    v_fmac_f32 v76, v74, v77
    s_add_u32 s30, s33, 0x0
    buffer_store_dwordx4 v[10:13], v3, s[4:7], s30 offen sc1
    buffer_store_dword v14, v4, s[4:7], s30 offen offset:1024 sc1
    s_nop 1
    v_add_f32_dpp v76, v76, v76 quad_perm:[1,0,3,2] row_mask:0xf bank_mask:0xf
    s_nop 1
    v_add_f32_dpp v76, v76, v76 quad_perm:[2,3,0,1] row_mask:0xf bank_mask:0xf
    s_nop 1
    v_add_f32_dpp v76, v76, v76 row_half_mirror row_mask:0xf bank_mask:0xf
    s_nop 1
    v_add_f32_dpp v76, v76, v76 row_mirror row_mask:0xf bank_mask:0xf
    v_mov_b32 v71, v76
    s_nop 1
    v_permlane16_swap_b32 v76, v71
    v_add_f32 v76, v76, v71
    v_mov_b32 v71, v76
    s_nop 1
    v_permlane32_swap_b32 v76, v71
    v_add_f32 v76, v76, v71
    v_cvt_pk_bf16_f32 v76, v76, v76
    v_lshlrev_b32 v76, 16, v76
    s_lshl_b32 s30, s29, 2
    s_add_u32 s30, s30, 0x280000
    s_mov_b64 exec, 1
    buffer_store_dword v76, off, s[4:7], s30 sc1
    s_mov_b64 exec, -1
INR_96:
    s_add_u32 s29, s28, 1
    s_cmp_ge_u32 s29, 2048
    s_cbranch_scc1 INR_97
    v_lshlrev_b32 v50, 16, v16
    v_and_b32 v60, 0xffff0000, v16
    v_lshlrev_b32 v51, 16, v17
    v_and_b32 v61, 0xffff0000, v17
    v_lshlrev_b32 v52, 16, v18
    v_and_b32 v62, 0xffff0000, v18
    v_lshlrev_b32 v53, 16, v19
    v_and_b32 v63, 0xffff0000, v19
    v_lshlrev_b32 v54, 16, v20
    v_and_b32 v64, 0xffff0000, v20
    v_add_f32 v70, v50, v60
    v_add_f32 v70, v70, v51
    v_add_f32 v70, v70, v61
    v_add_f32 v70, v70, v52
    v_add_f32 v70, v70, v62
    v_add_f32 v70, v70, v53
    v_add_f32 v70, v70, v63
    v_add_f32 v70, v70, v54
    v_add_f32 v70, v70, v64
    s_nop 1
    v_add_f32_dpp v70, v70, v70 quad_perm:[1,0,3,2] row_mask:0xf bank_mask:0xf
    s_nop 1
    v_add_f32_dpp v70, v70, v70 quad_perm:[2,3,0,1] row_mask:0xf bank_mask:0xf
    s_nop 1
    v_add_f32_dpp v70, v70, v70 row_half_mirror row_mask:0xf bank_mask:0xf
    s_nop 1
    v_add_f32_dpp v70, v70, v70 row_mirror row_mask:0xf bank_mask:0xf
    v_mov_b32 v71, v70
    s_nop 1
    v_permlane16_swap_b32 v70, v71
    v_add_f32 v70, v70, v71
    v_mov_b32 v71, v70
    s_nop 1
    v_permlane32_swap_b32 v70, v71
    v_add_f32 v70, v70, v71
    v_mul_f32 v72, 0x3acccccd, v70
    v_mov_b32 v73, 0
    v_sub_f32 v74, v50, v72
    v_fmac_f32 v73, v74, v74
    v_sub_f32 v74, v60, v72
    v_fmac_f32 v73, v74, v74
    v_sub_f32 v74, v51, v72
    v_fmac_f32 v73, v74, v74
    v_sub_f32 v74, v61, v72
    v_fmac_f32 v73, v74, v74
    v_sub_f32 v74, v52, v72
    v_fmac_f32 v73, v74, v74
    v_sub_f32 v74, v62, v72
    v_fmac_f32 v73, v74, v74
    v_sub_f32 v74, v53, v72
    v_fmac_f32 v73, v74, v74
    v_sub_f32 v74, v63, v72
    v_fmac_f32 v73, v74, v74
    v_sub_f32 v74, v54, v72
    v_fmac_f32 v73, v74, v74
    v_sub_f32 v74, v64, v72
    v_fmac_f32 v73, v74, v74
    s_nop 1
    v_add_f32_dpp v73, v73, v73 quad_perm:[1,0,3,2] row_mask:0xf bank_mask:0xf
    s_nop 1
    v_add_f32_dpp v73, v73, v73 quad_perm:[2,3,0,1] row_mask:0xf bank_mask:0xf
    s_nop 1
    v_add_f32_dpp v73, v73, v73 row_half_mirror row_mask:0xf bank_mask:0xf
    s_nop 1
    v_add_f32_dpp v73, v73, v73 row_mirror row_mask:0xf bank_mask:0xf
    v_mov_b32 v71, v73
    s_nop 1
    v_permlane16_swap_b32 v73, v71
    v_add_f32 v73, v73, v71
    v_mov_b32 v71, v73
    s_nop 1
    v_permlane32_swap_b32 v73, v71
    v_add_f32 v73, v73, v71
    v_mul_f32 v73, 0x3acccccd, v73
    v_cvt_pk_bf16_f32 v72, v72, v72
    v_lshlrev_b32 v72, 16, v72
    v_cvt_pk_bf16_f32 v73, v73, v73
    v_lshlrev_b32 v73, 16, v73
    v_add_f32 v73, 0x3727c5ac, v73
    v_cvt_pk_bf16_f32 v73, v73, v73
    v_lshlrev_b32 v73, 16, v73
    v_sqrt_f32 v73, v73
    s_nop 0
    v_cvt_pk_bf16_f32 v73, v73, v73
    v_lshlrev_b32 v73, 16, v73
    v_rcp_f32 v75, v73
    s_nop 0
    v_mov_b32 v76, 0
    v_sub_f32 v50, v50, v72
    v_cvt_pk_bf16_f32 v50, v50, v50
    v_lshlrev_b32 v50, 16, v50
    v_mul_f32 v74, v50, v75
    v_fma_f32 v77, -v74, v73, v50
    v_fma_f32 v50, v77, v75, v74
    v_sub_f32 v60, v60, v72
    v_cvt_pk_bf16_f32 v60, v60, v60
    v_lshlrev_b32 v60, 16, v60
    v_mul_f32 v74, v60, v75
    v_fma_f32 v77, -v74, v73, v60
    v_fma_f32 v60, v77, v75, v74
    v_cvt_pk_bf16_f32 v16, v50, v60
    v_lshlrev_b32 v74, 16, v16
    v_lshlrev_b32 v77, 16, v28
    v_fmac_f32 v76, v74, v77
    v_and_b32 v74, 0xffff0000, v16
    v_and_b32 v77, 0xffff0000, v28
    v_fmac_f32 v76, v74, v77
    v_sub_f32 v51, v51, v72
    v_cvt_pk_bf16_f32 v51, v51, v51
    v_lshlrev_b32 v51, 16, v51
    v_mul_f32 v74, v51, v75
    v_fma_f32 v77, -v74, v73, v51
    v_fma_f32 v51, v77, v75, v74
    v_sub_f32 v61, v61, v72
    v_cvt_pk_bf16_f32 v61, v61, v61
    v_lshlrev_b32 v61, 16, v61
    v_mul_f32 v74, v61, v75
    v_fma_f32 v77, -v74, v73, v61
    v_fma_f32 v61, v77, v75, v74
    v_cvt_pk_bf16_f32 v17, v51, v61
    v_lshlrev_b32 v74, 16, v17
    v_lshlrev_b32 v77, 16, v29
    v_fmac_f32 v76, v74, v77
    v_and_b32 v74, 0xffff0000, v17
    v_and_b32 v77, 0xffff0000, v29
    v_fmac_f32 v76, v74, v77
    v_sub_f32 v52, v52, v72
    v_cvt_pk_bf16_f32 v52, v52, v52
    v_lshlrev_b32 v52, 16, v52
    v_mul_f32 v74, v52, v75
    v_fma_f32 v77, -v74, v73, v52
    v_fma_f32 v52, v77, v75, v74
    v_sub_f32 v62, v62, v72
    v_cvt_pk_bf16_f32 v62, v62, v62
    v_lshlrev_b32 v62, 16, v62
    v_mul_f32 v74, v62, v75
    v_fma_f32 v77, -v74, v73, v62
    v_fma_f32 v62, v77, v75, v74
    v_cvt_pk_bf16_f32 v18, v52, v62
    v_lshlrev_b32 v74, 16, v18
    v_lshlrev_b32 v77, 16, v30
    v_fmac_f32 v76, v74, v77
    v_and_b32 v74, 0xffff0000, v18
    v_and_b32 v77, 0xffff0000, v30
    v_fmac_f32 v76, v74, v77
    v_sub_f32 v53, v53, v72
    v_cvt_pk_bf16_f32 v53, v53, v53
    v_lshlrev_b32 v53, 16, v53
    v_mul_f32 v74, v53, v75
    v_fma_f32 v77, -v74, v73, v53
    v_fma_f32 v53, v77, v75, v74
    v_sub_f32 v63, v63, v72
    v_cvt_pk_bf16_f32 v63, v63, v63
    v_lshlrev_b32 v63, 16, v63
    v_mul_f32 v74, v63, v75
    v_fma_f32 v77, -v74, v73, v63
    v_fma_f32 v63, v77, v75, v74
    v_cvt_pk_bf16_f32 v19, v53, v63
    v_lshlrev_b32 v74, 16, v19
    v_lshlrev_b32 v77, 16, v31
    v_fmac_f32 v76, v74, v77
    v_and_b32 v74, 0xffff0000, v19
    v_and_b32 v77, 0xffff0000, v31
    v_fmac_f32 v76, v74, v77
    v_sub_f32 v54, v54, v72
    v_cvt_pk_bf16_f32 v54, v54, v54
    v_lshlrev_b32 v54, 16, v54
    v_mul_f32 v74, v54, v75
    v_fma_f32 v77, -v74, v73, v54
    v_fma_f32 v54, v77, v75, v74
    v_sub_f32 v64, v64, v72
    v_cvt_pk_bf16_f32 v64, v64, v64
    v_lshlrev_b32 v64, 16, v64
    v_mul_f32 v74, v64, v75
    v_fma_f32 v77, -v74, v73, v64
    v_fma_f32 v64, v77, v75, v74
    v_cvt_pk_bf16_f32 v20, v54, v64
    v_lshlrev_b32 v74, 16, v20
    v_lshlrev_b32 v77, 16, v32
    v_fmac_f32 v76, v74, v77
    v_and_b32 v74, 0xffff0000, v20
    v_and_b32 v77, 0xffff0000, v32
    v_fmac_f32 v76, v74, v77
    s_add_u32 s30, s34, 0x0
    buffer_store_dwordx4 v[16:19], v3, s[4:7], s30 offen sc1
    buffer_store_dword v20, v4, s[4:7], s30 offen offset:1024 sc1
    s_nop 1
    v_add_f32_dpp v76, v76, v76 quad_perm:[1,0,3,2] row_mask:0xf bank_mask:0xf
    s_nop 1
    v_add_f32_dpp v76, v76, v76 quad_perm:[2,3,0,1] row_mask:0xf bank_mask:0xf
    s_nop 1
    v_add_f32_dpp v76, v76, v76 row_half_mirror row_mask:0xf bank_mask:0xf
    s_nop 1
    v_add_f32_dpp v76, v76, v76 row_mirror row_mask:0xf bank_mask:0xf
    v_mov_b32 v71, v76
    s_nop 1
    v_permlane16_swap_b32 v76, v71
    v_add_f32 v76, v76, v71
    v_mov_b32 v71, v76
    s_nop 1
    v_permlane32_swap_b32 v76, v71
    v_add_f32 v76, v76, v71
    v_cvt_pk_bf16_f32 v76, v76, v76
    v_lshlrev_b32 v76, 16, v76
    s_lshl_b32 s30, s29, 2
    s_add_u32 s30, s30, 0x280000
    s_mov_b64 exec, 1
    buffer_store_dword v76, off, s[4:7], s30 sc1
    s_mov_b64 exec, -1
INR_97:
    s_add_u32 s29, s28, 2
    s_cmp_ge_u32 s29, 2048
    s_cbranch_scc1 INR_98
    v_lshlrev_b32 v50, 16, v22
    v_and_b32 v60, 0xffff0000, v22
    v_lshlrev_b32 v51, 16, v23
    v_and_b32 v61, 0xffff0000, v23
    v_lshlrev_b32 v52, 16, v24
    v_and_b32 v62, 0xffff0000, v24
    v_lshlrev_b32 v53, 16, v25
    v_and_b32 v63, 0xffff0000, v25
    v_lshlrev_b32 v54, 16, v26
    v_and_b32 v64, 0xffff0000, v26
    v_add_f32 v70, v50, v60
    v_add_f32 v70, v70, v51
    v_add_f32 v70, v70, v61
    v_add_f32 v70, v70, v52
    v_add_f32 v70, v70, v62
    v_add_f32 v70, v70, v53
    v_add_f32 v70, v70, v63
    v_add_f32 v70, v70, v54
    v_add_f32 v70, v70, v64
    s_nop 1
    v_add_f32_dpp v70, v70, v70 quad_perm:[1,0,3,2] row_mask:0xf bank_mask:0xf
    s_nop 1
    v_add_f32_dpp v70, v70, v70 quad_perm:[2,3,0,1] row_mask:0xf bank_mask:0xf
    s_nop 1
    v_add_f32_dpp v70, v70, v70 row_half_mirror row_mask:0xf bank_mask:0xf
    s_nop 1
    v_add_f32_dpp v70, v70, v70 row_mirror row_mask:0xf bank_mask:0xf
    v_mov_b32 v71, v70
    s_nop 1
    v_permlane16_swap_b32 v70, v71
    v_add_f32 v70, v70, v71
    v_mov_b32 v71, v70
    s_nop 1
    v_permlane32_swap_b32 v70, v71
    v_add_f32 v70, v70, v71
    v_mul_f32 v72, 0x3acccccd, v70
    v_mov_b32 v73, 0
    v_sub_f32 v74, v50, v72
    v_fmac_f32 v73, v74, v74
    v_sub_f32 v74, v60, v72
    v_fmac_f32 v73, v74, v74
    v_sub_f32 v74, v51, v72
    v_fmac_f32 v73, v74, v74
    v_sub_f32 v74, v61, v72
    v_fmac_f32 v73, v74, v74
    v_sub_f32 v74, v52, v72
    v_fmac_f32 v73, v74, v74
    v_sub_f32 v74, v62, v72
    v_fmac_f32 v73, v74, v74
    v_sub_f32 v74, v53, v72
    v_fmac_f32 v73, v74, v74
    v_sub_f32 v74, v63, v72
    v_fmac_f32 v73, v74, v74
    v_sub_f32 v74, v54, v72
    v_fmac_f32 v73, v74, v74
    v_sub_f32 v74, v64, v72
    v_fmac_f32 v73, v74, v74
    s_nop 1
    v_add_f32_dpp v73, v73, v73 quad_perm:[1,0,3,2] row_mask:0xf bank_mask:0xf
    s_nop 1
    v_add_f32_dpp v73, v73, v73 quad_perm:[2,3,0,1] row_mask:0xf bank_mask:0xf
    s_nop 1
    v_add_f32_dpp v73, v73, v73 row_half_mirror row_mask:0xf bank_mask:0xf
    s_nop 1
    v_add_f32_dpp v73, v73, v73 row_mirror row_mask:0xf bank_mask:0xf
    v_mov_b32 v71, v73
    s_nop 1
    v_permlane16_swap_b32 v73, v71
    v_add_f32 v73, v73, v71
    v_mov_b32 v71, v73
    s_nop 1
    v_permlane32_swap_b32 v73, v71
    v_add_f32 v73, v73, v71
    v_mul_f32 v73, 0x3acccccd, v73
    v_cvt_pk_bf16_f32 v72, v72, v72
    v_lshlrev_b32 v72, 16, v72
    v_cvt_pk_bf16_f32 v73, v73, v73
    v_lshlrev_b32 v73, 16, v73
    v_add_f32 v73, 0x3727c5ac, v73
    v_cvt_pk_bf16_f32 v73, v73, v73
    v_lshlrev_b32 v73, 16, v73
    v_sqrt_f32 v73, v73
    s_nop 0
    v_cvt_pk_bf16_f32 v73, v73, v73
    v_lshlrev_b32 v73, 16, v73
    v_rcp_f32 v75, v73
    s_nop 0
    v_mov_b32 v76, 0
    v_sub_f32 v50, v50, v72
    v_cvt_pk_bf16_f32 v50, v50, v50
    v_lshlrev_b32 v50, 16, v50
    v_mul_f32 v74, v50, v75
    v_fma_f32 v77, -v74, v73, v50
    v_fma_f32 v50, v77, v75, v74
    v_sub_f32 v60, v60, v72
    v_cvt_pk_bf16_f32 v60, v60, v60
    v_lshlrev_b32 v60, 16, v60
    v_mul_f32 v74, v60, v75
    v_fma_f32 v77, -v74, v73, v60
    v_fma_f32 v60, v77, v75, v74
    v_cvt_pk_bf16_f32 v22, v50, v60
    v_lshlrev_b32 v74, 16, v22
    v_lshlrev_b32 v77, 16, v28
    v_fmac_f32 v76, v74, v77
    v_and_b32 v74, 0xffff0000, v22
    v_and_b32 v77, 0xffff0000, v28
    v_fmac_f32 v76, v74, v77
    v_sub_f32 v51, v51, v72
    v_cvt_pk_bf16_f32 v51, v51, v51
    v_lshlrev_b32 v51, 16, v51
    v_mul_f32 v74, v51, v75
    v_fma_f32 v77, -v74, v73, v51
    v_fma_f32 v51, v77, v75, v74
    v_sub_f32 v61, v61, v72
    v_cvt_pk_bf16_f32 v61, v61, v61
    v_lshlrev_b32 v61, 16, v61
    v_mul_f32 v74, v61, v75
    v_fma_f32 v77, -v74, v73, v61
    v_fma_f32 v61, v77, v75, v74
    v_cvt_pk_bf16_f32 v23, v51, v61
    v_lshlrev_b32 v74, 16, v23
    v_lshlrev_b32 v77, 16, v29
    v_fmac_f32 v76, v74, v77
    v_and_b32 v74, 0xffff0000, v23
    v_and_b32 v77, 0xffff0000, v29
    v_fmac_f32 v76, v74, v77
    v_sub_f32 v52, v52, v72
    v_cvt_pk_bf16_f32 v52, v52, v52
    v_lshlrev_b32 v52, 16, v52
    v_mul_f32 v74, v52, v75
    v_fma_f32 v77, -v74, v73, v52
    v_fma_f32 v52, v77, v75, v74
    v_sub_f32 v62, v62, v72
    v_cvt_pk_bf16_f32 v62, v62, v62
    v_lshlrev_b32 v62, 16, v62
    v_mul_f32 v74, v62, v75
    v_fma_f32 v77, -v74, v73, v62
    v_fma_f32 v62, v77, v75, v74
    v_cvt_pk_bf16_f32 v24, v52, v62
    v_lshlrev_b32 v74, 16, v24
    v_lshlrev_b32 v77, 16, v30
    v_fmac_f32 v76, v74, v77
    v_and_b32 v74, 0xffff0000, v24
    v_and_b32 v77, 0xffff0000, v30
    v_fmac_f32 v76, v74, v77
    v_sub_f32 v53, v53, v72
    v_cvt_pk_bf16_f32 v53, v53, v53
    v_lshlrev_b32 v53, 16, v53
    v_mul_f32 v74, v53, v75
    v_fma_f32 v77, -v74, v73, v53
    v_fma_f32 v53, v77, v75, v74
    v_sub_f32 v63, v63, v72
    v_cvt_pk_bf16_f32 v63, v63, v63
    v_lshlrev_b32 v63, 16, v63
    v_mul_f32 v74, v63, v75
    v_fma_f32 v77, -v74, v73, v63
    v_fma_f32 v63, v77, v75, v74
    v_cvt_pk_bf16_f32 v25, v53, v63
    v_lshlrev_b32 v74, 16, v25
    v_lshlrev_b32 v77, 16, v31
    v_fmac_f32 v76, v74, v77
    v_and_b32 v74, 0xffff0000, v25
    v_and_b32 v77, 0xffff0000, v31
    v_fmac_f32 v76, v74, v77
    v_sub_f32 v54, v54, v72
    v_cvt_pk_bf16_f32 v54, v54, v54
    v_lshlrev_b32 v54, 16, v54
    v_mul_f32 v74, v54, v75
    v_fma_f32 v77, -v74, v73, v54
    v_fma_f32 v54, v77, v75, v74
    v_sub_f32 v64, v64, v72
    v_cvt_pk_bf16_f32 v64, v64, v64
    v_lshlrev_b32 v64, 16, v64
    v_mul_f32 v74, v64, v75
    v_fma_f32 v77, -v74, v73, v64
    v_fma_f32 v64, v77, v75, v74
    v_cvt_pk_bf16_f32 v26, v54, v64
    v_lshlrev_b32 v74, 16, v26
    v_lshlrev_b32 v77, 16, v32
    v_fmac_f32 v76, v74, v77
    v_and_b32 v74, 0xffff0000, v26
    v_and_b32 v77, 0xffff0000, v32
    v_fmac_f32 v76, v74, v77
    s_add_u32 s30, s35, 0x0
    buffer_store_dwordx4 v[22:25], v3, s[4:7], s30 offen sc1
    buffer_store_dword v26, v4, s[4:7], s30 offen offset:1024 sc1
    s_nop 1
    v_add_f32_dpp v76, v76, v76 quad_perm:[1,0,3,2] row_mask:0xf bank_mask:0xf
    s_nop 1
    v_add_f32_dpp v76, v76, v76 quad_perm:[2,3,0,1] row_mask:0xf bank_mask:0xf
    s_nop 1
    v_add_f32_dpp v76, v76, v76 row_half_mirror row_mask:0xf bank_mask:0xf
    s_nop 1
    v_add_f32_dpp v76, v76, v76 row_mirror row_mask:0xf bank_mask:0xf
    v_mov_b32 v71, v76
    s_nop 1
    v_permlane16_swap_b32 v76, v71
    v_add_f32 v76, v76, v71
    v_mov_b32 v71, v76
    s_nop 1
    v_permlane32_swap_b32 v76, v71
    v_add_f32 v76, v76, v71
    v_cvt_pk_bf16_f32 v76, v76, v76
    v_lshlrev_b32 v76, 16, v76
    s_lshl_b32 s30, s29, 2
    s_add_u32 s30, s30, 0x280000
    s_mov_b64 exec, 1
    buffer_store_dword v76, off, s[4:7], s30 sc1
    s_mov_b64 exec, -1
INR_98:
    s_lshl_b32 s29, s96, 2
    s_add_u32 s29, s29, s14
    s_lshl_b32 s29, s29, 6
    v_add_u32 v5, s29, v0
    v_lshlrev_b32 v6, 4, v5
    v_mov_b32 v40, -1
    v_mov_b32 v44, 0
    v_mov_b32 v41, -1
    v_mov_b32 v45, 0
    v_mov_b32 v42, -1
    v_mov_b32 v46, 0
    v_mov_b32 v43, -1
    v_mov_b32 v47, 0
    v_cmp_gt_u32 vcc, 0x1000, v5
    s_nop 0
    s_and_saveexec_b64 s[38:39], vcc
    s_cbranch_execz INF_99
    s_mov_b32 s30, 0x290000
    buffer_store_dwordx4 v[44:47], v6, s[4:7], s30 offen sc1
INF_99:
    s_mov_b64 exec, s[38:39]
    s_waitcnt vmcnt(0)
    s_barrier
    s_cmp_lg_u32 s14, 0
    s_cbranch_scc1 INA_100
    v_mov_b32 v8, 1
    s_mov_b64 exec, 1
    buffer_atomic_add v8, off, s[60:63], s95 sc1
    s_mov_b64 exec, -1
INA_100:
    v_cmp_gt_u32 vcc, 0x5000, v5
    s_nop 0
    s_and_saveexec_b64 s[38:39], vcc
    s_cbranch_execz INF_101
    s_mov_b32 s30, 0x300000
    buffer_store_dwordx4 v[40:43], v6, s[4:7], s30 offen sc1
INF_101:
    s_mov_b64 exec, s[38:39]
    v_lshrrev_b32 v7, 6, v5
    v_mul_u32_u24 v7, 52429, v7
    v_lshrrev_b32 v7, 18, v7
    v_mul_u32_u24 v8, 320, v7
    v_sub_u32 v8, v5, v8
    v_lshlrev_b32 v48, 4, v8
    v_lshl_add_u32 v49, v7, 13, v48
    v_cmp_gt_u32 vcc, 0xa000, v5
    s_nop 0
    s_and_saveexec_b64 s[38:39], vcc
    s_cbranch_execz INF_102
    s_mov_b32 s30, 0x5904000
    buffer_store_dwordx4 v[40:43], v49, s[4:7], s30 offen sc1
INF_102:
    s_mov_b64 exec, s[38:39]
    s_mov_b32 s65, 0
CW_103:
    buffer_load_dwordx2 v[8:9], off, s[60:63], 0 offset:132 sc1
    s_add_u32 s65, s65, 1
    s_waitcnt vmcnt(0)
    v_readfirstlane_b32 s31, v8
    v_readfirstlane_b32 s32, v9
    s_min_u32 s64, s31, s32
    s_cmp_lg_u32 s64, 0
    s_cbranch_scc1 CWD_104
    s_cmp_gt_u32 s65, 65536
    s_cbranch_scc1 CWD_104
    s_sleep 4
    s_branch CW_103
CWD_104:
    s_sub_u32 s31, s31, 1
    s_and_b32 s31, s31, 3
    s_sub_u32 s32, s32, 1
    s_and_b32 s32, s32, 3
    s_lshl_b32 s31, s31, 13
    s_lshl_b32 s32, s32, 13
    s_add_u32 s32, s32, 0x200000
    v_and_b32 v8, 1, v7
    v_cmp_eq_u32 vcc, 1, v8
    v_mov_b32 v8, s31
    v_mov_b32 v9, s32
    v_cndmask_b32 v8, v8, v9, vcc
    v_lshrrev_b32 v9, 1, v7
    v_lshl_add_u32 v8, v9, 15, v8
    v_add_u32 v49, v8, v48
    v_cmp_le_u32 vcc, 640, v5
    v_mov_b32 v9, 0x40000000
    s_nop 0
    v_cndmask_b32 v49, v9, v49, vcc
    v_cmp_gt_u32 vcc, 0xa000, v5
    s_nop 0
    s_and_saveexec_b64 s[38:39], vcc
    s_cbranch_execz INF_105
    s_mov_b32 s30, 0x6000000
    buffer_store_dwordx4 v[40:43], v49, s[4:7], s30 offen sc1
INF_105:
    s_mov_b64 exec, s[38:39]
    s_cmp_ge_u32 s96, 10
    s_cbranch_scc1 INM1_106
    s_cmp_ge_u32 s14, 2
    s_cbranch_scc1 INM1_106
    s_cmp_ge_u32 s96, 5
    s_cselect_b32 s36, 1, 0
    s_mul_i32 s29, s36, 5
    s_sub_u32 s29, s96, s29
    s_lshl_b32 s29, s29, 10
    s_lshl_b32 s30, s36, 13
    s_add_u32 s30, s30, 0x5900000
    s_cmp_eq_u32 s36, 0
    s_cselect_b32 s37, s31, s32
    s_add_u32 s37, s37, 0x6000000
    s_cmp_eq_u32 s14, 0
    s_cselect_b32 s30, s30, s37
    s_add_u32 s30, s30, s29
    buffer_store_dwordx4 v[34:37], v3, s[4:7], s30 offen sc1
INM1_106:
    s_lshl_b32 s40, s13, 8
    s_lshl_b32 s42, s14, 6
    s_add_u32 s40, s40, s42
    s_mul_i32 s41, s14, 36864
    v_lshrrev_b32 v80, 2, v0
    v_mul_u32_u24 v79, 8192, v80
    v_lshrrev_b32 v80, 5, v0
    v_lshlrev_b32 v80, 1, v80
    v_and_b32 v81, 3, v0
    v_xor_b32 v80, v80, v81
    v_lshl_add_u32 v79, v80, 4, v79
    s_add_u32 m0, s41, 0
    s_add_u32 s42, s40, 0x0
    buffer_load_dwordx4 v79, s[44:47], s42 offen lds
    s_add_u32 m0, s41, 1024
    s_add_u32 s42, s40, 0x20000
    buffer_load_dwordx4 v79, s[44:47], s42 offen lds
    s_add_u32 m0, s41, 2048
    s_add_u32 s42, s40, 0x40000
    buffer_load_dwordx4 v79, s[44:47], s42 offen lds
    s_add_u32 m0, s41, 3072
    s_add_u32 s42, s40, 0x60000
    buffer_load_dwordx4 v79, s[44:47], s42 offen lds
    s_add_u32 m0, s41, 4096
    s_add_u32 s42, s40, 0x80000
    buffer_load_dwordx4 v79, s[44:47], s42 offen lds
    s_add_u32 m0, s41, 5120
    s_add_u32 s42, s40, 0xa0000
    buffer_load_dwordx4 v79, s[44:47], s42 offen lds
    s_add_u32 m0, s41, 6144
    s_add_u32 s42, s40, 0xc0000
    buffer_load_dwordx4 v79, s[44:47], s42 offen lds
    s_add_u32 m0, s41, 7168
    s_add_u32 s42, s40, 0xe0000
    buffer_load_dwordx4 v79, s[44:47], s42 offen lds
    s_add_u32 m0, s41, 8192
    s_add_u32 s42, s40, 0x100000
    buffer_load_dwordx4 v79, s[44:47], s42 offen lds
    s_add_u32 m0, s41, 9216
    s_add_u32 s42, s40, 0x120000
    buffer_load_dwordx4 v79, s[44:47], s42 offen lds
    s_add_u32 m0, s41, 10240
    s_add_u32 s42, s40, 0x140000
    buffer_load_dwordx4 v79, s[44:47], s42 offen lds
    s_add_u32 m0, s41, 11264
    s_add_u32 s42, s40, 0x160000
    buffer_load_dwordx4 v79, s[44:47], s42 offen lds
    s_add_u32 m0, s41, 12288
    s_add_u32 s42, s40, 0x180000
    buffer_load_dwordx4 v79, s[44:47], s42 offen lds
    s_add_u32 m0, s41, 13312
    s_add_u32 s42, s40, 0x1a0000
    buffer_load_dwordx4 v79, s[44:47], s42 offen lds
    s_add_u32 m0, s41, 14336
    s_add_u32 s42, s40, 0x1c0000
    buffer_load_dwordx4 v79, s[44:47], s42 offen lds
    s_add_u32 m0, s41, 15360
    s_add_u32 s42, s40, 0x1e0000
    buffer_load_dwordx4 v79, s[44:47], s42 offen lds
    s_add_u32 m0, s41, 16384
    s_add_u32 s42, s40, 0x200000
    buffer_load_dwordx4 v79, s[44:47], s42 offen lds
    s_add_u32 m0, s41, 17408
    s_add_u32 s42, s40, 0x220000
    buffer_load_dwordx4 v79, s[44:47], s42 offen lds
    s_add_u32 m0, s41, 18432
    s_add_u32 s42, s40, 0x240000
    buffer_load_dwordx4 v79, s[44:47], s42 offen lds
    s_add_u32 m0, s41, 19456
    s_add_u32 s42, s40, 0x260000
    buffer_load_dwordx4 v79, s[44:47], s42 offen lds
    s_add_u32 m0, s41, 20480
    s_add_u32 s42, s40, 0x280000
    buffer_load_dwordx4 v79, s[44:47], s42 offen lds
    s_add_u32 m0, s41, 21504
    s_add_u32 s42, s40, 0x2a0000
    buffer_load_dwordx4 v79, s[44:47], s42 offen lds
    s_add_u32 m0, s41, 22528
    s_add_u32 s42, s40, 0x2c0000
    buffer_load_dwordx4 v79, s[44:47], s42 offen lds
    s_add_u32 m0, s41, 23552
    s_add_u32 s42, s40, 0x2e0000
    buffer_load_dwordx4 v79, s[44:47], s42 offen lds
    s_add_u32 m0, s41, 24576
    s_add_u32 s42, s40, 0x300000
    buffer_load_dwordx4 v79, s[44:47], s42 offen lds
    s_add_u32 m0, s41, 25600
    s_add_u32 s42, s40, 0x320000
    buffer_load_dwordx4 v79, s[44:47], s42 offen lds
    s_add_u32 m0, s41, 26624
    s_add_u32 s42, s40, 0x340000
    buffer_load_dwordx4 v79, s[44:47], s42 offen lds
    s_add_u32 m0, s41, 27648
    s_add_u32 s42, s40, 0x360000
    buffer_load_dwordx4 v79, s[44:47], s42 offen lds
    s_add_u32 m0, s41, 28672
    s_add_u32 s42, s40, 0x380000
    buffer_load_dwordx4 v79, s[44:47], s42 offen lds
    s_add_u32 m0, s41, 29696
    s_add_u32 s42, s40, 0x3a0000
    buffer_load_dwordx4 v79, s[44:47], s42 offen lds
    s_add_u32 m0, s41, 30720
    s_add_u32 s42, s40, 0x3c0000
    buffer_load_dwordx4 v79, s[44:47], s42 offen lds
    s_add_u32 m0, s41, 31744
    s_add_u32 s42, s40, 0x3e0000
    buffer_load_dwordx4 v79, s[44:47], s42 offen lds
    s_add_u32 m0, s41, 32768
    s_add_u32 s42, s40, 0x400000
    buffer_load_dwordx4 v79, s[44:47], s42 offen lds
    s_add_u32 m0, s41, 33792
    s_add_u32 s42, s40, 0x420000
    buffer_load_dwordx4 v79, s[44:47], s42 offen lds
    s_add_u32 m0, s41, 34816
    s_add_u32 s42, s40, 0x440000
    buffer_load_dwordx4 v79, s[44:47], s42 offen lds
    s_add_u32 m0, s41, 35840
    s_add_u32 s42, s40, 0x460000
    buffer_load_dwordx4 v79, s[44:47], s42 offen lds
    v_mbcnt_lo_u32_b32 v0, -1, 0
    v_mbcnt_hi_u32_b32 v0, -1, v0
    s_cmp_eq_u32 s3, 0
    s_cbranch_scc1 H_E0
    s_cmp_eq_u32 s3, 1
    s_cbranch_scc1 H_E1
    s_cmp_eq_u32 s3, 2
    s_cbranch_scc1 H_E2
    s_branch M_EXIT
H_E0:
    s_lshl_b32 s16, s13, 14
    s_mov_b32 s17, 0x80000
    s_lshl_b32 s64, s14, 10
    s_add_u32 s16, s16, 0x1400000
    s_add_u32 s16, s16, s64
    s_mul_i32 s64, s12, s17
    s_lshl_b32 s64, s64, 2
    s_add_u32 s16, s16, s64
    s_lshl_b32 s18, s13, 4
    s_add_u32 s18, s18, 0x291000
    s_branch G_T
H_E1:
    s_lshl_b32 s16, s13, 14
    s_mov_b32 s17, 0x80000
    s_lshl_b32 s64, s14, 11
    s_add_u32 s16, s16, 0x1402000
    s_add_u32 s16, s16, s64
    s_mul_i32 s64, s12, s17
    s_lshl_b32 s64, s64, 2
    s_add_u32 s16, s16, s64
    s_lshl_b32 s18, s13, 4
    s_add_u32 s18, s18, 0x291004
    s_branch G_N
H_E2:
    s_lshl_b32 s16, s13, 13
    s_mov_b32 s17, 0x40000
    s_lshl_b32 s64, s14, 10
    s_add_u32 s16, s16, 0x3400000
    s_add_u32 s16, s16, s64
    s_mul_i32 s64, s12, s17
    s_lshl_b32 s64, s64, 2
    s_add_u32 s16, s16, s64
    s_lshl_b32 s18, s13, 4
    s_add_u32 s18, s18, 0x291008
    s_branch G_T
G_T:
    s_lshl_b32 s65, s13, 8
    s_lshl_b32 s66, s14, 6
    s_add_u32 s20, s65, s66
    s_mul_i32 s21, s14, 36864
    v_lshrrev_b32 v6, 2, v0
    v_mul_u32_u24 v5, 8192, v6
    v_lshrrev_b32 v6, 5, v0
    v_lshlrev_b32 v6, 1, v6
    v_and_b32 v7, 3, v0
    v_xor_b32 v6, v6, v7
    v_lshl_add_u32 v5, v6, 4, v5
    v_lshrrev_b32 v6, 5, v0
    v_lshlrev_b32 v3, 10, v6
    v_bfe_u32 v6, v0, 2, 2
    v_lshl_add_u32 v3, v6, 6, v3
    v_and_b32 v6, 3, v0
    v_lshl_add_u32 v3, v6, 3, v3
    v_bfe_u32 v6, v0, 4, 1
    v_lshl_add_u32 v3, v6, 9, v3
    v_add_u32 v3, s21, v3
    v_lshlrev_b32 v6, 5, v6
    v_sub_u32 v4, 32, v6
    v_add_u32 v4, v4, v3
    v_add_u32 v3, v3, v6
    s_waitcnt vmcnt(0)
    ds_read_b64_tr_b16 v[96:97], v3 offset:0
    ds_read_b64_tr_b16 v[98:99], v3 offset:256
    ds_read_b64_tr_b16 v[100:101], v4 offset:0
    ds_read_b64_tr_b16 v[102:103], v4 offset:256
    ds_read_b64_tr_b16 v[104:105], v3 offset:2048
    ds_read_b64_tr_b16 v[106:107], v3 offset:2304
    ds_read_b64_tr_b16 v[108:109], v4 offset:2048
    ds_read_b64_tr_b16 v[110:111], v4 offset:2304
    s_waitcnt lgkmcnt(0)
    s_add_u32 m0, s21, 0
    s_add_u32 s64, s20, 0x480000
    buffer_load_dwordx4 v5, s[44:47], s64 offen lds
    s_add_u32 m0, s21, 1024
    s_add_u32 s64, s20, 0x4a0000
    buffer_load_dwordx4 v5, s[44:47], s64 offen lds
    s_add_u32 m0, s21, 2048
    s_add_u32 s64, s20, 0x4c0000
    buffer_load_dwordx4 v5, s[44:47], s64 offen lds
    s_add_u32 m0, s21, 3072
    s_add_u32 s64, s20, 0x4e0000
    buffer_load_dwordx4 v5, s[44:47], s64 offen lds
    ds_read_b64_tr_b16 v[112:113], v3 offset:4096
    ds_read_b64_tr_b16 v[114:115], v3 offset:4352
    ds_read_b64_tr_b16 v[116:117], v4 offset:4096
    ds_read_b64_tr_b16 v[118:119], v4 offset:4352
    ds_read_b64_tr_b16 v[120:121], v3 offset:6144
    ds_read_b64_tr_b16 v[122:123], v3 offset:6400
    ds_read_b64_tr_b16 v[124:125], v4 offset:6144
    ds_read_b64_tr_b16 v[126:127], v4 offset:6400
    s_waitcnt lgkmcnt(0)
    ds_read_b64_tr_b16 v[128:129], v3 offset:8192
    ds_read_b64_tr_b16 v[130:131], v3 offset:8448
    ds_read_b64_tr_b16 v[132:133], v4 offset:8192
    ds_read_b64_tr_b16 v[134:135], v4 offset:8448
    ds_read_b64_tr_b16 v[136:137], v3 offset:10240
    ds_read_b64_tr_b16 v[138:139], v3 offset:10496
    ds_read_b64_tr_b16 v[140:141], v4 offset:10240
    ds_read_b64_tr_b16 v[142:143], v4 offset:10496
    s_waitcnt lgkmcnt(0)
    ds_read_b64_tr_b16 v[144:145], v3 offset:12288
    ds_read_b64_tr_b16 v[146:147], v3 offset:12544
    ds_read_b64_tr_b16 v[148:149], v4 offset:12288
    ds_read_b64_tr_b16 v[150:151], v4 offset:12544
    ds_read_b64_tr_b16 v[152:153], v3 offset:14336
    ds_read_b64_tr_b16 v[154:155], v3 offset:14592
    ds_read_b64_tr_b16 v[156:157], v4 offset:14336
    ds_read_b64_tr_b16 v[158:159], v4 offset:14592
    s_waitcnt lgkmcnt(0)
    ds_read_b64_tr_b16 v[160:161], v3 offset:16384
    ds_read_b64_tr_b16 v[162:163], v3 offset:16640
    ds_read_b64_tr_b16 v[164:165], v4 offset:16384
    ds_read_b64_tr_b16 v[166:167], v4 offset:16640
    ds_read_b64_tr_b16 v[168:169], v3 offset:18432
    ds_read_b64_tr_b16 v[170:171], v3 offset:18688
    ds_read_b64_tr_b16 v[172:173], v4 offset:18432
    ds_read_b64_tr_b16 v[174:175], v4 offset:18688
    s_waitcnt lgkmcnt(0)
    ds_read_b64_tr_b16 v[176:177], v3 offset:20480
    ds_read_b64_tr_b16 v[178:179], v3 offset:20736
    ds_read_b64_tr_b16 v[180:181], v4 offset:20480
    ds_read_b64_tr_b16 v[182:183], v4 offset:20736
    ds_read_b64_tr_b16 v[184:185], v3 offset:22528
    ds_read_b64_tr_b16 v[186:187], v3 offset:22784
    ds_read_b64_tr_b16 v[188:189], v4 offset:22528
    ds_read_b64_tr_b16 v[190:191], v4 offset:22784
    s_waitcnt lgkmcnt(0)
    ds_read_b64_tr_b16 v[192:193], v3 offset:24576
    ds_read_b64_tr_b16 v[194:195], v3 offset:24832
    ds_read_b64_tr_b16 v[196:197], v4 offset:24576
    ds_read_b64_tr_b16 v[198:199], v4 offset:24832
    ds_read_b64_tr_b16 v[200:201], v3 offset:26624
    ds_read_b64_tr_b16 v[202:203], v3 offset:26880
    ds_read_b64_tr_b16 v[204:205], v4 offset:26624
    ds_read_b64_tr_b16 v[206:207], v4 offset:26880
    s_waitcnt lgkmcnt(0)
    ds_read_b64_tr_b16 v[208:209], v3 offset:28672
    ds_read_b64_tr_b16 v[210:211], v3 offset:28928
    ds_read_b64_tr_b16 v[212:213], v4 offset:28672
    ds_read_b64_tr_b16 v[214:215], v4 offset:28928
    ds_read_b64_tr_b16 v[216:217], v3 offset:30720
    ds_read_b64_tr_b16 v[218:219], v3 offset:30976
    ds_read_b64_tr_b16 v[220:221], v4 offset:30720
    ds_read_b64_tr_b16 v[222:223], v4 offset:30976
    s_waitcnt lgkmcnt(0)
    ds_read_b64_tr_b16 v[224:225], v3 offset:32768
    ds_read_b64_tr_b16 v[226:227], v3 offset:33024
    ds_read_b64_tr_b16 v[228:229], v4 offset:32768
    ds_read_b64_tr_b16 v[230:231], v4 offset:33024
    ds_read_b64_tr_b16 v[232:233], v3 offset:34816
    ds_read_b64_tr_b16 v[234:235], v3 offset:35072
    ds_read_b64_tr_b16 v[236:237], v4 offset:34816
    ds_read_b64_tr_b16 v[238:239], v4 offset:35072
    s_waitcnt lgkmcnt(0)
    s_waitcnt vmcnt(0)
    ds_read_b64_tr_b16 v[240:241], v3 offset:0
    ds_read_b64_tr_b16 v[242:243], v3 offset:256
    ds_read_b64_tr_b16 v[244:245], v4 offset:0
    ds_read_b64_tr_b16 v[246:247], v4 offset:256
    ds_read_b64_tr_b16 v[248:249], v3 offset:2048
    ds_read_b64_tr_b16 v[250:251], v3 offset:2304
    ds_read_b64_tr_b16 v[252:253], v4 offset:2048
    ds_read_b64_tr_b16 v[254:255], v4 offset:2304
    s_waitcnt lgkmcnt(0)
    s_cmp_lg_u32 s97, 0
    s_cbranch_scc1 CM_107
    v_mbcnt_lo_u32_b32 v0, -1, 0
    v_mbcnt_hi_u32_b32 v0, -1, v0
    v_mul_u32_u24 v8, 32, v0
    s_mov_b32 s64, 0x0
    s_mov_b32 s65, 0
    s_mov_b64 exec, 0xff
TK_108:
    buffer_load_dword v9, v8, s[60:63], s64 offen sc1
    s_add_u32 s65, s65, 1
    s_waitcnt vmcnt(0)
    s_mov_b32 s66, 0
    v_readlane_b32 s67, v9, 0
    s_add_u32 s66, s66, s67
    v_readlane_b32 s67, v9, 1
    s_add_u32 s66, s66, s67
    v_readlane_b32 s67, v9, 2
    s_add_u32 s66, s66, s67
    v_readlane_b32 s67, v9, 3
    s_add_u32 s66, s66, s67
    v_readlane_b32 s67, v9, 4
    s_add_u32 s66, s66, s67
    v_readlane_b32 s67, v9, 5
    s_add_u32 s66, s66, s67
    v_readlane_b32 s67, v9, 6
    s_add_u32 s66, s66, s67
    v_readlane_b32 s67, v9, 7
    s_add_u32 s66, s66, s67
    s_cmp_ge_u32 s66, 256
    s_cbranch_scc1 TKD_109
    s_cmp_gt_u32 s65, 262144
    s_cbranch_scc0 TK_108
TKD_109:
    v_cmp_ne_u32 vcc, 32, v9
    s_mov_b64 exec, -1
    s_cbranch_vccnz M_SLOW
CM_107:
    s_mov_b32 s65, 0
GI_110:
    buffer_load_dword v8, off, s[60:63], s95 sc1
    s_add_u32 s65, s65, 1
    s_waitcnt vmcnt(0)
    v_readfirstlane_b32 s64, v8
    s_cmp_ge_u32 s64, 192
    s_cbranch_scc1 GID_111
    s_cmp_gt_u32 s65, 65536
    s_cbranch_scc1 GID_111
    s_sleep 4
    s_branch GI_110
GID_111:
    v_mbcnt_lo_u32_b32 v0, -1, 0
    v_mbcnt_hi_u32_b32 v0, -1, v0
    s_waitcnt vmcnt(0)
    s_barrier
    s_cmp_lg_u32 s14, 0
    s_cbranch_scc1 INE_112
    s_cmp_lg_u32 s96, 10
    s_cbranch_scc1 ING_113
    v_mov_b32 v44, 1
    v_lshlrev_b32 v6, 7, v0
    s_mov_b32 s65, 0x29a000
    s_mov_b64 exec, 3
    buffer_store_dword v44, v6, s[4:7], s65 offen sc1
    s_mov_b64 exec, -1
    s_waitcnt vmcnt(0)
ING_113:
    v_mov_b32 v8, 1
    s_mov_b32 s65, 0x290800
    s_mov_b64 exec, 1
    buffer_atomic_add v8, off, s[4:7], s65 sc1
    s_mov_b64 exec, -1
INE_112:
    s_cmp_lg_u32 s3, 2
    s_cbranch_scc1 NOSEL_114
    s_or_b32 s64, s13, s12
    s_or_b32 s64, s64, s14
    s_cmp_lg_u32 s64, 0
    s_cbranch_scc1 NOSEL_114
    s_mov_b32 s29, 0
    v_lshlrev_b32 v1, 4, v0
    s_mov_b32 s64, 0x280000
    buffer_load_dwordx4 v[16:19], v1, s[4:7], s64 offen offset:0 sc1
    buffer_load_dwordx4 v[20:23], v1, s[4:7], s64 offen offset:1024 sc1
    buffer_load_dwordx4 v[24:27], v1, s[4:7], s64 offen offset:2048 sc1
    buffer_load_dwordx4 v[28:31], v1, s[4:7], s64 offen offset:3072 sc1
    s_add_u32 s64, s64, 4096
    buffer_load_dwordx4 v[32:35], v1, s[4:7], s64 offen offset:0 sc1
    buffer_load_dwordx4 v[36:39], v1, s[4:7], s64 offen offset:1024 sc1
    buffer_load_dwordx4 v[40:43], v1, s[4:7], s64 offen offset:2048 sc1
    buffer_load_dwordx4 v[44:47], v1, s[4:7], s64 offen offset:3072 sc1
    s_waitcnt vmcnt(0)
    v_lshlrev_b32 v2, 2, v0
    v_ashrrev_i32 v3, 31, v16
    v_or_b32 v3, 0x80000000, v3
    v_xor_b32 v16, v16, v3
    v_and_b32 v16, 0xffff0000, v16
    v_sub_u32 v3, 65535, v2
    v_or_b32 v16, v16, v3
    v_ashrrev_i32 v3, 31, v17
    v_or_b32 v3, 0x80000000, v3
    v_xor_b32 v17, v17, v3
    v_and_b32 v17, 0xffff0000, v17
    v_sub_u32 v3, 65534, v2
    v_or_b32 v17, v17, v3
    v_ashrrev_i32 v3, 31, v18
    v_or_b32 v3, 0x80000000, v3
    v_xor_b32 v18, v18, v3
    v_and_b32 v18, 0xffff0000, v18
    v_sub_u32 v3, 65533, v2
    v_or_b32 v18, v18, v3
    v_ashrrev_i32 v3, 31, v19
    v_or_b32 v3, 0x80000000, v3
    v_xor_b32 v19, v19, v3
    v_and_b32 v19, 0xffff0000, v19
    v_sub_u32 v3, 65532, v2
    v_or_b32 v19, v19, v3
    v_ashrrev_i32 v3, 31, v20
    v_or_b32 v3, 0x80000000, v3
    v_xor_b32 v20, v20, v3
    v_and_b32 v20, 0xffff0000, v20
    v_sub_u32 v3, 65279, v2
    v_or_b32 v20, v20, v3
    v_ashrrev_i32 v3, 31, v21
    v_or_b32 v3, 0x80000000, v3
    v_xor_b32 v21, v21, v3
    v_and_b32 v21, 0xffff0000, v21
    v_sub_u32 v3, 65278, v2
    v_or_b32 v21, v21, v3
    v_ashrrev_i32 v3, 31, v22
    v_or_b32 v3, 0x80000000, v3
    v_xor_b32 v22, v22, v3
    v_and_b32 v22, 0xffff0000, v22
    v_sub_u32 v3, 65277, v2
    v_or_b32 v22, v22, v3
    v_ashrrev_i32 v3, 31, v23
    v_or_b32 v3, 0x80000000, v3
    v_xor_b32 v23, v23, v3
    v_and_b32 v23, 0xffff0000, v23
    v_sub_u32 v3, 65276, v2
    v_or_b32 v23, v23, v3
    v_ashrrev_i32 v3, 31, v24
    v_or_b32 v3, 0x80000000, v3
    v_xor_b32 v24, v24, v3
    v_and_b32 v24, 0xffff0000, v24
    v_sub_u32 v3, 65023, v2
    v_or_b32 v24, v24, v3
    v_ashrrev_i32 v3, 31, v25
    v_or_b32 v3, 0x80000000, v3
    v_xor_b32 v25, v25, v3
    v_and_b32 v25, 0xffff0000, v25
    v_sub_u32 v3, 65022, v2
    v_or_b32 v25, v25, v3
    v_ashrrev_i32 v3, 31, v26
    v_or_b32 v3, 0x80000000, v3
    v_xor_b32 v26, v26, v3
    v_and_b32 v26, 0xffff0000, v26
    v_sub_u32 v3, 65021, v2
    v_or_b32 v26, v26, v3
    v_ashrrev_i32 v3, 31, v27
    v_or_b32 v3, 0x80000000, v3
    v_xor_b32 v27, v27, v3
    v_and_b32 v27, 0xffff0000, v27
    v_sub_u32 v3, 65020, v2
    v_or_b32 v27, v27, v3
    v_ashrrev_i32 v3, 31, v28
    v_or_b32 v3, 0x80000000, v3
    v_xor_b32 v28, v28, v3
    v_and_b32 v28, 0xffff0000, v28
    v_sub_u32 v3, 64767, v2
    v_or_b32 v28, v28, v3
    v_ashrrev_i32 v3, 31, v29
    v_or_b32 v3, 0x80000000, v3
    v_xor_b32 v29, v29, v3
    v_and_b32 v29, 0xffff0000, v29
    v_sub_u32 v3, 64766, v2
    v_or_b32 v29, v29, v3
    v_ashrrev_i32 v3, 31, v30
    v_or_b32 v3, 0x80000000, v3
    v_xor_b32 v30, v30, v3
    v_and_b32 v30, 0xffff0000, v30
    v_sub_u32 v3, 64765, v2
    v_or_b32 v30, v30, v3
    v_ashrrev_i32 v3, 31, v31
    v_or_b32 v3, 0x80000000, v3
    v_xor_b32 v31, v31, v3
    v_and_b32 v31, 0xffff0000, v31
    v_sub_u32 v3, 64764, v2
    v_or_b32 v31, v31, v3
    v_ashrrev_i32 v3, 31, v32
    v_or_b32 v3, 0x80000000, v3
    v_xor_b32 v32, v32, v3
    v_and_b32 v32, 0xffff0000, v32
    v_sub_u32 v3, 64511, v2
    v_or_b32 v32, v32, v3
    v_ashrrev_i32 v3, 31, v33
    v_or_b32 v3, 0x80000000, v3
    v_xor_b32 v33, v33, v3
    v_and_b32 v33, 0xffff0000, v33
    v_sub_u32 v3, 64510, v2
    v_or_b32 v33, v33, v3
    v_ashrrev_i32 v3, 31, v34
    v_or_b32 v3, 0x80000000, v3
    v_xor_b32 v34, v34, v3
    v_and_b32 v34, 0xffff0000, v34
    v_sub_u32 v3, 64509, v2
    v_or_b32 v34, v34, v3
    v_ashrrev_i32 v3, 31, v35
    v_or_b32 v3, 0x80000000, v3
    v_xor_b32 v35, v35, v3
    v_and_b32 v35, 0xffff0000, v35
    v_sub_u32 v3, 64508, v2
    v_or_b32 v35, v35, v3
    v_ashrrev_i32 v3, 31, v36
    v_or_b32 v3, 0x80000000, v3
    v_xor_b32 v36, v36, v3
    v_and_b32 v36, 0xffff0000, v36
    v_sub_u32 v3, 64255, v2
    v_or_b32 v36, v36, v3
    v_ashrrev_i32 v3, 31, v37
    v_or_b32 v3, 0x80000000, v3
    v_xor_b32 v37, v37, v3
    v_and_b32 v37, 0xffff0000, v37
    v_sub_u32 v3, 64254, v2
    v_or_b32 v37, v37, v3
    v_ashrrev_i32 v3, 31, v38
    v_or_b32 v3, 0x80000000, v3
    v_xor_b32 v38, v38, v3
    v_and_b32 v38, 0xffff0000, v38
    v_sub_u32 v3, 64253, v2
    v_or_b32 v38, v38, v3
    v_ashrrev_i32 v3, 31, v39
    v_or_b32 v3, 0x80000000, v3
    v_xor_b32 v39, v39, v3
    v_and_b32 v39, 0xffff0000, v39
    v_sub_u32 v3, 64252, v2
    v_or_b32 v39, v39, v3
    v_ashrrev_i32 v3, 31, v40
    v_or_b32 v3, 0x80000000, v3
    v_xor_b32 v40, v40, v3
    v_and_b32 v40, 0xffff0000, v40
    v_sub_u32 v3, 63999, v2
    v_or_b32 v40, v40, v3
    v_ashrrev_i32 v3, 31, v41
    v_or_b32 v3, 0x80000000, v3
    v_xor_b32 v41, v41, v3
    v_and_b32 v41, 0xffff0000, v41
    v_sub_u32 v3, 63998, v2
    v_or_b32 v41, v41, v3
    v_ashrrev_i32 v3, 31, v42
    v_or_b32 v3, 0x80000000, v3
    v_xor_b32 v42, v42, v3
    v_and_b32 v42, 0xffff0000, v42
    v_sub_u32 v3, 63997, v2
    v_or_b32 v42, v42, v3
    v_ashrrev_i32 v3, 31, v43
    v_or_b32 v3, 0x80000000, v3
    v_xor_b32 v43, v43, v3
    v_and_b32 v43, 0xffff0000, v43
    v_sub_u32 v3, 63996, v2
    v_or_b32 v43, v43, v3
    v_ashrrev_i32 v3, 31, v44
    v_or_b32 v3, 0x80000000, v3
    v_xor_b32 v44, v44, v3
    v_and_b32 v44, 0xffff0000, v44
    v_sub_u32 v3, 63743, v2
    v_or_b32 v44, v44, v3
    v_ashrrev_i32 v3, 31, v45
    v_or_b32 v3, 0x80000000, v3
    v_xor_b32 v45, v45, v3
    v_and_b32 v45, 0xffff0000, v45
    v_sub_u32 v3, 63742, v2
    v_or_b32 v45, v45, v3
    v_ashrrev_i32 v3, 31, v46
    v_or_b32 v3, 0x80000000, v3
    v_xor_b32 v46, v46, v3
    v_and_b32 v46, 0xffff0000, v46
    v_sub_u32 v3, 63741, v2
    v_or_b32 v46, v46, v3
    v_ashrrev_i32 v3, 31, v47
    v_or_b32 v3, 0x80000000, v3
    v_xor_b32 v47, v47, v3
    v_and_b32 v47, 0xffff0000, v47
    v_sub_u32 v3, 63740, v2
    v_or_b32 v47, v47, v3
    v_max3_u32 v4, v16, v17, v18
    v_max3_u32 v4, v4, v19, v20
    v_max3_u32 v4, v4, v21, v22
    v_max3_u32 v4, v4, v23, v24
    v_max3_u32 v4, v4, v25, v26
    v_max3_u32 v4, v4, v27, v28
    v_max3_u32 v4, v4, v29, v30
    v_max3_u32 v4, v4, v31, v32
    v_max3_u32 v4, v4, v33, v34
    v_max3_u32 v4, v4, v35, v36
    v_max3_u32 v4, v4, v37, v38
    v_max3_u32 v4, v4, v39, v40
    v_max3_u32 v4, v4, v41, v42
    v_max3_u32 v4, v4, v43, v44
    v_max3_u32 v4, v4, v45, v46
    v_max_u32 v4, v4, v47
    s_nop 1
    v_max_u32_dpp v4, v4, v4 quad_perm:[1,0,3,2] row_mask:0xf bank_mask:0xf
    s_nop 1
    v_max_u32_dpp v4, v4, v4 quad_perm:[2,3,0,1] row_mask:0xf bank_mask:0xf
    s_nop 1
    v_max_u32_dpp v4, v4, v4 row_half_mirror row_mask:0xf bank_mask:0xf
    s_nop 1
    v_max_u32_dpp v4, v4, v4 row_mirror row_mask:0xf bank_mask:0xf
    v_mov_b32 v5, v4
    s_nop 1
    v_permlane16_swap_b32 v4, v5
    v_max_u32 v4, v4, v5
    v_mov_b32 v5, v4
    s_nop 1
    v_permlane32_swap_b32 v4, v5
    v_max_u32 v4, v4, v5
    v_mov_b32 v56, v4
    v_cmp_eq_u32 vcc, v4, v16
    s_nop 1
    v_cndmask_b32 v16, v16, 0, vcc
    v_cmp_eq_u32 vcc, v4, v17
    s_nop 1
    v_cndmask_b32 v17, v17, 0, vcc
    v_cmp_eq_u32 vcc, v4, v18
    s_nop 1
    v_cndmask_b32 v18, v18, 0, vcc
    v_cmp_eq_u32 vcc, v4, v19
    s_nop 1
    v_cndmask_b32 v19, v19, 0, vcc
    v_cmp_eq_u32 vcc, v4, v20
    s_nop 1
    v_cndmask_b32 v20, v20, 0, vcc
    v_cmp_eq_u32 vcc, v4, v21
    s_nop 1
    v_cndmask_b32 v21, v21, 0, vcc
    v_cmp_eq_u32 vcc, v4, v22
    s_nop 1
    v_cndmask_b32 v22, v22, 0, vcc
    v_cmp_eq_u32 vcc, v4, v23
    s_nop 1
    v_cndmask_b32 v23, v23, 0, vcc
    v_cmp_eq_u32 vcc, v4, v24
    s_nop 1
    v_cndmask_b32 v24, v24, 0, vcc
    v_cmp_eq_u32 vcc, v4, v25
    s_nop 1
    v_cndmask_b32 v25, v25, 0, vcc
    v_cmp_eq_u32 vcc, v4, v26
    s_nop 1
    v_cndmask_b32 v26, v26, 0, vcc
    v_cmp_eq_u32 vcc, v4, v27
    s_nop 1
    v_cndmask_b32 v27, v27, 0, vcc
    v_cmp_eq_u32 vcc, v4, v28
    s_nop 1
    v_cndmask_b32 v28, v28, 0, vcc
    v_cmp_eq_u32 vcc, v4, v29
    s_nop 1
    v_cndmask_b32 v29, v29, 0, vcc
    v_cmp_eq_u32 vcc, v4, v30
    s_nop 1
    v_cndmask_b32 v30, v30, 0, vcc
    v_cmp_eq_u32 vcc, v4, v31
    s_nop 1
    v_cndmask_b32 v31, v31, 0, vcc
    v_cmp_eq_u32 vcc, v4, v32
    s_nop 1
    v_cndmask_b32 v32, v32, 0, vcc
    v_cmp_eq_u32 vcc, v4, v33
    s_nop 1
    v_cndmask_b32 v33, v33, 0, vcc
    v_cmp_eq_u32 vcc, v4, v34
    s_nop 1
    v_cndmask_b32 v34, v34, 0, vcc
    v_cmp_eq_u32 vcc, v4, v35
    s_nop 1
    v_cndmask_b32 v35, v35, 0, vcc
    v_cmp_eq_u32 vcc, v4, v36
    s_nop 1
    v_cndmask_b32 v36, v36, 0, vcc
    v_cmp_eq_u32 vcc, v4, v37
    s_nop 1
    v_cndmask_b32 v37, v37, 0, vcc
    v_cmp_eq_u32 vcc, v4, v38
    s_nop 1
    v_cndmask_b32 v38, v38, 0, vcc
    v_cmp_eq_u32 vcc, v4, v39
    s_nop 1
    v_cndmask_b32 v39, v39, 0, vcc
    v_cmp_eq_u32 vcc, v4, v40
    s_nop 1
    v_cndmask_b32 v40, v40, 0, vcc
    v_cmp_eq_u32 vcc, v4, v41
    s_nop 1
    v_cndmask_b32 v41, v41, 0, vcc
    v_cmp_eq_u32 vcc, v4, v42
    s_nop 1
    v_cndmask_b32 v42, v42, 0, vcc
    v_cmp_eq_u32 vcc, v4, v43
    s_nop 1
    v_cndmask_b32 v43, v43, 0, vcc
    v_cmp_eq_u32 vcc, v4, v44
    s_nop 1
    v_cndmask_b32 v44, v44, 0, vcc
    v_cmp_eq_u32 vcc, v4, v45
    s_nop 1
    v_cndmask_b32 v45, v45, 0, vcc
    v_cmp_eq_u32 vcc, v4, v46
    s_nop 1
    v_cndmask_b32 v46, v46, 0, vcc
    v_cmp_eq_u32 vcc, v4, v47
    s_nop 1
    v_cndmask_b32 v47, v47, 0, vcc
    v_max3_u32 v4, v16, v17, v18
    v_max3_u32 v4, v4, v19, v20
    v_max3_u32 v4, v4, v21, v22
    v_max3_u32 v4, v4, v23, v24
    v_max3_u32 v4, v4, v25, v26
    v_max3_u32 v4, v4, v27, v28
    v_max3_u32 v4, v4, v29, v30
    v_max3_u32 v4, v4, v31, v32
    v_max3_u32 v4, v4, v33, v34
    v_max3_u32 v4, v4, v35, v36
    v_max3_u32 v4, v4, v37, v38
    v_max3_u32 v4, v4, v39, v40
    v_max3_u32 v4, v4, v41, v42
    v_max3_u32 v4, v4, v43, v44
    v_max3_u32 v4, v4, v45, v46
    v_max_u32 v4, v4, v47
    s_nop 1
    v_max_u32_dpp v4, v4, v4 quad_perm:[1,0,3,2] row_mask:0xf bank_mask:0xf
    s_nop 1
    v_max_u32_dpp v4, v4, v4 quad_perm:[2,3,0,1] row_mask:0xf bank_mask:0xf
    s_nop 1
    v_max_u32_dpp v4, v4, v4 row_half_mirror row_mask:0xf bank_mask:0xf
    s_nop 1
    v_max_u32_dpp v4, v4, v4 row_mirror row_mask:0xf bank_mask:0xf
    v_mov_b32 v5, v4
    s_nop 1
    v_permlane16_swap_b32 v4, v5
    v_max_u32 v4, v4, v5
    v_mov_b32 v5, v4
    s_nop 1
    v_permlane32_swap_b32 v4, v5
    v_max_u32 v4, v4, v5
    v_mov_b32 v57, v4
    v_cmp_eq_u32 vcc, v4, v16
    s_nop 1
    v_cndmask_b32 v16, v16, 0, vcc
    v_cmp_eq_u32 vcc, v4, v17
    s_nop 1
    v_cndmask_b32 v17, v17, 0, vcc
    v_cmp_eq_u32 vcc, v4, v18
    s_nop 1
    v_cndmask_b32 v18, v18, 0, vcc
    v_cmp_eq_u32 vcc, v4, v19
    s_nop 1
    v_cndmask_b32 v19, v19, 0, vcc
    v_cmp_eq_u32 vcc, v4, v20
    s_nop 1
    v_cndmask_b32 v20, v20, 0, vcc
    v_cmp_eq_u32 vcc, v4, v21
    s_nop 1
    v_cndmask_b32 v21, v21, 0, vcc
    v_cmp_eq_u32 vcc, v4, v22
    s_nop 1
    v_cndmask_b32 v22, v22, 0, vcc
    v_cmp_eq_u32 vcc, v4, v23
    s_nop 1
    v_cndmask_b32 v23, v23, 0, vcc
    v_cmp_eq_u32 vcc, v4, v24
    s_nop 1
    v_cndmask_b32 v24, v24, 0, vcc
    v_cmp_eq_u32 vcc, v4, v25
    s_nop 1
    v_cndmask_b32 v25, v25, 0, vcc
    v_cmp_eq_u32 vcc, v4, v26
    s_nop 1
    v_cndmask_b32 v26, v26, 0, vcc
    v_cmp_eq_u32 vcc, v4, v27
    s_nop 1
    v_cndmask_b32 v27, v27, 0, vcc
    v_cmp_eq_u32 vcc, v4, v28
    s_nop 1
    v_cndmask_b32 v28, v28, 0, vcc
    v_cmp_eq_u32 vcc, v4, v29
    s_nop 1
    v_cndmask_b32 v29, v29, 0, vcc
    v_cmp_eq_u32 vcc, v4, v30
    s_nop 1
    v_cndmask_b32 v30, v30, 0, vcc
    v_cmp_eq_u32 vcc, v4, v31
    s_nop 1
    v_cndmask_b32 v31, v31, 0, vcc
    v_cmp_eq_u32 vcc, v4, v32
    s_nop 1
    v_cndmask_b32 v32, v32, 0, vcc
    v_cmp_eq_u32 vcc, v4, v33
    s_nop 1
    v_cndmask_b32 v33, v33, 0, vcc
    v_cmp_eq_u32 vcc, v4, v34
    s_nop 1
    v_cndmask_b32 v34, v34, 0, vcc
    v_cmp_eq_u32 vcc, v4, v35
    s_nop 1
    v_cndmask_b32 v35, v35, 0, vcc
    v_cmp_eq_u32 vcc, v4, v36
    s_nop 1
    v_cndmask_b32 v36, v36, 0, vcc
    v_cmp_eq_u32 vcc, v4, v37
    s_nop 1
    v_cndmask_b32 v37, v37, 0, vcc
    v_cmp_eq_u32 vcc, v4, v38
    s_nop 1
    v_cndmask_b32 v38, v38, 0, vcc
    v_cmp_eq_u32 vcc, v4, v39
    s_nop 1
    v_cndmask_b32 v39, v39, 0, vcc
    v_cmp_eq_u32 vcc, v4, v40
    s_nop 1
    v_cndmask_b32 v40, v40, 0, vcc
    v_cmp_eq_u32 vcc, v4, v41
    s_nop 1
    v_cndmask_b32 v41, v41, 0, vcc
    v_cmp_eq_u32 vcc, v4, v42
    s_nop 1
    v_cndmask_b32 v42, v42, 0, vcc
    v_cmp_eq_u32 vcc, v4, v43
    s_nop 1
    v_cndmask_b32 v43, v43, 0, vcc
    v_cmp_eq_u32 vcc, v4, v44
    s_nop 1
    v_cndmask_b32 v44, v44, 0, vcc
    v_cmp_eq_u32 vcc, v4, v45
    s_nop 1
    v_cndmask_b32 v45, v45, 0, vcc
    v_cmp_eq_u32 vcc, v4, v46
    s_nop 1
    v_cndmask_b32 v46, v46, 0, vcc
    v_cmp_eq_u32 vcc, v4, v47
    s_nop 1
    v_cndmask_b32 v47, v47, 0, vcc
    v_max3_u32 v4, v16, v17, v18
    v_max3_u32 v4, v4, v19, v20
    v_max3_u32 v4, v4, v21, v22
    v_max3_u32 v4, v4, v23, v24
    v_max3_u32 v4, v4, v25, v26
    v_max3_u32 v4, v4, v27, v28
    v_max3_u32 v4, v4, v29, v30
    v_max3_u32 v4, v4, v31, v32
    v_max3_u32 v4, v4, v33, v34
    v_max3_u32 v4, v4, v35, v36
    v_max3_u32 v4, v4, v37, v38
    v_max3_u32 v4, v4, v39, v40
    v_max3_u32 v4, v4, v41, v42
    v_max3_u32 v4, v4, v43, v44
    v_max3_u32 v4, v4, v45, v46
    v_max_u32 v4, v4, v47
    s_nop 1
    v_max_u32_dpp v4, v4, v4 quad_perm:[1,0,3,2] row_mask:0xf bank_mask:0xf
    s_nop 1
    v_max_u32_dpp v4, v4, v4 quad_perm:[2,3,0,1] row_mask:0xf bank_mask:0xf
    s_nop 1
    v_max_u32_dpp v4, v4, v4 row_half_mirror row_mask:0xf bank_mask:0xf
    s_nop 1
    v_max_u32_dpp v4, v4, v4 row_mirror row_mask:0xf bank_mask:0xf
    v_mov_b32 v5, v4
    s_nop 1
    v_permlane16_swap_b32 v4, v5
    v_max_u32 v4, v4, v5
    v_mov_b32 v5, v4
    s_nop 1
    v_permlane32_swap_b32 v4, v5
    v_max_u32 v4, v4, v5
    v_mov_b32 v58, v4
    v_cmp_eq_u32 vcc, v4, v16
    s_nop 1
    v_cndmask_b32 v16, v16, 0, vcc
    v_cmp_eq_u32 vcc, v4, v17
    s_nop 1
    v_cndmask_b32 v17, v17, 0, vcc
    v_cmp_eq_u32 vcc, v4, v18
    s_nop 1
    v_cndmask_b32 v18, v18, 0, vcc
    v_cmp_eq_u32 vcc, v4, v19
    s_nop 1
    v_cndmask_b32 v19, v19, 0, vcc
    v_cmp_eq_u32 vcc, v4, v20
    s_nop 1
    v_cndmask_b32 v20, v20, 0, vcc
    v_cmp_eq_u32 vcc, v4, v21
    s_nop 1
    v_cndmask_b32 v21, v21, 0, vcc
    v_cmp_eq_u32 vcc, v4, v22
    s_nop 1
    v_cndmask_b32 v22, v22, 0, vcc
    v_cmp_eq_u32 vcc, v4, v23
    s_nop 1
    v_cndmask_b32 v23, v23, 0, vcc
    v_cmp_eq_u32 vcc, v4, v24
    s_nop 1
    v_cndmask_b32 v24, v24, 0, vcc
    v_cmp_eq_u32 vcc, v4, v25
    s_nop 1
    v_cndmask_b32 v25, v25, 0, vcc
    v_cmp_eq_u32 vcc, v4, v26
    s_nop 1
    v_cndmask_b32 v26, v26, 0, vcc
    v_cmp_eq_u32 vcc, v4, v27
    s_nop 1
    v_cndmask_b32 v27, v27, 0, vcc
    v_cmp_eq_u32 vcc, v4, v28
    s_nop 1
    v_cndmask_b32 v28, v28, 0, vcc
    v_cmp_eq_u32 vcc, v4, v29
    s_nop 1
    v_cndmask_b32 v29, v29, 0, vcc
    v_cmp_eq_u32 vcc, v4, v30
    s_nop 1
    v_cndmask_b32 v30, v30, 0, vcc
    v_cmp_eq_u32 vcc, v4, v31
    s_nop 1
    v_cndmask_b32 v31, v31, 0, vcc
    v_cmp_eq_u32 vcc, v4, v32
    s_nop 1
    v_cndmask_b32 v32, v32, 0, vcc
    v_cmp_eq_u32 vcc, v4, v33
    s_nop 1
    v_cndmask_b32 v33, v33, 0, vcc
    v_cmp_eq_u32 vcc, v4, v34
    s_nop 1
    v_cndmask_b32 v34, v34, 0, vcc
    v_cmp_eq_u32 vcc, v4, v35
    s_nop 1
    v_cndmask_b32 v35, v35, 0, vcc
    v_cmp_eq_u32 vcc, v4, v36
    s_nop 1
    v_cndmask_b32 v36, v36, 0, vcc
    v_cmp_eq_u32 vcc, v4, v37
    s_nop 1
    v_cndmask_b32 v37, v37, 0, vcc
    v_cmp_eq_u32 vcc, v4, v38
    s_nop 1
    v_cndmask_b32 v38, v38, 0, vcc
    v_cmp_eq_u32 vcc, v4, v39
    s_nop 1
    v_cndmask_b32 v39, v39, 0, vcc
    v_cmp_eq_u32 vcc, v4, v40
    s_nop 1
    v_cndmask_b32 v40, v40, 0, vcc
    v_cmp_eq_u32 vcc, v4, v41
    s_nop 1
    v_cndmask_b32 v41, v41, 0, vcc
    v_cmp_eq_u32 vcc, v4, v42
    s_nop 1
    v_cndmask_b32 v42, v42, 0, vcc
    v_cmp_eq_u32 vcc, v4, v43
    s_nop 1
    v_cndmask_b32 v43, v43, 0, vcc
    v_cmp_eq_u32 vcc, v4, v44
    s_nop 1
    v_cndmask_b32 v44, v44, 0, vcc
    v_cmp_eq_u32 vcc, v4, v45
    s_nop 1
    v_cndmask_b32 v45, v45, 0, vcc
    v_cmp_eq_u32 vcc, v4, v46
    s_nop 1
    v_cndmask_b32 v46, v46, 0, vcc
    v_cmp_eq_u32 vcc, v4, v47
    s_nop 1
    v_cndmask_b32 v47, v47, 0, vcc
    v_max3_u32 v4, v16, v17, v18
    v_max3_u32 v4, v4, v19, v20
    v_max3_u32 v4, v4, v21, v22
    v_max3_u32 v4, v4, v23, v24
    v_max3_u32 v4, v4, v25, v26
    v_max3_u32 v4, v4, v27, v28
    v_max3_u32 v4, v4, v29, v30
    v_max3_u32 v4, v4, v31, v32
    v_max3_u32 v4, v4, v33, v34
    v_max3_u32 v4, v4, v35, v36
    v_max3_u32 v4, v4, v37, v38
    v_max3_u32 v4, v4, v39, v40
    v_max3_u32 v4, v4, v41, v42
    v_max3_u32 v4, v4, v43, v44
    v_max3_u32 v4, v4, v45, v46
    v_max_u32 v4, v4, v47
    s_nop 1
    v_max_u32_dpp v4, v4, v4 quad_perm:[1,0,3,2] row_mask:0xf bank_mask:0xf
    s_nop 1
    v_max_u32_dpp v4, v4, v4 quad_perm:[2,3,0,1] row_mask:0xf bank_mask:0xf
    s_nop 1
    v_max_u32_dpp v4, v4, v4 row_half_mirror row_mask:0xf bank_mask:0xf
    s_nop 1
    v_max_u32_dpp v4, v4, v4 row_mirror row_mask:0xf bank_mask:0xf
    v_mov_b32 v5, v4
    s_nop 1
    v_permlane16_swap_b32 v4, v5
    v_max_u32 v4, v4, v5
    v_mov_b32 v5, v4
    s_nop 1
    v_permlane32_swap_b32 v4, v5
    v_max_u32 v4, v4, v5
    v_mov_b32 v59, v4
    v_cmp_eq_u32 vcc, v4, v16
    s_nop 1
    v_cndmask_b32 v16, v16, 0, vcc
    v_cmp_eq_u32 vcc, v4, v17
    s_nop 1
    v_cndmask_b32 v17, v17, 0, vcc
    v_cmp_eq_u32 vcc, v4, v18
    s_nop 1
    v_cndmask_b32 v18, v18, 0, vcc
    v_cmp_eq_u32 vcc, v4, v19
    s_nop 1
    v_cndmask_b32 v19, v19, 0, vcc
    v_cmp_eq_u32 vcc, v4, v20
    s_nop 1
    v_cndmask_b32 v20, v20, 0, vcc
    v_cmp_eq_u32 vcc, v4, v21
    s_nop 1
    v_cndmask_b32 v21, v21, 0, vcc
    v_cmp_eq_u32 vcc, v4, v22
    s_nop 1
    v_cndmask_b32 v22, v22, 0, vcc
    v_cmp_eq_u32 vcc, v4, v23
    s_nop 1
    v_cndmask_b32 v23, v23, 0, vcc
    v_cmp_eq_u32 vcc, v4, v24
    s_nop 1
    v_cndmask_b32 v24, v24, 0, vcc
    v_cmp_eq_u32 vcc, v4, v25
    s_nop 1
    v_cndmask_b32 v25, v25, 0, vcc
    v_cmp_eq_u32 vcc, v4, v26
    s_nop 1
    v_cndmask_b32 v26, v26, 0, vcc
    v_cmp_eq_u32 vcc, v4, v27
    s_nop 1
    v_cndmask_b32 v27, v27, 0, vcc
    v_cmp_eq_u32 vcc, v4, v28
    s_nop 1
    v_cndmask_b32 v28, v28, 0, vcc
    v_cmp_eq_u32 vcc, v4, v29
    s_nop 1
    v_cndmask_b32 v29, v29, 0, vcc
    v_cmp_eq_u32 vcc, v4, v30
    s_nop 1
    v_cndmask_b32 v30, v30, 0, vcc
    v_cmp_eq_u32 vcc, v4, v31
    s_nop 1
    v_cndmask_b32 v31, v31, 0, vcc
    v_cmp_eq_u32 vcc, v4, v32
    s_nop 1
    v_cndmask_b32 v32, v32, 0, vcc
    v_cmp_eq_u32 vcc, v4, v33
    s_nop 1
    v_cndmask_b32 v33, v33, 0, vcc
    v_cmp_eq_u32 vcc, v4, v34
    s_nop 1
    v_cndmask_b32 v34, v34, 0, vcc
    v_cmp_eq_u32 vcc, v4, v35
    s_nop 1
    v_cndmask_b32 v35, v35, 0, vcc
    v_cmp_eq_u32 vcc, v4, v36
    s_nop 1
    v_cndmask_b32 v36, v36, 0, vcc
    v_cmp_eq_u32 vcc, v4, v37
    s_nop 1
    v_cndmask_b32 v37, v37, 0, vcc
    v_cmp_eq_u32 vcc, v4, v38
    s_nop 1
    v_cndmask_b32 v38, v38, 0, vcc
    v_cmp_eq_u32 vcc, v4, v39
    s_nop 1
    v_cndmask_b32 v39, v39, 0, vcc
    v_cmp_eq_u32 vcc, v4, v40
    s_nop 1
    v_cndmask_b32 v40, v40, 0, vcc
    v_cmp_eq_u32 vcc, v4, v41
    s_nop 1
    v_cndmask_b32 v41, v41, 0, vcc
    v_cmp_eq_u32 vcc, v4, v42
    s_nop 1
    v_cndmask_b32 v42, v42, 0, vcc
    v_cmp_eq_u32 vcc, v4, v43
    s_nop 1
    v_cndmask_b32 v43, v43, 0, vcc
    v_cmp_eq_u32 vcc, v4, v44
    s_nop 1
    v_cndmask_b32 v44, v44, 0, vcc
    v_cmp_eq_u32 vcc, v4, v45
    s_nop 1
    v_cndmask_b32 v45, v45, 0, vcc
    v_cmp_eq_u32 vcc, v4, v46
    s_nop 1
    v_cndmask_b32 v46, v46, 0, vcc
    v_cmp_eq_u32 vcc, v4, v47
    s_nop 1
    v_cndmask_b32 v47, v47, 0, vcc
    v_max3_u32 v4, v16, v17, v18
    v_max3_u32 v4, v4, v19, v20
    v_max3_u32 v4, v4, v21, v22
    v_max3_u32 v4, v4, v23, v24
    v_max3_u32 v4, v4, v25, v26
    v_max3_u32 v4, v4, v27, v28
    v_max3_u32 v4, v4, v29, v30
    v_max3_u32 v4, v4, v31, v32
    v_max3_u32 v4, v4, v33, v34
    v_max3_u32 v4, v4, v35, v36
    v_max3_u32 v4, v4, v37, v38
    v_max3_u32 v4, v4, v39, v40
    v_max3_u32 v4, v4, v41, v42
    v_max3_u32 v4, v4, v43, v44
    v_max3_u32 v4, v4, v45, v46
    v_max_u32 v4, v4, v47
    s_nop 1
    v_max_u32_dpp v4, v4, v4 quad_perm:[1,0,3,2] row_mask:0xf bank_mask:0xf
    s_nop 1
    v_max_u32_dpp v4, v4, v4 quad_perm:[2,3,0,1] row_mask:0xf bank_mask:0xf
    s_nop 1
    v_max_u32_dpp v4, v4, v4 row_half_mirror row_mask:0xf bank_mask:0xf
    s_nop 1
    v_max_u32_dpp v4, v4, v4 row_mirror row_mask:0xf bank_mask:0xf
    v_mov_b32 v5, v4
    s_nop 1
    v_permlane16_swap_b32 v4, v5
    v_max_u32 v4, v4, v5
    v_mov_b32 v5, v4
    s_nop 1
    v_permlane32_swap_b32 v4, v5
    v_max_u32 v4, v4, v5
    v_mov_b32 v60, v4
    v_cmp_eq_u32 vcc, v4, v16
    s_nop 1
    v_cndmask_b32 v16, v16, 0, vcc
    v_cmp_eq_u32 vcc, v4, v17
    s_nop 1
    v_cndmask_b32 v17, v17, 0, vcc
    v_cmp_eq_u32 vcc, v4, v18
    s_nop 1
    v_cndmask_b32 v18, v18, 0, vcc
    v_cmp_eq_u32 vcc, v4, v19
    s_nop 1
    v_cndmask_b32 v19, v19, 0, vcc
    v_cmp_eq_u32 vcc, v4, v20
    s_nop 1
    v_cndmask_b32 v20, v20, 0, vcc
    v_cmp_eq_u32 vcc, v4, v21
    s_nop 1
    v_cndmask_b32 v21, v21, 0, vcc
    v_cmp_eq_u32 vcc, v4, v22
    s_nop 1
    v_cndmask_b32 v22, v22, 0, vcc
    v_cmp_eq_u32 vcc, v4, v23
    s_nop 1
    v_cndmask_b32 v23, v23, 0, vcc
    v_cmp_eq_u32 vcc, v4, v24
    s_nop 1
    v_cndmask_b32 v24, v24, 0, vcc
    v_cmp_eq_u32 vcc, v4, v25
    s_nop 1
    v_cndmask_b32 v25, v25, 0, vcc
    v_cmp_eq_u32 vcc, v4, v26
    s_nop 1
    v_cndmask_b32 v26, v26, 0, vcc
    v_cmp_eq_u32 vcc, v4, v27
    s_nop 1
    v_cndmask_b32 v27, v27, 0, vcc
    v_cmp_eq_u32 vcc, v4, v28
    s_nop 1
    v_cndmask_b32 v28, v28, 0, vcc
    v_cmp_eq_u32 vcc, v4, v29
    s_nop 1
    v_cndmask_b32 v29, v29, 0, vcc
    v_cmp_eq_u32 vcc, v4, v30
    s_nop 1
    v_cndmask_b32 v30, v30, 0, vcc
    v_cmp_eq_u32 vcc, v4, v31
    s_nop 1
    v_cndmask_b32 v31, v31, 0, vcc
    v_cmp_eq_u32 vcc, v4, v32
    s_nop 1
    v_cndmask_b32 v32, v32, 0, vcc
    v_cmp_eq_u32 vcc, v4, v33
    s_nop 1
    v_cndmask_b32 v33, v33, 0, vcc
    v_cmp_eq_u32 vcc, v4, v34
    s_nop 1
    v_cndmask_b32 v34, v34, 0, vcc
    v_cmp_eq_u32 vcc, v4, v35
    s_nop 1
    v_cndmask_b32 v35, v35, 0, vcc
    v_cmp_eq_u32 vcc, v4, v36
    s_nop 1
    v_cndmask_b32 v36, v36, 0, vcc
    v_cmp_eq_u32 vcc, v4, v37
    s_nop 1
    v_cndmask_b32 v37, v37, 0, vcc
    v_cmp_eq_u32 vcc, v4, v38
    s_nop 1
    v_cndmask_b32 v38, v38, 0, vcc
    v_cmp_eq_u32 vcc, v4, v39
    s_nop 1
    v_cndmask_b32 v39, v39, 0, vcc
    v_cmp_eq_u32 vcc, v4, v40
    s_nop 1
    v_cndmask_b32 v40, v40, 0, vcc
    v_cmp_eq_u32 vcc, v4, v41
    s_nop 1
    v_cndmask_b32 v41, v41, 0, vcc
    v_cmp_eq_u32 vcc, v4, v42
    s_nop 1
    v_cndmask_b32 v42, v42, 0, vcc
    v_cmp_eq_u32 vcc, v4, v43
    s_nop 1
    v_cndmask_b32 v43, v43, 0, vcc
    v_cmp_eq_u32 vcc, v4, v44
    s_nop 1
    v_cndmask_b32 v44, v44, 0, vcc
    v_cmp_eq_u32 vcc, v4, v45
    s_nop 1
    v_cndmask_b32 v45, v45, 0, vcc
    v_cmp_eq_u32 vcc, v4, v46
    s_nop 1
    v_cndmask_b32 v46, v46, 0, vcc
    v_cmp_eq_u32 vcc, v4, v47
    s_nop 1
    v_cndmask_b32 v47, v47, 0, vcc
    v_max3_u32 v4, v16, v17, v18
    v_max3_u32 v4, v4, v19, v20
    v_max3_u32 v4, v4, v21, v22
    v_max3_u32 v4, v4, v23, v24
    v_max3_u32 v4, v4, v25, v26
    v_max3_u32 v4, v4, v27, v28
    v_max3_u32 v4, v4, v29, v30
    v_max3_u32 v4, v4, v31, v32
    v_max3_u32 v4, v4, v33, v34
    v_max3_u32 v4, v4, v35, v36
    v_max3_u32 v4, v4, v37, v38
    v_max3_u32 v4, v4, v39, v40
    v_max3_u32 v4, v4, v41, v42
    v_max3_u32 v4, v4, v43, v44
    v_max3_u32 v4, v4, v45, v46
    v_max_u32 v4, v4, v47
    s_nop 1
    v_max_u32_dpp v4, v4, v4 quad_perm:[1,0,3,2] row_mask:0xf bank_mask:0xf
    s_nop 1
    v_max_u32_dpp v4, v4, v4 quad_perm:[2,3,0,1] row_mask:0xf bank_mask:0xf
    s_nop 1
    v_max_u32_dpp v4, v4, v4 row_half_mirror row_mask:0xf bank_mask:0xf
    s_nop 1
    v_max_u32_dpp v4, v4, v4 row_mirror row_mask:0xf bank_mask:0xf
    v_mov_b32 v5, v4
    s_nop 1
    v_permlane16_swap_b32 v4, v5
    v_max_u32 v4, v4, v5
    v_mov_b32 v5, v4
    s_nop 1
    v_permlane32_swap_b32 v4, v5
    v_max_u32 v4, v4, v5
    v_mov_b32 v61, v4
    v_cmp_eq_u32 vcc, v4, v16
    s_nop 1
    v_cndmask_b32 v16, v16, 0, vcc
    v_cmp_eq_u32 vcc, v4, v17
    s_nop 1
    v_cndmask_b32 v17, v17, 0, vcc
    v_cmp_eq_u32 vcc, v4, v18
    s_nop 1
    v_cndmask_b32 v18, v18, 0, vcc
    v_cmp_eq_u32 vcc, v4, v19
    s_nop 1
    v_cndmask_b32 v19, v19, 0, vcc
    v_cmp_eq_u32 vcc, v4, v20
    s_nop 1
    v_cndmask_b32 v20, v20, 0, vcc
    v_cmp_eq_u32 vcc, v4, v21
    s_nop 1
    v_cndmask_b32 v21, v21, 0, vcc
    v_cmp_eq_u32 vcc, v4, v22
    s_nop 1
    v_cndmask_b32 v22, v22, 0, vcc
    v_cmp_eq_u32 vcc, v4, v23
    s_nop 1
    v_cndmask_b32 v23, v23, 0, vcc
    v_cmp_eq_u32 vcc, v4, v24
    s_nop 1
    v_cndmask_b32 v24, v24, 0, vcc
    v_cmp_eq_u32 vcc, v4, v25
    s_nop 1
    v_cndmask_b32 v25, v25, 0, vcc
    v_cmp_eq_u32 vcc, v4, v26
    s_nop 1
    v_cndmask_b32 v26, v26, 0, vcc
    v_cmp_eq_u32 vcc, v4, v27
    s_nop 1
    v_cndmask_b32 v27, v27, 0, vcc
    v_cmp_eq_u32 vcc, v4, v28
    s_nop 1
    v_cndmask_b32 v28, v28, 0, vcc
    v_cmp_eq_u32 vcc, v4, v29
    s_nop 1
    v_cndmask_b32 v29, v29, 0, vcc
    v_cmp_eq_u32 vcc, v4, v30
    s_nop 1
    v_cndmask_b32 v30, v30, 0, vcc
    v_cmp_eq_u32 vcc, v4, v31
    s_nop 1
    v_cndmask_b32 v31, v31, 0, vcc
    v_cmp_eq_u32 vcc, v4, v32
    s_nop 1
    v_cndmask_b32 v32, v32, 0, vcc
    v_cmp_eq_u32 vcc, v4, v33
    s_nop 1
    v_cndmask_b32 v33, v33, 0, vcc
    v_cmp_eq_u32 vcc, v4, v34
    s_nop 1
    v_cndmask_b32 v34, v34, 0, vcc
    v_cmp_eq_u32 vcc, v4, v35
    s_nop 1
    v_cndmask_b32 v35, v35, 0, vcc
    v_cmp_eq_u32 vcc, v4, v36
    s_nop 1
    v_cndmask_b32 v36, v36, 0, vcc
    v_cmp_eq_u32 vcc, v4, v37
    s_nop 1
    v_cndmask_b32 v37, v37, 0, vcc
    v_cmp_eq_u32 vcc, v4, v38
    s_nop 1
    v_cndmask_b32 v38, v38, 0, vcc
    v_cmp_eq_u32 vcc, v4, v39
    s_nop 1
    v_cndmask_b32 v39, v39, 0, vcc
    v_cmp_eq_u32 vcc, v4, v40
    s_nop 1
    v_cndmask_b32 v40, v40, 0, vcc
    v_cmp_eq_u32 vcc, v4, v41
    s_nop 1
    v_cndmask_b32 v41, v41, 0, vcc
    v_cmp_eq_u32 vcc, v4, v42
    s_nop 1
    v_cndmask_b32 v42, v42, 0, vcc
    v_cmp_eq_u32 vcc, v4, v43
    s_nop 1
    v_cndmask_b32 v43, v43, 0, vcc
    v_cmp_eq_u32 vcc, v4, v44
    s_nop 1
    v_cndmask_b32 v44, v44, 0, vcc
    v_cmp_eq_u32 vcc, v4, v45
    s_nop 1
    v_cndmask_b32 v45, v45, 0, vcc
    v_cmp_eq_u32 vcc, v4, v46
    s_nop 1
    v_cndmask_b32 v46, v46, 0, vcc
    v_cmp_eq_u32 vcc, v4, v47
    s_nop 1
    v_cndmask_b32 v47, v47, 0, vcc
    v_max3_u32 v4, v16, v17, v18
    v_max3_u32 v4, v4, v19, v20
    v_max3_u32 v4, v4, v21, v22
    v_max3_u32 v4, v4, v23, v24
    v_max3_u32 v4, v4, v25, v26
    v_max3_u32 v4, v4, v27, v28
    v_max3_u32 v4, v4, v29, v30
    v_max3_u32 v4, v4, v31, v32
    v_max3_u32 v4, v4, v33, v34
    v_max3_u32 v4, v4, v35, v36
    v_max3_u32 v4, v4, v37, v38
    v_max3_u32 v4, v4, v39, v40
    v_max3_u32 v4, v4, v41, v42
    v_max3_u32 v4, v4, v43, v44
    v_max3_u32 v4, v4, v45, v46
    v_max_u32 v4, v4, v47
    s_nop 1
    v_max_u32_dpp v4, v4, v4 quad_perm:[1,0,3,2] row_mask:0xf bank_mask:0xf
    s_nop 1
    v_max_u32_dpp v4, v4, v4 quad_perm:[2,3,0,1] row_mask:0xf bank_mask:0xf
    s_nop 1
    v_max_u32_dpp v4, v4, v4 row_half_mirror row_mask:0xf bank_mask:0xf
    s_nop 1
    v_max_u32_dpp v4, v4, v4 row_mirror row_mask:0xf bank_mask:0xf
    v_mov_b32 v5, v4
    s_nop 1
    v_permlane16_swap_b32 v4, v5
    v_max_u32 v4, v4, v5
    v_mov_b32 v5, v4
    s_nop 1
    v_permlane32_swap_b32 v4, v5
    v_max_u32 v4, v4, v5
    v_mov_b32 v62, v4
    v_cmp_eq_u32 vcc, v4, v16
    s_nop 1
    v_cndmask_b32 v16, v16, 0, vcc
    v_cmp_eq_u32 vcc, v4, v17
    s_nop 1
    v_cndmask_b32 v17, v17, 0, vcc
    v_cmp_eq_u32 vcc, v4, v18
    s_nop 1
    v_cndmask_b32 v18, v18, 0, vcc
    v_cmp_eq_u32 vcc, v4, v19
    s_nop 1
    v_cndmask_b32 v19, v19, 0, vcc
    v_cmp_eq_u32 vcc, v4, v20
    s_nop 1
    v_cndmask_b32 v20, v20, 0, vcc
    v_cmp_eq_u32 vcc, v4, v21
    s_nop 1
    v_cndmask_b32 v21, v21, 0, vcc
    v_cmp_eq_u32 vcc, v4, v22
    s_nop 1
    v_cndmask_b32 v22, v22, 0, vcc
    v_cmp_eq_u32 vcc, v4, v23
    s_nop 1
    v_cndmask_b32 v23, v23, 0, vcc
    v_cmp_eq_u32 vcc, v4, v24
    s_nop 1
    v_cndmask_b32 v24, v24, 0, vcc
    v_cmp_eq_u32 vcc, v4, v25
    s_nop 1
    v_cndmask_b32 v25, v25, 0, vcc
    v_cmp_eq_u32 vcc, v4, v26
    s_nop 1
    v_cndmask_b32 v26, v26, 0, vcc
    v_cmp_eq_u32 vcc, v4, v27
    s_nop 1
    v_cndmask_b32 v27, v27, 0, vcc
    v_cmp_eq_u32 vcc, v4, v28
    s_nop 1
    v_cndmask_b32 v28, v28, 0, vcc
    v_cmp_eq_u32 vcc, v4, v29
    s_nop 1
    v_cndmask_b32 v29, v29, 0, vcc
    v_cmp_eq_u32 vcc, v4, v30
    s_nop 1
    v_cndmask_b32 v30, v30, 0, vcc
    v_cmp_eq_u32 vcc, v4, v31
    s_nop 1
    v_cndmask_b32 v31, v31, 0, vcc
    v_cmp_eq_u32 vcc, v4, v32
    s_nop 1
    v_cndmask_b32 v32, v32, 0, vcc
    v_cmp_eq_u32 vcc, v4, v33
    s_nop 1
    v_cndmask_b32 v33, v33, 0, vcc
    v_cmp_eq_u32 vcc, v4, v34
    s_nop 1
    v_cndmask_b32 v34, v34, 0, vcc
    v_cmp_eq_u32 vcc, v4, v35
    s_nop 1
    v_cndmask_b32 v35, v35, 0, vcc
    v_cmp_eq_u32 vcc, v4, v36
    s_nop 1
    v_cndmask_b32 v36, v36, 0, vcc
    v_cmp_eq_u32 vcc, v4, v37
    s_nop 1
    v_cndmask_b32 v37, v37, 0, vcc
    v_cmp_eq_u32 vcc, v4, v38
    s_nop 1
    v_cndmask_b32 v38, v38, 0, vcc
    v_cmp_eq_u32 vcc, v4, v39
    s_nop 1
    v_cndmask_b32 v39, v39, 0, vcc
    v_cmp_eq_u32 vcc, v4, v40
    s_nop 1
    v_cndmask_b32 v40, v40, 0, vcc
    v_cmp_eq_u32 vcc, v4, v41
    s_nop 1
    v_cndmask_b32 v41, v41, 0, vcc
    v_cmp_eq_u32 vcc, v4, v42
    s_nop 1
    v_cndmask_b32 v42, v42, 0, vcc
    v_cmp_eq_u32 vcc, v4, v43
    s_nop 1
    v_cndmask_b32 v43, v43, 0, vcc
    v_cmp_eq_u32 vcc, v4, v44
    s_nop 1
    v_cndmask_b32 v44, v44, 0, vcc
    v_cmp_eq_u32 vcc, v4, v45
    s_nop 1
    v_cndmask_b32 v45, v45, 0, vcc
    v_cmp_eq_u32 vcc, v4, v46
    s_nop 1
    v_cndmask_b32 v46, v46, 0, vcc
    v_cmp_eq_u32 vcc, v4, v47
    s_nop 1
    v_cndmask_b32 v47, v47, 0, vcc
    v_max3_u32 v4, v16, v17, v18
    v_max3_u32 v4, v4, v19, v20
    v_max3_u32 v4, v4, v21, v22
    v_max3_u32 v4, v4, v23, v24
    v_max3_u32 v4, v4, v25, v26
    v_max3_u32 v4, v4, v27, v28
    v_max3_u32 v4, v4, v29, v30
    v_max3_u32 v4, v4, v31, v32
    v_max3_u32 v4, v4, v33, v34
    v_max3_u32 v4, v4, v35, v36
    v_max3_u32 v4, v4, v37, v38
    v_max3_u32 v4, v4, v39, v40
    v_max3_u32 v4, v4, v41, v42
    v_max3_u32 v4, v4, v43, v44
    v_max3_u32 v4, v4, v45, v46
    v_max_u32 v4, v4, v47
    s_nop 1
    v_max_u32_dpp v4, v4, v4 quad_perm:[1,0,3,2] row_mask:0xf bank_mask:0xf
    s_nop 1
    v_max_u32_dpp v4, v4, v4 quad_perm:[2,3,0,1] row_mask:0xf bank_mask:0xf
    s_nop 1
    v_max_u32_dpp v4, v4, v4 row_half_mirror row_mask:0xf bank_mask:0xf
    s_nop 1
    v_max_u32_dpp v4, v4, v4 row_mirror row_mask:0xf bank_mask:0xf
    v_mov_b32 v5, v4
    s_nop 1
    v_permlane16_swap_b32 v4, v5
    v_max_u32 v4, v4, v5
    v_mov_b32 v5, v4
    s_nop 1
    v_permlane32_swap_b32 v4, v5
    v_max_u32 v4, v4, v5
    v_mov_b32 v63, v4
    v_mov_b32 v4, v56
    v_cmp_eq_u32 vcc, 1, v0
    s_nop 1
    v_cndmask_b32 v4, v4, v57, vcc
    v_cmp_eq_u32 vcc, 2, v0
    s_nop 1
    v_cndmask_b32 v4, v4, v58, vcc
    v_cmp_eq_u32 vcc, 3, v0
    s_nop 1
    v_cndmask_b32 v4, v4, v59, vcc
    v_cmp_eq_u32 vcc, 4, v0
    s_nop 1
    v_cndmask_b32 v4, v4, v60, vcc
    v_cmp_eq_u32 vcc, 5, v0
    s_nop 1
    v_cndmask_b32 v4, v4, v61, vcc
    v_cmp_eq_u32 vcc, 6, v0
    s_nop 1
    v_cndmask_b32 v4, v4, v62, vcc
    v_cmp_eq_u32 vcc, 7, v0
    s_nop 1
    v_cndmask_b32 v4, v4, v63, vcc
    v_and_b32 v5, 0xffff, v4
    v_sub_u32 v5, 0xffff, v5
    v_and_b32 v4, 0xffff0000, v4
    v_ashrrev_i32 v3, 31, v4
    v_not_b32 v3, v3
    v_or_b32 v3, 0x80000000, v3
    v_xor_b32 v4, v4, v3
    v_and_b32 v4, 0xffff0000, v4
    v_mul_f32 v4, 0xbfb8aa3b, v4
    v_exp_f32 v4, v4
    s_nop 0
    v_add_f32 v4, 1.0, v4
    v_rcp_f32 v4, v4
    s_nop 0
    v_cvt_pk_bf16_f32 v4, v4, v4
    v_lshlrev_b32 v4, 16, v4
    v_lshlrev_b32 v6, 2, v0
    s_mov_b32 s64, 0x5400000
    s_mov_b64 exec, 0xff
    buffer_store_dword v5, v6, s[4:7], s64 offen sc1
    buffer_store_dword v4, v6, s[4:7], s64 offen offset:32 sc1
    s_mov_b64 exec, -1
    s_waitcnt vmcnt(0)
    v_mov_b32 v7, 1
    v_mov_b32 v8, 0
    s_mov_b32 s64, 0x298000
    s_mov_b64 exec, 1
    buffer_atomic_add v7, v8, s[4:7], s64 offen sc1
    s_mov_b64 exec, -1
    v_mbcnt_lo_u32_b32 v0, -1, 0
    v_mbcnt_hi_u32_b32 v0, -1, v0
NOSEL_114:
    v_lshlrev_b32 v1, 4, v0
    v_lshrrev_b32 v6, 3, v0
    v_mul_u32_u24 v2, 1280, v6
    v_and_b32 v7, 7, v0
    v_xor_b32 v7, v7, v6
    v_lshl_add_u32 v2, v7, 4, v2
    v_bfe_u32 v6, v0, 3, 1
    v_lshlrev_b32 v9, 10, v6
    v_and_b32 v6, 7, v0
    v_lshl_add_u32 v9, v6, 7, v9
    v_lshrrev_b32 v7, 4, v0
    v_xor_b32 v7, v7, v6
    v_lshl_add_u32 v3, v7, 4, v9
    v_xor_b32 v7, 4, v7
    v_lshl_add_u32 v4, v7, 4, v9
    v_add_u32 v6, 0x10000, v3
    v_add_u32 v9, 0x10000, v4
    s_barrier
    s_mul_i32 s20, s12, 163840
    s_mul_i32 s64, s14, 40960
    s_add_u32 s20, s20, s64
    s_add_u32 s20, s20, 0x0
    s_lshl_b32 s21, s14, 12
    s_add_u32 m0, s21, 0
    s_add_u32 s64, s20, 0x0
    buffer_load_dwordx4 v2, s[4:7], s64 offen lds
    s_add_u32 m0, s21, 1024
    s_add_u32 s64, s20, 0x2800
    buffer_load_dwordx4 v2, s[4:7], s64 offen lds
    s_add_u32 m0, s21, 2048
    s_add_u32 s64, s20, 0x5000
    buffer_load_dwordx4 v2, s[4:7], s64 offen lds
    s_add_u32 m0, s21, 3072
    s_add_u32 s64, s20, 0x7800
    buffer_load_dwordx4 v2, s[4:7], s64 offen lds
    s_add_u32 m0, s21, 16384
    s_add_u32 s64, s20, 0x80
    buffer_load_dwordx4 v2, s[4:7], s64 offen lds
    s_add_u32 m0, s21, 17408
    s_add_u32 s64, s20, 0x2880
    buffer_load_dwordx4 v2, s[4:7], s64 offen lds
    s_add_u32 m0, s21, 18432
    s_add_u32 s64, s20, 0x5080
    buffer_load_dwordx4 v2, s[4:7], s64 offen lds
    s_add_u32 m0, s21, 19456
    s_add_u32 s64, s20, 0x7880
    buffer_load_dwordx4 v2, s[4:7], s64 offen lds
    s_add_u32 m0, s21, 32768
    s_add_u32 s64, s20, 0x100
    buffer_load_dwordx4 v2, s[4:7], s64 offen lds
    s_add_u32 m0, s21, 33792
    s_add_u32 s64, s20, 0x2900
    buffer_load_dwordx4 v2, s[4:7], s64 offen lds
    s_add_u32 m0, s21, 34816
    s_add_u32 s64, s20, 0x5100
    buffer_load_dwordx4 v2, s[4:7], s64 offen lds
    s_add_u32 m0, s21, 35840
    s_add_u32 s64, s20, 0x7900
    buffer_load_dwordx4 v2, s[4:7], s64 offen lds
    s_add_u32 m0, s21, 49152
    s_add_u32 s64, s20, 0x180
    buffer_load_dwordx4 v2, s[4:7], s64 offen lds
    s_add_u32 m0, s21, 50176
    s_add_u32 s64, s20, 0x2980
    buffer_load_dwordx4 v2, s[4:7], s64 offen lds
    s_add_u32 m0, s21, 51200
    s_add_u32 s64, s20, 0x5180
    buffer_load_dwordx4 v2, s[4:7], s64 offen lds
    s_add_u32 m0, s21, 52224
    s_add_u32 s64, s20, 0x7980
    buffer_load_dwordx4 v2, s[4:7], s64 offen lds
    s_mov_b32 s64, 0x40000000
    buffer_store_dword v7, v1, s[4:7], s64 offen
    buffer_store_dword v7, v1, s[4:7], s64 offen
    buffer_store_dword v7, v1, s[4:7], s64 offen
    buffer_store_dword v7, v1, s[4:7], s64 offen
    buffer_store_dword v7, v1, s[4:7], s64 offen
    buffer_store_dword v7, v1, s[4:7], s64 offen
    buffer_store_dword v7, v1, s[4:7], s64 offen
    buffer_store_dword v7, v1, s[4:7], s64 offen
    s_waitcnt vmcnt(20)
    s_barrier
    ds_read_b128 a[0:3], v3 offset:0
    ds_read_b128 a[4:7], v3 offset:2048
    ds_read_b128 a[8:11], v3 offset:4096
    ds_read_b128 a[12:15], v3 offset:6144
    ds_read_b128 a[16:19], v3 offset:8192
    ds_read_b128 a[20:23], v3 offset:10240
    ds_read_b128 a[24:27], v3 offset:12288
    ds_read_b128 a[28:31], v3 offset:14336
    s_mov_b32 s19, 0
    s_mov_b32 s22, s16
    s_mov_b32 s23, 0x40000000
G_T_LOOP:
    s_waitcnt lgkmcnt(4)
    v_mfma_f32_16x16x32_bf16 v[16:19], v[96:99], a[0:3], 0
    v_mfma_f32_16x16x32_bf16 v[20:23], v[100:103], a[0:3], 0
    ds_read_b128 a[32:35], v4 offset:0
    v_mfma_f32_16x16x32_bf16 v[24:27], v[96:99], a[4:7], 0
    v_mfma_f32_16x16x32_bf16 v[28:31], v[100:103], a[4:7], 0
    ds_read_b128 a[36:39], v4 offset:2048
    v_mfma_f32_16x16x32_bf16 v[32:35], v[96:99], a[8:11], 0
    v_mfma_f32_16x16x32_bf16 v[36:39], v[100:103], a[8:11], 0
    ds_read_b128 a[40:43], v4 offset:4096
    v_mfma_f32_16x16x32_bf16 v[40:43], v[96:99], a[12:15], 0
    v_mfma_f32_16x16x32_bf16 v[44:47], v[100:103], a[12:15], 0
    ds_read_b128 a[44:47], v4 offset:6144
    s_waitcnt lgkmcnt(4)
    v_mfma_f32_16x16x32_bf16 v[48:51], v[96:99], a[16:19], 0
    v_mfma_f32_16x16x32_bf16 v[52:55], v[100:103], a[16:19], 0
    ds_read_b128 a[48:51], v4 offset:8192
    v_mfma_f32_16x16x32_bf16 v[56:59], v[96:99], a[20:23], 0
    v_mfma_f32_16x16x32_bf16 v[60:63], v[100:103], a[20:23], 0
    ds_read_b128 a[52:55], v4 offset:10240
    v_mfma_f32_16x16x32_bf16 v[64:67], v[96:99], a[24:27], 0
    v_mfma_f32_16x16x32_bf16 v[68:71], v[100:103], a[24:27], 0
    ds_read_b128 a[56:59], v4 offset:12288
    v_mfma_f32_16x16x32_bf16 v[72:75], v[96:99], a[28:31], 0
    v_mfma_f32_16x16x32_bf16 v[76:79], v[100:103], a[28:31], 0
    ds_read_b128 a[60:63], v4 offset:14336
    s_waitcnt vmcnt(16)
    s_barrier
    s_waitcnt lgkmcnt(4)
    v_mfma_f32_16x16x32_bf16 v[16:19], v[104:107], a[32:35], v[16:19]
    v_mfma_f32_16x16x32_bf16 v[20:23], v[108:111], a[32:35], v[20:23]
    ds_read_b128 a[0:3], v3 offset:16384
    s_add_u32 m0, s21, 65536
    v_mfma_f32_16x16x32_bf16 v[24:27], v[104:107], a[36:39], v[24:27]
    v_mfma_f32_16x16x32_bf16 v[28:31], v[108:111], a[36:39], v[28:31]
    ds_read_b128 a[4:7], v3 offset:18432
    s_add_u32 s64, s20, 0x200
    buffer_load_dwordx4 v2, s[4:7], s64 offen lds
    v_mfma_f32_16x16x32_bf16 v[32:35], v[104:107], a[40:43], v[32:35]
    v_mfma_f32_16x16x32_bf16 v[36:39], v[108:111], a[40:43], v[36:39]
    ds_read_b128 a[8:11], v3 offset:20480
    s_add_u32 m0, s21, 66560
    v_mfma_f32_16x16x32_bf16 v[40:43], v[104:107], a[44:47], v[40:43]
    v_mfma_f32_16x16x32_bf16 v[44:47], v[108:111], a[44:47], v[44:47]
    ds_read_b128 a[12:15], v3 offset:22528
    s_add_u32 s64, s20, 0x2a00
    buffer_load_dwordx4 v2, s[4:7], s64 offen lds
    s_waitcnt lgkmcnt(4)
    v_mfma_f32_16x16x32_bf16 v[48:51], v[104:107], a[48:51], v[48:51]
    v_mfma_f32_16x16x32_bf16 v[52:55], v[108:111], a[48:51], v[52:55]
    ds_read_b128 a[16:19], v3 offset:24576
    s_add_u32 m0, s21, 67584
    v_mfma_f32_16x16x32_bf16 v[56:59], v[104:107], a[52:55], v[56:59]
    v_mfma_f32_16x16x32_bf16 v[60:63], v[108:111], a[52:55], v[60:63]
    ds_read_b128 a[20:23], v3 offset:26624
    s_add_u32 s64, s20, 0x5200
    buffer_load_dwordx4 v2, s[4:7], s64 offen lds
    v_mfma_f32_16x16x32_bf16 v[64:67], v[104:107], a[56:59], v[64:67]
    v_mfma_f32_16x16x32_bf16 v[68:71], v[108:111], a[56:59], v[68:71]
    ds_read_b128 a[24:27], v3 offset:28672
    s_add_u32 m0, s21, 68608
    v_mfma_f32_16x16x32_bf16 v[72:75], v[104:107], a[60:63], v[72:75]
    v_mfma_f32_16x16x32_bf16 v[76:79], v[108:111], a[60:63], v[76:79]
    ds_read_b128 a[28:31], v3 offset:30720
    s_add_u32 s64, s20, 0x7a00
    buffer_load_dwordx4 v2, s[4:7], s64 offen lds
    s_waitcnt lgkmcnt(4)
    v_mfma_f32_16x16x32_bf16 v[16:19], v[112:115], a[0:3], v[16:19]
    v_mfma_f32_16x16x32_bf16 v[20:23], v[116:119], a[0:3], v[20:23]
    ds_read_b128 a[32:35], v4 offset:16384
    v_mfma_f32_16x16x32_bf16 v[24:27], v[112:115], a[4:7], v[24:27]
    v_mfma_f32_16x16x32_bf16 v[28:31], v[116:119], a[4:7], v[28:31]
    ds_read_b128 a[36:39], v4 offset:18432
    v_mfma_f32_16x16x32_bf16 v[32:35], v[112:115], a[8:11], v[32:35]
    v_mfma_f32_16x16x32_bf16 v[36:39], v[116:119], a[8:11], v[36:39]
    ds_read_b128 a[40:43], v4 offset:20480
    v_mfma_f32_16x16x32_bf16 v[40:43], v[112:115], a[12:15], v[40:43]
    v_mfma_f32_16x16x32_bf16 v[44:47], v[116:119], a[12:15], v[44:47]
    ds_read_b128 a[44:47], v4 offset:22528
    s_waitcnt lgkmcnt(4)
    v_mfma_f32_16x16x32_bf16 v[48:51], v[112:115], a[16:19], v[48:51]
    v_mfma_f32_16x16x32_bf16 v[52:55], v[116:119], a[16:19], v[52:55]
    ds_read_b128 a[48:51], v4 offset:24576
    v_mfma_f32_16x16x32_bf16 v[56:59], v[112:115], a[20:23], v[56:59]
    v_mfma_f32_16x16x32_bf16 v[60:63], v[116:119], a[20:23], v[60:63]
    ds_read_b128 a[52:55], v4 offset:26624
    v_mfma_f32_16x16x32_bf16 v[64:67], v[112:115], a[24:27], v[64:67]
    v_mfma_f32_16x16x32_bf16 v[68:71], v[116:119], a[24:27], v[68:71]
    ds_read_b128 a[56:59], v4 offset:28672
    v_mfma_f32_16x16x32_bf16 v[72:75], v[112:115], a[28:31], v[72:75]
    v_mfma_f32_16x16x32_bf16 v[76:79], v[116:119], a[28:31], v[76:79]
    ds_read_b128 a[60:63], v4 offset:30720
    s_waitcnt vmcnt(16)
    s_barrier
    s_waitcnt lgkmcnt(4)
    v_mfma_f32_16x16x32_bf16 v[16:19], v[120:123], a[32:35], v[16:19]
    v_mfma_f32_16x16x32_bf16 v[20:23], v[124:127], a[32:35], v[20:23]
    ds_read_b128 a[0:3], v3 offset:32768
    s_add_u32 m0, s21, 0
    v_mfma_f32_16x16x32_bf16 v[24:27], v[120:123], a[36:39], v[24:27]
    v_mfma_f32_16x16x32_bf16 v[28:31], v[124:127], a[36:39], v[28:31]
    ds_read_b128 a[4:7], v3 offset:34816
    s_add_u32 s64, s20, 0x280
    buffer_load_dwordx4 v2, s[4:7], s64 offen lds
    v_mfma_f32_16x16x32_bf16 v[32:35], v[120:123], a[40:43], v[32:35]
    v_mfma_f32_16x16x32_bf16 v[36:39], v[124:127], a[40:43], v[36:39]
    ds_read_b128 a[8:11], v3 offset:36864
    s_add_u32 m0, s21, 1024
    v_mfma_f32_16x16x32_bf16 v[40:43], v[120:123], a[44:47], v[40:43]
    v_mfma_f32_16x16x32_bf16 v[44:47], v[124:127], a[44:47], v[44:47]
    ds_read_b128 a[12:15], v3 offset:38912
    s_add_u32 s64, s20, 0x2a80
    buffer_load_dwordx4 v2, s[4:7], s64 offen lds
    s_waitcnt lgkmcnt(4)
    v_mfma_f32_16x16x32_bf16 v[48:51], v[120:123], a[48:51], v[48:51]
    v_mfma_f32_16x16x32_bf16 v[52:55], v[124:127], a[48:51], v[52:55]
    ds_read_b128 a[16:19], v3 offset:40960
    s_add_u32 m0, s21, 2048
    v_mfma_f32_16x16x32_bf16 v[56:59], v[120:123], a[52:55], v[56:59]
    v_mfma_f32_16x16x32_bf16 v[60:63], v[124:127], a[52:55], v[60:63]
    ds_read_b128 a[20:23], v3 offset:43008
    s_add_u32 s64, s20, 0x5280
    buffer_load_dwordx4 v2, s[4:7], s64 offen lds
    v_mfma_f32_16x16x32_bf16 v[64:67], v[120:123], a[56:59], v[64:67]
    v_mfma_f32_16x16x32_bf16 v[68:71], v[124:127], a[56:59], v[68:71]
    ds_read_b128 a[24:27], v3 offset:45056
    s_add_u32 m0, s21, 3072
    v_mfma_f32_16x16x32_bf16 v[72:75], v[120:123], a[60:63], v[72:75]
    v_mfma_f32_16x16x32_bf16 v[76:79], v[124:127], a[60:63], v[76:79]
    ds_read_b128 a[28:31], v3 offset:47104
    s_add_u32 s64, s20, 0x7a80
    buffer_load_dwordx4 v2, s[4:7], s64 offen lds
    s_waitcnt lgkmcnt(4)
    v_mfma_f32_16x16x32_bf16 v[16:19], v[128:131], a[0:3], v[16:19]
    v_mfma_f32_16x16x32_bf16 v[20:23], v[132:135], a[0:3], v[20:23]
    ds_read_b128 a[32:35], v4 offset:32768
    v_mfma_f32_16x16x32_bf16 v[24:27], v[128:131], a[4:7], v[24:27]
    v_mfma_f32_16x16x32_bf16 v[28:31], v[132:135], a[4:7], v[28:31]
    ds_read_b128 a[36:39], v4 offset:34816
    v_mfma_f32_16x16x32_bf16 v[32:35], v[128:131], a[8:11], v[32:35]
    v_mfma_f32_16x16x32_bf16 v[36:39], v[132:135], a[8:11], v[36:39]
    ds_read_b128 a[40:43], v4 offset:36864
    v_mfma_f32_16x16x32_bf16 v[40:43], v[128:131], a[12:15], v[40:43]
    v_mfma_f32_16x16x32_bf16 v[44:47], v[132:135], a[12:15], v[44:47]
    ds_read_b128 a[44:47], v4 offset:38912
    s_waitcnt lgkmcnt(4)
    v_mfma_f32_16x16x32_bf16 v[48:51], v[128:131], a[16:19], v[48:51]
    v_mfma_f32_16x16x32_bf16 v[52:55], v[132:135], a[16:19], v[52:55]
    ds_read_b128 a[48:51], v4 offset:40960
    v_mfma_f32_16x16x32_bf16 v[56:59], v[128:131], a[20:23], v[56:59]
    v_mfma_f32_16x16x32_bf16 v[60:63], v[132:135], a[20:23], v[60:63]
    ds_read_b128 a[52:55], v4 offset:43008
    v_mfma_f32_16x16x32_bf16 v[64:67], v[128:131], a[24:27], v[64:67]
    v_mfma_f32_16x16x32_bf16 v[68:71], v[132:135], a[24:27], v[68:71]
    ds_read_b128 a[56:59], v4 offset:45056
    v_mfma_f32_16x16x32_bf16 v[72:75], v[128:131], a[28:31], v[72:75]
    v_mfma_f32_16x16x32_bf16 v[76:79], v[132:135], a[28:31], v[76:79]
    ds_read_b128 a[60:63], v4 offset:47104
    s_waitcnt vmcnt(16)
    s_barrier
    s_waitcnt lgkmcnt(4)
    v_mfma_f32_16x16x32_bf16 v[16:19], v[136:139], a[32:35], v[16:19]
    v_mfma_f32_16x16x32_bf16 v[20:23], v[140:143], a[32:35], v[20:23]
    ds_read_b128 a[0:3], v3 offset:49152
    s_add_u32 m0, s21, 16384
    v_mfma_f32_16x16x32_bf16 v[24:27], v[136:139], a[36:39], v[24:27]
    v_mfma_f32_16x16x32_bf16 v[28:31], v[140:143], a[36:39], v[28:31]
    ds_read_b128 a[4:7], v3 offset:51200
    s_add_u32 s64, s20, 0x300
    buffer_load_dwordx4 v2, s[4:7], s64 offen lds
    v_mfma_f32_16x16x32_bf16 v[32:35], v[136:139], a[40:43], v[32:35]
    v_mfma_f32_16x16x32_bf16 v[36:39], v[140:143], a[40:43], v[36:39]
    ds_read_b128 a[8:11], v3 offset:53248
    s_add_u32 m0, s21, 17408
    v_mfma_f32_16x16x32_bf16 v[40:43], v[136:139], a[44:47], v[40:43]
    v_mfma_f32_16x16x32_bf16 v[44:47], v[140:143], a[44:47], v[44:47]
    ds_read_b128 a[12:15], v3 offset:55296
    s_add_u32 s64, s20, 0x2b00
    buffer_load_dwordx4 v2, s[4:7], s64 offen lds
    s_waitcnt lgkmcnt(4)
    v_mfma_f32_16x16x32_bf16 v[48:51], v[136:139], a[48:51], v[48:51]
    v_mfma_f32_16x16x32_bf16 v[52:55], v[140:143], a[48:51], v[52:55]
    ds_read_b128 a[16:19], v3 offset:57344
    s_add_u32 m0, s21, 18432
    v_mfma_f32_16x16x32_bf16 v[56:59], v[136:139], a[52:55], v[56:59]
    v_mfma_f32_16x16x32_bf16 v[60:63], v[140:143], a[52:55], v[60:63]
    ds_read_b128 a[20:23], v3 offset:59392
    s_add_u32 s64, s20, 0x5300
    buffer_load_dwordx4 v2, s[4:7], s64 offen lds
    v_mfma_f32_16x16x32_bf16 v[64:67], v[136:139], a[56:59], v[64:67]
    v_mfma_f32_16x16x32_bf16 v[68:71], v[140:143], a[56:59], v[68:71]
    ds_read_b128 a[24:27], v3 offset:61440
    s_add_u32 m0, s21, 19456
    v_mfma_f32_16x16x32_bf16 v[72:75], v[136:139], a[60:63], v[72:75]
    v_mfma_f32_16x16x32_bf16 v[76:79], v[140:143], a[60:63], v[76:79]
    ds_read_b128 a[28:31], v3 offset:63488
    s_add_u32 s64, s20, 0x7b00
    buffer_load_dwordx4 v2, s[4:7], s64 offen lds
    s_waitcnt lgkmcnt(4)
    v_mfma_f32_16x16x32_bf16 v[16:19], v[144:147], a[0:3], v[16:19]
    v_mfma_f32_16x16x32_bf16 v[20:23], v[148:151], a[0:3], v[20:23]
    ds_read_b128 a[32:35], v4 offset:49152
    v_mfma_f32_16x16x32_bf16 v[24:27], v[144:147], a[4:7], v[24:27]
    v_mfma_f32_16x16x32_bf16 v[28:31], v[148:151], a[4:7], v[28:31]
    ds_read_b128 a[36:39], v4 offset:51200
    v_mfma_f32_16x16x32_bf16 v[32:35], v[144:147], a[8:11], v[32:35]
    v_mfma_f32_16x16x32_bf16 v[36:39], v[148:151], a[8:11], v[36:39]
    ds_read_b128 a[40:43], v4 offset:53248
    v_mfma_f32_16x16x32_bf16 v[40:43], v[144:147], a[12:15], v[40:43]
    v_mfma_f32_16x16x32_bf16 v[44:47], v[148:151], a[12:15], v[44:47]
    ds_read_b128 a[44:47], v4 offset:55296
    s_waitcnt lgkmcnt(4)
    v_mfma_f32_16x16x32_bf16 v[48:51], v[144:147], a[16:19], v[48:51]
    v_mfma_f32_16x16x32_bf16 v[52:55], v[148:151], a[16:19], v[52:55]
    ds_read_b128 a[48:51], v4 offset:57344
    v_mfma_f32_16x16x32_bf16 v[56:59], v[144:147], a[20:23], v[56:59]
    v_mfma_f32_16x16x32_bf16 v[60:63], v[148:151], a[20:23], v[60:63]
    ds_read_b128 a[52:55], v4 offset:59392
    v_mfma_f32_16x16x32_bf16 v[64:67], v[144:147], a[24:27], v[64:67]
    v_mfma_f32_16x16x32_bf16 v[68:71], v[148:151], a[24:27], v[68:71]
    ds_read_b128 a[56:59], v4 offset:61440
    v_mfma_f32_16x16x32_bf16 v[72:75], v[144:147], a[28:31], v[72:75]
    v_mfma_f32_16x16x32_bf16 v[76:79], v[148:151], a[28:31], v[76:79]
    ds_read_b128 a[60:63], v4 offset:63488
    s_waitcnt vmcnt(8)
    s_barrier
    s_cmp_lg_u32 s14, 0
    s_cbranch_scc1 GF_115
    v_mov_b32 v7, 1
    v_mov_b32 v8, 0
    s_mov_b64 exec, 1
    buffer_store_dword v7, v8, s[4:7], s23 offen sc1
    s_mov_b64 exec, -1
GF_115:
    s_waitcnt lgkmcnt(4)
    v_mfma_f32_16x16x32_bf16 v[16:19], v[152:155], a[32:35], v[16:19]
    v_mfma_f32_16x16x32_bf16 v[20:23], v[156:159], a[32:35], v[20:23]
    ds_read_b128 a[0:3], v6 offset:0
    s_add_u32 m0, s21, 32768
    v_mfma_f32_16x16x32_bf16 v[24:27], v[152:155], a[36:39], v[24:27]
    v_mfma_f32_16x16x32_bf16 v[28:31], v[156:159], a[36:39], v[28:31]
    ds_read_b128 a[4:7], v6 offset:2048
    s_add_u32 s64, s20, 0x380
    buffer_load_dwordx4 v2, s[4:7], s64 offen lds
    v_mfma_f32_16x16x32_bf16 v[32:35], v[152:155], a[40:43], v[32:35]
    v_mfma_f32_16x16x32_bf16 v[36:39], v[156:159], a[40:43], v[36:39]
    ds_read_b128 a[8:11], v6 offset:4096
    s_add_u32 m0, s21, 33792
    v_mfma_f32_16x16x32_bf16 v[40:43], v[152:155], a[44:47], v[40:43]
    v_mfma_f32_16x16x32_bf16 v[44:47], v[156:159], a[44:47], v[44:47]
    ds_read_b128 a[12:15], v6 offset:6144
    s_add_u32 s64, s20, 0x2b80
    buffer_load_dwordx4 v2, s[4:7], s64 offen lds
    s_waitcnt lgkmcnt(4)
    v_mfma_f32_16x16x32_bf16 v[48:51], v[152:155], a[48:51], v[48:51]
    v_mfma_f32_16x16x32_bf16 v[52:55], v[156:159], a[48:51], v[52:55]
    ds_read_b128 a[16:19], v6 offset:8192
    s_add_u32 m0, s21, 34816
    v_mfma_f32_16x16x32_bf16 v[56:59], v[152:155], a[52:55], v[56:59]
    v_mfma_f32_16x16x32_bf16 v[60:63], v[156:159], a[52:55], v[60:63]
    ds_read_b128 a[20:23], v6 offset:10240
    s_add_u32 s64, s20, 0x5380
    buffer_load_dwordx4 v2, s[4:7], s64 offen lds
    v_mfma_f32_16x16x32_bf16 v[64:67], v[152:155], a[56:59], v[64:67]
    v_mfma_f32_16x16x32_bf16 v[68:71], v[156:159], a[56:59], v[68:71]
    ds_read_b128 a[24:27], v6 offset:12288
    s_add_u32 m0, s21, 35840
    v_mfma_f32_16x16x32_bf16 v[72:75], v[152:155], a[60:63], v[72:75]
    v_mfma_f32_16x16x32_bf16 v[76:79], v[156:159], a[60:63], v[76:79]
    ds_read_b128 a[28:31], v6 offset:14336
    s_add_u32 s64, s20, 0x7b80
    buffer_load_dwordx4 v2, s[4:7], s64 offen lds
    s_waitcnt lgkmcnt(4)
    v_mfma_f32_16x16x32_bf16 v[16:19], v[160:163], a[0:3], v[16:19]
    v_mfma_f32_16x16x32_bf16 v[20:23], v[164:167], a[0:3], v[20:23]
    ds_read_b128 a[32:35], v9 offset:0
    v_mfma_f32_16x16x32_bf16 v[24:27], v[160:163], a[4:7], v[24:27]
    v_mfma_f32_16x16x32_bf16 v[28:31], v[164:167], a[4:7], v[28:31]
    ds_read_b128 a[36:39], v9 offset:2048
    v_mfma_f32_16x16x32_bf16 v[32:35], v[160:163], a[8:11], v[32:35]
    v_mfma_f32_16x16x32_bf16 v[36:39], v[164:167], a[8:11], v[36:39]
    ds_read_b128 a[40:43], v9 offset:4096
    v_mfma_f32_16x16x32_bf16 v[40:43], v[160:163], a[12:15], v[40:43]
    v_mfma_f32_16x16x32_bf16 v[44:47], v[164:167], a[12:15], v[44:47]
    ds_read_b128 a[44:47], v9 offset:6144
    s_waitcnt lgkmcnt(4)
    v_mfma_f32_16x16x32_bf16 v[48:51], v[160:163], a[16:19], v[48:51]
    v_mfma_f32_16x16x32_bf16 v[52:55], v[164:167], a[16:19], v[52:55]
    ds_read_b128 a[48:51], v9 offset:8192
    v_mfma_f32_16x16x32_bf16 v[56:59], v[160:163], a[20:23], v[56:59]
    v_mfma_f32_16x16x32_bf16 v[60:63], v[164:167], a[20:23], v[60:63]
    ds_read_b128 a[52:55], v9 offset:10240
    v_mfma_f32_16x16x32_bf16 v[64:67], v[160:163], a[24:27], v[64:67]
    v_mfma_f32_16x16x32_bf16 v[68:71], v[164:167], a[24:27], v[68:71]
    ds_read_b128 a[56:59], v9 offset:12288
    v_mfma_f32_16x16x32_bf16 v[72:75], v[160:163], a[28:31], v[72:75]
    v_mfma_f32_16x16x32_bf16 v[76:79], v[164:167], a[28:31], v[76:79]
    ds_read_b128 a[60:63], v9 offset:14336
    s_waitcnt vmcnt(8)
    s_barrier
    s_waitcnt lgkmcnt(4)
    v_mfma_f32_16x16x32_bf16 v[16:19], v[168:171], a[32:35], v[16:19]
    v_mfma_f32_16x16x32_bf16 v[20:23], v[172:175], a[32:35], v[20:23]
    ds_read_b128 a[0:3], v3 offset:0
    s_add_u32 m0, s21, 49152
    v_mfma_f32_16x16x32_bf16 v[24:27], v[168:171], a[36:39], v[24:27]
    v_mfma_f32_16x16x32_bf16 v[28:31], v[172:175], a[36:39], v[28:31]
    ds_read_b128 a[4:7], v3 offset:2048
    s_add_u32 s64, s20, 0x400
    buffer_load_dwordx4 v2, s[4:7], s64 offen lds
    v_mfma_f32_16x16x32_bf16 v[32:35], v[168:171], a[40:43], v[32:35]
    v_mfma_f32_16x16x32_bf16 v[36:39], v[172:175], a[40:43], v[36:39]
    ds_read_b128 a[8:11], v3 offset:4096
    s_add_u32 m0, s21, 50176
    v_mfma_f32_16x16x32_bf16 v[40:43], v[168:171], a[44:47], v[40:43]
    v_mfma_f32_16x16x32_bf16 v[44:47], v[172:175], a[44:47], v[44:47]
    ds_read_b128 a[12:15], v3 offset:6144
    s_add_u32 s64, s20, 0x2c00
    buffer_load_dwordx4 v2, s[4:7], s64 offen lds
    s_waitcnt lgkmcnt(4)
    v_mfma_f32_16x16x32_bf16 v[48:51], v[168:171], a[48:51], v[48:51]
    v_mfma_f32_16x16x32_bf16 v[52:55], v[172:175], a[48:51], v[52:55]
    ds_read_b128 a[16:19], v3 offset:8192
    s_add_u32 m0, s21, 51200
    v_mfma_f32_16x16x32_bf16 v[56:59], v[168:171], a[52:55], v[56:59]
    v_mfma_f32_16x16x32_bf16 v[60:63], v[172:175], a[52:55], v[60:63]
    ds_read_b128 a[20:23], v3 offset:10240
    s_add_u32 s64, s20, 0x5400
    buffer_load_dwordx4 v2, s[4:7], s64 offen lds
    v_mfma_f32_16x16x32_bf16 v[64:67], v[168:171], a[56:59], v[64:67]
    v_mfma_f32_16x16x32_bf16 v[68:71], v[172:175], a[56:59], v[68:71]
    ds_read_b128 a[24:27], v3 offset:12288
    s_add_u32 m0, s21, 52224
    v_mfma_f32_16x16x32_bf16 v[72:75], v[168:171], a[60:63], v[72:75]
    v_mfma_f32_16x16x32_bf16 v[76:79], v[172:175], a[60:63], v[76:79]
    ds_read_b128 a[28:31], v3 offset:14336
    s_add_u32 s64, s20, 0x7c00
    buffer_load_dwordx4 v2, s[4:7], s64 offen lds
    s_waitcnt lgkmcnt(4)
    v_mfma_f32_16x16x32_bf16 v[16:19], v[176:179], a[0:3], v[16:19]
    v_mfma_f32_16x16x32_bf16 v[20:23], v[180:183], a[0:3], v[20:23]
    ds_read_b128 a[32:35], v4 offset:0
    v_mfma_f32_16x16x32_bf16 v[24:27], v[176:179], a[4:7], v[24:27]
    v_mfma_f32_16x16x32_bf16 v[28:31], v[180:183], a[4:7], v[28:31]
    ds_read_b128 a[36:39], v4 offset:2048
    v_mfma_f32_16x16x32_bf16 v[32:35], v[176:179], a[8:11], v[32:35]
    v_mfma_f32_16x16x32_bf16 v[36:39], v[180:183], a[8:11], v[36:39]
    ds_read_b128 a[40:43], v4 offset:4096
    v_mfma_f32_16x16x32_bf16 v[40:43], v[176:179], a[12:15], v[40:43]
    v_mfma_f32_16x16x32_bf16 v[44:47], v[180:183], a[12:15], v[44:47]
    ds_read_b128 a[44:47], v4 offset:6144
    s_waitcnt lgkmcnt(4)
    v_mfma_f32_16x16x32_bf16 v[48:51], v[176:179], a[16:19], v[48:51]
    v_mfma_f32_16x16x32_bf16 v[52:55], v[180:183], a[16:19], v[52:55]
    ds_read_b128 a[48:51], v4 offset:8192
    v_mfma_f32_16x16x32_bf16 v[56:59], v[176:179], a[20:23], v[56:59]
    v_mfma_f32_16x16x32_bf16 v[60:63], v[180:183], a[20:23], v[60:63]
    ds_read_b128 a[52:55], v4 offset:10240
    v_mfma_f32_16x16x32_bf16 v[64:67], v[176:179], a[24:27], v[64:67]
    v_mfma_f32_16x16x32_bf16 v[68:71], v[180:183], a[24:27], v[68:71]
    ds_read_b128 a[56:59], v4 offset:12288
    v_mfma_f32_16x16x32_bf16 v[72:75], v[176:179], a[28:31], v[72:75]
    v_mfma_f32_16x16x32_bf16 v[76:79], v[180:183], a[28:31], v[76:79]
    ds_read_b128 a[60:63], v4 offset:14336
    s_waitcnt vmcnt(8)
    s_barrier
    s_waitcnt lgkmcnt(4)
    v_mfma_f32_16x16x32_bf16 v[16:19], v[184:187], a[32:35], v[16:19]
    v_mfma_f32_16x16x32_bf16 v[20:23], v[188:191], a[32:35], v[20:23]
    ds_read_b128 a[0:3], v3 offset:16384
    s_add_u32 m0, s21, 65536
    v_mfma_f32_16x16x32_bf16 v[24:27], v[184:187], a[36:39], v[24:27]
    v_mfma_f32_16x16x32_bf16 v[28:31], v[188:191], a[36:39], v[28:31]
    ds_read_b128 a[4:7], v3 offset:18432
    s_add_u32 s64, s20, 0x480
    buffer_load_dwordx4 v2, s[4:7], s64 offen lds
    v_mfma_f32_16x16x32_bf16 v[32:35], v[184:187], a[40:43], v[32:35]
    v_mfma_f32_16x16x32_bf16 v[36:39], v[188:191], a[40:43], v[36:39]
    ds_read_b128 a[8:11], v3 offset:20480
    s_add_u32 m0, s21, 66560
    v_mfma_f32_16x16x32_bf16 v[40:43], v[184:187], a[44:47], v[40:43]
    v_mfma_f32_16x16x32_bf16 v[44:47], v[188:191], a[44:47], v[44:47]
    ds_read_b128 a[12:15], v3 offset:22528
    s_add_u32 s64, s20, 0x2c80
    buffer_load_dwordx4 v2, s[4:7], s64 offen lds
    s_waitcnt lgkmcnt(4)
    v_mfma_f32_16x16x32_bf16 v[48:51], v[184:187], a[48:51], v[48:51]
    v_mfma_f32_16x16x32_bf16 v[52:55], v[188:191], a[48:51], v[52:55]
    ds_read_b128 a[16:19], v3 offset:24576
    s_add_u32 m0, s21, 67584
    v_mfma_f32_16x16x32_bf16 v[56:59], v[184:187], a[52:55], v[56:59]
    v_mfma_f32_16x16x32_bf16 v[60:63], v[188:191], a[52:55], v[60:63]
    ds_read_b128 a[20:23], v3 offset:26624
    s_add_u32 s64, s20, 0x5480
    buffer_load_dwordx4 v2, s[4:7], s64 offen lds
    v_mfma_f32_16x16x32_bf16 v[64:67], v[184:187], a[56:59], v[64:67]
    v_mfma_f32_16x16x32_bf16 v[68:71], v[188:191], a[56:59], v[68:71]
    ds_read_b128 a[24:27], v3 offset:28672
    s_add_u32 m0, s21, 68608
    v_mfma_f32_16x16x32_bf16 v[72:75], v[184:187], a[60:63], v[72:75]
    v_mfma_f32_16x16x32_bf16 v[76:79], v[188:191], a[60:63], v[76:79]
    ds_read_b128 a[28:31], v3 offset:30720
    s_add_u32 s64, s20, 0x7c80
    buffer_load_dwordx4 v2, s[4:7], s64 offen lds
    s_waitcnt lgkmcnt(4)
    v_mfma_f32_16x16x32_bf16 v[16:19], v[192:195], a[0:3], v[16:19]
    v_mfma_f32_16x16x32_bf16 v[20:23], v[196:199], a[0:3], v[20:23]
    ds_read_b128 a[32:35], v4 offset:16384
    v_mfma_f32_16x16x32_bf16 v[24:27], v[192:195], a[4:7], v[24:27]
    v_mfma_f32_16x16x32_bf16 v[28:31], v[196:199], a[4:7], v[28:31]
    ds_read_b128 a[36:39], v4 offset:18432
    v_mfma_f32_16x16x32_bf16 v[32:35], v[192:195], a[8:11], v[32:35]
    v_mfma_f32_16x16x32_bf16 v[36:39], v[196:199], a[8:11], v[36:39]
    ds_read_b128 a[40:43], v4 offset:20480
    v_mfma_f32_16x16x32_bf16 v[40:43], v[192:195], a[12:15], v[40:43]
    v_mfma_f32_16x16x32_bf16 v[44:47], v[196:199], a[12:15], v[44:47]
    ds_read_b128 a[44:47], v4 offset:22528
    s_waitcnt lgkmcnt(4)
    v_mfma_f32_16x16x32_bf16 v[48:51], v[192:195], a[16:19], v[48:51]
    v_mfma_f32_16x16x32_bf16 v[52:55], v[196:199], a[16:19], v[52:55]
    ds_read_b128 a[48:51], v4 offset:24576
    v_mfma_f32_16x16x32_bf16 v[56:59], v[192:195], a[20:23], v[56:59]
    v_mfma_f32_16x16x32_bf16 v[60:63], v[196:199], a[20:23], v[60:63]
    ds_read_b128 a[52:55], v4 offset:26624
    v_mfma_f32_16x16x32_bf16 v[64:67], v[192:195], a[24:27], v[64:67]
    v_mfma_f32_16x16x32_bf16 v[68:71], v[196:199], a[24:27], v[68:71]
    ds_read_b128 a[56:59], v4 offset:28672
    v_mfma_f32_16x16x32_bf16 v[72:75], v[192:195], a[28:31], v[72:75]
    v_mfma_f32_16x16x32_bf16 v[76:79], v[196:199], a[28:31], v[76:79]
    ds_read_b128 a[60:63], v4 offset:30720
    s_waitcnt vmcnt(8)
    s_barrier
    s_waitcnt lgkmcnt(4)
    v_mfma_f32_16x16x32_bf16 v[16:19], v[200:203], a[32:35], v[16:19]
    v_mfma_f32_16x16x32_bf16 v[20:23], v[204:207], a[32:35], v[20:23]
    ds_read_b128 a[0:3], v3 offset:32768
    s_add_u32 m0, s21, 0
    v_mfma_f32_16x16x32_bf16 v[24:27], v[200:203], a[36:39], v[24:27]
    v_mfma_f32_16x16x32_bf16 v[28:31], v[204:207], a[36:39], v[28:31]
    ds_read_b128 a[4:7], v3 offset:34816
    s_add_u32 s64, s20, 0x50000
    buffer_load_dwordx4 v2, s[4:7], s64 offen lds
    v_mfma_f32_16x16x32_bf16 v[32:35], v[200:203], a[40:43], v[32:35]
    v_mfma_f32_16x16x32_bf16 v[36:39], v[204:207], a[40:43], v[36:39]
    ds_read_b128 a[8:11], v3 offset:36864
    s_add_u32 m0, s21, 1024
    v_mfma_f32_16x16x32_bf16 v[40:43], v[200:203], a[44:47], v[40:43]
    v_mfma_f32_16x16x32_bf16 v[44:47], v[204:207], a[44:47], v[44:47]
    ds_read_b128 a[12:15], v3 offset:38912
    s_add_u32 s64, s20, 0x52800
    buffer_load_dwordx4 v2, s[4:7], s64 offen lds
    s_waitcnt lgkmcnt(4)
    v_mfma_f32_16x16x32_bf16 v[48:51], v[200:203], a[48:51], v[48:51]
    v_mfma_f32_16x16x32_bf16 v[52:55], v[204:207], a[48:51], v[52:55]
    ds_read_b128 a[16:19], v3 offset:40960
    s_add_u32 m0, s21, 2048
    v_mfma_f32_16x16x32_bf16 v[56:59], v[200:203], a[52:55], v[56:59]
    v_mfma_f32_16x16x32_bf16 v[60:63], v[204:207], a[52:55], v[60:63]
    ds_read_b128 a[20:23], v3 offset:43008
    s_add_u32 s64, s20, 0x55000
    buffer_load_dwordx4 v2, s[4:7], s64 offen lds
    v_mfma_f32_16x16x32_bf16 v[64:67], v[200:203], a[56:59], v[64:67]
    v_mfma_f32_16x16x32_bf16 v[68:71], v[204:207], a[56:59], v[68:71]
    ds_read_b128 a[24:27], v3 offset:45056
    s_add_u32 m0, s21, 3072
    v_mfma_f32_16x16x32_bf16 v[72:75], v[200:203], a[60:63], v[72:75]
    v_mfma_f32_16x16x32_bf16 v[76:79], v[204:207], a[60:63], v[76:79]
    ds_read_b128 a[28:31], v3 offset:47104
    s_add_u32 s64, s20, 0x57800
    buffer_load_dwordx4 v2, s[4:7], s64 offen lds
    s_waitcnt lgkmcnt(4)
    v_mfma_f32_16x16x32_bf16 v[16:19], v[208:211], a[0:3], v[16:19]
    v_mfma_f32_16x16x32_bf16 v[20:23], v[212:215], a[0:3], v[20:23]
    ds_read_b128 a[32:35], v4 offset:32768
    v_mfma_f32_16x16x32_bf16 v[24:27], v[208:211], a[4:7], v[24:27]
    v_mfma_f32_16x16x32_bf16 v[28:31], v[212:215], a[4:7], v[28:31]
    ds_read_b128 a[36:39], v4 offset:34816
    v_mfma_f32_16x16x32_bf16 v[32:35], v[208:211], a[8:11], v[32:35]
    v_mfma_f32_16x16x32_bf16 v[36:39], v[212:215], a[8:11], v[36:39]
    ds_read_b128 a[40:43], v4 offset:36864
    v_mfma_f32_16x16x32_bf16 v[40:43], v[208:211], a[12:15], v[40:43]
    v_mfma_f32_16x16x32_bf16 v[44:47], v[212:215], a[12:15], v[44:47]
    ds_read_b128 a[44:47], v4 offset:38912
    s_waitcnt lgkmcnt(4)
    v_mfma_f32_16x16x32_bf16 v[48:51], v[208:211], a[16:19], v[48:51]
    v_mfma_f32_16x16x32_bf16 v[52:55], v[212:215], a[16:19], v[52:55]
    ds_read_b128 a[48:51], v4 offset:40960
    v_mfma_f32_16x16x32_bf16 v[56:59], v[208:211], a[20:23], v[56:59]
    v_mfma_f32_16x16x32_bf16 v[60:63], v[212:215], a[20:23], v[60:63]
    ds_read_b128 a[52:55], v4 offset:43008
    v_mfma_f32_16x16x32_bf16 v[64:67], v[208:211], a[24:27], v[64:67]
    v_mfma_f32_16x16x32_bf16 v[68:71], v[212:215], a[24:27], v[68:71]
    ds_read_b128 a[56:59], v4 offset:45056
    v_mfma_f32_16x16x32_bf16 v[72:75], v[208:211], a[28:31], v[72:75]
    v_mfma_f32_16x16x32_bf16 v[76:79], v[212:215], a[28:31], v[76:79]
    ds_read_b128 a[60:63], v4 offset:47104
    s_waitcnt vmcnt(8)
    s_barrier
    s_waitcnt lgkmcnt(4)
    v_mfma_f32_16x16x32_bf16 v[16:19], v[216:219], a[32:35], v[16:19]
    v_mfma_f32_16x16x32_bf16 v[20:23], v[220:223], a[32:35], v[20:23]
    ds_read_b128 a[0:3], v3 offset:49152
    s_add_u32 m0, s21, 16384
    v_mfma_f32_16x16x32_bf16 v[24:27], v[216:219], a[36:39], v[24:27]
    v_mfma_f32_16x16x32_bf16 v[28:31], v[220:223], a[36:39], v[28:31]
    ds_read_b128 a[4:7], v3 offset:51200
    s_add_u32 s64, s20, 0x50080
    buffer_load_dwordx4 v2, s[4:7], s64 offen lds
    v_mfma_f32_16x16x32_bf16 v[32:35], v[216:219], a[40:43], v[32:35]
    v_mfma_f32_16x16x32_bf16 v[36:39], v[220:223], a[40:43], v[36:39]
    ds_read_b128 a[8:11], v3 offset:53248
    s_add_u32 m0, s21, 17408
    v_mfma_f32_16x16x32_bf16 v[40:43], v[216:219], a[44:47], v[40:43]
    v_mfma_f32_16x16x32_bf16 v[44:47], v[220:223], a[44:47], v[44:47]
    ds_read_b128 a[12:15], v3 offset:55296
    s_add_u32 s64, s20, 0x52880
    buffer_load_dwordx4 v2, s[4:7], s64 offen lds
    s_waitcnt lgkmcnt(4)
    v_mfma_f32_16x16x32_bf16 v[48:51], v[216:219], a[48:51], v[48:51]
    v_mfma_f32_16x16x32_bf16 v[52:55], v[220:223], a[48:51], v[52:55]
    ds_read_b128 a[16:19], v3 offset:57344
    s_add_u32 m0, s21, 18432
    v_mfma_f32_16x16x32_bf16 v[56:59], v[216:219], a[52:55], v[56:59]
    v_mfma_f32_16x16x32_bf16 v[60:63], v[220:223], a[52:55], v[60:63]
    ds_read_b128 a[20:23], v3 offset:59392
    s_add_u32 s64, s20, 0x55080
    buffer_load_dwordx4 v2, s[4:7], s64 offen lds
    v_mfma_f32_16x16x32_bf16 v[64:67], v[216:219], a[56:59], v[64:67]
    v_mfma_f32_16x16x32_bf16 v[68:71], v[220:223], a[56:59], v[68:71]
    ds_read_b128 a[24:27], v3 offset:61440
    s_add_u32 m0, s21, 19456
    v_mfma_f32_16x16x32_bf16 v[72:75], v[216:219], a[60:63], v[72:75]
    v_mfma_f32_16x16x32_bf16 v[76:79], v[220:223], a[60:63], v[76:79]
    ds_read_b128 a[28:31], v3 offset:63488
    s_add_u32 s64, s20, 0x57880
    buffer_load_dwordx4 v2, s[4:7], s64 offen lds
    s_waitcnt lgkmcnt(4)
    v_mfma_f32_16x16x32_bf16 v[16:19], v[224:227], a[0:3], v[16:19]
    v_mfma_f32_16x16x32_bf16 v[20:23], v[228:231], a[0:3], v[20:23]
    ds_read_b128 a[32:35], v4 offset:49152
    v_mfma_f32_16x16x32_bf16 v[24:27], v[224:227], a[4:7], v[24:27]
    v_mfma_f32_16x16x32_bf16 v[28:31], v[228:231], a[4:7], v[28:31]
    ds_read_b128 a[36:39], v4 offset:51200
    v_mfma_f32_16x16x32_bf16 v[32:35], v[224:227], a[8:11], v[32:35]
    v_mfma_f32_16x16x32_bf16 v[36:39], v[228:231], a[8:11], v[36:39]
    ds_read_b128 a[40:43], v4 offset:53248
    v_mfma_f32_16x16x32_bf16 v[40:43], v[224:227], a[12:15], v[40:43]
    v_mfma_f32_16x16x32_bf16 v[44:47], v[228:231], a[12:15], v[44:47]
    ds_read_b128 a[44:47], v4 offset:55296
    s_waitcnt lgkmcnt(4)
    v_mfma_f32_16x16x32_bf16 v[48:51], v[224:227], a[16:19], v[48:51]
    v_mfma_f32_16x16x32_bf16 v[52:55], v[228:231], a[16:19], v[52:55]
    ds_read_b128 a[48:51], v4 offset:57344
    v_mfma_f32_16x16x32_bf16 v[56:59], v[224:227], a[20:23], v[56:59]
    v_mfma_f32_16x16x32_bf16 v[60:63], v[228:231], a[20:23], v[60:63]
    ds_read_b128 a[52:55], v4 offset:59392
    v_mfma_f32_16x16x32_bf16 v[64:67], v[224:227], a[24:27], v[64:67]
    v_mfma_f32_16x16x32_bf16 v[68:71], v[228:231], a[24:27], v[68:71]
    ds_read_b128 a[56:59], v4 offset:61440
    v_mfma_f32_16x16x32_bf16 v[72:75], v[224:227], a[28:31], v[72:75]
    v_mfma_f32_16x16x32_bf16 v[76:79], v[228:231], a[28:31], v[76:79]
    ds_read_b128 a[60:63], v4 offset:63488
    s_waitcnt vmcnt(8)
    s_barrier
    s_waitcnt lgkmcnt(4)
    v_mfma_f32_16x16x32_bf16 v[16:19], v[232:235], a[32:35], v[16:19]
    v_mfma_f32_16x16x32_bf16 v[20:23], v[236:239], a[32:35], v[20:23]
    ds_read_b128 a[0:3], v6 offset:0
    s_add_u32 m0, s21, 32768
    v_mfma_f32_16x16x32_bf16 v[24:27], v[232:235], a[36:39], v[24:27]
    v_mfma_f32_16x16x32_bf16 v[28:31], v[236:239], a[36:39], v[28:31]
    ds_read_b128 a[4:7], v6 offset:2048
    s_add_u32 s64, s20, 0x50100
    buffer_load_dwordx4 v2, s[4:7], s64 offen lds
    v_mfma_f32_16x16x32_bf16 v[32:35], v[232:235], a[40:43], v[32:35]
    v_mfma_f32_16x16x32_bf16 v[36:39], v[236:239], a[40:43], v[36:39]
    ds_read_b128 a[8:11], v6 offset:4096
    s_add_u32 m0, s21, 33792
    v_mfma_f32_16x16x32_bf16 v[40:43], v[232:235], a[44:47], v[40:43]
    v_mfma_f32_16x16x32_bf16 v[44:47], v[236:239], a[44:47], v[44:47]
    ds_read_b128 a[12:15], v6 offset:6144
    s_add_u32 s64, s20, 0x52900
    buffer_load_dwordx4 v2, s[4:7], s64 offen lds
    s_waitcnt lgkmcnt(4)
    v_mfma_f32_16x16x32_bf16 v[48:51], v[232:235], a[48:51], v[48:51]
    v_mfma_f32_16x16x32_bf16 v[52:55], v[236:239], a[48:51], v[52:55]
    ds_read_b128 a[16:19], v6 offset:8192
    s_add_u32 m0, s21, 34816
    v_mfma_f32_16x16x32_bf16 v[56:59], v[232:235], a[52:55], v[56:59]
    v_mfma_f32_16x16x32_bf16 v[60:63], v[236:239], a[52:55], v[60:63]
    ds_read_b128 a[20:23], v6 offset:10240
    s_add_u32 s64, s20, 0x55100
    buffer_load_dwordx4 v2, s[4:7], s64 offen lds
    v_mfma_f32_16x16x32_bf16 v[64:67], v[232:235], a[56:59], v[64:67]
    v_mfma_f32_16x16x32_bf16 v[68:71], v[236:239], a[56:59], v[68:71]
    ds_read_b128 a[24:27], v6 offset:12288
    s_add_u32 m0, s21, 35840
    v_mfma_f32_16x16x32_bf16 v[72:75], v[232:235], a[60:63], v[72:75]
    v_mfma_f32_16x16x32_bf16 v[76:79], v[236:239], a[60:63], v[76:79]
    ds_read_b128 a[28:31], v6 offset:14336
    s_add_u32 s64, s20, 0x57900
    buffer_load_dwordx4 v2, s[4:7], s64 offen lds
    s_waitcnt lgkmcnt(4)
    v_mfma_f32_16x16x32_bf16 v[16:19], v[240:243], a[0:3], v[16:19]
    v_mfma_f32_16x16x32_bf16 v[20:23], v[244:247], a[0:3], v[20:23]
    ds_read_b128 a[32:35], v9 offset:0
    v_mfma_f32_16x16x32_bf16 v[24:27], v[240:243], a[4:7], v[24:27]
    v_mfma_f32_16x16x32_bf16 v[28:31], v[244:247], a[4:7], v[28:31]
    ds_read_b128 a[36:39], v9 offset:2048
    v_mfma_f32_16x16x32_bf16 v[32:35], v[240:243], a[8:11], v[32:35]
    v_mfma_f32_16x16x32_bf16 v[36:39], v[244:247], a[8:11], v[36:39]
    ds_read_b128 a[40:43], v9 offset:4096
    v_mfma_f32_16x16x32_bf16 v[40:43], v[240:243], a[12:15], v[40:43]
    v_mfma_f32_16x16x32_bf16 v[44:47], v[244:247], a[12:15], v[44:47]
    ds_read_b128 a[44:47], v9 offset:6144
    s_waitcnt lgkmcnt(4)
    v_mfma_f32_16x16x32_bf16 v[48:51], v[240:243], a[16:19], v[48:51]
    v_mfma_f32_16x16x32_bf16 v[52:55], v[244:247], a[16:19], v[52:55]
    ds_read_b128 a[48:51], v9 offset:8192
    v_mfma_f32_16x16x32_bf16 v[56:59], v[240:243], a[20:23], v[56:59]
    v_mfma_f32_16x16x32_bf16 v[60:63], v[244:247], a[20:23], v[60:63]
    ds_read_b128 a[52:55], v9 offset:10240
    v_mfma_f32_16x16x32_bf16 v[64:67], v[240:243], a[24:27], v[64:67]
    v_mfma_f32_16x16x32_bf16 v[68:71], v[244:247], a[24:27], v[68:71]
    ds_read_b128 a[56:59], v9 offset:12288
    v_mfma_f32_16x16x32_bf16 v[72:75], v[240:243], a[28:31], v[72:75]
    v_mfma_f32_16x16x32_bf16 v[76:79], v[244:247], a[28:31], v[76:79]
    ds_read_b128 a[60:63], v9 offset:14336
    s_waitcnt vmcnt(8)
    s_barrier
    s_waitcnt lgkmcnt(4)
    v_mfma_f32_16x16x32_bf16 v[16:19], v[248:251], a[32:35], v[16:19]
    v_mfma_f32_16x16x32_bf16 v[20:23], v[252:255], a[32:35], v[20:23]
    ds_read_b128 a[0:3], v3 offset:0
    s_add_u32 m0, s21, 49152
    v_mfma_f32_16x16x32_bf16 v[24:27], v[248:251], a[36:39], v[24:27]
    v_mfma_f32_16x16x32_bf16 v[28:31], v[252:255], a[36:39], v[28:31]
    ds_read_b128 a[4:7], v3 offset:2048
    s_add_u32 s64, s20, 0x50180
    buffer_load_dwordx4 v2, s[4:7], s64 offen lds
    v_mfma_f32_16x16x32_bf16 v[32:35], v[248:251], a[40:43], v[32:35]
    v_mfma_f32_16x16x32_bf16 v[36:39], v[252:255], a[40:43], v[36:39]
    ds_read_b128 a[8:11], v3 offset:4096
    s_add_u32 m0, s21, 50176
    v_mfma_f32_16x16x32_bf16 v[40:43], v[248:251], a[44:47], v[40:43]
    v_mfma_f32_16x16x32_bf16 v[44:47], v[252:255], a[44:47], v[44:47]
    ds_read_b128 a[12:15], v3 offset:6144
    s_add_u32 s64, s20, 0x52980
    buffer_load_dwordx4 v2, s[4:7], s64 offen lds
    s_waitcnt lgkmcnt(4)
    v_mfma_f32_16x16x32_bf16 v[48:51], v[248:251], a[48:51], v[48:51]
    v_mfma_f32_16x16x32_bf16 v[52:55], v[252:255], a[48:51], v[52:55]
    ds_read_b128 a[16:19], v3 offset:8192
    s_add_u32 m0, s21, 51200
    v_mfma_f32_16x16x32_bf16 v[56:59], v[248:251], a[52:55], v[56:59]
    v_mfma_f32_16x16x32_bf16 v[60:63], v[252:255], a[52:55], v[60:63]
    ds_read_b128 a[20:23], v3 offset:10240
    s_add_u32 s64, s20, 0x55180
    buffer_load_dwordx4 v2, s[4:7], s64 offen lds
    v_mfma_f32_16x16x32_bf16 v[64:67], v[248:251], a[56:59], v[64:67]
    v_mfma_f32_16x16x32_bf16 v[68:71], v[252:255], a[56:59], v[68:71]
    ds_read_b128 a[24:27], v3 offset:12288
    s_add_u32 m0, s21, 52224
    v_mfma_f32_16x16x32_bf16 v[72:75], v[248:251], a[60:63], v[72:75]
    v_mfma_f32_16x16x32_bf16 v[76:79], v[252:255], a[60:63], v[76:79]
    ds_read_b128 a[28:31], v3 offset:14336
    s_add_u32 s64, s20, 0x57980
    buffer_load_dwordx4 v2, s[4:7], s64 offen lds
    s_nop 5
    s_mul_i32 s65, s17, 0
    s_add_u32 s65, s65, s22
    s_add_u32 s64, s65, 0
    v_cvt_pk_bf16_f32 v80, v16, v17
    v_cvt_pk_bf16_f32 v81, v18, v19
    v_cvt_pk_bf16_f32 v82, v20, v21
    v_cvt_pk_bf16_f32 v83, v22, v23
    buffer_store_dwordx4 v[80:83], v1, s[4:7], s64 offen sc1
    s_add_u32 s64, s65, 4096
    v_cvt_pk_bf16_f32 v84, v24, v25
    v_cvt_pk_bf16_f32 v85, v26, v27
    v_cvt_pk_bf16_f32 v86, v28, v29
    v_cvt_pk_bf16_f32 v87, v30, v31
    buffer_store_dwordx4 v[84:87], v1, s[4:7], s64 offen sc1
    s_mul_i32 s65, s17, 1
    s_add_u32 s65, s65, s22
    s_add_u32 s64, s65, 0
    v_cvt_pk_bf16_f32 v88, v32, v33
    v_cvt_pk_bf16_f32 v89, v34, v35
    v_cvt_pk_bf16_f32 v90, v36, v37
    v_cvt_pk_bf16_f32 v91, v38, v39
    buffer_store_dwordx4 v[88:91], v1, s[4:7], s64 offen sc1
    s_add_u32 s64, s65, 4096
    v_cvt_pk_bf16_f32 v92, v40, v41
    v_cvt_pk_bf16_f32 v93, v42, v43
    v_cvt_pk_bf16_f32 v94, v44, v45
    v_cvt_pk_bf16_f32 v95, v46, v47
    buffer_store_dwordx4 v[92:95], v1, s[4:7], s64 offen sc1
    s_mul_i32 s65, s17, 2
    s_add_u32 s65, s65, s22
    s_add_u32 s64, s65, 0
    v_cvt_pk_bf16_f32 v80, v48, v49
    v_cvt_pk_bf16_f32 v81, v50, v51
    v_cvt_pk_bf16_f32 v82, v52, v53
    v_cvt_pk_bf16_f32 v83, v54, v55
    buffer_store_dwordx4 v[80:83], v1, s[4:7], s64 offen sc1
    s_add_u32 s64, s65, 4096
    v_cvt_pk_bf16_f32 v84, v56, v57
    v_cvt_pk_bf16_f32 v85, v58, v59
    v_cvt_pk_bf16_f32 v86, v60, v61
    v_cvt_pk_bf16_f32 v87, v62, v63
    buffer_store_dwordx4 v[84:87], v1, s[4:7], s64 offen sc1
    s_mul_i32 s65, s17, 3
    s_add_u32 s65, s65, s22
    s_add_u32 s64, s65, 0
    v_cvt_pk_bf16_f32 v88, v64, v65
    v_cvt_pk_bf16_f32 v89, v66, v67
    v_cvt_pk_bf16_f32 v90, v68, v69
    v_cvt_pk_bf16_f32 v91, v70, v71
    buffer_store_dwordx4 v[88:91], v1, s[4:7], s64 offen sc1
    s_add_u32 s64, s65, 4096
    v_cvt_pk_bf16_f32 v92, v72, v73
    v_cvt_pk_bf16_f32 v93, v74, v75
    v_cvt_pk_bf16_f32 v94, v76, v77
    v_cvt_pk_bf16_f32 v95, v78, v79
    buffer_store_dwordx4 v[92:95], v1, s[4:7], s64 offen sc1
    s_lshl_b32 s64, s19, 1
    s_add_u32 s64, s64, s12
    s_lshl_b32 s64, s64, 9
    s_add_u32 s23, s18, s64
    s_lshl_b32 s64, s17, 3
    s_add_u32 s22, s22, s64
    s_add_u32 s19, s19, 1
    s_add_u32 s20, s20, 0x50000
    s_cmp_lg_u32 s19, 1
    s_cbranch_scc1 GE0_116
    s_waitcnt vmcnt(0)
    s_barrier
    s_cmp_lg_u32 s14, 0
    s_cbranch_scc1 GF_117
    v_mov_b32 v7, 1
    v_mov_b32 v8, 0
    s_mov_b64 exec, 1
    buffer_store_dword v7, v8, s[4:7], s23 offen sc1
    s_mov_b64 exec, -1
GF_117:
GE0_116:
    s_cmp_lt_u32 s19, 8
    s_cbranch_scc1 G_T_LOOP
    s_waitcnt vmcnt(0) lgkmcnt(0)
    s_barrier
    s_cmp_lg_u32 s14, 0
    s_cbranch_scc1 GF_118
    v_mov_b32 v7, 1
    v_mov_b32 v8, 0
    s_mov_b64 exec, 1
    buffer_store_dword v7, v8, s[4:7], s23 offen sc1
    s_mov_b64 exec, -1
GF_118:
    s_cmp_eq_u32 s3, 2
    s_cbranch_scc1 H_Q
    s_cmp_eq_u32 s12, 1
    s_cbranch_scc1 H_OUT
    s_lshl_b32 s88, s3, 5
    s_add_u32 s88, s88, s13
    s_mov_b32 s29, 0
    v_lshlrev_b32 v1, 4, v0
    s_mov_b32 s65, 0
CW_119:
    buffer_load_dwordx2 v[8:9], off, s[60:63], 0 offset:132 sc1
    s_add_u32 s65, s65, 1
    s_waitcnt vmcnt(0)
    v_readfirstlane_b32 s66, v8
    v_readfirstlane_b32 s67, v9
    s_min_u32 s64, s66, s67
    s_cmp_lg_u32 s64, 0
    s_cbranch_scc1 CWD_120
    s_cmp_gt_u32 s65, 65536
    s_cbranch_scc1 CWD_120
    s_sleep 4
    s_branch CW_119
CWD_120:
    s_sub_u32 s66, s66, 1
    s_and_b32 s66, s66, 3
    s_sub_u32 s67, s67, 1
    s_and_b32 s67, s67, 3
    s_mov_b32 s64, s66
    s_mov_b32 s65, s67
    s_and_b32 s64, s64, 3
    s_lshl_b32 s64, s64, 13
    s_and_b32 s65, s65, 3
    s_lshl_b32 s65, s65, 13
    s_add_u32 s25, s64, 0x6000000
    s_add_u32 s30, s65, 0x6200000
    v_bfe_u32 v4, v0, 3, 1
    v_mul_u32_u24 v2, 0x8000, v4
    v_lshrrev_b32 v4, 5, v0
    v_lshl_add_u32 v2, v4, 8, v2
    v_bfe_u32 v4, v0, 4, 1
    v_lshl_add_u32 v2, v4, 7, v2
    v_and_b32 v4, 7, v0
    v_lshl_add_u32 v2, v4, 4, v2
    v_bfe_u32 v4, v0, 3, 1
    v_lshlrev_b32 v3, 16, v4
    v_lshrrev_b32 v4, 4, v0
    v_lshl_add_u32 v3, v4, 7, v3
    v_and_b32 v4, 7, v0
    v_lshl_add_u32 v3, v4, 4, v3
    s_lshl_b32 s26, s13, 11
    s_lshl_b32 s64, s14, 9
    s_add_u32 s26, s26, s64
    s_add_u32 s26, s26, 0x640000
    s_lshl_b32 s27, s13, 3
    s_add_u32 s27, s27, 0x294000
    s_mov_b32 s28, 0x29a000
    s_mov_b32 s24, 0
    v_lshlrev_b32 v6, 7, v0
MKT_LOOP:
    s_cmp_lg_u32 s24, 10
    s_cbranch_scc1 MKH_121
    v_mov_b32 v10, v2
    v_mov_b32 v11, v3
    s_cmp_ge_u32 s88, 60
    s_cbranch_scc1 NOWO_122
    s_mov_b32 s89, s13
    s_mul_hi_u32 s65, s88, 0xccccccd
    s_mul_i32 s65, s65, 20
    s_sub_u32 s13, s88, s65
    s_load_dwordx2 s[44:45], s[0:1], 40
    s_mov_b32 s46, 0x500000
    s_mov_b32 s47, 0x00020000
    s_waitcnt lgkmcnt(0)
    s_mul_i32 s21, s14, 36864
    v_lshrrev_b32 v7, 2, v0
    v_mul_u32_u24 v4, 1280, v7
    v_bfe_u32 v7, v0, 4, 1
    v_lshlrev_b32 v7, 1, v7
    v_and_b32 v8, 3, v0
    v_xor_b32 v7, v7, v8
    v_lshl_add_u32 v4, v7, 4, v4
    v_lshrrev_b32 v7, 4, v0
    v_lshlrev_b32 v2, 8, v7
    v_bfe_u32 v7, v0, 2, 2
    v_lshl_add_u32 v2, v7, 6, v2
    v_and_b32 v7, 3, v0
    v_lshl_add_u32 v2, v7, 3, v2
    v_add_u32 v2, s21, v2
    v_bfe_u32 v7, v0, 4, 1
    v_lshlrev_b32 v7, 5, v7
    v_sub_u32 v3, 32, v7
    v_add_u32 v3, v3, v2
    v_add_u32 v2, v2, v7
    s_mul_i32 s65, s14, 1310720
    s_lshl_b32 s66, s13, 6
    s_add_u32 s65, s65, s66
    s_add_u32 m0, s21, 0
    s_add_u32 s64, s65, 0x0
    buffer_load_dwordx4 v4, s[44:47], s64 offen lds
    s_add_u32 m0, s21, 1024
    s_add_u32 s64, s65, 0x5000
    buffer_load_dwordx4 v4, s[44:47], s64 offen lds
    s_add_u32 m0, s21, 2048
    s_add_u32 s64, s65, 0xa000
    buffer_load_dwordx4 v4, s[44:47], s64 offen lds
    s_add_u32 m0, s21, 3072
    s_add_u32 s64, s65, 0xf000
    buffer_load_dwordx4 v4, s[44:47], s64 offen lds
    s_add_u32 m0, s21, 4096
    s_add_u32 s64, s65, 0x14000
    buffer_load_dwordx4 v4, s[44:47], s64 offen lds
    s_add_u32 m0, s21, 5120
    s_add_u32 s64, s65, 0x19000
    buffer_load_dwordx4 v4, s[44:47], s64 offen lds
    s_add_u32 m0, s21, 6144
    s_add_u32 s64, s65, 0x1e000
    buffer_load_dwordx4 v4, s[44:47], s64 offen lds
    s_add_u32 m0, s21, 7168
    s_add_u32 s64, s65, 0x23000
    buffer_load_dwordx4 v4, s[44:47], s64 offen lds
    s_add_u32 m0, s21, 8192
    s_add_u32 s64, s65, 0x28000
    buffer_load_dwordx4 v4, s[44:47], s64 offen lds
    s_add_u32 m0, s21, 9216
    s_add_u32 s64, s65, 0x2d000
    buffer_load_dwordx4 v4, s[44:47], s64 offen lds
    s_add_u32 m0, s21, 10240
    s_add_u32 s64, s65, 0x32000
    buffer_load_dwordx4 v4, s[44:47], s64 offen lds
    s_add_u32 m0, s21, 11264
    s_add_u32 s64, s65, 0x37000
    buffer_load_dwordx4 v4, s[44:47], s64 offen lds
    s_add_u32 m0, s21, 12288
    s_add_u32 s64, s65, 0x3c000
    buffer_load_dwordx4 v4, s[44:47], s64 offen lds
    s_add_u32 m0, s21, 13312
    s_add_u32 s64, s65, 0x41000
    buffer_load_dwordx4 v4, s[44:47], s64 offen lds
    s_add_u32 m0, s21, 14336
    s_add_u32 s64, s65, 0x46000
    buffer_load_dwordx4 v4, s[44:47], s64 offen lds
    s_add_u32 m0, s21, 15360
    s_add_u32 s64, s65, 0x4b000
    buffer_load_dwordx4 v4, s[44:47], s64 offen lds
    s_add_u32 m0, s21, 16384
    s_add_u32 s64, s65, 0x50000
    buffer_load_dwordx4 v4, s[44:47], s64 offen lds
    s_add_u32 m0, s21, 17408
    s_add_u32 s64, s65, 0x55000
    buffer_load_dwordx4 v4, s[44:47], s64 offen lds
    s_add_u32 m0, s21, 18432
    s_add_u32 s64, s65, 0x5a000
    buffer_load_dwordx4 v4, s[44:47], s64 offen lds
    s_add_u32 m0, s21, 19456
    s_add_u32 s64, s65, 0x5f000
    buffer_load_dwordx4 v4, s[44:47], s64 offen lds
    s_add_u32 m0, s21, 20480
    s_add_u32 s64, s65, 0x64000
    buffer_load_dwordx4 v4, s[44:47], s64 offen lds
    s_add_u32 m0, s21, 21504
    s_add_u32 s64, s65, 0x69000
    buffer_load_dwordx4 v4, s[44:47], s64 offen lds
    s_add_u32 m0, s21, 22528
    s_add_u32 s64, s65, 0x6e000
    buffer_load_dwordx4 v4, s[44:47], s64 offen lds
    s_add_u32 m0, s21, 23552
    s_add_u32 s64, s65, 0x73000
    buffer_load_dwordx4 v4, s[44:47], s64 offen lds
    s_add_u32 m0, s21, 24576
    s_add_u32 s64, s65, 0x78000
    buffer_load_dwordx4 v4, s[44:47], s64 offen lds
    s_add_u32 m0, s21, 25600
    s_add_u32 s64, s65, 0x7d000
    buffer_load_dwordx4 v4, s[44:47], s64 offen lds
    s_add_u32 m0, s21, 26624
    s_add_u32 s64, s65, 0x82000
    buffer_load_dwordx4 v4, s[44:47], s64 offen lds
    s_add_u32 m0, s21, 27648
    s_add_u32 s64, s65, 0x87000
    buffer_load_dwordx4 v4, s[44:47], s64 offen lds
    s_add_u32 m0, s21, 28672
    s_add_u32 s64, s65, 0x8c000
    buffer_load_dwordx4 v4, s[44:47], s64 offen lds
    s_add_u32 m0, s21, 29696
    s_add_u32 s64, s65, 0x91000
    buffer_load_dwordx4 v4, s[44:47], s64 offen lds
    s_add_u32 m0, s21, 30720
    s_add_u32 s64, s65, 0x96000
    buffer_load_dwordx4 v4, s[44:47], s64 offen lds
    s_add_u32 m0, s21, 31744
    s_add_u32 s64, s65, 0x9b000
    buffer_load_dwordx4 v4, s[44:47], s64 offen lds
    s_add_u32 m0, s21, 32768
    s_add_u32 s64, s65, 0xa0000
    buffer_load_dwordx4 v4, s[44:47], s64 offen lds
    s_add_u32 m0, s21, 33792
    s_add_u32 s64, s65, 0xa5000
    buffer_load_dwordx4 v4, s[44:47], s64 offen lds
    s_add_u32 m0, s21, 34816
    s_add_u32 s64, s65, 0xaa000
    buffer_load_dwordx4 v4, s[44:47], s64 offen lds
    s_add_u32 m0, s21, 35840
    s_add_u32 s64, s65, 0xaf000
    buffer_load_dwordx4 v4, s[44:47], s64 offen lds
    s_waitcnt vmcnt(32)
    ds_read_b64_tr_b16 a[0:1], v2 offset:0
    ds_read_b64_tr_b16 a[2:3], v2 offset:1024
    ds_read_b64_tr_b16 a[4:5], v3 offset:0
    ds_read_b64_tr_b16 a[6:7], v3 offset:1024
    ds_read_b64_tr_b16 a[8:9], v2 offset:2048
    ds_read_b64_tr_b16 a[10:11], v2 offset:3072
    ds_read_b64_tr_b16 a[12:13], v3 offset:2048
    ds_read_b64_tr_b16 a[14:15], v3 offset:3072
    s_waitcnt lgkmcnt(0)
    s_add_u32 m0, s21, 0
    s_add_u32 s64, s65, 0xb4000
    buffer_load_dwordx4 v4, s[44:47], s64 offen lds
    s_add_u32 m0, s21, 1024
    s_add_u32 s64, s65, 0xb9000
    buffer_load_dwordx4 v4, s[44:47], s64 offen lds
    s_add_u32 m0, s21, 2048
    s_add_u32 s64, s65, 0xbe000
    buffer_load_dwordx4 v4, s[44:47], s64 offen lds
    s_add_u32 m0, s21, 3072
    s_add_u32 s64, s65, 0xc3000
    buffer_load_dwordx4 v4, s[44:47], s64 offen lds
    s_waitcnt vmcnt(32)
    ds_read_b64_tr_b16 a[16:17], v2 offset:4096
    ds_read_b64_tr_b16 a[18:19], v2 offset:5120
    ds_read_b64_tr_b16 a[20:21], v3 offset:4096
    ds_read_b64_tr_b16 a[22:23], v3 offset:5120
    ds_read_b64_tr_b16 a[24:25], v2 offset:6144
    ds_read_b64_tr_b16 a[26:27], v2 offset:7168
    ds_read_b64_tr_b16 a[28:29], v3 offset:6144
    ds_read_b64_tr_b16 a[30:31], v3 offset:7168
    s_waitcnt lgkmcnt(0)
    s_add_u32 m0, s21, 4096
    s_add_u32 s64, s65, 0xc8000
    buffer_load_dwordx4 v4, s[44:47], s64 offen lds
    s_add_u32 m0, s21, 5120
    s_add_u32 s64, s65, 0xcd000
    buffer_load_dwordx4 v4, s[44:47], s64 offen lds
    s_add_u32 m0, s21, 6144
    s_add_u32 s64, s65, 0xd2000
    buffer_load_dwordx4 v4, s[44:47], s64 offen lds
    s_add_u32 m0, s21, 7168
    s_add_u32 s64, s65, 0xd7000
    buffer_load_dwordx4 v4, s[44:47], s64 offen lds
    s_waitcnt vmcnt(32)
    ds_read_b64_tr_b16 a[32:33], v2 offset:8192
    ds_read_b64_tr_b16 a[34:35], v2 offset:9216
    ds_read_b64_tr_b16 a[36:37], v3 offset:8192
    ds_read_b64_tr_b16 a[38:39], v3 offset:9216
    ds_read_b64_tr_b16 a[40:41], v2 offset:10240
    ds_read_b64_tr_b16 a[42:43], v2 offset:11264
    ds_read_b64_tr_b16 a[44:45], v3 offset:10240
    ds_read_b64_tr_b16 a[46:47], v3 offset:11264
    s_waitcnt lgkmcnt(0)
    s_add_u32 m0, s21, 8192
    s_add_u32 s64, s65, 0xdc000
    buffer_load_dwordx4 v4, s[44:47], s64 offen lds
    s_add_u32 m0, s21, 9216
    s_add_u32 s64, s65, 0xe1000
    buffer_load_dwordx4 v4, s[44:47], s64 offen lds
    s_add_u32 m0, s21, 10240
    s_add_u32 s64, s65, 0xe6000
    buffer_load_dwordx4 v4, s[44:47], s64 offen lds
    s_add_u32 m0, s21, 11264
    s_add_u32 s64, s65, 0xeb000
    buffer_load_dwordx4 v4, s[44:47], s64 offen lds
    s_waitcnt vmcnt(32)
    ds_read_b64_tr_b16 a[48:49], v2 offset:12288
    ds_read_b64_tr_b16 a[50:51], v2 offset:13312
    ds_read_b64_tr_b16 a[52:53], v3 offset:12288
    ds_read_b64_tr_b16 a[54:55], v3 offset:13312
    ds_read_b64_tr_b16 a[56:57], v2 offset:14336
    ds_read_b64_tr_b16 a[58:59], v2 offset:15360
    ds_read_b64_tr_b16 a[60:61], v3 offset:14336
    ds_read_b64_tr_b16 a[62:63], v3 offset:15360
    s_waitcnt lgkmcnt(0)
    s_add_u32 m0, s21, 12288
    s_add_u32 s64, s65, 0xf0000
    buffer_load_dwordx4 v4, s[44:47], s64 offen lds
    s_add_u32 m0, s21, 13312
    s_add_u32 s64, s65, 0xf5000
    buffer_load_dwordx4 v4, s[44:47], s64 offen lds
    s_add_u32 m0, s21, 14336
    s_add_u32 s64, s65, 0xfa000
    buffer_load_dwordx4 v4, s[44:47], s64 offen lds
    s_add_u32 m0, s21, 15360
    s_add_u32 s64, s65, 0xff000
    buffer_load_dwordx4 v4, s[44:47], s64 offen lds
    s_waitcnt vmcnt(32)
    ds_read_b64_tr_b16 a[64:65], v2 offset:16384
    ds_read_b64_tr_b16 a[66:67], v2 offset:17408
    ds_read_b64_tr_b16 a[68:69], v3 offset:16384
    ds_read_b64_tr_b16 a[70:71], v3 offset:17408
    ds_read_b64_tr_b16 a[72:73], v2 offset:18432
    ds_read_b64_tr_b16 a[74:75], v2 offset:19456
    ds_read_b64_tr_b16 a[76:77], v3 offset:18432
    ds_read_b64_tr_b16 a[78:79], v3 offset:19456
    s_waitcnt lgkmcnt(0)
    s_add_u32 m0, s21, 16384
    s_add_u32 s64, s65, 0x104000
    buffer_load_dwordx4 v4, s[44:47], s64 offen lds
    s_add_u32 m0, s21, 17408
    s_add_u32 s64, s65, 0x109000
    buffer_load_dwordx4 v4, s[44:47], s64 offen lds
    s_add_u32 m0, s21, 18432
    s_add_u32 s64, s65, 0x10e000
    buffer_load_dwordx4 v4, s[44:47], s64 offen lds
    s_add_u32 m0, s21, 19456
    s_add_u32 s64, s65, 0x113000
    buffer_load_dwordx4 v4, s[44:47], s64 offen lds
    s_waitcnt vmcnt(32)
    ds_read_b64_tr_b16 a[80:81], v2 offset:20480
    ds_read_b64_tr_b16 a[82:83], v2 offset:21504
    ds_read_b64_tr_b16 a[84:85], v3 offset:20480
    ds_read_b64_tr_b16 a[86:87], v3 offset:21504
    ds_read_b64_tr_b16 a[88:89], v2 offset:22528
    ds_read_b64_tr_b16 a[90:91], v2 offset:23552
    ds_read_b64_tr_b16 a[92:93], v3 offset:22528
    ds_read_b64_tr_b16 a[94:95], v3 offset:23552
    s_waitcnt lgkmcnt(0)
    s_add_u32 m0, s21, 20480
    s_add_u32 s64, s65, 0x118000
    buffer_load_dwordx4 v4, s[44:47], s64 offen lds
    s_add_u32 m0, s21, 21504
    s_add_u32 s64, s65, 0x11d000
    buffer_load_dwordx4 v4, s[44:47], s64 offen lds
    s_add_u32 m0, s21, 22528
    s_add_u32 s64, s65, 0x122000
    buffer_load_dwordx4 v4, s[44:47], s64 offen lds
    s_add_u32 m0, s21, 23552
    s_add_u32 s64, s65, 0x127000
    buffer_load_dwordx4 v4, s[44:47], s64 offen lds
    s_waitcnt vmcnt(32)
    ds_read_b64_tr_b16 a[96:97], v2 offset:24576
    ds_read_b64_tr_b16 a[98:99], v2 offset:25600
    ds_read_b64_tr_b16 a[100:101], v3 offset:24576
    ds_read_b64_tr_b16 a[102:103], v3 offset:25600
    ds_read_b64_tr_b16 a[104:105], v2 offset:26624
    ds_read_b64_tr_b16 a[106:107], v2 offset:27648
    ds_read_b64_tr_b16 a[108:109], v3 offset:26624
    ds_read_b64_tr_b16 a[110:111], v3 offset:27648
    s_waitcnt lgkmcnt(0)
    s_add_u32 m0, s21, 24576
    s_add_u32 s64, s65, 0x12c000
    buffer_load_dwordx4 v4, s[44:47], s64 offen lds
    s_add_u32 m0, s21, 25600
    s_add_u32 s64, s65, 0x131000
    buffer_load_dwordx4 v4, s[44:47], s64 offen lds
    s_add_u32 m0, s21, 26624
    s_add_u32 s64, s65, 0x136000
    buffer_load_dwordx4 v4, s[44:47], s64 offen lds
    s_add_u32 m0, s21, 27648
    s_add_u32 s64, s65, 0x13b000
    buffer_load_dwordx4 v4, s[44:47], s64 offen lds
    s_waitcnt vmcnt(32)
    ds_read_b64_tr_b16 a[112:113], v2 offset:28672
    ds_read_b64_tr_b16 a[114:115], v2 offset:29696
    ds_read_b64_tr_b16 a[116:117], v3 offset:28672
    ds_read_b64_tr_b16 a[118:119], v3 offset:29696
    ds_read_b64_tr_b16 a[120:121], v2 offset:30720
    ds_read_b64_tr_b16 a[122:123], v2 offset:31744
    ds_read_b64_tr_b16 a[124:125], v3 offset:30720
    ds_read_b64_tr_b16 a[126:127], v3 offset:31744
    s_waitcnt lgkmcnt(0)
    s_waitcnt vmcnt(28)
    ds_read_b64_tr_b16 a[128:129], v2 offset:32768
    ds_read_b64_tr_b16 a[130:131], v2 offset:33792
    ds_read_b64_tr_b16 a[132:133], v3 offset:32768
    ds_read_b64_tr_b16 a[134:135], v3 offset:33792
    ds_read_b64_tr_b16 a[136:137], v2 offset:34816
    ds_read_b64_tr_b16 a[138:139], v2 offset:35840
    ds_read_b64_tr_b16 a[140:141], v3 offset:34816
    ds_read_b64_tr_b16 a[142:143], v3 offset:35840
    s_waitcnt lgkmcnt(0)
    s_waitcnt vmcnt(24)
    ds_read_b64_tr_b16 a[144:145], v2 offset:0
    ds_read_b64_tr_b16 a[146:147], v2 offset:1024
    ds_read_b64_tr_b16 a[148:149], v3 offset:0
    ds_read_b64_tr_b16 a[150:151], v3 offset:1024
    ds_read_b64_tr_b16 a[152:153], v2 offset:2048
    ds_read_b64_tr_b16 a[154:155], v2 offset:3072
    ds_read_b64_tr_b16 a[156:157], v3 offset:2048
    ds_read_b64_tr_b16 a[158:159], v3 offset:3072
    s_waitcnt lgkmcnt(0)
    s_waitcnt vmcnt(20)
    ds_read_b64_tr_b16 a[160:161], v2 offset:4096
    ds_read_b64_tr_b16 a[162:163], v2 offset:5120
    ds_read_b64_tr_b16 a[164:165], v3 offset:4096
    ds_read_b64_tr_b16 a[166:167], v3 offset:5120
    ds_read_b64_tr_b16 a[168:169], v2 offset:6144
    ds_read_b64_tr_b16 a[170:171], v2 offset:7168
    ds_read_b64_tr_b16 a[172:173], v3 offset:6144
    ds_read_b64_tr_b16 a[174:175], v3 offset:7168
    s_waitcnt lgkmcnt(0)
    s_waitcnt vmcnt(16)
    ds_read_b64_tr_b16 a[176:177], v2 offset:8192
    ds_read_b64_tr_b16 a[178:179], v2 offset:9216
    ds_read_b64_tr_b16 a[180:181], v3 offset:8192
    ds_read_b64_tr_b16 a[182:183], v3 offset:9216
    ds_read_b64_tr_b16 a[184:185], v2 offset:10240
    ds_read_b64_tr_b16 a[186:187], v2 offset:11264
    ds_read_b64_tr_b16 a[188:189], v3 offset:10240
    ds_read_b64_tr_b16 a[190:191], v3 offset:11264
    s_waitcnt lgkmcnt(0)
    s_waitcnt vmcnt(12)
    ds_read_b64_tr_b16 a[192:193], v2 offset:12288
    ds_read_b64_tr_b16 a[194:195], v2 offset:13312
    ds_read_b64_tr_b16 a[196:197], v3 offset:12288
    ds_read_b64_tr_b16 a[198:199], v3 offset:13312
    ds_read_b64_tr_b16 a[200:201], v2 offset:14336
    ds_read_b64_tr_b16 a[202:203], v2 offset:15360
    ds_read_b64_tr_b16 a[204:205], v3 offset:14336
    ds_read_b64_tr_b16 a[206:207], v3 offset:15360
    s_waitcnt lgkmcnt(0)
    s_waitcnt vmcnt(8)
    ds_read_b64_tr_b16 a[208:209], v2 offset:16384
    ds_read_b64_tr_b16 a[210:211], v2 offset:17408
    ds_read_b64_tr_b16 a[212:213], v3 offset:16384
    ds_read_b64_tr_b16 a[214:215], v3 offset:17408
    ds_read_b64_tr_b16 a[216:217], v2 offset:18432
    ds_read_b64_tr_b16 a[218:219], v2 offset:19456
    ds_read_b64_tr_b16 a[220:221], v3 offset:18432
    ds_read_b64_tr_b16 a[222:223], v3 offset:19456
    s_waitcnt lgkmcnt(0)
    s_waitcnt vmcnt(4)
    ds_read_b64_tr_b16 a[224:225], v2 offset:20480
    ds_read_b64_tr_b16 a[226:227], v2 offset:21504
    ds_read_b64_tr_b16 a[228:229], v3 offset:20480
    ds_read_b64_tr_b16 a[230:231], v3 offset:21504
    ds_read_b64_tr_b16 a[232:233], v2 offset:22528
    ds_read_b64_tr_b16 a[234:235], v2 offset:23552
    ds_read_b64_tr_b16 a[236:237], v3 offset:22528
    ds_read_b64_tr_b16 a[238:239], v3 offset:23552
    s_waitcnt lgkmcnt(0)
    s_waitcnt vmcnt(0)
    ds_read_b64_tr_b16 a[240:241], v2 offset:24576
    ds_read_b64_tr_b16 a[242:243], v2 offset:25600
    ds_read_b64_tr_b16 a[244:245], v3 offset:24576
    ds_read_b64_tr_b16 a[246:247], v3 offset:25600
    ds_read_b64_tr_b16 a[248:249], v2 offset:26624
    ds_read_b64_tr_b16 a[250:251], v2 offset:27648
    ds_read_b64_tr_b16 a[252:253], v3 offset:26624
    ds_read_b64_tr_b16 a[254:255], v3 offset:27648
    s_waitcnt lgkmcnt(0)
    s_mov_b32 s13, s89
NOWO_122:
    v_mov_b32 v2, v10
    v_mov_b32 v3, v11
MKH_121:
    s_cmp_lg_u32 s24, 31
    s_mov_b64 exec, 0xf
    s_cbranch_scc1 MKL_123
    s_mov_b64 exec, -1
    v_bfe_u32 v4, v0, 3, 1
    v_mul_u32_u24 v4, 0x8000, v4
    v_sub_u32 v2, v2, v4
    s_mov_b64 exec, 3
MKL_123:
MKT_M_124:
    buffer_load_dword v5, v6, s[4:7], s28 offen sc1
    s_add_u32 s29, s29, 1
    s_waitcnt vmcnt(0)
    v_cmp_eq_u32 vcc, 0, v5
    s_cbranch_vccz MKT_MD_125
    s_cmp_gt_u32 s29, 262144
    s_cbranch_scc1 MKT_MD_125
    s_sleep 1
    s_branch MKT_M_124
MKT_MD_125:
    s_mov_b64 exec, -1
MKR_126:
    s_add_u32 s64, s25, 0x0
    buffer_load_dwordx4 v[16:19], v2, s[4:7], s64 offen sc1
    s_add_u32 s64, s25, 0x200
    buffer_load_dwordx4 v[20:23], v2, s[4:7], s64 offen sc1
    s_add_u32 s64, s25, 0x400
    buffer_load_dwordx4 v[24:27], v2, s[4:7], s64 offen sc1
    s_add_u32 s64, s25, 0x600
    buffer_load_dwordx4 v[28:31], v2, s[4:7], s64 offen sc1
    s_add_u32 s64, s25, 0x800
    buffer_load_dwordx4 v[32:35], v2, s[4:7], s64 offen sc1
    s_add_u32 s64, s25, 0xa00
    buffer_load_dwordx4 v[36:39], v2, s[4:7], s64 offen sc1
    s_add_u32 s64, s25, 0xc00
    buffer_load_dwordx4 v[40:43], v2, s[4:7], s64 offen sc1
    s_add_u32 s64, s25, 0xe00
    buffer_load_dwordx4 v[44:47], v2, s[4:7], s64 offen sc1
    s_add_u32 s64, s25, 0x1000
    buffer_load_dwordx4 v[48:51], v2, s[4:7], s64 offen sc1
    s_add_u32 s64, s25, 0x1200
    buffer_load_dwordx4 v[52:55], v2, s[4:7], s64 offen sc1
    s_add_u32 s64, s30, 0x0
    buffer_load_dwordx4 v[56:59], v2, s[4:7], s64 offen sc1
    s_add_u32 s64, s30, 0x200
    buffer_load_dwordx4 v[60:63], v2, s[4:7], s64 offen sc1
    s_add_u32 s64, s30, 0x400
    buffer_load_dwordx4 v[64:67], v2, s[4:7], s64 offen sc1
    s_add_u32 s64, s30, 0x600
    buffer_load_dwordx4 v[68:71], v2, s[4:7], s64 offen sc1
    s_add_u32 s64, s30, 0x800
    buffer_load_dwordx4 v[72:75], v2, s[4:7], s64 offen sc1
    s_add_u32 s64, s30, 0xa00
    buffer_load_dwordx4 v[76:79], v2, s[4:7], s64 offen sc1
    s_add_u32 s64, s30, 0xc00
    buffer_load_dwordx4 v[80:83], v2, s[4:7], s64 offen sc1
    s_add_u32 s64, s30, 0xe00
    buffer_load_dwordx4 v[84:87], v2, s[4:7], s64 offen sc1
    s_add_u32 s64, s30, 0x1000
    buffer_load_dwordx4 v[88:91], v2, s[4:7], s64 offen sc1
    s_add_u32 s64, s30, 0x1200
    buffer_load_dwordx4 v[92:95], v2, s[4:7], s64 offen sc1
    s_add_u32 s29, s29, 1
    s_waitcnt vmcnt(0)
    v_max3_u32 v4, v19, v23, v27
    v_max3_u32 v4, v4, v31, v35
    v_max3_u32 v4, v4, v39, v43
    v_max3_u32 v4, v4, v47, v51
    v_max3_u32 v4, v4, v55, v59
    v_max3_u32 v4, v4, v63, v67
    v_max3_u32 v4, v4, v71, v75
    v_max3_u32 v4, v4, v79, v83
    v_max3_u32 v4, v4, v87, v91
    v_max_u32 v4, v4, v95
    v_cmp_eq_u32 vcc, -1, v4
    s_cbranch_vccz MKO_127
    s_cmp_gt_u32 s29, 262144
    s_cbranch_scc0 MKR_126
MKO_127:
    v_mfma_f32_16x16x32_bf16 v[8:11], v[96:99], v[16:19], 0
    v_mfma_f32_16x16x32_bf16 v[12:15], v[100:103], v[16:19], 0
    v_mfma_f32_16x16x32_bf16 v[8:11], v[104:107], v[20:23], v[8:11]
    v_mfma_f32_16x16x32_bf16 v[12:15], v[108:111], v[20:23], v[12:15]
    v_mfma_f32_16x16x32_bf16 v[8:11], v[112:115], v[24:27], v[8:11]
    v_mfma_f32_16x16x32_bf16 v[12:15], v[116:119], v[24:27], v[12:15]
    v_mfma_f32_16x16x32_bf16 v[8:11], v[120:123], v[28:31], v[8:11]
    v_mfma_f32_16x16x32_bf16 v[12:15], v[124:127], v[28:31], v[12:15]
    v_mfma_f32_16x16x32_bf16 v[8:11], v[128:131], v[32:35], v[8:11]
    v_mfma_f32_16x16x32_bf16 v[12:15], v[132:135], v[32:35], v[12:15]
    v_mfma_f32_16x16x32_bf16 v[8:11], v[136:139], v[36:39], v[8:11]
    v_mfma_f32_16x16x32_bf16 v[12:15], v[140:143], v[36:39], v[12:15]
    v_mfma_f32_16x16x32_bf16 v[8:11], v[144:147], v[40:43], v[8:11]
    v_mfma_f32_16x16x32_bf16 v[12:15], v[148:151], v[40:43], v[12:15]
    v_mfma_f32_16x16x32_bf16 v[8:11], v[152:155], v[44:47], v[8:11]
    v_mfma_f32_16x16x32_bf16 v[12:15], v[156:159], v[44:47], v[12:15]
    v_mfma_f32_16x16x32_bf16 v[8:11], v[160:163], v[48:51], v[8:11]
    v_mfma_f32_16x16x32_bf16 v[12:15], v[164:167], v[48:51], v[12:15]
    v_mfma_f32_16x16x32_bf16 v[8:11], v[168:171], v[52:55], v[8:11]
    v_mfma_f32_16x16x32_bf16 v[12:15], v[172:175], v[52:55], v[12:15]
    v_mfma_f32_16x16x32_bf16 v[8:11], v[176:179], v[56:59], v[8:11]
    v_mfma_f32_16x16x32_bf16 v[12:15], v[180:183], v[56:59], v[12:15]
    v_mfma_f32_16x16x32_bf16 v[8:11], v[184:187], v[60:63], v[8:11]
    v_mfma_f32_16x16x32_bf16 v[12:15], v[188:191], v[60:63], v[12:15]
    v_mfma_f32_16x16x32_bf16 v[8:11], v[192:195], v[64:67], v[8:11]
    v_mfma_f32_16x16x32_bf16 v[12:15], v[196:199], v[64:67], v[12:15]
    v_mfma_f32_16x16x32_bf16 v[8:11], v[200:203], v[68:71], v[8:11]
    v_mfma_f32_16x16x32_bf16 v[12:15], v[204:207], v[68:71], v[12:15]
    v_mfma_f32_16x16x32_bf16 v[8:11], v[208:211], v[72:75], v[8:11]
    v_mfma_f32_16x16x32_bf16 v[12:15], v[212:215], v[72:75], v[12:15]
    v_mfma_f32_16x16x32_bf16 v[8:11], v[216:219], v[76:79], v[8:11]
    v_mfma_f32_16x16x32_bf16 v[12:15], v[220:223], v[76:79], v[12:15]
    v_mfma_f32_16x16x32_bf16 v[8:11], v[224:227], v[80:83], v[8:11]
    v_mfma_f32_16x16x32_bf16 v[12:15], v[228:231], v[80:83], v[12:15]
    v_mfma_f32_16x16x32_bf16 v[8:11], v[232:235], v[84:87], v[8:11]
    v_mfma_f32_16x16x32_bf16 v[12:15], v[236:239], v[84:87], v[12:15]
    v_mfma_f32_16x16x32_bf16 v[8:11], v[240:243], v[88:91], v[8:11]
    v_mfma_f32_16x16x32_bf16 v[12:15], v[244:247], v[88:91], v[12:15]
    v_mfma_f32_16x16x32_bf16 v[8:11], v[248:251], v[92:95], v[8:11]
    v_mfma_f32_16x16x32_bf16 v[12:15], v[252:255], v[92:95], v[12:15]
    s_nop 7
    v_cvt_pk_bf16_f32 v16, v8, v9
    v_cvt_pk_bf16_f32 v17, v10, v11
    v_cvt_pk_bf16_f32 v18, v12, v13
    v_cvt_pk_bf16_f32 v19, v14, v15
    buffer_store_dwordx4 v[16:19], v3, s[4:7], s26 offen sc1
    s_waitcnt vmcnt(0)
    s_barrier
    s_cmp_lg_u32 s14, 0
    s_cbranch_scc1 GF_128
    v_mov_b32 v7, 1
    v_mov_b32 v8, 0
    s_mov_b64 exec, 1
    buffer_store_dword v7, v8, s[4:7], s27 offen sc1
    s_mov_b64 exec, -1
GF_128:
    s_add_u32 s25, s25, 0x10000
    s_add_u32 s30, s30, 0x10000
    s_add_u32 s26, s26, 0x20000
    s_add_u32 s27, s27, 256
    s_add_u32 s28, s28, 512
    s_add_u32 s24, s24, 1
    s_cmp_lt_u32 s24, 32
    s_cbranch_scc1 MKT_LOOP
    s_cmp_ge_u32 s88, 60
    s_cbranch_scc1 M_EXIT
    s_branch H_EXTRA
G_N:
    s_lshl_b32 s65, s13, 8
    s_lshl_b32 s66, s14, 6
    s_add_u32 s20, s65, s66
    s_mul_i32 s21, s14, 36864
    v_lshrrev_b32 v6, 2, v0
    v_mul_u32_u24 v5, 8192, v6
    v_lshrrev_b32 v6, 5, v0
    v_lshlrev_b32 v6, 1, v6
    v_and_b32 v7, 3, v0
    v_xor_b32 v6, v6, v7
    v_lshl_add_u32 v5, v6, 4, v5
    v_lshrrev_b32 v6, 5, v0
    v_lshlrev_b32 v3, 10, v6
    v_bfe_u32 v6, v0, 2, 2
    v_lshl_add_u32 v3, v6, 6, v3
    v_and_b32 v6, 3, v0
    v_lshl_add_u32 v3, v6, 3, v3
    v_bfe_u32 v6, v0, 4, 1
    v_lshl_add_u32 v3, v6, 9, v3
    v_add_u32 v3, s21, v3
    v_lshlrev_b32 v6, 5, v6
    v_sub_u32 v4, 32, v6
    v_add_u32 v4, v4, v3
    v_add_u32 v3, v3, v6
    s_waitcnt vmcnt(0)
    ds_read_b64_tr_b16 v[96:97], v3 offset:0
    ds_read_b64_tr_b16 v[98:99], v3 offset:256
    ds_read_b64_tr_b16 v[100:101], v4 offset:0
    ds_read_b64_tr_b16 v[102:103], v4 offset:256
    ds_read_b64_tr_b16 v[104:105], v3 offset:2048
    ds_read_b64_tr_b16 v[106:107], v3 offset:2304
    ds_read_b64_tr_b16 v[108:109], v4 offset:2048
    ds_read_b64_tr_b16 v[110:111], v4 offset:2304
    s_waitcnt lgkmcnt(0)
    s_add_u32 m0, s21, 0
    s_add_u32 s64, s20, 0x480000
    buffer_load_dwordx4 v5, s[44:47], s64 offen lds
    s_add_u32 m0, s21, 1024
    s_add_u32 s64, s20, 0x4a0000
    buffer_load_dwordx4 v5, s[44:47], s64 offen lds
    s_add_u32 m0, s21, 2048
    s_add_u32 s64, s20, 0x4c0000
    buffer_load_dwordx4 v5, s[44:47], s64 offen lds
    s_add_u32 m0, s21, 3072
    s_add_u32 s64, s20, 0x4e0000
    buffer_load_dwordx4 v5, s[44:47], s64 offen lds
    ds_read_b64_tr_b16 v[112:113], v3 offset:4096
    ds_read_b64_tr_b16 v[114:115], v3 offset:4352
    ds_read_b64_tr_b16 v[116:117], v4 offset:4096
    ds_read_b64_tr_b16 v[118:119], v4 offset:4352
    ds_read_b64_tr_b16 v[120:121], v3 offset:6144
    ds_read_b64_tr_b16 v[122:123], v3 offset:6400
    ds_read_b64_tr_b16 v[124:125], v4 offset:6144
    ds_read_b64_tr_b16 v[126:127], v4 offset:6400
    s_waitcnt lgkmcnt(0)
    ds_read_b64_tr_b16 v[128:129], v3 offset:8192
    ds_read_b64_tr_b16 v[130:131], v3 offset:8448
    ds_read_b64_tr_b16 v[132:133], v4 offset:8192
    ds_read_b64_tr_b16 v[134:135], v4 offset:8448
    ds_read_b64_tr_b16 v[136:137], v3 offset:10240
    ds_read_b64_tr_b16 v[138:139], v3 offset:10496
    ds_read_b64_tr_b16 v[140:141], v4 offset:10240
    ds_read_b64_tr_b16 v[142:143], v4 offset:10496
    s_waitcnt lgkmcnt(0)
    ds_read_b64_tr_b16 v[144:145], v3 offset:12288
    ds_read_b64_tr_b16 v[146:147], v3 offset:12544
    ds_read_b64_tr_b16 v[148:149], v4 offset:12288
    ds_read_b64_tr_b16 v[150:151], v4 offset:12544
    ds_read_b64_tr_b16 v[152:153], v3 offset:14336
    ds_read_b64_tr_b16 v[154:155], v3 offset:14592
    ds_read_b64_tr_b16 v[156:157], v4 offset:14336
    ds_read_b64_tr_b16 v[158:159], v4 offset:14592
    s_waitcnt lgkmcnt(0)
    ds_read_b64_tr_b16 v[160:161], v3 offset:16384
    ds_read_b64_tr_b16 v[162:163], v3 offset:16640
    ds_read_b64_tr_b16 v[164:165], v4 offset:16384
    ds_read_b64_tr_b16 v[166:167], v4 offset:16640
    ds_read_b64_tr_b16 v[168:169], v3 offset:18432
    ds_read_b64_tr_b16 v[170:171], v3 offset:18688
    ds_read_b64_tr_b16 v[172:173], v4 offset:18432
    ds_read_b64_tr_b16 v[174:175], v4 offset:18688
    s_waitcnt lgkmcnt(0)
    ds_read_b64_tr_b16 v[176:177], v3 offset:20480
    ds_read_b64_tr_b16 v[178:179], v3 offset:20736
    ds_read_b64_tr_b16 v[180:181], v4 offset:20480
    ds_read_b64_tr_b16 v[182:183], v4 offset:20736
    ds_read_b64_tr_b16 v[184:185], v3 offset:22528
    ds_read_b64_tr_b16 v[186:187], v3 offset:22784
    ds_read_b64_tr_b16 v[188:189], v4 offset:22528
    ds_read_b64_tr_b16 v[190:191], v4 offset:22784
    s_waitcnt lgkmcnt(0)
    ds_read_b64_tr_b16 v[192:193], v3 offset:24576
    ds_read_b64_tr_b16 v[194:195], v3 offset:24832
    ds_read_b64_tr_b16 v[196:197], v4 offset:24576
    ds_read_b64_tr_b16 v[198:199], v4 offset:24832
    ds_read_b64_tr_b16 v[200:201], v3 offset:26624
    ds_read_b64_tr_b16 v[202:203], v3 offset:26880
    ds_read_b64_tr_b16 v[204:205], v4 offset:26624
    ds_read_b64_tr_b16 v[206:207], v4 offset:26880
    s_waitcnt lgkmcnt(0)
    ds_read_b64_tr_b16 v[208:209], v3 offset:28672
    ds_read_b64_tr_b16 v[210:211], v3 offset:28928
    ds_read_b64_tr_b16 v[212:213], v4 offset:28672
    ds_read_b64_tr_b16 v[214:215], v4 offset:28928
    ds_read_b64_tr_b16 v[216:217], v3 offset:30720
    ds_read_b64_tr_b16 v[218:219], v3 offset:30976
    ds_read_b64_tr_b16 v[220:221], v4 offset:30720
    ds_read_b64_tr_b16 v[222:223], v4 offset:30976
    s_waitcnt lgkmcnt(0)
    ds_read_b64_tr_b16 v[224:225], v3 offset:32768
    ds_read_b64_tr_b16 v[226:227], v3 offset:33024
    ds_read_b64_tr_b16 v[228:229], v4 offset:32768
    ds_read_b64_tr_b16 v[230:231], v4 offset:33024
    ds_read_b64_tr_b16 v[232:233], v3 offset:34816
    ds_read_b64_tr_b16 v[234:235], v3 offset:35072
    ds_read_b64_tr_b16 v[236:237], v4 offset:34816
    ds_read_b64_tr_b16 v[238:239], v4 offset:35072
    s_waitcnt lgkmcnt(0)
    s_waitcnt vmcnt(0)
    ds_read_b64_tr_b16 v[240:241], v3 offset:0
    ds_read_b64_tr_b16 v[242:243], v3 offset:256
    ds_read_b64_tr_b16 v[244:245], v4 offset:0
    ds_read_b64_tr_b16 v[246:247], v4 offset:256
    ds_read_b64_tr_b16 v[248:249], v3 offset:2048
    ds_read_b64_tr_b16 v[250:251], v3 offset:2304
    ds_read_b64_tr_b16 v[252:253], v4 offset:2048
    ds_read_b64_tr_b16 v[254:255], v4 offset:2304
    s_waitcnt lgkmcnt(0)
    s_cmp_lg_u32 s97, 0
    s_cbranch_scc1 CM_129
    v_mbcnt_lo_u32_b32 v0, -1, 0
    v_mbcnt_hi_u32_b32 v0, -1, v0
    v_mul_u32_u24 v8, 32, v0
    s_mov_b32 s64, 0x0
    s_mov_b32 s65, 0
    s_mov_b64 exec, 0xff
TK_130:
    buffer_load_dword v9, v8, s[60:63], s64 offen sc1
    s_add_u32 s65, s65, 1
    s_waitcnt vmcnt(0)
    s_mov_b32 s66, 0
    v_readlane_b32 s67, v9, 0
    s_add_u32 s66, s66, s67
    v_readlane_b32 s67, v9, 1
    s_add_u32 s66, s66, s67
    v_readlane_b32 s67, v9, 2
    s_add_u32 s66, s66, s67
    v_readlane_b32 s67, v9, 3
    s_add_u32 s66, s66, s67
    v_readlane_b32 s67, v9, 4
    s_add_u32 s66, s66, s67
    v_readlane_b32 s67, v9, 5
    s_add_u32 s66, s66, s67
    v_readlane_b32 s67, v9, 6
    s_add_u32 s66, s66, s67
    v_readlane_b32 s67, v9, 7
    s_add_u32 s66, s66, s67
    s_cmp_ge_u32 s66, 256
    s_cbranch_scc1 TKD_131
    s_cmp_gt_u32 s65, 262144
    s_cbranch_scc0 TK_130
TKD_131:
    v_cmp_ne_u32 vcc, 32, v9
    s_mov_b64 exec, -1
    s_cbranch_vccnz M_SLOW
CM_129:
    s_mov_b32 s65, 0
GI_132:
    buffer_load_dword v8, off, s[60:63], s95 sc1
    s_add_u32 s65, s65, 1
    s_waitcnt vmcnt(0)
    v_readfirstlane_b32 s64, v8
    s_cmp_ge_u32 s64, 192
    s_cbranch_scc1 GID_133
    s_cmp_gt_u32 s65, 65536
    s_cbranch_scc1 GID_133
    s_sleep 4
    s_branch GI_132
GID_133:
    v_mbcnt_lo_u32_b32 v0, -1, 0
    v_mbcnt_hi_u32_b32 v0, -1, v0
    s_waitcnt vmcnt(0)
    s_barrier
    s_cmp_lg_u32 s14, 0
    s_cbranch_scc1 INE_134
    s_cmp_lg_u32 s96, 10
    s_cbranch_scc1 ING_135
    v_mov_b32 v44, 1
    v_lshlrev_b32 v6, 7, v0
    s_mov_b32 s65, 0x29a000
    s_mov_b64 exec, 3
    buffer_store_dword v44, v6, s[4:7], s65 offen sc1
    s_mov_b64 exec, -1
    s_waitcnt vmcnt(0)
ING_135:
    v_mov_b32 v8, 1
    s_mov_b32 s65, 0x290800
    s_mov_b64 exec, 1
    buffer_atomic_add v8, off, s[4:7], s65 sc1
    s_mov_b64 exec, -1
INE_134:
    v_lshlrev_b32 v1, 4, v0
    v_lshrrev_b32 v6, 3, v0
    v_mul_u32_u24 v2, 1280, v6
    v_and_b32 v7, 7, v0
    v_xor_b32 v7, v7, v6
    v_lshl_add_u32 v2, v7, 4, v2
    v_bfe_u32 v6, v0, 3, 1
    v_lshlrev_b32 v9, 10, v6
    v_and_b32 v6, 7, v0
    v_lshl_add_u32 v9, v6, 7, v9
    v_lshrrev_b32 v7, 4, v0
    v_xor_b32 v7, v7, v6
    v_lshl_add_u32 v3, v7, 4, v9
    v_xor_b32 v7, 4, v7
    v_lshl_add_u32 v4, v7, 4, v9
    v_add_u32 v6, 0x10000, v3
    v_add_u32 v9, 0x10000, v4
    s_barrier
    s_mul_i32 s20, s12, 163840
    s_mul_i32 s64, s14, 40960
    s_add_u32 s20, s20, s64
    s_add_u32 s20, s20, 0x0
    s_lshl_b32 s21, s14, 12
    s_add_u32 m0, s21, 0
    s_add_u32 s64, s20, 0x0
    buffer_load_dwordx4 v2, s[4:7], s64 offen lds
    s_add_u32 m0, s21, 1024
    s_add_u32 s64, s20, 0x2800
    buffer_load_dwordx4 v2, s[4:7], s64 offen lds
    s_add_u32 m0, s21, 2048
    s_add_u32 s64, s20, 0x5000
    buffer_load_dwordx4 v2, s[4:7], s64 offen lds
    s_add_u32 m0, s21, 3072
    s_add_u32 s64, s20, 0x7800
    buffer_load_dwordx4 v2, s[4:7], s64 offen lds
    s_add_u32 m0, s21, 16384
    s_add_u32 s64, s20, 0x80
    buffer_load_dwordx4 v2, s[4:7], s64 offen lds
    s_add_u32 m0, s21, 17408
    s_add_u32 s64, s20, 0x2880
    buffer_load_dwordx4 v2, s[4:7], s64 offen lds
    s_add_u32 m0, s21, 18432
    s_add_u32 s64, s20, 0x5080
    buffer_load_dwordx4 v2, s[4:7], s64 offen lds
    s_add_u32 m0, s21, 19456
    s_add_u32 s64, s20, 0x7880
    buffer_load_dwordx4 v2, s[4:7], s64 offen lds
    s_add_u32 m0, s21, 32768
    s_add_u32 s64, s20, 0x100
    buffer_load_dwordx4 v2, s[4:7], s64 offen lds
    s_add_u32 m0, s21, 33792
    s_add_u32 s64, s20, 0x2900
    buffer_load_dwordx4 v2, s[4:7], s64 offen lds
    s_add_u32 m0, s21, 34816
    s_add_u32 s64, s20, 0x5100
    buffer_load_dwordx4 v2, s[4:7], s64 offen lds
    s_add_u32 m0, s21, 35840
    s_add_u32 s64, s20, 0x7900
    buffer_load_dwordx4 v2, s[4:7], s64 offen lds
    s_add_u32 m0, s21, 49152
    s_add_u32 s64, s20, 0x180
    buffer_load_dwordx4 v2, s[4:7], s64 offen lds
    s_add_u32 m0, s21, 50176
    s_add_u32 s64, s20, 0x2980
    buffer_load_dwordx4 v2, s[4:7], s64 offen lds
    s_add_u32 m0, s21, 51200
    s_add_u32 s64, s20, 0x5180
    buffer_load_dwordx4 v2, s[4:7], s64 offen lds
    s_add_u32 m0, s21, 52224
    s_add_u32 s64, s20, 0x7980
    buffer_load_dwordx4 v2, s[4:7], s64 offen lds
    s_mov_b32 s64, 0x40000000
    buffer_store_dword v7, v1, s[4:7], s64 offen
    buffer_store_dword v7, v1, s[4:7], s64 offen
    buffer_store_dword v7, v1, s[4:7], s64 offen
    buffer_store_dword v7, v1, s[4:7], s64 offen
    buffer_store_dword v7, v1, s[4:7], s64 offen
    buffer_store_dword v7, v1, s[4:7], s64 offen
    buffer_store_dword v7, v1, s[4:7], s64 offen
    buffer_store_dword v7, v1, s[4:7], s64 offen
    s_waitcnt vmcnt(20)
    s_barrier
    ds_read_b128 a[0:3], v3 offset:0
    ds_read_b128 a[4:7], v3 offset:2048
    ds_read_b128 a[8:11], v3 offset:4096
    ds_read_b128 a[12:15], v3 offset:6144
    ds_read_b128 a[16:19], v3 offset:8192
    ds_read_b128 a[20:23], v3 offset:10240
    ds_read_b128 a[24:27], v3 offset:12288
    ds_read_b128 a[28:31], v3 offset:14336
    s_mov_b32 s19, 0
    s_mov_b32 s22, s16
    s_mov_b32 s23, 0x40000000
G_N_LOOP:
    s_waitcnt lgkmcnt(4)
    v_mfma_f32_16x16x32_bf16 v[16:19], a[0:3], v[96:99], 0
    v_mfma_f32_16x16x32_bf16 v[20:23], a[0:3], v[100:103], 0
    ds_read_b128 a[32:35], v4 offset:0
    v_mfma_f32_16x16x32_bf16 v[24:27], a[4:7], v[96:99], 0
    v_mfma_f32_16x16x32_bf16 v[28:31], a[4:7], v[100:103], 0
    ds_read_b128 a[36:39], v4 offset:2048
    v_mfma_f32_16x16x32_bf16 v[32:35], a[8:11], v[96:99], 0
    v_mfma_f32_16x16x32_bf16 v[36:39], a[8:11], v[100:103], 0
    ds_read_b128 a[40:43], v4 offset:4096
    v_mfma_f32_16x16x32_bf16 v[40:43], a[12:15], v[96:99], 0
    v_mfma_f32_16x16x32_bf16 v[44:47], a[12:15], v[100:103], 0
    ds_read_b128 a[44:47], v4 offset:6144
    s_waitcnt lgkmcnt(4)
    v_mfma_f32_16x16x32_bf16 v[48:51], a[16:19], v[96:99], 0
    v_mfma_f32_16x16x32_bf16 v[52:55], a[16:19], v[100:103], 0
    ds_read_b128 a[48:51], v4 offset:8192
    v_mfma_f32_16x16x32_bf16 v[56:59], a[20:23], v[96:99], 0
    v_mfma_f32_16x16x32_bf16 v[60:63], a[20:23], v[100:103], 0
    ds_read_b128 a[52:55], v4 offset:10240
    v_mfma_f32_16x16x32_bf16 v[64:67], a[24:27], v[96:99], 0
    v_mfma_f32_16x16x32_bf16 v[68:71], a[24:27], v[100:103], 0
    ds_read_b128 a[56:59], v4 offset:12288
    v_mfma_f32_16x16x32_bf16 v[72:75], a[28:31], v[96:99], 0
    v_mfma_f32_16x16x32_bf16 v[76:79], a[28:31], v[100:103], 0
    ds_read_b128 a[60:63], v4 offset:14336
    s_waitcnt vmcnt(16)
    s_barrier
    s_waitcnt lgkmcnt(4)
    v_mfma_f32_16x16x32_bf16 v[16:19], a[32:35], v[104:107], v[16:19]
    v_mfma_f32_16x16x32_bf16 v[20:23], a[32:35], v[108:111], v[20:23]
    ds_read_b128 a[0:3], v3 offset:16384
    s_add_u32 m0, s21, 65536
    v_mfma_f32_16x16x32_bf16 v[24:27], a[36:39], v[104:107], v[24:27]
    v_mfma_f32_16x16x32_bf16 v[28:31], a[36:39], v[108:111], v[28:31]
    ds_read_b128 a[4:7], v3 offset:18432
    s_add_u32 s64, s20, 0x200
    buffer_load_dwordx4 v2, s[4:7], s64 offen lds
    v_mfma_f32_16x16x32_bf16 v[32:35], a[40:43], v[104:107], v[32:35]
    v_mfma_f32_16x16x32_bf16 v[36:39], a[40:43], v[108:111], v[36:39]
    ds_read_b128 a[8:11], v3 offset:20480
    s_add_u32 m0, s21, 66560
    v_mfma_f32_16x16x32_bf16 v[40:43], a[44:47], v[104:107], v[40:43]
    v_mfma_f32_16x16x32_bf16 v[44:47], a[44:47], v[108:111], v[44:47]
    ds_read_b128 a[12:15], v3 offset:22528
    s_add_u32 s64, s20, 0x2a00
    buffer_load_dwordx4 v2, s[4:7], s64 offen lds
    s_waitcnt lgkmcnt(4)
    v_mfma_f32_16x16x32_bf16 v[48:51], a[48:51], v[104:107], v[48:51]
    v_mfma_f32_16x16x32_bf16 v[52:55], a[48:51], v[108:111], v[52:55]
    ds_read_b128 a[16:19], v3 offset:24576
    s_add_u32 m0, s21, 67584
    v_mfma_f32_16x16x32_bf16 v[56:59], a[52:55], v[104:107], v[56:59]
    v_mfma_f32_16x16x32_bf16 v[60:63], a[52:55], v[108:111], v[60:63]
    ds_read_b128 a[20:23], v3 offset:26624
    s_add_u32 s64, s20, 0x5200
    buffer_load_dwordx4 v2, s[4:7], s64 offen lds
    v_mfma_f32_16x16x32_bf16 v[64:67], a[56:59], v[104:107], v[64:67]
    v_mfma_f32_16x16x32_bf16 v[68:71], a[56:59], v[108:111], v[68:71]
    ds_read_b128 a[24:27], v3 offset:28672
    s_add_u32 m0, s21, 68608
    v_mfma_f32_16x16x32_bf16 v[72:75], a[60:63], v[104:107], v[72:75]
    v_mfma_f32_16x16x32_bf16 v[76:79], a[60:63], v[108:111], v[76:79]
    ds_read_b128 a[28:31], v3 offset:30720
    s_add_u32 s64, s20, 0x7a00
    buffer_load_dwordx4 v2, s[4:7], s64 offen lds
    s_waitcnt lgkmcnt(4)
    v_mfma_f32_16x16x32_bf16 v[16:19], a[0:3], v[112:115], v[16:19]
    v_mfma_f32_16x16x32_bf16 v[20:23], a[0:3], v[116:119], v[20:23]
    ds_read_b128 a[32:35], v4 offset:16384
    v_mfma_f32_16x16x32_bf16 v[24:27], a[4:7], v[112:115], v[24:27]
    v_mfma_f32_16x16x32_bf16 v[28:31], a[4:7], v[116:119], v[28:31]
    ds_read_b128 a[36:39], v4 offset:18432
    v_mfma_f32_16x16x32_bf16 v[32:35], a[8:11], v[112:115], v[32:35]
    v_mfma_f32_16x16x32_bf16 v[36:39], a[8:11], v[116:119], v[36:39]
    ds_read_b128 a[40:43], v4 offset:20480
    v_mfma_f32_16x16x32_bf16 v[40:43], a[12:15], v[112:115], v[40:43]
    v_mfma_f32_16x16x32_bf16 v[44:47], a[12:15], v[116:119], v[44:47]
    ds_read_b128 a[44:47], v4 offset:22528
    s_waitcnt lgkmcnt(4)
    v_mfma_f32_16x16x32_bf16 v[48:51], a[16:19], v[112:115], v[48:51]
    v_mfma_f32_16x16x32_bf16 v[52:55], a[16:19], v[116:119], v[52:55]
    ds_read_b128 a[48:51], v4 offset:24576
    v_mfma_f32_16x16x32_bf16 v[56:59], a[20:23], v[112:115], v[56:59]
    v_mfma_f32_16x16x32_bf16 v[60:63], a[20:23], v[116:119], v[60:63]
    ds_read_b128 a[52:55], v4 offset:26624
    v_mfma_f32_16x16x32_bf16 v[64:67], a[24:27], v[112:115], v[64:67]
    v_mfma_f32_16x16x32_bf16 v[68:71], a[24:27], v[116:119], v[68:71]
    ds_read_b128 a[56:59], v4 offset:28672
    v_mfma_f32_16x16x32_bf16 v[72:75], a[28:31], v[112:115], v[72:75]
    v_mfma_f32_16x16x32_bf16 v[76:79], a[28:31], v[116:119], v[76:79]
    ds_read_b128 a[60:63], v4 offset:30720
    s_waitcnt vmcnt(16)
    s_barrier
    s_waitcnt lgkmcnt(4)
    v_mfma_f32_16x16x32_bf16 v[16:19], a[32:35], v[120:123], v[16:19]
    v_mfma_f32_16x16x32_bf16 v[20:23], a[32:35], v[124:127], v[20:23]
    ds_read_b128 a[0:3], v3 offset:32768
    s_add_u32 m0, s21, 0
    v_mfma_f32_16x16x32_bf16 v[24:27], a[36:39], v[120:123], v[24:27]
    v_mfma_f32_16x16x32_bf16 v[28:31], a[36:39], v[124:127], v[28:31]
    ds_read_b128 a[4:7], v3 offset:34816
    s_add_u32 s64, s20, 0x280
    buffer_load_dwordx4 v2, s[4:7], s64 offen lds
    v_mfma_f32_16x16x32_bf16 v[32:35], a[40:43], v[120:123], v[32:35]
    v_mfma_f32_16x16x32_bf16 v[36:39], a[40:43], v[124:127], v[36:39]
    ds_read_b128 a[8:11], v3 offset:36864
    s_add_u32 m0, s21, 1024
    v_mfma_f32_16x16x32_bf16 v[40:43], a[44:47], v[120:123], v[40:43]
    v_mfma_f32_16x16x32_bf16 v[44:47], a[44:47], v[124:127], v[44:47]
    ds_read_b128 a[12:15], v3 offset:38912
    s_add_u32 s64, s20, 0x2a80
    buffer_load_dwordx4 v2, s[4:7], s64 offen lds
    s_waitcnt lgkmcnt(4)
    v_mfma_f32_16x16x32_bf16 v[48:51], a[48:51], v[120:123], v[48:51]
    v_mfma_f32_16x16x32_bf16 v[52:55], a[48:51], v[124:127], v[52:55]
    ds_read_b128 a[16:19], v3 offset:40960
    s_add_u32 m0, s21, 2048
    v_mfma_f32_16x16x32_bf16 v[56:59], a[52:55], v[120:123], v[56:59]
    v_mfma_f32_16x16x32_bf16 v[60:63], a[52:55], v[124:127], v[60:63]
    ds_read_b128 a[20:23], v3 offset:43008
    s_add_u32 s64, s20, 0x5280
    buffer_load_dwordx4 v2, s[4:7], s64 offen lds
    v_mfma_f32_16x16x32_bf16 v[64:67], a[56:59], v[120:123], v[64:67]
    v_mfma_f32_16x16x32_bf16 v[68:71], a[56:59], v[124:127], v[68:71]
    ds_read_b128 a[24:27], v3 offset:45056
    s_add_u32 m0, s21, 3072
    v_mfma_f32_16x16x32_bf16 v[72:75], a[60:63], v[120:123], v[72:75]
    v_mfma_f32_16x16x32_bf16 v[76:79], a[60:63], v[124:127], v[76:79]
    ds_read_b128 a[28:31], v3 offset:47104
    s_add_u32 s64, s20, 0x7a80
    buffer_load_dwordx4 v2, s[4:7], s64 offen lds
    s_waitcnt lgkmcnt(4)
    v_mfma_f32_16x16x32_bf16 v[16:19], a[0:3], v[128:131], v[16:19]
    v_mfma_f32_16x16x32_bf16 v[20:23], a[0:3], v[132:135], v[20:23]
    ds_read_b128 a[32:35], v4 offset:32768
    v_mfma_f32_16x16x32_bf16 v[24:27], a[4:7], v[128:131], v[24:27]
    v_mfma_f32_16x16x32_bf16 v[28:31], a[4:7], v[132:135], v[28:31]
    ds_read_b128 a[36:39], v4 offset:34816
    v_mfma_f32_16x16x32_bf16 v[32:35], a[8:11], v[128:131], v[32:35]
    v_mfma_f32_16x16x32_bf16 v[36:39], a[8:11], v[132:135], v[36:39]
    ds_read_b128 a[40:43], v4 offset:36864
    v_mfma_f32_16x16x32_bf16 v[40:43], a[12:15], v[128:131], v[40:43]
    v_mfma_f32_16x16x32_bf16 v[44:47], a[12:15], v[132:135], v[44:47]
    ds_read_b128 a[44:47], v4 offset:38912
    s_waitcnt lgkmcnt(4)
    v_mfma_f32_16x16x32_bf16 v[48:51], a[16:19], v[128:131], v[48:51]
    v_mfma_f32_16x16x32_bf16 v[52:55], a[16:19], v[132:135], v[52:55]
    ds_read_b128 a[48:51], v4 offset:40960
    v_mfma_f32_16x16x32_bf16 v[56:59], a[20:23], v[128:131], v[56:59]
    v_mfma_f32_16x16x32_bf16 v[60:63], a[20:23], v[132:135], v[60:63]
    ds_read_b128 a[52:55], v4 offset:43008
    v_mfma_f32_16x16x32_bf16 v[64:67], a[24:27], v[128:131], v[64:67]
    v_mfma_f32_16x16x32_bf16 v[68:71], a[24:27], v[132:135], v[68:71]
    ds_read_b128 a[56:59], v4 offset:45056
    v_mfma_f32_16x16x32_bf16 v[72:75], a[28:31], v[128:131], v[72:75]
    v_mfma_f32_16x16x32_bf16 v[76:79], a[28:31], v[132:135], v[76:79]
    ds_read_b128 a[60:63], v4 offset:47104
    s_waitcnt vmcnt(16)
    s_barrier
    s_waitcnt lgkmcnt(4)
    v_mfma_f32_16x16x32_bf16 v[16:19], a[32:35], v[136:139], v[16:19]
    v_mfma_f32_16x16x32_bf16 v[20:23], a[32:35], v[140:143], v[20:23]
    ds_read_b128 a[0:3], v3 offset:49152
    s_add_u32 m0, s21, 16384
    v_mfma_f32_16x16x32_bf16 v[24:27], a[36:39], v[136:139], v[24:27]
    v_mfma_f32_16x16x32_bf16 v[28:31], a[36:39], v[140:143], v[28:31]
    ds_read_b128 a[4:7], v3 offset:51200
    s_add_u32 s64, s20, 0x300
    buffer_load_dwordx4 v2, s[4:7], s64 offen lds
    v_mfma_f32_16x16x32_bf16 v[32:35], a[40:43], v[136:139], v[32:35]
    v_mfma_f32_16x16x32_bf16 v[36:39], a[40:43], v[140:143], v[36:39]
    ds_read_b128 a[8:11], v3 offset:53248
    s_add_u32 m0, s21, 17408
    v_mfma_f32_16x16x32_bf16 v[40:43], a[44:47], v[136:139], v[40:43]
    v_mfma_f32_16x16x32_bf16 v[44:47], a[44:47], v[140:143], v[44:47]
    ds_read_b128 a[12:15], v3 offset:55296
    s_add_u32 s64, s20, 0x2b00
    buffer_load_dwordx4 v2, s[4:7], s64 offen lds
    s_waitcnt lgkmcnt(4)
    v_mfma_f32_16x16x32_bf16 v[48:51], a[48:51], v[136:139], v[48:51]
    v_mfma_f32_16x16x32_bf16 v[52:55], a[48:51], v[140:143], v[52:55]
    ds_read_b128 a[16:19], v3 offset:57344
    s_add_u32 m0, s21, 18432
    v_mfma_f32_16x16x32_bf16 v[56:59], a[52:55], v[136:139], v[56:59]
    v_mfma_f32_16x16x32_bf16 v[60:63], a[52:55], v[140:143], v[60:63]
    ds_read_b128 a[20:23], v3 offset:59392
    s_add_u32 s64, s20, 0x5300
    buffer_load_dwordx4 v2, s[4:7], s64 offen lds
    v_mfma_f32_16x16x32_bf16 v[64:67], a[56:59], v[136:139], v[64:67]
    v_mfma_f32_16x16x32_bf16 v[68:71], a[56:59], v[140:143], v[68:71]
    ds_read_b128 a[24:27], v3 offset:61440
    s_add_u32 m0, s21, 19456
    v_mfma_f32_16x16x32_bf16 v[72:75], a[60:63], v[136:139], v[72:75]
    v_mfma_f32_16x16x32_bf16 v[76:79], a[60:63], v[140:143], v[76:79]
    ds_read_b128 a[28:31], v3 offset:63488
    s_add_u32 s64, s20, 0x7b00
    buffer_load_dwordx4 v2, s[4:7], s64 offen lds
    s_waitcnt lgkmcnt(4)
    v_mfma_f32_16x16x32_bf16 v[16:19], a[0:3], v[144:147], v[16:19]
    v_mfma_f32_16x16x32_bf16 v[20:23], a[0:3], v[148:151], v[20:23]
    ds_read_b128 a[32:35], v4 offset:49152
    v_mfma_f32_16x16x32_bf16 v[24:27], a[4:7], v[144:147], v[24:27]
    v_mfma_f32_16x16x32_bf16 v[28:31], a[4:7], v[148:151], v[28:31]
    ds_read_b128 a[36:39], v4 offset:51200
    v_mfma_f32_16x16x32_bf16 v[32:35], a[8:11], v[144:147], v[32:35]
    v_mfma_f32_16x16x32_bf16 v[36:39], a[8:11], v[148:151], v[36:39]
    ds_read_b128 a[40:43], v4 offset:53248
    v_mfma_f32_16x16x32_bf16 v[40:43], a[12:15], v[144:147], v[40:43]
    v_mfma_f32_16x16x32_bf16 v[44:47], a[12:15], v[148:151], v[44:47]
    ds_read_b128 a[44:47], v4 offset:55296
    s_waitcnt lgkmcnt(4)
    v_mfma_f32_16x16x32_bf16 v[48:51], a[16:19], v[144:147], v[48:51]
    v_mfma_f32_16x16x32_bf16 v[52:55], a[16:19], v[148:151], v[52:55]
    ds_read_b128 a[48:51], v4 offset:57344
    v_mfma_f32_16x16x32_bf16 v[56:59], a[20:23], v[144:147], v[56:59]
    v_mfma_f32_16x16x32_bf16 v[60:63], a[20:23], v[148:151], v[60:63]
    ds_read_b128 a[52:55], v4 offset:59392
    v_mfma_f32_16x16x32_bf16 v[64:67], a[24:27], v[144:147], v[64:67]
    v_mfma_f32_16x16x32_bf16 v[68:71], a[24:27], v[148:151], v[68:71]
    ds_read_b128 a[56:59], v4 offset:61440
    v_mfma_f32_16x16x32_bf16 v[72:75], a[28:31], v[144:147], v[72:75]
    v_mfma_f32_16x16x32_bf16 v[76:79], a[28:31], v[148:151], v[76:79]
    ds_read_b128 a[60:63], v4 offset:63488
    s_waitcnt vmcnt(8)
    s_barrier
    s_cmp_lg_u32 s14, 0
    s_cbranch_scc1 GF_136
    v_mov_b32 v7, 1
    v_mov_b32 v8, 0
    s_mov_b64 exec, 1
    buffer_store_dword v7, v8, s[4:7], s23 offen sc1
    s_mov_b64 exec, -1
GF_136:
    s_waitcnt lgkmcnt(4)
    v_mfma_f32_16x16x32_bf16 v[16:19], a[32:35], v[152:155], v[16:19]
    v_mfma_f32_16x16x32_bf16 v[20:23], a[32:35], v[156:159], v[20:23]
    ds_read_b128 a[0:3], v6 offset:0
    s_add_u32 m0, s21, 32768
    v_mfma_f32_16x16x32_bf16 v[24:27], a[36:39], v[152:155], v[24:27]
    v_mfma_f32_16x16x32_bf16 v[28:31], a[36:39], v[156:159], v[28:31]
    ds_read_b128 a[4:7], v6 offset:2048
    s_add_u32 s64, s20, 0x380
    buffer_load_dwordx4 v2, s[4:7], s64 offen lds
    v_mfma_f32_16x16x32_bf16 v[32:35], a[40:43], v[152:155], v[32:35]
    v_mfma_f32_16x16x32_bf16 v[36:39], a[40:43], v[156:159], v[36:39]
    ds_read_b128 a[8:11], v6 offset:4096
    s_add_u32 m0, s21, 33792
    v_mfma_f32_16x16x32_bf16 v[40:43], a[44:47], v[152:155], v[40:43]
    v_mfma_f32_16x16x32_bf16 v[44:47], a[44:47], v[156:159], v[44:47]
    ds_read_b128 a[12:15], v6 offset:6144
    s_add_u32 s64, s20, 0x2b80
    buffer_load_dwordx4 v2, s[4:7], s64 offen lds
    s_waitcnt lgkmcnt(4)
    v_mfma_f32_16x16x32_bf16 v[48:51], a[48:51], v[152:155], v[48:51]
    v_mfma_f32_16x16x32_bf16 v[52:55], a[48:51], v[156:159], v[52:55]
    ds_read_b128 a[16:19], v6 offset:8192
    s_add_u32 m0, s21, 34816
    v_mfma_f32_16x16x32_bf16 v[56:59], a[52:55], v[152:155], v[56:59]
    v_mfma_f32_16x16x32_bf16 v[60:63], a[52:55], v[156:159], v[60:63]
    ds_read_b128 a[20:23], v6 offset:10240
    s_add_u32 s64, s20, 0x5380
    buffer_load_dwordx4 v2, s[4:7], s64 offen lds
    v_mfma_f32_16x16x32_bf16 v[64:67], a[56:59], v[152:155], v[64:67]
    v_mfma_f32_16x16x32_bf16 v[68:71], a[56:59], v[156:159], v[68:71]
    ds_read_b128 a[24:27], v6 offset:12288
    s_add_u32 m0, s21, 35840
    v_mfma_f32_16x16x32_bf16 v[72:75], a[60:63], v[152:155], v[72:75]
    v_mfma_f32_16x16x32_bf16 v[76:79], a[60:63], v[156:159], v[76:79]
    ds_read_b128 a[28:31], v6 offset:14336
    s_add_u32 s64, s20, 0x7b80
    buffer_load_dwordx4 v2, s[4:7], s64 offen lds
    s_waitcnt lgkmcnt(4)
    v_mfma_f32_16x16x32_bf16 v[16:19], a[0:3], v[160:163], v[16:19]
    v_mfma_f32_16x16x32_bf16 v[20:23], a[0:3], v[164:167], v[20:23]
    ds_read_b128 a[32:35], v9 offset:0
    v_mfma_f32_16x16x32_bf16 v[24:27], a[4:7], v[160:163], v[24:27]
    v_mfma_f32_16x16x32_bf16 v[28:31], a[4:7], v[164:167], v[28:31]
    ds_read_b128 a[36:39], v9 offset:2048
    v_mfma_f32_16x16x32_bf16 v[32:35], a[8:11], v[160:163], v[32:35]
    v_mfma_f32_16x16x32_bf16 v[36:39], a[8:11], v[164:167], v[36:39]
    ds_read_b128 a[40:43], v9 offset:4096
    v_mfma_f32_16x16x32_bf16 v[40:43], a[12:15], v[160:163], v[40:43]
    v_mfma_f32_16x16x32_bf16 v[44:47], a[12:15], v[164:167], v[44:47]
    ds_read_b128 a[44:47], v9 offset:6144
    s_waitcnt lgkmcnt(4)
    v_mfma_f32_16x16x32_bf16 v[48:51], a[16:19], v[160:163], v[48:51]
    v_mfma_f32_16x16x32_bf16 v[52:55], a[16:19], v[164:167], v[52:55]
    ds_read_b128 a[48:51], v9 offset:8192
    v_mfma_f32_16x16x32_bf16 v[56:59], a[20:23], v[160:163], v[56:59]
    v_mfma_f32_16x16x32_bf16 v[60:63], a[20:23], v[164:167], v[60:63]
    ds_read_b128 a[52:55], v9 offset:10240
    v_mfma_f32_16x16x32_bf16 v[64:67], a[24:27], v[160:163], v[64:67]
    v_mfma_f32_16x16x32_bf16 v[68:71], a[24:27], v[164:167], v[68:71]
    ds_read_b128 a[56:59], v9 offset:12288
    v_mfma_f32_16x16x32_bf16 v[72:75], a[28:31], v[160:163], v[72:75]
    v_mfma_f32_16x16x32_bf16 v[76:79], a[28:31], v[164:167], v[76:79]
    ds_read_b128 a[60:63], v9 offset:14336
    s_waitcnt vmcnt(8)
    s_barrier
    s_waitcnt lgkmcnt(4)
    v_mfma_f32_16x16x32_bf16 v[16:19], a[32:35], v[168:171], v[16:19]
    v_mfma_f32_16x16x32_bf16 v[20:23], a[32:35], v[172:175], v[20:23]
    ds_read_b128 a[0:3], v3 offset:0
    s_add_u32 m0, s21, 49152
    v_mfma_f32_16x16x32_bf16 v[24:27], a[36:39], v[168:171], v[24:27]
    v_mfma_f32_16x16x32_bf16 v[28:31], a[36:39], v[172:175], v[28:31]
    ds_read_b128 a[4:7], v3 offset:2048
    s_add_u32 s64, s20, 0x400
    buffer_load_dwordx4 v2, s[4:7], s64 offen lds
    v_mfma_f32_16x16x32_bf16 v[32:35], a[40:43], v[168:171], v[32:35]
    v_mfma_f32_16x16x32_bf16 v[36:39], a[40:43], v[172:175], v[36:39]
    ds_read_b128 a[8:11], v3 offset:4096
    s_add_u32 m0, s21, 50176
    v_mfma_f32_16x16x32_bf16 v[40:43], a[44:47], v[168:171], v[40:43]
    v_mfma_f32_16x16x32_bf16 v[44:47], a[44:47], v[172:175], v[44:47]
    ds_read_b128 a[12:15], v3 offset:6144
    s_add_u32 s64, s20, 0x2c00
    buffer_load_dwordx4 v2, s[4:7], s64 offen lds
    s_waitcnt lgkmcnt(4)
    v_mfma_f32_16x16x32_bf16 v[48:51], a[48:51], v[168:171], v[48:51]
    v_mfma_f32_16x16x32_bf16 v[52:55], a[48:51], v[172:175], v[52:55]
    ds_read_b128 a[16:19], v3 offset:8192
    s_add_u32 m0, s21, 51200
    v_mfma_f32_16x16x32_bf16 v[56:59], a[52:55], v[168:171], v[56:59]
    v_mfma_f32_16x16x32_bf16 v[60:63], a[52:55], v[172:175], v[60:63]
    ds_read_b128 a[20:23], v3 offset:10240
    s_add_u32 s64, s20, 0x5400
    buffer_load_dwordx4 v2, s[4:7], s64 offen lds
    v_mfma_f32_16x16x32_bf16 v[64:67], a[56:59], v[168:171], v[64:67]
    v_mfma_f32_16x16x32_bf16 v[68:71], a[56:59], v[172:175], v[68:71]
    ds_read_b128 a[24:27], v3 offset:12288
    s_add_u32 m0, s21, 52224
    v_mfma_f32_16x16x32_bf16 v[72:75], a[60:63], v[168:171], v[72:75]
    v_mfma_f32_16x16x32_bf16 v[76:79], a[60:63], v[172:175], v[76:79]
    ds_read_b128 a[28:31], v3 offset:14336
    s_add_u32 s64, s20, 0x7c00
    buffer_load_dwordx4 v2, s[4:7], s64 offen lds
    s_waitcnt lgkmcnt(4)
    v_mfma_f32_16x16x32_bf16 v[16:19], a[0:3], v[176:179], v[16:19]
    v_mfma_f32_16x16x32_bf16 v[20:23], a[0:3], v[180:183], v[20:23]
    ds_read_b128 a[32:35], v4 offset:0
    v_mfma_f32_16x16x32_bf16 v[24:27], a[4:7], v[176:179], v[24:27]
    v_mfma_f32_16x16x32_bf16 v[28:31], a[4:7], v[180:183], v[28:31]
    ds_read_b128 a[36:39], v4 offset:2048
    v_mfma_f32_16x16x32_bf16 v[32:35], a[8:11], v[176:179], v[32:35]
    v_mfma_f32_16x16x32_bf16 v[36:39], a[8:11], v[180:183], v[36:39]
    ds_read_b128 a[40:43], v4 offset:4096
    v_mfma_f32_16x16x32_bf16 v[40:43], a[12:15], v[176:179], v[40:43]
    v_mfma_f32_16x16x32_bf16 v[44:47], a[12:15], v[180:183], v[44:47]
    ds_read_b128 a[44:47], v4 offset:6144
    s_waitcnt lgkmcnt(4)
    v_mfma_f32_16x16x32_bf16 v[48:51], a[16:19], v[176:179], v[48:51]
    v_mfma_f32_16x16x32_bf16 v[52:55], a[16:19], v[180:183], v[52:55]
    ds_read_b128 a[48:51], v4 offset:8192
    v_mfma_f32_16x16x32_bf16 v[56:59], a[20:23], v[176:179], v[56:59]
    v_mfma_f32_16x16x32_bf16 v[60:63], a[20:23], v[180:183], v[60:63]
    ds_read_b128 a[52:55], v4 offset:10240
    v_mfma_f32_16x16x32_bf16 v[64:67], a[24:27], v[176:179], v[64:67]
    v_mfma_f32_16x16x32_bf16 v[68:71], a[24:27], v[180:183], v[68:71]
    ds_read_b128 a[56:59], v4 offset:12288
    v_mfma_f32_16x16x32_bf16 v[72:75], a[28:31], v[176:179], v[72:75]
    v_mfma_f32_16x16x32_bf16 v[76:79], a[28:31], v[180:183], v[76:79]
    ds_read_b128 a[60:63], v4 offset:14336
    s_waitcnt vmcnt(8)
    s_barrier
    s_waitcnt lgkmcnt(4)
    v_mfma_f32_16x16x32_bf16 v[16:19], a[32:35], v[184:187], v[16:19]
    v_mfma_f32_16x16x32_bf16 v[20:23], a[32:35], v[188:191], v[20:23]
    ds_read_b128 a[0:3], v3 offset:16384
    s_add_u32 m0, s21, 65536
    v_mfma_f32_16x16x32_bf16 v[24:27], a[36:39], v[184:187], v[24:27]
    v_mfma_f32_16x16x32_bf16 v[28:31], a[36:39], v[188:191], v[28:31]
    ds_read_b128 a[4:7], v3 offset:18432
    s_add_u32 s64, s20, 0x480
    buffer_load_dwordx4 v2, s[4:7], s64 offen lds
    v_mfma_f32_16x16x32_bf16 v[32:35], a[40:43], v[184:187], v[32:35]
    v_mfma_f32_16x16x32_bf16 v[36:39], a[40:43], v[188:191], v[36:39]
    ds_read_b128 a[8:11], v3 offset:20480
    s_add_u32 m0, s21, 66560
    v_mfma_f32_16x16x32_bf16 v[40:43], a[44:47], v[184:187], v[40:43]
    v_mfma_f32_16x16x32_bf16 v[44:47], a[44:47], v[188:191], v[44:47]
    ds_read_b128 a[12:15], v3 offset:22528
    s_add_u32 s64, s20, 0x2c80
    buffer_load_dwordx4 v2, s[4:7], s64 offen lds
    s_waitcnt lgkmcnt(4)
    v_mfma_f32_16x16x32_bf16 v[48:51], a[48:51], v[184:187], v[48:51]
    v_mfma_f32_16x16x32_bf16 v[52:55], a[48:51], v[188:191], v[52:55]
    ds_read_b128 a[16:19], v3 offset:24576
    s_add_u32 m0, s21, 67584
    v_mfma_f32_16x16x32_bf16 v[56:59], a[52:55], v[184:187], v[56:59]
    v_mfma_f32_16x16x32_bf16 v[60:63], a[52:55], v[188:191], v[60:63]
    ds_read_b128 a[20:23], v3 offset:26624
    s_add_u32 s64, s20, 0x5480
    buffer_load_dwordx4 v2, s[4:7], s64 offen lds
    v_mfma_f32_16x16x32_bf16 v[64:67], a[56:59], v[184:187], v[64:67]
    v_mfma_f32_16x16x32_bf16 v[68:71], a[56:59], v[188:191], v[68:71]
    ds_read_b128 a[24:27], v3 offset:28672
    s_add_u32 m0, s21, 68608
    v_mfma_f32_16x16x32_bf16 v[72:75], a[60:63], v[184:187], v[72:75]
    v_mfma_f32_16x16x32_bf16 v[76:79], a[60:63], v[188:191], v[76:79]
    ds_read_b128 a[28:31], v3 offset:30720
    s_add_u32 s64, s20, 0x7c80
    buffer_load_dwordx4 v2, s[4:7], s64 offen lds
    s_waitcnt lgkmcnt(4)
    v_mfma_f32_16x16x32_bf16 v[16:19], a[0:3], v[192:195], v[16:19]
    v_mfma_f32_16x16x32_bf16 v[20:23], a[0:3], v[196:199], v[20:23]
    ds_read_b128 a[32:35], v4 offset:16384
    v_mfma_f32_16x16x32_bf16 v[24:27], a[4:7], v[192:195], v[24:27]
    v_mfma_f32_16x16x32_bf16 v[28:31], a[4:7], v[196:199], v[28:31]
    ds_read_b128 a[36:39], v4 offset:18432
    v_mfma_f32_16x16x32_bf16 v[32:35], a[8:11], v[192:195], v[32:35]
    v_mfma_f32_16x16x32_bf16 v[36:39], a[8:11], v[196:199], v[36:39]
    ds_read_b128 a[40:43], v4 offset:20480
    v_mfma_f32_16x16x32_bf16 v[40:43], a[12:15], v[192:195], v[40:43]
    v_mfma_f32_16x16x32_bf16 v[44:47], a[12:15], v[196:199], v[44:47]
    ds_read_b128 a[44:47], v4 offset:22528
    s_waitcnt lgkmcnt(4)
    v_mfma_f32_16x16x32_bf16 v[48:51], a[16:19], v[192:195], v[48:51]
    v_mfma_f32_16x16x32_bf16 v[52:55], a[16:19], v[196:199], v[52:55]
    ds_read_b128 a[48:51], v4 offset:24576
    v_mfma_f32_16x16x32_bf16 v[56:59], a[20:23], v[192:195], v[56:59]
    v_mfma_f32_16x16x32_bf16 v[60:63], a[20:23], v[196:199], v[60:63]
    ds_read_b128 a[52:55], v4 offset:26624
    v_mfma_f32_16x16x32_bf16 v[64:67], a[24:27], v[192:195], v[64:67]
    v_mfma_f32_16x16x32_bf16 v[68:71], a[24:27], v[196:199], v[68:71]
    ds_read_b128 a[56:59], v4 offset:28672
    v_mfma_f32_16x16x32_bf16 v[72:75], a[28:31], v[192:195], v[72:75]
    v_mfma_f32_16x16x32_bf16 v[76:79], a[28:31], v[196:199], v[76:79]
    ds_read_b128 a[60:63], v4 offset:30720
    s_waitcnt vmcnt(8)
    s_barrier
    s_waitcnt lgkmcnt(4)
    v_mfma_f32_16x16x32_bf16 v[16:19], a[32:35], v[200:203], v[16:19]
    v_mfma_f32_16x16x32_bf16 v[20:23], a[32:35], v[204:207], v[20:23]
    ds_read_b128 a[0:3], v3 offset:32768
    s_add_u32 m0, s21, 0
    v_mfma_f32_16x16x32_bf16 v[24:27], a[36:39], v[200:203], v[24:27]
    v_mfma_f32_16x16x32_bf16 v[28:31], a[36:39], v[204:207], v[28:31]
    ds_read_b128 a[4:7], v3 offset:34816
    s_add_u32 s64, s20, 0x50000
    buffer_load_dwordx4 v2, s[4:7], s64 offen lds
    v_mfma_f32_16x16x32_bf16 v[32:35], a[40:43], v[200:203], v[32:35]
    v_mfma_f32_16x16x32_bf16 v[36:39], a[40:43], v[204:207], v[36:39]
    ds_read_b128 a[8:11], v3 offset:36864
    s_add_u32 m0, s21, 1024
    v_mfma_f32_16x16x32_bf16 v[40:43], a[44:47], v[200:203], v[40:43]
    v_mfma_f32_16x16x32_bf16 v[44:47], a[44:47], v[204:207], v[44:47]
    ds_read_b128 a[12:15], v3 offset:38912
    s_add_u32 s64, s20, 0x52800
    buffer_load_dwordx4 v2, s[4:7], s64 offen lds
    s_waitcnt lgkmcnt(4)
    v_mfma_f32_16x16x32_bf16 v[48:51], a[48:51], v[200:203], v[48:51]
    v_mfma_f32_16x16x32_bf16 v[52:55], a[48:51], v[204:207], v[52:55]
    ds_read_b128 a[16:19], v3 offset:40960
    s_add_u32 m0, s21, 2048
    v_mfma_f32_16x16x32_bf16 v[56:59], a[52:55], v[200:203], v[56:59]
    v_mfma_f32_16x16x32_bf16 v[60:63], a[52:55], v[204:207], v[60:63]
    ds_read_b128 a[20:23], v3 offset:43008
    s_add_u32 s64, s20, 0x55000
    buffer_load_dwordx4 v2, s[4:7], s64 offen lds
    v_mfma_f32_16x16x32_bf16 v[64:67], a[56:59], v[200:203], v[64:67]
    v_mfma_f32_16x16x32_bf16 v[68:71], a[56:59], v[204:207], v[68:71]
    ds_read_b128 a[24:27], v3 offset:45056
    s_add_u32 m0, s21, 3072
    v_mfma_f32_16x16x32_bf16 v[72:75], a[60:63], v[200:203], v[72:75]
    v_mfma_f32_16x16x32_bf16 v[76:79], a[60:63], v[204:207], v[76:79]
    ds_read_b128 a[28:31], v3 offset:47104
    s_add_u32 s64, s20, 0x57800
    buffer_load_dwordx4 v2, s[4:7], s64 offen lds
    s_waitcnt lgkmcnt(4)
    v_mfma_f32_16x16x32_bf16 v[16:19], a[0:3], v[208:211], v[16:19]
    v_mfma_f32_16x16x32_bf16 v[20:23], a[0:3], v[212:215], v[20:23]
    ds_read_b128 a[32:35], v4 offset:32768
    v_mfma_f32_16x16x32_bf16 v[24:27], a[4:7], v[208:211], v[24:27]
    v_mfma_f32_16x16x32_bf16 v[28:31], a[4:7], v[212:215], v[28:31]
    ds_read_b128 a[36:39], v4 offset:34816
    v_mfma_f32_16x16x32_bf16 v[32:35], a[8:11], v[208:211], v[32:35]
    v_mfma_f32_16x16x32_bf16 v[36:39], a[8:11], v[212:215], v[36:39]
    ds_read_b128 a[40:43], v4 offset:36864
    v_mfma_f32_16x16x32_bf16 v[40:43], a[12:15], v[208:211], v[40:43]
    v_mfma_f32_16x16x32_bf16 v[44:47], a[12:15], v[212:215], v[44:47]
    ds_read_b128 a[44:47], v4 offset:38912
    s_waitcnt lgkmcnt(4)
    v_mfma_f32_16x16x32_bf16 v[48:51], a[16:19], v[208:211], v[48:51]
    v_mfma_f32_16x16x32_bf16 v[52:55], a[16:19], v[212:215], v[52:55]
    ds_read_b128 a[48:51], v4 offset:40960
    v_mfma_f32_16x16x32_bf16 v[56:59], a[20:23], v[208:211], v[56:59]
    v_mfma_f32_16x16x32_bf16 v[60:63], a[20:23], v[212:215], v[60:63]
    ds_read_b128 a[52:55], v4 offset:43008
    v_mfma_f32_16x16x32_bf16 v[64:67], a[24:27], v[208:211], v[64:67]
    v_mfma_f32_16x16x32_bf16 v[68:71], a[24:27], v[212:215], v[68:71]
    ds_read_b128 a[56:59], v4 offset:45056
    v_mfma_f32_16x16x32_bf16 v[72:75], a[28:31], v[208:211], v[72:75]
    v_mfma_f32_16x16x32_bf16 v[76:79], a[28:31], v[212:215], v[76:79]
    ds_read_b128 a[60:63], v4 offset:47104
    s_waitcnt vmcnt(8)
    s_barrier
    s_waitcnt lgkmcnt(4)
    v_mfma_f32_16x16x32_bf16 v[16:19], a[32:35], v[216:219], v[16:19]
    v_mfma_f32_16x16x32_bf16 v[20:23], a[32:35], v[220:223], v[20:23]
    ds_read_b128 a[0:3], v3 offset:49152
    s_add_u32 m0, s21, 16384
    v_mfma_f32_16x16x32_bf16 v[24:27], a[36:39], v[216:219], v[24:27]
    v_mfma_f32_16x16x32_bf16 v[28:31], a[36:39], v[220:223], v[28:31]
    ds_read_b128 a[4:7], v3 offset:51200
    s_add_u32 s64, s20, 0x50080
    buffer_load_dwordx4 v2, s[4:7], s64 offen lds
    v_mfma_f32_16x16x32_bf16 v[32:35], a[40:43], v[216:219], v[32:35]
    v_mfma_f32_16x16x32_bf16 v[36:39], a[40:43], v[220:223], v[36:39]
    ds_read_b128 a[8:11], v3 offset:53248
    s_add_u32 m0, s21, 17408
    v_mfma_f32_16x16x32_bf16 v[40:43], a[44:47], v[216:219], v[40:43]
    v_mfma_f32_16x16x32_bf16 v[44:47], a[44:47], v[220:223], v[44:47]
    ds_read_b128 a[12:15], v3 offset:55296
    s_add_u32 s64, s20, 0x52880
    buffer_load_dwordx4 v2, s[4:7], s64 offen lds
    s_waitcnt lgkmcnt(4)
    v_mfma_f32_16x16x32_bf16 v[48:51], a[48:51], v[216:219], v[48:51]
    v_mfma_f32_16x16x32_bf16 v[52:55], a[48:51], v[220:223], v[52:55]
    ds_read_b128 a[16:19], v3 offset:57344
    s_add_u32 m0, s21, 18432
    v_mfma_f32_16x16x32_bf16 v[56:59], a[52:55], v[216:219], v[56:59]
    v_mfma_f32_16x16x32_bf16 v[60:63], a[52:55], v[220:223], v[60:63]
    ds_read_b128 a[20:23], v3 offset:59392
    s_add_u32 s64, s20, 0x55080
    buffer_load_dwordx4 v2, s[4:7], s64 offen lds
    v_mfma_f32_16x16x32_bf16 v[64:67], a[56:59], v[216:219], v[64:67]
    v_mfma_f32_16x16x32_bf16 v[68:71], a[56:59], v[220:223], v[68:71]
    ds_read_b128 a[24:27], v3 offset:61440
    s_add_u32 m0, s21, 19456
    v_mfma_f32_16x16x32_bf16 v[72:75], a[60:63], v[216:219], v[72:75]
    v_mfma_f32_16x16x32_bf16 v[76:79], a[60:63], v[220:223], v[76:79]
    ds_read_b128 a[28:31], v3 offset:63488
    s_add_u32 s64, s20, 0x57880
    buffer_load_dwordx4 v2, s[4:7], s64 offen lds
    s_waitcnt lgkmcnt(4)
    v_mfma_f32_16x16x32_bf16 v[16:19], a[0:3], v[224:227], v[16:19]
    v_mfma_f32_16x16x32_bf16 v[20:23], a[0:3], v[228:231], v[20:23]
    ds_read_b128 a[32:35], v4 offset:49152
    v_mfma_f32_16x16x32_bf16 v[24:27], a[4:7], v[224:227], v[24:27]
    v_mfma_f32_16x16x32_bf16 v[28:31], a[4:7], v[228:231], v[28:31]
    ds_read_b128 a[36:39], v4 offset:51200
    v_mfma_f32_16x16x32_bf16 v[32:35], a[8:11], v[224:227], v[32:35]
    v_mfma_f32_16x16x32_bf16 v[36:39], a[8:11], v[228:231], v[36:39]
    ds_read_b128 a[40:43], v4 offset:53248
    v_mfma_f32_16x16x32_bf16 v[40:43], a[12:15], v[224:227], v[40:43]
    v_mfma_f32_16x16x32_bf16 v[44:47], a[12:15], v[228:231], v[44:47]
    ds_read_b128 a[44:47], v4 offset:55296
    s_waitcnt lgkmcnt(4)
    v_mfma_f32_16x16x32_bf16 v[48:51], a[16:19], v[224:227], v[48:51]
    v_mfma_f32_16x16x32_bf16 v[52:55], a[16:19], v[228:231], v[52:55]
    ds_read_b128 a[48:51], v4 offset:57344
    v_mfma_f32_16x16x32_bf16 v[56:59], a[20:23], v[224:227], v[56:59]
    v_mfma_f32_16x16x32_bf16 v[60:63], a[20:23], v[228:231], v[60:63]
    ds_read_b128 a[52:55], v4 offset:59392
    v_mfma_f32_16x16x32_bf16 v[64:67], a[24:27], v[224:227], v[64:67]
    v_mfma_f32_16x16x32_bf16 v[68:71], a[24:27], v[228:231], v[68:71]
    ds_read_b128 a[56:59], v4 offset:61440
    v_mfma_f32_16x16x32_bf16 v[72:75], a[28:31], v[224:227], v[72:75]
    v_mfma_f32_16x16x32_bf16 v[76:79], a[28:31], v[228:231], v[76:79]
    ds_read_b128 a[60:63], v4 offset:63488
    s_waitcnt vmcnt(8)
    s_barrier
    s_waitcnt lgkmcnt(4)
    v_mfma_f32_16x16x32_bf16 v[16:19], a[32:35], v[232:235], v[16:19]
    v_mfma_f32_16x16x32_bf16 v[20:23], a[32:35], v[236:239], v[20:23]
    ds_read_b128 a[0:3], v6 offset:0
    s_add_u32 m0, s21, 32768
    v_mfma_f32_16x16x32_bf16 v[24:27], a[36:39], v[232:235], v[24:27]
    v_mfma_f32_16x16x32_bf16 v[28:31], a[36:39], v[236:239], v[28:31]
    ds_read_b128 a[4:7], v6 offset:2048
    s_add_u32 s64, s20, 0x50100
    buffer_load_dwordx4 v2, s[4:7], s64 offen lds
    v_mfma_f32_16x16x32_bf16 v[32:35], a[40:43], v[232:235], v[32:35]
    v_mfma_f32_16x16x32_bf16 v[36:39], a[40:43], v[236:239], v[36:39]
    ds_read_b128 a[8:11], v6 offset:4096
    s_add_u32 m0, s21, 33792
    v_mfma_f32_16x16x32_bf16 v[40:43], a[44:47], v[232:235], v[40:43]
    v_mfma_f32_16x16x32_bf16 v[44:47], a[44:47], v[236:239], v[44:47]
    ds_read_b128 a[12:15], v6 offset:6144
    s_add_u32 s64, s20, 0x52900
    buffer_load_dwordx4 v2, s[4:7], s64 offen lds
    s_waitcnt lgkmcnt(4)
    v_mfma_f32_16x16x32_bf16 v[48:51], a[48:51], v[232:235], v[48:51]
    v_mfma_f32_16x16x32_bf16 v[52:55], a[48:51], v[236:239], v[52:55]
    ds_read_b128 a[16:19], v6 offset:8192
    s_add_u32 m0, s21, 34816
    v_mfma_f32_16x16x32_bf16 v[56:59], a[52:55], v[232:235], v[56:59]
    v_mfma_f32_16x16x32_bf16 v[60:63], a[52:55], v[236:239], v[60:63]
    ds_read_b128 a[20:23], v6 offset:10240
    s_add_u32 s64, s20, 0x55100
    buffer_load_dwordx4 v2, s[4:7], s64 offen lds
    v_mfma_f32_16x16x32_bf16 v[64:67], a[56:59], v[232:235], v[64:67]
    v_mfma_f32_16x16x32_bf16 v[68:71], a[56:59], v[236:239], v[68:71]
    ds_read_b128 a[24:27], v6 offset:12288
    s_add_u32 m0, s21, 35840
    v_mfma_f32_16x16x32_bf16 v[72:75], a[60:63], v[232:235], v[72:75]
    v_mfma_f32_16x16x32_bf16 v[76:79], a[60:63], v[236:239], v[76:79]
    ds_read_b128 a[28:31], v6 offset:14336
    s_add_u32 s64, s20, 0x57900
    buffer_load_dwordx4 v2, s[4:7], s64 offen lds
    s_waitcnt lgkmcnt(4)
    v_mfma_f32_16x16x32_bf16 v[16:19], a[0:3], v[240:243], v[16:19]
    v_mfma_f32_16x16x32_bf16 v[20:23], a[0:3], v[244:247], v[20:23]
    ds_read_b128 a[32:35], v9 offset:0
    v_mfma_f32_16x16x32_bf16 v[24:27], a[4:7], v[240:243], v[24:27]
    v_mfma_f32_16x16x32_bf16 v[28:31], a[4:7], v[244:247], v[28:31]
    ds_read_b128 a[36:39], v9 offset:2048
    v_mfma_f32_16x16x32_bf16 v[32:35], a[8:11], v[240:243], v[32:35]
    v_mfma_f32_16x16x32_bf16 v[36:39], a[8:11], v[244:247], v[36:39]
    ds_read_b128 a[40:43], v9 offset:4096
    v_mfma_f32_16x16x32_bf16 v[40:43], a[12:15], v[240:243], v[40:43]
    v_mfma_f32_16x16x32_bf16 v[44:47], a[12:15], v[244:247], v[44:47]
    ds_read_b128 a[44:47], v9 offset:6144
    s_waitcnt lgkmcnt(4)
    v_mfma_f32_16x16x32_bf16 v[48:51], a[16:19], v[240:243], v[48:51]
    v_mfma_f32_16x16x32_bf16 v[52:55], a[16:19], v[244:247], v[52:55]
    ds_read_b128 a[48:51], v9 offset:8192
    v_mfma_f32_16x16x32_bf16 v[56:59], a[20:23], v[240:243], v[56:59]
    v_mfma_f32_16x16x32_bf16 v[60:63], a[20:23], v[244:247], v[60:63]
    ds_read_b128 a[52:55], v9 offset:10240
    v_mfma_f32_16x16x32_bf16 v[64:67], a[24:27], v[240:243], v[64:67]
    v_mfma_f32_16x16x32_bf16 v[68:71], a[24:27], v[244:247], v[68:71]
    ds_read_b128 a[56:59], v9 offset:12288
    v_mfma_f32_16x16x32_bf16 v[72:75], a[28:31], v[240:243], v[72:75]
    v_mfma_f32_16x16x32_bf16 v[76:79], a[28:31], v[244:247], v[76:79]
    ds_read_b128 a[60:63], v9 offset:14336
    s_waitcnt vmcnt(8)
    s_barrier
    s_waitcnt lgkmcnt(4)
    v_mfma_f32_16x16x32_bf16 v[16:19], a[32:35], v[248:251], v[16:19]
    v_mfma_f32_16x16x32_bf16 v[20:23], a[32:35], v[252:255], v[20:23]
    ds_read_b128 a[0:3], v3 offset:0
    s_add_u32 m0, s21, 49152
    v_mfma_f32_16x16x32_bf16 v[24:27], a[36:39], v[248:251], v[24:27]
    v_mfma_f32_16x16x32_bf16 v[28:31], a[36:39], v[252:255], v[28:31]
    ds_read_b128 a[4:7], v3 offset:2048
    s_add_u32 s64, s20, 0x50180
    buffer_load_dwordx4 v2, s[4:7], s64 offen lds
    v_mfma_f32_16x16x32_bf16 v[32:35], a[40:43], v[248:251], v[32:35]
    v_mfma_f32_16x16x32_bf16 v[36:39], a[40:43], v[252:255], v[36:39]
    ds_read_b128 a[8:11], v3 offset:4096
    s_add_u32 m0, s21, 50176
    v_mfma_f32_16x16x32_bf16 v[40:43], a[44:47], v[248:251], v[40:43]
    v_mfma_f32_16x16x32_bf16 v[44:47], a[44:47], v[252:255], v[44:47]
    ds_read_b128 a[12:15], v3 offset:6144
    s_add_u32 s64, s20, 0x52980
    buffer_load_dwordx4 v2, s[4:7], s64 offen lds
    s_waitcnt lgkmcnt(4)
    v_mfma_f32_16x16x32_bf16 v[48:51], a[48:51], v[248:251], v[48:51]
    v_mfma_f32_16x16x32_bf16 v[52:55], a[48:51], v[252:255], v[52:55]
    ds_read_b128 a[16:19], v3 offset:8192
    s_add_u32 m0, s21, 51200
    v_mfma_f32_16x16x32_bf16 v[56:59], a[52:55], v[248:251], v[56:59]
    v_mfma_f32_16x16x32_bf16 v[60:63], a[52:55], v[252:255], v[60:63]
    ds_read_b128 a[20:23], v3 offset:10240
    s_add_u32 s64, s20, 0x55180
    buffer_load_dwordx4 v2, s[4:7], s64 offen lds
    v_mfma_f32_16x16x32_bf16 v[64:67], a[56:59], v[248:251], v[64:67]
    v_mfma_f32_16x16x32_bf16 v[68:71], a[56:59], v[252:255], v[68:71]
    ds_read_b128 a[24:27], v3 offset:12288
    s_add_u32 m0, s21, 52224
    v_mfma_f32_16x16x32_bf16 v[72:75], a[60:63], v[248:251], v[72:75]
    v_mfma_f32_16x16x32_bf16 v[76:79], a[60:63], v[252:255], v[76:79]
    ds_read_b128 a[28:31], v3 offset:14336
    s_add_u32 s64, s20, 0x57980
    buffer_load_dwordx4 v2, s[4:7], s64 offen lds
    s_nop 5
    s_mul_i32 s65, s17, 0
    s_add_u32 s65, s65, s22
    s_add_u32 s64, s65, 0
    v_cvt_pk_bf16_f32 v80, v16, v17
    v_cvt_pk_bf16_f32 v81, v18, v19
    v_cvt_pk_bf16_f32 v82, v24, v25
    v_cvt_pk_bf16_f32 v83, v26, v27
    buffer_store_dwordx4 v[80:83], v1, s[4:7], s64 offen sc1
    s_add_u32 s64, s65, 1024
    v_cvt_pk_bf16_f32 v84, v20, v21
    v_cvt_pk_bf16_f32 v85, v22, v23
    v_cvt_pk_bf16_f32 v86, v28, v29
    v_cvt_pk_bf16_f32 v87, v30, v31
    buffer_store_dwordx4 v[84:87], v1, s[4:7], s64 offen sc1
    s_mul_i32 s65, s17, 1
    s_add_u32 s65, s65, s22
    s_add_u32 s64, s65, 0
    v_cvt_pk_bf16_f32 v88, v32, v33
    v_cvt_pk_bf16_f32 v89, v34, v35
    v_cvt_pk_bf16_f32 v90, v40, v41
    v_cvt_pk_bf16_f32 v91, v42, v43
    buffer_store_dwordx4 v[88:91], v1, s[4:7], s64 offen sc1
    s_add_u32 s64, s65, 1024
    v_cvt_pk_bf16_f32 v92, v36, v37
    v_cvt_pk_bf16_f32 v93, v38, v39
    v_cvt_pk_bf16_f32 v94, v44, v45
    v_cvt_pk_bf16_f32 v95, v46, v47
    buffer_store_dwordx4 v[92:95], v1, s[4:7], s64 offen sc1
    s_mul_i32 s65, s17, 2
    s_add_u32 s65, s65, s22
    s_add_u32 s64, s65, 0
    v_cvt_pk_bf16_f32 v80, v48, v49
    v_cvt_pk_bf16_f32 v81, v50, v51
    v_cvt_pk_bf16_f32 v82, v56, v57
    v_cvt_pk_bf16_f32 v83, v58, v59
    buffer_store_dwordx4 v[80:83], v1, s[4:7], s64 offen sc1
    s_add_u32 s64, s65, 1024
    v_cvt_pk_bf16_f32 v84, v52, v53
    v_cvt_pk_bf16_f32 v85, v54, v55
    v_cvt_pk_bf16_f32 v86, v60, v61
    v_cvt_pk_bf16_f32 v87, v62, v63
    buffer_store_dwordx4 v[84:87], v1, s[4:7], s64 offen sc1
    s_mul_i32 s65, s17, 3
    s_add_u32 s65, s65, s22
    s_add_u32 s64, s65, 0
    v_cvt_pk_bf16_f32 v88, v64, v65
    v_cvt_pk_bf16_f32 v89, v66, v67
    v_cvt_pk_bf16_f32 v90, v72, v73
    v_cvt_pk_bf16_f32 v91, v74, v75
    buffer_store_dwordx4 v[88:91], v1, s[4:7], s64 offen sc1
    s_add_u32 s64, s65, 1024
    v_cvt_pk_bf16_f32 v92, v68, v69
    v_cvt_pk_bf16_f32 v93, v70, v71
    v_cvt_pk_bf16_f32 v94, v76, v77
    v_cvt_pk_bf16_f32 v95, v78, v79
    buffer_store_dwordx4 v[92:95], v1, s[4:7], s64 offen sc1
    s_lshl_b32 s64, s19, 1
    s_add_u32 s64, s64, s12
    s_lshl_b32 s64, s64, 9
    s_add_u32 s23, s18, s64
    s_lshl_b32 s64, s17, 3
    s_add_u32 s22, s22, s64
    s_add_u32 s19, s19, 1
    s_add_u32 s20, s20, 0x50000
    s_cmp_lg_u32 s19, 1
    s_cbranch_scc1 GE0_137
    s_waitcnt vmcnt(0)
    s_barrier
    s_cmp_lg_u32 s14, 0
    s_cbranch_scc1 GF_138
    v_mov_b32 v7, 1
    v_mov_b32 v8, 0
    s_mov_b64 exec, 1
    buffer_store_dword v7, v8, s[4:7], s23 offen sc1
    s_mov_b64 exec, -1
GF_138:
GE0_137:
    s_cmp_lt_u32 s19, 8
    s_cbranch_scc1 G_N_LOOP
    s_waitcnt vmcnt(0) lgkmcnt(0)
    s_barrier
    s_cmp_lg_u32 s14, 0
    s_cbranch_scc1 GF_139
    v_mov_b32 v7, 1
    v_mov_b32 v8, 0
    s_mov_b64 exec, 1
    buffer_store_dword v7, v8, s[4:7], s23 offen sc1
    s_mov_b64 exec, -1
GF_139:
    s_cmp_eq_u32 s12, 1
    s_cbranch_scc1 H_OUT
    s_lshl_b32 s88, s3, 5
    s_add_u32 s88, s88, s13
    s_mov_b32 s29, 0
    v_lshlrev_b32 v1, 4, v0
    s_mov_b32 s65, 0
CW_140:
    buffer_load_dwordx2 v[8:9], off, s[60:63], 0 offset:132 sc1
    s_add_u32 s65, s65, 1
    s_waitcnt vmcnt(0)
    v_readfirstlane_b32 s66, v8
    v_readfirstlane_b32 s67, v9
    s_min_u32 s64, s66, s67
    s_cmp_lg_u32 s64, 0
    s_cbranch_scc1 CWD_141
    s_cmp_gt_u32 s65, 65536
    s_cbranch_scc1 CWD_141
    s_sleep 4
    s_branch CW_140
CWD_141:
    s_sub_u32 s66, s66, 1
    s_and_b32 s66, s66, 3
    s_sub_u32 s67, s67, 1
    s_and_b32 s67, s67, 3
    s_mov_b32 s64, s66
    s_mov_b32 s65, s67
    s_and_b32 s64, s64, 3
    s_lshl_b32 s64, s64, 13
    s_and_b32 s65, s65, 3
    s_lshl_b32 s65, s65, 13
    s_add_u32 s25, s64, 0x6000000
    s_add_u32 s30, s65, 0x6200000
    v_bfe_u32 v4, v0, 3, 1
    v_mul_u32_u24 v2, 0x8000, v4
    v_lshrrev_b32 v4, 5, v0
    v_lshl_add_u32 v2, v4, 8, v2
    v_bfe_u32 v4, v0, 4, 1
    v_lshl_add_u32 v2, v4, 7, v2
    v_and_b32 v4, 7, v0
    v_lshl_add_u32 v2, v4, 4, v2
    v_lshrrev_b32 v4, 5, v0
    v_lshlrev_b32 v3, 16, v4
    v_bfe_u32 v4, v0, 4, 1
    v_lshl_add_u32 v3, v4, 7, v3
    v_and_b32 v4, 15, v0
    v_lshl_add_u32 v3, v4, 3, v3
    s_lshl_b32 s26, s13, 11
    s_lshl_b32 s64, s14, 9
    s_add_u32 s26, s26, s64
    s_add_u32 s26, s26, 0xa40000
    s_lshl_b32 s27, s13, 3
    s_add_u32 s27, s27, 0x294004
    s_mov_b32 s28, 0x29a000
    s_mov_b32 s24, 0
    v_lshlrev_b32 v6, 7, v0
MKN_LOOP:
    s_cmp_lg_u32 s24, 10
    s_cbranch_scc1 MKH_142
    v_mov_b32 v10, v2
    v_mov_b32 v11, v3
    s_cmp_ge_u32 s88, 60
    s_cbranch_scc1 NOWO_143
    s_mov_b32 s89, s13
    s_mul_hi_u32 s65, s88, 0xccccccd
    s_mul_i32 s65, s65, 20
    s_sub_u32 s13, s88, s65
    s_load_dwordx2 s[44:45], s[0:1], 40
    s_mov_b32 s46, 0x500000
    s_mov_b32 s47, 0x00020000
    s_waitcnt lgkmcnt(0)
    s_mul_i32 s21, s14, 36864
    v_lshrrev_b32 v7, 2, v0
    v_mul_u32_u24 v4, 1280, v7
    v_bfe_u32 v7, v0, 4, 1
    v_lshlrev_b32 v7, 1, v7
    v_and_b32 v8, 3, v0
    v_xor_b32 v7, v7, v8
    v_lshl_add_u32 v4, v7, 4, v4
    v_lshrrev_b32 v7, 4, v0
    v_lshlrev_b32 v2, 8, v7
    v_bfe_u32 v7, v0, 2, 2
    v_lshl_add_u32 v2, v7, 6, v2
    v_and_b32 v7, 3, v0
    v_lshl_add_u32 v2, v7, 3, v2
    v_add_u32 v2, s21, v2
    v_bfe_u32 v7, v0, 4, 1
    v_lshlrev_b32 v7, 5, v7
    v_sub_u32 v3, 32, v7
    v_add_u32 v3, v3, v2
    v_add_u32 v2, v2, v7
    s_mul_i32 s65, s14, 1310720
    s_lshl_b32 s66, s13, 6
    s_add_u32 s65, s65, s66
    s_add_u32 m0, s21, 0
    s_add_u32 s64, s65, 0x0
    buffer_load_dwordx4 v4, s[44:47], s64 offen lds
    s_add_u32 m0, s21, 1024
    s_add_u32 s64, s65, 0x5000
    buffer_load_dwordx4 v4, s[44:47], s64 offen lds
    s_add_u32 m0, s21, 2048
    s_add_u32 s64, s65, 0xa000
    buffer_load_dwordx4 v4, s[44:47], s64 offen lds
    s_add_u32 m0, s21, 3072
    s_add_u32 s64, s65, 0xf000
    buffer_load_dwordx4 v4, s[44:47], s64 offen lds
    s_add_u32 m0, s21, 4096
    s_add_u32 s64, s65, 0x14000
    buffer_load_dwordx4 v4, s[44:47], s64 offen lds
    s_add_u32 m0, s21, 5120
    s_add_u32 s64, s65, 0x19000
    buffer_load_dwordx4 v4, s[44:47], s64 offen lds
    s_add_u32 m0, s21, 6144
    s_add_u32 s64, s65, 0x1e000
    buffer_load_dwordx4 v4, s[44:47], s64 offen lds
    s_add_u32 m0, s21, 7168
    s_add_u32 s64, s65, 0x23000
    buffer_load_dwordx4 v4, s[44:47], s64 offen lds
    s_add_u32 m0, s21, 8192
    s_add_u32 s64, s65, 0x28000
    buffer_load_dwordx4 v4, s[44:47], s64 offen lds
    s_add_u32 m0, s21, 9216
    s_add_u32 s64, s65, 0x2d000
    buffer_load_dwordx4 v4, s[44:47], s64 offen lds
    s_add_u32 m0, s21, 10240
    s_add_u32 s64, s65, 0x32000
    buffer_load_dwordx4 v4, s[44:47], s64 offen lds
    s_add_u32 m0, s21, 11264
    s_add_u32 s64, s65, 0x37000
    buffer_load_dwordx4 v4, s[44:47], s64 offen lds
    s_add_u32 m0, s21, 12288
    s_add_u32 s64, s65, 0x3c000
    buffer_load_dwordx4 v4, s[44:47], s64 offen lds
    s_add_u32 m0, s21, 13312
    s_add_u32 s64, s65, 0x41000
    buffer_load_dwordx4 v4, s[44:47], s64 offen lds
    s_add_u32 m0, s21, 14336
    s_add_u32 s64, s65, 0x46000
    buffer_load_dwordx4 v4, s[44:47], s64 offen lds
    s_add_u32 m0, s21, 15360
    s_add_u32 s64, s65, 0x4b000
    buffer_load_dwordx4 v4, s[44:47], s64 offen lds
    s_add_u32 m0, s21, 16384
    s_add_u32 s64, s65, 0x50000
    buffer_load_dwordx4 v4, s[44:47], s64 offen lds
    s_add_u32 m0, s21, 17408
    s_add_u32 s64, s65, 0x55000
    buffer_load_dwordx4 v4, s[44:47], s64 offen lds
    s_add_u32 m0, s21, 18432
    s_add_u32 s64, s65, 0x5a000
    buffer_load_dwordx4 v4, s[44:47], s64 offen lds
    s_add_u32 m0, s21, 19456
    s_add_u32 s64, s65, 0x5f000
    buffer_load_dwordx4 v4, s[44:47], s64 offen lds
    s_add_u32 m0, s21, 20480
    s_add_u32 s64, s65, 0x64000
    buffer_load_dwordx4 v4, s[44:47], s64 offen lds
    s_add_u32 m0, s21, 21504
    s_add_u32 s64, s65, 0x69000
    buffer_load_dwordx4 v4, s[44:47], s64 offen lds
    s_add_u32 m0, s21, 22528
    s_add_u32 s64, s65, 0x6e000
    buffer_load_dwordx4 v4, s[44:47], s64 offen lds
    s_add_u32 m0, s21, 23552
    s_add_u32 s64, s65, 0x73000
    buffer_load_dwordx4 v4, s[44:47], s64 offen lds
    s_add_u32 m0, s21, 24576
    s_add_u32 s64, s65, 0x78000
    buffer_load_dwordx4 v4, s[44:47], s64 offen lds
    s_add_u32 m0, s21, 25600
    s_add_u32 s64, s65, 0x7d000
    buffer_load_dwordx4 v4, s[44:47], s64 offen lds
    s_add_u32 m0, s21, 26624
    s_add_u32 s64, s65, 0x82000
    buffer_load_dwordx4 v4, s[44:47], s64 offen lds
    s_add_u32 m0, s21, 27648
    s_add_u32 s64, s65, 0x87000
    buffer_load_dwordx4 v4, s[44:47], s64 offen lds
    s_add_u32 m0, s21, 28672
    s_add_u32 s64, s65, 0x8c000
    buffer_load_dwordx4 v4, s[44:47], s64 offen lds
    s_add_u32 m0, s21, 29696
    s_add_u32 s64, s65, 0x91000
    buffer_load_dwordx4 v4, s[44:47], s64 offen lds
    s_add_u32 m0, s21, 30720
    s_add_u32 s64, s65, 0x96000
    buffer_load_dwordx4 v4, s[44:47], s64 offen lds
    s_add_u32 m0, s21, 31744
    s_add_u32 s64, s65, 0x9b000
    buffer_load_dwordx4 v4, s[44:47], s64 offen lds
    s_add_u32 m0, s21, 32768
    s_add_u32 s64, s65, 0xa0000
    buffer_load_dwordx4 v4, s[44:47], s64 offen lds
    s_add_u32 m0, s21, 33792
    s_add_u32 s64, s65, 0xa5000
    buffer_load_dwordx4 v4, s[44:47], s64 offen lds
    s_add_u32 m0, s21, 34816
    s_add_u32 s64, s65, 0xaa000
    buffer_load_dwordx4 v4, s[44:47], s64 offen lds
    s_add_u32 m0, s21, 35840
    s_add_u32 s64, s65, 0xaf000
    buffer_load_dwordx4 v4, s[44:47], s64 offen lds
    s_waitcnt vmcnt(32)
    ds_read_b64_tr_b16 a[0:1], v2 offset:0
    ds_read_b64_tr_b16 a[2:3], v2 offset:1024
    ds_read_b64_tr_b16 a[4:5], v3 offset:0
    ds_read_b64_tr_b16 a[6:7], v3 offset:1024
    ds_read_b64_tr_b16 a[8:9], v2 offset:2048
    ds_read_b64_tr_b16 a[10:11], v2 offset:3072
    ds_read_b64_tr_b16 a[12:13], v3 offset:2048
    ds_read_b64_tr_b16 a[14:15], v3 offset:3072
    s_waitcnt lgkmcnt(0)
    s_add_u32 m0, s21, 0
    s_add_u32 s64, s65, 0xb4000
    buffer_load_dwordx4 v4, s[44:47], s64 offen lds
    s_add_u32 m0, s21, 1024
    s_add_u32 s64, s65, 0xb9000
    buffer_load_dwordx4 v4, s[44:47], s64 offen lds
    s_add_u32 m0, s21, 2048
    s_add_u32 s64, s65, 0xbe000
    buffer_load_dwordx4 v4, s[44:47], s64 offen lds
    s_add_u32 m0, s21, 3072
    s_add_u32 s64, s65, 0xc3000
    buffer_load_dwordx4 v4, s[44:47], s64 offen lds
    s_waitcnt vmcnt(32)
    ds_read_b64_tr_b16 a[16:17], v2 offset:4096
    ds_read_b64_tr_b16 a[18:19], v2 offset:5120
    ds_read_b64_tr_b16 a[20:21], v3 offset:4096
    ds_read_b64_tr_b16 a[22:23], v3 offset:5120
    ds_read_b64_tr_b16 a[24:25], v2 offset:6144
    ds_read_b64_tr_b16 a[26:27], v2 offset:7168
    ds_read_b64_tr_b16 a[28:29], v3 offset:6144
    ds_read_b64_tr_b16 a[30:31], v3 offset:7168
    s_waitcnt lgkmcnt(0)
    s_add_u32 m0, s21, 4096
    s_add_u32 s64, s65, 0xc8000
    buffer_load_dwordx4 v4, s[44:47], s64 offen lds
    s_add_u32 m0, s21, 5120
    s_add_u32 s64, s65, 0xcd000
    buffer_load_dwordx4 v4, s[44:47], s64 offen lds
    s_add_u32 m0, s21, 6144
    s_add_u32 s64, s65, 0xd2000
    buffer_load_dwordx4 v4, s[44:47], s64 offen lds
    s_add_u32 m0, s21, 7168
    s_add_u32 s64, s65, 0xd7000
    buffer_load_dwordx4 v4, s[44:47], s64 offen lds
    s_waitcnt vmcnt(32)
    ds_read_b64_tr_b16 a[32:33], v2 offset:8192
    ds_read_b64_tr_b16 a[34:35], v2 offset:9216
    ds_read_b64_tr_b16 a[36:37], v3 offset:8192
    ds_read_b64_tr_b16 a[38:39], v3 offset:9216
    ds_read_b64_tr_b16 a[40:41], v2 offset:10240
    ds_read_b64_tr_b16 a[42:43], v2 offset:11264
    ds_read_b64_tr_b16 a[44:45], v3 offset:10240
    ds_read_b64_tr_b16 a[46:47], v3 offset:11264
    s_waitcnt lgkmcnt(0)
    s_add_u32 m0, s21, 8192
    s_add_u32 s64, s65, 0xdc000
    buffer_load_dwordx4 v4, s[44:47], s64 offen lds
    s_add_u32 m0, s21, 9216
    s_add_u32 s64, s65, 0xe1000
    buffer_load_dwordx4 v4, s[44:47], s64 offen lds
    s_add_u32 m0, s21, 10240
    s_add_u32 s64, s65, 0xe6000
    buffer_load_dwordx4 v4, s[44:47], s64 offen lds
    s_add_u32 m0, s21, 11264
    s_add_u32 s64, s65, 0xeb000
    buffer_load_dwordx4 v4, s[44:47], s64 offen lds
    s_waitcnt vmcnt(32)
    ds_read_b64_tr_b16 a[48:49], v2 offset:12288
    ds_read_b64_tr_b16 a[50:51], v2 offset:13312
    ds_read_b64_tr_b16 a[52:53], v3 offset:12288
    ds_read_b64_tr_b16 a[54:55], v3 offset:13312
    ds_read_b64_tr_b16 a[56:57], v2 offset:14336
    ds_read_b64_tr_b16 a[58:59], v2 offset:15360
    ds_read_b64_tr_b16 a[60:61], v3 offset:14336
    ds_read_b64_tr_b16 a[62:63], v3 offset:15360
    s_waitcnt lgkmcnt(0)
    s_add_u32 m0, s21, 12288
    s_add_u32 s64, s65, 0xf0000
    buffer_load_dwordx4 v4, s[44:47], s64 offen lds
    s_add_u32 m0, s21, 13312
    s_add_u32 s64, s65, 0xf5000
    buffer_load_dwordx4 v4, s[44:47], s64 offen lds
    s_add_u32 m0, s21, 14336
    s_add_u32 s64, s65, 0xfa000
    buffer_load_dwordx4 v4, s[44:47], s64 offen lds
    s_add_u32 m0, s21, 15360
    s_add_u32 s64, s65, 0xff000
    buffer_load_dwordx4 v4, s[44:47], s64 offen lds
    s_waitcnt vmcnt(32)
    ds_read_b64_tr_b16 a[64:65], v2 offset:16384
    ds_read_b64_tr_b16 a[66:67], v2 offset:17408
    ds_read_b64_tr_b16 a[68:69], v3 offset:16384
    ds_read_b64_tr_b16 a[70:71], v3 offset:17408
    ds_read_b64_tr_b16 a[72:73], v2 offset:18432
    ds_read_b64_tr_b16 a[74:75], v2 offset:19456
    ds_read_b64_tr_b16 a[76:77], v3 offset:18432
    ds_read_b64_tr_b16 a[78:79], v3 offset:19456
    s_waitcnt lgkmcnt(0)
    s_add_u32 m0, s21, 16384
    s_add_u32 s64, s65, 0x104000
    buffer_load_dwordx4 v4, s[44:47], s64 offen lds
    s_add_u32 m0, s21, 17408
    s_add_u32 s64, s65, 0x109000
    buffer_load_dwordx4 v4, s[44:47], s64 offen lds
    s_add_u32 m0, s21, 18432
    s_add_u32 s64, s65, 0x10e000
    buffer_load_dwordx4 v4, s[44:47], s64 offen lds
    s_add_u32 m0, s21, 19456
    s_add_u32 s64, s65, 0x113000
    buffer_load_dwordx4 v4, s[44:47], s64 offen lds
    s_waitcnt vmcnt(32)
    ds_read_b64_tr_b16 a[80:81], v2 offset:20480
    ds_read_b64_tr_b16 a[82:83], v2 offset:21504
    ds_read_b64_tr_b16 a[84:85], v3 offset:20480
    ds_read_b64_tr_b16 a[86:87], v3 offset:21504
    ds_read_b64_tr_b16 a[88:89], v2 offset:22528
    ds_read_b64_tr_b16 a[90:91], v2 offset:23552
    ds_read_b64_tr_b16 a[92:93], v3 offset:22528
    ds_read_b64_tr_b16 a[94:95], v3 offset:23552
    s_waitcnt lgkmcnt(0)
    s_add_u32 m0, s21, 20480
    s_add_u32 s64, s65, 0x118000
    buffer_load_dwordx4 v4, s[44:47], s64 offen lds
    s_add_u32 m0, s21, 21504
    s_add_u32 s64, s65, 0x11d000
    buffer_load_dwordx4 v4, s[44:47], s64 offen lds
    s_add_u32 m0, s21, 22528
    s_add_u32 s64, s65, 0x122000
    buffer_load_dwordx4 v4, s[44:47], s64 offen lds
    s_add_u32 m0, s21, 23552
    s_add_u32 s64, s65, 0x127000
    buffer_load_dwordx4 v4, s[44:47], s64 offen lds
    s_waitcnt vmcnt(32)
    ds_read_b64_tr_b16 a[96:97], v2 offset:24576
    ds_read_b64_tr_b16 a[98:99], v2 offset:25600
    ds_read_b64_tr_b16 a[100:101], v3 offset:24576
    ds_read_b64_tr_b16 a[102:103], v3 offset:25600
    ds_read_b64_tr_b16 a[104:105], v2 offset:26624
    ds_read_b64_tr_b16 a[106:107], v2 offset:27648
    ds_read_b64_tr_b16 a[108:109], v3 offset:26624
    ds_read_b64_tr_b16 a[110:111], v3 offset:27648
    s_waitcnt lgkmcnt(0)
    s_add_u32 m0, s21, 24576
    s_add_u32 s64, s65, 0x12c000
    buffer_load_dwordx4 v4, s[44:47], s64 offen lds
    s_add_u32 m0, s21, 25600
    s_add_u32 s64, s65, 0x131000
    buffer_load_dwordx4 v4, s[44:47], s64 offen lds
    s_add_u32 m0, s21, 26624
    s_add_u32 s64, s65, 0x136000
    buffer_load_dwordx4 v4, s[44:47], s64 offen lds
    s_add_u32 m0, s21, 27648
    s_add_u32 s64, s65, 0x13b000
    buffer_load_dwordx4 v4, s[44:47], s64 offen lds
    s_waitcnt vmcnt(32)
    ds_read_b64_tr_b16 a[112:113], v2 offset:28672
    ds_read_b64_tr_b16 a[114:115], v2 offset:29696
    ds_read_b64_tr_b16 a[116:117], v3 offset:28672
    ds_read_b64_tr_b16 a[118:119], v3 offset:29696
    ds_read_b64_tr_b16 a[120:121], v2 offset:30720
    ds_read_b64_tr_b16 a[122:123], v2 offset:31744
    ds_read_b64_tr_b16 a[124:125], v3 offset:30720
    ds_read_b64_tr_b16 a[126:127], v3 offset:31744
    s_waitcnt lgkmcnt(0)
    s_waitcnt vmcnt(28)
    ds_read_b64_tr_b16 a[128:129], v2 offset:32768
    ds_read_b64_tr_b16 a[130:131], v2 offset:33792
    ds_read_b64_tr_b16 a[132:133], v3 offset:32768
    ds_read_b64_tr_b16 a[134:135], v3 offset:33792
    ds_read_b64_tr_b16 a[136:137], v2 offset:34816
    ds_read_b64_tr_b16 a[138:139], v2 offset:35840
    ds_read_b64_tr_b16 a[140:141], v3 offset:34816
    ds_read_b64_tr_b16 a[142:143], v3 offset:35840
    s_waitcnt lgkmcnt(0)
    s_waitcnt vmcnt(24)
    ds_read_b64_tr_b16 a[144:145], v2 offset:0
    ds_read_b64_tr_b16 a[146:147], v2 offset:1024
    ds_read_b64_tr_b16 a[148:149], v3 offset:0
    ds_read_b64_tr_b16 a[150:151], v3 offset:1024
    ds_read_b64_tr_b16 a[152:153], v2 offset:2048
    ds_read_b64_tr_b16 a[154:155], v2 offset:3072
    ds_read_b64_tr_b16 a[156:157], v3 offset:2048
    ds_read_b64_tr_b16 a[158:159], v3 offset:3072
    s_waitcnt lgkmcnt(0)
    s_waitcnt vmcnt(20)
    ds_read_b64_tr_b16 a[160:161], v2 offset:4096
    ds_read_b64_tr_b16 a[162:163], v2 offset:5120
    ds_read_b64_tr_b16 a[164:165], v3 offset:4096
    ds_read_b64_tr_b16 a[166:167], v3 offset:5120
    ds_read_b64_tr_b16 a[168:169], v2 offset:6144
    ds_read_b64_tr_b16 a[170:171], v2 offset:7168
    ds_read_b64_tr_b16 a[172:173], v3 offset:6144
    ds_read_b64_tr_b16 a[174:175], v3 offset:7168
    s_waitcnt lgkmcnt(0)
    s_waitcnt vmcnt(16)
    ds_read_b64_tr_b16 a[176:177], v2 offset:8192
    ds_read_b64_tr_b16 a[178:179], v2 offset:9216
    ds_read_b64_tr_b16 a[180:181], v3 offset:8192
    ds_read_b64_tr_b16 a[182:183], v3 offset:9216
    ds_read_b64_tr_b16 a[184:185], v2 offset:10240
    ds_read_b64_tr_b16 a[186:187], v2 offset:11264
    ds_read_b64_tr_b16 a[188:189], v3 offset:10240
    ds_read_b64_tr_b16 a[190:191], v3 offset:11264
    s_waitcnt lgkmcnt(0)
    s_waitcnt vmcnt(12)
    ds_read_b64_tr_b16 a[192:193], v2 offset:12288
    ds_read_b64_tr_b16 a[194:195], v2 offset:13312
    ds_read_b64_tr_b16 a[196:197], v3 offset:12288
    ds_read_b64_tr_b16 a[198:199], v3 offset:13312
    ds_read_b64_tr_b16 a[200:201], v2 offset:14336
    ds_read_b64_tr_b16 a[202:203], v2 offset:15360
    ds_read_b64_tr_b16 a[204:205], v3 offset:14336
    ds_read_b64_tr_b16 a[206:207], v3 offset:15360
    s_waitcnt lgkmcnt(0)
    s_waitcnt vmcnt(8)
    ds_read_b64_tr_b16 a[208:209], v2 offset:16384
    ds_read_b64_tr_b16 a[210:211], v2 offset:17408
    ds_read_b64_tr_b16 a[212:213], v3 offset:16384
    ds_read_b64_tr_b16 a[214:215], v3 offset:17408
    ds_read_b64_tr_b16 a[216:217], v2 offset:18432
    ds_read_b64_tr_b16 a[218:219], v2 offset:19456
    ds_read_b64_tr_b16 a[220:221], v3 offset:18432
    ds_read_b64_tr_b16 a[222:223], v3 offset:19456
    s_waitcnt lgkmcnt(0)
    s_waitcnt vmcnt(4)
    ds_read_b64_tr_b16 a[224:225], v2 offset:20480
    ds_read_b64_tr_b16 a[226:227], v2 offset:21504
    ds_read_b64_tr_b16 a[228:229], v3 offset:20480
    ds_read_b64_tr_b16 a[230:231], v3 offset:21504
    ds_read_b64_tr_b16 a[232:233], v2 offset:22528
    ds_read_b64_tr_b16 a[234:235], v2 offset:23552
    ds_read_b64_tr_b16 a[236:237], v3 offset:22528
    ds_read_b64_tr_b16 a[238:239], v3 offset:23552
    s_waitcnt lgkmcnt(0)
    s_waitcnt vmcnt(0)
    ds_read_b64_tr_b16 a[240:241], v2 offset:24576
    ds_read_b64_tr_b16 a[242:243], v2 offset:25600
    ds_read_b64_tr_b16 a[244:245], v3 offset:24576
    ds_read_b64_tr_b16 a[246:247], v3 offset:25600
    ds_read_b64_tr_b16 a[248:249], v2 offset:26624
    ds_read_b64_tr_b16 a[250:251], v2 offset:27648
    ds_read_b64_tr_b16 a[252:253], v3 offset:26624
    ds_read_b64_tr_b16 a[254:255], v3 offset:27648
    s_waitcnt lgkmcnt(0)
    s_mov_b32 s13, s89
NOWO_143:
    v_mov_b32 v2, v10
    v_mov_b32 v3, v11
MKH_142:
    s_cmp_lg_u32 s24, 31
    s_mov_b64 exec, 0xf
    s_cbranch_scc1 MKL_144
    s_mov_b64 exec, -1
    v_bfe_u32 v4, v0, 3, 1
    v_mul_u32_u24 v4, 0x8000, v4
    v_sub_u32 v2, v2, v4
    s_mov_b64 exec, 3
MKL_144:
MKN_M_145:
    buffer_load_dword v5, v6, s[4:7], s28 offen sc1
    s_add_u32 s29, s29, 1
    s_waitcnt vmcnt(0)
    v_cmp_eq_u32 vcc, 0, v5
    s_cbranch_vccz MKN_MD_146
    s_cmp_gt_u32 s29, 262144
    s_cbranch_scc1 MKN_MD_146
    s_sleep 1
    s_branch MKN_M_145
MKN_MD_146:
    s_mov_b64 exec, -1
MKR_147:
    s_add_u32 s64, s25, 0x0
    buffer_load_dwordx4 v[16:19], v2, s[4:7], s64 offen sc1
    s_add_u32 s64, s25, 0x200
    buffer_load_dwordx4 v[20:23], v2, s[4:7], s64 offen sc1
    s_add_u32 s64, s25, 0x400
    buffer_load_dwordx4 v[24:27], v2, s[4:7], s64 offen sc1
    s_add_u32 s64, s25, 0x600
    buffer_load_dwordx4 v[28:31], v2, s[4:7], s64 offen sc1
    s_add_u32 s64, s25, 0x800
    buffer_load_dwordx4 v[32:35], v2, s[4:7], s64 offen sc1
    s_add_u32 s64, s25, 0xa00
    buffer_load_dwordx4 v[36:39], v2, s[4:7], s64 offen sc1
    s_add_u32 s64, s25, 0xc00
    buffer_load_dwordx4 v[40:43], v2, s[4:7], s64 offen sc1
    s_add_u32 s64, s25, 0xe00
    buffer_load_dwordx4 v[44:47], v2, s[4:7], s64 offen sc1
    s_add_u32 s64, s25, 0x1000
    buffer_load_dwordx4 v[48:51], v2, s[4:7], s64 offen sc1
    s_add_u32 s64, s25, 0x1200
    buffer_load_dwordx4 v[52:55], v2, s[4:7], s64 offen sc1
    s_add_u32 s64, s30, 0x0
    buffer_load_dwordx4 v[56:59], v2, s[4:7], s64 offen sc1
    s_add_u32 s64, s30, 0x200
    buffer_load_dwordx4 v[60:63], v2, s[4:7], s64 offen sc1
    s_add_u32 s64, s30, 0x400
    buffer_load_dwordx4 v[64:67], v2, s[4:7], s64 offen sc1
    s_add_u32 s64, s30, 0x600
    buffer_load_dwordx4 v[68:71], v2, s[4:7], s64 offen sc1
    s_add_u32 s64, s30, 0x800
    buffer_load_dwordx4 v[72:75], v2, s[4:7], s64 offen sc1
    s_add_u32 s64, s30, 0xa00
    buffer_load_dwordx4 v[76:79], v2, s[4:7], s64 offen sc1
    s_add_u32 s64, s30, 0xc00
    buffer_load_dwordx4 v[80:83], v2, s[4:7], s64 offen sc1
    s_add_u32 s64, s30, 0xe00
    buffer_load_dwordx4 v[84:87], v2, s[4:7], s64 offen sc1
    s_add_u32 s64, s30, 0x1000
    buffer_load_dwordx4 v[88:91], v2, s[4:7], s64 offen sc1
    s_add_u32 s64, s30, 0x1200
    buffer_load_dwordx4 v[92:95], v2, s[4:7], s64 offen sc1
    s_add_u32 s29, s29, 1
    s_waitcnt vmcnt(0)
    v_max3_u32 v4, v19, v23, v27
    v_max3_u32 v4, v4, v31, v35
    v_max3_u32 v4, v4, v39, v43
    v_max3_u32 v4, v4, v47, v51
    v_max3_u32 v4, v4, v55, v59
    v_max3_u32 v4, v4, v63, v67
    v_max3_u32 v4, v4, v71, v75
    v_max3_u32 v4, v4, v79, v83
    v_max3_u32 v4, v4, v87, v91
    v_max_u32 v4, v4, v95
    v_cmp_eq_u32 vcc, -1, v4
    s_cbranch_vccz MKO_148
    s_cmp_gt_u32 s29, 262144
    s_cbranch_scc0 MKR_147
MKO_148:
    v_mfma_f32_16x16x32_bf16 v[8:11], v[16:19], v[96:99], 0
    v_mfma_f32_16x16x32_bf16 v[12:15], v[16:19], v[100:103], 0
    v_mfma_f32_16x16x32_bf16 v[8:11], v[20:23], v[104:107], v[8:11]
    v_mfma_f32_16x16x32_bf16 v[12:15], v[20:23], v[108:111], v[12:15]
    v_mfma_f32_16x16x32_bf16 v[8:11], v[24:27], v[112:115], v[8:11]
    v_mfma_f32_16x16x32_bf16 v[12:15], v[24:27], v[116:119], v[12:15]
    v_mfma_f32_16x16x32_bf16 v[8:11], v[28:31], v[120:123], v[8:11]
    v_mfma_f32_16x16x32_bf16 v[12:15], v[28:31], v[124:127], v[12:15]
    v_mfma_f32_16x16x32_bf16 v[8:11], v[32:35], v[128:131], v[8:11]
    v_mfma_f32_16x16x32_bf16 v[12:15], v[32:35], v[132:135], v[12:15]
    v_mfma_f32_16x16x32_bf16 v[8:11], v[36:39], v[136:139], v[8:11]
    v_mfma_f32_16x16x32_bf16 v[12:15], v[36:39], v[140:143], v[12:15]
    v_mfma_f32_16x16x32_bf16 v[8:11], v[40:43], v[144:147], v[8:11]
    v_mfma_f32_16x16x32_bf16 v[12:15], v[40:43], v[148:151], v[12:15]
    v_mfma_f32_16x16x32_bf16 v[8:11], v[44:47], v[152:155], v[8:11]
    v_mfma_f32_16x16x32_bf16 v[12:15], v[44:47], v[156:159], v[12:15]
    v_mfma_f32_16x16x32_bf16 v[8:11], v[48:51], v[160:163], v[8:11]
    v_mfma_f32_16x16x32_bf16 v[12:15], v[48:51], v[164:167], v[12:15]
    v_mfma_f32_16x16x32_bf16 v[8:11], v[52:55], v[168:171], v[8:11]
    v_mfma_f32_16x16x32_bf16 v[12:15], v[52:55], v[172:175], v[12:15]
    v_mfma_f32_16x16x32_bf16 v[8:11], v[56:59], v[176:179], v[8:11]
    v_mfma_f32_16x16x32_bf16 v[12:15], v[56:59], v[180:183], v[12:15]
    v_mfma_f32_16x16x32_bf16 v[8:11], v[60:63], v[184:187], v[8:11]
    v_mfma_f32_16x16x32_bf16 v[12:15], v[60:63], v[188:191], v[12:15]
    v_mfma_f32_16x16x32_bf16 v[8:11], v[64:67], v[192:195], v[8:11]
    v_mfma_f32_16x16x32_bf16 v[12:15], v[64:67], v[196:199], v[12:15]
    v_mfma_f32_16x16x32_bf16 v[8:11], v[68:71], v[200:203], v[8:11]
    v_mfma_f32_16x16x32_bf16 v[12:15], v[68:71], v[204:207], v[12:15]
    v_mfma_f32_16x16x32_bf16 v[8:11], v[72:75], v[208:211], v[8:11]
    v_mfma_f32_16x16x32_bf16 v[12:15], v[72:75], v[212:215], v[12:15]
    v_mfma_f32_16x16x32_bf16 v[8:11], v[76:79], v[216:219], v[8:11]
    v_mfma_f32_16x16x32_bf16 v[12:15], v[76:79], v[220:223], v[12:15]
    v_mfma_f32_16x16x32_bf16 v[8:11], v[80:83], v[224:227], v[8:11]
    v_mfma_f32_16x16x32_bf16 v[12:15], v[80:83], v[228:231], v[12:15]
    v_mfma_f32_16x16x32_bf16 v[8:11], v[84:87], v[232:235], v[8:11]
    v_mfma_f32_16x16x32_bf16 v[12:15], v[84:87], v[236:239], v[12:15]
    v_mfma_f32_16x16x32_bf16 v[8:11], v[88:91], v[240:243], v[8:11]
    v_mfma_f32_16x16x32_bf16 v[12:15], v[88:91], v[244:247], v[12:15]
    v_mfma_f32_16x16x32_bf16 v[8:11], v[92:95], v[248:251], v[8:11]
    v_mfma_f32_16x16x32_bf16 v[12:15], v[92:95], v[252:255], v[12:15]
    s_nop 7
    v_cvt_pk_bf16_f32 v16, v8, v9
    v_cvt_pk_bf16_f32 v17, v10, v11
    v_cvt_pk_bf16_f32 v18, v12, v13
    v_cvt_pk_bf16_f32 v19, v14, v15
    buffer_store_dwordx2 v[16:17], v3, s[4:7], s26 offen sc1
    buffer_store_dwordx2 v[18:19], v3, s[4:7], s26 offen offset:256 sc1
    s_waitcnt vmcnt(0)
    s_barrier
    s_cmp_lg_u32 s14, 0
    s_cbranch_scc1 GF_149
    v_mov_b32 v7, 1
    v_mov_b32 v8, 0
    s_mov_b64 exec, 1
    buffer_store_dword v7, v8, s[4:7], s27 offen sc1
    s_mov_b64 exec, -1
GF_149:
    s_add_u32 s25, s25, 0x10000
    s_add_u32 s30, s30, 0x10000
    s_add_u32 s26, s26, 0x20000
    s_add_u32 s27, s27, 256
    s_add_u32 s28, s28, 512
    s_add_u32 s24, s24, 1
    s_cmp_lt_u32 s24, 32
    s_cbranch_scc1 MKN_LOOP
    s_cmp_ge_u32 s88, 60
    s_cbranch_scc1 M_EXIT
    s_branch H_EXTRA
H_OUT:
    s_lshl_b32 s64, s3, 5
    s_add_u32 s64, s64, s13
    s_cmp_ge_u32 s64, 60
    s_cbranch_scc1 M_EXIT
    s_mul_hi_u32 s12, s64, 0xccccccd
    s_mul_i32 s65, s12, 20
    s_sub_u32 s13, s64, s65
    s_load_dwordx2 s[44:45], s[0:1], 40
    s_mov_b32 s46, 0x500000
    s_mov_b32 s47, 0x00020000
    s_load_dwordx2 s[48:49], s[0:1], 0
    s_mov_b32 s50, 0x280000
    s_mov_b32 s51, 0x00020000
    s_load_dwordx2 s[52:53], s[0:1], 96
    s_mov_b32 s54, 0x280000
    s_mov_b32 s55, 0x00020000
    s_mov_b32 s36, -1
    s_mov_b32 s37, 0
    s_waitcnt lgkmcnt(0)
    s_mul_i32 s21, s14, 36864
    v_lshrrev_b32 v7, 2, v0
    v_mul_u32_u24 v4, 1280, v7
    v_bfe_u32 v7, v0, 4, 1
    v_lshlrev_b32 v7, 1, v7
    v_and_b32 v8, 3, v0
    v_xor_b32 v7, v7, v8
    v_lshl_add_u32 v4, v7, 4, v4
    v_lshrrev_b32 v7, 4, v0
    v_lshlrev_b32 v2, 8, v7
    v_bfe_u32 v7, v0, 2, 2
    v_lshl_add_u32 v2, v7, 6, v2
    v_and_b32 v7, 3, v0
    v_lshl_add_u32 v2, v7, 3, v2
    v_add_u32 v2, s21, v2
    v_bfe_u32 v7, v0, 4, 1
    v_lshlrev_b32 v7, 5, v7
    v_sub_u32 v3, 32, v7
    v_add_u32 v3, v3, v2
    v_add_u32 v2, v2, v7
    s_mul_i32 s65, s14, 1310720
    s_lshl_b32 s66, s13, 6
    s_add_u32 s65, s65, s66
    s_add_u32 m0, s21, 0
    s_add_u32 s64, s65, 0x0
    buffer_load_dwordx4 v4, s[44:47], s64 offen lds
    s_add_u32 m0, s21, 1024
    s_add_u32 s64, s65, 0x5000
    buffer_load_dwordx4 v4, s[44:47], s64 offen lds
    s_add_u32 m0, s21, 2048
    s_add_u32 s64, s65, 0xa000
    buffer_load_dwordx4 v4, s[44:47], s64 offen lds
    s_add_u32 m0, s21, 3072
    s_add_u32 s64, s65, 0xf000
    buffer_load_dwordx4 v4, s[44:47], s64 offen lds
    s_add_u32 m0, s21, 4096
    s_add_u32 s64, s65, 0x14000
    buffer_load_dwordx4 v4, s[44:47], s64 offen lds
    s_add_u32 m0, s21, 5120
    s_add_u32 s64, s65, 0x19000
    buffer_load_dwordx4 v4, s[44:47], s64 offen lds
    s_add_u32 m0, s21, 6144
    s_add_u32 s64, s65, 0x1e000
    buffer_load_dwordx4 v4, s[44:47], s64 offen lds
    s_add_u32 m0, s21, 7168
    s_add_u32 s64, s65, 0x23000
    buffer_load_dwordx4 v4, s[44:47], s64 offen lds
    s_add_u32 m0, s21, 8192
    s_add_u32 s64, s65, 0x28000
    buffer_load_dwordx4 v4, s[44:47], s64 offen lds
    s_add_u32 m0, s21, 9216
    s_add_u32 s64, s65, 0x2d000
    buffer_load_dwordx4 v4, s[44:47], s64 offen lds
    s_add_u32 m0, s21, 10240
    s_add_u32 s64, s65, 0x32000
    buffer_load_dwordx4 v4, s[44:47], s64 offen lds
    s_add_u32 m0, s21, 11264
    s_add_u32 s64, s65, 0x37000
    buffer_load_dwordx4 v4, s[44:47], s64 offen lds
    s_add_u32 m0, s21, 12288
    s_add_u32 s64, s65, 0x3c000
    buffer_load_dwordx4 v4, s[44:47], s64 offen lds
    s_add_u32 m0, s21, 13312
    s_add_u32 s64, s65, 0x41000
    buffer_load_dwordx4 v4, s[44:47], s64 offen lds
    s_add_u32 m0, s21, 14336
    s_add_u32 s64, s65, 0x46000
    buffer_load_dwordx4 v4, s[44:47], s64 offen lds
    s_add_u32 m0, s21, 15360
    s_add_u32 s64, s65, 0x4b000
    buffer_load_dwordx4 v4, s[44:47], s64 offen lds
    s_add_u32 m0, s21, 16384
    s_add_u32 s64, s65, 0x50000
    buffer_load_dwordx4 v4, s[44:47], s64 offen lds
    s_add_u32 m0, s21, 17408
    s_add_u32 s64, s65, 0x55000
    buffer_load_dwordx4 v4, s[44:47], s64 offen lds
    s_add_u32 m0, s21, 18432
    s_add_u32 s64, s65, 0x5a000
    buffer_load_dwordx4 v4, s[44:47], s64 offen lds
    s_add_u32 m0, s21, 19456
    s_add_u32 s64, s65, 0x5f000
    buffer_load_dwordx4 v4, s[44:47], s64 offen lds
    s_add_u32 m0, s21, 20480
    s_add_u32 s64, s65, 0x64000
    buffer_load_dwordx4 v4, s[44:47], s64 offen lds
    s_add_u32 m0, s21, 21504
    s_add_u32 s64, s65, 0x69000
    buffer_load_dwordx4 v4, s[44:47], s64 offen lds
    s_add_u32 m0, s21, 22528
    s_add_u32 s64, s65, 0x6e000
    buffer_load_dwordx4 v4, s[44:47], s64 offen lds
    s_add_u32 m0, s21, 23552
    s_add_u32 s64, s65, 0x73000
    buffer_load_dwordx4 v4, s[44:47], s64 offen lds
    s_add_u32 m0, s21, 24576
    s_add_u32 s64, s65, 0x78000
    buffer_load_dwordx4 v4, s[44:47], s64 offen lds
    s_add_u32 m0, s21, 25600
    s_add_u32 s64, s65, 0x7d000
    buffer_load_dwordx4 v4, s[44:47], s64 offen lds
    s_add_u32 m0, s21, 26624
    s_add_u32 s64, s65, 0x82000
    buffer_load_dwordx4 v4, s[44:47], s64 offen lds
    s_add_u32 m0, s21, 27648
    s_add_u32 s64, s65, 0x87000
    buffer_load_dwordx4 v4, s[44:47], s64 offen lds
    s_add_u32 m0, s21, 28672
    s_add_u32 s64, s65, 0x8c000
    buffer_load_dwordx4 v4, s[44:47], s64 offen lds
    s_add_u32 m0, s21, 29696
    s_add_u32 s64, s65, 0x91000
    buffer_load_dwordx4 v4, s[44:47], s64 offen lds
    s_add_u32 m0, s21, 30720
    s_add_u32 s64, s65, 0x96000
    buffer_load_dwordx4 v4, s[44:47], s64 offen lds
    s_add_u32 m0, s21, 31744
    s_add_u32 s64, s65, 0x9b000
    buffer_load_dwordx4 v4, s[44:47], s64 offen lds
    s_add_u32 m0, s21, 32768
    s_add_u32 s64, s65, 0xa0000
    buffer_load_dwordx4 v4, s[44:47], s64 offen lds
    s_add_u32 m0, s21, 33792
    s_add_u32 s64, s65, 0xa5000
    buffer_load_dwordx4 v4, s[44:47], s64 offen lds
    s_add_u32 m0, s21, 34816
    s_add_u32 s64, s65, 0xaa000
    buffer_load_dwordx4 v4, s[44:47], s64 offen lds
    s_add_u32 m0, s21, 35840
    s_add_u32 s64, s65, 0xaf000
    buffer_load_dwordx4 v4, s[44:47], s64 offen lds
    s_waitcnt vmcnt(32)
    ds_read_b64_tr_b16 a[0:1], v2 offset:0
    ds_read_b64_tr_b16 a[2:3], v2 offset:1024
    ds_read_b64_tr_b16 a[4:5], v3 offset:0
    ds_read_b64_tr_b16 a[6:7], v3 offset:1024
    ds_read_b64_tr_b16 a[8:9], v2 offset:2048
    ds_read_b64_tr_b16 a[10:11], v2 offset:3072
    ds_read_b64_tr_b16 a[12:13], v3 offset:2048
    ds_read_b64_tr_b16 a[14:15], v3 offset:3072
    s_waitcnt lgkmcnt(0)
    s_add_u32 m0, s21, 0
    s_add_u32 s64, s65, 0xb4000
    buffer_load_dwordx4 v4, s[44:47], s64 offen lds
    s_add_u32 m0, s21, 1024
    s_add_u32 s64, s65, 0xb9000
    buffer_load_dwordx4 v4, s[44:47], s64 offen lds
    s_add_u32 m0, s21, 2048
    s_add_u32 s64, s65, 0xbe000
    buffer_load_dwordx4 v4, s[44:47], s64 offen lds
    s_add_u32 m0, s21, 3072
    s_add_u32 s64, s65, 0xc3000
    buffer_load_dwordx4 v4, s[44:47], s64 offen lds
    s_waitcnt vmcnt(32)
    ds_read_b64_tr_b16 a[16:17], v2 offset:4096
    ds_read_b64_tr_b16 a[18:19], v2 offset:5120
    ds_read_b64_tr_b16 a[20:21], v3 offset:4096
    ds_read_b64_tr_b16 a[22:23], v3 offset:5120
    ds_read_b64_tr_b16 a[24:25], v2 offset:6144
    ds_read_b64_tr_b16 a[26:27], v2 offset:7168
    ds_read_b64_tr_b16 a[28:29], v3 offset:6144
    ds_read_b64_tr_b16 a[30:31], v3 offset:7168
    s_waitcnt lgkmcnt(0)
    s_add_u32 m0, s21, 4096
    s_add_u32 s64, s65, 0xc8000
    buffer_load_dwordx4 v4, s[44:47], s64 offen lds
    s_add_u32 m0, s21, 5120
    s_add_u32 s64, s65, 0xcd000
    buffer_load_dwordx4 v4, s[44:47], s64 offen lds
    s_add_u32 m0, s21, 6144
    s_add_u32 s64, s65, 0xd2000
    buffer_load_dwordx4 v4, s[44:47], s64 offen lds
    s_add_u32 m0, s21, 7168
    s_add_u32 s64, s65, 0xd7000
    buffer_load_dwordx4 v4, s[44:47], s64 offen lds
    s_waitcnt vmcnt(32)
    ds_read_b64_tr_b16 a[32:33], v2 offset:8192
    ds_read_b64_tr_b16 a[34:35], v2 offset:9216
    ds_read_b64_tr_b16 a[36:37], v3 offset:8192
    ds_read_b64_tr_b16 a[38:39], v3 offset:9216
    ds_read_b64_tr_b16 a[40:41], v2 offset:10240
    ds_read_b64_tr_b16 a[42:43], v2 offset:11264
    ds_read_b64_tr_b16 a[44:45], v3 offset:10240
    ds_read_b64_tr_b16 a[46:47], v3 offset:11264
    s_waitcnt lgkmcnt(0)
    s_add_u32 m0, s21, 8192
    s_add_u32 s64, s65, 0xdc000
    buffer_load_dwordx4 v4, s[44:47], s64 offen lds
    s_add_u32 m0, s21, 9216
    s_add_u32 s64, s65, 0xe1000
    buffer_load_dwordx4 v4, s[44:47], s64 offen lds
    s_add_u32 m0, s21, 10240
    s_add_u32 s64, s65, 0xe6000
    buffer_load_dwordx4 v4, s[44:47], s64 offen lds
    s_add_u32 m0, s21, 11264
    s_add_u32 s64, s65, 0xeb000
    buffer_load_dwordx4 v4, s[44:47], s64 offen lds
    s_waitcnt vmcnt(32)
    ds_read_b64_tr_b16 a[48:49], v2 offset:12288
    ds_read_b64_tr_b16 a[50:51], v2 offset:13312
    ds_read_b64_tr_b16 a[52:53], v3 offset:12288
    ds_read_b64_tr_b16 a[54:55], v3 offset:13312
    ds_read_b64_tr_b16 a[56:57], v2 offset:14336
    ds_read_b64_tr_b16 a[58:59], v2 offset:15360
    ds_read_b64_tr_b16 a[60:61], v3 offset:14336
    ds_read_b64_tr_b16 a[62:63], v3 offset:15360
    s_waitcnt lgkmcnt(0)
    s_add_u32 m0, s21, 12288
    s_add_u32 s64, s65, 0xf0000
    buffer_load_dwordx4 v4, s[44:47], s64 offen lds
    s_add_u32 m0, s21, 13312
    s_add_u32 s64, s65, 0xf5000
    buffer_load_dwordx4 v4, s[44:47], s64 offen lds
    s_add_u32 m0, s21, 14336
    s_add_u32 s64, s65, 0xfa000
    buffer_load_dwordx4 v4, s[44:47], s64 offen lds
    s_add_u32 m0, s21, 15360
    s_add_u32 s64, s65, 0xff000
    buffer_load_dwordx4 v4, s[44:47], s64 offen lds
    s_waitcnt vmcnt(32)
    ds_read_b64_tr_b16 a[64:65], v2 offset:16384
    ds_read_b64_tr_b16 a[66:67], v2 offset:17408
    ds_read_b64_tr_b16 a[68:69], v3 offset:16384
    ds_read_b64_tr_b16 a[70:71], v3 offset:17408
    ds_read_b64_tr_b16 a[72:73], v2 offset:18432
    ds_read_b64_tr_b16 a[74:75], v2 offset:19456
    ds_read_b64_tr_b16 a[76:77], v3 offset:18432
    ds_read_b64_tr_b16 a[78:79], v3 offset:19456
    s_waitcnt lgkmcnt(0)
    s_add_u32 m0, s21, 16384
    s_add_u32 s64, s65, 0x104000
    buffer_load_dwordx4 v4, s[44:47], s64 offen lds
    s_add_u32 m0, s21, 17408
    s_add_u32 s64, s65, 0x109000
    buffer_load_dwordx4 v4, s[44:47], s64 offen lds
    s_add_u32 m0, s21, 18432
    s_add_u32 s64, s65, 0x10e000
    buffer_load_dwordx4 v4, s[44:47], s64 offen lds
    s_add_u32 m0, s21, 19456
    s_add_u32 s64, s65, 0x113000
    buffer_load_dwordx4 v4, s[44:47], s64 offen lds
    s_waitcnt vmcnt(32)
    ds_read_b64_tr_b16 a[80:81], v2 offset:20480
    ds_read_b64_tr_b16 a[82:83], v2 offset:21504
    ds_read_b64_tr_b16 a[84:85], v3 offset:20480
    ds_read_b64_tr_b16 a[86:87], v3 offset:21504
    ds_read_b64_tr_b16 a[88:89], v2 offset:22528
    ds_read_b64_tr_b16 a[90:91], v2 offset:23552
    ds_read_b64_tr_b16 a[92:93], v3 offset:22528
    ds_read_b64_tr_b16 a[94:95], v3 offset:23552
    s_waitcnt lgkmcnt(0)
    s_add_u32 m0, s21, 20480
    s_add_u32 s64, s65, 0x118000
    buffer_load_dwordx4 v4, s[44:47], s64 offen lds
    s_add_u32 m0, s21, 21504
    s_add_u32 s64, s65, 0x11d000
    buffer_load_dwordx4 v4, s[44:47], s64 offen lds
    s_add_u32 m0, s21, 22528
    s_add_u32 s64, s65, 0x122000
    buffer_load_dwordx4 v4, s[44:47], s64 offen lds
    s_add_u32 m0, s21, 23552
    s_add_u32 s64, s65, 0x127000
    buffer_load_dwordx4 v4, s[44:47], s64 offen lds
    s_waitcnt vmcnt(32)
    ds_read_b64_tr_b16 a[96:97], v2 offset:24576
    ds_read_b64_tr_b16 a[98:99], v2 offset:25600
    ds_read_b64_tr_b16 a[100:101], v3 offset:24576
    ds_read_b64_tr_b16 a[102:103], v3 offset:25600
    ds_read_b64_tr_b16 a[104:105], v2 offset:26624
    ds_read_b64_tr_b16 a[106:107], v2 offset:27648
    ds_read_b64_tr_b16 a[108:109], v3 offset:26624
    ds_read_b64_tr_b16 a[110:111], v3 offset:27648
    s_waitcnt lgkmcnt(0)
    s_add_u32 m0, s21, 24576
    s_add_u32 s64, s65, 0x12c000
    buffer_load_dwordx4 v4, s[44:47], s64 offen lds
    s_add_u32 m0, s21, 25600
    s_add_u32 s64, s65, 0x131000
    buffer_load_dwordx4 v4, s[44:47], s64 offen lds
    s_add_u32 m0, s21, 26624
    s_add_u32 s64, s65, 0x136000
    buffer_load_dwordx4 v4, s[44:47], s64 offen lds
    s_add_u32 m0, s21, 27648
    s_add_u32 s64, s65, 0x13b000
    buffer_load_dwordx4 v4, s[44:47], s64 offen lds
    s_waitcnt vmcnt(32)
    ds_read_b64_tr_b16 a[112:113], v2 offset:28672
    ds_read_b64_tr_b16 a[114:115], v2 offset:29696
    ds_read_b64_tr_b16 a[116:117], v3 offset:28672
    ds_read_b64_tr_b16 a[118:119], v3 offset:29696
    ds_read_b64_tr_b16 a[120:121], v2 offset:30720
    ds_read_b64_tr_b16 a[122:123], v2 offset:31744
    ds_read_b64_tr_b16 a[124:125], v3 offset:30720
    ds_read_b64_tr_b16 a[126:127], v3 offset:31744
    s_waitcnt lgkmcnt(0)
    s_waitcnt vmcnt(28)
    ds_read_b64_tr_b16 a[128:129], v2 offset:32768
    ds_read_b64_tr_b16 a[130:131], v2 offset:33792
    ds_read_b64_tr_b16 a[132:133], v3 offset:32768
    ds_read_b64_tr_b16 a[134:135], v3 offset:33792
    ds_read_b64_tr_b16 a[136:137], v2 offset:34816
    ds_read_b64_tr_b16 a[138:139], v2 offset:35840
    ds_read_b64_tr_b16 a[140:141], v3 offset:34816
    ds_read_b64_tr_b16 a[142:143], v3 offset:35840
    s_waitcnt lgkmcnt(0)
    s_waitcnt vmcnt(24)
    ds_read_b64_tr_b16 a[144:145], v2 offset:0
    ds_read_b64_tr_b16 a[146:147], v2 offset:1024
    ds_read_b64_tr_b16 a[148:149], v3 offset:0
    ds_read_b64_tr_b16 a[150:151], v3 offset:1024
    ds_read_b64_tr_b16 a[152:153], v2 offset:2048
    ds_read_b64_tr_b16 a[154:155], v2 offset:3072
    ds_read_b64_tr_b16 a[156:157], v3 offset:2048
    ds_read_b64_tr_b16 a[158:159], v3 offset:3072
    s_waitcnt lgkmcnt(0)
    s_waitcnt vmcnt(20)
    ds_read_b64_tr_b16 a[160:161], v2 offset:4096
    ds_read_b64_tr_b16 a[162:163], v2 offset:5120
    ds_read_b64_tr_b16 a[164:165], v3 offset:4096
    ds_read_b64_tr_b16 a[166:167], v3 offset:5120
    ds_read_b64_tr_b16 a[168:169], v2 offset:6144
    ds_read_b64_tr_b16 a[170:171], v2 offset:7168
    ds_read_b64_tr_b16 a[172:173], v3 offset:6144
    ds_read_b64_tr_b16 a[174:175], v3 offset:7168
    s_waitcnt lgkmcnt(0)
    s_waitcnt vmcnt(16)
    ds_read_b64_tr_b16 a[176:177], v2 offset:8192
    ds_read_b64_tr_b16 a[178:179], v2 offset:9216
    ds_read_b64_tr_b16 a[180:181], v3 offset:8192
    ds_read_b64_tr_b16 a[182:183], v3 offset:9216
    ds_read_b64_tr_b16 a[184:185], v2 offset:10240
    ds_read_b64_tr_b16 a[186:187], v2 offset:11264
    ds_read_b64_tr_b16 a[188:189], v3 offset:10240
    ds_read_b64_tr_b16 a[190:191], v3 offset:11264
    s_waitcnt lgkmcnt(0)
    s_waitcnt vmcnt(12)
    ds_read_b64_tr_b16 a[192:193], v2 offset:12288
    ds_read_b64_tr_b16 a[194:195], v2 offset:13312
    ds_read_b64_tr_b16 a[196:197], v3 offset:12288
    ds_read_b64_tr_b16 a[198:199], v3 offset:13312
    ds_read_b64_tr_b16 a[200:201], v2 offset:14336
    ds_read_b64_tr_b16 a[202:203], v2 offset:15360
    ds_read_b64_tr_b16 a[204:205], v3 offset:14336
    ds_read_b64_tr_b16 a[206:207], v3 offset:15360
    s_waitcnt lgkmcnt(0)
    s_waitcnt vmcnt(8)
    ds_read_b64_tr_b16 a[208:209], v2 offset:16384
    ds_read_b64_tr_b16 a[210:211], v2 offset:17408
    ds_read_b64_tr_b16 a[212:213], v3 offset:16384
    ds_read_b64_tr_b16 a[214:215], v3 offset:17408
    ds_read_b64_tr_b16 a[216:217], v2 offset:18432
    ds_read_b64_tr_b16 a[218:219], v2 offset:19456
    ds_read_b64_tr_b16 a[220:221], v3 offset:18432
    ds_read_b64_tr_b16 a[222:223], v3 offset:19456
    s_waitcnt lgkmcnt(0)
    s_waitcnt vmcnt(4)
    ds_read_b64_tr_b16 a[224:225], v2 offset:20480
    ds_read_b64_tr_b16 a[226:227], v2 offset:21504
    ds_read_b64_tr_b16 a[228:229], v3 offset:20480
    ds_read_b64_tr_b16 a[230:231], v3 offset:21504
    ds_read_b64_tr_b16 a[232:233], v2 offset:22528
    ds_read_b64_tr_b16 a[234:235], v2 offset:23552
    ds_read_b64_tr_b16 a[236:237], v3 offset:22528
    ds_read_b64_tr_b16 a[238:239], v3 offset:23552
    s_waitcnt lgkmcnt(0)
    s_waitcnt vmcnt(0)
    ds_read_b64_tr_b16 a[240:241], v2 offset:24576
    ds_read_b64_tr_b16 a[242:243], v2 offset:25600
    ds_read_b64_tr_b16 a[244:245], v3 offset:24576
    ds_read_b64_tr_b16 a[246:247], v3 offset:25600
    ds_read_b64_tr_b16 a[248:249], v2 offset:26624
    ds_read_b64_tr_b16 a[250:251], v2 offset:27648
    ds_read_b64_tr_b16 a[252:253], v3 offset:26624
    ds_read_b64_tr_b16 a[254:255], v3 offset:27648
    s_waitcnt lgkmcnt(0)
    s_barrier
    s_mov_b32 s29, 0
    v_lshlrev_b32 v1, 4, v0
    v_mov_b32 v8, 0
    s_mov_b32 s64, 0x298000
OUS_150:
    buffer_load_dword v7, v8, s[4:7], s64 offen sc1
    s_add_u32 s29, s29, 1
    s_waitcnt vmcnt(0)
    v_cmp_gt_u32 vcc, 1, v7
    s_cbranch_vccz OUSD_151
    s_cmp_gt_u32 s29, 262144
    s_cbranch_scc1 OUSD_151
    s_sleep 8
    s_branch OUS_150
OUSD_151:
    v_lshlrev_b32 v6, 2, v0
    s_mov_b32 s64, 0x5400000
    buffer_load_dword v7, v6, s[4:7], s64 offen sc1
    s_waitcnt vmcnt(0)
    v_readlane_b32 s72, v7, 0
    v_readlane_b32 s73, v7, 1
    v_readlane_b32 s74, v7, 2
    v_readlane_b32 s75, v7, 3
    v_readlane_b32 s76, v7, 4
    v_readlane_b32 s77, v7, 5
    v_readlane_b32 s78, v7, 6
    v_readlane_b32 s79, v7, 7
    s_and_b32 s64, s14, 1
    s_lshl_b32 s64, s64, 4
    v_and_b32 v6, 15, v0
    v_add_u32 v6, s64, v6
    v_mov_b32 v9, v6
    v_mul_u32_u24 v5, 1280, v6
    v_lshrrev_b32 v6, 4, v0
    v_lshl_add_u32 v5, v6, 3, v5
    s_lshr_b32 s64, s14, 1
    s_lshl_b32 s64, s64, 5
    s_lshl_b32 s65, s13, 6
    s_add_u32 s64, s64, s65
    v_add_u32 v5, s64, v5
    v_lshlrev_b32 v6, 2, v0
    s_mov_b32 s80, 0x49249249
    s_mov_b32 s81, 0x92492492
    s_lshl_b64 s[80:81], s[80:81], s12
    s_bitset0_b64 s[80:81], 63
    s_bitset0_b64 s[80:81], 62
    s_mov_b64 s[82:83], 0
    s_lshr_b32 s64, s72, 5
    s_bitset1_b64 s[82:83], s64
    s_lshr_b32 s64, s73, 5
    s_bitset1_b64 s[82:83], s64
    s_lshr_b32 s64, s74, 5
    s_bitset1_b64 s[82:83], s64
    s_lshr_b32 s64, s75, 5
    s_bitset1_b64 s[82:83], s64
    s_lshr_b32 s64, s76, 5
    s_bitset1_b64 s[82:83], s64
    s_lshr_b32 s64, s77, 5
    s_bitset1_b64 s[82:83], s64
    s_lshr_b32 s64, s78, 5
    s_bitset1_b64 s[82:83], s64
    s_lshr_b32 s64, s79, 5
    s_bitset1_b64 s[82:83], s64
OU_LOOP:
    s_cmp_eq_u64 s[80:81], 0
    s_cbranch_scc1 OU_END
    s_andn2_b64 s[84:85], s[80:81], s[82:83]
    s_cbranch_scc0 OU_WM
    s_ff1_i32_b64 s24, s[84:85]
    s_branch OU_GO
OU_WM:
    v_mov_b32 v8, 0
    s_mov_b32 s64, 0x298100
OUW_152:
    buffer_load_dword v7, v8, s[4:7], s64 offen sc1
    s_add_u32 s29, s29, 1
    s_waitcnt vmcnt(0)
    v_cmp_gt_u32 vcc, 40, v7
    s_cbranch_vccz OUWD_153
    s_cmp_gt_u32 s29, 262144
    s_cbranch_scc1 OUWD_153
    s_sleep 8
    s_branch OUW_152
OUWD_153:
    s_mov_b64 s[82:83], 0
    s_branch OU_LOOP
OU_GO:
    s_bitset0_b64 s[80:81], s24
    s_lshr_b32 s86, s14, 1
    s_mul_i32 s67, s24, 40960
    buffer_load_dwordx2 v[160:161], v5, s[48:51], s67 offen
    s_add_u32 s64, s67, 0x0
    buffer_load_dwordx2 v[162:163], v5, s[4:7], s64 offen
    s_mov_b32 s64, 0x298100
    buffer_load_dword v12, off, s[4:7], s64 sc1
    s_lshl_b32 s64, s24, 7
    s_add_u32 s64, s64, 0x296000
    s_mov_b64 exec, s[36:37]
OU_F_154:
    buffer_load_dword v7, v6, s[4:7], s64 offen sc1
    s_add_u32 s29, s29, 1
    s_waitcnt vmcnt(0)
    v_cmp_eq_u32 vcc, 0, v7
    s_cbranch_vccz OU_FD_155
    s_cmp_gt_u32 s29, 262144
    s_cbranch_scc1 OU_FD_155
    s_sleep 1
    s_branch OU_F_154
OU_FD_155:
    s_mov_b64 exec, -1
    s_lshl_b32 s25, s24, 18
    s_lshl_b32 s64, s14, 15
    s_add_u32 s25, s25, s64
    s_add_u32 s25, s25, 0x4400000
    s_add_u32 s64, s25, 0x0
    buffer_load_dwordx4 v[16:19], v1, s[4:7], s64 offen
    s_add_u32 s64, s25, 0x20000
    buffer_load_dwordx4 v[20:23], v1, s[4:7], s64 offen
    s_add_u32 s64, s25, 0x400
    buffer_load_dwordx4 v[24:27], v1, s[4:7], s64 offen
    s_add_u32 s64, s25, 0x20400
    buffer_load_dwordx4 v[28:31], v1, s[4:7], s64 offen
    s_add_u32 s64, s25, 0x800
    buffer_load_dwordx4 v[32:35], v1, s[4:7], s64 offen
    s_add_u32 s64, s25, 0x20800
    buffer_load_dwordx4 v[36:39], v1, s[4:7], s64 offen
    s_add_u32 s64, s25, 0xc00
    buffer_load_dwordx4 v[40:43], v1, s[4:7], s64 offen
    s_add_u32 s64, s25, 0x20c00
    buffer_load_dwordx4 v[44:47], v1, s[4:7], s64 offen
    s_add_u32 s64, s25, 0x1000
    buffer_load_dwordx4 v[48:51], v1, s[4:7], s64 offen
    s_add_u32 s64, s25, 0x21000
    buffer_load_dwordx4 v[52:55], v1, s[4:7], s64 offen
    s_add_u32 s64, s25, 0x1400
    buffer_load_dwordx4 v[56:59], v1, s[4:7], s64 offen
    s_add_u32 s64, s25, 0x21400
    buffer_load_dwordx4 v[60:63], v1, s[4:7], s64 offen
    s_add_u32 s64, s25, 0x1800
    buffer_load_dwordx4 v[64:67], v1, s[4:7], s64 offen
    s_add_u32 s64, s25, 0x21800
    buffer_load_dwordx4 v[68:71], v1, s[4:7], s64 offen
    s_add_u32 s64, s25, 0x1c00
    buffer_load_dwordx4 v[72:75], v1, s[4:7], s64 offen
    s_add_u32 s64, s25, 0x21c00
    buffer_load_dwordx4 v[76:79], v1, s[4:7], s64 offen
    s_add_u32 s64, s25, 0x2000
    buffer_load_dwordx4 v[80:83], v1, s[4:7], s64 offen
    s_add_u32 s64, s25, 0x22000
    buffer_load_dwordx4 v[84:87], v1, s[4:7], s64 offen
    s_add_u32 s64, s25, 0x2400
    buffer_load_dwordx4 v[88:91], v1, s[4:7], s64 offen
    s_add_u32 s64, s25, 0x22400
    buffer_load_dwordx4 v[92:95], v1, s[4:7], s64 offen
    s_add_u32 s64, s25, 0x2800
    buffer_load_dwordx4 v[96:99], v1, s[4:7], s64 offen
    s_add_u32 s64, s25, 0x22800
    buffer_load_dwordx4 v[100:103], v1, s[4:7], s64 offen
    s_add_u32 s64, s25, 0x2c00
    buffer_load_dwordx4 v[104:107], v1, s[4:7], s64 offen
    s_add_u32 s64, s25, 0x22c00
    buffer_load_dwordx4 v[108:111], v1, s[4:7], s64 offen
    s_add_u32 s64, s25, 0x3000
    buffer_load_dwordx4 v[112:115], v1, s[4:7], s64 offen
    s_add_u32 s64, s25, 0x23000
    buffer_load_dwordx4 v[116:119], v1, s[4:7], s64 offen
    s_add_u32 s64, s25, 0x3400
    buffer_load_dwordx4 v[120:123], v1, s[4:7], s64 offen
    s_add_u32 s64, s25, 0x23400
    buffer_load_dwordx4 v[124:127], v1, s[4:7], s64 offen
    s_add_u32 s64, s25, 0x3800
    buffer_load_dwordx4 v[128:131], v1, s[4:7], s64 offen
    s_add_u32 s64, s25, 0x23800
    buffer_load_dwordx4 v[132:135], v1, s[4:7], s64 offen
    s_add_u32 s64, s25, 0x3c00
    buffer_load_dwordx4 v[136:139], v1, s[4:7], s64 offen
    s_add_u32 s64, s25, 0x23c00
    buffer_load_dwordx4 v[140:143], v1, s[4:7], s64 offen
    s_waitcnt vmcnt(30)
    v_mfma_f32_16x16x32_bf16 v[144:147], a[0:3], v[16:19], 0
    v_mfma_f32_16x16x32_bf16 v[148:151], a[0:3], v[20:23], 0
    v_mfma_f32_16x16x32_bf16 v[152:155], a[4:7], v[16:19], 0
    v_mfma_f32_16x16x32_bf16 v[156:159], a[4:7], v[20:23], 0
    s_add_u32 s64, s25, 0x4000
    buffer_load_dwordx4 v[16:19], v1, s[4:7], s64 offen
    s_add_u32 s64, s25, 0x24000
    buffer_load_dwordx4 v[20:23], v1, s[4:7], s64 offen
    s_waitcnt vmcnt(30)
    v_mfma_f32_16x16x32_bf16 v[144:147], a[8:11], v[24:27], v[144:147]
    v_mfma_f32_16x16x32_bf16 v[148:151], a[8:11], v[28:31], v[148:151]
    v_mfma_f32_16x16x32_bf16 v[152:155], a[12:15], v[24:27], v[152:155]
    v_mfma_f32_16x16x32_bf16 v[156:159], a[12:15], v[28:31], v[156:159]
    s_add_u32 s64, s25, 0x4400
    buffer_load_dwordx4 v[24:27], v1, s[4:7], s64 offen
    s_add_u32 s64, s25, 0x24400
    buffer_load_dwordx4 v[28:31], v1, s[4:7], s64 offen
    s_waitcnt vmcnt(30)
    v_mfma_f32_16x16x32_bf16 v[144:147], a[16:19], v[32:35], v[144:147]
    v_mfma_f32_16x16x32_bf16 v[148:151], a[16:19], v[36:39], v[148:151]
    v_mfma_f32_16x16x32_bf16 v[152:155], a[20:23], v[32:35], v[152:155]
    v_mfma_f32_16x16x32_bf16 v[156:159], a[20:23], v[36:39], v[156:159]
    s_add_u32 s64, s25, 0x4800
    buffer_load_dwordx4 v[32:35], v1, s[4:7], s64 offen
    s_add_u32 s64, s25, 0x24800
    buffer_load_dwordx4 v[36:39], v1, s[4:7], s64 offen
    s_waitcnt vmcnt(30)
    v_mfma_f32_16x16x32_bf16 v[144:147], a[24:27], v[40:43], v[144:147]
    v_mfma_f32_16x16x32_bf16 v[148:151], a[24:27], v[44:47], v[148:151]
    v_mfma_f32_16x16x32_bf16 v[152:155], a[28:31], v[40:43], v[152:155]
    v_mfma_f32_16x16x32_bf16 v[156:159], a[28:31], v[44:47], v[156:159]
    s_add_u32 s64, s25, 0x4c00
    buffer_load_dwordx4 v[40:43], v1, s[4:7], s64 offen
    s_add_u32 s64, s25, 0x24c00
    buffer_load_dwordx4 v[44:47], v1, s[4:7], s64 offen
    s_waitcnt vmcnt(30)
    v_mfma_f32_16x16x32_bf16 v[144:147], a[32:35], v[48:51], v[144:147]
    v_mfma_f32_16x16x32_bf16 v[148:151], a[32:35], v[52:55], v[148:151]
    v_mfma_f32_16x16x32_bf16 v[152:155], a[36:39], v[48:51], v[152:155]
    v_mfma_f32_16x16x32_bf16 v[156:159], a[36:39], v[52:55], v[156:159]
    s_add_u32 s64, s25, 0x5000
    buffer_load_dwordx4 v[48:51], v1, s[4:7], s64 offen
    s_add_u32 s64, s25, 0x25000
    buffer_load_dwordx4 v[52:55], v1, s[4:7], s64 offen
    s_waitcnt vmcnt(30)
    v_mfma_f32_16x16x32_bf16 v[144:147], a[40:43], v[56:59], v[144:147]
    v_mfma_f32_16x16x32_bf16 v[148:151], a[40:43], v[60:63], v[148:151]
    v_mfma_f32_16x16x32_bf16 v[152:155], a[44:47], v[56:59], v[152:155]
    v_mfma_f32_16x16x32_bf16 v[156:159], a[44:47], v[60:63], v[156:159]
    s_add_u32 s64, s25, 0x5400
    buffer_load_dwordx4 v[56:59], v1, s[4:7], s64 offen
    s_add_u32 s64, s25, 0x25400
    buffer_load_dwordx4 v[60:63], v1, s[4:7], s64 offen
    s_waitcnt vmcnt(30)
    v_mfma_f32_16x16x32_bf16 v[144:147], a[48:51], v[64:67], v[144:147]
    v_mfma_f32_16x16x32_bf16 v[148:151], a[48:51], v[68:71], v[148:151]
    v_mfma_f32_16x16x32_bf16 v[152:155], a[52:55], v[64:67], v[152:155]
    v_mfma_f32_16x16x32_bf16 v[156:159], a[52:55], v[68:71], v[156:159]
    s_add_u32 s64, s25, 0x5800
    buffer_load_dwordx4 v[64:67], v1, s[4:7], s64 offen
    s_add_u32 s64, s25, 0x25800
    buffer_load_dwordx4 v[68:71], v1, s[4:7], s64 offen
    s_waitcnt vmcnt(30)
    v_mfma_f32_16x16x32_bf16 v[144:147], a[56:59], v[72:75], v[144:147]
    v_mfma_f32_16x16x32_bf16 v[148:151], a[56:59], v[76:79], v[148:151]
    v_mfma_f32_16x16x32_bf16 v[152:155], a[60:63], v[72:75], v[152:155]
    v_mfma_f32_16x16x32_bf16 v[156:159], a[60:63], v[76:79], v[156:159]
    s_add_u32 s64, s25, 0x5c00
    buffer_load_dwordx4 v[72:75], v1, s[4:7], s64 offen
    s_add_u32 s64, s25, 0x25c00
    buffer_load_dwordx4 v[76:79], v1, s[4:7], s64 offen
    s_waitcnt vmcnt(30)
    v_mfma_f32_16x16x32_bf16 v[144:147], a[64:67], v[80:83], v[144:147]
    v_mfma_f32_16x16x32_bf16 v[148:151], a[64:67], v[84:87], v[148:151]
    v_mfma_f32_16x16x32_bf16 v[152:155], a[68:71], v[80:83], v[152:155]
    v_mfma_f32_16x16x32_bf16 v[156:159], a[68:71], v[84:87], v[156:159]
    s_add_u32 s64, s25, 0x6000
    buffer_load_dwordx4 v[80:83], v1, s[4:7], s64 offen
    s_add_u32 s64, s25, 0x26000
    buffer_load_dwordx4 v[84:87], v1, s[4:7], s64 offen
    s_waitcnt vmcnt(30)
    v_mfma_f32_16x16x32_bf16 v[144:147], a[72:75], v[88:91], v[144:147]
    v_mfma_f32_16x16x32_bf16 v[148:151], a[72:75], v[92:95], v[148:151]
    v_mfma_f32_16x16x32_bf16 v[152:155], a[76:79], v[88:91], v[152:155]
    v_mfma_f32_16x16x32_bf16 v[156:159], a[76:79], v[92:95], v[156:159]
    s_add_u32 s64, s25, 0x6400
    buffer_load_dwordx4 v[88:91], v1, s[4:7], s64 offen
    s_add_u32 s64, s25, 0x26400
    buffer_load_dwordx4 v[92:95], v1, s[4:7], s64 offen
    s_waitcnt vmcnt(30)
    v_mfma_f32_16x16x32_bf16 v[144:147], a[80:83], v[96:99], v[144:147]
    v_mfma_f32_16x16x32_bf16 v[148:151], a[80:83], v[100:103], v[148:151]
    v_mfma_f32_16x16x32_bf16 v[152:155], a[84:87], v[96:99], v[152:155]
    v_mfma_f32_16x16x32_bf16 v[156:159], a[84:87], v[100:103], v[156:159]
    s_add_u32 s64, s25, 0x6800
    buffer_load_dwordx4 v[96:99], v1, s[4:7], s64 offen
    s_add_u32 s64, s25, 0x26800
    buffer_load_dwordx4 v[100:103], v1, s[4:7], s64 offen
    s_waitcnt vmcnt(30)
    v_mfma_f32_16x16x32_bf16 v[144:147], a[88:91], v[104:107], v[144:147]
    v_mfma_f32_16x16x32_bf16 v[148:151], a[88:91], v[108:111], v[148:151]
    v_mfma_f32_16x16x32_bf16 v[152:155], a[92:95], v[104:107], v[152:155]
    v_mfma_f32_16x16x32_bf16 v[156:159], a[92:95], v[108:111], v[156:159]
    s_add_u32 s64, s25, 0x6c00
    buffer_load_dwordx4 v[104:107], v1, s[4:7], s64 offen
    s_add_u32 s64, s25, 0x26c00
    buffer_load_dwordx4 v[108:111], v1, s[4:7], s64 offen
    s_waitcnt vmcnt(30)
    v_mfma_f32_16x16x32_bf16 v[144:147], a[96:99], v[112:115], v[144:147]
    v_mfma_f32_16x16x32_bf16 v[148:151], a[96:99], v[116:119], v[148:151]
    v_mfma_f32_16x16x32_bf16 v[152:155], a[100:103], v[112:115], v[152:155]
    v_mfma_f32_16x16x32_bf16 v[156:159], a[100:103], v[116:119], v[156:159]
    s_add_u32 s64, s25, 0x7000
    buffer_load_dwordx4 v[112:115], v1, s[4:7], s64 offen
    s_add_u32 s64, s25, 0x27000
    buffer_load_dwordx4 v[116:119], v1, s[4:7], s64 offen
    s_waitcnt vmcnt(30)
    v_mfma_f32_16x16x32_bf16 v[144:147], a[104:107], v[120:123], v[144:147]
    v_mfma_f32_16x16x32_bf16 v[148:151], a[104:107], v[124:127], v[148:151]
    v_mfma_f32_16x16x32_bf16 v[152:155], a[108:111], v[120:123], v[152:155]
    v_mfma_f32_16x16x32_bf16 v[156:159], a[108:111], v[124:127], v[156:159]
    s_add_u32 s64, s25, 0x7400
    buffer_load_dwordx4 v[120:123], v1, s[4:7], s64 offen
    s_add_u32 s64, s25, 0x27400
    buffer_load_dwordx4 v[124:127], v1, s[4:7], s64 offen
    s_waitcnt vmcnt(30)
    v_mfma_f32_16x16x32_bf16 v[144:147], a[112:115], v[128:131], v[144:147]
    v_mfma_f32_16x16x32_bf16 v[148:151], a[112:115], v[132:135], v[148:151]
    v_mfma_f32_16x16x32_bf16 v[152:155], a[116:119], v[128:131], v[152:155]
    v_mfma_f32_16x16x32_bf16 v[156:159], a[116:119], v[132:135], v[156:159]
    s_add_u32 s64, s25, 0x7800
    buffer_load_dwordx4 v[128:131], v1, s[4:7], s64 offen
    s_add_u32 s64, s25, 0x27800
    buffer_load_dwordx4 v[132:135], v1, s[4:7], s64 offen
    s_waitcnt vmcnt(30)
    v_mfma_f32_16x16x32_bf16 v[144:147], a[120:123], v[136:139], v[144:147]
    v_mfma_f32_16x16x32_bf16 v[148:151], a[120:123], v[140:143], v[148:151]
    v_mfma_f32_16x16x32_bf16 v[152:155], a[124:127], v[136:139], v[152:155]
    v_mfma_f32_16x16x32_bf16 v[156:159], a[124:127], v[140:143], v[156:159]
    s_add_u32 s64, s25, 0x7c00
    buffer_load_dwordx4 v[136:139], v1, s[4:7], s64 offen
    s_add_u32 s64, s25, 0x27c00
    buffer_load_dwordx4 v[140:143], v1, s[4:7], s64 offen
    s_waitcnt vmcnt(30)
    v_mfma_f32_16x16x32_bf16 v[144:147], a[128:131], v[16:19], v[144:147]
    v_mfma_f32_16x16x32_bf16 v[148:151], a[128:131], v[20:23], v[148:151]
    v_mfma_f32_16x16x32_bf16 v[152:155], a[132:135], v[16:19], v[152:155]
    v_mfma_f32_16x16x32_bf16 v[156:159], a[132:135], v[20:23], v[156:159]
    s_waitcnt vmcnt(28)
    v_mfma_f32_16x16x32_bf16 v[144:147], a[136:139], v[24:27], v[144:147]
    v_mfma_f32_16x16x32_bf16 v[148:151], a[136:139], v[28:31], v[148:151]
    v_mfma_f32_16x16x32_bf16 v[152:155], a[140:143], v[24:27], v[152:155]
    v_mfma_f32_16x16x32_bf16 v[156:159], a[140:143], v[28:31], v[156:159]
    s_waitcnt vmcnt(26)
    v_mfma_f32_16x16x32_bf16 v[144:147], a[144:147], v[32:35], v[144:147]
    v_mfma_f32_16x16x32_bf16 v[148:151], a[144:147], v[36:39], v[148:151]
    v_mfma_f32_16x16x32_bf16 v[152:155], a[148:151], v[32:35], v[152:155]
    v_mfma_f32_16x16x32_bf16 v[156:159], a[148:151], v[36:39], v[156:159]
    s_waitcnt vmcnt(24)
    v_mfma_f32_16x16x32_bf16 v[144:147], a[152:155], v[40:43], v[144:147]
    v_mfma_f32_16x16x32_bf16 v[148:151], a[152:155], v[44:47], v[148:151]
    v_mfma_f32_16x16x32_bf16 v[152:155], a[156:159], v[40:43], v[152:155]
    v_mfma_f32_16x16x32_bf16 v[156:159], a[156:159], v[44:47], v[156:159]
    s_waitcnt vmcnt(22)
    v_mfma_f32_16x16x32_bf16 v[144:147], a[160:163], v[48:51], v[144:147]
    v_mfma_f32_16x16x32_bf16 v[148:151], a[160:163], v[52:55], v[148:151]
    v_mfma_f32_16x16x32_bf16 v[152:155], a[164:167], v[48:51], v[152:155]
    v_mfma_f32_16x16x32_bf16 v[156:159], a[164:167], v[52:55], v[156:159]
    s_waitcnt vmcnt(20)
    v_mfma_f32_16x16x32_bf16 v[144:147], a[168:171], v[56:59], v[144:147]
    v_mfma_f32_16x16x32_bf16 v[148:151], a[168:171], v[60:63], v[148:151]
    v_mfma_f32_16x16x32_bf16 v[152:155], a[172:175], v[56:59], v[152:155]
    v_mfma_f32_16x16x32_bf16 v[156:159], a[172:175], v[60:63], v[156:159]
    s_waitcnt vmcnt(18)
    v_mfma_f32_16x16x32_bf16 v[144:147], a[176:179], v[64:67], v[144:147]
    v_mfma_f32_16x16x32_bf16 v[148:151], a[176:179], v[68:71], v[148:151]
    v_mfma_f32_16x16x32_bf16 v[152:155], a[180:183], v[64:67], v[152:155]
    v_mfma_f32_16x16x32_bf16 v[156:159], a[180:183], v[68:71], v[156:159]
    s_waitcnt vmcnt(16)
    v_mfma_f32_16x16x32_bf16 v[144:147], a[184:187], v[72:75], v[144:147]
    v_mfma_f32_16x16x32_bf16 v[148:151], a[184:187], v[76:79], v[148:151]
    v_mfma_f32_16x16x32_bf16 v[152:155], a[188:191], v[72:75], v[152:155]
    v_mfma_f32_16x16x32_bf16 v[156:159], a[188:191], v[76:79], v[156:159]
    s_waitcnt vmcnt(14)
    v_mfma_f32_16x16x32_bf16 v[144:147], a[192:195], v[80:83], v[144:147]
    v_mfma_f32_16x16x32_bf16 v[148:151], a[192:195], v[84:87], v[148:151]
    v_mfma_f32_16x16x32_bf16 v[152:155], a[196:199], v[80:83], v[152:155]
    v_mfma_f32_16x16x32_bf16 v[156:159], a[196:199], v[84:87], v[156:159]
    s_waitcnt vmcnt(12)
    v_mfma_f32_16x16x32_bf16 v[144:147], a[200:203], v[88:91], v[144:147]
    v_mfma_f32_16x16x32_bf16 v[148:151], a[200:203], v[92:95], v[148:151]
    v_mfma_f32_16x16x32_bf16 v[152:155], a[204:207], v[88:91], v[152:155]
    v_mfma_f32_16x16x32_bf16 v[156:159], a[204:207], v[92:95], v[156:159]
    s_waitcnt vmcnt(10)
    v_mfma_f32_16x16x32_bf16 v[144:147], a[208:211], v[96:99], v[144:147]
    v_mfma_f32_16x16x32_bf16 v[148:151], a[208:211], v[100:103], v[148:151]
    v_mfma_f32_16x16x32_bf16 v[152:155], a[212:215], v[96:99], v[152:155]
    v_mfma_f32_16x16x32_bf16 v[156:159], a[212:215], v[100:103], v[156:159]
    s_waitcnt vmcnt(8)
    v_mfma_f32_16x16x32_bf16 v[144:147], a[216:219], v[104:107], v[144:147]
    v_mfma_f32_16x16x32_bf16 v[148:151], a[216:219], v[108:111], v[148:151]
    v_mfma_f32_16x16x32_bf16 v[152:155], a[220:223], v[104:107], v[152:155]
    v_mfma_f32_16x16x32_bf16 v[156:159], a[220:223], v[108:111], v[156:159]
    s_waitcnt vmcnt(6)
    v_mfma_f32_16x16x32_bf16 v[144:147], a[224:227], v[112:115], v[144:147]
    v_mfma_f32_16x16x32_bf16 v[148:151], a[224:227], v[116:119], v[148:151]
    v_mfma_f32_16x16x32_bf16 v[152:155], a[228:231], v[112:115], v[152:155]
    v_mfma_f32_16x16x32_bf16 v[156:159], a[228:231], v[116:119], v[156:159]
    s_waitcnt vmcnt(4)
    v_mfma_f32_16x16x32_bf16 v[144:147], a[232:235], v[120:123], v[144:147]
    v_mfma_f32_16x16x32_bf16 v[148:151], a[232:235], v[124:127], v[148:151]
    v_mfma_f32_16x16x32_bf16 v[152:155], a[236:239], v[120:123], v[152:155]
    v_mfma_f32_16x16x32_bf16 v[156:159], a[236:239], v[124:127], v[156:159]
    s_waitcnt vmcnt(2)
    v_mfma_f32_16x16x32_bf16 v[144:147], a[240:243], v[128:131], v[144:147]
    v_mfma_f32_16x16x32_bf16 v[148:151], a[240:243], v[132:135], v[148:151]
    v_mfma_f32_16x16x32_bf16 v[152:155], a[244:247], v[128:131], v[152:155]
    v_mfma_f32_16x16x32_bf16 v[156:159], a[244:247], v[132:135], v[156:159]
    s_waitcnt vmcnt(0)
    v_mfma_f32_16x16x32_bf16 v[144:147], a[248:251], v[136:139], v[144:147]
    v_mfma_f32_16x16x32_bf16 v[148:151], a[248:251], v[140:143], v[148:151]
    v_mfma_f32_16x16x32_bf16 v[152:155], a[252:255], v[136:139], v[152:155]
    v_mfma_f32_16x16x32_bf16 v[156:159], a[252:255], v[140:143], v[156:159]
    s_lshl_b32 s64, s14, 12
    v_add_u32 v7, s64, v1
    s_barrier
    s_nop 3
    ds_write_b128 v7, v[144:147] offset:0
    ds_write_b128 v7, v[148:151] offset:1024
    ds_write_b128 v7, v[152:155] offset:2048
    ds_write_b128 v7, v[156:159] offset:3072
    v_mov_b32 v13, 16384
    s_cmp_lg_u32 s14, 0
    s_cbranch_scc1 OW0_156
    ds_write_b32 v13, v12
OW0_156:
    s_waitcnt lgkmcnt(0)
    s_barrier
    ds_read_b32 v12, v13
    s_waitcnt lgkmcnt(0)
    v_readfirstlane_b32 s64, v12
    s_cmp_lt_u32 s64, 40
    s_cselect_b64 s[82:83], s[82:83], 0
    s_lshl_b32 s64, s14, 10
    v_add_u32 v7, s64, v1
    ds_read_b128 v[16:19], v7 offset:0
    ds_read_b128 v[20:23], v7 offset:4096
    ds_read_b128 v[24:27], v7 offset:8192
    ds_read_b128 v[28:31], v7 offset:12288
    s_waitcnt lgkmcnt(0)
    v_add_f32 v16, v16, v20
    v_add_f32 v24, v24, v28
    v_add_f32 v16, v16, v24
    v_add_f32 v17, v17, v21
    v_add_f32 v25, v25, v29
    v_add_f32 v17, v17, v25
    v_add_f32 v18, v18, v22
    v_add_f32 v26, v26, v30
    v_add_f32 v18, v18, v26
    v_add_f32 v19, v19, v23
    v_add_f32 v27, v27, v31
    v_add_f32 v19, v19, v27
    v_cvt_pk_bf16_f32 v16, v16, v16
    v_lshlrev_b32 v16, 16, v16
    v_cvt_pk_bf16_f32 v17, v17, v17
    v_lshlrev_b32 v17, 16, v17
    v_cvt_pk_bf16_f32 v18, v18, v18
    v_lshlrev_b32 v18, 16, v18
    v_cvt_pk_bf16_f32 v19, v19, v19
    v_lshlrev_b32 v19, 16, v19
    v_lshlrev_b32 v20, 16, v162
    v_and_b32 v21, 0xffff0000, v162
    v_lshlrev_b32 v24, 16, v160
    v_and_b32 v25, 0xffff0000, v160
    v_lshlrev_b32 v22, 16, v163
    v_and_b32 v23, 0xffff0000, v163
    v_lshlrev_b32 v26, 16, v161
    v_and_b32 v27, 0xffff0000, v161
    s_lshl_b32 s64, s24, 5
    v_add_u32 v8, s64, v9
    v_mov_b32 v10, -1
    v_cmp_eq_u32 vcc, s72, v8
    s_nop 1
    v_cndmask_b32 v10, v10, 0, vcc
    v_cmp_eq_u32 vcc, s73, v8
    s_nop 1
    v_cndmask_b32 v10, v10, 1, vcc
    v_cmp_eq_u32 vcc, s74, v8
    s_nop 1
    v_cndmask_b32 v10, v10, 2, vcc
    v_cmp_eq_u32 vcc, s75, v8
    s_nop 1
    v_cndmask_b32 v10, v10, 3, vcc
    v_cmp_eq_u32 vcc, s76, v8
    s_nop 1
    v_cndmask_b32 v10, v10, 4, vcc
    v_cmp_eq_u32 vcc, s77, v8
    s_nop 1
    v_cndmask_b32 v10, v10, 5, vcc
    v_cmp_eq_u32 vcc, s78, v8
    s_nop 1
    v_cndmask_b32 v10, v10, 6, vcc
    v_cmp_eq_u32 vcc, s79, v8
    s_nop 1
    v_cndmask_b32 v10, v10, 7, vcc
    v_cmp_le_i32 vcc, 0, v10
    s_and_saveexec_b64 s[68:69], vcc
    s_cbranch_execz NOUPD_158
    v_mul_u32_u24 v10, 2560, v10
    v_lshrrev_b32 v11, 4, v0
    v_lshl_add_u32 v10, v11, 4, v10
    s_lshl_b32 s64, s86, 6
    s_lshl_b32 s65, s13, 7
    s_add_u32 s64, s64, s65
    s_add_u32 s64, s64, 0x5410000
    buffer_load_dwordx4 v[164:167], v10, s[4:7], s64 offen sc1
    s_waitcnt vmcnt(0)
    v_add_f32 v20, v20, v164
    v_cvt_pk_bf16_f32 v20, v20, v20
    v_lshlrev_b32 v20, 16, v20
    v_add_f32 v21, v21, v165
    v_cvt_pk_bf16_f32 v21, v21, v21
    v_lshlrev_b32 v21, 16, v21
    v_add_f32 v22, v22, v166
    v_cvt_pk_bf16_f32 v22, v22, v22
    v_lshlrev_b32 v22, 16, v22
    v_add_f32 v23, v23, v167
    v_cvt_pk_bf16_f32 v23, v23, v23
    v_lshlrev_b32 v23, 16, v23
NOUPD_158:
    s_mov_b64 exec, -1
    v_mul_f32 v28, 0xbfb8aa3b, v20
    v_exp_f32 v28, v28
    s_nop 0
    v_add_f32 v28, 1.0, v28
    v_rcp_f32 v28, v28
    s_nop 0
    v_mul_f32 v28, v28, v20
    v_cvt_pk_bf16_f32 v28, v28, v28
    v_lshlrev_b32 v28, 16, v28
    v_mul_f32 v28, v28, v16
    v_cvt_pk_bf16_f32 v28, v28, v28
    v_lshlrev_b32 v28, 16, v28
    v_add_f32 v28, v28, v24
    v_mul_f32 v29, 0xbfb8aa3b, v21
    v_exp_f32 v29, v29
    s_nop 0
    v_add_f32 v29, 1.0, v29
    v_rcp_f32 v29, v29
    s_nop 0
    v_mul_f32 v29, v29, v21
    v_cvt_pk_bf16_f32 v29, v29, v29
    v_lshlrev_b32 v29, 16, v29
    v_mul_f32 v29, v29, v17
    v_cvt_pk_bf16_f32 v29, v29, v29
    v_lshlrev_b32 v29, 16, v29
    v_add_f32 v29, v29, v25
    v_mul_f32 v30, 0xbfb8aa3b, v22
    v_exp_f32 v30, v30
    s_nop 0
    v_add_f32 v30, 1.0, v30
    v_rcp_f32 v30, v30
    s_nop 0
    v_mul_f32 v30, v30, v22
    v_cvt_pk_bf16_f32 v30, v30, v30
    v_lshlrev_b32 v30, 16, v30
    v_mul_f32 v30, v30, v18
    v_cvt_pk_bf16_f32 v30, v30, v30
    v_lshlrev_b32 v30, 16, v30
    v_add_f32 v30, v30, v26
    v_mul_f32 v31, 0xbfb8aa3b, v23
    v_exp_f32 v31, v31
    s_nop 0
    v_add_f32 v31, 1.0, v31
    v_rcp_f32 v31, v31
    s_nop 0
    v_mul_f32 v31, v31, v23
    v_cvt_pk_bf16_f32 v31, v31, v31
    v_lshlrev_b32 v31, 16, v31
    v_mul_f32 v31, v31, v19
    v_cvt_pk_bf16_f32 v31, v31, v31
    v_lshlrev_b32 v31, 16, v31
    v_add_f32 v31, v31, v27
    v_cvt_pk_bf16_f32 v164, v28, v29
    v_cvt_pk_bf16_f32 v165, v30, v31
    buffer_store_dwordx2 v[164:165], v5, s[52:55], s67 offen
OTD_157:
    s_branch OU_LOOP
OU_END:
    s_cmp_lg_u32 s12, 2
    s_cbranch_scc1 OU_X
    v_mov_b32 v8, 0
    s_mov_b32 s64, 0x298100
OUW_159:
    buffer_load_dword v7, v8, s[4:7], s64 offen sc1
    s_add_u32 s29, s29, 1
    s_waitcnt vmcnt(0)
    v_cmp_gt_u32 vcc, 40, v7
    s_cbranch_vccz OUWD_160
    s_cmp_gt_u32 s29, 262144
    s_cbranch_scc1 OUWD_160
    s_sleep 8
    s_branch OUW_159
OUWD_160:
    s_mov_b32 s24, 62
    s_mov_b32 s87, 0
    s_and_b32 s86, s14, 1
    s_lshl_b32 s64, s87, 4
    v_and_b32 v6, 15, v0
    v_add_u32 v6, s64, v6
    v_mov_b32 v9, v6
    v_mul_u32_u24 v5, 1280, v6
    v_lshrrev_b32 v6, 4, v0
    v_lshl_add_u32 v5, v6, 3, v5
    s_and_b32 s64, s14, 1
    s_lshl_b32 s64, s64, 5
    s_lshl_b32 s65, s13, 6
    s_add_u32 s64, s64, s65
    v_add_u32 v5, s64, v5
    v_lshlrev_b32 v6, 2, v0
    s_mul_i32 s67, s24, 40960
    buffer_load_dwordx2 v[160:161], v5, s[48:51], s67 offen
    s_add_u32 s64, s67, 0x0
    buffer_load_dwordx2 v[162:163], v5, s[4:7], s64 offen
    s_lshl_b32 s64, s24, 7
    s_add_u32 s64, s64, 0x296000
    s_mov_b64 exec, s[36:37]
OUH_F_161:
    buffer_load_dword v7, v6, s[4:7], s64 offen sc1
    s_add_u32 s29, s29, 1
    s_waitcnt vmcnt(0)
    v_cmp_eq_u32 vcc, 0, v7
    s_cbranch_vccz OUH_FD_162
    s_cmp_gt_u32 s29, 262144
    s_cbranch_scc1 OUH_FD_162
    s_sleep 1
    s_branch OUH_F_161
OUH_FD_162:
    s_mov_b64 exec, -1
    s_lshl_b32 s25, s24, 18
    s_lshl_b32 s64, s14, 15
    s_add_u32 s25, s25, s64
    s_add_u32 s25, s25, 0x4400000
    s_lshl_b32 s64, s87, 17
    s_add_u32 s25, s25, s64
    s_add_u32 s64, s25, 0x0
    buffer_load_dwordx4 v[16:19], v1, s[4:7], s64 offen
    s_add_u32 s64, s25, 0x400
    buffer_load_dwordx4 v[20:23], v1, s[4:7], s64 offen
    s_add_u32 s64, s25, 0x800
    buffer_load_dwordx4 v[24:27], v1, s[4:7], s64 offen
    s_add_u32 s64, s25, 0xc00
    buffer_load_dwordx4 v[28:31], v1, s[4:7], s64 offen
    s_add_u32 s64, s25, 0x1000
    buffer_load_dwordx4 v[32:35], v1, s[4:7], s64 offen
    s_add_u32 s64, s25, 0x1400
    buffer_load_dwordx4 v[36:39], v1, s[4:7], s64 offen
    s_add_u32 s64, s25, 0x1800
    buffer_load_dwordx4 v[40:43], v1, s[4:7], s64 offen
    s_add_u32 s64, s25, 0x1c00
    buffer_load_dwordx4 v[44:47], v1, s[4:7], s64 offen
    s_add_u32 s64, s25, 0x2000
    buffer_load_dwordx4 v[48:51], v1, s[4:7], s64 offen
    s_add_u32 s64, s25, 0x2400
    buffer_load_dwordx4 v[52:55], v1, s[4:7], s64 offen
    s_add_u32 s64, s25, 0x2800
    buffer_load_dwordx4 v[56:59], v1, s[4:7], s64 offen
    s_add_u32 s64, s25, 0x2c00
    buffer_load_dwordx4 v[60:63], v1, s[4:7], s64 offen
    s_add_u32 s64, s25, 0x3000
    buffer_load_dwordx4 v[64:67], v1, s[4:7], s64 offen
    s_add_u32 s64, s25, 0x3400
    buffer_load_dwordx4 v[68:71], v1, s[4:7], s64 offen
    s_add_u32 s64, s25, 0x3800
    buffer_load_dwordx4 v[72:75], v1, s[4:7], s64 offen
    s_add_u32 s64, s25, 0x3c00
    buffer_load_dwordx4 v[76:79], v1, s[4:7], s64 offen
    s_add_u32 s64, s25, 0x4000
    buffer_load_dwordx4 v[80:83], v1, s[4:7], s64 offen
    s_add_u32 s64, s25, 0x4400
    buffer_load_dwordx4 v[84:87], v1, s[4:7], s64 offen
    s_add_u32 s64, s25, 0x4800
    buffer_load_dwordx4 v[88:91], v1, s[4:7], s64 offen
    s_add_u32 s64, s25, 0x4c00
    buffer_load_dwordx4 v[92:95], v1, s[4:7], s64 offen
    s_add_u32 s64, s25, 0x5000
    buffer_load_dwordx4 v[96:99], v1, s[4:7], s64 offen
    s_add_u32 s64, s25, 0x5400
    buffer_load_dwordx4 v[100:103], v1, s[4:7], s64 offen
    s_add_u32 s64, s25, 0x5800
    buffer_load_dwordx4 v[104:107], v1, s[4:7], s64 offen
    s_add_u32 s64, s25, 0x5c00
    buffer_load_dwordx4 v[108:111], v1, s[4:7], s64 offen
    s_add_u32 s64, s25, 0x6000
    buffer_load_dwordx4 v[112:115], v1, s[4:7], s64 offen
    s_add_u32 s64, s25, 0x6400
    buffer_load_dwordx4 v[116:119], v1, s[4:7], s64 offen
    s_add_u32 s64, s25, 0x6800
    buffer_load_dwordx4 v[120:123], v1, s[4:7], s64 offen
    s_add_u32 s64, s25, 0x6c00
    buffer_load_dwordx4 v[124:127], v1, s[4:7], s64 offen
    s_add_u32 s64, s25, 0x7000
    buffer_load_dwordx4 v[128:131], v1, s[4:7], s64 offen
    s_add_u32 s64, s25, 0x7400
    buffer_load_dwordx4 v[132:135], v1, s[4:7], s64 offen
    s_add_u32 s64, s25, 0x7800
    buffer_load_dwordx4 v[136:139], v1, s[4:7], s64 offen
    s_add_u32 s64, s25, 0x7c00
    buffer_load_dwordx4 v[140:143], v1, s[4:7], s64 offen
    s_waitcnt vmcnt(31)
    v_mfma_f32_16x16x32_bf16 v[144:147], a[0:3], v[16:19], 0
    v_mfma_f32_16x16x32_bf16 v[148:151], a[4:7], v[16:19], 0
    s_waitcnt vmcnt(30)
    v_mfma_f32_16x16x32_bf16 v[144:147], a[8:11], v[20:23], v[144:147]
    v_mfma_f32_16x16x32_bf16 v[148:151], a[12:15], v[20:23], v[148:151]
    s_waitcnt vmcnt(29)
    v_mfma_f32_16x16x32_bf16 v[144:147], a[16:19], v[24:27], v[144:147]
    v_mfma_f32_16x16x32_bf16 v[148:151], a[20:23], v[24:27], v[148:151]
    s_waitcnt vmcnt(28)
    v_mfma_f32_16x16x32_bf16 v[144:147], a[24:27], v[28:31], v[144:147]
    v_mfma_f32_16x16x32_bf16 v[148:151], a[28:31], v[28:31], v[148:151]
    s_waitcnt vmcnt(27)
    v_mfma_f32_16x16x32_bf16 v[144:147], a[32:35], v[32:35], v[144:147]
    v_mfma_f32_16x16x32_bf16 v[148:151], a[36:39], v[32:35], v[148:151]
    s_waitcnt vmcnt(26)
    v_mfma_f32_16x16x32_bf16 v[144:147], a[40:43], v[36:39], v[144:147]
    v_mfma_f32_16x16x32_bf16 v[148:151], a[44:47], v[36:39], v[148:151]
    s_waitcnt vmcnt(25)
    v_mfma_f32_16x16x32_bf16 v[144:147], a[48:51], v[40:43], v[144:147]
    v_mfma_f32_16x16x32_bf16 v[148:151], a[52:55], v[40:43], v[148:151]
    s_waitcnt vmcnt(24)
    v_mfma_f32_16x16x32_bf16 v[144:147], a[56:59], v[44:47], v[144:147]
    v_mfma_f32_16x16x32_bf16 v[148:151], a[60:63], v[44:47], v[148:151]
    s_waitcnt vmcnt(23)
    v_mfma_f32_16x16x32_bf16 v[144:147], a[64:67], v[48:51], v[144:147]
    v_mfma_f32_16x16x32_bf16 v[148:151], a[68:71], v[48:51], v[148:151]
    s_waitcnt vmcnt(22)
    v_mfma_f32_16x16x32_bf16 v[144:147], a[72:75], v[52:55], v[144:147]
    v_mfma_f32_16x16x32_bf16 v[148:151], a[76:79], v[52:55], v[148:151]
    s_waitcnt vmcnt(21)
    v_mfma_f32_16x16x32_bf16 v[144:147], a[80:83], v[56:59], v[144:147]
    v_mfma_f32_16x16x32_bf16 v[148:151], a[84:87], v[56:59], v[148:151]
    s_waitcnt vmcnt(20)
    v_mfma_f32_16x16x32_bf16 v[144:147], a[88:91], v[60:63], v[144:147]
    v_mfma_f32_16x16x32_bf16 v[148:151], a[92:95], v[60:63], v[148:151]
    s_waitcnt vmcnt(19)
    v_mfma_f32_16x16x32_bf16 v[144:147], a[96:99], v[64:67], v[144:147]
    v_mfma_f32_16x16x32_bf16 v[148:151], a[100:103], v[64:67], v[148:151]
    s_waitcnt vmcnt(18)
    v_mfma_f32_16x16x32_bf16 v[144:147], a[104:107], v[68:71], v[144:147]
    v_mfma_f32_16x16x32_bf16 v[148:151], a[108:111], v[68:71], v[148:151]
    s_waitcnt vmcnt(17)
    v_mfma_f32_16x16x32_bf16 v[144:147], a[112:115], v[72:75], v[144:147]
    v_mfma_f32_16x16x32_bf16 v[148:151], a[116:119], v[72:75], v[148:151]
    s_waitcnt vmcnt(16)
    v_mfma_f32_16x16x32_bf16 v[144:147], a[120:123], v[76:79], v[144:147]
    v_mfma_f32_16x16x32_bf16 v[148:151], a[124:127], v[76:79], v[148:151]
    s_waitcnt vmcnt(15)
    v_mfma_f32_16x16x32_bf16 v[144:147], a[128:131], v[80:83], v[144:147]
    v_mfma_f32_16x16x32_bf16 v[148:151], a[132:135], v[80:83], v[148:151]
    s_waitcnt vmcnt(14)
    v_mfma_f32_16x16x32_bf16 v[144:147], a[136:139], v[84:87], v[144:147]
    v_mfma_f32_16x16x32_bf16 v[148:151], a[140:143], v[84:87], v[148:151]
    s_waitcnt vmcnt(13)
    v_mfma_f32_16x16x32_bf16 v[144:147], a[144:147], v[88:91], v[144:147]
    v_mfma_f32_16x16x32_bf16 v[148:151], a[148:151], v[88:91], v[148:151]
    s_waitcnt vmcnt(12)
    v_mfma_f32_16x16x32_bf16 v[144:147], a[152:155], v[92:95], v[144:147]
    v_mfma_f32_16x16x32_bf16 v[148:151], a[156:159], v[92:95], v[148:151]
    s_waitcnt vmcnt(11)
    v_mfma_f32_16x16x32_bf16 v[144:147], a[160:163], v[96:99], v[144:147]
    v_mfma_f32_16x16x32_bf16 v[148:151], a[164:167], v[96:99], v[148:151]
    s_waitcnt vmcnt(10)
    v_mfma_f32_16x16x32_bf16 v[144:147], a[168:171], v[100:103], v[144:147]
    v_mfma_f32_16x16x32_bf16 v[148:151], a[172:175], v[100:103], v[148:151]
    s_waitcnt vmcnt(9)
    v_mfma_f32_16x16x32_bf16 v[144:147], a[176:179], v[104:107], v[144:147]
    v_mfma_f32_16x16x32_bf16 v[148:151], a[180:183], v[104:107], v[148:151]
    s_waitcnt vmcnt(8)
    v_mfma_f32_16x16x32_bf16 v[144:147], a[184:187], v[108:111], v[144:147]
    v_mfma_f32_16x16x32_bf16 v[148:151], a[188:191], v[108:111], v[148:151]
    s_waitcnt vmcnt(7)
    v_mfma_f32_16x16x32_bf16 v[144:147], a[192:195], v[112:115], v[144:147]
    v_mfma_f32_16x16x32_bf16 v[148:151], a[196:199], v[112:115], v[148:151]
    s_waitcnt vmcnt(6)
    v_mfma_f32_16x16x32_bf16 v[144:147], a[200:203], v[116:119], v[144:147]
    v_mfma_f32_16x16x32_bf16 v[148:151], a[204:207], v[116:119], v[148:151]
    s_waitcnt vmcnt(5)
    v_mfma_f32_16x16x32_bf16 v[144:147], a[208:211], v[120:123], v[144:147]
    v_mfma_f32_16x16x32_bf16 v[148:151], a[212:215], v[120:123], v[148:151]
    s_waitcnt vmcnt(4)
    v_mfma_f32_16x16x32_bf16 v[144:147], a[216:219], v[124:127], v[144:147]
    v_mfma_f32_16x16x32_bf16 v[148:151], a[220:223], v[124:127], v[148:151]
    s_waitcnt vmcnt(3)
    v_mfma_f32_16x16x32_bf16 v[144:147], a[224:227], v[128:131], v[144:147]
    v_mfma_f32_16x16x32_bf16 v[148:151], a[228:231], v[128:131], v[148:151]
    s_waitcnt vmcnt(2)
    v_mfma_f32_16x16x32_bf16 v[144:147], a[232:235], v[132:135], v[144:147]
    v_mfma_f32_16x16x32_bf16 v[148:151], a[236:239], v[132:135], v[148:151]
    s_waitcnt vmcnt(1)
    v_mfma_f32_16x16x32_bf16 v[144:147], a[240:243], v[136:139], v[144:147]
    v_mfma_f32_16x16x32_bf16 v[148:151], a[244:247], v[136:139], v[148:151]
    s_waitcnt vmcnt(0)
    v_mfma_f32_16x16x32_bf16 v[144:147], a[248:251], v[140:143], v[144:147]
    v_mfma_f32_16x16x32_bf16 v[148:151], a[252:255], v[140:143], v[148:151]
    s_lshl_b32 s64, s14, 12
    v_add_u32 v7, s64, v1
    s_barrier
    s_nop 3
    ds_write_b128 v7, v[144:147] offset:0
    ds_write_b128 v7, v[148:151] offset:1024
    s_waitcnt lgkmcnt(0)
    s_barrier
    s_cmp_ge_u32 s14, 2
    s_cbranch_scc1 OTD_163
    s_lshl_b32 s64, s14, 10
    v_add_u32 v7, s64, v1
    ds_read_b128 v[16:19], v7 offset:0
    ds_read_b128 v[20:23], v7 offset:4096
    ds_read_b128 v[24:27], v7 offset:8192
    ds_read_b128 v[28:31], v7 offset:12288
    s_waitcnt lgkmcnt(0)
    v_add_f32 v16, v16, v20
    v_add_f32 v24, v24, v28
    v_add_f32 v16, v16, v24
    v_add_f32 v17, v17, v21
    v_add_f32 v25, v25, v29
    v_add_f32 v17, v17, v25
    v_add_f32 v18, v18, v22
    v_add_f32 v26, v26, v30
    v_add_f32 v18, v18, v26
    v_add_f32 v19, v19, v23
    v_add_f32 v27, v27, v31
    v_add_f32 v19, v19, v27
    v_cvt_pk_bf16_f32 v16, v16, v16
    v_lshlrev_b32 v16, 16, v16
    v_cvt_pk_bf16_f32 v17, v17, v17
    v_lshlrev_b32 v17, 16, v17
    v_cvt_pk_bf16_f32 v18, v18, v18
    v_lshlrev_b32 v18, 16, v18
    v_cvt_pk_bf16_f32 v19, v19, v19
    v_lshlrev_b32 v19, 16, v19
    v_lshlrev_b32 v20, 16, v162
    v_and_b32 v21, 0xffff0000, v162
    v_lshlrev_b32 v24, 16, v160
    v_and_b32 v25, 0xffff0000, v160
    v_lshlrev_b32 v22, 16, v163
    v_and_b32 v23, 0xffff0000, v163
    v_lshlrev_b32 v26, 16, v161
    v_and_b32 v27, 0xffff0000, v161
    s_lshl_b32 s64, s24, 5
    v_add_u32 v8, s64, v9
    v_mov_b32 v10, -1
    v_cmp_eq_u32 vcc, s72, v8
    s_nop 1
    v_cndmask_b32 v10, v10, 0, vcc
    v_cmp_eq_u32 vcc, s73, v8
    s_nop 1
    v_cndmask_b32 v10, v10, 1, vcc
    v_cmp_eq_u32 vcc, s74, v8
    s_nop 1
    v_cndmask_b32 v10, v10, 2, vcc
    v_cmp_eq_u32 vcc, s75, v8
    s_nop 1
    v_cndmask_b32 v10, v10, 3, vcc
    v_cmp_eq_u32 vcc, s76, v8
    s_nop 1
    v_cndmask_b32 v10, v10, 4, vcc
    v_cmp_eq_u32 vcc, s77, v8
    s_nop 1
    v_cndmask_b32 v10, v10, 5, vcc
    v_cmp_eq_u32 vcc, s78, v8
    s_nop 1
    v_cndmask_b32 v10, v10, 6, vcc
    v_cmp_eq_u32 vcc, s79, v8
    s_nop 1
    v_cndmask_b32 v10, v10, 7, vcc
    v_cmp_le_i32 vcc, 0, v10
    s_and_saveexec_b64 s[68:69], vcc
    s_cbranch_execz NOUPD_164
    v_mul_u32_u24 v10, 2560, v10
    v_lshrrev_b32 v11, 4, v0
    v_lshl_add_u32 v10, v11, 4, v10
    s_lshl_b32 s64, s86, 6
    s_lshl_b32 s65, s13, 7
    s_add_u32 s64, s64, s65
    s_add_u32 s64, s64, 0x5410000
    buffer_load_dwordx4 v[164:167], v10, s[4:7], s64 offen sc1
    s_waitcnt vmcnt(0)
    v_add_f32 v20, v20, v164
    v_cvt_pk_bf16_f32 v20, v20, v20
    v_lshlrev_b32 v20, 16, v20
    v_add_f32 v21, v21, v165
    v_cvt_pk_bf16_f32 v21, v21, v21
    v_lshlrev_b32 v21, 16, v21
    v_add_f32 v22, v22, v166
    v_cvt_pk_bf16_f32 v22, v22, v22
    v_lshlrev_b32 v22, 16, v22
    v_add_f32 v23, v23, v167
    v_cvt_pk_bf16_f32 v23, v23, v23
    v_lshlrev_b32 v23, 16, v23
NOUPD_164:
    s_mov_b64 exec, -1
    v_mul_f32 v28, 0xbfb8aa3b, v20
    v_exp_f32 v28, v28
    s_nop 0
    v_add_f32 v28, 1.0, v28
    v_rcp_f32 v28, v28
    s_nop 0
    v_mul_f32 v28, v28, v20
    v_cvt_pk_bf16_f32 v28, v28, v28
    v_lshlrev_b32 v28, 16, v28
    v_mul_f32 v28, v28, v16
    v_cvt_pk_bf16_f32 v28, v28, v28
    v_lshlrev_b32 v28, 16, v28
    v_add_f32 v28, v28, v24
    v_mul_f32 v29, 0xbfb8aa3b, v21
    v_exp_f32 v29, v29
    s_nop 0
    v_add_f32 v29, 1.0, v29
    v_rcp_f32 v29, v29
    s_nop 0
    v_mul_f32 v29, v29, v21
    v_cvt_pk_bf16_f32 v29, v29, v29
    v_lshlrev_b32 v29, 16, v29
    v_mul_f32 v29, v29, v17
    v_cvt_pk_bf16_f32 v29, v29, v29
    v_lshlrev_b32 v29, 16, v29
    v_add_f32 v29, v29, v25
    v_mul_f32 v30, 0xbfb8aa3b, v22
    v_exp_f32 v30, v30
    s_nop 0
    v_add_f32 v30, 1.0, v30
    v_rcp_f32 v30, v30
    s_nop 0
    v_mul_f32 v30, v30, v22
    v_cvt_pk_bf16_f32 v30, v30, v30
    v_lshlrev_b32 v30, 16, v30
    v_mul_f32 v30, v30, v18
    v_cvt_pk_bf16_f32 v30, v30, v30
    v_lshlrev_b32 v30, 16, v30
    v_add_f32 v30, v30, v26
    v_mul_f32 v31, 0xbfb8aa3b, v23
    v_exp_f32 v31, v31
    s_nop 0
    v_add_f32 v31, 1.0, v31
    v_rcp_f32 v31, v31
    s_nop 0
    v_mul_f32 v31, v31, v23
    v_cvt_pk_bf16_f32 v31, v31, v31
    v_lshlrev_b32 v31, 16, v31
    v_mul_f32 v31, v31, v19
    v_cvt_pk_bf16_f32 v31, v31, v31
    v_lshlrev_b32 v31, 16, v31
    v_add_f32 v31, v31, v27
    v_cvt_pk_bf16_f32 v164, v28, v29
    v_cvt_pk_bf16_f32 v165, v30, v31
    buffer_store_dwordx2 v[164:165], v5, s[52:55], s67 offen
OTD_163:
OU_X:
    s_branch M_EXIT
H_EXTRA:
    s_mul_hi_u32 s12, s88, 0xccccccd
    s_mul_i32 s65, s12, 20
    s_sub_u32 s13, s88, s65
    s_add_u32 s12, s12, 3
    s_load_dwordx2 s[48:49], s[0:1], 0
    s_mov_b32 s50, 0x280000
    s_mov_b32 s51, 0x00020000
    s_load_dwordx2 s[52:53], s[0:1], 96
    s_mov_b32 s54, 0x280000
    s_mov_b32 s55, 0x00020000
    s_mov_b32 s36, -1
    s_mov_b32 s37, 0
    s_waitcnt lgkmcnt(0)
    v_mbcnt_lo_u32_b32 v0, -1, 0
    v_mbcnt_hi_u32_b32 v0, -1, v0
    s_mov_b32 s29, 0
    v_lshlrev_b32 v1, 4, v0
    v_lshlrev_b32 v6, 2, v0
    v_mov_b32 v8, 0
    s_mov_b32 s64, 0x298100
OXW_165:
    buffer_load_dword v7, v8, s[4:7], s64 offen sc1
    s_add_u32 s29, s29, 1
    s_waitcnt vmcnt(0)
    v_cmp_gt_u32 vcc, 40, v7
    s_cbranch_vccz OXWD_166
    s_cmp_gt_u32 s29, 262144
    s_cbranch_scc1 OXWD_166
    s_sleep 8
    s_branch OXW_165
OXWD_166:
    v_lshlrev_b32 v6, 2, v0
    s_mov_b32 s64, 0x5400000
    buffer_load_dword v7, v6, s[4:7], s64 offen sc1
    s_waitcnt vmcnt(0)
    v_readlane_b32 s72, v7, 0
    v_readlane_b32 s73, v7, 1
    v_readlane_b32 s74, v7, 2
    v_readlane_b32 s75, v7, 3
    v_readlane_b32 s76, v7, 4
    v_readlane_b32 s77, v7, 5
    v_readlane_b32 s78, v7, 6
    v_readlane_b32 s79, v7, 7
    s_cmp_eq_u32 s12, 3
    s_cselect_b32 s24, 62, 63
    s_cmp_eq_u32 s12, 4
    s_cselect_b32 s87, 0, 1
    s_and_b32 s86, s14, 1
    s_lshl_b32 s64, s87, 4
    v_and_b32 v6, 15, v0
    v_add_u32 v6, s64, v6
    v_mov_b32 v9, v6
    v_mul_u32_u24 v5, 1280, v6
    v_lshrrev_b32 v6, 4, v0
    v_lshl_add_u32 v5, v6, 3, v5
    s_and_b32 s64, s14, 1
    s_lshl_b32 s64, s64, 5
    s_lshl_b32 s65, s13, 6
    s_add_u32 s64, s64, s65
    v_add_u32 v5, s64, v5
    v_lshlrev_b32 v6, 2, v0
    s_mul_i32 s67, s24, 40960
    buffer_load_dwordx2 v[160:161], v5, s[48:51], s67 offen
    s_add_u32 s64, s67, 0x0
    buffer_load_dwordx2 v[162:163], v5, s[4:7], s64 offen
    s_lshl_b32 s64, s24, 7
    s_add_u32 s64, s64, 0x296000
    s_mov_b64 exec, s[36:37]
OX_F_167:
    buffer_load_dword v7, v6, s[4:7], s64 offen sc1
    s_add_u32 s29, s29, 1
    s_waitcnt vmcnt(0)
    v_cmp_eq_u32 vcc, 0, v7
    s_cbranch_vccz OX_FD_168
    s_cmp_gt_u32 s29, 262144
    s_cbranch_scc1 OX_FD_168
    s_sleep 1
    s_branch OX_F_167
OX_FD_168:
    s_mov_b64 exec, -1
    s_lshl_b32 s25, s24, 18
    s_lshl_b32 s64, s14, 15
    s_add_u32 s25, s25, s64
    s_add_u32 s25, s25, 0x4400000
    s_lshl_b32 s64, s87, 17
    s_add_u32 s25, s25, s64
    s_add_u32 s64, s25, 0x0
    buffer_load_dwordx4 v[16:19], v1, s[4:7], s64 offen
    s_add_u32 s64, s25, 0x400
    buffer_load_dwordx4 v[20:23], v1, s[4:7], s64 offen
    s_add_u32 s64, s25, 0x800
    buffer_load_dwordx4 v[24:27], v1, s[4:7], s64 offen
    s_add_u32 s64, s25, 0xc00
    buffer_load_dwordx4 v[28:31], v1, s[4:7], s64 offen
    s_add_u32 s64, s25, 0x1000
    buffer_load_dwordx4 v[32:35], v1, s[4:7], s64 offen
    s_add_u32 s64, s25, 0x1400
    buffer_load_dwordx4 v[36:39], v1, s[4:7], s64 offen
    s_add_u32 s64, s25, 0x1800
    buffer_load_dwordx4 v[40:43], v1, s[4:7], s64 offen
    s_add_u32 s64, s25, 0x1c00
    buffer_load_dwordx4 v[44:47], v1, s[4:7], s64 offen
    s_add_u32 s64, s25, 0x2000
    buffer_load_dwordx4 v[48:51], v1, s[4:7], s64 offen
    s_add_u32 s64, s25, 0x2400
    buffer_load_dwordx4 v[52:55], v1, s[4:7], s64 offen
    s_add_u32 s64, s25, 0x2800
    buffer_load_dwordx4 v[56:59], v1, s[4:7], s64 offen
    s_add_u32 s64, s25, 0x2c00
    buffer_load_dwordx4 v[60:63], v1, s[4:7], s64 offen
    s_add_u32 s64, s25, 0x3000
    buffer_load_dwordx4 v[64:67], v1, s[4:7], s64 offen
    s_add_u32 s64, s25, 0x3400
    buffer_load_dwordx4 v[68:71], v1, s[4:7], s64 offen
    s_add_u32 s64, s25, 0x3800
    buffer_load_dwordx4 v[72:75], v1, s[4:7], s64 offen
    s_add_u32 s64, s25, 0x3c00
    buffer_load_dwordx4 v[76:79], v1, s[4:7], s64 offen
    s_add_u32 s64, s25, 0x4000
    buffer_load_dwordx4 v[80:83], v1, s[4:7], s64 offen
    s_add_u32 s64, s25, 0x4400
    buffer_load_dwordx4 v[84:87], v1, s[4:7], s64 offen
    s_add_u32 s64, s25, 0x4800
    buffer_load_dwordx4 v[88:91], v1, s[4:7], s64 offen
    s_add_u32 s64, s25, 0x4c00
    buffer_load_dwordx4 v[92:95], v1, s[4:7], s64 offen
    s_add_u32 s64, s25, 0x5000
    buffer_load_dwordx4 v[96:99], v1, s[4:7], s64 offen
    s_add_u32 s64, s25, 0x5400
    buffer_load_dwordx4 v[100:103], v1, s[4:7], s64 offen
    s_add_u32 s64, s25, 0x5800
    buffer_load_dwordx4 v[104:107], v1, s[4:7], s64 offen
    s_add_u32 s64, s25, 0x5c00
    buffer_load_dwordx4 v[108:111], v1, s[4:7], s64 offen
    s_add_u32 s64, s25, 0x6000
    buffer_load_dwordx4 v[112:115], v1, s[4:7], s64 offen
    s_add_u32 s64, s25, 0x6400
    buffer_load_dwordx4 v[116:119], v1, s[4:7], s64 offen
    s_add_u32 s64, s25, 0x6800
    buffer_load_dwordx4 v[120:123], v1, s[4:7], s64 offen
    s_add_u32 s64, s25, 0x6c00
    buffer_load_dwordx4 v[124:127], v1, s[4:7], s64 offen
    s_add_u32 s64, s25, 0x7000
    buffer_load_dwordx4 v[128:131], v1, s[4:7], s64 offen
    s_add_u32 s64, s25, 0x7400
    buffer_load_dwordx4 v[132:135], v1, s[4:7], s64 offen
    s_add_u32 s64, s25, 0x7800
    buffer_load_dwordx4 v[136:139], v1, s[4:7], s64 offen
    s_add_u32 s64, s25, 0x7c00
    buffer_load_dwordx4 v[140:143], v1, s[4:7], s64 offen
    s_waitcnt vmcnt(31)
    v_mfma_f32_16x16x32_bf16 v[144:147], a[0:3], v[16:19], 0
    v_mfma_f32_16x16x32_bf16 v[148:151], a[4:7], v[16:19], 0
    s_waitcnt vmcnt(30)
    v_mfma_f32_16x16x32_bf16 v[144:147], a[8:11], v[20:23], v[144:147]
    v_mfma_f32_16x16x32_bf16 v[148:151], a[12:15], v[20:23], v[148:151]
    s_waitcnt vmcnt(29)
    v_mfma_f32_16x16x32_bf16 v[144:147], a[16:19], v[24:27], v[144:147]
    v_mfma_f32_16x16x32_bf16 v[148:151], a[20:23], v[24:27], v[148:151]
    s_waitcnt vmcnt(28)
    v_mfma_f32_16x16x32_bf16 v[144:147], a[24:27], v[28:31], v[144:147]
    v_mfma_f32_16x16x32_bf16 v[148:151], a[28:31], v[28:31], v[148:151]
    s_waitcnt vmcnt(27)
    v_mfma_f32_16x16x32_bf16 v[144:147], a[32:35], v[32:35], v[144:147]
    v_mfma_f32_16x16x32_bf16 v[148:151], a[36:39], v[32:35], v[148:151]
    s_waitcnt vmcnt(26)
    v_mfma_f32_16x16x32_bf16 v[144:147], a[40:43], v[36:39], v[144:147]
    v_mfma_f32_16x16x32_bf16 v[148:151], a[44:47], v[36:39], v[148:151]
    s_waitcnt vmcnt(25)
    v_mfma_f32_16x16x32_bf16 v[144:147], a[48:51], v[40:43], v[144:147]
    v_mfma_f32_16x16x32_bf16 v[148:151], a[52:55], v[40:43], v[148:151]
    s_waitcnt vmcnt(24)
    v_mfma_f32_16x16x32_bf16 v[144:147], a[56:59], v[44:47], v[144:147]
    v_mfma_f32_16x16x32_bf16 v[148:151], a[60:63], v[44:47], v[148:151]
    s_waitcnt vmcnt(23)
    v_mfma_f32_16x16x32_bf16 v[144:147], a[64:67], v[48:51], v[144:147]
    v_mfma_f32_16x16x32_bf16 v[148:151], a[68:71], v[48:51], v[148:151]
    s_waitcnt vmcnt(22)
    v_mfma_f32_16x16x32_bf16 v[144:147], a[72:75], v[52:55], v[144:147]
    v_mfma_f32_16x16x32_bf16 v[148:151], a[76:79], v[52:55], v[148:151]
    s_waitcnt vmcnt(21)
    v_mfma_f32_16x16x32_bf16 v[144:147], a[80:83], v[56:59], v[144:147]
    v_mfma_f32_16x16x32_bf16 v[148:151], a[84:87], v[56:59], v[148:151]
    s_waitcnt vmcnt(20)
    v_mfma_f32_16x16x32_bf16 v[144:147], a[88:91], v[60:63], v[144:147]
    v_mfma_f32_16x16x32_bf16 v[148:151], a[92:95], v[60:63], v[148:151]
    s_waitcnt vmcnt(19)
    v_mfma_f32_16x16x32_bf16 v[144:147], a[96:99], v[64:67], v[144:147]
    v_mfma_f32_16x16x32_bf16 v[148:151], a[100:103], v[64:67], v[148:151]
    s_waitcnt vmcnt(18)
    v_mfma_f32_16x16x32_bf16 v[144:147], a[104:107], v[68:71], v[144:147]
    v_mfma_f32_16x16x32_bf16 v[148:151], a[108:111], v[68:71], v[148:151]
    s_waitcnt vmcnt(17)
    v_mfma_f32_16x16x32_bf16 v[144:147], a[112:115], v[72:75], v[144:147]
    v_mfma_f32_16x16x32_bf16 v[148:151], a[116:119], v[72:75], v[148:151]
    s_waitcnt vmcnt(16)
    v_mfma_f32_16x16x32_bf16 v[144:147], a[120:123], v[76:79], v[144:147]
    v_mfma_f32_16x16x32_bf16 v[148:151], a[124:127], v[76:79], v[148:151]
    s_waitcnt vmcnt(15)
    v_mfma_f32_16x16x32_bf16 v[144:147], a[128:131], v[80:83], v[144:147]
    v_mfma_f32_16x16x32_bf16 v[148:151], a[132:135], v[80:83], v[148:151]
    s_waitcnt vmcnt(14)
    v_mfma_f32_16x16x32_bf16 v[144:147], a[136:139], v[84:87], v[144:147]
    v_mfma_f32_16x16x32_bf16 v[148:151], a[140:143], v[84:87], v[148:151]
    s_waitcnt vmcnt(13)
    v_mfma_f32_16x16x32_bf16 v[144:147], a[144:147], v[88:91], v[144:147]
    v_mfma_f32_16x16x32_bf16 v[148:151], a[148:151], v[88:91], v[148:151]
    s_waitcnt vmcnt(12)
    v_mfma_f32_16x16x32_bf16 v[144:147], a[152:155], v[92:95], v[144:147]
    v_mfma_f32_16x16x32_bf16 v[148:151], a[156:159], v[92:95], v[148:151]
    s_waitcnt vmcnt(11)
    v_mfma_f32_16x16x32_bf16 v[144:147], a[160:163], v[96:99], v[144:147]
    v_mfma_f32_16x16x32_bf16 v[148:151], a[164:167], v[96:99], v[148:151]
    s_waitcnt vmcnt(10)
    v_mfma_f32_16x16x32_bf16 v[144:147], a[168:171], v[100:103], v[144:147]
    v_mfma_f32_16x16x32_bf16 v[148:151], a[172:175], v[100:103], v[148:151]
    s_waitcnt vmcnt(9)
    v_mfma_f32_16x16x32_bf16 v[144:147], a[176:179], v[104:107], v[144:147]
    v_mfma_f32_16x16x32_bf16 v[148:151], a[180:183], v[104:107], v[148:151]
    s_waitcnt vmcnt(8)
    v_mfma_f32_16x16x32_bf16 v[144:147], a[184:187], v[108:111], v[144:147]
    v_mfma_f32_16x16x32_bf16 v[148:151], a[188:191], v[108:111], v[148:151]
    s_waitcnt vmcnt(7)
    v_mfma_f32_16x16x32_bf16 v[144:147], a[192:195], v[112:115], v[144:147]
    v_mfma_f32_16x16x32_bf16 v[148:151], a[196:199], v[112:115], v[148:151]
    s_waitcnt vmcnt(6)
    v_mfma_f32_16x16x32_bf16 v[144:147], a[200:203], v[116:119], v[144:147]
    v_mfma_f32_16x16x32_bf16 v[148:151], a[204:207], v[116:119], v[148:151]
    s_waitcnt vmcnt(5)
    v_mfma_f32_16x16x32_bf16 v[144:147], a[208:211], v[120:123], v[144:147]
    v_mfma_f32_16x16x32_bf16 v[148:151], a[212:215], v[120:123], v[148:151]
    s_waitcnt vmcnt(4)
    v_mfma_f32_16x16x32_bf16 v[144:147], a[216:219], v[124:127], v[144:147]
    v_mfma_f32_16x16x32_bf16 v[148:151], a[220:223], v[124:127], v[148:151]
    s_waitcnt vmcnt(3)
    v_mfma_f32_16x16x32_bf16 v[144:147], a[224:227], v[128:131], v[144:147]
    v_mfma_f32_16x16x32_bf16 v[148:151], a[228:231], v[128:131], v[148:151]
    s_waitcnt vmcnt(2)
    v_mfma_f32_16x16x32_bf16 v[144:147], a[232:235], v[132:135], v[144:147]
    v_mfma_f32_16x16x32_bf16 v[148:151], a[236:239], v[132:135], v[148:151]
    s_waitcnt vmcnt(1)
    v_mfma_f32_16x16x32_bf16 v[144:147], a[240:243], v[136:139], v[144:147]
    v_mfma_f32_16x16x32_bf16 v[148:151], a[244:247], v[136:139], v[148:151]
    s_waitcnt vmcnt(0)
    v_mfma_f32_16x16x32_bf16 v[144:147], a[248:251], v[140:143], v[144:147]
    v_mfma_f32_16x16x32_bf16 v[148:151], a[252:255], v[140:143], v[148:151]
    s_lshl_b32 s64, s14, 12
    v_add_u32 v7, s64, v1
    s_barrier
    s_nop 3
    ds_write_b128 v7, v[144:147] offset:0
    ds_write_b128 v7, v[148:151] offset:1024
    s_waitcnt lgkmcnt(0)
    s_barrier
    s_cmp_ge_u32 s14, 2
    s_cbranch_scc1 OTD_169
    s_lshl_b32 s64, s14, 10
    v_add_u32 v7, s64, v1
    ds_read_b128 v[16:19], v7 offset:0
    ds_read_b128 v[20:23], v7 offset:4096
    ds_read_b128 v[24:27], v7 offset:8192
    ds_read_b128 v[28:31], v7 offset:12288
    s_waitcnt lgkmcnt(0)
    v_add_f32 v16, v16, v20
    v_add_f32 v24, v24, v28
    v_add_f32 v16, v16, v24
    v_add_f32 v17, v17, v21
    v_add_f32 v25, v25, v29
    v_add_f32 v17, v17, v25
    v_add_f32 v18, v18, v22
    v_add_f32 v26, v26, v30
    v_add_f32 v18, v18, v26
    v_add_f32 v19, v19, v23
    v_add_f32 v27, v27, v31
    v_add_f32 v19, v19, v27
    v_cvt_pk_bf16_f32 v16, v16, v16
    v_lshlrev_b32 v16, 16, v16
    v_cvt_pk_bf16_f32 v17, v17, v17
    v_lshlrev_b32 v17, 16, v17
    v_cvt_pk_bf16_f32 v18, v18, v18
    v_lshlrev_b32 v18, 16, v18
    v_cvt_pk_bf16_f32 v19, v19, v19
    v_lshlrev_b32 v19, 16, v19
    v_lshlrev_b32 v20, 16, v162
    v_and_b32 v21, 0xffff0000, v162
    v_lshlrev_b32 v24, 16, v160
    v_and_b32 v25, 0xffff0000, v160
    v_lshlrev_b32 v22, 16, v163
    v_and_b32 v23, 0xffff0000, v163
    v_lshlrev_b32 v26, 16, v161
    v_and_b32 v27, 0xffff0000, v161
    s_lshl_b32 s64, s24, 5
    v_add_u32 v8, s64, v9
    v_mov_b32 v10, -1
    v_cmp_eq_u32 vcc, s72, v8
    s_nop 1
    v_cndmask_b32 v10, v10, 0, vcc
    v_cmp_eq_u32 vcc, s73, v8
    s_nop 1
    v_cndmask_b32 v10, v10, 1, vcc
    v_cmp_eq_u32 vcc, s74, v8
    s_nop 1
    v_cndmask_b32 v10, v10, 2, vcc
    v_cmp_eq_u32 vcc, s75, v8
    s_nop 1
    v_cndmask_b32 v10, v10, 3, vcc
    v_cmp_eq_u32 vcc, s76, v8
    s_nop 1
    v_cndmask_b32 v10, v10, 4, vcc
    v_cmp_eq_u32 vcc, s77, v8
    s_nop 1
    v_cndmask_b32 v10, v10, 5, vcc
    v_cmp_eq_u32 vcc, s78, v8
    s_nop 1
    v_cndmask_b32 v10, v10, 6, vcc
    v_cmp_eq_u32 vcc, s79, v8
    s_nop 1
    v_cndmask_b32 v10, v10, 7, vcc
    v_cmp_le_i32 vcc, 0, v10
    s_and_saveexec_b64 s[68:69], vcc
    s_cbranch_execz NOUPD_170
    v_mul_u32_u24 v10, 2560, v10
    v_lshrrev_b32 v11, 4, v0
    v_lshl_add_u32 v10, v11, 4, v10
    s_lshl_b32 s64, s86, 6
    s_lshl_b32 s65, s13, 7
    s_add_u32 s64, s64, s65
    s_add_u32 s64, s64, 0x5410000
    buffer_load_dwordx4 v[164:167], v10, s[4:7], s64 offen sc1
    s_waitcnt vmcnt(0)
    v_add_f32 v20, v20, v164
    v_cvt_pk_bf16_f32 v20, v20, v20
    v_lshlrev_b32 v20, 16, v20
    v_add_f32 v21, v21, v165
    v_cvt_pk_bf16_f32 v21, v21, v21
    v_lshlrev_b32 v21, 16, v21
    v_add_f32 v22, v22, v166
    v_cvt_pk_bf16_f32 v22, v22, v22
    v_lshlrev_b32 v22, 16, v22
    v_add_f32 v23, v23, v167
    v_cvt_pk_bf16_f32 v23, v23, v23
    v_lshlrev_b32 v23, 16, v23
NOUPD_170:
    s_mov_b64 exec, -1
    v_mul_f32 v28, 0xbfb8aa3b, v20
    v_exp_f32 v28, v28
    s_nop 0
    v_add_f32 v28, 1.0, v28
    v_rcp_f32 v28, v28
    s_nop 0
    v_mul_f32 v28, v28, v20
    v_cvt_pk_bf16_f32 v28, v28, v28
    v_lshlrev_b32 v28, 16, v28
    v_mul_f32 v28, v28, v16
    v_cvt_pk_bf16_f32 v28, v28, v28
    v_lshlrev_b32 v28, 16, v28
    v_add_f32 v28, v28, v24
    v_mul_f32 v29, 0xbfb8aa3b, v21
    v_exp_f32 v29, v29
    s_nop 0
    v_add_f32 v29, 1.0, v29
    v_rcp_f32 v29, v29
    s_nop 0
    v_mul_f32 v29, v29, v21
    v_cvt_pk_bf16_f32 v29, v29, v29
    v_lshlrev_b32 v29, 16, v29
    v_mul_f32 v29, v29, v17
    v_cvt_pk_bf16_f32 v29, v29, v29
    v_lshlrev_b32 v29, 16, v29
    v_add_f32 v29, v29, v25
    v_mul_f32 v30, 0xbfb8aa3b, v22
    v_exp_f32 v30, v30
    s_nop 0
    v_add_f32 v30, 1.0, v30
    v_rcp_f32 v30, v30
    s_nop 0
    v_mul_f32 v30, v30, v22
    v_cvt_pk_bf16_f32 v30, v30, v30
    v_lshlrev_b32 v30, 16, v30
    v_mul_f32 v30, v30, v18
    v_cvt_pk_bf16_f32 v30, v30, v30
    v_lshlrev_b32 v30, 16, v30
    v_add_f32 v30, v30, v26
    v_mul_f32 v31, 0xbfb8aa3b, v23
    v_exp_f32 v31, v31
    s_nop 0
    v_add_f32 v31, 1.0, v31
    v_rcp_f32 v31, v31
    s_nop 0
    v_mul_f32 v31, v31, v23
    v_cvt_pk_bf16_f32 v31, v31, v31
    v_lshlrev_b32 v31, 16, v31
    v_mul_f32 v31, v31, v19
    v_cvt_pk_bf16_f32 v31, v31, v31
    v_lshlrev_b32 v31, 16, v31
    v_add_f32 v31, v31, v27
    v_cvt_pk_bf16_f32 v164, v28, v29
    v_cvt_pk_bf16_f32 v165, v30, v31
    buffer_store_dwordx2 v[164:165], v5, s[52:55], s67 offen
OTD_169:
    s_branch M_EXIT
H_Q:
    s_mov_b32 s29, 0
    v_lshlrev_b32 v1, 4, v0
    v_lshrrev_b32 v5, 4, v0
    v_lshlrev_b32 v2, 7, v5
    v_and_b32 v5, 7, v0
    v_lshl_add_u32 v2, v5, 4, v2
    v_bfe_u32 v5, v0, 4, 1
    v_lshlrev_b32 v3, 7, v5
    v_and_b32 v5, 15, v0
    v_lshl_add_u32 v3, v5, 3, v3
    s_mov_b32 s34, 0x3e0293ee
    s_mov_b32 s35, 0x3e0293ee
    s_mov_b32 s36, -1
    s_mov_b32 s37, 0
    v_lshrrev_b32 v5, 4, v0
    v_lshlrev_b32 v5, 2, v5
    v_and_b32 v6, 15, v0
    v_add_u32 v7, 0, v5
    v_cmp_le_u32 s[38:39], v7, v6
    v_add_u32 v7, 1, v5
    v_cmp_le_u32 s[40:41], v7, v6
    v_add_u32 v7, 2, v5
    v_cmp_le_u32 s[42:43], v7, v6
    v_add_u32 v7, 3, v5
    v_cmp_le_u32 s[44:45], v7, v6
    v_mov_b32 v248, 0x3f803f80
    v_mov_b32 v249, 0x3f803f80
    v_mov_b32 v250, 0x3f803f80
    v_mov_b32 v251, 0x3f803f80
    s_lshl_b32 s24, s12, 2
    s_add_u32 s24, s24, s14
    s_mov_b32 s25, 0
AT0_LOOP:
    s_cmp_eq_u32 s24, 63
    s_cbranch_scc1 AT0_END
    s_lshl_b32 s64, s24, 5
    s_add_u32 s64, s64, s13
    s_lshl_b32 s26, s64, 13
    s_add_u32 s26, s26, 0x3400000
    s_lshl_b32 s27, s64, 14
    s_add_u32 s27, s27, 0x1400000
    s_lshl_b32 s65, s64, 11
    s_add_u32 s30, s65, 0x640000
    s_add_u32 s31, s65, 0xa40000
    s_lshl_b32 s33, s64, 2
    s_add_u32 s33, s33, 0x296000
    s_lshl_b32 s32, s24, 18
    s_lshl_b32 s65, s13, 12
    s_add_u32 s32, s32, s65
    s_add_u32 s32, s32, 0x4400000
    s_lshr_b32 s65, s24, 2
    s_lshl_b32 s65, s65, 9
    s_lshl_b32 s66, s13, 4
    s_add_u32 s65, s65, s66
    s_add_u32 s65, s65, 0x291000
    s_lshr_b32 s66, s24, 1
    s_lshl_b32 s66, s66, 8
    s_lshl_b32 s64, s13, 3
    s_add_u32 s66, s66, s64
    s_add_u32 s66, s66, 0x293ff4
    v_lshlrev_b32 v5, 2, v0
    v_mov_b32 v6, s65
    v_mov_b32 v7, s66
    v_cmp_gt_u32 vcc, 3, v0
    s_nop 1
    v_cndmask_b32 v6, v7, v6, vcc
    v_add_u32 v4, v5, v6
    s_mov_b32 s64, 0
    s_mov_b64 exec, 7
AT0_F_171:
    buffer_load_dword v5, v4, s[4:7], s64 offen sc1
    s_add_u32 s29, s29, 1
    s_waitcnt vmcnt(0)
    v_cmp_eq_u32 vcc, 0, v5
    s_cbranch_vccz AT0_FD_172
    s_cmp_gt_u32 s29, 262144
    s_cbranch_scc1 AT0_FD_172
    s_sleep 1
    s_branch AT0_F_171
AT0_FD_172:
    s_mov_b64 exec, -1
    buffer_load_dwordx4 v[16:19], v1, s[4:7], s26 offen offset:0
    buffer_load_dwordx4 v[20:23], v1, s[4:7], s26 offen offset:1024
    buffer_load_dwordx4 v[24:27], v1, s[4:7], s26 offen offset:2048
    buffer_load_dwordx4 v[28:31], v1, s[4:7], s26 offen offset:3072
    s_add_u32 s26, s26, 4096
    buffer_load_dwordx4 v[32:35], v1, s[4:7], s26 offen offset:0
    buffer_load_dwordx4 v[36:39], v1, s[4:7], s26 offen offset:1024
    buffer_load_dwordx4 v[40:43], v1, s[4:7], s26 offen offset:2048
    buffer_load_dwordx4 v[44:47], v1, s[4:7], s26 offen offset:3072
    buffer_load_dwordx4 v[48:51], v1, s[4:7], s27 offen offset:0
    buffer_load_dwordx4 v[52:55], v1, s[4:7], s27 offen offset:1024
    buffer_load_dwordx4 v[56:59], v1, s[4:7], s27 offen offset:2048
    buffer_load_dwordx4 v[60:63], v1, s[4:7], s27 offen offset:3072
    s_add_u32 s27, s27, 4096
    buffer_load_dwordx4 v[64:67], v1, s[4:7], s27 offen offset:0
    buffer_load_dwordx4 v[68:71], v1, s[4:7], s27 offen offset:1024
    buffer_load_dwordx4 v[72:75], v1, s[4:7], s27 offen offset:2048
    buffer_load_dwordx4 v[76:79], v1, s[4:7], s27 offen offset:3072
    s_add_u32 s27, s27, 4096
    buffer_load_dwordx4 v[80:83], v1, s[4:7], s27 offen offset:0
    buffer_load_dwordx4 v[84:87], v1, s[4:7], s27 offen offset:1024
    buffer_load_dwordx4 v[88:91], v1, s[4:7], s27 offen offset:2048
    buffer_load_dwordx4 v[92:95], v1, s[4:7], s27 offen offset:3072
    s_add_u32 s27, s27, 4096
    buffer_load_dwordx4 v[96:99], v1, s[4:7], s27 offen offset:0
    buffer_load_dwordx4 v[100:103], v1, s[4:7], s27 offen offset:1024
    buffer_load_dwordx4 v[104:107], v1, s[4:7], s27 offen offset:2048
    buffer_load_dwordx4 v[108:111], v1, s[4:7], s27 offen offset:3072
    s_mov_b64 exec, 0x18
AT0_G_173:
    buffer_load_dword v5, v4, s[4:7], s64 offen sc1
    s_add_u32 s29, s29, 1
    s_waitcnt vmcnt(0)
    v_cmp_eq_u32 vcc, 0, v5
    s_cbranch_vccz AT0_GD_174
    s_cmp_gt_u32 s29, 262144
    s_cbranch_scc1 AT0_GD_174
    s_sleep 1
    s_branch AT0_G_173
AT0_GD_174:
    s_mov_b64 exec, -1
    buffer_load_dwordx4 v[112:115], v2, s[4:7], s30 offen offset:0
    buffer_load_dwordx4 v[116:119], v2, s[4:7], s30 offen offset:512
    buffer_load_dwordx4 v[120:123], v2, s[4:7], s30 offen offset:1024
    buffer_load_dwordx4 v[124:127], v2, s[4:7], s30 offen offset:1536
    buffer_load_dwordx2 v[128:129], v3, s[4:7], s31 offen offset:0
    buffer_load_dwordx2 v[130:131], v3, s[4:7], s31 offen offset:256
    buffer_load_dwordx2 v[132:133], v3, s[4:7], s31 offen offset:512
    buffer_load_dwordx2 v[134:135], v3, s[4:7], s31 offen offset:768
    buffer_load_dwordx2 v[136:137], v3, s[4:7], s31 offen offset:1024
    buffer_load_dwordx2 v[138:139], v3, s[4:7], s31 offen offset:1280
    buffer_load_dwordx2 v[140:141], v3, s[4:7], s31 offen offset:1536
    buffer_load_dwordx2 v[142:143], v3, s[4:7], s31 offen offset:1792
    v_mfma_f32_16x16x32_bf16 v[148:151], v[48:51], v[16:19], 0
    v_mfma_f32_16x16x32_bf16 v[156:159], v[48:51], v[32:35], 0
    v_mfma_f32_16x16x32_bf16 v[160:163], v[64:67], v[32:35], 0
    v_mfma_f32_16x16x32_bf16 v[148:151], v[52:55], v[20:23], v[148:151]
    v_mfma_f32_16x16x32_bf16 v[156:159], v[52:55], v[36:39], v[156:159]
    v_mfma_f32_16x16x32_bf16 v[160:163], v[68:71], v[36:39], v[160:163]
    v_mfma_f32_16x16x32_bf16 v[148:151], v[56:59], v[24:27], v[148:151]
    v_mfma_f32_16x16x32_bf16 v[156:159], v[56:59], v[40:43], v[156:159]
    v_mfma_f32_16x16x32_bf16 v[160:163], v[72:75], v[40:43], v[160:163]
    v_mfma_f32_16x16x32_bf16 v[148:151], v[60:63], v[28:31], v[148:151]
    v_mfma_f32_16x16x32_bf16 v[156:159], v[60:63], v[44:47], v[156:159]
    v_mfma_f32_16x16x32_bf16 v[160:163], v[76:79], v[44:47], v[160:163]
    s_waitcnt vmcnt(8)
    v_mfma_f32_16x16x32_bf16 v[144:147], v[112:115], v[16:19], 0
    v_mfma_f32_16x16x32_bf16 v[152:155], v[112:115], v[32:35], 0
    v_mfma_f32_16x16x32_bf16 v[144:147], v[116:119], v[20:23], v[144:147]
    v_mfma_f32_16x16x32_bf16 v[152:155], v[116:119], v[36:39], v[152:155]
    v_mfma_f32_16x16x32_bf16 v[144:147], v[120:123], v[24:27], v[144:147]
    v_mfma_f32_16x16x32_bf16 v[152:155], v[120:123], v[40:43], v[152:155]
    v_mfma_f32_16x16x32_bf16 v[144:147], v[124:127], v[28:31], v[144:147]
    v_mfma_f32_16x16x32_bf16 v[152:155], v[124:127], v[44:47], v[152:155]
    v_mov_b32 v11, 0xff800000
    s_nop 7
    v_cndmask_b32 v148, v11, v148, s[38:39]
    v_cndmask_b32 v160, v11, v160, s[38:39]
    v_cndmask_b32 v144, v11, v144, s[36:37]
    v_cndmask_b32 v152, v11, v152, s[36:37]
    v_cndmask_b32 v149, v11, v149, s[40:41]
    v_cndmask_b32 v161, v11, v161, s[40:41]
    v_cndmask_b32 v145, v11, v145, s[36:37]
    v_cndmask_b32 v153, v11, v153, s[36:37]
    v_cndmask_b32 v150, v11, v150, s[42:43]
    v_cndmask_b32 v162, v11, v162, s[42:43]
    v_cndmask_b32 v146, v11, v146, s[36:37]
    v_cndmask_b32 v154, v11, v154, s[36:37]
    v_cndmask_b32 v151, v11, v151, s[44:45]
    v_cndmask_b32 v163, v11, v163, s[44:45]
    v_cndmask_b32 v147, v11, v147, s[36:37]
    v_cndmask_b32 v155, v11, v155, s[36:37]
    v_max3_f32 v8, v144, v145, v146
    v_max3_f32 v8, v8, v147, v148
    v_max3_f32 v8, v8, v149, v150
    v_max_f32 v8, v8, v151
    v_mov_b32 v9, v8
    s_nop 1
    v_permlane16_swap_b32 v8, v9
    v_max_f32 v8, v8, v9
    v_mov_b32 v9, v8
    s_nop 1
    v_permlane32_swap_b32 v8, v9
    v_max_f32 v8, v8, v9
    v_mul_f32 v8, s34, v8
    v_fma_f32 v144, v144, s34, -v8
    v_fma_f32 v145, v145, s34, -v8
    v_fma_f32 v146, v146, s34, -v8
    v_fma_f32 v147, v147, s34, -v8
    v_fma_f32 v148, v148, s34, -v8
    v_fma_f32 v149, v149, s34, -v8
    v_fma_f32 v150, v150, s34, -v8
    v_fma_f32 v151, v151, s34, -v8
    v_exp_f32 v144, v144
    v_exp_f32 v145, v145
    v_exp_f32 v146, v146
    v_exp_f32 v147, v147
    v_exp_f32 v148, v148
    v_exp_f32 v149, v149
    v_exp_f32 v150, v150
    v_exp_f32 v151, v151
    s_nop 0
    v_cvt_pk_bf16_f32 v164, v148, v149
    v_cvt_pk_bf16_f32 v165, v150, v151
    v_mov_b32 v166, 0
    v_mov_b32 v167, 0
    v_cvt_pk_bf16_f32 v168, v144, v145
    v_cvt_pk_bf16_f32 v169, v146, v147
    v_max3_f32 v8, v152, v153, v154
    v_max3_f32 v8, v8, v155, v156
    v_max3_f32 v8, v8, v157, v158
    v_max3_f32 v8, v8, v159, v160
    v_max3_f32 v8, v8, v161, v162
    v_max_f32 v8, v8, v163
    v_mov_b32 v9, v8
    s_nop 1
    v_permlane16_swap_b32 v8, v9
    v_max_f32 v8, v8, v9
    v_mov_b32 v9, v8
    s_nop 1
    v_permlane32_swap_b32 v8, v9
    v_max_f32 v8, v8, v9
    v_mul_f32 v8, s34, v8
    v_fma_f32 v152, v152, s34, -v8
    v_fma_f32 v153, v153, s34, -v8
    v_fma_f32 v154, v154, s34, -v8
    v_fma_f32 v155, v155, s34, -v8
    v_fma_f32 v156, v156, s34, -v8
    v_fma_f32 v157, v157, s34, -v8
    v_fma_f32 v158, v158, s34, -v8
    v_fma_f32 v159, v159, s34, -v8
    v_fma_f32 v160, v160, s34, -v8
    v_fma_f32 v161, v161, s34, -v8
    v_fma_f32 v162, v162, s34, -v8
    v_fma_f32 v163, v163, s34, -v8
    v_exp_f32 v152, v152
    v_exp_f32 v153, v153
    v_exp_f32 v154, v154
    v_exp_f32 v155, v155
    v_exp_f32 v156, v156
    v_exp_f32 v157, v157
    v_exp_f32 v158, v158
    v_exp_f32 v159, v159
    v_exp_f32 v160, v160
    v_exp_f32 v161, v161
    v_exp_f32 v162, v162
    v_exp_f32 v163, v163
    s_nop 0
    v_cvt_pk_bf16_f32 v170, v156, v157
    v_cvt_pk_bf16_f32 v171, v158, v159
    v_cvt_pk_bf16_f32 v172, v160, v161
    v_cvt_pk_bf16_f32 v173, v162, v163
    v_cvt_pk_bf16_f32 v174, v152, v153
    v_cvt_pk_bf16_f32 v175, v154, v155
    s_waitcnt vmcnt(0)
    v_mfma_f32_16x16x32_bf16 v[240:243], v[248:251], v[164:167], 0
    v_mfma_f32_16x16x32_bf16 v[244:247], v[248:251], v[170:173], 0
    v_mfma_f32_16x16x32_bf16 v[176:179], v[80:83], v[164:167], 0
    v_mfma_f32_16x16x32_bf16 v[180:183], v[80:83], v[170:173], 0
    v_mfma_f32_16x16x32_bf16 v[184:187], v[84:87], v[164:167], 0
    v_mfma_f32_16x16x32_bf16 v[188:191], v[84:87], v[170:173], 0
    v_mfma_f32_16x16x32_bf16 v[192:195], v[88:91], v[164:167], 0
    v_mfma_f32_16x16x32_bf16 v[196:199], v[88:91], v[170:173], 0
    v_mfma_f32_16x16x32_bf16 v[200:203], v[92:95], v[164:167], 0
    v_mfma_f32_16x16x32_bf16 v[204:207], v[92:95], v[170:173], 0
    v_mfma_f32_16x16x32_bf16 v[208:211], v[96:99], v[164:167], 0
    v_mfma_f32_16x16x32_bf16 v[212:215], v[96:99], v[170:173], 0
    v_mfma_f32_16x16x32_bf16 v[216:219], v[100:103], v[164:167], 0
    v_mfma_f32_16x16x32_bf16 v[220:223], v[100:103], v[170:173], 0
    v_mfma_f32_16x16x32_bf16 v[224:227], v[104:107], v[164:167], 0
    v_mfma_f32_16x16x32_bf16 v[228:231], v[104:107], v[170:173], 0
    v_mfma_f32_16x16x32_bf16 v[232:235], v[108:111], v[164:167], 0
    v_mfma_f32_16x16x32_bf16 v[236:239], v[108:111], v[170:173], 0
    v_mfma_f32_16x16x16_bf16 v[240:243], v[248:249], v[168:169], v[240:243]
    v_mfma_f32_16x16x16_bf16 v[244:247], v[248:249], v[174:175], v[244:247]
    v_mfma_f32_16x16x16_bf16 v[176:179], v[128:129], v[168:169], v[176:179]
    v_mfma_f32_16x16x16_bf16 v[180:183], v[128:129], v[174:175], v[180:183]
    v_mfma_f32_16x16x16_bf16 v[184:187], v[130:131], v[168:169], v[184:187]
    v_mfma_f32_16x16x16_bf16 v[188:191], v[130:131], v[174:175], v[188:191]
    v_mfma_f32_16x16x16_bf16 v[192:195], v[132:133], v[168:169], v[192:195]
    v_mfma_f32_16x16x16_bf16 v[196:199], v[132:133], v[174:175], v[196:199]
    v_mfma_f32_16x16x16_bf16 v[200:203], v[134:135], v[168:169], v[200:203]
    v_mfma_f32_16x16x16_bf16 v[204:207], v[134:135], v[174:175], v[204:207]
    v_mfma_f32_16x16x16_bf16 v[208:211], v[136:137], v[168:169], v[208:211]
    v_mfma_f32_16x16x16_bf16 v[212:215], v[136:137], v[174:175], v[212:215]
    v_mfma_f32_16x16x16_bf16 v[216:219], v[138:139], v[168:169], v[216:219]
    v_mfma_f32_16x16x16_bf16 v[220:223], v[138:139], v[174:175], v[220:223]
    v_mfma_f32_16x16x16_bf16 v[224:227], v[140:141], v[168:169], v[224:227]
    v_mfma_f32_16x16x16_bf16 v[228:231], v[140:141], v[174:175], v[228:231]
    v_mfma_f32_16x16x16_bf16 v[232:235], v[142:143], v[168:169], v[232:235]
    v_mfma_f32_16x16x16_bf16 v[236:239], v[142:143], v[174:175], v[236:239]
    v_rcp_f32 v8, v240
    v_rcp_f32 v9, v244
    s_nop 7
    v_mul_f32 v176, v176, v8
    v_mul_f32 v177, v177, v8
    v_mul_f32 v178, v178, v8
    v_mul_f32 v179, v179, v8
    v_cvt_pk_bf16_f32 v16, v176, v177
    v_cvt_pk_bf16_f32 v17, v178, v179
    v_mul_f32 v184, v184, v8
    v_mul_f32 v185, v185, v8
    v_mul_f32 v186, v186, v8
    v_mul_f32 v187, v187, v8
    v_cvt_pk_bf16_f32 v18, v184, v185
    v_cvt_pk_bf16_f32 v19, v186, v187
    s_add_u32 s64, s32, 0x0
    buffer_store_dwordx4 v[16:19], v1, s[4:7], s64 offen offset:0 sc1
    v_mul_f32 v192, v192, v8
    v_mul_f32 v193, v193, v8
    v_mul_f32 v194, v194, v8
    v_mul_f32 v195, v195, v8
    v_cvt_pk_bf16_f32 v20, v192, v193
    v_cvt_pk_bf16_f32 v21, v194, v195
    v_mul_f32 v200, v200, v8
    v_mul_f32 v201, v201, v8
    v_mul_f32 v202, v202, v8
    v_mul_f32 v203, v203, v8
    v_cvt_pk_bf16_f32 v22, v200, v201
    v_cvt_pk_bf16_f32 v23, v202, v203
    s_add_u32 s64, s32, 0x0
    buffer_store_dwordx4 v[20:23], v1, s[4:7], s64 offen offset:1024 sc1
    v_mul_f32 v208, v208, v8
    v_mul_f32 v209, v209, v8
    v_mul_f32 v210, v210, v8
    v_mul_f32 v211, v211, v8
    v_cvt_pk_bf16_f32 v24, v208, v209
    v_cvt_pk_bf16_f32 v25, v210, v211
    v_mul_f32 v216, v216, v8
    v_mul_f32 v217, v217, v8
    v_mul_f32 v218, v218, v8
    v_mul_f32 v219, v219, v8
    v_cvt_pk_bf16_f32 v26, v216, v217
    v_cvt_pk_bf16_f32 v27, v218, v219
    s_add_u32 s64, s32, 0x0
    buffer_store_dwordx4 v[24:27], v1, s[4:7], s64 offen offset:2048 sc1
    v_mul_f32 v224, v224, v8
    v_mul_f32 v225, v225, v8
    v_mul_f32 v226, v226, v8
    v_mul_f32 v227, v227, v8
    v_cvt_pk_bf16_f32 v28, v224, v225
    v_cvt_pk_bf16_f32 v29, v226, v227
    v_mul_f32 v232, v232, v8
    v_mul_f32 v233, v233, v8
    v_mul_f32 v234, v234, v8
    v_mul_f32 v235, v235, v8
    v_cvt_pk_bf16_f32 v30, v232, v233
    v_cvt_pk_bf16_f32 v31, v234, v235
    s_add_u32 s64, s32, 0x0
    buffer_store_dwordx4 v[28:31], v1, s[4:7], s64 offen offset:3072 sc1
    v_mul_f32 v180, v180, v9
    v_mul_f32 v181, v181, v9
    v_mul_f32 v182, v182, v9
    v_mul_f32 v183, v183, v9
    v_cvt_pk_bf16_f32 v32, v180, v181
    v_cvt_pk_bf16_f32 v33, v182, v183
    v_mul_f32 v188, v188, v9
    v_mul_f32 v189, v189, v9
    v_mul_f32 v190, v190, v9
    v_mul_f32 v191, v191, v9
    v_cvt_pk_bf16_f32 v34, v188, v189
    v_cvt_pk_bf16_f32 v35, v190, v191
    s_add_u32 s64, s32, 0x20000
    buffer_store_dwordx4 v[32:35], v1, s[4:7], s64 offen offset:0 sc1
    v_mul_f32 v196, v196, v9
    v_mul_f32 v197, v197, v9
    v_mul_f32 v198, v198, v9
    v_mul_f32 v199, v199, v9
    v_cvt_pk_bf16_f32 v36, v196, v197
    v_cvt_pk_bf16_f32 v37, v198, v199
    v_mul_f32 v204, v204, v9
    v_mul_f32 v205, v205, v9
    v_mul_f32 v206, v206, v9
    v_mul_f32 v207, v207, v9
    v_cvt_pk_bf16_f32 v38, v204, v205
    v_cvt_pk_bf16_f32 v39, v206, v207
    s_add_u32 s64, s32, 0x20000
    buffer_store_dwordx4 v[36:39], v1, s[4:7], s64 offen offset:1024 sc1
    v_mul_f32 v212, v212, v9
    v_mul_f32 v213, v213, v9
    v_mul_f32 v214, v214, v9
    v_mul_f32 v215, v215, v9
    v_cvt_pk_bf16_f32 v40, v212, v213
    v_cvt_pk_bf16_f32 v41, v214, v215
    v_mul_f32 v220, v220, v9
    v_mul_f32 v221, v221, v9
    v_mul_f32 v222, v222, v9
    v_mul_f32 v223, v223, v9
    v_cvt_pk_bf16_f32 v42, v220, v221
    v_cvt_pk_bf16_f32 v43, v222, v223
    s_add_u32 s64, s32, 0x20000
    buffer_store_dwordx4 v[40:43], v1, s[4:7], s64 offen offset:2048 sc1
    v_mul_f32 v228, v228, v9
    v_mul_f32 v229, v229, v9
    v_mul_f32 v230, v230, v9
    v_mul_f32 v231, v231, v9
    v_cvt_pk_bf16_f32 v44, v228, v229
    v_cvt_pk_bf16_f32 v45, v230, v231
    v_mul_f32 v236, v236, v9
    v_mul_f32 v237, v237, v9
    v_mul_f32 v238, v238, v9
    v_mul_f32 v239, v239, v9
    v_cvt_pk_bf16_f32 v46, v236, v237
    v_cvt_pk_bf16_f32 v47, v238, v239
    s_add_u32 s64, s32, 0x20000
    buffer_store_dwordx4 v[44:47], v1, s[4:7], s64 offen offset:3072 sc1
    s_waitcnt vmcnt(0)
    v_mov_b32 v7, 1
    v_mov_b32 v8, 0
    s_mov_b64 exec, 1
    buffer_store_dword v7, v8, s[4:7], s33 offen sc1
    s_mov_b64 exec, -1
    s_add_u32 s24, s24, 8
    s_add_u32 s25, s25, 1
    s_cmp_lt_u32 s25, 1
    s_cbranch_scc1 AT0_LOOP
AT0_END:
    s_lshl_b32 s70, s13, 1
    s_add_u32 s70, s70, s12
    s_load_dwordx2 s[44:45], s[0:1], 72
    s_mov_b32 s46, 0x21c000
    s_mov_b32 s47, 0x00020000
    s_load_dwordx2 s[48:49], s[0:1], 80
    s_mov_b32 s50, 0x21c000
    s_mov_b32 s51, 0x00020000
    s_load_dwordx2 s[52:53], s[0:1], 88
    s_mov_b32 s54, 0x21c000
    s_mov_b32 s55, 0x00020000
    s_mov_b32 s29, 0
    s_waitcnt lgkmcnt(0)
    v_mbcnt_lo_u32_b32 v0, -1, 0
    v_mbcnt_hi_u32_b32 v0, -1, v0
    s_lshl_b32 s24, s70, 2
    s_add_u32 s24, s24, s14
    s_cmp_ge_u32 s24, 108
    s_cbranch_scc1 H_A1
    v_mov_b32 v8, 0
    s_mov_b32 s64, 0x298000
F1W_175:
    buffer_load_dword v7, v8, s[4:7], s64 offen sc1
    s_add_u32 s29, s29, 1
    s_waitcnt vmcnt(0)
    v_cmp_gt_u32 vcc, 1, v7
    s_cbranch_vccz F1WD_176
    s_cmp_gt_u32 s29, 262144
    s_cbranch_scc1 F1WD_176
    s_sleep 8
    s_branch F1W_175
F1WD_176:
    s_mul_i32 s25, s14, 40960
    v_lshrrev_b32 v7, 1, v0
    v_mul_u32_u24 v2, 3456, v7
    v_and_b32 v7, 1, v0
    v_lshl_add_u32 v2, v7, 4, v2
    v_lshrrev_b32 v7, 4, v0
    v_lshlrev_b32 v3, 8, v7
    v_bfe_u32 v7, v0, 2, 2
    v_lshl_add_u32 v3, v7, 5, v3
    v_and_b32 v7, 3, v0
    v_lshl_add_u32 v3, v7, 3, v3
    v_add_u32 v3, s25, v3
    v_and_b32 v7, 7, v0
    v_lshlrev_b32 v7, 2, v7
    s_mov_b32 s64, 0x5400000
    buffer_load_dword v4, v7, s[4:7], s64 offen sc1
    s_waitcnt vmcnt(0)
    v_mul_u32_u24 v4, 1280, v4
    v_lshrrev_b32 v7, 4, v0
    v_lshl_add_u32 v4, v7, 4, v4
    s_mov_b32 s65, 0x0
    buffer_load_dwordx4 v[16:19], v4, s[4:7], s65 offen offset:0 sc1
    buffer_load_dwordx4 v[20:23], v4, s[4:7], s65 offen offset:64 sc1
    buffer_load_dwordx4 v[24:27], v4, s[4:7], s65 offen offset:128 sc1
    buffer_load_dwordx4 v[28:31], v4, s[4:7], s65 offen offset:192 sc1
    buffer_load_dwordx4 v[32:35], v4, s[4:7], s65 offen offset:256 sc1
    buffer_load_dwordx4 v[36:39], v4, s[4:7], s65 offen offset:320 sc1
    buffer_load_dwordx4 v[40:43], v4, s[4:7], s65 offen offset:384 sc1
    buffer_load_dwordx4 v[44:47], v4, s[4:7], s65 offen offset:448 sc1
    buffer_load_dwordx4 v[48:51], v4, s[4:7], s65 offen offset:512 sc1
    buffer_load_dwordx4 v[52:55], v4, s[4:7], s65 offen offset:576 sc1
    buffer_load_dwordx4 v[56:59], v4, s[4:7], s65 offen offset:640 sc1
    buffer_load_dwordx4 v[60:63], v4, s[4:7], s65 offen offset:704 sc1
    buffer_load_dwordx4 v[64:67], v4, s[4:7], s65 offen offset:768 sc1
    buffer_load_dwordx4 v[68:71], v4, s[4:7], s65 offen offset:832 sc1
    buffer_load_dwordx4 v[72:75], v4, s[4:7], s65 offen offset:896 sc1
    buffer_load_dwordx4 v[76:79], v4, s[4:7], s65 offen offset:960 sc1
    buffer_load_dwordx4 v[80:83], v4, s[4:7], s65 offen offset:1024 sc1
    buffer_load_dwordx4 v[84:87], v4, s[4:7], s65 offen offset:1088 sc1
    buffer_load_dwordx4 v[88:91], v4, s[4:7], s65 offen offset:1152 sc1
    buffer_load_dwordx4 v[92:95], v4, s[4:7], s65 offen offset:1216 sc1
    s_lshl_b32 s26, s24, 5
    s_add_u32 m0, s25, 0
    s_add_u32 s64, s26, 0x0
    buffer_load_dwordx4 v2, s[44:47], s64 offen lds
    s_add_u32 m0, s25, 1024
    s_add_u32 s64, s26, 0x1b000
    buffer_load_dwordx4 v2, s[44:47], s64 offen lds
    s_add_u32 m0, s25, 2048
    s_add_u32 s64, s26, 0x36000
    buffer_load_dwordx4 v2, s[44:47], s64 offen lds
    s_add_u32 m0, s25, 3072
    s_add_u32 s64, s26, 0x51000
    buffer_load_dwordx4 v2, s[44:47], s64 offen lds
    s_add_u32 m0, s25, 4096
    s_add_u32 s64, s26, 0x6c000
    buffer_load_dwordx4 v2, s[44:47], s64 offen lds
    s_add_u32 m0, s25, 5120
    s_add_u32 s64, s26, 0x87000
    buffer_load_dwordx4 v2, s[44:47], s64 offen lds
    s_add_u32 m0, s25, 6144
    s_add_u32 s64, s26, 0xa2000
    buffer_load_dwordx4 v2, s[44:47], s64 offen lds
    s_add_u32 m0, s25, 7168
    s_add_u32 s64, s26, 0xbd000
    buffer_load_dwordx4 v2, s[44:47], s64 offen lds
    s_add_u32 m0, s25, 8192
    s_add_u32 s64, s26, 0xd8000
    buffer_load_dwordx4 v2, s[44:47], s64 offen lds
    s_add_u32 m0, s25, 9216
    s_add_u32 s64, s26, 0xf3000
    buffer_load_dwordx4 v2, s[44:47], s64 offen lds
    s_add_u32 m0, s25, 10240
    s_add_u32 s64, s26, 0x10e000
    buffer_load_dwordx4 v2, s[44:47], s64 offen lds
    s_add_u32 m0, s25, 11264
    s_add_u32 s64, s26, 0x129000
    buffer_load_dwordx4 v2, s[44:47], s64 offen lds
    s_add_u32 m0, s25, 12288
    s_add_u32 s64, s26, 0x144000
    buffer_load_dwordx4 v2, s[44:47], s64 offen lds
    s_add_u32 m0, s25, 13312
    s_add_u32 s64, s26, 0x15f000
    buffer_load_dwordx4 v2, s[44:47], s64 offen lds
    s_add_u32 m0, s25, 14336
    s_add_u32 s64, s26, 0x17a000
    buffer_load_dwordx4 v2, s[44:47], s64 offen lds
    s_add_u32 m0, s25, 15360
    s_add_u32 s64, s26, 0x195000
    buffer_load_dwordx4 v2, s[44:47], s64 offen lds
    s_add_u32 m0, s25, 16384
    s_add_u32 s64, s26, 0x1b0000
    buffer_load_dwordx4 v2, s[44:47], s64 offen lds
    s_add_u32 m0, s25, 17408
    s_add_u32 s64, s26, 0x1cb000
    buffer_load_dwordx4 v2, s[44:47], s64 offen lds
    s_add_u32 m0, s25, 18432
    s_add_u32 s64, s26, 0x1e6000
    buffer_load_dwordx4 v2, s[44:47], s64 offen lds
    s_add_u32 m0, s25, 19456
    s_add_u32 s64, s26, 0x201000
    buffer_load_dwordx4 v2, s[44:47], s64 offen lds
    s_waitcnt vmcnt(0)
    ds_read_b64_tr_b16 v[96:97], v3 offset:0
    ds_read_b64_tr_b16 v[98:99], v3 offset:128
    ds_read_b64_tr_b16 v[100:101], v3 offset:1024
    ds_read_b64_tr_b16 v[102:103], v3 offset:1152
    ds_read_b64_tr_b16 v[104:105], v3 offset:2048
    ds_read_b64_tr_b16 v[106:107], v3 offset:2176
    ds_read_b64_tr_b16 v[108:109], v3 offset:3072
    ds_read_b64_tr_b16 v[110:111], v3 offset:3200
    ds_read_b64_tr_b16 v[112:113], v3 offset:4096
    ds_read_b64_tr_b16 v[114:115], v3 offset:4224
    ds_read_b64_tr_b16 v[116:117], v3 offset:5120
    ds_read_b64_tr_b16 v[118:119], v3 offset:5248
    s_waitcnt lgkmcnt(4)
    ds_read_b64_tr_b16 v[120:121], v3 offset:6144
    ds_read_b64_tr_b16 v[122:123], v3 offset:6272
    ds_read_b64_tr_b16 v[124:125], v3 offset:7168
    ds_read_b64_tr_b16 v[126:127], v3 offset:7296
    ds_read_b64_tr_b16 v[128:129], v3 offset:8192
    ds_read_b64_tr_b16 v[130:131], v3 offset:8320
    ds_read_b64_tr_b16 v[132:133], v3 offset:9216
    ds_read_b64_tr_b16 v[134:135], v3 offset:9344
    ds_read_b64_tr_b16 v[136:137], v3 offset:10240
    ds_read_b64_tr_b16 v[138:139], v3 offset:10368
    ds_read_b64_tr_b16 v[140:141], v3 offset:11264
    ds_read_b64_tr_b16 v[142:143], v3 offset:11392
    s_waitcnt lgkmcnt(4)
    ds_read_b64_tr_b16 v[144:145], v3 offset:12288
    ds_read_b64_tr_b16 v[146:147], v3 offset:12416
    ds_read_b64_tr_b16 v[148:149], v3 offset:13312
    ds_read_b64_tr_b16 v[150:151], v3 offset:13440
    ds_read_b64_tr_b16 v[152:153], v3 offset:14336
    ds_read_b64_tr_b16 v[154:155], v3 offset:14464
    ds_read_b64_tr_b16 v[156:157], v3 offset:15360
    ds_read_b64_tr_b16 v[158:159], v3 offset:15488
    ds_read_b64_tr_b16 v[160:161], v3 offset:16384
    ds_read_b64_tr_b16 v[162:163], v3 offset:16512
    ds_read_b64_tr_b16 v[164:165], v3 offset:17408
    ds_read_b64_tr_b16 v[166:167], v3 offset:17536
    s_waitcnt lgkmcnt(4)
    ds_read_b64_tr_b16 v[168:169], v3 offset:18432
    ds_read_b64_tr_b16 v[170:171], v3 offset:18560
    ds_read_b64_tr_b16 v[172:173], v3 offset:19456
    ds_read_b64_tr_b16 v[174:175], v3 offset:19584
    s_waitcnt lgkmcnt(0)
    s_add_u32 s25, s25, 20480
    v_add_u32 v3, 20480, v3
    s_add_u32 m0, s25, 0
    s_add_u32 s64, s26, 0x0
    buffer_load_dwordx4 v2, s[48:51], s64 offen lds
    s_add_u32 m0, s25, 1024
    s_add_u32 s64, s26, 0x1b000
    buffer_load_dwordx4 v2, s[48:51], s64 offen lds
    s_add_u32 m0, s25, 2048
    s_add_u32 s64, s26, 0x36000
    buffer_load_dwordx4 v2, s[48:51], s64 offen lds
    s_add_u32 m0, s25, 3072
    s_add_u32 s64, s26, 0x51000
    buffer_load_dwordx4 v2, s[48:51], s64 offen lds
    s_add_u32 m0, s25, 4096
    s_add_u32 s64, s26, 0x6c000
    buffer_load_dwordx4 v2, s[48:51], s64 offen lds
    s_add_u32 m0, s25, 5120
    s_add_u32 s64, s26, 0x87000
    buffer_load_dwordx4 v2, s[48:51], s64 offen lds
    s_add_u32 m0, s25, 6144
    s_add_u32 s64, s26, 0xa2000
    buffer_load_dwordx4 v2, s[48:51], s64 offen lds
    s_add_u32 m0, s25, 7168
    s_add_u32 s64, s26, 0xbd000
    buffer_load_dwordx4 v2, s[48:51], s64 offen lds
    s_add_u32 m0, s25, 8192
    s_add_u32 s64, s26, 0xd8000
    buffer_load_dwordx4 v2, s[48:51], s64 offen lds
    s_add_u32 m0, s25, 9216
    s_add_u32 s64, s26, 0xf3000
    buffer_load_dwordx4 v2, s[48:51], s64 offen lds
    s_add_u32 m0, s25, 10240
    s_add_u32 s64, s26, 0x10e000
    buffer_load_dwordx4 v2, s[48:51], s64 offen lds
    s_add_u32 m0, s25, 11264
    s_add_u32 s64, s26, 0x129000
    buffer_load_dwordx4 v2, s[48:51], s64 offen lds
    s_add_u32 m0, s25, 12288
    s_add_u32 s64, s26, 0x144000
    buffer_load_dwordx4 v2, s[48:51], s64 offen lds
    s_add_u32 m0, s25, 13312
    s_add_u32 s64, s26, 0x15f000
    buffer_load_dwordx4 v2, s[48:51], s64 offen lds
    s_add_u32 m0, s25, 14336
    s_add_u32 s64, s26, 0x17a000
    buffer_load_dwordx4 v2, s[48:51], s64 offen lds
    s_add_u32 m0, s25, 15360
    s_add_u32 s64, s26, 0x195000
    buffer_load_dwordx4 v2, s[48:51], s64 offen lds
    s_add_u32 m0, s25, 16384
    s_add_u32 s64, s26, 0x1b0000
    buffer_load_dwordx4 v2, s[48:51], s64 offen lds
    s_add_u32 m0, s25, 17408
    s_add_u32 s64, s26, 0x1cb000
    buffer_load_dwordx4 v2, s[48:51], s64 offen lds
    s_add_u32 m0, s25, 18432
    s_add_u32 s64, s26, 0x1e6000
    buffer_load_dwordx4 v2, s[48:51], s64 offen lds
    s_add_u32 m0, s25, 19456
    s_add_u32 s64, s26, 0x201000
    buffer_load_dwordx4 v2, s[48:51], s64 offen lds
    s_waitcnt vmcnt(0)
    ds_read_b64_tr_b16 v[176:177], v3 offset:0
    ds_read_b64_tr_b16 v[178:179], v3 offset:128
    ds_read_b64_tr_b16 v[180:181], v3 offset:1024
    ds_read_b64_tr_b16 v[182:183], v3 offset:1152
    ds_read_b64_tr_b16 v[184:185], v3 offset:2048
    ds_read_b64_tr_b16 v[186:187], v3 offset:2176
    ds_read_b64_tr_b16 v[188:189], v3 offset:3072
    ds_read_b64_tr_b16 v[190:191], v3 offset:3200
    ds_read_b64_tr_b16 v[192:193], v3 offset:4096
    ds_read_b64_tr_b16 v[194:195], v3 offset:4224
    ds_read_b64_tr_b16 v[196:197], v3 offset:5120
    ds_read_b64_tr_b16 v[198:199], v3 offset:5248
    s_waitcnt lgkmcnt(4)
    ds_read_b64_tr_b16 v[200:201], v3 offset:6144
    ds_read_b64_tr_b16 v[202:203], v3 offset:6272
    ds_read_b64_tr_b16 v[204:205], v3 offset:7168
    ds_read_b64_tr_b16 v[206:207], v3 offset:7296
    ds_read_b64_tr_b16 v[208:209], v3 offset:8192
    ds_read_b64_tr_b16 v[210:211], v3 offset:8320
    ds_read_b64_tr_b16 v[212:213], v3 offset:9216
    ds_read_b64_tr_b16 v[214:215], v3 offset:9344
    ds_read_b64_tr_b16 v[216:217], v3 offset:10240
    ds_read_b64_tr_b16 v[218:219], v3 offset:10368
    ds_read_b64_tr_b16 v[220:221], v3 offset:11264
    ds_read_b64_tr_b16 v[222:223], v3 offset:11392
    s_waitcnt lgkmcnt(4)
    ds_read_b64_tr_b16 v[224:225], v3 offset:12288
    ds_read_b64_tr_b16 v[226:227], v3 offset:12416
    ds_read_b64_tr_b16 v[228:229], v3 offset:13312
    ds_read_b64_tr_b16 v[230:231], v3 offset:13440
    ds_read_b64_tr_b16 v[232:233], v3 offset:14336
    ds_read_b64_tr_b16 v[234:235], v3 offset:14464
    ds_read_b64_tr_b16 v[236:237], v3 offset:15360
    ds_read_b64_tr_b16 v[238:239], v3 offset:15488
    ds_read_b64_tr_b16 v[240:241], v3 offset:16384
    ds_read_b64_tr_b16 v[242:243], v3 offset:16512
    ds_read_b64_tr_b16 v[244:245], v3 offset:17408
    ds_read_b64_tr_b16 v[246:247], v3 offset:17536
    s_waitcnt lgkmcnt(4)
    ds_read_b64_tr_b16 v[248:249], v3 offset:18432
    ds_read_b64_tr_b16 v[250:251], v3 offset:18560
    ds_read_b64_tr_b16 v[252:253], v3 offset:19456
    ds_read_b64_tr_b16 v[254:255], v3 offset:19584
    s_waitcnt lgkmcnt(0)
    v_mfma_f32_16x16x32_bf16 v[8:11], v[96:99], v[16:19], 0
    v_mfma_f32_16x16x32_bf16 v[12:15], v[176:179], v[16:19], 0
    v_mfma_f32_16x16x32_bf16 v[8:11], v[100:103], v[20:23], v[8:11]
    v_mfma_f32_16x16x32_bf16 v[12:15], v[180:183], v[20:23], v[12:15]
    v_mfma_f32_16x16x32_bf16 v[8:11], v[104:107], v[24:27], v[8:11]
    v_mfma_f32_16x16x32_bf16 v[12:15], v[184:187], v[24:27], v[12:15]
    v_mfma_f32_16x16x32_bf16 v[8:11], v[108:111], v[28:31], v[8:11]
    v_mfma_f32_16x16x32_bf16 v[12:15], v[188:191], v[28:31], v[12:15]
    v_mfma_f32_16x16x32_bf16 v[8:11], v[112:115], v[32:35], v[8:11]
    v_mfma_f32_16x16x32_bf16 v[12:15], v[192:195], v[32:35], v[12:15]
    v_mfma_f32_16x16x32_bf16 v[8:11], v[116:119], v[36:39], v[8:11]
    v_mfma_f32_16x16x32_bf16 v[12:15], v[196:199], v[36:39], v[12:15]
    v_mfma_f32_16x16x32_bf16 v[8:11], v[120:123], v[40:43], v[8:11]
    v_mfma_f32_16x16x32_bf16 v[12:15], v[200:203], v[40:43], v[12:15]
    v_mfma_f32_16x16x32_bf16 v[8:11], v[124:127], v[44:47], v[8:11]
    v_mfma_f32_16x16x32_bf16 v[12:15], v[204:207], v[44:47], v[12:15]
    v_mfma_f32_16x16x32_bf16 v[8:11], v[128:131], v[48:51], v[8:11]
    v_mfma_f32_16x16x32_bf16 v[12:15], v[208:211], v[48:51], v[12:15]
    v_mfma_f32_16x16x32_bf16 v[8:11], v[132:135], v[52:55], v[8:11]
    v_mfma_f32_16x16x32_bf16 v[12:15], v[212:215], v[52:55], v[12:15]
    v_mfma_f32_16x16x32_bf16 v[8:11], v[136:139], v[56:59], v[8:11]
    v_mfma_f32_16x16x32_bf16 v[12:15], v[216:219], v[56:59], v[12:15]
    v_mfma_f32_16x16x32_bf16 v[8:11], v[140:143], v[60:63], v[8:11]
    v_mfma_f32_16x16x32_bf16 v[12:15], v[220:223], v[60:63], v[12:15]
    v_mfma_f32_16x16x32_bf16 v[8:11], v[144:147], v[64:67], v[8:11]
    v_mfma_f32_16x16x32_bf16 v[12:15], v[224:227], v[64:67], v[12:15]
    v_mfma_f32_16x16x32_bf16 v[8:11], v[148:151], v[68:71], v[8:11]
    v_mfma_f32_16x16x32_bf16 v[12:15], v[228:231], v[68:71], v[12:15]
    v_mfma_f32_16x16x32_bf16 v[8:11], v[152:155], v[72:75], v[8:11]
    v_mfma_f32_16x16x32_bf16 v[12:15], v[232:235], v[72:75], v[12:15]
    v_mfma_f32_16x16x32_bf16 v[8:11], v[156:159], v[76:79], v[8:11]
    v_mfma_f32_16x16x32_bf16 v[12:15], v[236:239], v[76:79], v[12:15]
    v_mfma_f32_16x16x32_bf16 v[8:11], v[160:163], v[80:83], v[8:11]
    v_mfma_f32_16x16x32_bf16 v[12:15], v[240:243], v[80:83], v[12:15]
    v_mfma_f32_16x16x32_bf16 v[8:11], v[164:167], v[84:87], v[8:11]
    v_mfma_f32_16x16x32_bf16 v[12:15], v[244:247], v[84:87], v[12:15]
    v_mfma_f32_16x16x32_bf16 v[8:11], v[168:171], v[88:91], v[8:11]
    v_mfma_f32_16x16x32_bf16 v[12:15], v[248:251], v[88:91], v[12:15]
    v_mfma_f32_16x16x32_bf16 v[8:11], v[172:175], v[92:95], v[8:11]
    v_mfma_f32_16x16x32_bf16 v[12:15], v[252:255], v[92:95], v[12:15]
    s_nop 7
    v_cvt_pk_bf16_f32 v8, v8, v8
    v_lshlrev_b32 v8, 16, v8
    v_cvt_pk_bf16_f32 v12, v12, v12
    v_lshlrev_b32 v12, 16, v12
    v_mul_f32 v16, 0xbfb8aa3b, v8
    v_exp_f32 v16, v16
    s_nop 0
    v_add_f32 v16, 1.0, v16
    v_rcp_f32 v16, v16
    s_nop 0
    v_mul_f32 v8, v8, v16
    v_cvt_pk_bf16_f32 v8, v8, v8
    v_lshlrev_b32 v8, 16, v8
    v_mul_f32 v8, v8, v12
    v_cvt_pk_bf16_f32 v9, v9, v9
    v_lshlrev_b32 v9, 16, v9
    v_cvt_pk_bf16_f32 v13, v13, v13
    v_lshlrev_b32 v13, 16, v13
    v_mul_f32 v17, 0xbfb8aa3b, v9
    v_exp_f32 v17, v17
    s_nop 0
    v_add_f32 v17, 1.0, v17
    v_rcp_f32 v17, v17
    s_nop 0
    v_mul_f32 v9, v9, v17
    v_cvt_pk_bf16_f32 v9, v9, v9
    v_lshlrev_b32 v9, 16, v9
    v_mul_f32 v9, v9, v13
    v_cvt_pk_bf16_f32 v10, v10, v10
    v_lshlrev_b32 v10, 16, v10
    v_cvt_pk_bf16_f32 v14, v14, v14
    v_lshlrev_b32 v14, 16, v14
    v_mul_f32 v18, 0xbfb8aa3b, v10
    v_exp_f32 v18, v18
    s_nop 0
    v_add_f32 v18, 1.0, v18
    v_rcp_f32 v18, v18
    s_nop 0
    v_mul_f32 v10, v10, v18
    v_cvt_pk_bf16_f32 v10, v10, v10
    v_lshlrev_b32 v10, 16, v10
    v_mul_f32 v10, v10, v14
    v_cvt_pk_bf16_f32 v11, v11, v11
    v_lshlrev_b32 v11, 16, v11
    v_cvt_pk_bf16_f32 v15, v15, v15
    v_lshlrev_b32 v15, 16, v15
    v_mul_f32 v19, 0xbfb8aa3b, v11
    v_exp_f32 v19, v19
    s_nop 0
    v_add_f32 v19, 1.0, v19
    v_rcp_f32 v19, v19
    s_nop 0
    v_mul_f32 v11, v11, v19
    v_cvt_pk_bf16_f32 v11, v11, v11
    v_lshlrev_b32 v11, 16, v11
    v_mul_f32 v11, v11, v15
    v_cvt_pk_bf16_f32 v16, v8, v9
    v_cvt_pk_bf16_f32 v17, v10, v11
    s_lshr_b32 s65, s24, 1
    s_lshl_b32 s65, s65, 10
    s_and_b32 s66, s24, 1
    s_lshl_b32 s66, s66, 3
    s_add_u32 s65, s65, s66
    s_add_u32 s65, s65, 0x5401000
    v_lshlrev_b32 v4, 4, v0
    buffer_store_dwordx2 v[16:17], v4, s[4:7], s65 offen sc1
    s_waitcnt vmcnt(0)
    v_mov_b32 v7, 1
    v_mov_b32 v8, 0
    s_mov_b32 s64, 0x298080
    s_mov_b64 exec, 1
    buffer_atomic_add v7, v8, s[4:7], s64 offen sc1
    s_mov_b64 exec, -1
H_A1:
    v_mbcnt_lo_u32_b32 v0, -1, 0
    v_mbcnt_hi_u32_b32 v0, -1, v0
    s_mov_b32 s29, 0
    v_lshlrev_b32 v1, 4, v0
    v_lshrrev_b32 v5, 4, v0
    v_lshlrev_b32 v2, 7, v5
    v_and_b32 v5, 7, v0
    v_lshl_add_u32 v2, v5, 4, v2
    v_bfe_u32 v5, v0, 4, 1
    v_lshlrev_b32 v3, 7, v5
    v_and_b32 v5, 15, v0
    v_lshl_add_u32 v3, v5, 3, v3
    s_mov_b32 s34, 0x3e0293ee
    s_mov_b32 s35, 0x3e0293ee
    s_mov_b32 s36, -1
    s_mov_b32 s37, 0
    v_lshrrev_b32 v5, 4, v0
    v_lshlrev_b32 v5, 2, v5
    v_and_b32 v6, 15, v0
    v_add_u32 v7, 0, v5
    v_cmp_le_u32 s[38:39], v7, v6
    v_add_u32 v7, 1, v5
    v_cmp_le_u32 s[40:41], v7, v6
    v_add_u32 v7, 2, v5
    v_cmp_le_u32 s[42:43], v7, v6
    v_add_u32 v7, 3, v5
    v_cmp_le_u32 s[44:45], v7, v6
    v_mov_b32 v248, 0x3f803f80
    v_mov_b32 v249, 0x3f803f80
    v_mov_b32 v250, 0x3f803f80
    v_mov_b32 v251, 0x3f803f80
    s_lshl_b32 s24, s12, 2
    s_add_u32 s24, s24, s14
    s_add_u32 s24, s24, 8
    s_mov_b32 s25, 1
AT1_LOOP:
    s_cmp_eq_u32 s24, 63
    s_cbranch_scc1 AT1_END
    s_lshl_b32 s64, s24, 5
    s_add_u32 s64, s64, s13
    s_lshl_b32 s26, s64, 13
    s_add_u32 s26, s26, 0x3400000
    s_lshl_b32 s27, s64, 14
    s_add_u32 s27, s27, 0x1400000
    s_lshl_b32 s65, s64, 11
    s_add_u32 s30, s65, 0x640000
    s_add_u32 s31, s65, 0xa40000
    s_lshl_b32 s33, s64, 2
    s_add_u32 s33, s33, 0x296000
    s_lshl_b32 s32, s24, 18
    s_lshl_b32 s65, s13, 12
    s_add_u32 s32, s32, s65
    s_add_u32 s32, s32, 0x4400000
    s_lshr_b32 s65, s24, 2
    s_lshl_b32 s65, s65, 9
    s_lshl_b32 s66, s13, 4
    s_add_u32 s65, s65, s66
    s_add_u32 s65, s65, 0x291000
    s_lshr_b32 s66, s24, 1
    s_lshl_b32 s66, s66, 8
    s_lshl_b32 s64, s13, 3
    s_add_u32 s66, s66, s64
    s_add_u32 s66, s66, 0x293ff4
    v_lshlrev_b32 v5, 2, v0
    v_mov_b32 v6, s65
    v_mov_b32 v7, s66
    v_cmp_gt_u32 vcc, 3, v0
    s_nop 1
    v_cndmask_b32 v6, v7, v6, vcc
    v_add_u32 v4, v5, v6
    s_mov_b32 s64, 0
    s_mov_b64 exec, 7
AT1_F_177:
    buffer_load_dword v5, v4, s[4:7], s64 offen sc1
    s_add_u32 s29, s29, 1
    s_waitcnt vmcnt(0)
    v_cmp_eq_u32 vcc, 0, v5
    s_cbranch_vccz AT1_FD_178
    s_cmp_gt_u32 s29, 262144
    s_cbranch_scc1 AT1_FD_178
    s_sleep 1
    s_branch AT1_F_177
AT1_FD_178:
    s_mov_b64 exec, -1
    buffer_load_dwordx4 v[16:19], v1, s[4:7], s26 offen offset:0
    buffer_load_dwordx4 v[20:23], v1, s[4:7], s26 offen offset:1024
    buffer_load_dwordx4 v[24:27], v1, s[4:7], s26 offen offset:2048
    buffer_load_dwordx4 v[28:31], v1, s[4:7], s26 offen offset:3072
    s_add_u32 s26, s26, 4096
    buffer_load_dwordx4 v[32:35], v1, s[4:7], s26 offen offset:0
    buffer_load_dwordx4 v[36:39], v1, s[4:7], s26 offen offset:1024
    buffer_load_dwordx4 v[40:43], v1, s[4:7], s26 offen offset:2048
    buffer_load_dwordx4 v[44:47], v1, s[4:7], s26 offen offset:3072
    buffer_load_dwordx4 v[48:51], v1, s[4:7], s27 offen offset:0
    buffer_load_dwordx4 v[52:55], v1, s[4:7], s27 offen offset:1024
    buffer_load_dwordx4 v[56:59], v1, s[4:7], s27 offen offset:2048
    buffer_load_dwordx4 v[60:63], v1, s[4:7], s27 offen offset:3072
    s_add_u32 s27, s27, 4096
    buffer_load_dwordx4 v[64:67], v1, s[4:7], s27 offen offset:0
    buffer_load_dwordx4 v[68:71], v1, s[4:7], s27 offen offset:1024
    buffer_load_dwordx4 v[72:75], v1, s[4:7], s27 offen offset:2048
    buffer_load_dwordx4 v[76:79], v1, s[4:7], s27 offen offset:3072
    s_add_u32 s27, s27, 4096
    buffer_load_dwordx4 v[80:83], v1, s[4:7], s27 offen offset:0
    buffer_load_dwordx4 v[84:87], v1, s[4:7], s27 offen offset:1024
    buffer_load_dwordx4 v[88:91], v1, s[4:7], s27 offen offset:2048
    buffer_load_dwordx4 v[92:95], v1, s[4:7], s27 offen offset:3072
    s_add_u32 s27, s27, 4096
    buffer_load_dwordx4 v[96:99], v1, s[4:7], s27 offen offset:0
    buffer_load_dwordx4 v[100:103], v1, s[4:7], s27 offen offset:1024
    buffer_load_dwordx4 v[104:107], v1, s[4:7], s27 offen offset:2048
    buffer_load_dwordx4 v[108:111], v1, s[4:7], s27 offen offset:3072
    s_mov_b64 exec, 0x18
AT1_G_179:
    buffer_load_dword v5, v4, s[4:7], s64 offen sc1
    s_add_u32 s29, s29, 1
    s_waitcnt vmcnt(0)
    v_cmp_eq_u32 vcc, 0, v5
    s_cbranch_vccz AT1_GD_180
    s_cmp_gt_u32 s29, 262144
    s_cbranch_scc1 AT1_GD_180
    s_sleep 1
    s_branch AT1_G_179
AT1_GD_180:
    s_mov_b64 exec, -1
    buffer_load_dwordx4 v[112:115], v2, s[4:7], s30 offen offset:0
    buffer_load_dwordx4 v[116:119], v2, s[4:7], s30 offen offset:512
    buffer_load_dwordx4 v[120:123], v2, s[4:7], s30 offen offset:1024
    buffer_load_dwordx4 v[124:127], v2, s[4:7], s30 offen offset:1536
    buffer_load_dwordx2 v[128:129], v3, s[4:7], s31 offen offset:0
    buffer_load_dwordx2 v[130:131], v3, s[4:7], s31 offen offset:256
    buffer_load_dwordx2 v[132:133], v3, s[4:7], s31 offen offset:512
    buffer_load_dwordx2 v[134:135], v3, s[4:7], s31 offen offset:768
    buffer_load_dwordx2 v[136:137], v3, s[4:7], s31 offen offset:1024
    buffer_load_dwordx2 v[138:139], v3, s[4:7], s31 offen offset:1280
    buffer_load_dwordx2 v[140:141], v3, s[4:7], s31 offen offset:1536
    buffer_load_dwordx2 v[142:143], v3, s[4:7], s31 offen offset:1792
    v_mfma_f32_16x16x32_bf16 v[148:151], v[48:51], v[16:19], 0
    v_mfma_f32_16x16x32_bf16 v[156:159], v[48:51], v[32:35], 0
    v_mfma_f32_16x16x32_bf16 v[160:163], v[64:67], v[32:35], 0
    v_mfma_f32_16x16x32_bf16 v[148:151], v[52:55], v[20:23], v[148:151]
    v_mfma_f32_16x16x32_bf16 v[156:159], v[52:55], v[36:39], v[156:159]
    v_mfma_f32_16x16x32_bf16 v[160:163], v[68:71], v[36:39], v[160:163]
    v_mfma_f32_16x16x32_bf16 v[148:151], v[56:59], v[24:27], v[148:151]
    v_mfma_f32_16x16x32_bf16 v[156:159], v[56:59], v[40:43], v[156:159]
    v_mfma_f32_16x16x32_bf16 v[160:163], v[72:75], v[40:43], v[160:163]
    v_mfma_f32_16x16x32_bf16 v[148:151], v[60:63], v[28:31], v[148:151]
    v_mfma_f32_16x16x32_bf16 v[156:159], v[60:63], v[44:47], v[156:159]
    v_mfma_f32_16x16x32_bf16 v[160:163], v[76:79], v[44:47], v[160:163]
    s_waitcnt vmcnt(8)
    v_mfma_f32_16x16x32_bf16 v[144:147], v[112:115], v[16:19], 0
    v_mfma_f32_16x16x32_bf16 v[152:155], v[112:115], v[32:35], 0
    v_mfma_f32_16x16x32_bf16 v[144:147], v[116:119], v[20:23], v[144:147]
    v_mfma_f32_16x16x32_bf16 v[152:155], v[116:119], v[36:39], v[152:155]
    v_mfma_f32_16x16x32_bf16 v[144:147], v[120:123], v[24:27], v[144:147]
    v_mfma_f32_16x16x32_bf16 v[152:155], v[120:123], v[40:43], v[152:155]
    v_mfma_f32_16x16x32_bf16 v[144:147], v[124:127], v[28:31], v[144:147]
    v_mfma_f32_16x16x32_bf16 v[152:155], v[124:127], v[44:47], v[152:155]
    v_mov_b32 v11, 0xff800000
    s_nop 7
    v_cndmask_b32 v148, v11, v148, s[38:39]
    v_cndmask_b32 v160, v11, v160, s[38:39]
    v_cndmask_b32 v144, v11, v144, s[36:37]
    v_cndmask_b32 v152, v11, v152, s[36:37]
    v_cndmask_b32 v149, v11, v149, s[40:41]
    v_cndmask_b32 v161, v11, v161, s[40:41]
    v_cndmask_b32 v145, v11, v145, s[36:37]
    v_cndmask_b32 v153, v11, v153, s[36:37]
    v_cndmask_b32 v150, v11, v150, s[42:43]
    v_cndmask_b32 v162, v11, v162, s[42:43]
    v_cndmask_b32 v146, v11, v146, s[36:37]
    v_cndmask_b32 v154, v11, v154, s[36:37]
    v_cndmask_b32 v151, v11, v151, s[44:45]
    v_cndmask_b32 v163, v11, v163, s[44:45]
    v_cndmask_b32 v147, v11, v147, s[36:37]
    v_cndmask_b32 v155, v11, v155, s[36:37]
    v_max3_f32 v8, v144, v145, v146
    v_max3_f32 v8, v8, v147, v148
    v_max3_f32 v8, v8, v149, v150
    v_max_f32 v8, v8, v151
    v_mov_b32 v9, v8
    s_nop 1
    v_permlane16_swap_b32 v8, v9
    v_max_f32 v8, v8, v9
    v_mov_b32 v9, v8
    s_nop 1
    v_permlane32_swap_b32 v8, v9
    v_max_f32 v8, v8, v9
    v_mul_f32 v8, s34, v8
    v_fma_f32 v144, v144, s34, -v8
    v_fma_f32 v145, v145, s34, -v8
    v_fma_f32 v146, v146, s34, -v8
    v_fma_f32 v147, v147, s34, -v8
    v_fma_f32 v148, v148, s34, -v8
    v_fma_f32 v149, v149, s34, -v8
    v_fma_f32 v150, v150, s34, -v8
    v_fma_f32 v151, v151, s34, -v8
    v_exp_f32 v144, v144
    v_exp_f32 v145, v145
    v_exp_f32 v146, v146
    v_exp_f32 v147, v147
    v_exp_f32 v148, v148
    v_exp_f32 v149, v149
    v_exp_f32 v150, v150
    v_exp_f32 v151, v151
    s_nop 0
    v_cvt_pk_bf16_f32 v164, v148, v149
    v_cvt_pk_bf16_f32 v165, v150, v151
    v_mov_b32 v166, 0
    v_mov_b32 v167, 0
    v_cvt_pk_bf16_f32 v168, v144, v145
    v_cvt_pk_bf16_f32 v169, v146, v147
    v_max3_f32 v8, v152, v153, v154
    v_max3_f32 v8, v8, v155, v156
    v_max3_f32 v8, v8, v157, v158
    v_max3_f32 v8, v8, v159, v160
    v_max3_f32 v8, v8, v161, v162
    v_max_f32 v8, v8, v163
    v_mov_b32 v9, v8
    s_nop 1
    v_permlane16_swap_b32 v8, v9
    v_max_f32 v8, v8, v9
    v_mov_b32 v9, v8
    s_nop 1
    v_permlane32_swap_b32 v8, v9
    v_max_f32 v8, v8, v9
    v_mul_f32 v8, s34, v8
    v_fma_f32 v152, v152, s34, -v8
    v_fma_f32 v153, v153, s34, -v8
    v_fma_f32 v154, v154, s34, -v8
    v_fma_f32 v155, v155, s34, -v8
    v_fma_f32 v156, v156, s34, -v8
    v_fma_f32 v157, v157, s34, -v8
    v_fma_f32 v158, v158, s34, -v8
    v_fma_f32 v159, v159, s34, -v8
    v_fma_f32 v160, v160, s34, -v8
    v_fma_f32 v161, v161, s34, -v8
    v_fma_f32 v162, v162, s34, -v8
    v_fma_f32 v163, v163, s34, -v8
    v_exp_f32 v152, v152
    v_exp_f32 v153, v153
    v_exp_f32 v154, v154
    v_exp_f32 v155, v155
    v_exp_f32 v156, v156
    v_exp_f32 v157, v157
    v_exp_f32 v158, v158
    v_exp_f32 v159, v159
    v_exp_f32 v160, v160
    v_exp_f32 v161, v161
    v_exp_f32 v162, v162
    v_exp_f32 v163, v163
    s_nop 0
    v_cvt_pk_bf16_f32 v170, v156, v157
    v_cvt_pk_bf16_f32 v171, v158, v159
    v_cvt_pk_bf16_f32 v172, v160, v161
    v_cvt_pk_bf16_f32 v173, v162, v163
    v_cvt_pk_bf16_f32 v174, v152, v153
    v_cvt_pk_bf16_f32 v175, v154, v155
    s_waitcnt vmcnt(0)
    v_mfma_f32_16x16x32_bf16 v[240:243], v[248:251], v[164:167], 0
    v_mfma_f32_16x16x32_bf16 v[244:247], v[248:251], v[170:173], 0
    v_mfma_f32_16x16x32_bf16 v[176:179], v[80:83], v[164:167], 0
    v_mfma_f32_16x16x32_bf16 v[180:183], v[80:83], v[170:173], 0
    v_mfma_f32_16x16x32_bf16 v[184:187], v[84:87], v[164:167], 0
    v_mfma_f32_16x16x32_bf16 v[188:191], v[84:87], v[170:173], 0
    v_mfma_f32_16x16x32_bf16 v[192:195], v[88:91], v[164:167], 0
    v_mfma_f32_16x16x32_bf16 v[196:199], v[88:91], v[170:173], 0
    v_mfma_f32_16x16x32_bf16 v[200:203], v[92:95], v[164:167], 0
    v_mfma_f32_16x16x32_bf16 v[204:207], v[92:95], v[170:173], 0
    v_mfma_f32_16x16x32_bf16 v[208:211], v[96:99], v[164:167], 0
    v_mfma_f32_16x16x32_bf16 v[212:215], v[96:99], v[170:173], 0
    v_mfma_f32_16x16x32_bf16 v[216:219], v[100:103], v[164:167], 0
    v_mfma_f32_16x16x32_bf16 v[220:223], v[100:103], v[170:173], 0
    v_mfma_f32_16x16x32_bf16 v[224:227], v[104:107], v[164:167], 0
    v_mfma_f32_16x16x32_bf16 v[228:231], v[104:107], v[170:173], 0
    v_mfma_f32_16x16x32_bf16 v[232:235], v[108:111], v[164:167], 0
    v_mfma_f32_16x16x32_bf16 v[236:239], v[108:111], v[170:173], 0
    v_mfma_f32_16x16x16_bf16 v[240:243], v[248:249], v[168:169], v[240:243]
    v_mfma_f32_16x16x16_bf16 v[244:247], v[248:249], v[174:175], v[244:247]
    v_mfma_f32_16x16x16_bf16 v[176:179], v[128:129], v[168:169], v[176:179]
    v_mfma_f32_16x16x16_bf16 v[180:183], v[128:129], v[174:175], v[180:183]
    v_mfma_f32_16x16x16_bf16 v[184:187], v[130:131], v[168:169], v[184:187]
    v_mfma_f32_16x16x16_bf16 v[188:191], v[130:131], v[174:175], v[188:191]
    v_mfma_f32_16x16x16_bf16 v[192:195], v[132:133], v[168:169], v[192:195]
    v_mfma_f32_16x16x16_bf16 v[196:199], v[132:133], v[174:175], v[196:199]
    v_mfma_f32_16x16x16_bf16 v[200:203], v[134:135], v[168:169], v[200:203]
    v_mfma_f32_16x16x16_bf16 v[204:207], v[134:135], v[174:175], v[204:207]
    v_mfma_f32_16x16x16_bf16 v[208:211], v[136:137], v[168:169], v[208:211]
    v_mfma_f32_16x16x16_bf16 v[212:215], v[136:137], v[174:175], v[212:215]
    v_mfma_f32_16x16x16_bf16 v[216:219], v[138:139], v[168:169], v[216:219]
    v_mfma_f32_16x16x16_bf16 v[220:223], v[138:139], v[174:175], v[220:223]
    v_mfma_f32_16x16x16_bf16 v[224:227], v[140:141], v[168:169], v[224:227]
    v_mfma_f32_16x16x16_bf16 v[228:231], v[140:141], v[174:175], v[228:231]
    v_mfma_f32_16x16x16_bf16 v[232:235], v[142:143], v[168:169], v[232:235]
    v_mfma_f32_16x16x16_bf16 v[236:239], v[142:143], v[174:175], v[236:239]
    v_rcp_f32 v8, v240
    v_rcp_f32 v9, v244
    s_nop 7
    v_mul_f32 v176, v176, v8
    v_mul_f32 v177, v177, v8
    v_mul_f32 v178, v178, v8
    v_mul_f32 v179, v179, v8
    v_cvt_pk_bf16_f32 v16, v176, v177
    v_cvt_pk_bf16_f32 v17, v178, v179
    v_mul_f32 v184, v184, v8
    v_mul_f32 v185, v185, v8
    v_mul_f32 v186, v186, v8
    v_mul_f32 v187, v187, v8
    v_cvt_pk_bf16_f32 v18, v184, v185
    v_cvt_pk_bf16_f32 v19, v186, v187
    s_add_u32 s64, s32, 0x0
    buffer_store_dwordx4 v[16:19], v1, s[4:7], s64 offen offset:0 sc1
    v_mul_f32 v192, v192, v8
    v_mul_f32 v193, v193, v8
    v_mul_f32 v194, v194, v8
    v_mul_f32 v195, v195, v8
    v_cvt_pk_bf16_f32 v20, v192, v193
    v_cvt_pk_bf16_f32 v21, v194, v195
    v_mul_f32 v200, v200, v8
    v_mul_f32 v201, v201, v8
    v_mul_f32 v202, v202, v8
    v_mul_f32 v203, v203, v8
    v_cvt_pk_bf16_f32 v22, v200, v201
    v_cvt_pk_bf16_f32 v23, v202, v203
    s_add_u32 s64, s32, 0x0
    buffer_store_dwordx4 v[20:23], v1, s[4:7], s64 offen offset:1024 sc1
    v_mul_f32 v208, v208, v8
    v_mul_f32 v209, v209, v8
    v_mul_f32 v210, v210, v8
    v_mul_f32 v211, v211, v8
    v_cvt_pk_bf16_f32 v24, v208, v209
    v_cvt_pk_bf16_f32 v25, v210, v211
    v_mul_f32 v216, v216, v8
    v_mul_f32 v217, v217, v8
    v_mul_f32 v218, v218, v8
    v_mul_f32 v219, v219, v8
    v_cvt_pk_bf16_f32 v26, v216, v217
    v_cvt_pk_bf16_f32 v27, v218, v219
    s_add_u32 s64, s32, 0x0
    buffer_store_dwordx4 v[24:27], v1, s[4:7], s64 offen offset:2048 sc1
    v_mul_f32 v224, v224, v8
    v_mul_f32 v225, v225, v8
    v_mul_f32 v226, v226, v8
    v_mul_f32 v227, v227, v8
    v_cvt_pk_bf16_f32 v28, v224, v225
    v_cvt_pk_bf16_f32 v29, v226, v227
    v_mul_f32 v232, v232, v8
    v_mul_f32 v233, v233, v8
    v_mul_f32 v234, v234, v8
    v_mul_f32 v235, v235, v8
    v_cvt_pk_bf16_f32 v30, v232, v233
    v_cvt_pk_bf16_f32 v31, v234, v235
    s_add_u32 s64, s32, 0x0
    buffer_store_dwordx4 v[28:31], v1, s[4:7], s64 offen offset:3072 sc1
    v_mul_f32 v180, v180, v9
    v_mul_f32 v181, v181, v9
    v_mul_f32 v182, v182, v9
    v_mul_f32 v183, v183, v9
    v_cvt_pk_bf16_f32 v32, v180, v181
    v_cvt_pk_bf16_f32 v33, v182, v183
    v_mul_f32 v188, v188, v9
    v_mul_f32 v189, v189, v9
    v_mul_f32 v190, v190, v9
    v_mul_f32 v191, v191, v9
    v_cvt_pk_bf16_f32 v34, v188, v189
    v_cvt_pk_bf16_f32 v35, v190, v191
    s_add_u32 s64, s32, 0x20000
    buffer_store_dwordx4 v[32:35], v1, s[4:7], s64 offen offset:0 sc1
    v_mul_f32 v196, v196, v9
    v_mul_f32 v197, v197, v9
    v_mul_f32 v198, v198, v9
    v_mul_f32 v199, v199, v9
    v_cvt_pk_bf16_f32 v36, v196, v197
    v_cvt_pk_bf16_f32 v37, v198, v199
    v_mul_f32 v204, v204, v9
    v_mul_f32 v205, v205, v9
    v_mul_f32 v206, v206, v9
    v_mul_f32 v207, v207, v9
    v_cvt_pk_bf16_f32 v38, v204, v205
    v_cvt_pk_bf16_f32 v39, v206, v207
    s_add_u32 s64, s32, 0x20000
    buffer_store_dwordx4 v[36:39], v1, s[4:7], s64 offen offset:1024 sc1
    v_mul_f32 v212, v212, v9
    v_mul_f32 v213, v213, v9
    v_mul_f32 v214, v214, v9
    v_mul_f32 v215, v215, v9
    v_cvt_pk_bf16_f32 v40, v212, v213
    v_cvt_pk_bf16_f32 v41, v214, v215
    v_mul_f32 v220, v220, v9
    v_mul_f32 v221, v221, v9
    v_mul_f32 v222, v222, v9
    v_mul_f32 v223, v223, v9
    v_cvt_pk_bf16_f32 v42, v220, v221
    v_cvt_pk_bf16_f32 v43, v222, v223
    s_add_u32 s64, s32, 0x20000
    buffer_store_dwordx4 v[40:43], v1, s[4:7], s64 offen offset:2048 sc1
    v_mul_f32 v228, v228, v9
    v_mul_f32 v229, v229, v9
    v_mul_f32 v230, v230, v9
    v_mul_f32 v231, v231, v9
    v_cvt_pk_bf16_f32 v44, v228, v229
    v_cvt_pk_bf16_f32 v45, v230, v231
    v_mul_f32 v236, v236, v9
    v_mul_f32 v237, v237, v9
    v_mul_f32 v238, v238, v9
    v_mul_f32 v239, v239, v9
    v_cvt_pk_bf16_f32 v46, v236, v237
    v_cvt_pk_bf16_f32 v47, v238, v239
    s_add_u32 s64, s32, 0x20000
    buffer_store_dwordx4 v[44:47], v1, s[4:7], s64 offen offset:3072 sc1
    s_waitcnt vmcnt(0)
    v_mov_b32 v7, 1
    v_mov_b32 v8, 0
    s_mov_b64 exec, 1
    buffer_store_dword v7, v8, s[4:7], s33 offen sc1
    s_mov_b64 exec, -1
    s_add_u32 s24, s24, 8
    s_add_u32 s25, s25, 1
    s_cmp_lt_u32 s25, 2
    s_cbranch_scc1 AT1_LOOP
AT1_END:
    s_lshl_b32 s70, s13, 1
    s_add_u32 s70, s70, s12
    s_load_dwordx2 s[44:45], s[0:1], 72
    s_mov_b32 s46, 0x21c000
    s_mov_b32 s47, 0x00020000
    s_load_dwordx2 s[48:49], s[0:1], 80
    s_mov_b32 s50, 0x21c000
    s_mov_b32 s51, 0x00020000
    s_load_dwordx2 s[52:53], s[0:1], 88
    s_mov_b32 s54, 0x21c000
    s_mov_b32 s55, 0x00020000
    s_mov_b32 s29, 0
    s_waitcnt lgkmcnt(0)
    v_mbcnt_lo_u32_b32 v0, -1, 0
    v_mbcnt_hi_u32_b32 v0, -1, v0
    s_cmp_lg_u32 s14, 0
    s_cbranch_scc1 H_ATT
    s_cmp_ge_u32 s70, 40
    s_cbranch_scc1 H_ATT
    s_mov_b32 s24, s70
    v_mov_b32 v8, 0
    s_mov_b32 s64, 0x298080
F2W_181:
    buffer_load_dword v7, v8, s[4:7], s64 offen sc1
    s_add_u32 s29, s29, 1
    s_waitcnt vmcnt(0)
    v_mov_b32 v9, 108
    v_cmp_gt_u32 vcc, v9, v7
    s_cbranch_vccz F2WD_182
    s_cmp_gt_u32 s29, 262144
    s_cbranch_scc1 F2WD_182
    s_sleep 8
    s_branch F2W_181
F2WD_182:
    s_mov_b32 s25, 0
    v_lshrrev_b32 v7, 1, v0
    v_mul_u32_u24 v2, 1280, v7
    v_and_b32 v7, 1, v0
    v_lshl_add_u32 v2, v7, 4, v2
    v_lshrrev_b32 v7, 4, v0
    v_lshlrev_b32 v3, 7, v7
    v_bfe_u32 v7, v0, 2, 2
    v_lshl_add_u32 v3, v7, 5, v3
    v_and_b32 v7, 3, v0
    v_lshl_add_u32 v3, v7, 3, v3
    v_add_u32 v3, s25, v3
    v_lshlrev_b32 v4, 4, v0
    s_mov_b32 s65, 0x5401000
    buffer_load_dwordx4 v[16:19], v4, s[4:7], s65 offen offset:0 sc1
    buffer_load_dwordx4 v[20:23], v4, s[4:7], s65 offen offset:1024 sc1
    buffer_load_dwordx4 v[24:27], v4, s[4:7], s65 offen offset:2048 sc1
    buffer_load_dwordx4 v[28:31], v4, s[4:7], s65 offen offset:3072 sc1
    s_add_u32 s65, s65, 4096
    buffer_load_dwordx4 v[32:35], v4, s[4:7], s65 offen offset:0 sc1
    buffer_load_dwordx4 v[36:39], v4, s[4:7], s65 offen offset:1024 sc1
    buffer_load_dwordx4 v[40:43], v4, s[4:7], s65 offen offset:2048 sc1
    buffer_load_dwordx4 v[44:47], v4, s[4:7], s65 offen offset:3072 sc1
    s_add_u32 s65, s65, 4096
    buffer_load_dwordx4 v[48:51], v4, s[4:7], s65 offen offset:0 sc1
    buffer_load_dwordx4 v[52:55], v4, s[4:7], s65 offen offset:1024 sc1
    buffer_load_dwordx4 v[56:59], v4, s[4:7], s65 offen offset:2048 sc1
    buffer_load_dwordx4 v[60:63], v4, s[4:7], s65 offen offset:3072 sc1
    s_add_u32 s65, s65, 4096
    buffer_load_dwordx4 v[64:67], v4, s[4:7], s65 offen offset:0 sc1
    buffer_load_dwordx4 v[68:71], v4, s[4:7], s65 offen offset:1024 sc1
    buffer_load_dwordx4 v[72:75], v4, s[4:7], s65 offen offset:2048 sc1
    buffer_load_dwordx4 v[76:79], v4, s[4:7], s65 offen offset:3072 sc1
    s_add_u32 s65, s65, 4096
    buffer_load_dwordx4 v[80:83], v4, s[4:7], s65 offen offset:0 sc1
    buffer_load_dwordx4 v[84:87], v4, s[4:7], s65 offen offset:1024 sc1
    buffer_load_dwordx4 v[88:91], v4, s[4:7], s65 offen offset:2048 sc1
    buffer_load_dwordx4 v[92:95], v4, s[4:7], s65 offen offset:3072 sc1
    s_add_u32 s65, s65, 4096
    buffer_load_dwordx4 v[96:99], v4, s[4:7], s65 offen offset:0 sc1
    buffer_load_dwordx4 v[100:103], v4, s[4:7], s65 offen offset:1024 sc1
    buffer_load_dwordx4 v[104:107], v4, s[4:7], s65 offen offset:2048 sc1
    buffer_load_dwordx4 v[108:111], v4, s[4:7], s65 offen offset:3072 sc1
    s_add_u32 s65, s65, 4096
    buffer_load_dwordx4 v[112:115], v4, s[4:7], s65 offen offset:0 sc1
    buffer_load_dwordx4 v[116:119], v4, s[4:7], s65 offen offset:1024 sc1
    buffer_load_dwordx4 v[120:123], v4, s[4:7], s65 offen offset:2048 sc1
    buffer_load_dwordx4 v[124:127], v4, s[4:7], s65 offen offset:3072 sc1
    s_add_u32 s65, s65, 4096
    buffer_load_dwordx4 v[128:131], v4, s[4:7], s65 offen offset:0 sc1
    buffer_load_dwordx4 v[132:135], v4, s[4:7], s65 offen offset:1024 sc1
    buffer_load_dwordx4 v[136:139], v4, s[4:7], s65 offen offset:2048 sc1
    buffer_load_dwordx4 v[140:143], v4, s[4:7], s65 offen offset:3072 sc1
    s_add_u32 s65, s65, 4096
    buffer_load_dwordx4 v[144:147], v4, s[4:7], s65 offen offset:0 sc1
    buffer_load_dwordx4 v[148:151], v4, s[4:7], s65 offen offset:1024 sc1
    buffer_load_dwordx4 v[152:155], v4, s[4:7], s65 offen offset:2048 sc1
    buffer_load_dwordx4 v[156:159], v4, s[4:7], s65 offen offset:3072 sc1
    s_add_u32 s65, s65, 4096
    buffer_load_dwordx4 v[160:163], v4, s[4:7], s65 offen offset:0 sc1
    buffer_load_dwordx4 v[164:167], v4, s[4:7], s65 offen offset:1024 sc1
    buffer_load_dwordx4 v[168:171], v4, s[4:7], s65 offen offset:2048 sc1
    buffer_load_dwordx4 v[172:175], v4, s[4:7], s65 offen offset:3072 sc1
    s_add_u32 s65, s65, 4096
    buffer_load_dwordx4 v[176:179], v4, s[4:7], s65 offen offset:0 sc1
    s_waitcnt vmcnt(20)
    buffer_load_dwordx4 v[180:183], v4, s[4:7], s65 offen offset:1024 sc1
    buffer_load_dwordx4 v[184:187], v4, s[4:7], s65 offen offset:2048 sc1
    buffer_load_dwordx4 v[188:191], v4, s[4:7], s65 offen offset:3072 sc1
    s_add_u32 s65, s65, 4096
    buffer_load_dwordx4 v[192:195], v4, s[4:7], s65 offen offset:0 sc1
    buffer_load_dwordx4 v[196:199], v4, s[4:7], s65 offen offset:1024 sc1
    buffer_load_dwordx4 v[200:203], v4, s[4:7], s65 offen offset:2048 sc1
    buffer_load_dwordx4 v[204:207], v4, s[4:7], s65 offen offset:3072 sc1
    s_add_u32 s65, s65, 4096
    buffer_load_dwordx4 v[208:211], v4, s[4:7], s65 offen offset:0 sc1
    buffer_load_dwordx4 v[212:215], v4, s[4:7], s65 offen offset:1024 sc1
    buffer_load_dwordx4 v[216:219], v4, s[4:7], s65 offen offset:2048 sc1
    buffer_load_dwordx4 v[220:223], v4, s[4:7], s65 offen offset:3072 sc1
    s_add_u32 s65, s65, 4096
    buffer_load_dwordx4 v[224:227], v4, s[4:7], s65 offen offset:0 sc1
    buffer_load_dwordx4 v[228:231], v4, s[4:7], s65 offen offset:1024 sc1
    s_waitcnt vmcnt(0)
    s_lshl_b32 s26, s24, 5
    s_add_u32 m0, s25, 0
    s_add_u32 s64, s26, 0x0
    buffer_load_dwordx4 v2, s[52:55], s64 offen lds
    s_add_u32 m0, s25, 1024
    s_add_u32 s64, s26, 0xa000
    buffer_load_dwordx4 v2, s[52:55], s64 offen lds
    s_add_u32 m0, s25, 2048
    s_add_u32 s64, s26, 0x14000
    buffer_load_dwordx4 v2, s[52:55], s64 offen lds
    s_add_u32 m0, s25, 3072
    s_add_u32 s64, s26, 0x1e000
    buffer_load_dwordx4 v2, s[52:55], s64 offen lds
    s_add_u32 m0, s25, 4096
    s_add_u32 s64, s26, 0x28000
    buffer_load_dwordx4 v2, s[52:55], s64 offen lds
    s_add_u32 m0, s25, 5120
    s_add_u32 s64, s26, 0x32000
    buffer_load_dwordx4 v2, s[52:55], s64 offen lds
    s_add_u32 m0, s25, 6144
    s_add_u32 s64, s26, 0x3c000
    buffer_load_dwordx4 v2, s[52:55], s64 offen lds
    s_add_u32 m0, s25, 7168
    s_add_u32 s64, s26, 0x46000
    buffer_load_dwordx4 v2, s[52:55], s64 offen lds
    s_add_u32 m0, s25, 8192
    s_add_u32 s64, s26, 0x50000
    buffer_load_dwordx4 v2, s[52:55], s64 offen lds
    s_add_u32 m0, s25, 9216
    s_add_u32 s64, s26, 0x5a000
    buffer_load_dwordx4 v2, s[52:55], s64 offen lds
    s_add_u32 m0, s25, 10240
    s_add_u32 s64, s26, 0x64000
    buffer_load_dwordx4 v2, s[52:55], s64 offen lds
    s_add_u32 m0, s25, 11264
    s_add_u32 s64, s26, 0x6e000
    buffer_load_dwordx4 v2, s[52:55], s64 offen lds
    s_add_u32 m0, s25, 12288
    s_add_u32 s64, s26, 0x78000
    buffer_load_dwordx4 v2, s[52:55], s64 offen lds
    s_add_u32 m0, s25, 13312
    s_add_u32 s64, s26, 0x82000
    buffer_load_dwordx4 v2, s[52:55], s64 offen lds
    s_add_u32 m0, s25, 14336
    s_add_u32 s64, s26, 0x8c000
    buffer_load_dwordx4 v2, s[52:55], s64 offen lds
    s_add_u32 m0, s25, 15360
    s_add_u32 s64, s26, 0x96000
    buffer_load_dwordx4 v2, s[52:55], s64 offen lds
    s_add_u32 m0, s25, 16384
    s_add_u32 s64, s26, 0xa0000
    buffer_load_dwordx4 v2, s[52:55], s64 offen lds
    s_add_u32 m0, s25, 17408
    s_add_u32 s64, s26, 0xaa000
    buffer_load_dwordx4 v2, s[52:55], s64 offen lds
    s_add_u32 m0, s25, 18432
    s_add_u32 s64, s26, 0xb4000
    buffer_load_dwordx4 v2, s[52:55], s64 offen lds
    s_add_u32 m0, s25, 19456
    s_add_u32 s64, s26, 0xbe000
    buffer_load_dwordx4 v2, s[52:55], s64 offen lds
    s_add_u32 m0, s25, 20480
    s_add_u32 s64, s26, 0xc8000
    buffer_load_dwordx4 v2, s[52:55], s64 offen lds
    s_add_u32 m0, s25, 21504
    s_add_u32 s64, s26, 0xd2000
    buffer_load_dwordx4 v2, s[52:55], s64 offen lds
    s_add_u32 m0, s25, 22528
    s_add_u32 s64, s26, 0xdc000
    buffer_load_dwordx4 v2, s[52:55], s64 offen lds
    s_add_u32 m0, s25, 23552
    s_add_u32 s64, s26, 0xe6000
    buffer_load_dwordx4 v2, s[52:55], s64 offen lds
    s_add_u32 m0, s25, 24576
    s_add_u32 s64, s26, 0xf0000
    buffer_load_dwordx4 v2, s[52:55], s64 offen lds
    s_add_u32 m0, s25, 25600
    s_add_u32 s64, s26, 0xfa000
    buffer_load_dwordx4 v2, s[52:55], s64 offen lds
    s_add_u32 m0, s25, 26624
    s_add_u32 s64, s26, 0x104000
    buffer_load_dwordx4 v2, s[52:55], s64 offen lds
    s_add_u32 m0, s25, 27648
    s_add_u32 s64, s26, 0x10e000
    buffer_load_dwordx4 v2, s[52:55], s64 offen lds
    s_add_u32 m0, s25, 28672
    s_add_u32 s64, s26, 0x118000
    buffer_load_dwordx4 v2, s[52:55], s64 offen lds
    s_add_u32 m0, s25, 29696
    s_add_u32 s64, s26, 0x122000
    buffer_load_dwordx4 v2, s[52:55], s64 offen lds
    s_add_u32 m0, s25, 30720
    s_add_u32 s64, s26, 0x12c000
    buffer_load_dwordx4 v2, s[52:55], s64 offen lds
    s_add_u32 m0, s25, 31744
    s_add_u32 s64, s26, 0x136000
    buffer_load_dwordx4 v2, s[52:55], s64 offen lds
    s_add_u32 m0, s25, 32768
    s_add_u32 s64, s26, 0x140000
    buffer_load_dwordx4 v2, s[52:55], s64 offen lds
    s_add_u32 m0, s25, 33792
    s_add_u32 s64, s26, 0x14a000
    buffer_load_dwordx4 v2, s[52:55], s64 offen lds
    s_add_u32 m0, s25, 34816
    s_add_u32 s64, s26, 0x154000
    buffer_load_dwordx4 v2, s[52:55], s64 offen lds
    s_add_u32 m0, s25, 35840
    s_add_u32 s64, s26, 0x15e000
    buffer_load_dwordx4 v2, s[52:55], s64 offen lds
    s_add_u32 m0, s25, 36864
    s_add_u32 s64, s26, 0x168000
    buffer_load_dwordx4 v2, s[52:55], s64 offen lds
    s_add_u32 m0, s25, 37888
    s_add_u32 s64, s26, 0x172000
    buffer_load_dwordx4 v2, s[52:55], s64 offen lds
    s_add_u32 m0, s25, 38912
    s_add_u32 s64, s26, 0x17c000
    buffer_load_dwordx4 v2, s[52:55], s64 offen lds
    s_add_u32 m0, s25, 39936
    s_add_u32 s64, s26, 0x186000
    buffer_load_dwordx4 v2, s[52:55], s64 offen lds
    s_add_u32 m0, s25, 40960
    s_add_u32 s64, s26, 0x190000
    buffer_load_dwordx4 v2, s[52:55], s64 offen lds
    s_waitcnt vmcnt(20)
    s_add_u32 m0, s25, 41984
    s_add_u32 s64, s26, 0x19a000
    buffer_load_dwordx4 v2, s[52:55], s64 offen lds
    s_add_u32 m0, s25, 43008
    s_add_u32 s64, s26, 0x1a4000
    buffer_load_dwordx4 v2, s[52:55], s64 offen lds
    s_add_u32 m0, s25, 44032
    s_add_u32 s64, s26, 0x1ae000
    buffer_load_dwordx4 v2, s[52:55], s64 offen lds
    s_add_u32 m0, s25, 45056
    s_add_u32 s64, s26, 0x1b8000
    buffer_load_dwordx4 v2, s[52:55], s64 offen lds
    s_add_u32 m0, s25, 46080
    s_add_u32 s64, s26, 0x1c2000
    buffer_load_dwordx4 v2, s[52:55], s64 offen lds
    s_add_u32 m0, s25, 47104
    s_add_u32 s64, s26, 0x1cc000
    buffer_load_dwordx4 v2, s[52:55], s64 offen lds
    s_add_u32 m0, s25, 48128
    s_add_u32 s64, s26, 0x1d6000
    buffer_load_dwordx4 v2, s[52:55], s64 offen lds
    s_add_u32 m0, s25, 49152
    s_add_u32 s64, s26, 0x1e0000
    buffer_load_dwordx4 v2, s[52:55], s64 offen lds
    s_add_u32 m0, s25, 50176
    s_add_u32 s64, s26, 0x1ea000
    buffer_load_dwordx4 v2, s[52:55], s64 offen lds
    s_add_u32 m0, s25, 51200
    s_add_u32 s64, s26, 0x1f4000
    buffer_load_dwordx4 v2, s[52:55], s64 offen lds
    s_add_u32 m0, s25, 52224
    s_add_u32 s64, s26, 0x1fe000
    buffer_load_dwordx4 v2, s[52:55], s64 offen lds
    s_add_u32 m0, s25, 53248
    s_add_u32 s64, s26, 0x208000
    buffer_load_dwordx4 v2, s[52:55], s64 offen lds
    s_add_u32 m0, s25, 54272
    s_add_u32 s64, s26, 0x212000
    buffer_load_dwordx4 v2, s[52:55], s64 offen lds
    s_waitcnt vmcnt(0)
    ds_read_b64_tr_b16 v[232:233], v3 offset:0
    ds_read_b64_tr_b16 v[234:235], v3 offset:512
    s_waitcnt lgkmcnt(0)
    v_mfma_f32_16x16x32_bf16 v[8:11], v[232:235], v[16:19], 0
    ds_read_b64_tr_b16 v[236:237], v3 offset:1024
    ds_read_b64_tr_b16 v[238:239], v3 offset:1536
    s_waitcnt lgkmcnt(0)
    v_mfma_f32_16x16x32_bf16 v[8:11], v[236:239], v[20:23], v[8:11]
    ds_read_b64_tr_b16 v[240:241], v3 offset:2048
    ds_read_b64_tr_b16 v[242:243], v3 offset:2560
    s_waitcnt lgkmcnt(0)
    v_mfma_f32_16x16x32_bf16 v[8:11], v[240:243], v[24:27], v[8:11]
    ds_read_b64_tr_b16 v[244:245], v3 offset:3072
    ds_read_b64_tr_b16 v[246:247], v3 offset:3584
    s_waitcnt lgkmcnt(0)
    v_mfma_f32_16x16x32_bf16 v[8:11], v[244:247], v[28:31], v[8:11]
    ds_read_b64_tr_b16 v[232:233], v3 offset:4096
    ds_read_b64_tr_b16 v[234:235], v3 offset:4608
    s_waitcnt lgkmcnt(0)
    v_mfma_f32_16x16x32_bf16 v[8:11], v[232:235], v[32:35], v[8:11]
    ds_read_b64_tr_b16 v[236:237], v3 offset:5120
    ds_read_b64_tr_b16 v[238:239], v3 offset:5632
    s_waitcnt lgkmcnt(0)
    v_mfma_f32_16x16x32_bf16 v[8:11], v[236:239], v[36:39], v[8:11]
    ds_read_b64_tr_b16 v[240:241], v3 offset:6144
    ds_read_b64_tr_b16 v[242:243], v3 offset:6656
    s_waitcnt lgkmcnt(0)
    v_mfma_f32_16x16x32_bf16 v[8:11], v[240:243], v[40:43], v[8:11]
    ds_read_b64_tr_b16 v[244:245], v3 offset:7168
    ds_read_b64_tr_b16 v[246:247], v3 offset:7680
    s_waitcnt lgkmcnt(0)
    v_mfma_f32_16x16x32_bf16 v[8:11], v[244:247], v[44:47], v[8:11]
    ds_read_b64_tr_b16 v[232:233], v3 offset:8192
    ds_read_b64_tr_b16 v[234:235], v3 offset:8704
    s_waitcnt lgkmcnt(0)
    v_mfma_f32_16x16x32_bf16 v[8:11], v[232:235], v[48:51], v[8:11]
    ds_read_b64_tr_b16 v[236:237], v3 offset:9216
    ds_read_b64_tr_b16 v[238:239], v3 offset:9728
    s_waitcnt lgkmcnt(0)
    v_mfma_f32_16x16x32_bf16 v[8:11], v[236:239], v[52:55], v[8:11]
    ds_read_b64_tr_b16 v[240:241], v3 offset:10240
    ds_read_b64_tr_b16 v[242:243], v3 offset:10752
    s_waitcnt lgkmcnt(0)
    v_mfma_f32_16x16x32_bf16 v[8:11], v[240:243], v[56:59], v[8:11]
    ds_read_b64_tr_b16 v[244:245], v3 offset:11264
    ds_read_b64_tr_b16 v[246:247], v3 offset:11776
    s_waitcnt lgkmcnt(0)
    v_mfma_f32_16x16x32_bf16 v[8:11], v[244:247], v[60:63], v[8:11]
    ds_read_b64_tr_b16 v[232:233], v3 offset:12288
    ds_read_b64_tr_b16 v[234:235], v3 offset:12800
    s_waitcnt lgkmcnt(0)
    v_mfma_f32_16x16x32_bf16 v[8:11], v[232:235], v[64:67], v[8:11]
    ds_read_b64_tr_b16 v[236:237], v3 offset:13312
    ds_read_b64_tr_b16 v[238:239], v3 offset:13824
    s_waitcnt lgkmcnt(0)
    v_mfma_f32_16x16x32_bf16 v[8:11], v[236:239], v[68:71], v[8:11]
    ds_read_b64_tr_b16 v[240:241], v3 offset:14336
    ds_read_b64_tr_b16 v[242:243], v3 offset:14848
    s_waitcnt lgkmcnt(0)
    v_mfma_f32_16x16x32_bf16 v[8:11], v[240:243], v[72:75], v[8:11]
    ds_read_b64_tr_b16 v[244:245], v3 offset:15360
    ds_read_b64_tr_b16 v[246:247], v3 offset:15872
    s_waitcnt lgkmcnt(0)
    v_mfma_f32_16x16x32_bf16 v[8:11], v[244:247], v[76:79], v[8:11]
    ds_read_b64_tr_b16 v[232:233], v3 offset:16384
    ds_read_b64_tr_b16 v[234:235], v3 offset:16896
    s_waitcnt lgkmcnt(0)
    v_mfma_f32_16x16x32_bf16 v[8:11], v[232:235], v[80:83], v[8:11]
    ds_read_b64_tr_b16 v[236:237], v3 offset:17408
    ds_read_b64_tr_b16 v[238:239], v3 offset:17920
    s_waitcnt lgkmcnt(0)
    v_mfma_f32_16x16x32_bf16 v[8:11], v[236:239], v[84:87], v[8:11]
    ds_read_b64_tr_b16 v[240:241], v3 offset:18432
    ds_read_b64_tr_b16 v[242:243], v3 offset:18944
    s_waitcnt lgkmcnt(0)
    v_mfma_f32_16x16x32_bf16 v[8:11], v[240:243], v[88:91], v[8:11]
    ds_read_b64_tr_b16 v[244:245], v3 offset:19456
    ds_read_b64_tr_b16 v[246:247], v3 offset:19968
    s_waitcnt lgkmcnt(0)
    v_mfma_f32_16x16x32_bf16 v[8:11], v[244:247], v[92:95], v[8:11]
    ds_read_b64_tr_b16 v[232:233], v3 offset:20480
    ds_read_b64_tr_b16 v[234:235], v3 offset:20992
    s_waitcnt lgkmcnt(0)
    v_mfma_f32_16x16x32_bf16 v[8:11], v[232:235], v[96:99], v[8:11]
    ds_read_b64_tr_b16 v[236:237], v3 offset:21504
    ds_read_b64_tr_b16 v[238:239], v3 offset:22016
    s_waitcnt lgkmcnt(0)
    v_mfma_f32_16x16x32_bf16 v[8:11], v[236:239], v[100:103], v[8:11]
    ds_read_b64_tr_b16 v[240:241], v3 offset:22528
    ds_read_b64_tr_b16 v[242:243], v3 offset:23040
    s_waitcnt lgkmcnt(0)
    v_mfma_f32_16x16x32_bf16 v[8:11], v[240:243], v[104:107], v[8:11]
    ds_read_b64_tr_b16 v[244:245], v3 offset:23552
    ds_read_b64_tr_b16 v[246:247], v3 offset:24064
    s_waitcnt lgkmcnt(0)
    v_mfma_f32_16x16x32_bf16 v[8:11], v[244:247], v[108:111], v[8:11]
    ds_read_b64_tr_b16 v[232:233], v3 offset:24576
    ds_read_b64_tr_b16 v[234:235], v3 offset:25088
    s_waitcnt lgkmcnt(0)
    v_mfma_f32_16x16x32_bf16 v[8:11], v[232:235], v[112:115], v[8:11]
    ds_read_b64_tr_b16 v[236:237], v3 offset:25600
    ds_read_b64_tr_b16 v[238:239], v3 offset:26112
    s_waitcnt lgkmcnt(0)
    v_mfma_f32_16x16x32_bf16 v[8:11], v[236:239], v[116:119], v[8:11]
    ds_read_b64_tr_b16 v[240:241], v3 offset:26624
    ds_read_b64_tr_b16 v[242:243], v3 offset:27136
    s_waitcnt lgkmcnt(0)
    v_mfma_f32_16x16x32_bf16 v[8:11], v[240:243], v[120:123], v[8:11]
    ds_read_b64_tr_b16 v[244:245], v3 offset:27648
    ds_read_b64_tr_b16 v[246:247], v3 offset:28160
    s_waitcnt lgkmcnt(0)
    v_mfma_f32_16x16x32_bf16 v[8:11], v[244:247], v[124:127], v[8:11]
    ds_read_b64_tr_b16 v[232:233], v3 offset:28672
    ds_read_b64_tr_b16 v[234:235], v3 offset:29184
    s_waitcnt lgkmcnt(0)
    v_mfma_f32_16x16x32_bf16 v[8:11], v[232:235], v[128:131], v[8:11]
    ds_read_b64_tr_b16 v[236:237], v3 offset:29696
    ds_read_b64_tr_b16 v[238:239], v3 offset:30208
    s_waitcnt lgkmcnt(0)
    v_mfma_f32_16x16x32_bf16 v[8:11], v[236:239], v[132:135], v[8:11]
    ds_read_b64_tr_b16 v[240:241], v3 offset:30720
    ds_read_b64_tr_b16 v[242:243], v3 offset:31232
    s_waitcnt lgkmcnt(0)
    v_mfma_f32_16x16x32_bf16 v[8:11], v[240:243], v[136:139], v[8:11]
    ds_read_b64_tr_b16 v[244:245], v3 offset:31744
    ds_read_b64_tr_b16 v[246:247], v3 offset:32256
    s_waitcnt lgkmcnt(0)
    v_mfma_f32_16x16x32_bf16 v[8:11], v[244:247], v[140:143], v[8:11]
    ds_read_b64_tr_b16 v[232:233], v3 offset:32768
    ds_read_b64_tr_b16 v[234:235], v3 offset:33280
    s_waitcnt lgkmcnt(0)
    v_mfma_f32_16x16x32_bf16 v[8:11], v[232:235], v[144:147], v[8:11]
    ds_read_b64_tr_b16 v[236:237], v3 offset:33792
    ds_read_b64_tr_b16 v[238:239], v3 offset:34304
    s_waitcnt lgkmcnt(0)
    v_mfma_f32_16x16x32_bf16 v[8:11], v[236:239], v[148:151], v[8:11]
    ds_read_b64_tr_b16 v[240:241], v3 offset:34816
    ds_read_b64_tr_b16 v[242:243], v3 offset:35328
    s_waitcnt lgkmcnt(0)
    v_mfma_f32_16x16x32_bf16 v[8:11], v[240:243], v[152:155], v[8:11]
    ds_read_b64_tr_b16 v[244:245], v3 offset:35840
    ds_read_b64_tr_b16 v[246:247], v3 offset:36352
    s_waitcnt lgkmcnt(0)
    v_mfma_f32_16x16x32_bf16 v[8:11], v[244:247], v[156:159], v[8:11]
    ds_read_b64_tr_b16 v[232:233], v3 offset:36864
    ds_read_b64_tr_b16 v[234:235], v3 offset:37376
    s_waitcnt lgkmcnt(0)
    v_mfma_f32_16x16x32_bf16 v[8:11], v[232:235], v[160:163], v[8:11]
    ds_read_b64_tr_b16 v[236:237], v3 offset:37888
    ds_read_b64_tr_b16 v[238:239], v3 offset:38400
    s_waitcnt lgkmcnt(0)
    v_mfma_f32_16x16x32_bf16 v[8:11], v[236:239], v[164:167], v[8:11]
    ds_read_b64_tr_b16 v[240:241], v3 offset:38912
    ds_read_b64_tr_b16 v[242:243], v3 offset:39424
    s_waitcnt lgkmcnt(0)
    v_mfma_f32_16x16x32_bf16 v[8:11], v[240:243], v[168:171], v[8:11]
    ds_read_b64_tr_b16 v[244:245], v3 offset:39936
    ds_read_b64_tr_b16 v[246:247], v3 offset:40448
    s_waitcnt lgkmcnt(0)
    v_mfma_f32_16x16x32_bf16 v[8:11], v[244:247], v[172:175], v[8:11]
    ds_read_b64_tr_b16 v[232:233], v3 offset:40960
    ds_read_b64_tr_b16 v[234:235], v3 offset:41472
    s_waitcnt lgkmcnt(0)
    v_mfma_f32_16x16x32_bf16 v[8:11], v[232:235], v[176:179], v[8:11]
    ds_read_b64_tr_b16 v[236:237], v3 offset:41984
    ds_read_b64_tr_b16 v[238:239], v3 offset:42496
    s_waitcnt lgkmcnt(0)
    v_mfma_f32_16x16x32_bf16 v[8:11], v[236:239], v[180:183], v[8:11]
    ds_read_b64_tr_b16 v[240:241], v3 offset:43008
    ds_read_b64_tr_b16 v[242:243], v3 offset:43520
    s_waitcnt lgkmcnt(0)
    v_mfma_f32_16x16x32_bf16 v[8:11], v[240:243], v[184:187], v[8:11]
    ds_read_b64_tr_b16 v[244:245], v3 offset:44032
    ds_read_b64_tr_b16 v[246:247], v3 offset:44544
    s_waitcnt lgkmcnt(0)
    v_mfma_f32_16x16x32_bf16 v[8:11], v[244:247], v[188:191], v[8:11]
    ds_read_b64_tr_b16 v[232:233], v3 offset:45056
    ds_read_b64_tr_b16 v[234:235], v3 offset:45568
    s_waitcnt lgkmcnt(0)
    v_mfma_f32_16x16x32_bf16 v[8:11], v[232:235], v[192:195], v[8:11]
    ds_read_b64_tr_b16 v[236:237], v3 offset:46080
    ds_read_b64_tr_b16 v[238:239], v3 offset:46592
    s_waitcnt lgkmcnt(0)
    v_mfma_f32_16x16x32_bf16 v[8:11], v[236:239], v[196:199], v[8:11]
    ds_read_b64_tr_b16 v[240:241], v3 offset:47104
    ds_read_b64_tr_b16 v[242:243], v3 offset:47616
    s_waitcnt lgkmcnt(0)
    v_mfma_f32_16x16x32_bf16 v[8:11], v[240:243], v[200:203], v[8:11]
    ds_read_b64_tr_b16 v[244:245], v3 offset:48128
    ds_read_b64_tr_b16 v[246:247], v3 offset:48640
    s_waitcnt lgkmcnt(0)
    v_mfma_f32_16x16x32_bf16 v[8:11], v[244:247], v[204:207], v[8:11]
    ds_read_b64_tr_b16 v[232:233], v3 offset:49152
    ds_read_b64_tr_b16 v[234:235], v3 offset:49664
    s_waitcnt lgkmcnt(0)
    v_mfma_f32_16x16x32_bf16 v[8:11], v[232:235], v[208:211], v[8:11]
    ds_read_b64_tr_b16 v[236:237], v3 offset:50176
    ds_read_b64_tr_b16 v[238:239], v3 offset:50688
    s_waitcnt lgkmcnt(0)
    v_mfma_f32_16x16x32_bf16 v[8:11], v[236:239], v[212:215], v[8:11]
    ds_read_b64_tr_b16 v[240:241], v3 offset:51200
    ds_read_b64_tr_b16 v[242:243], v3 offset:51712
    s_waitcnt lgkmcnt(0)
    v_mfma_f32_16x16x32_bf16 v[8:11], v[240:243], v[216:219], v[8:11]
    ds_read_b64_tr_b16 v[244:245], v3 offset:52224
    ds_read_b64_tr_b16 v[246:247], v3 offset:52736
    s_waitcnt lgkmcnt(0)
    v_mfma_f32_16x16x32_bf16 v[8:11], v[244:247], v[220:223], v[8:11]
    ds_read_b64_tr_b16 v[232:233], v3 offset:53248
    ds_read_b64_tr_b16 v[234:235], v3 offset:53760
    s_waitcnt lgkmcnt(0)
    v_mfma_f32_16x16x32_bf16 v[8:11], v[232:235], v[224:227], v[8:11]
    ds_read_b64_tr_b16 v[236:237], v3 offset:54272
    ds_read_b64_tr_b16 v[238:239], v3 offset:54784
    s_waitcnt lgkmcnt(0)
    v_mfma_f32_16x16x32_bf16 v[8:11], v[236:239], v[228:231], v[8:11]
    v_and_b32 v7, 7, v0
    v_lshlrev_b32 v7, 2, v7
    s_mov_b32 s64, 0x5400020
    buffer_load_dword v12, v7, s[4:7], s64 offen sc1
    s_waitcnt vmcnt(0)
    s_nop 7
    v_cvt_pk_bf16_f32 v8, v8, v8
    v_lshlrev_b32 v8, 16, v8
    v_mul_f32 v8, v8, v12
    v_cvt_pk_bf16_f32 v8, v8, v8
    v_lshlrev_b32 v8, 16, v8
    v_cvt_pk_bf16_f32 v9, v9, v9
    v_lshlrev_b32 v9, 16, v9
    v_mul_f32 v9, v9, v12
    v_cvt_pk_bf16_f32 v9, v9, v9
    v_lshlrev_b32 v9, 16, v9
    v_cvt_pk_bf16_f32 v10, v10, v10
    v_lshlrev_b32 v10, 16, v10
    v_mul_f32 v10, v10, v12
    v_cvt_pk_bf16_f32 v10, v10, v10
    v_lshlrev_b32 v10, 16, v10
    v_cvt_pk_bf16_f32 v11, v11, v11
    v_lshlrev_b32 v11, 16, v11
    v_mul_f32 v11, v11, v12
    v_cvt_pk_bf16_f32 v11, v11, v11
    v_lshlrev_b32 v11, 16, v11
    v_and_b32 v7, 7, v0
    v_mul_u32_u24 v7, 2560, v7
    v_lshrrev_b32 v13, 4, v0
    v_lshl_add_u32 v7, v13, 4, v7
    s_lshl_b32 s64, s24, 6
    s_add_u32 s64, s64, 0x5410000
    s_mov_b32 s68, 0x00ff00ff
    s_mov_b32 s69, 0x00ff00ff
    s_mov_b64 exec, s[68:69]
    buffer_store_dwordx4 v[8:11], v7, s[4:7], s64 offen sc1
    s_mov_b64 exec, -1
    s_waitcnt vmcnt(0)
    v_mov_b32 v7, 1
    v_mov_b32 v8, 0
    s_mov_b32 s64, 0x298100
    s_mov_b64 exec, 1
    buffer_atomic_add v7, v8, s[4:7], s64 offen sc1
    s_mov_b64 exec, -1
H_ATT:
    v_mbcnt_lo_u32_b32 v0, -1, 0
    v_mbcnt_hi_u32_b32 v0, -1, v0
    s_mov_b32 s29, 0
    v_lshlrev_b32 v1, 4, v0
    v_lshrrev_b32 v5, 4, v0
    v_lshlrev_b32 v2, 7, v5
    v_and_b32 v5, 7, v0
    v_lshl_add_u32 v2, v5, 4, v2
    v_bfe_u32 v5, v0, 4, 1
    v_lshlrev_b32 v3, 7, v5
    v_and_b32 v5, 15, v0
    v_lshl_add_u32 v3, v5, 3, v3
    s_mov_b32 s34, 0x3e0293ee
    s_mov_b32 s35, 0x3e0293ee
    s_mov_b32 s36, -1
    s_mov_b32 s37, 0
    v_lshrrev_b32 v5, 4, v0
    v_lshlrev_b32 v5, 2, v5
    v_and_b32 v6, 15, v0
    v_add_u32 v7, 0, v5
    v_cmp_le_u32 s[38:39], v7, v6
    v_add_u32 v7, 1, v5
    v_cmp_le_u32 s[40:41], v7, v6
    v_add_u32 v7, 2, v5
    v_cmp_le_u32 s[42:43], v7, v6
    v_add_u32 v7, 3, v5
    v_cmp_le_u32 s[44:45], v7, v6
    v_mov_b32 v248, 0x3f803f80
    v_mov_b32 v249, 0x3f803f80
    v_mov_b32 v250, 0x3f803f80
    v_mov_b32 v251, 0x3f803f80
    s_lshl_b32 s24, s12, 2
    s_add_u32 s24, s24, s14
    s_add_u32 s24, s24, 16
    s_mov_b32 s25, 2
AT2_LOOP:
    s_cmp_eq_u32 s24, 63
    s_cbranch_scc1 AT2_END
    s_lshl_b32 s64, s24, 5
    s_add_u32 s64, s64, s13
    s_lshl_b32 s26, s64, 13
    s_add_u32 s26, s26, 0x3400000
    s_lshl_b32 s27, s64, 14
    s_add_u32 s27, s27, 0x1400000
    s_lshl_b32 s65, s64, 11
    s_add_u32 s30, s65, 0x640000
    s_add_u32 s31, s65, 0xa40000
    s_lshl_b32 s33, s64, 2
    s_add_u32 s33, s33, 0x296000
    s_lshl_b32 s32, s24, 18
    s_lshl_b32 s65, s13, 12
    s_add_u32 s32, s32, s65
    s_add_u32 s32, s32, 0x4400000
    s_lshr_b32 s65, s24, 2
    s_lshl_b32 s65, s65, 9
    s_lshl_b32 s66, s13, 4
    s_add_u32 s65, s65, s66
    s_add_u32 s65, s65, 0x291000
    s_lshr_b32 s66, s24, 1
    s_lshl_b32 s66, s66, 8
    s_lshl_b32 s64, s13, 3
    s_add_u32 s66, s66, s64
    s_add_u32 s66, s66, 0x293ff4
    v_lshlrev_b32 v5, 2, v0
    v_mov_b32 v6, s65
    v_mov_b32 v7, s66
    v_cmp_gt_u32 vcc, 3, v0
    s_nop 1
    v_cndmask_b32 v6, v7, v6, vcc
    v_add_u32 v4, v5, v6
    s_mov_b32 s64, 0
    s_mov_b64 exec, 7
AT2_F_183:
    buffer_load_dword v5, v4, s[4:7], s64 offen sc1
    s_add_u32 s29, s29, 1
    s_waitcnt vmcnt(0)
    v_cmp_eq_u32 vcc, 0, v5
    s_cbranch_vccz AT2_FD_184
    s_cmp_gt_u32 s29, 262144
    s_cbranch_scc1 AT2_FD_184
    s_sleep 1
    s_branch AT2_F_183
AT2_FD_184:
    s_mov_b64 exec, -1
    buffer_load_dwordx4 v[16:19], v1, s[4:7], s26 offen offset:0
    buffer_load_dwordx4 v[20:23], v1, s[4:7], s26 offen offset:1024
    buffer_load_dwordx4 v[24:27], v1, s[4:7], s26 offen offset:2048
    buffer_load_dwordx4 v[28:31], v1, s[4:7], s26 offen offset:3072
    s_add_u32 s26, s26, 4096
    buffer_load_dwordx4 v[32:35], v1, s[4:7], s26 offen offset:0
    buffer_load_dwordx4 v[36:39], v1, s[4:7], s26 offen offset:1024
    buffer_load_dwordx4 v[40:43], v1, s[4:7], s26 offen offset:2048
    buffer_load_dwordx4 v[44:47], v1, s[4:7], s26 offen offset:3072
    buffer_load_dwordx4 v[48:51], v1, s[4:7], s27 offen offset:0
    buffer_load_dwordx4 v[52:55], v1, s[4:7], s27 offen offset:1024
    buffer_load_dwordx4 v[56:59], v1, s[4:7], s27 offen offset:2048
    buffer_load_dwordx4 v[60:63], v1, s[4:7], s27 offen offset:3072
    s_add_u32 s27, s27, 4096
    buffer_load_dwordx4 v[64:67], v1, s[4:7], s27 offen offset:0
    buffer_load_dwordx4 v[68:71], v1, s[4:7], s27 offen offset:1024
    buffer_load_dwordx4 v[72:75], v1, s[4:7], s27 offen offset:2048
    buffer_load_dwordx4 v[76:79], v1, s[4:7], s27 offen offset:3072
    s_add_u32 s27, s27, 4096
    buffer_load_dwordx4 v[80:83], v1, s[4:7], s27 offen offset:0
    buffer_load_dwordx4 v[84:87], v1, s[4:7], s27 offen offset:1024
    buffer_load_dwordx4 v[88:91], v1, s[4:7], s27 offen offset:2048
    buffer_load_dwordx4 v[92:95], v1, s[4:7], s27 offen offset:3072
    s_add_u32 s27, s27, 4096
    buffer_load_dwordx4 v[96:99], v1, s[4:7], s27 offen offset:0
    buffer_load_dwordx4 v[100:103], v1, s[4:7], s27 offen offset:1024
    buffer_load_dwordx4 v[104:107], v1, s[4:7], s27 offen offset:2048
    buffer_load_dwordx4 v[108:111], v1, s[4:7], s27 offen offset:3072
    s_mov_b64 exec, 0x18
AT2_G_185:
    buffer_load_dword v5, v4, s[4:7], s64 offen sc1
    s_add_u32 s29, s29, 1
    s_waitcnt vmcnt(0)
    v_cmp_eq_u32 vcc, 0, v5
    s_cbranch_vccz AT2_GD_186
    s_cmp_gt_u32 s29, 262144
    s_cbranch_scc1 AT2_GD_186
    s_sleep 1
    s_branch AT2_G_185
AT2_GD_186:
    s_mov_b64 exec, -1
    buffer_load_dwordx4 v[112:115], v2, s[4:7], s30 offen offset:0
    buffer_load_dwordx4 v[116:119], v2, s[4:7], s30 offen offset:512
    buffer_load_dwordx4 v[120:123], v2, s[4:7], s30 offen offset:1024
    buffer_load_dwordx4 v[124:127], v2, s[4:7], s30 offen offset:1536
    buffer_load_dwordx2 v[128:129], v3, s[4:7], s31 offen offset:0
    buffer_load_dwordx2 v[130:131], v3, s[4:7], s31 offen offset:256
    buffer_load_dwordx2 v[132:133], v3, s[4:7], s31 offen offset:512
    buffer_load_dwordx2 v[134:135], v3, s[4:7], s31 offen offset:768
    buffer_load_dwordx2 v[136:137], v3, s[4:7], s31 offen offset:1024
    buffer_load_dwordx2 v[138:139], v3, s[4:7], s31 offen offset:1280
    buffer_load_dwordx2 v[140:141], v3, s[4:7], s31 offen offset:1536
    buffer_load_dwordx2 v[142:143], v3, s[4:7], s31 offen offset:1792
    v_mfma_f32_16x16x32_bf16 v[148:151], v[48:51], v[16:19], 0
    v_mfma_f32_16x16x32_bf16 v[156:159], v[48:51], v[32:35], 0
    v_mfma_f32_16x16x32_bf16 v[160:163], v[64:67], v[32:35], 0
    v_mfma_f32_16x16x32_bf16 v[148:151], v[52:55], v[20:23], v[148:151]
    v_mfma_f32_16x16x32_bf16 v[156:159], v[52:55], v[36:39], v[156:159]
    v_mfma_f32_16x16x32_bf16 v[160:163], v[68:71], v[36:39], v[160:163]
    v_mfma_f32_16x16x32_bf16 v[148:151], v[56:59], v[24:27], v[148:151]
    v_mfma_f32_16x16x32_bf16 v[156:159], v[56:59], v[40:43], v[156:159]
    v_mfma_f32_16x16x32_bf16 v[160:163], v[72:75], v[40:43], v[160:163]
    v_mfma_f32_16x16x32_bf16 v[148:151], v[60:63], v[28:31], v[148:151]
    v_mfma_f32_16x16x32_bf16 v[156:159], v[60:63], v[44:47], v[156:159]
    v_mfma_f32_16x16x32_bf16 v[160:163], v[76:79], v[44:47], v[160:163]
    s_waitcnt vmcnt(8)
    v_mfma_f32_16x16x32_bf16 v[144:147], v[112:115], v[16:19], 0
    v_mfma_f32_16x16x32_bf16 v[152:155], v[112:115], v[32:35], 0
    v_mfma_f32_16x16x32_bf16 v[144:147], v[116:119], v[20:23], v[144:147]
    v_mfma_f32_16x16x32_bf16 v[152:155], v[116:119], v[36:39], v[152:155]
    v_mfma_f32_16x16x32_bf16 v[144:147], v[120:123], v[24:27], v[144:147]
    v_mfma_f32_16x16x32_bf16 v[152:155], v[120:123], v[40:43], v[152:155]
    v_mfma_f32_16x16x32_bf16 v[144:147], v[124:127], v[28:31], v[144:147]
    v_mfma_f32_16x16x32_bf16 v[152:155], v[124:127], v[44:47], v[152:155]
    v_mov_b32 v11, 0xff800000
    s_nop 7
    v_cndmask_b32 v148, v11, v148, s[38:39]
    v_cndmask_b32 v160, v11, v160, s[38:39]
    v_cndmask_b32 v144, v11, v144, s[36:37]
    v_cndmask_b32 v152, v11, v152, s[36:37]
    v_cndmask_b32 v149, v11, v149, s[40:41]
    v_cndmask_b32 v161, v11, v161, s[40:41]
    v_cndmask_b32 v145, v11, v145, s[36:37]
    v_cndmask_b32 v153, v11, v153, s[36:37]
    v_cndmask_b32 v150, v11, v150, s[42:43]
    v_cndmask_b32 v162, v11, v162, s[42:43]
    v_cndmask_b32 v146, v11, v146, s[36:37]
    v_cndmask_b32 v154, v11, v154, s[36:37]
    v_cndmask_b32 v151, v11, v151, s[44:45]
    v_cndmask_b32 v163, v11, v163, s[44:45]
    v_cndmask_b32 v147, v11, v147, s[36:37]
    v_cndmask_b32 v155, v11, v155, s[36:37]
    v_max3_f32 v8, v144, v145, v146
    v_max3_f32 v8, v8, v147, v148
    v_max3_f32 v8, v8, v149, v150
    v_max_f32 v8, v8, v151
    v_mov_b32 v9, v8
    s_nop 1
    v_permlane16_swap_b32 v8, v9
    v_max_f32 v8, v8, v9
    v_mov_b32 v9, v8
    s_nop 1
    v_permlane32_swap_b32 v8, v9
    v_max_f32 v8, v8, v9
    v_mul_f32 v8, s34, v8
    v_fma_f32 v144, v144, s34, -v8
    v_fma_f32 v145, v145, s34, -v8
    v_fma_f32 v146, v146, s34, -v8
    v_fma_f32 v147, v147, s34, -v8
    v_fma_f32 v148, v148, s34, -v8
    v_fma_f32 v149, v149, s34, -v8
    v_fma_f32 v150, v150, s34, -v8
    v_fma_f32 v151, v151, s34, -v8
    v_exp_f32 v144, v144
    v_exp_f32 v145, v145
    v_exp_f32 v146, v146
    v_exp_f32 v147, v147
    v_exp_f32 v148, v148
    v_exp_f32 v149, v149
    v_exp_f32 v150, v150
    v_exp_f32 v151, v151
    s_nop 0
    v_cvt_pk_bf16_f32 v164, v148, v149
    v_cvt_pk_bf16_f32 v165, v150, v151
    v_mov_b32 v166, 0
    v_mov_b32 v167, 0
    v_cvt_pk_bf16_f32 v168, v144, v145
    v_cvt_pk_bf16_f32 v169, v146, v147
    v_max3_f32 v8, v152, v153, v154
    v_max3_f32 v8, v8, v155, v156
    v_max3_f32 v8, v8, v157, v158
    v_max3_f32 v8, v8, v159, v160
    v_max3_f32 v8, v8, v161, v162
    v_max_f32 v8, v8, v163
    v_mov_b32 v9, v8
    s_nop 1
    v_permlane16_swap_b32 v8, v9
    v_max_f32 v8, v8, v9
    v_mov_b32 v9, v8
    s_nop 1
    v_permlane32_swap_b32 v8, v9
    v_max_f32 v8, v8, v9
    v_mul_f32 v8, s34, v8
    v_fma_f32 v152, v152, s34, -v8
    v_fma_f32 v153, v153, s34, -v8
    v_fma_f32 v154, v154, s34, -v8
    v_fma_f32 v155, v155, s34, -v8
    v_fma_f32 v156, v156, s34, -v8
    v_fma_f32 v157, v157, s34, -v8
    v_fma_f32 v158, v158, s34, -v8
    v_fma_f32 v159, v159, s34, -v8
    v_fma_f32 v160, v160, s34, -v8
    v_fma_f32 v161, v161, s34, -v8
    v_fma_f32 v162, v162, s34, -v8
    v_fma_f32 v163, v163, s34, -v8
    v_exp_f32 v152, v152
    v_exp_f32 v153, v153
    v_exp_f32 v154, v154
    v_exp_f32 v155, v155
    v_exp_f32 v156, v156
    v_exp_f32 v157, v157
    v_exp_f32 v158, v158
    v_exp_f32 v159, v159
    v_exp_f32 v160, v160
    v_exp_f32 v161, v161
    v_exp_f32 v162, v162
    v_exp_f32 v163, v163
    s_nop 0
    v_cvt_pk_bf16_f32 v170, v156, v157
    v_cvt_pk_bf16_f32 v171, v158, v159
    v_cvt_pk_bf16_f32 v172, v160, v161
    v_cvt_pk_bf16_f32 v173, v162, v163
    v_cvt_pk_bf16_f32 v174, v152, v153
    v_cvt_pk_bf16_f32 v175, v154, v155
    s_waitcnt vmcnt(0)
    v_mfma_f32_16x16x32_bf16 v[240:243], v[248:251], v[164:167], 0
    v_mfma_f32_16x16x32_bf16 v[244:247], v[248:251], v[170:173], 0
    v_mfma_f32_16x16x32_bf16 v[176:179], v[80:83], v[164:167], 0
    v_mfma_f32_16x16x32_bf16 v[180:183], v[80:83], v[170:173], 0
    v_mfma_f32_16x16x32_bf16 v[184:187], v[84:87], v[164:167], 0
    v_mfma_f32_16x16x32_bf16 v[188:191], v[84:87], v[170:173], 0
    v_mfma_f32_16x16x32_bf16 v[192:195], v[88:91], v[164:167], 0
    v_mfma_f32_16x16x32_bf16 v[196:199], v[88:91], v[170:173], 0
    v_mfma_f32_16x16x32_bf16 v[200:203], v[92:95], v[164:167], 0
    v_mfma_f32_16x16x32_bf16 v[204:207], v[92:95], v[170:173], 0
    v_mfma_f32_16x16x32_bf16 v[208:211], v[96:99], v[164:167], 0
    v_mfma_f32_16x16x32_bf16 v[212:215], v[96:99], v[170:173], 0
    v_mfma_f32_16x16x32_bf16 v[216:219], v[100:103], v[164:167], 0
    v_mfma_f32_16x16x32_bf16 v[220:223], v[100:103], v[170:173], 0
    v_mfma_f32_16x16x32_bf16 v[224:227], v[104:107], v[164:167], 0
    v_mfma_f32_16x16x32_bf16 v[228:231], v[104:107], v[170:173], 0
    v_mfma_f32_16x16x32_bf16 v[232:235], v[108:111], v[164:167], 0
    v_mfma_f32_16x16x32_bf16 v[236:239], v[108:111], v[170:173], 0
    v_mfma_f32_16x16x16_bf16 v[240:243], v[248:249], v[168:169], v[240:243]
    v_mfma_f32_16x16x16_bf16 v[244:247], v[248:249], v[174:175], v[244:247]
    v_mfma_f32_16x16x16_bf16 v[176:179], v[128:129], v[168:169], v[176:179]
    v_mfma_f32_16x16x16_bf16 v[180:183], v[128:129], v[174:175], v[180:183]
    v_mfma_f32_16x16x16_bf16 v[184:187], v[130:131], v[168:169], v[184:187]
    v_mfma_f32_16x16x16_bf16 v[188:191], v[130:131], v[174:175], v[188:191]
    v_mfma_f32_16x16x16_bf16 v[192:195], v[132:133], v[168:169], v[192:195]
    v_mfma_f32_16x16x16_bf16 v[196:199], v[132:133], v[174:175], v[196:199]
    v_mfma_f32_16x16x16_bf16 v[200:203], v[134:135], v[168:169], v[200:203]
    v_mfma_f32_16x16x16_bf16 v[204:207], v[134:135], v[174:175], v[204:207]
    v_mfma_f32_16x16x16_bf16 v[208:211], v[136:137], v[168:169], v[208:211]
    v_mfma_f32_16x16x16_bf16 v[212:215], v[136:137], v[174:175], v[212:215]
    v_mfma_f32_16x16x16_bf16 v[216:219], v[138:139], v[168:169], v[216:219]
    v_mfma_f32_16x16x16_bf16 v[220:223], v[138:139], v[174:175], v[220:223]
    v_mfma_f32_16x16x16_bf16 v[224:227], v[140:141], v[168:169], v[224:227]
    v_mfma_f32_16x16x16_bf16 v[228:231], v[140:141], v[174:175], v[228:231]
    v_mfma_f32_16x16x16_bf16 v[232:235], v[142:143], v[168:169], v[232:235]
    v_mfma_f32_16x16x16_bf16 v[236:239], v[142:143], v[174:175], v[236:239]
    v_rcp_f32 v8, v240
    v_rcp_f32 v9, v244
    s_nop 7
    v_mul_f32 v176, v176, v8
    v_mul_f32 v177, v177, v8
    v_mul_f32 v178, v178, v8
    v_mul_f32 v179, v179, v8
    v_cvt_pk_bf16_f32 v16, v176, v177
    v_cvt_pk_bf16_f32 v17, v178, v179
    v_mul_f32 v184, v184, v8
    v_mul_f32 v185, v185, v8
    v_mul_f32 v186, v186, v8
    v_mul_f32 v187, v187, v8
    v_cvt_pk_bf16_f32 v18, v184, v185
    v_cvt_pk_bf16_f32 v19, v186, v187
    s_add_u32 s64, s32, 0x0
    buffer_store_dwordx4 v[16:19], v1, s[4:7], s64 offen offset:0 sc1
    v_mul_f32 v192, v192, v8
    v_mul_f32 v193, v193, v8
    v_mul_f32 v194, v194, v8
    v_mul_f32 v195, v195, v8
    v_cvt_pk_bf16_f32 v20, v192, v193
    v_cvt_pk_bf16_f32 v21, v194, v195
    v_mul_f32 v200, v200, v8
    v_mul_f32 v201, v201, v8
    v_mul_f32 v202, v202, v8
    v_mul_f32 v203, v203, v8
    v_cvt_pk_bf16_f32 v22, v200, v201
    v_cvt_pk_bf16_f32 v23, v202, v203
    s_add_u32 s64, s32, 0x0
    buffer_store_dwordx4 v[20:23], v1, s[4:7], s64 offen offset:1024 sc1
    v_mul_f32 v208, v208, v8
    v_mul_f32 v209, v209, v8
    v_mul_f32 v210, v210, v8
    v_mul_f32 v211, v211, v8
    v_cvt_pk_bf16_f32 v24, v208, v209
    v_cvt_pk_bf16_f32 v25, v210, v211
    v_mul_f32 v216, v216, v8
    v_mul_f32 v217, v217, v8
    v_mul_f32 v218, v218, v8
    v_mul_f32 v219, v219, v8
    v_cvt_pk_bf16_f32 v26, v216, v217
    v_cvt_pk_bf16_f32 v27, v218, v219
    s_add_u32 s64, s32, 0x0
    buffer_store_dwordx4 v[24:27], v1, s[4:7], s64 offen offset:2048 sc1
    v_mul_f32 v224, v224, v8
    v_mul_f32 v225, v225, v8
    v_mul_f32 v226, v226, v8
    v_mul_f32 v227, v227, v8
    v_cvt_pk_bf16_f32 v28, v224, v225
    v_cvt_pk_bf16_f32 v29, v226, v227
    v_mul_f32 v232, v232, v8
    v_mul_f32 v233, v233, v8
    v_mul_f32 v234, v234, v8
    v_mul_f32 v235, v235, v8
    v_cvt_pk_bf16_f32 v30, v232, v233
    v_cvt_pk_bf16_f32 v31, v234, v235
    s_add_u32 s64, s32, 0x0
    buffer_store_dwordx4 v[28:31], v1, s[4:7], s64 offen offset:3072 sc1
    v_mul_f32 v180, v180, v9
    v_mul_f32 v181, v181, v9
    v_mul_f32 v182, v182, v9
    v_mul_f32 v183, v183, v9
    v_cvt_pk_bf16_f32 v32, v180, v181
    v_cvt_pk_bf16_f32 v33, v182, v183
    v_mul_f32 v188, v188, v9
    v_mul_f32 v189, v189, v9
    v_mul_f32 v190, v190, v9
    v_mul_f32 v191, v191, v9
    v_cvt_pk_bf16_f32 v34, v188, v189
    v_cvt_pk_bf16_f32 v35, v190, v191
    s_add_u32 s64, s32, 0x20000
    buffer_store_dwordx4 v[32:35], v1, s[4:7], s64 offen offset:0 sc1
    v_mul_f32 v196, v196, v9
    v_mul_f32 v197, v197, v9
    v_mul_f32 v198, v198, v9
    v_mul_f32 v199, v199, v9
    v_cvt_pk_bf16_f32 v36, v196, v197
    v_cvt_pk_bf16_f32 v37, v198, v199
    v_mul_f32 v204, v204, v9
    v_mul_f32 v205, v205, v9
    v_mul_f32 v206, v206, v9
    v_mul_f32 v207, v207, v9
    v_cvt_pk_bf16_f32 v38, v204, v205
    v_cvt_pk_bf16_f32 v39, v206, v207
    s_add_u32 s64, s32, 0x20000
    buffer_store_dwordx4 v[36:39], v1, s[4:7], s64 offen offset:1024 sc1
    v_mul_f32 v212, v212, v9
    v_mul_f32 v213, v213, v9
    v_mul_f32 v214, v214, v9
    v_mul_f32 v215, v215, v9
    v_cvt_pk_bf16_f32 v40, v212, v213
    v_cvt_pk_bf16_f32 v41, v214, v215
    v_mul_f32 v220, v220, v9
    v_mul_f32 v221, v221, v9
    v_mul_f32 v222, v222, v9
    v_mul_f32 v223, v223, v9
    v_cvt_pk_bf16_f32 v42, v220, v221
    v_cvt_pk_bf16_f32 v43, v222, v223
    s_add_u32 s64, s32, 0x20000
    buffer_store_dwordx4 v[40:43], v1, s[4:7], s64 offen offset:2048 sc1
    v_mul_f32 v228, v228, v9
    v_mul_f32 v229, v229, v9
    v_mul_f32 v230, v230, v9
    v_mul_f32 v231, v231, v9
    v_cvt_pk_bf16_f32 v44, v228, v229
    v_cvt_pk_bf16_f32 v45, v230, v231
    v_mul_f32 v236, v236, v9
    v_mul_f32 v237, v237, v9
    v_mul_f32 v238, v238, v9
    v_mul_f32 v239, v239, v9
    v_cvt_pk_bf16_f32 v46, v236, v237
    v_cvt_pk_bf16_f32 v47, v238, v239
    s_add_u32 s64, s32, 0x20000
    buffer_store_dwordx4 v[44:47], v1, s[4:7], s64 offen offset:3072 sc1
    s_waitcnt vmcnt(0)
    v_mov_b32 v7, 1
    v_mov_b32 v8, 0
    s_mov_b64 exec, 1
    buffer_store_dword v7, v8, s[4:7], s33 offen sc1
    s_mov_b64 exec, -1
    s_add_u32 s24, s24, 8
    s_add_u32 s25, s25, 1
    s_cmp_lt_u32 s25, 8
    s_cbranch_scc1 AT2_LOOP
AT2_END:
M_EXIT:
    s_endpgm
.section .rodata,"a"
.p2align 6
.amdhsa_kernel main_kernel
  .amdhsa_next_free_vgpr 512
  .amdhsa_next_free_sgpr 102
  .amdhsa_accum_offset 256
  .amdhsa_group_segment_fixed_size 0
  .amdhsa_kernarg_size 120
  .amdhsa_user_sgpr_count 2
  .amdhsa_user_sgpr_kernarg_segment_ptr 1
  .amdhsa_system_sgpr_workgroup_id_x 1
.end_amdhsa_kernel
```

```asm
; @launch kernel=main_kernel grid=(256,1,1) block=(256,1,1) lds=163840
.amdgcn_target "amdgcn-amd-amdhsa--gfx950"
.text
.globl main_kernel
.p2align 8
.type main_kernel,@function
main_kernel:
    s_cmp_ge_u32 s2, 256
    s_cbranch_scc1 M_EXIT
    s_load_dwordx2 s[4:5], s[0:1], 112
    s_mov_b32 s6, 0x10000000
    s_mov_b32 s7, 0x00020000
    s_load_dwordx2 s[60:61], s[0:1], 104
    s_mov_b32 s62, 256
    s_mov_b32 s63, 0x00020000
    s_load_dwordx2 s[44:45], s[0:1], 16
    s_mov_b32 s46, 0x500000
    s_mov_b32 s47, 0x00020000
    s_load_dwordx2 s[48:49], s[0:1], 24
    s_mov_b32 s50, 0x500000
    s_mov_b32 s51, 0x00020000
    s_load_dwordx2 s[52:53], s[0:1], 32
    s_mov_b32 s54, 0x500000
    s_mov_b32 s55, 0x00020000
    s_load_dwordx2 s[56:57], s[0:1], 40
    s_mov_b32 s58, 0x500000
    s_mov_b32 s59, 0x00020000
    v_lshrrev_b32 v1, 6, v0
    v_and_b32 v0, 63, v0
    s_nop 0
    v_readfirstlane_b32 s14, v1
    s_getreg_b32 s98, hwreg(HW_REG_XCC_ID)
    s_and_b32 s98, s98, 7
    s_mov_b32 s97, 0
    s_mov_b32 s95, 4
    s_waitcnt lgkmcnt(0)
    s_cmp_lg_u32 s14, 0
    s_cbranch_scc1 NOMEAS_1
    s_and_b32 s64, s2, 0xfffffffd
    s_cmp_lg_u32 s64, 1
    s_cbranch_scc1 NOMEAS_1
    s_lshr_b32 s70, s2, 1
    s_mov_b32 s72, s60
    s_mov_b32 s73, s61
    s_mov_b32 s74, s62
    s_mov_b32 s75, s63
    s_lshl_b32 s60, s70, 21
    s_add_u32 s60, s60, 0x6001800
    v_mov_b32 v60, 0
    v_mov_b32 v61, -1
    s_mov_b32 s66, 0x7fffffff
    s_mov_b32 s67, 0x7fffffff
    s_mov_b32 s68, 0x7fffffff
    s_mov_b32 s69, 0x7fffffff
    s_mov_b64 exec, 1
    s_add_u32 s61, s60, 0
    s_memtime s[62:63]
    s_waitcnt lgkmcnt(0)
    buffer_store_dword v61, v60, s[4:7], s61 offen offset:0 sc1
    s_waitcnt vmcnt(0)
    s_memtime s[64:65]
    s_waitcnt lgkmcnt(0)
    s_sub_u32 s62, s64, s62
    s_min_u32 s66, s66, s62
    s_add_u32 s61, s60, 8192
    s_memtime s[62:63]
    s_waitcnt lgkmcnt(0)
    buffer_store_dword v61, v60, s[4:7], s61 offen offset:0 sc1
    s_waitcnt vmcnt(0)
    s_memtime s[64:65]
    s_waitcnt lgkmcnt(0)
    s_sub_u32 s62, s64, s62
    s_min_u32 s67, s67, s62
    s_add_u32 s61, s60, 16384
    s_memtime s[62:63]
    s_waitcnt lgkmcnt(0)
    buffer_store_dword v61, v60, s[4:7], s61 offen offset:0 sc1
    s_waitcnt vmcnt(0)
    s_memtime s[64:65]
    s_waitcnt lgkmcnt(0)
    s_sub_u32 s62, s64, s62
    s_min_u32 s68, s68, s62
    s_add_u32 s61, s60, 24576
    s_memtime s[62:63]
    s_waitcnt lgkmcnt(0)
    buffer_store_dword v61, v60, s[4:7], s61 offen offset:0 sc1
    s_waitcnt vmcnt(0)
    s_memtime s[64:65]
    s_waitcnt lgkmcnt(0)
    s_sub_u32 s62, s64, s62
    s_min_u32 s69, s69, s62
    s_add_u32 s61, s60, 0
    s_memtime s[62:63]
    s_waitcnt lgkmcnt(0)
    buffer_store_dword v61, v60, s[4:7], s61 offen offset:128 sc1
    s_waitcnt vmcnt(0)
    s_memtime s[64:65]
    s_waitcnt lgkmcnt(0)
    s_sub_u32 s62, s64, s62
    s_min_u32 s66, s66, s62
    s_add_u32 s61, s60, 8192
    s_memtime s[62:63]
    s_waitcnt lgkmcnt(0)
    buffer_store_dword v61, v60, s[4:7], s61 offen offset:128 sc1
    s_waitcnt vmcnt(0)
    s_memtime s[64:65]
    s_waitcnt lgkmcnt(0)
    s_sub_u32 s62, s64, s62
    s_min_u32 s67, s67, s62
    s_add_u32 s61, s60, 16384
    s_memtime s[62:63]
    s_waitcnt lgkmcnt(0)
    buffer_store_dword v61, v60, s[4:7], s61 offen offset:128 sc1
    s_waitcnt vmcnt(0)
    s_memtime s[64:65]
    s_waitcnt lgkmcnt(0)
    s_sub_u32 s62, s64, s62
    s_min_u32 s68, s68, s62
    s_add_u32 s61, s60, 24576
    s_memtime s[62:63]
    s_waitcnt lgkmcnt(0)
    buffer_store_dword v61, v60, s[4:7], s61 offen offset:128 sc1
    s_waitcnt vmcnt(0)
    s_memtime s[64:65]
    s_waitcnt lgkmcnt(0)
    s_sub_u32 s62, s64, s62
    s_min_u32 s69, s69, s62
    s_mov_b64 exec, -1
    s_mov_b32 s60, 0
    s_mov_b32 s61, s66
    s_cmp_lt_u32 s67, s61
    s_cselect_b32 s60, 1, s60
    s_min_u32 s61, s61, s67
    s_cmp_lt_u32 s68, s61
    s_cselect_b32 s60, 2, s60
    s_min_u32 s61, s61, s68
    s_cmp_lt_u32 s69, s61
    s_cselect_b32 s60, 3, s60
    s_min_u32 s61, s61, s69
    s_and_b32 s61, s98, 1
    s_lshl_b32 s61, s61, 1
    s_lshr_b32 s62, s98, 2
    s_add_u32 s61, s61, s62
    s_xor_b32 s60, s60, s61
    s_add_u32 s71, s60, 1
    s_mov_b32 s60, s72
    s_mov_b32 s61, s73
    s_mov_b32 s62, s74
    s_mov_b32 s63, s75
    s_lshl_b32 s70, s70, 2
    s_add_u32 s70, s70, 132
    v_mov_b32 v61, s71
    s_mov_b64 exec, 1
    buffer_store_dword v61, off, s[60:63], s70 sc1
    s_mov_b64 exec, -1
NOMEAS_1:
    s_cmp_eq_u32 s98, 0
    s_cselect_b32 s80, 1, 0
    s_cmp_eq_u32 s98, 2
    s_cselect_b32 s80, 1, s80
    s_mov_b32 s94, 0
    s_lshr_b32 s13, s2, 3
    s_and_b32 s13, s13, 31
    s_cmp_eq_u32 s14, 0
    s_cbranch_scc1 M_TICK0
    s_cmp_eq_u32 s80, 1
    s_cbranch_scc1 M_GUESS
    s_branch M_TICKW
M_TICK0:
    s_mul_i32 s64, s98, 32
    s_add_u32 s64, s64, 0x0
    v_mov_b32 v1, 0
    v_mov_b32 v70, 1
    s_mov_b64 exec, 1
    s_cmp_eq_u32 s98, 0
    s_cselect_b32 s65, 24, 28
    s_cmp_eq_u32 s80, 1
    s_cselect_b32 s65, s65, 0x1000
    s_lshl_b32 s66, 1, s13
    v_mov_b32 v4, s66
    buffer_atomic_or v4, off, s[60:63], s65 sc1
    buffer_atomic_add v70, v1, s[60:63], s64 offen sc0
    s_mov_b64 exec, -1
    s_getpc_b64 s[76:77]
M_PCREF:
    s_cmp_eq_u32 s80, 1
    s_mov_b32 s82, M_REC-M_PCREF
    s_mov_b32 s83, M_HELP-M_PCREF
    s_cselect_b32 s81, s82, s83
    s_mov_b32 s82, M_HELP-M_REC
    s_mov_b32 s83, M_EXIT-M_HELP
    s_cselect_b32 s78, s82, s83
    s_add_u32 s76, s76, s81
    s_addc_u32 s77, s77, 0
    s_and_b32 s77, s77, 0xffff
    s_mov_b32 s79, 0x00020000
    s_lshr_b32 s81, s2, 3
    s_and_b32 s81, s81, 3
    s_lshl_b32 s81, s81, 12
    v_mbcnt_lo_u32_b32 v3, -1, 0
    v_mbcnt_hi_u32_b32 v3, -1, v3
    v_lshlrev_b32 v3, 6, v3
    s_mov_b32 m0, 1024
    s_nop 0
    buffer_load_dword v3, s[76:79], s81 offen lds
    s_add_u32 s81, s81, 16384
    buffer_load_dword v3, s[76:79], s81 offen lds
    s_add_u32 s81, s81, 16384
    buffer_load_dword v3, s[76:79], s81 offen lds
    s_add_u32 s81, s81, 16384
    buffer_load_dword v3, s[76:79], s81 offen lds
    s_add_u32 s81, s81, 16384
    buffer_load_dword v3, s[76:79], s81 offen lds
    s_add_u32 s81, s81, 16384
    s_cmp_eq_u32 s80, 1
    s_cbranch_scc1 M_GUESS
    s_mov_b64 exec, 1
    s_waitcnt vmcnt(5)
    ds_write_b32 v1, v70
    s_waitcnt lgkmcnt(0)
    s_mov_b64 exec, -1
M_TICKW:
    s_barrier
    v_mov_b32 v1, 0
    ds_read_b32 v2, v1
    s_waitcnt lgkmcnt(0)
    v_readfirstlane_b32 s99, v2
    s_barrier
    s_cmp_ge_u32 s99, 32
    s_cbranch_scc1 M_SLOW0
    s_mov_b32 s12, s98
    s_cmp_eq_u32 s12, 0
    s_cbranch_scc1 XOK_2
    s_cmp_eq_u32 s12, 2
    s_cbranch_scc0 M_FH
    s_mov_b32 s12, 1
XOK_2:
    s_mov_b32 s13, s99
    s_branch M_REC
M_FH:
    s_sub_u32 s96, s98, 1
    s_cmp_gt_u32 s98, 2
    s_cselect_b32 s64, 1, 0
    s_sub_u32 s96, s96, s64
    s_lshl_b32 s96, s96, 5
    s_add_u32 s96, s96, s99
    s_branch M_HELP
M_GUESS:
    s_mov_b32 s94, 1
    s_cmp_eq_u32 s98, 0
    s_cselect_b32 s12, 0, 1
    s_branch M_REC
M_GFAIL:
    s_waitcnt vmcnt(0) lgkmcnt(0)
    s_barrier
    s_cmp_lg_u32 s14, 0
    s_cbranch_scc1 M_GF1
    v_mov_b32 v1, 0
    s_mov_b64 exec, 1
    ds_write_b32 v1, v70
    s_waitcnt lgkmcnt(0)
    s_mov_b64 exec, -1
M_GF1:
    s_barrier
    v_mov_b32 v1, 0
    ds_read_b32 v2, v1
    s_waitcnt lgkmcnt(0)
    v_readfirstlane_b32 s99, v2
    s_barrier
    s_mov_b32 s94, 0
    s_cmp_ge_u32 s99, 32
    s_cbranch_scc1 M_SLOW0
    s_mov_b32 s13, s99
    v_mbcnt_lo_u32_b32 v0, -1, 0
    v_mbcnt_hi_u32_b32 v0, -1, v0
    s_branch M_REC
M_SLOW0:
    v_mbcnt_lo_u32_b32 v0, -1, 0
    v_mbcnt_hi_u32_b32 v0, -1, v0
    v_mul_u32_u24 v8, 32, v0
    s_mov_b32 s64, 0x0
    s_mov_b32 s65, 0
    s_mov_b64 exec, 0xff
TK_3:
    buffer_load_dword v9, v8, s[60:63], s64 offen sc1
    s_add_u32 s65, s65, 1
    s_waitcnt vmcnt(0)
    s_mov_b32 s66, 0
    v_readlane_b32 s67, v9, 0
    s_add_u32 s66, s66, s67
    v_readlane_b32 s67, v9, 1
    s_add_u32 s66, s66, s67
    v_readlane_b32 s67, v9, 2
    s_add_u32 s66, s66, s67
    v_readlane_b32 s67, v9, 3
    s_add_u32 s66, s66, s67
    v_readlane_b32 s67, v9, 4
    s_add_u32 s66, s66, s67
    v_readlane_b32 s67, v9, 5
    s_add_u32 s66, s66, s67
    v_readlane_b32 s67, v9, 6
    s_add_u32 s66, s66, s67
    v_readlane_b32 s67, v9, 7
    s_add_u32 s66, s66, s67
    s_cmp_ge_u32 s66, 256
    s_cbranch_scc1 TKD_4
    s_cmp_gt_u32 s65, 262144
    s_cbranch_scc0 TK_3
TKD_4:
    v_cmp_ne_u32 vcc, 32, v9
    s_mov_b64 exec, -1
M_SLOW:
    s_waitcnt vmcnt(0) lgkmcnt(0)
    s_barrier
    s_cmp_lg_u32 s14, 0
    s_cbranch_scc1 M_SLOWB
    v_mov_b32 v8, 1
    s_mov_b64 exec, 1
    buffer_atomic_add v8, off, s[60:63], 12 sc1
    s_mov_b64 exec, -1
M_SLOWB:
    s_mov_b32 s95, 12
    s_mov_b32 s65, 0
SB_5:
    buffer_load_dword v8, off, s[60:63], s95 sc1
    s_add_u32 s65, s65, 1
    s_waitcnt vmcnt(0)
    v_readfirstlane_b32 s64, v8
    s_cmp_ge_u32 s64, 256
    s_cbranch_scc1 SBD_6
    s_cmp_gt_u32 s65, 65536
    s_cbranch_scc1 SBD_6
    s_sleep 4
    s_branch SB_5
SBD_6:
    s_mov_b32 s95, 8
    s_mov_b32 s97, 1
    s_mov_b32 s94, 0
    s_cmp_lt_u32 s2, 64
    s_cbranch_scc0 M_SH
    s_load_dwordx2 s[44:45], s[0:1], 16
    s_mov_b32 s46, 0x500000
    s_mov_b32 s47, 0x00020000
    s_load_dwordx2 s[48:49], s[0:1], 24
    s_mov_b32 s50, 0x500000
    s_mov_b32 s51, 0x00020000
    s_load_dwordx2 s[52:53], s[0:1], 32
    s_mov_b32 s54, 0x500000
    s_mov_b32 s55, 0x00020000
    s_load_dwordx2 s[56:57], s[0:1], 40
    s_mov_b32 s58, 0x500000
    s_mov_b32 s59, 0x00020000
    s_waitcnt lgkmcnt(0)
    s_lshr_b32 s12, s2, 5
    s_and_b32 s13, s2, 31
    s_branch M_REC
M_SH:
    s_sub_u32 s96, s2, 64
    s_branch M_HELP
M_REC:
    v_mbcnt_lo_u32_b32 v0, -1, 0
    v_mbcnt_hi_u32_b32 v0, -1, v0
    v_and_b32 v0, 63, v0
    s_mul_i32 s40, s14, 36864
    s_add_u32 s40, s40, 16384
    v_lshrrev_b32 v95, 4, v0
    v_lshlrev_b32 v8, 13, v95
    v_and_b32 v95, 1, v95
    v_lshlrev_b32 v95, 1, v95
    v_and_b32 v9, 15, v0
    v_xor_b32 v9, v9, v95
    v_xor_b32 v95, 0, v9
    v_lshl_add_u32 v76, v95, 4, v8
    v_xor_b32 v95, 4, v9
    v_lshl_add_u32 v77, v95, 4, v8
    v_xor_b32 v95, 8, v9
    v_lshl_add_u32 v78, v95, 4, v8
    v_xor_b32 v95, 12, v9
    v_lshl_add_u32 v79, v95, 4, v8
    s_lshl_b32 s64, s13, 8
    s_lshl_b32 s65, s14, 17
    s_add_u32 s64, s64, s65
    s_mul_i32 s65, s12, 2621440
    s_add_u32 s71, s64, s65
    s_sub_u32 s65, 2621440, s65
    s_add_u32 s72, s64, s65
    s_add_u32 m0, s40, 0
    s_add_u32 s64, s71, 0x0
    buffer_load_dwordx4 v76, s[44:47], s64 offen lds
    s_add_u32 m0, s40, 1024
    s_add_u32 s64, s71, 0x8000
    buffer_load_dwordx4 v77, s[44:47], s64 offen lds
    s_add_u32 m0, s40, 2048
    s_add_u32 s64, s71, 0x10000
    buffer_load_dwordx4 v78, s[44:47], s64 offen lds
    s_add_u32 m0, s40, 3072
    s_add_u32 s64, s71, 0x18000
    buffer_load_dwordx4 v79, s[44:47], s64 offen lds
    s_add_u32 m0, s40, 4096
    s_add_u32 s64, s71, 0x80000
    buffer_load_dwordx4 v76, s[44:47], s64 offen lds
    s_add_u32 m0, s40, 5120
    s_add_u32 s64, s71, 0x88000
    buffer_load_dwordx4 v77, s[44:47], s64 offen lds
    s_add_u32 m0, s40, 6144
    s_add_u32 s64, s71, 0x90000
    buffer_load_dwordx4 v78, s[44:47], s64 offen lds
    s_add_u32 m0, s40, 7168
    s_add_u32 s64, s71, 0x98000
    buffer_load_dwordx4 v79, s[44:47], s64 offen lds
    s_add_u32 m0, s40, 8192
    s_add_u32 s64, s71, 0x100000
    buffer_load_dwordx4 v76, s[44:47], s64 offen lds
    s_add_u32 m0, s40, 9216
    s_add_u32 s64, s71, 0x108000
    buffer_load_dwordx4 v77, s[44:47], s64 offen lds
    s_add_u32 m0, s40, 10240
    s_add_u32 s64, s71, 0x110000
    buffer_load_dwordx4 v78, s[44:47], s64 offen lds
    s_add_u32 m0, s40, 11264
    s_add_u32 s64, s71, 0x118000
    buffer_load_dwordx4 v79, s[44:47], s64 offen lds
    s_add_u32 m0, s40, 12288
    s_add_u32 s64, s71, 0x180000
    buffer_load_dwordx4 v76, s[44:47], s64 offen lds
    s_add_u32 m0, s40, 13312
    s_add_u32 s64, s71, 0x188000
    buffer_load_dwordx4 v77, s[44:47], s64 offen lds
    s_add_u32 m0, s40, 14336
    s_add_u32 s64, s71, 0x190000
    buffer_load_dwordx4 v78, s[44:47], s64 offen lds
    s_add_u32 m0, s40, 15360
    s_add_u32 s64, s71, 0x198000
    buffer_load_dwordx4 v79, s[44:47], s64 offen lds
    s_add_u32 m0, s40, 16384
    s_add_u32 s64, s71, 0x200000
    buffer_load_dwordx4 v76, s[44:47], s64 offen lds
    s_add_u32 m0, s40, 17408
    s_add_u32 s64, s71, 0x208000
    buffer_load_dwordx4 v77, s[44:47], s64 offen lds
    s_add_u32 m0, s40, 18432
    s_add_u32 s64, s71, 0x210000
    buffer_load_dwordx4 v78, s[44:47], s64 offen lds
    s_add_u32 m0, s40, 19456
    s_add_u32 s64, s71, 0x218000
    buffer_load_dwordx4 v79, s[44:47], s64 offen lds
    s_add_u32 m0, s40, 20480
    s_add_u32 s64, s72, 0x0
    buffer_load_dwordx4 v76, s[44:47], s64 offen lds
    s_add_u32 m0, s40, 21504
    s_add_u32 s64, s72, 0x8000
    buffer_load_dwordx4 v77, s[44:47], s64 offen lds
    s_add_u32 m0, s40, 22528
    s_add_u32 s64, s72, 0x10000
    buffer_load_dwordx4 v78, s[44:47], s64 offen lds
    s_add_u32 m0, s40, 23552
    s_add_u32 s64, s72, 0x18000
    buffer_load_dwordx4 v79, s[44:47], s64 offen lds
    s_add_u32 m0, s40, 24576
    s_add_u32 s64, s72, 0x80000
    buffer_load_dwordx4 v76, s[44:47], s64 offen lds
    s_add_u32 m0, s40, 25600
    s_add_u32 s64, s72, 0x88000
    buffer_load_dwordx4 v77, s[44:47], s64 offen lds
    s_add_u32 m0, s40, 26624
    s_add_u32 s64, s72, 0x90000
    buffer_load_dwordx4 v78, s[44:47], s64 offen lds
    s_add_u32 m0, s40, 27648
    s_add_u32 s64, s72, 0x98000
    buffer_load_dwordx4 v79, s[44:47], s64 offen lds
    s_add_u32 m0, s40, 28672
    s_add_u32 s64, s72, 0x100000
    buffer_load_dwordx4 v76, s[44:47], s64 offen lds
    s_add_u32 m0, s40, 29696
    s_add_u32 s64, s72, 0x108000
    buffer_load_dwordx4 v77, s[44:47], s64 offen lds
    s_add_u32 m0, s40, 30720
    s_add_u32 s64, s72, 0x110000
    buffer_load_dwordx4 v78, s[44:47], s64 offen lds
    s_add_u32 m0, s40, 31744
    s_add_u32 s64, s72, 0x118000
    buffer_load_dwordx4 v79, s[44:47], s64 offen lds
    v_lshrrev_b32 v95, 5, v0
    v_mul_u32_u24 v8, 36864, v95
    v_bfe_u32 v95, v0, 3, 1
    v_lshl_add_u32 v8, v95, 11, v8
    v_lshlrev_b32 v9, 3, v95
    v_bfe_u32 v95, v0, 4, 1
    v_lshl_add_u32 v8, v95, 10, v8
    v_lshl_add_u32 v9, v95, 2, v9
    v_bfe_u32 v95, v0, 2, 1
    v_lshl_add_u32 v8, v95, 8, v8
    v_lshl_add_u32 v9, v95, 1, v9
    v_and_b32 v95, 1, v0
    v_lshl_add_u32 v8, v95, 3, v8
    v_add_u32 v8, 16384, v8
    v_bfe_u32 v95, v0, 1, 1
    s_lshl_b32 s64, s14, 2
    v_add_u32 v10, s64, v95
    v_add_u32 v95, 0, v10
    v_xor_b32 v95, v95, v9
    v_lshl_add_u32 v72, v95, 4, v8
    v_add_u32 v73, 73728, v72
    v_add_u32 v95, 2, v10
    v_xor_b32 v95, v95, v9
    v_lshl_add_u32 v74, v95, 4, v8
    v_add_u32 v75, 73728, v74
    v_bfe_u32 v95, v0, 2, 1
    v_mov_b32 v8, v95
    v_bfe_u32 v95, v0, 3, 1
    v_lshl_add_u32 v8, v95, 2, v8
    v_bfe_u32 v95, v0, 4, 1
    v_lshl_add_u32 v8, v95, 1, v8
    v_bfe_u32 v95, v0, 5, 1
    v_lshl_add_u32 v8, v95, 3, v8
    v_mul_u32_u24 v8, 1280, v8
    v_and_b32 v95, 3, v0
    v_lshl_add_u32 v89, v95, 4, v8
    v_lshrrev_b32 v95, 1, v0
    v_mul_u32_u24 v8, 1280, v95
    v_and_b32 v95, 1, v0
    v_lshl_add_u32 v90, v95, 4, v8
    v_lshrrev_b32 v95, 5, v0
    v_lshlrev_b32 v93, 9, v95
    v_bfe_u32 v95, v0, 4, 1
    v_lshl_add_u32 v93, v95, 7, v93
    v_bfe_u32 v95, v0, 2, 1
    v_lshl_add_u32 v93, v95, 6, v93
    v_bfe_u32 v95, v0, 3, 1
    v_lshl_add_u32 v93, v95, 5, v93
    v_and_b32 v95, 3, v0
    v_lshl_add_u32 v93, v95, 3, v93
    v_add_u32 v93, s40, v93
    v_lshrrev_b32 v95, 4, v0
    v_lshlrev_b32 v94, 8, v95
    v_bfe_u32 v95, v0, 2, 2
    v_lshl_add_u32 v94, v95, 5, v94
    v_and_b32 v95, 3, v0
    v_lshl_add_u32 v94, v95, 3, v94
    v_add_u32 v94, s40, v94
    s_mul_i32 s39, s13, 163840
    s_mul_i32 s64, s12, 640
    s_add_u32 s39, s39, s64
    s_lshl_b32 s64, s14, 5
    s_add_u32 s41, s39, s64
    s_add_u32 s41, s41, 0x200
    s_lshl_b32 s64, s14, 6
    s_add_u32 s39, s39, s64
    v_and_b32 v0, 63, v0
    v_lshlrev_b32 v1, 4, v0
    s_mul_i32 s64, s14, 36864
    s_add_u32 s64, s64, 16384
    v_add_u32 v2, s64, v1
    v_bfe_u32 v8, v0, 4, 1
    v_mul_u32_u24 v8, 1152, v8
    v_lshrrev_b32 v9, 5, v0
    v_lshlrev_b32 v9, 4, v9
    v_and_b32 v10, 15, v0
    v_add_u32 v9, v9, v10
    s_lshl_b32 s64, s14, 5
    v_add_u32 v9, s64, v9
    v_lshl_add_u32 v8, v9, 3, v8
    v_add_u32 v3, 8192, v8
    v_and_b32 v8, 1, v0
    v_mul_u32_u24 v8, 1152, v8
    v_lshrrev_b32 v9, 4, v0
    v_lshlrev_b32 v9, 2, v9
    v_bfe_u32 v10, v0, 2, 2
    v_add_u32 v9, v9, v10
    v_lshl_add_u32 v8, v9, 3, v8
    v_add_u32 v4, 8192, v8
    v_and_b32 v8, 7, v0
    v_mul_u32_u24 v8, 288, v8
    v_bfe_u32 v9, v0, 3, 1
    v_lshl_add_u32 v8, v9, 5, v8
    v_lshrrev_b32 v9, 4, v0
    v_lshl_add_u32 v8, v9, 3, v8
    s_lshl_b32 s64, s14, 6
    s_add_u32 s64, s64, 12800
    v_add_u32 v5, s64, v8
    s_mov_b32 s32, 0x00ff00ff
    s_mov_b32 s33, 0x00ff00ff
    s_mov_b32 s34, -1
    s_mov_b32 s35, 0
    s_mov_b32 s36, 0x00010001
    s_mov_b32 s37, 0x00010001
    v_mov_b32 v8, 0xeeee
    v_mov_b32 v9, 0x4444
    v_cndmask_b32 v6, v8, v9, s[32:33]
    v_lshrrev_b32 v8, 5, v0
    v_lshlrev_b32 v8, 13, v8
    v_bfe_u32 v9, v0, 3, 1
    v_lshl_add_u32 v8, v9, 12, v8
    v_and_b32 v9, 7, v0
    v_lshl_add_u32 v8, v9, 4, v8
    v_bfe_u32 v9, v0, 4, 1
    v_lshl_add_u32 v7, v9, 3, v8
    s_mov_b32 s10, 0x3e0293ee
    s_mov_b32 s11, 0x3e0293ee
    s_cmp_eq_u32 s14, 0
    s_cselect_b32 s42, 1, 0
    s_cmp_ge_u32 s13, 24
    s_cselect_b32 s65, 1, 0
    s_cmp_eq_u32 s14, 1
    s_cselect_b32 s65, s65, 0
    s_or_b32 s42, s42, s65
    s_lshl_b32 s65, s65, 3
    s_add_u32 s64, s13, s65
    s_cmp_eq_u32 s64, 39
    s_cselect_b32 s22, s42, 0
    s_mul_i32 s24, s12, 163840
    s_add_u32 s24, s24, 0x300000
    s_lshl_b32 s67, s13, 7
    s_add_u32 s26, s24, s67
    s_lshl_b32 s67, s14, 14
    s_add_u32 s23, s26, s67
    s_add_u32 s25, s23, 0x10000
    s_lshl_b32 s67, s14, 13
    s_add_u32 s26, s26, s67
    s_add_u32 s26, s26, 0x20000
    s_lshl_b32 s67, s64, 12
    s_add_u32 s24, s24, s67
    s_lshl_b32 s64, s64, 7
    s_lshl_b32 s65, s12, 13
    s_add_u32 s17, s65, 0x5900000
    s_add_u32 s18, s17, s64
    s_lshl_b32 s65, s12, 21
    s_add_u32 s66, s65, 0x6000000
    s_add_u32 s21, s66, s64
    s_xor_b32 s65, s65, 0x200000
    s_add_u32 s20, s65, 0x5ff8000
    s_and_b32 s64, s13, 1
    s_cmp_eq_u32 s64, s12
    s_cselect_b32 s43, 1, 0
    s_mov_b32 s43, 0
    s_lshl_b32 s64, s13, 4
    s_add_u32 s69, s64, 0x291000
    s_lshl_b32 s64, s13, 2
    s_add_u32 s70, s64, 0x294000
    s_lshl_b32 s64, s13, 14
    s_lshl_b32 s73, s14, 11
    s_lshl_b32 s65, s14, 12
    s_add_u32 s65, s65, s64
    s_add_u32 s3, s65, 0x1500000
    s_add_u32 s64, s64, s73
    s_add_u32 s28, s64, 0x1400000
    s_add_u32 s29, s64, 0x1402000
    s_lshl_b32 s64, s13, 11
    s_add_u32 s30, s64, 0x640000
    s_lshl_b32 s64, s13, 12
    s_lshl_b32 s65, s14, 10
    s_add_u32 s64, s64, s65
    s_add_u32 s31, s64, 0xa40000
    s_waitcnt vmcnt(28)
    s_barrier
    s_add_u32 m0, s40, 32768
    s_add_u32 s64, s72, 0x180000
    buffer_load_dwordx4 v76, s[44:47], s64 offen lds
    s_add_u32 m0, s40, 33792
    s_add_u32 s64, s72, 0x188000
    buffer_load_dwordx4 v77, s[44:47], s64 offen lds
    s_add_u32 m0, s40, 34816
    s_add_u32 s64, s72, 0x190000
    buffer_load_dwordx4 v78, s[44:47], s64 offen lds
    s_add_u32 m0, s40, 35840
    s_add_u32 s64, s72, 0x198000
    buffer_load_dwordx4 v79, s[44:47], s64 offen lds
    ds_read_b64_tr_b16 v[96:97], v72 offset:0
    ds_read_b64_tr_b16 v[98:99], v72 offset:512
    ds_read_b64_tr_b16 v[100:101], v73 offset:0
    ds_read_b64_tr_b16 v[102:103], v73 offset:512
    ds_read_b64_tr_b16 v[104:105], v74 offset:0
    ds_read_b64_tr_b16 v[106:107], v74 offset:512
    ds_read_b64_tr_b16 v[108:109], v75 offset:0
    ds_read_b64_tr_b16 v[110:111], v75 offset:512
    s_waitcnt lgkmcnt(0)
    s_waitcnt vmcnt(28)
    s_barrier
    s_add_u32 m0, s40, 0
    s_add_u32 s64, s72, 0x200000
    buffer_load_dwordx4 v76, s[44:47], s64 offen lds
    s_add_u32 m0, s40, 1024
    s_add_u32 s64, s72, 0x208000
    buffer_load_dwordx4 v77, s[44:47], s64 offen lds
    s_add_u32 m0, s40, 2048
    s_add_u32 s64, s72, 0x210000
    buffer_load_dwordx4 v78, s[44:47], s64 offen lds
    s_add_u32 m0, s40, 3072
    s_add_u32 s64, s72, 0x218000
    buffer_load_dwordx4 v79, s[44:47], s64 offen lds
    ds_read_b64_tr_b16 v[112:113], v72 offset:4096
    ds_read_b64_tr_b16 v[114:115], v72 offset:4608
    ds_read_b64_tr_b16 v[116:117], v73 offset:4096
    ds_read_b64_tr_b16 v[118:119], v73 offset:4608
    ds_read_b64_tr_b16 v[120:121], v74 offset:4096
    ds_read_b64_tr_b16 v[122:123], v74 offset:4608
    ds_read_b64_tr_b16 v[124:125], v75 offset:4096
    ds_read_b64_tr_b16 v[126:127], v75 offset:4608
    s_waitcnt lgkmcnt(0)
    s_waitcnt vmcnt(28)
    s_barrier
    s_add_u32 m0, s40, 4096
    s_add_u32 s64, s72, 0x200000
    buffer_load_dwordx4 v76, s[48:51], s64 offen lds
    s_add_u32 m0, s40, 5120
    s_add_u32 s64, s72, 0x208000
    buffer_load_dwordx4 v77, s[48:51], s64 offen lds
    s_add_u32 m0, s40, 6144
    s_add_u32 s64, s72, 0x210000
    buffer_load_dwordx4 v78, s[48:51], s64 offen lds
    s_add_u32 m0, s40, 7168
    s_add_u32 s64, s72, 0x218000
    buffer_load_dwordx4 v79, s[48:51], s64 offen lds
    ds_read_b64_tr_b16 v[128:129], v72 offset:8192
    ds_read_b64_tr_b16 v[130:131], v72 offset:8704
    ds_read_b64_tr_b16 v[132:133], v73 offset:8192
    ds_read_b64_tr_b16 v[134:135], v73 offset:8704
    ds_read_b64_tr_b16 v[136:137], v74 offset:8192
    ds_read_b64_tr_b16 v[138:139], v74 offset:8704
    ds_read_b64_tr_b16 v[140:141], v75 offset:8192
    ds_read_b64_tr_b16 v[142:143], v75 offset:8704
    s_waitcnt lgkmcnt(0)
    s_waitcnt vmcnt(28)
    s_barrier
    s_add_u32 m0, s40, 8192
    s_add_u32 s64, s71, 0x0
    buffer_load_dwordx4 v76, s[52:55], s64 offen lds
    s_add_u32 m0, s40, 9216
    s_add_u32 s64, s71, 0x8000
    buffer_load_dwordx4 v77, s[52:55], s64 offen lds
    s_add_u32 m0, s40, 10240
    s_add_u32 s64, s71, 0x10000
    buffer_load_dwordx4 v78, s[52:55], s64 offen lds
    s_add_u32 m0, s40, 11264
    s_add_u32 s64, s71, 0x18000
    buffer_load_dwordx4 v79, s[52:55], s64 offen lds
    ds_read_b64_tr_b16 v[144:145], v72 offset:12288
    ds_read_b64_tr_b16 v[146:147], v72 offset:12800
    ds_read_b64_tr_b16 v[148:149], v73 offset:12288
    ds_read_b64_tr_b16 v[150:151], v73 offset:12800
    ds_read_b64_tr_b16 v[152:153], v74 offset:12288
    ds_read_b64_tr_b16 v[154:155], v74 offset:12800
    ds_read_b64_tr_b16 v[156:157], v75 offset:12288
    ds_read_b64_tr_b16 v[158:159], v75 offset:12800
    s_waitcnt lgkmcnt(0)
    s_waitcnt vmcnt(28)
    s_barrier
    s_add_u32 m0, s40, 12288
    s_add_u32 s64, s71, 0x80000
    buffer_load_dwordx4 v76, s[52:55], s64 offen lds
    s_add_u32 m0, s40, 13312
    s_add_u32 s64, s71, 0x88000
    buffer_load_dwordx4 v77, s[52:55], s64 offen lds
    s_add_u32 m0, s40, 14336
    s_add_u32 s64, s71, 0x90000
    buffer_load_dwordx4 v78, s[52:55], s64 offen lds
    s_add_u32 m0, s40, 15360
    s_add_u32 s64, s71, 0x98000
    buffer_load_dwordx4 v79, s[52:55], s64 offen lds
    ds_read_b64_tr_b16 v[160:161], v72 offset:16384
    ds_read_b64_tr_b16 v[162:163], v72 offset:16896
    ds_read_b64_tr_b16 v[164:165], v73 offset:16384
    ds_read_b64_tr_b16 v[166:167], v73 offset:16896
    ds_read_b64_tr_b16 v[168:169], v74 offset:16384
    ds_read_b64_tr_b16 v[170:171], v74 offset:16896
    ds_read_b64_tr_b16 v[172:173], v75 offset:16384
    ds_read_b64_tr_b16 v[174:175], v75 offset:16896
    s_waitcnt lgkmcnt(0)
    s_waitcnt vmcnt(28)
    s_barrier
    s_add_u32 m0, s40, 16384
    s_add_u32 s64, s71, 0x100000
    buffer_load_dwordx4 v76, s[52:55], s64 offen lds
    s_add_u32 m0, s40, 17408
    s_add_u32 s64, s71, 0x108000
    buffer_load_dwordx4 v77, s[52:55], s64 offen lds
    s_add_u32 m0, s40, 18432
    s_add_u32 s64, s71, 0x110000
    buffer_load_dwordx4 v78, s[52:55], s64 offen lds
    s_add_u32 m0, s40, 19456
    s_add_u32 s64, s71, 0x118000
    buffer_load_dwordx4 v79, s[52:55], s64 offen lds
    ds_read_b64_tr_b16 v[176:177], v72 offset:20480
    ds_read_b64_tr_b16 v[178:179], v72 offset:20992
    ds_read_b64_tr_b16 v[180:181], v73 offset:20480
    ds_read_b64_tr_b16 v[182:183], v73 offset:20992
    ds_read_b64_tr_b16 v[184:185], v74 offset:20480
    ds_read_b64_tr_b16 v[186:187], v74 offset:20992
    ds_read_b64_tr_b16 v[188:189], v75 offset:20480
    ds_read_b64_tr_b16 v[190:191], v75 offset:20992
    s_waitcnt lgkmcnt(0)
    s_waitcnt vmcnt(28)
    s_barrier
    s_add_u32 m0, s40, 20480
    s_add_u32 s64, s71, 0x180000
    buffer_load_dwordx4 v76, s[52:55], s64 offen lds
    s_add_u32 m0, s40, 21504
    s_add_u32 s64, s71, 0x188000
    buffer_load_dwordx4 v77, s[52:55], s64 offen lds
    s_add_u32 m0, s40, 22528
    s_add_u32 s64, s71, 0x190000
    buffer_load_dwordx4 v78, s[52:55], s64 offen lds
    s_add_u32 m0, s40, 23552
    s_add_u32 s64, s71, 0x198000
    buffer_load_dwordx4 v79, s[52:55], s64 offen lds
    ds_read_b64_tr_b16 v[192:193], v72 offset:24576
    ds_read_b64_tr_b16 v[194:195], v72 offset:25088
    ds_read_b64_tr_b16 v[196:197], v73 offset:24576
    ds_read_b64_tr_b16 v[198:199], v73 offset:25088
    ds_read_b64_tr_b16 v[200:201], v74 offset:24576
    ds_read_b64_tr_b16 v[202:203], v74 offset:25088
    ds_read_b64_tr_b16 v[204:205], v75 offset:24576
    ds_read_b64_tr_b16 v[206:207], v75 offset:25088
    s_waitcnt lgkmcnt(0)
    s_waitcnt vmcnt(28)
    s_barrier
    s_add_u32 m0, s40, 24576
    s_add_u32 s64, s71, 0x200000
    buffer_load_dwordx4 v76, s[52:55], s64 offen lds
    s_add_u32 m0, s40, 25600
    s_add_u32 s64, s71, 0x208000
    buffer_load_dwordx4 v77, s[52:55], s64 offen lds
    s_add_u32 m0, s40, 26624
    s_add_u32 s64, s71, 0x210000
    buffer_load_dwordx4 v78, s[52:55], s64 offen lds
    s_add_u32 m0, s40, 27648
    s_add_u32 s64, s71, 0x218000
    buffer_load_dwordx4 v79, s[52:55], s64 offen lds
    ds_read_b64_tr_b16 v[208:209], v72 offset:28672
    ds_read_b64_tr_b16 v[210:211], v72 offset:29184
    ds_read_b64_tr_b16 v[212:213], v73 offset:28672
    ds_read_b64_tr_b16 v[214:215], v73 offset:29184
    ds_read_b64_tr_b16 v[216:217], v74 offset:28672
    ds_read_b64_tr_b16 v[218:219], v74 offset:29184
    ds_read_b64_tr_b16 v[220:221], v75 offset:28672
    ds_read_b64_tr_b16 v[222:223], v75 offset:29184
    s_waitcnt lgkmcnt(0)
    s_waitcnt vmcnt(28)
    s_barrier
    s_add_u32 m0, s40, 28672
    s_add_u32 s64, s72, 0x0
    buffer_load_dwordx4 v76, s[52:55], s64 offen lds
    s_add_u32 m0, s40, 29696
    s_add_u32 s64, s72, 0x8000
    buffer_load_dwordx4 v77, s[52:55], s64 offen lds
    s_add_u32 m0, s40, 30720
    s_add_u32 s64, s72, 0x10000
    buffer_load_dwordx4 v78, s[52:55], s64 offen lds
    s_add_u32 m0, s40, 31744
    s_add_u32 s64, s72, 0x18000
    buffer_load_dwordx4 v79, s[52:55], s64 offen lds
    ds_read_b64_tr_b16 v[224:225], v72 offset:32768
    ds_read_b64_tr_b16 v[226:227], v72 offset:33280
    ds_read_b64_tr_b16 v[228:229], v73 offset:32768
    ds_read_b64_tr_b16 v[230:231], v73 offset:33280
    ds_read_b64_tr_b16 v[232:233], v74 offset:32768
    ds_read_b64_tr_b16 v[234:235], v74 offset:33280
    ds_read_b64_tr_b16 v[236:237], v75 offset:32768
    ds_read_b64_tr_b16 v[238:239], v75 offset:33280
    s_waitcnt lgkmcnt(0)
    s_waitcnt vmcnt(28)
    s_barrier
    s_add_u32 m0, s40, 32768
    s_add_u32 s64, s72, 0x80000
    buffer_load_dwordx4 v76, s[52:55], s64 offen lds
    s_add_u32 m0, s40, 33792
    s_add_u32 s64, s72, 0x88000
    buffer_load_dwordx4 v77, s[52:55], s64 offen lds
    s_add_u32 m0, s40, 34816
    s_add_u32 s64, s72, 0x90000
    buffer_load_dwordx4 v78, s[52:55], s64 offen lds
    s_add_u32 m0, s40, 35840
    s_add_u32 s64, s72, 0x98000
    buffer_load_dwordx4 v79, s[52:55], s64 offen lds
    ds_read_b64_tr_b16 v[240:241], v72 offset:0
    ds_read_b64_tr_b16 v[242:243], v72 offset:512
    ds_read_b64_tr_b16 v[244:245], v73 offset:0
    ds_read_b64_tr_b16 v[246:247], v73 offset:512
    ds_read_b64_tr_b16 v[248:249], v74 offset:0
    ds_read_b64_tr_b16 v[250:251], v74 offset:512
    ds_read_b64_tr_b16 v[252:253], v75 offset:0
    ds_read_b64_tr_b16 v[254:255], v75 offset:512
    s_waitcnt lgkmcnt(0)
    s_waitcnt vmcnt(28)
    s_barrier
    s_add_u32 m0, s40, 0
    s_add_u32 s64, s72, 0x100000
    buffer_load_dwordx4 v76, s[52:55], s64 offen lds
    s_add_u32 m0, s40, 1024
    s_add_u32 s64, s72, 0x108000
    buffer_load_dwordx4 v77, s[52:55], s64 offen lds
    s_add_u32 m0, s40, 2048
    s_add_u32 s64, s72, 0x110000
    buffer_load_dwordx4 v78, s[52:55], s64 offen lds
    s_add_u32 m0, s40, 3072
    s_add_u32 s64, s72, 0x118000
    buffer_load_dwordx4 v79, s[52:55], s64 offen lds
    ds_read_b64_tr_b16 a[240:241], v72 offset:4096
    ds_read_b64_tr_b16 a[242:243], v72 offset:4608
    ds_read_b64_tr_b16 a[244:245], v73 offset:4096
    ds_read_b64_tr_b16 a[246:247], v73 offset:4608
    ds_read_b64_tr_b16 a[248:249], v74 offset:4096
    ds_read_b64_tr_b16 a[250:251], v74 offset:4608
    ds_read_b64_tr_b16 a[252:253], v75 offset:4096
    ds_read_b64_tr_b16 a[254:255], v75 offset:4608
    s_waitcnt lgkmcnt(0)
    s_waitcnt vmcnt(28)
    s_barrier
    s_add_u32 m0, s40, 4096
    s_add_u32 s64, s72, 0x180000
    buffer_load_dwordx4 v76, s[52:55], s64 offen lds
    s_add_u32 m0, s40, 5120
    s_add_u32 s64, s72, 0x188000
    buffer_load_dwordx4 v77, s[52:55], s64 offen lds
    s_add_u32 m0, s40, 6144
    s_add_u32 s64, s72, 0x190000
    buffer_load_dwordx4 v78, s[52:55], s64 offen lds
    s_add_u32 m0, s40, 7168
    s_add_u32 s64, s72, 0x198000
    buffer_load_dwordx4 v79, s[52:55], s64 offen lds
    ds_read_b64_tr_b16 a[0:1], v72 offset:8192
    ds_read_b64_tr_b16 a[2:3], v72 offset:8704
    ds_read_b64_tr_b16 a[4:5], v73 offset:8192
    ds_read_b64_tr_b16 a[6:7], v73 offset:8704
    ds_read_b64_tr_b16 a[8:9], v74 offset:8192
    ds_read_b64_tr_b16 a[10:11], v74 offset:8704
    ds_read_b64_tr_b16 a[12:13], v75 offset:8192
    ds_read_b64_tr_b16 a[14:15], v75 offset:8704
    s_waitcnt lgkmcnt(0)
    s_waitcnt vmcnt(28)
    s_barrier
    s_add_u32 m0, s40, 8192
    s_add_u32 s64, s72, 0x200000
    buffer_load_dwordx4 v76, s[52:55], s64 offen lds
    s_add_u32 m0, s40, 9216
    s_add_u32 s64, s72, 0x208000
    buffer_load_dwordx4 v77, s[52:55], s64 offen lds
    s_add_u32 m0, s40, 10240
    s_add_u32 s64, s72, 0x210000
    buffer_load_dwordx4 v78, s[52:55], s64 offen lds
    s_add_u32 m0, s40, 11264
    s_add_u32 s64, s72, 0x218000
    buffer_load_dwordx4 v79, s[52:55], s64 offen lds
    ds_read_b64_tr_b16 a[16:17], v72 offset:12288
    ds_read_b64_tr_b16 a[18:19], v72 offset:12800
    ds_read_b64_tr_b16 a[20:21], v73 offset:12288
    ds_read_b64_tr_b16 a[22:23], v73 offset:12800
    ds_read_b64_tr_b16 a[24:25], v74 offset:12288
    ds_read_b64_tr_b16 a[26:27], v74 offset:12800
    ds_read_b64_tr_b16 a[28:29], v75 offset:12288
    ds_read_b64_tr_b16 a[30:31], v75 offset:12800
    s_waitcnt lgkmcnt(0)
    s_waitcnt vmcnt(28)
    s_barrier
    s_add_u32 m0, s40, 12288
    s_add_u32 s64, s39, 0x0
    buffer_load_dwordx4 v89, s[56:59], s64 offen lds
    s_add_u32 m0, s40, 13312
    s_add_u32 s64, s39, 0x5000
    buffer_load_dwordx4 v89, s[56:59], s64 offen lds
    s_add_u32 m0, s40, 14336
    s_add_u32 s64, s39, 0xa000
    buffer_load_dwordx4 v89, s[56:59], s64 offen lds
    s_add_u32 m0, s40, 15360
    s_add_u32 s64, s39, 0xf000
    buffer_load_dwordx4 v89, s[56:59], s64 offen lds
    ds_read_b64_tr_b16 a[32:33], v72 offset:16384
    ds_read_b64_tr_b16 a[34:35], v72 offset:16896
    ds_read_b64_tr_b16 a[36:37], v73 offset:16384
    ds_read_b64_tr_b16 a[38:39], v73 offset:16896
    ds_read_b64_tr_b16 a[40:41], v74 offset:16384
    ds_read_b64_tr_b16 a[42:43], v74 offset:16896
    ds_read_b64_tr_b16 a[44:45], v75 offset:16384
    ds_read_b64_tr_b16 a[46:47], v75 offset:16896
    s_waitcnt lgkmcnt(0)
    s_waitcnt vmcnt(28)
    s_barrier
    s_add_u32 m0, s40, 16384
    s_add_u32 s64, s39, 0x14000
    buffer_load_dwordx4 v89, s[56:59], s64 offen lds
    s_add_u32 m0, s40, 17408
    s_add_u32 s64, s39, 0x19000
    buffer_load_dwordx4 v89, s[56:59], s64 offen lds
    s_add_u32 m0, s40, 18432
    s_add_u32 s64, s39, 0x1e000
    buffer_load_dwordx4 v89, s[56:59], s64 offen lds
    s_add_u32 m0, s40, 19456
    s_add_u32 s64, s39, 0x23000
    buffer_load_dwordx4 v89, s[56:59], s64 offen lds
    ds_read_b64_tr_b16 a[48:49], v72 offset:20480
    ds_read_b64_tr_b16 a[50:51], v72 offset:20992
    ds_read_b64_tr_b16 a[52:53], v73 offset:20480
    ds_read_b64_tr_b16 a[54:55], v73 offset:20992
    ds_read_b64_tr_b16 a[56:57], v74 offset:20480
    ds_read_b64_tr_b16 a[58:59], v74 offset:20992
    ds_read_b64_tr_b16 a[60:61], v75 offset:20480
    ds_read_b64_tr_b16 a[62:63], v75 offset:20992
    s_waitcnt lgkmcnt(0)
    s_waitcnt vmcnt(28)
    s_barrier
    s_add_u32 m0, s40, 20480
    s_add_u32 s64, s39, 0x100
    buffer_load_dwordx4 v89, s[56:59], s64 offen lds
    s_add_u32 m0, s40, 21504
    s_add_u32 s64, s39, 0x5100
    buffer_load_dwordx4 v89, s[56:59], s64 offen lds
    s_add_u32 m0, s40, 22528
    s_add_u32 s64, s39, 0xa100
    buffer_load_dwordx4 v89, s[56:59], s64 offen lds
    s_add_u32 m0, s40, 23552
    s_add_u32 s64, s39, 0xf100
    buffer_load_dwordx4 v89, s[56:59], s64 offen lds
    ds_read_b64_tr_b16 a[64:65], v72 offset:24576
    ds_read_b64_tr_b16 a[66:67], v72 offset:25088
    ds_read_b64_tr_b16 a[68:69], v73 offset:24576
    ds_read_b64_tr_b16 a[70:71], v73 offset:25088
    ds_read_b64_tr_b16 a[72:73], v74 offset:24576
    ds_read_b64_tr_b16 a[74:75], v74 offset:25088
    ds_read_b64_tr_b16 a[76:77], v75 offset:24576
    ds_read_b64_tr_b16 a[78:79], v75 offset:25088
    s_waitcnt lgkmcnt(0)
    s_waitcnt vmcnt(28)
    s_barrier
    s_add_u32 m0, s40, 24576
    s_add_u32 s64, s39, 0x14100
    buffer_load_dwordx4 v89, s[56:59], s64 offen lds
    s_add_u32 m0, s40, 25600
    s_add_u32 s64, s39, 0x19100
    buffer_load_dwordx4 v89, s[56:59], s64 offen lds
    s_add_u32 m0, s40, 26624
    s_add_u32 s64, s39, 0x1e100
    buffer_load_dwordx4 v89, s[56:59], s64 offen lds
    s_add_u32 m0, s40, 27648
    s_add_u32 s64, s39, 0x23100
    buffer_load_dwordx4 v89, s[56:59], s64 offen lds
    ds_read_b64_tr_b16 a[80:81], v72 offset:28672
    ds_read_b64_tr_b16 a[82:83], v72 offset:29184
    ds_read_b64_tr_b16 a[84:85], v73 offset:28672
    ds_read_b64_tr_b16 a[86:87], v73 offset:29184
    ds_read_b64_tr_b16 a[88:89], v74 offset:28672
    ds_read_b64_tr_b16 a[90:91], v74 offset:29184
    ds_read_b64_tr_b16 a[92:93], v75 offset:28672
    ds_read_b64_tr_b16 a[94:95], v75 offset:29184
    s_waitcnt lgkmcnt(0)
    s_waitcnt vmcnt(28)
    s_barrier
    s_add_u32 m0, s40, 28672
    s_add_u32 s64, s41, 0x0
    buffer_load_dwordx4 v90, s[56:59], s64 offen lds
    s_add_u32 m0, s40, 29696
    s_add_u32 s64, s41, 0xa000
    buffer_load_dwordx4 v90, s[56:59], s64 offen lds
    s_add_u32 m0, s40, 30720
    s_add_u32 s64, s41, 0x14000
    buffer_load_dwordx4 v90, s[56:59], s64 offen lds
    s_add_u32 m0, s40, 31744
    s_add_u32 s64, s41, 0x1e000
    buffer_load_dwordx4 v90, s[56:59], s64 offen lds
    ds_read_b64_tr_b16 a[96:97], v72 offset:32768
    ds_read_b64_tr_b16 a[98:99], v72 offset:33280
    ds_read_b64_tr_b16 a[100:101], v73 offset:32768
    ds_read_b64_tr_b16 a[102:103], v73 offset:33280
    ds_read_b64_tr_b16 a[104:105], v74 offset:32768
    ds_read_b64_tr_b16 a[106:107], v74 offset:33280
    ds_read_b64_tr_b16 a[108:109], v75 offset:32768
    ds_read_b64_tr_b16 a[110:111], v75 offset:33280
    s_waitcnt lgkmcnt(0)
    s_waitcnt vmcnt(28)
    s_barrier
    s_add_u32 m0, s40, 32768
    s_add_u32 s64, s72, 0x180000
    buffer_load_dwordx4 v76, s[48:51], s64 offen lds
    s_add_u32 m0, s40, 33792
    s_add_u32 s64, s72, 0x188000
    buffer_load_dwordx4 v77, s[48:51], s64 offen lds
    s_add_u32 m0, s40, 34816
    s_add_u32 s64, s72, 0x190000
    buffer_load_dwordx4 v78, s[48:51], s64 offen lds
    s_add_u32 m0, s40, 35840
    s_add_u32 s64, s72, 0x198000
    buffer_load_dwordx4 v79, s[48:51], s64 offen lds
    v_lshlrev_b32 v80, 2, v0
    buffer_load_dword v81, v80, s[60:63], 0 offen sc1
    ds_read_b64_tr_b16 a[112:113], v72 offset:0
    ds_read_b64_tr_b16 a[114:115], v72 offset:512
    ds_read_b64_tr_b16 a[116:117], v73 offset:0
    ds_read_b64_tr_b16 a[118:119], v73 offset:512
    ds_read_b64_tr_b16 a[120:121], v74 offset:0
    ds_read_b64_tr_b16 a[122:123], v74 offset:512
    ds_read_b64_tr_b16 a[124:125], v75 offset:0
    ds_read_b64_tr_b16 a[126:127], v75 offset:512
    s_waitcnt lgkmcnt(0)
    s_waitcnt vmcnt(29)
    s_barrier
    s_add_u32 m0, s40, 0
    s_add_u32 s64, s71, 0x0
    buffer_load_dwordx4 v76, s[48:51], s64 offen lds
    s_add_u32 m0, s40, 1024
    s_add_u32 s64, s71, 0x8000
    buffer_load_dwordx4 v77, s[48:51], s64 offen lds
    s_add_u32 m0, s40, 2048
    s_add_u32 s64, s71, 0x10000
    buffer_load_dwordx4 v78, s[48:51], s64 offen lds
    s_add_u32 m0, s40, 3072
    s_add_u32 s64, s71, 0x18000
    buffer_load_dwordx4 v79, s[48:51], s64 offen lds
    ds_read_b64_tr_b16 a[128:129], v72 offset:4096
    ds_read_b64_tr_b16 a[130:131], v72 offset:4608
    ds_read_b64_tr_b16 a[132:133], v73 offset:4096
    ds_read_b64_tr_b16 a[134:135], v73 offset:4608
    ds_read_b64_tr_b16 a[136:137], v74 offset:4096
    ds_read_b64_tr_b16 a[138:139], v74 offset:4608
    ds_read_b64_tr_b16 a[140:141], v75 offset:4096
    ds_read_b64_tr_b16 a[142:143], v75 offset:4608
    s_waitcnt lgkmcnt(0)
    s_waitcnt vmcnt(29)
    s_barrier
    s_add_u32 m0, s40, 4096
    s_add_u32 s64, s71, 0x80000
    buffer_load_dwordx4 v76, s[48:51], s64 offen lds
    s_add_u32 m0, s40, 5120
    s_add_u32 s64, s71, 0x88000
    buffer_load_dwordx4 v77, s[48:51], s64 offen lds
    s_add_u32 m0, s40, 6144
    s_add_u32 s64, s71, 0x90000
    buffer_load_dwordx4 v78, s[48:51], s64 offen lds
    s_add_u32 m0, s40, 7168
    s_add_u32 s64, s71, 0x98000
    buffer_load_dwordx4 v79, s[48:51], s64 offen lds
    ds_read_b64_tr_b16 a[144:145], v72 offset:8192
    ds_read_b64_tr_b16 a[146:147], v72 offset:8704
    ds_read_b64_tr_b16 a[148:149], v73 offset:8192
    ds_read_b64_tr_b16 a[150:151], v73 offset:8704
    ds_read_b64_tr_b16 a[152:153], v74 offset:8192
    ds_read_b64_tr_b16 a[154:155], v74 offset:8704
    ds_read_b64_tr_b16 a[156:157], v75 offset:8192
    ds_read_b64_tr_b16 a[158:159], v75 offset:8704
    s_waitcnt lgkmcnt(0)
    s_waitcnt vmcnt(29)
    s_barrier
    s_add_u32 m0, s40, 8192
    s_add_u32 s64, s71, 0x100000
    buffer_load_dwordx4 v76, s[48:51], s64 offen lds
    s_add_u32 m0, s40, 9216
    s_add_u32 s64, s71, 0x108000
    buffer_load_dwordx4 v77, s[48:51], s64 offen lds
    s_add_u32 m0, s40, 10240
    s_add_u32 s64, s71, 0x110000
    buffer_load_dwordx4 v78, s[48:51], s64 offen lds
    s_add_u32 m0, s40, 11264
    s_add_u32 s64, s71, 0x118000
    buffer_load_dwordx4 v79, s[48:51], s64 offen lds
    ds_read_b64_tr_b16 a[160:161], v93 offset:12288
    ds_read_b64_tr_b16 a[162:163], v93 offset:12544
    ds_read_b64_tr_b16 a[164:165], v93 offset:13312
    ds_read_b64_tr_b16 a[166:167], v93 offset:13568
    ds_read_b64_tr_b16 a[168:169], v93 offset:14336
    ds_read_b64_tr_b16 a[170:171], v93 offset:14592
    ds_read_b64_tr_b16 a[172:173], v93 offset:15360
    ds_read_b64_tr_b16 a[174:175], v93 offset:15616
    s_waitcnt lgkmcnt(0)
    s_waitcnt vmcnt(29)
    s_barrier
    s_add_u32 m0, s40, 12288
    s_add_u32 s64, s71, 0x180000
    buffer_load_dwordx4 v76, s[48:51], s64 offen lds
    s_add_u32 m0, s40, 13312
    s_add_u32 s64, s71, 0x188000
    buffer_load_dwordx4 v77, s[48:51], s64 offen lds
    s_add_u32 m0, s40, 14336
    s_add_u32 s64, s71, 0x190000
    buffer_load_dwordx4 v78, s[48:51], s64 offen lds
    s_add_u32 m0, s40, 15360
    s_add_u32 s64, s71, 0x198000
    buffer_load_dwordx4 v79, s[48:51], s64 offen lds
    ds_read_b64_tr_b16 a[176:177], v93 offset:16384
    ds_read_b64_tr_b16 a[178:179], v93 offset:16640
    ds_read_b64_tr_b16 a[180:181], v93 offset:17408
    ds_read_b64_tr_b16 a[182:183], v93 offset:17664
    ds_read_b64_tr_b16 a[184:185], v93 offset:18432
    ds_read_b64_tr_b16 a[186:187], v93 offset:18688
    ds_read_b64_tr_b16 a[188:189], v93 offset:19456
    ds_read_b64_tr_b16 a[190:191], v93 offset:19712
    s_waitcnt lgkmcnt(0)
    s_waitcnt vmcnt(29)
    s_barrier
    s_add_u32 m0, s40, 16384
    s_add_u32 s64, s71, 0x200000
    buffer_load_dwordx4 v76, s[48:51], s64 offen lds
    s_add_u32 m0, s40, 17408
    s_add_u32 s64, s71, 0x208000
    buffer_load_dwordx4 v77, s[48:51], s64 offen lds
    s_add_u32 m0, s40, 18432
    s_add_u32 s64, s71, 0x210000
    buffer_load_dwordx4 v78, s[48:51], s64 offen lds
    s_add_u32 m0, s40, 19456
    s_add_u32 s64, s71, 0x218000
    buffer_load_dwordx4 v79, s[48:51], s64 offen lds
    ds_read_b64_tr_b16 a[192:193], v93 offset:20480
    ds_read_b64_tr_b16 a[194:195], v93 offset:20736
    ds_read_b64_tr_b16 a[196:197], v93 offset:21504
    ds_read_b64_tr_b16 a[198:199], v93 offset:21760
    ds_read_b64_tr_b16 a[200:201], v93 offset:22528
    ds_read_b64_tr_b16 a[202:203], v93 offset:22784
    ds_read_b64_tr_b16 a[204:205], v93 offset:23552
    ds_read_b64_tr_b16 a[206:207], v93 offset:23808
    s_waitcnt lgkmcnt(0)
    s_waitcnt vmcnt(29)
    s_barrier
    s_add_u32 m0, s40, 20480
    s_add_u32 s64, s72, 0x0
    buffer_load_dwordx4 v76, s[48:51], s64 offen lds
    s_add_u32 m0, s40, 21504
    s_add_u32 s64, s72, 0x8000
    buffer_load_dwordx4 v77, s[48:51], s64 offen lds
    s_add_u32 m0, s40, 22528
    s_add_u32 s64, s72, 0x10000
    buffer_load_dwordx4 v78, s[48:51], s64 offen lds
    s_add_u32 m0, s40, 23552
    s_add_u32 s64, s72, 0x18000
    buffer_load_dwordx4 v79, s[48:51], s64 offen lds
    ds_read_b64_tr_b16 a[208:209], v93 offset:24576
    ds_read_b64_tr_b16 a[210:211], v93 offset:24832
    ds_read_b64_tr_b16 a[212:213], v93 offset:25600
    ds_read_b64_tr_b16 a[214:215], v93 offset:25856
    ds_read_b64_tr_b16 a[216:217], v93 offset:26624
    ds_read_b64_tr_b16 a[218:219], v93 offset:26880
    ds_read_b64_tr_b16 a[220:221], v93 offset:27648
    ds_read_b64_tr_b16 a[222:223], v93 offset:27904
    s_waitcnt lgkmcnt(0)
    s_waitcnt vmcnt(29)
    s_barrier
    s_add_u32 m0, s40, 24576
    s_add_u32 s64, s72, 0x80000
    buffer_load_dwordx4 v76, s[48:51], s64 offen lds
    s_add_u32 m0, s40, 25600
    s_add_u32 s64, s72, 0x88000
    buffer_load_dwordx4 v77, s[48:51], s64 offen lds
    s_add_u32 m0, s40, 26624
    s_add_u32 s64, s72, 0x90000
    buffer_load_dwordx4 v78, s[48:51], s64 offen lds
    s_add_u32 m0, s40, 27648
    s_add_u32 s64, s72, 0x98000
    buffer_load_dwordx4 v79, s[48:51], s64 offen lds
    ds_read_b64_tr_b16 a[224:225], v94 offset:28672
    ds_read_b64_tr_b16 a[226:227], v94 offset:28800
    ds_read_b64_tr_b16 a[228:229], v94 offset:29696
    ds_read_b64_tr_b16 a[230:231], v94 offset:29824
    ds_read_b64_tr_b16 a[232:233], v94 offset:30720
    ds_read_b64_tr_b16 a[234:235], v94 offset:30848
    ds_read_b64_tr_b16 a[236:237], v94 offset:31744
    ds_read_b64_tr_b16 a[238:239], v94 offset:31872
    s_waitcnt lgkmcnt(0)
    s_waitcnt vmcnt(29)
    s_barrier
    s_add_u32 m0, s40, 28672
    s_add_u32 s64, s72, 0x100000
    buffer_load_dwordx4 v76, s[48:51], s64 offen lds
    s_add_u32 m0, s40, 29696
    s_add_u32 s64, s72, 0x108000
    buffer_load_dwordx4 v77, s[48:51], s64 offen lds
    s_add_u32 m0, s40, 30720
    s_add_u32 s64, s72, 0x110000
    buffer_load_dwordx4 v78, s[48:51], s64 offen lds
    s_add_u32 m0, s40, 31744
    s_add_u32 s64, s72, 0x118000
    buffer_load_dwordx4 v79, s[48:51], s64 offen lds
    s_mov_b32 s65, 0x290800
    buffer_load_dword v84, off, s[4:7], s65 sc1
    buffer_load_dwordx2 v[82:83], off, s[4:7], s69 sc1
    ds_read_b64_tr_b16 v[12:13], v72 offset:32768
    ds_read_b64_tr_b16 v[14:15], v72 offset:33280
    ds_read_b64_tr_b16 v[16:17], v73 offset:32768
    ds_read_b64_tr_b16 v[18:19], v73 offset:33280
    ds_read_b64_tr_b16 v[20:21], v74 offset:32768
    ds_read_b64_tr_b16 v[22:23], v74 offset:33280
    ds_read_b64_tr_b16 v[24:25], v75 offset:32768
    ds_read_b64_tr_b16 v[26:27], v75 offset:33280
    s_waitcnt lgkmcnt(0)
    s_barrier
    ds_write_b128 v2, v[12:15] offset:32768
    ds_write_b128 v2, v[16:19] offset:33792
    ds_write_b128 v2, v[20:23] offset:34816
    ds_write_b128 v2, v[24:27] offset:35840
    s_waitcnt lgkmcnt(0)
    s_waitcnt vmcnt(30)
    s_barrier
    ds_read_b64_tr_b16 v[12:13], v72 offset:0
    ds_read_b64_tr_b16 v[14:15], v72 offset:512
    ds_read_b64_tr_b16 v[16:17], v73 offset:0
    ds_read_b64_tr_b16 v[18:19], v73 offset:512
    ds_read_b64_tr_b16 v[20:21], v74 offset:0
    ds_read_b64_tr_b16 v[22:23], v74 offset:512
    ds_read_b64_tr_b16 v[24:25], v75 offset:0
    ds_read_b64_tr_b16 v[26:27], v75 offset:512
    s_waitcnt lgkmcnt(0)
    s_barrier
    ds_write_b128 v2, v[12:15] offset:0
    ds_write_b128 v2, v[16:19] offset:1024
    ds_write_b128 v2, v[20:23] offset:2048
    ds_write_b128 v2, v[24:27] offset:3072
    s_waitcnt lgkmcnt(0)
    s_waitcnt vmcnt(26)
    s_barrier
    ds_read_b64_tr_b16 v[12:13], v72 offset:4096
    ds_read_b64_tr_b16 v[14:15], v72 offset:4608
    ds_read_b64_tr_b16 v[16:17], v73 offset:4096
    ds_read_b64_tr_b16 v[18:19], v73 offset:4608
    ds_read_b64_tr_b16 v[20:21], v74 offset:4096
    ds_read_b64_tr_b16 v[22:23], v74 offset:4608
    ds_read_b64_tr_b16 v[24:25], v75 offset:4096
    ds_read_b64_tr_b16 v[26:27], v75 offset:4608
    s_waitcnt lgkmcnt(0)
    s_barrier
    ds_write_b128 v2, v[12:15] offset:4096
    ds_write_b128 v2, v[16:19] offset:5120
    ds_write_b128 v2, v[20:23] offset:6144
    ds_write_b128 v2, v[24:27] offset:7168
    s_waitcnt lgkmcnt(0)
    s_waitcnt vmcnt(22)
    s_barrier
    ds_read_b64_tr_b16 v[12:13], v72 offset:8192
    ds_read_b64_tr_b16 v[14:15], v72 offset:8704
    ds_read_b64_tr_b16 v[16:17], v73 offset:8192
    ds_read_b64_tr_b16 v[18:19], v73 offset:8704
    ds_read_b64_tr_b16 v[20:21], v74 offset:8192
    ds_read_b64_tr_b16 v[22:23], v74 offset:8704
    ds_read_b64_tr_b16 v[24:25], v75 offset:8192
    ds_read_b64_tr_b16 v[26:27], v75 offset:8704
    s_waitcnt lgkmcnt(0)
    s_barrier
    ds_write_b128 v2, v[12:15] offset:8192
    ds_write_b128 v2, v[16:19] offset:9216
    ds_write_b128 v2, v[20:23] offset:10240
    ds_write_b128 v2, v[24:27] offset:11264
    s_waitcnt lgkmcnt(0)
    s_waitcnt vmcnt(18)
    s_barrier
    ds_read_b64_tr_b16 v[12:13], v72 offset:12288
    ds_read_b64_tr_b16 v[14:15], v72 offset:12800
    ds_read_b64_tr_b16 v[16:17], v73 offset:12288
    ds_read_b64_tr_b16 v[18:19], v73 offset:12800
    ds_read_b64_tr_b16 v[20:21], v74 offset:12288
    ds_read_b64_tr_b16 v[22:23], v74 offset:12800
    ds_read_b64_tr_b16 v[24:25], v75 offset:12288
    ds_read_b64_tr_b16 v[26:27], v75 offset:12800
    s_waitcnt lgkmcnt(0)
    s_barrier
    ds_write_b128 v2, v[12:15] offset:12288
    ds_write_b128 v2, v[16:19] offset:13312
    ds_write_b128 v2, v[20:23] offset:14336
    ds_write_b128 v2, v[24:27] offset:15360
    s_waitcnt lgkmcnt(0)
    s_waitcnt vmcnt(14)
    s_barrier
    ds_read_b64_tr_b16 v[12:13], v72 offset:16384
    ds_read_b64_tr_b16 v[14:15], v72 offset:16896
    ds_read_b64_tr_b16 v[16:17], v73 offset:16384
    ds_read_b64_tr_b16 v[18:19], v73 offset:16896
    ds_read_b64_tr_b16 v[20:21], v74 offset:16384
    ds_read_b64_tr_b16 v[22:23], v74 offset:16896
    ds_read_b64_tr_b16 v[24:25], v75 offset:16384
    ds_read_b64_tr_b16 v[26:27], v75 offset:16896
    s_waitcnt lgkmcnt(0)
    s_barrier
    ds_write_b128 v2, v[12:15] offset:16384
    ds_write_b128 v2, v[16:19] offset:17408
    ds_write_b128 v2, v[20:23] offset:18432
    ds_write_b128 v2, v[24:27] offset:19456
    s_waitcnt lgkmcnt(0)
    s_waitcnt vmcnt(10)
    s_barrier
    ds_read_b64_tr_b16 v[12:13], v72 offset:20480
    ds_read_b64_tr_b16 v[14:15], v72 offset:20992
    ds_read_b64_tr_b16 v[16:17], v73 offset:20480
    ds_read_b64_tr_b16 v[18:19], v73 offset:20992
    ds_read_b64_tr_b16 v[20:21], v74 offset:20480
    ds_read_b64_tr_b16 v[22:23], v74 offset:20992
    ds_read_b64_tr_b16 v[24:25], v75 offset:20480
    ds_read_b64_tr_b16 v[26:27], v75 offset:20992
    s_waitcnt lgkmcnt(0)
    s_barrier
    ds_write_b128 v2, v[12:15] offset:20480
    ds_write_b128 v2, v[16:19] offset:21504
    ds_write_b128 v2, v[20:23] offset:22528
    ds_write_b128 v2, v[24:27] offset:23552
    s_waitcnt lgkmcnt(0)
    s_waitcnt vmcnt(6)
    s_barrier
    ds_read_b64_tr_b16 v[12:13], v72 offset:24576
    ds_read_b64_tr_b16 v[14:15], v72 offset:25088
    ds_read_b64_tr_b16 v[16:17], v73 offset:24576
    ds_read_b64_tr_b16 v[18:19], v73 offset:25088
    ds_read_b64_tr_b16 v[20:21], v74 offset:24576
    ds_read_b64_tr_b16 v[22:23], v74 offset:25088
    ds_read_b64_tr_b16 v[24:25], v75 offset:24576
    ds_read_b64_tr_b16 v[26:27], v75 offset:25088
    s_waitcnt lgkmcnt(0)
    s_barrier
    ds_write_b128 v2, v[12:15] offset:24576
    ds_write_b128 v2, v[16:19] offset:25600
    ds_write_b128 v2, v[20:23] offset:26624
    ds_write_b128 v2, v[24:27] offset:27648
    s_waitcnt lgkmcnt(0)
    s_waitcnt vmcnt(2)
    s_barrier
    ds_read_b64_tr_b16 v[12:13], v72 offset:28672
    ds_read_b64_tr_b16 v[14:15], v72 offset:29184
    ds_read_b64_tr_b16 v[16:17], v73 offset:28672
    ds_read_b64_tr_b16 v[18:19], v73 offset:29184
    ds_read_b64_tr_b16 v[20:21], v74 offset:28672
    ds_read_b64_tr_b16 v[22:23], v74 offset:29184
    ds_read_b64_tr_b16 v[24:25], v75 offset:28672
    ds_read_b64_tr_b16 v[26:27], v75 offset:29184
    s_waitcnt lgkmcnt(0)
    s_barrier
    ds_write_b128 v2, v[12:15] offset:28672
    ds_write_b128 v2, v[16:19] offset:29696
    ds_write_b128 v2, v[20:23] offset:30720
    ds_write_b128 v2, v[24:27] offset:31744
    s_waitcnt lgkmcnt(0)
    s_waitcnt vmcnt(0)
    s_cmp_lg_u32 s97, 0
    s_cbranch_scc1 NOTEARLY_8
    v_cmp_ne_u32 vcc, 32, v81
    v_readlane_b32 s64, v81, 1
    v_readlane_b32 s66, v81, 33
    v_readlane_b32 s67, v81, 34
    s_and_b32 s65, vcc_lo, 0x01010101
    s_cbranch_scc1 NOTEARLY_8
    s_and_b32 s65, vcc_hi, 0x01010101
    s_cbranch_scc1 NOTEARLY_8
    s_cmp_lt_u32 s64, 186
    s_cbranch_scc1 NOTEARLY_8
    v_readfirstlane_b32 s64, v84
    s_cmp_lt_u32 s64, 192
    s_cbranch_scc1 NOTEARLY_8
    s_min_u32 s65, s66, s67
    s_cmp_eq_u32 s65, 0
    s_cbranch_scc1 NOTEARLY_8
    v_readlane_b32 s64, v81, 6
    v_readlane_b32 s65, v81, 7
    s_and_b32 s64, s64, s65
    s_cmp_eq_u32 s64, -1
    s_cselect_b32 s64, 0, s94
    s_cmp_lg_u32 s64, 0
    s_cbranch_scc1 M_GFAIL
    s_sub_u32 s66, s66, 1
    s_sub_u32 s67, s67, 1
    s_branch EARLY_7
NOTEARLY_8:
    s_cmp_lg_u32 s97, 0
    s_cbranch_scc1 CM_9
    v_mbcnt_lo_u32_b32 v0, -1, 0
    v_mbcnt_hi_u32_b32 v0, -1, v0
    v_mul_u32_u24 v8, 32, v0
    s_mov_b32 s64, 0x0
    s_mov_b32 s65, 0
    s_mov_b64 exec, 0xff
TK_10:
    buffer_load_dword v9, v8, s[60:63], s64 offen sc1
    s_add_u32 s65, s65, 1
    s_waitcnt vmcnt(0)
    s_mov_b32 s66, 0
    v_readlane_b32 s67, v9, 0
    s_add_u32 s66, s66, s67
    v_readlane_b32 s67, v9, 1
    s_add_u32 s66, s66, s67
    v_readlane_b32 s67, v9, 2
    s_add_u32 s66, s66, s67
    v_readlane_b32 s67, v9, 3
    s_add_u32 s66, s66, s67
    v_readlane_b32 s67, v9, 4
    s_add_u32 s66, s66, s67
    v_readlane_b32 s67, v9, 5
    s_add_u32 s66, s66, s67
    v_readlane_b32 s67, v9, 6
    s_add_u32 s66, s66, s67
    v_readlane_b32 s67, v9, 7
    s_add_u32 s66, s66, s67
    s_cmp_ge_u32 s66, 256
    s_cbranch_scc1 TKD_11
    s_cmp_gt_u32 s65, 262144
    s_cbranch_scc0 TK_10
TKD_11:
    v_cmp_ne_u32 vcc, 32, v9
    s_mov_b64 exec, -1
    s_cbranch_vccnz M_SLOW
CM_9:
    s_mov_b32 s65, 0
RI_12:
    buffer_load_dword v8, off, s[60:63], s95 sc1
    s_add_u32 s65, s65, 1
    s_waitcnt vmcnt(0)
    v_readfirstlane_b32 s64, v8
    s_cmp_ge_u32 s64, 186
    s_cbranch_scc1 RID_13
    s_cmp_gt_u32 s65, 65536
    s_cbranch_scc1 RID_13
    s_sleep 4
    s_branch RI_12
RID_13:
    s_mov_b32 s65, 0
    s_mov_b32 s66, 0x290800
RB_14:
    buffer_load_dword v8, off, s[4:7], s66 sc1
    s_add_u32 s65, s65, 1
    s_waitcnt vmcnt(0)
    v_readfirstlane_b32 s64, v8
    s_cmp_ge_u32 s64, 192
    s_cbranch_scc1 RBD_15
    s_cmp_gt_u32 s65, 65536
    s_cbranch_scc1 RBD_15
    s_sleep 8
    s_branch RB_14
RBD_15:
    s_cmp_eq_u32 s94, 0
    s_cbranch_scc1 GOK_16
    buffer_load_dwordx2 v[8:9], off, s[60:63], 0 offset:24 sc1
    s_waitcnt vmcnt(0)
    v_and_b32 v8, v8, v9
    s_nop 0
    v_readfirstlane_b32 s64, v8
    s_cmp_lg_u32 s64, -1
    s_cbranch_scc1 M_GFAIL
GOK_16:
    s_mov_b32 s65, 0
CW_17:
    buffer_load_dwordx2 v[8:9], off, s[60:63], 0 offset:132 sc1
    s_add_u32 s65, s65, 1
    s_waitcnt vmcnt(0)
    v_readfirstlane_b32 s66, v8
    v_readfirstlane_b32 s67, v9
    s_min_u32 s64, s66, s67
    s_cmp_lg_u32 s64, 0
    s_cbranch_scc1 CWD_18
    s_cmp_gt_u32 s65, 65536
    s_cbranch_scc1 CWD_18
    s_sleep 4
    s_branch CW_17
CWD_18:
    s_sub_u32 s66, s66, 1
    s_and_b32 s66, s66, 3
    s_sub_u32 s67, s67, 1
    s_and_b32 s67, s67, 3
EARLY_7:
    s_mov_b32 s56, s66
    s_mov_b32 s57, s67
    s_mov_b32 s38, 0x3f80
    s_mov_b32 s53, 0
    s_cmp_eq_u32 s14, 2
    s_cselect_b32 s52, 1024, 0
    s_cmp_eq_u32 s14, 3
    s_cselect_b32 s58, 0, 1
    s_mov_b32 s59, 0
    s_cmp_eq_u32 s12, 0
    s_cselect_b32 s55, 2, 0
    s_mov_b32 s44, 0x3030303
    s_mov_b32 s45, 0x3030303
    s_mov_b32 s46, 0xc0c0c0c
    s_mov_b32 s47, 0xc0c0c0c
    s_mov_b32 s48, 0x30303030
    s_mov_b32 s49, 0x30303030
    s_mov_b32 s50, 0xc0c0c0c0
    s_mov_b32 s51, 0xc0c0c0c0
    v_and_b32 v8, 7, v0
    v_mul_u32_u24 v8, 288, v8
    v_lshrrev_b32 v9, 4, v0
    v_lshl_add_u32 v8, v9, 4, v8
    v_add_u32 v0, 12800, v8
    s_mov_b32 s68, 0
    s_mov_b32 s40, 0
    s_mov_b32 s64, s56
    s_mov_b32 s65, s57
    s_cmp_eq_u32 s12, 0
    s_cselect_b32 s66, s65, s64
    s_cselect_b32 s64, s64, s65
    s_and_b32 s64, s64, 3
    s_lshl_b32 s64, s64, 13
    s_and_b32 s66, s66, 3
    s_lshl_b32 s66, s66, 13
    s_add_u32 s21, s21, s64
    s_add_u32 s20, s20, s66
    s_cmp_eq_u32 s42, 0
    s_cselect_b32 s18, 0x40000000, s18
    s_cselect_b32 s21, 0x40000000, s21
    s_lshl_b32 s65, s12, 7
    s_add_u32 s65, s65, 0x29a000
    s_cmp_eq_u32 s22, 0
    s_cselect_b32 s22, 0x40000000, s65
    s_lshl_b32 s64, s13, 2
    s_add_u32 s64, s64, s14
    s_cmp_ge_u32 s64, 40
    s_cselect_b32 s65, 40, 0
    s_sub_u32 s64, s64, s65
    s_cmp_ge_u32 s64, 40
    s_cselect_b32 s65, 40, 0
    s_sub_u32 s64, s64, s65
    s_cmp_ge_u32 s64, 40
    s_cselect_b32 s65, 40, 0
    s_sub_u32 s64, s64, s65
    s_lshl_b32 s27, s64, 7
    s_add_u32 s19, s27, 0x4000
    v_and_b32 v82, v82, v83
    v_cmp_eq_u32 vcc, 0, v82
    s_cmp_lg_u32 s97, 0
    s_cselect_b64 vcc, -1, vcc
    s_cbranch_vccz KVOK_19
    v_mov_b32 v29, 0
FSPIN_20:
    buffer_load_dwordx2 v[12:13], v29, s[4:7], s69 offen sc1
    s_add_u32 s68, s68, 1
    s_waitcnt vmcnt(0)
    v_and_b32 v12, v12, v13
    v_cmp_eq_u32 vcc, 0, v12
    s_cbranch_vccz FDONE_21
    s_cmp_gt_u32 s68, 262144
    s_cbranch_scc0 FSPIN_20
FDONE_21:
KVOK_19:
    s_barrier
    s_mov_b32 m0, s73
    s_nop 0
    buffer_load_dwordx4 v1, s[4:7], s28 offen lds
    buffer_load_dwordx4 v1, s[4:7], s28 offen offset:1024 lds
    s_mov_b32 m0, 16128
    v_lshlrev_b32 v12, 2, v1
    s_add_u32 s65, s3, 0xfff80000
    buffer_load_dword v12, s[4:7], s65 offen lds
    s_mov_b32 s15, 0
    s_mov_b32 s16, 0
    s_add_u32 s66, s17, s52
    buffer_load_dwordx4 v[12:15], v1, s[4:7], s66 offen sc1
    buffer_load_dwordx4 v[16:19], v1, s[4:7], s17 offen offset:2048 sc1
    v_add_u32 v29, s52, v1
    s_waitcnt vmcnt(0)
    ds_write_b128 v29, v[12:15] offset:12800
    ds_write_b128 v1, v[16:19] offset:15104
    s_waitcnt lgkmcnt(0)
    v_mov_b64 v[32:33], 0
    v_mov_b64 v[34:35], 0
    v_mov_b64 v[36:37], 0
    v_mov_b64 v[38:39], 0
    v_mov_b64 v[40:41], 0
    v_mov_b64 v[42:43], 0
    v_mov_b64 v[44:45], 0
    v_mov_b64 v[46:47], 0
    v_mov_b64 v[48:49], 0
    v_mov_b64 v[50:51], 0
    v_mov_b64 v[52:53], 0
    v_mov_b64 v[54:55], 0
    v_mov_b32 v9, 0x40000000
    ds_read_b128 v[56:59], v2 offset:0
    ds_read_b128 v[60:63], v2 offset:1024
    ds_read_b128 v[64:67], v2 offset:2048
    ds_read_b128 v[68:71], v2 offset:3072
    s_cmp_eq_u32 s97, 0
    s_cbranch_scc1 REC_LOOP
    s_branch REC_LOOP_S
REC_POLL_S:
    s_cmp_eq_u32 s59, 0
    s_cbranch_scc1 NOFLG_22
    s_waitcnt vmcnt(0)
    v_lshrrev_b32 v29, 2, v1
    ds_read_b32 v12, v29 offset:15104
    s_add_u32 s64, s15, 2
    s_lshr_b32 s65, s64, 1
    s_add_u32 s67, s65, 1
    s_waitcnt lgkmcnt(0)
    v_cmp_ne_u32 vcc, 0, v12
    v_readlane_b32 s65, v12, s65
    v_readlane_b32 s67, v12, s67
    s_cmp_eq_u32 vcc_lo, -1
    s_cselect_b32 s58, 1, 0
    s_and_b32 s65, s65, s67
    s_cbranch_scc1 NOFLG_22
    s_lshl_b32 s64, s64, 7
    s_add_u32 s64, s64, s69
    v_mov_b32 v29, 0
FSPIN_24:
    buffer_load_dwordx2 v[12:13], v29, s[4:7], s64 offen sc1
    s_add_u32 s68, s68, 1
    s_waitcnt vmcnt(0)
    v_and_b32 v12, v12, v13
    v_cmp_eq_u32 vcc, 0, v12
    s_cbranch_vccz FDONE_25
    s_cmp_gt_u32 s68, 262144
    s_cbranch_scc0 FSPIN_24
FDONE_25:
NOFLG_22:
    s_add_u32 s64, s15, 3
    s_and_b32 s64, s64, 0x43
    s_or_b32 s64, s64, s58
    s_cmp_eq_u32 s64, 0
    s_cselect_b32 s59, 1, 0
    s_cmp_eq_u32 s15, 63
    s_cselect_b32 s59, s55, s59
    s_add_u32 s66, s17, s52
    v_add_u32 v10, s52, v1
    s_xor_b32 s16, s16, 1
    v_mov_b64 v[32:33], 0
    v_mov_b64 v[34:35], 0
    v_mov_b64 v[36:37], 0
    v_mov_b64 v[38:39], 0
    v_mov_b64 v[40:41], 0
    v_mov_b64 v[42:43], 0
    v_mov_b64 v[44:45], 0
    v_mov_b64 v[46:47], 0
    v_mov_b64 v[48:49], 0
    v_mov_b64 v[50:51], 0
    v_mov_b64 v[52:53], 0
    v_mov_b64 v[54:55], 0
    ds_read_b128 v[56:59], v2 offset:0
    ds_read_b128 v[60:63], v2 offset:1024
    ds_read_b128 v[64:67], v2 offset:2048
    ds_read_b128 v[68:71], v2 offset:3072
    s_barrier
    s_nop 14
    buffer_load_dwordx4 v[20:23], v1, s[4:7], s66 offen offset:0 sc1
    s_nop 7
    buffer_load_dwordx4 v[24:27], v1, s[4:7], s66 offen offset:0 sc1
    s_nop 7
    buffer_load_dwordx4 v[28:31], v1, s[4:7], s66 offen offset:0 sc1
IPOLL_27:
    s_waitcnt vmcnt(2)
    ds_write_b128 v10, v[20:23] offset:12800
    v_max3_u32 v11, v20, v21, v22
    v_max_u32 v11, v11, v23
    v_cmp_eq_u32 vcc, -1, v11
    s_cbranch_vccz IOK_26
    buffer_load_dwordx4 v[20:23], v1, s[4:7], s66 offen offset:0 sc1
    s_waitcnt vmcnt(2)
    ds_write_b128 v10, v[24:27] offset:12800
    v_max3_u32 v11, v24, v25, v26
    v_max_u32 v11, v11, v27
    v_cmp_eq_u32 vcc, -1, v11
    s_cbranch_vccz IOK_26
    buffer_load_dwordx4 v[24:27], v1, s[4:7], s66 offen offset:0 sc1
    s_waitcnt vmcnt(2)
    ds_write_b128 v10, v[28:31] offset:12800
    v_max3_u32 v11, v28, v29, v30
    v_max_u32 v11, v11, v31
    v_cmp_eq_u32 vcc, -1, v11
    s_add_u32 s68, s68, 1
    s_add_u32 s53, s53, 1
    s_cmp_gt_u32 s68, 262144
    s_cbranch_scc1 IOK_26
    s_cbranch_vccz IOK_26
    buffer_load_dwordx4 v[28:31], v1, s[4:7], s66 offen offset:0 sc1
    s_branch IPOLL_27
IOK_26:
    s_waitcnt lgkmcnt(0)
REC_LOOP_S:
    s_barrier
    ds_read_b128 v[12:15], v1 offset:12800
    ds_read_b128 v[16:19], v1 offset:13824
    buffer_load_dwordx4 v[20:23], v1, s[4:7], s17 offen offset:2048
    ds_read_b128 v[72:75], v2 offset:4096
    ds_read_b128 v[76:79], v2 offset:5120
    ds_read_b128 v[80:83], v2 offset:6144
    ds_read_b128 v[84:87], v2 offset:7168
    s_add_u32 s74, s17, 0x1000
    s_add_u32 s20, s20, 0x8000
    s_add_u32 s75, s20, 0x1000
    s_mov_b32 m0, 16128
    s_add_u32 s65, s20, s27
    s_waitcnt lgkmcnt(5)
    v_smfmac_f32_16x16x64_bf16 v[32:35], v[12:15], v[96:103], v6
    buffer_load_dwordx4 v[24:27], v1, s[4:7], s17 offen offset:3072
    v_smfmac_f32_16x16x64_bf16 v[36:39], v[12:15], v[104:111], v6
    v_smfmac_f32_16x16x64_bf16 v[40:43], v[12:15], v[56:63], v6
    buffer_load_dwordx4 v[28:31], v1, s[4:7], s74 offen offset:0
    ds_read_b128 v[56:59], v2 offset:8192
    ds_read_b128 v[60:63], v2 offset:9216
    v_smfmac_f32_16x16x64_bf16 v[44:47], v[12:15], v[64:71], v6
    ds_read_b128 v[64:67], v2 offset:10240
    ds_read_b128 v[68:71], v2 offset:11264
    s_waitcnt lgkmcnt(8)
    v_smfmac_f32_16x16x64_bf16 v[48:51], v[12:15], a[0:7], v6
    v_smfmac_f32_16x16x64_bf16 v[52:55], v[12:15], a[8:15], v6
    buffer_load_dwordx4 v[12:15], v1, s[4:7], s20 offen offset:0
    buffer_load_dword off, s[4:7], s65 lds
    v_smfmac_f32_16x16x64_bf16 v[32:35], v[16:19], v[112:119], v6
    v_smfmac_f32_16x16x64_bf16 v[36:39], v[16:19], v[120:127], v6
    s_waitcnt lgkmcnt(4)
    v_smfmac_f32_16x16x64_bf16 v[40:43], v[16:19], v[72:79], v6
    ds_read_b128 v[72:75], v2 offset:12288
    ds_read_b128 v[76:79], v2 offset:13312
    v_smfmac_f32_16x16x64_bf16 v[44:47], v[16:19], v[80:87], v6
    ds_read_b128 v[80:83], v2 offset:14336
    ds_read_b128 v[84:87], v2 offset:15360
    s_waitcnt vmcnt(4)
    v_cmp_eq_u32 vcc, -1, v23
    v_smfmac_f32_16x16x64_bf16 v[48:51], v[16:19], a[16:23], v6
    v_smfmac_f32_16x16x64_bf16 v[52:55], v[16:19], a[24:31], v6
    s_cbranch_vccnz RETRY_28
BACK_29:
    buffer_load_dwordx4 v[16:19], v1, s[4:7], s20 offen offset:1024
    v_smfmac_f32_16x16x64_bf16 v[32:35], v[20:23], v[128:135], v6
    v_smfmac_f32_16x16x64_bf16 v[36:39], v[20:23], v[136:143], v6
    s_waitcnt lgkmcnt(4)
    v_smfmac_f32_16x16x64_bf16 v[40:43], v[20:23], v[56:63], v6
    ds_read_b128 v[56:59], v2 offset:16384
    ds_read_b128 v[60:63], v2 offset:17408
    v_smfmac_f32_16x16x64_bf16 v[44:47], v[20:23], v[64:71], v6
    ds_read_b128 v[64:67], v2 offset:18432
    ds_read_b128 v[68:71], v2 offset:19456
    s_waitcnt vmcnt(4)
    v_cmp_eq_u32 vcc, -1, v27
    v_smfmac_f32_16x16x64_bf16 v[48:51], v[20:23], a[32:39], v6
    v_smfmac_f32_16x16x64_bf16 v[52:55], v[20:23], a[40:47], v6
    s_cbranch_vccnz RETRY_30
BACK_31:
    buffer_load_dwordx4 v[20:23], v1, s[4:7], s20 offen offset:2048
    v_smfmac_f32_16x16x64_bf16 v[32:35], v[24:27], v[144:151], v6
    v_smfmac_f32_16x16x64_bf16 v[36:39], v[24:27], v[152:159], v6
    s_waitcnt lgkmcnt(4)
    v_smfmac_f32_16x16x64_bf16 v[40:43], v[24:27], v[72:79], v6
    ds_read_b128 v[72:75], v2 offset:20480
    ds_read_b128 v[76:79], v2 offset:21504
    v_smfmac_f32_16x16x64_bf16 v[44:47], v[24:27], v[80:87], v6
    ds_read_b128 v[80:83], v2 offset:22528
    ds_read_b128 v[84:87], v2 offset:23552
    s_waitcnt vmcnt(4)
    v_cmp_eq_u32 vcc, -1, v31
    v_smfmac_f32_16x16x64_bf16 v[48:51], v[24:27], a[48:55], v6
    v_smfmac_f32_16x16x64_bf16 v[52:55], v[24:27], a[56:63], v6
    s_cbranch_vccnz RETRY_32
BACK_33:
    buffer_load_dwordx4 v[24:27], v1, s[4:7], s20 offen offset:3072
    v_smfmac_f32_16x16x64_bf16 v[32:35], v[28:31], v[160:167], v6
    v_smfmac_f32_16x16x64_bf16 v[36:39], v[28:31], v[168:175], v6
    s_waitcnt lgkmcnt(4)
    v_smfmac_f32_16x16x64_bf16 v[40:43], v[28:31], v[56:63], v6
    ds_read_b128 v[56:59], v2 offset:24576
    ds_read_b128 v[60:63], v2 offset:25600
    v_smfmac_f32_16x16x64_bf16 v[44:47], v[28:31], v[64:71], v6
    ds_read_b128 v[64:67], v2 offset:26624
    ds_read_b128 v[68:71], v2 offset:27648
    s_waitcnt vmcnt(4)
    v_cmp_eq_u32 vcc, -1, v15
    v_smfmac_f32_16x16x64_bf16 v[48:51], v[28:31], a[64:71], v6
    v_smfmac_f32_16x16x64_bf16 v[52:55], v[28:31], a[72:79], v6
    s_cbranch_vccnz RETRY_34
BACK_35:
    buffer_load_dwordx4 v[28:31], v1, s[4:7], s75 offen offset:0
    v_smfmac_f32_16x16x64_bf16 v[32:35], v[12:15], v[176:183], v6
    s_waitcnt vmcnt(3)
    v_cmp_eq_u32 vcc, -1, v19
    v_smfmac_f32_16x16x64_bf16 v[36:39], v[12:15], v[184:191], v6
    s_waitcnt lgkmcnt(4)
    v_smfmac_f32_16x16x64_bf16 v[40:43], v[12:15], v[72:79], v6
    ds_read_b128 v[72:75], v2 offset:28672
    ds_read_b128 v[76:79], v2 offset:29696
    v_smfmac_f32_16x16x64_bf16 v[44:47], v[12:15], v[80:87], v6
    ds_read_b128 v[80:83], v2 offset:30720
    ds_read_b128 v[84:87], v2 offset:31744
    buffer_load_dwordx4 v[88:91], v1, s[4:7], s29 offen offset:0
    s_cbranch_vccnz RETRY_36
BACK_37:
    v_smfmac_f32_16x16x64_bf16 v[32:35], v[16:19], v[192:199], v6
    s_waitcnt vmcnt(3)
    v_cmp_eq_u32 vcc, -1, v23
    v_smfmac_f32_16x16x64_bf16 v[36:39], v[16:19], v[200:207], v6
    s_waitcnt lgkmcnt(4)
    v_smfmac_f32_16x16x64_bf16 v[40:43], v[16:19], v[56:63], v6
    ds_read_b128 v[56:59], v2 offset:32768
    ds_read_b128 v[60:63], v2 offset:33792
    v_smfmac_f32_16x16x64_bf16 v[44:47], v[16:19], v[64:71], v6
    ds_read_b128 v[64:67], v2 offset:34816
    ds_read_b128 v[68:71], v2 offset:35840
    s_cbranch_vccnz RETRY_38
BACK_39:
    v_smfmac_f32_16x16x64_bf16 v[32:35], v[20:23], v[208:215], v6
    s_waitcnt vmcnt(2)
    v_cmp_eq_u32 vcc, -1, v27
    v_smfmac_f32_16x16x64_bf16 v[36:39], v[20:23], v[216:223], v6
    s_waitcnt lgkmcnt(4)
    v_smfmac_f32_16x16x64_bf16 v[40:43], v[20:23], v[72:79], v6
    ds_read_b128 v[72:75], v1 offset:0
    ds_read_b128 v[76:79], v1 offset:4096
    v_smfmac_f32_16x16x64_bf16 v[44:47], v[20:23], v[80:87], v6
    ds_read_b128 v[80:83], v1 offset:1024
    ds_read_b128 v[84:87], v1 offset:5120
    buffer_load_dwordx4 v[92:95], v1, s[4:7], s29 offen offset:1024
    s_cbranch_vccnz RETRY_40
BACK_41:
    v_smfmac_f32_16x16x64_bf16 v[32:35], v[24:27], v[224:231], v6
    s_waitcnt vmcnt(2)
    v_cmp_eq_u32 vcc, -1, v31
    v_smfmac_f32_16x16x64_bf16 v[36:39], v[24:27], v[232:239], v6
    s_waitcnt lgkmcnt(4)
    v_smfmac_f32_16x16x64_bf16 v[40:43], v[24:27], v[56:63], v6
    ds_read_b128 v[56:59], v1 offset:2048
    ds_read_b128 v[60:63], v1 offset:6144
    v_smfmac_f32_16x16x64_bf16 v[44:47], v[24:27], v[64:71], v6
    ds_read_b128 v[64:67], v1 offset:3072
    ds_read_b128 v[68:71], v1 offset:7168
    s_cbranch_vccnz RETRY_42
BACK_43:
    v_smfmac_f32_16x16x64_bf16 v[32:35], v[28:31], v[240:247], v6
    v_smfmac_f32_16x16x64_bf16 v[36:39], v[28:31], v[248:255], v6
    v_smfmac_f32_16x16x64_bf16 v[40:43], v[28:31], a[240:247], v6
    v_smfmac_f32_16x16x64_bf16 v[44:47], v[28:31], a[248:255], v6
    v_lshlrev_b32 v8, 2, v1
    s_add_u32 s65, s17, s19
    buffer_load_dword v8, s[4:7], s3 offen lds
    buffer_load_dword off, s[4:7], s65 sc1 lds
    buffer_store_dword v6, off, s[4:7], s22 sc1
    s_add_u32 s22, s22, 256
    s_cmp_eq_u32 s59, 0
    s_cbranch_scc1 KVLOOK_44
    s_cmp_eq_u32 s59, 1
    s_cbranch_scc1 KVL1_45
    s_lshl_b32 s64, s13, 13
    s_add_u32 s64, s64, 0x43c0000
    buffer_load_dwordx4 v[96:99], v1, s[4:7], s64 offen offset:0
    buffer_load_dwordx4 v[100:103], v1, s[4:7], s64 offen offset:1024
    buffer_load_dwordx4 v[104:107], v1, s[4:7], s64 offen offset:2048
    buffer_load_dwordx4 v[108:111], v1, s[4:7], s64 offen offset:3072
    s_add_u32 s64, s64, 0x1000
    buffer_load_dwordx4 v[112:115], v1, s[4:7], s64 offen offset:0
    buffer_load_dwordx4 v[116:119], v1, s[4:7], s64 offen offset:1024
    buffer_load_dwordx4 v[120:123], v1, s[4:7], s64 offen offset:2048
    buffer_load_dwordx4 v[124:127], v1, s[4:7], s64 offen offset:3072
    s_branch KVLOOK_44
KVL1_45:
    v_lshrrev_b32 v9, 5, v1
    v_lshlrev_b32 v9, 9, v9
    v_bfe_u32 v10, v1, 4, 1
    v_lshl_add_u32 v9, v10, 2, v9
    s_mov_b32 m0, 15104
    s_mov_b64 exec, s[34:35]
    buffer_load_dword v9, s[4:7], s69 offen sc1 lds
    s_mov_b64 exec, -1
    s_mov_b32 m0, 16128
KVLOOK_44:
    v_permlane32_swap_b32 v32, v36
    v_permlane32_swap_b32 v33, v37
    v_permlane32_swap_b32 v34, v38
    v_permlane32_swap_b32 v35, v39
    v_pk_add_f32 v[32:33], v[32:33], v[36:37]
    v_pk_add_f32 v[34:35], v[34:35], v[38:39]
    v_cvt_pk_bf16_f32 v36, v32, v33
    v_cvt_pk_bf16_f32 v37, v34, v35
    ds_write_b64 v3, v[36:37] offset:0
    v_permlane32_swap_b32 v40, v44
    v_permlane32_swap_b32 v41, v45
    v_permlane32_swap_b32 v42, v46
    v_permlane32_swap_b32 v43, v47
    v_pk_add_f32 v[40:41], v[40:41], v[44:45]
    v_pk_add_f32 v[42:43], v[42:43], v[46:47]
    v_cvt_pk_bf16_f32 v44, v40, v41
    v_cvt_pk_bf16_f32 v45, v42, v43
    ds_write_b64 v3, v[44:45] offset:2304
    v_smfmac_f32_16x16x64_bf16 v[48:51], v[12:15], a[80:87], v6
    v_smfmac_f32_16x16x64_bf16 v[52:55], v[12:15], a[88:95], v6
    v_smfmac_f32_16x16x64_bf16 v[48:51], v[16:19], a[96:103], v6
    v_smfmac_f32_16x16x64_bf16 v[52:55], v[16:19], a[104:111], v6
    s_waitcnt lgkmcnt(0)
    s_barrier
    ds_read_b64_tr_b16 v[32:33], v4 offset:0
    ds_read_b64_tr_b16 v[34:35], v4 offset:128
    ds_read_b64_tr_b16 v[36:37], v4 offset:256
    ds_read_b64_tr_b16 v[38:39], v4 offset:384
    s_cmp_eq_u32 s15, 63
    s_cbranch_scc1 REC_FINAL
    v_smfmac_f32_16x16x64_bf16 v[48:51], v[20:23], a[112:119], v6
    v_smfmac_f32_16x16x64_bf16 v[52:55], v[20:23], a[120:127], v6
    ds_read_b64_tr_b16 v[40:41], v4 offset:512
    ds_read_b64_tr_b16 v[42:43], v4 offset:640
    ds_read_b64_tr_b16 v[44:45], v4 offset:768
    ds_read_b64_tr_b16 v[46:47], v4 offset:896
    v_smfmac_f32_16x16x64_bf16 v[48:51], v[24:27], a[128:135], v6
    v_smfmac_f32_16x16x64_bf16 v[52:55], v[24:27], a[136:143], v6
    s_waitcnt lgkmcnt(4)
    v_mfma_f32_16x16x32_bf16 v[8:11], v[72:75], v[32:35], 0
    ds_read_b64_tr_b16 v[12:13], v4 offset:2304
    ds_read_b64_tr_b16 v[14:15], v4 offset:2432
    v_mfma_f32_16x16x32_bf16 v[8:11], v[80:83], v[36:39], v[8:11]
    ds_read_b64_tr_b16 v[16:17], v4 offset:2560
    ds_read_b64_tr_b16 v[18:19], v4 offset:2688
    s_waitcnt lgkmcnt(4)
    v_mfma_f32_16x16x32_bf16 v[8:11], v[56:59], v[40:43], v[8:11]
    ds_read_b64_tr_b16 v[56:57], v4 offset:2816
    ds_read_b64_tr_b16 v[58:59], v4 offset:2944
    v_mfma_f32_16x16x32_bf16 v[8:11], v[64:67], v[44:47], v[8:11]
    ds_read_b64_tr_b16 v[64:65], v4 offset:3072
    ds_read_b64_tr_b16 v[66:67], v4 offset:3200
    v_mfma_f32_16x16x32_bf16 v[72:75], v[76:79], v[32:35], 0
    v_mfma_f32_16x16x32_bf16 v[72:75], v[84:87], v[36:39], v[72:75]
    v_mfma_f32_16x16x32_bf16 v[72:75], v[60:63], v[40:43], v[72:75]
    v_mfma_f32_16x16x32_bf16 v[72:75], v[68:71], v[44:47], v[72:75]
    s_waitcnt lgkmcnt(4)
    v_mfma_f32_16x16x32_bf16 v[80:83], v[12:15], v[32:35], 0
    v_mfma_f32_16x16x32_bf16 v[80:83], v[16:19], v[36:39], v[80:83]
    s_waitcnt lgkmcnt(0)
    v_mfma_f32_16x16x32_bf16 v[80:83], v[56:59], v[40:43], v[80:83]
    v_mfma_f32_16x16x32_bf16 v[80:83], v[64:67], v[44:47], v[80:83]
    v_smfmac_f32_16x16x64_bf16 v[48:51], v[28:31], a[144:151], v6
    v_smfmac_f32_16x16x64_bf16 v[52:55], v[28:31], a[152:159], v6
    v_mov_b32 v24, 0x3f803f80
    v_mov_b32 v25, 0x3f803f80
    v_mov_b32 v26, 0x3f803f80
    v_mov_b32 v27, 0x3f803f80
    v_max3_f32 v20, v8, v9, v10
    v_max3_f32 v21, v11, v72, v73
    v_max3_f32 v20, v20, v21, v74
    v_max3_f32 v21, v80, v81, v82
    v_max3_f32 v20, v20, v75, v83
    v_max_f32 v20, v20, v21
    v_mov_b32 v21, v20
    v_cvt_pk_bf16_f32 v48, v48, v49
    v_cvt_pk_bf16_f32 v49, v50, v51
    v_permlane16_swap_b32 v20, v21
    v_max_f32 v20, v20, v21
    v_mov_b32 v21, v20
    v_cvt_pk_bf16_f32 v50, v52, v53
    v_cvt_pk_bf16_f32 v51, v54, v55
    v_permlane32_swap_b32 v20, v21
    v_max_f32 v20, v20, v21
    v_mul_f32 v22, s10, v20
    v_pk_fma_f32 v[8:9], v[8:9], s[10:11], v[22:23] op_sel_hi:[1,1,0] neg_lo:[0,0,1] neg_hi:[0,0,1]
    v_pk_fma_f32 v[10:11], v[10:11], s[10:11], v[22:23] op_sel_hi:[1,1,0] neg_lo:[0,0,1] neg_hi:[0,0,1]
    v_pk_fma_f32 v[72:73], v[72:73], s[10:11], v[22:23] op_sel_hi:[1,1,0] neg_lo:[0,0,1] neg_hi:[0,0,1]
    v_pk_fma_f32 v[74:75], v[74:75], s[10:11], v[22:23] op_sel_hi:[1,1,0] neg_lo:[0,0,1] neg_hi:[0,0,1]
    v_pk_fma_f32 v[80:81], v[80:81], s[10:11], v[22:23] op_sel_hi:[1,1,0] neg_lo:[0,0,1] neg_hi:[0,0,1]
    v_pk_fma_f32 v[82:83], v[82:83], s[10:11], v[22:23] op_sel_hi:[1,1,0] neg_lo:[0,0,1] neg_hi:[0,0,1]
    v_exp_f32 v8, v8
    v_exp_f32 v9, v9
    v_exp_f32 v10, v10
    v_exp_f32 v11, v11
    v_exp_f32 v72, v72
    v_exp_f32 v73, v73
    v_exp_f32 v74, v74
    v_exp_f32 v75, v75
    v_cvt_pk_bf16_f32 v32, v8, v9
    v_cvt_pk_bf16_f32 v33, v10, v11
    v_exp_f32 v80, v80
    v_exp_f32 v81, v81
    v_exp_f32 v82, v82
    v_exp_f32 v83, v83
    v_cvt_pk_bf16_f32 v34, v72, v73
    v_cvt_pk_bf16_f32 v35, v74, v75
    v_cndmask_b32 v12, 0, v24, s[34:35]
    v_cndmask_b32 v13, 0, v24, s[34:35]
    s_waitcnt vmcnt(3)
    v_mfma_f32_16x16x32_bf16 v[8:11], v[24:27], v[32:35], 0
    v_cvt_pk_bf16_f32 v36, v80, v81
    v_mfma_f32_16x16x32_bf16 v[40:43], v[88:91], v[32:35], 0
    v_cvt_pk_bf16_f32 v37, v82, v83
    v_mfma_f32_16x16x32_bf16 v[44:47], v[92:95], v[32:35], 0
    v_mfma_f32_16x16x16_bf16 v[8:11], v[12:13], v[36:37], v[8:11]
    v_mov_b64 v[72:73], 0
    v_mfma_f32_16x16x16_bf16 v[40:43], v[48:49], v[36:37], v[40:43]
    v_mov_b64 v[74:75], 0
    v_mfma_f32_16x16x16_bf16 v[44:47], v[50:51], v[36:37], v[44:47]
    v_mov_b64 v[76:77], 0
    v_mov_b64 v[78:79], 0
    v_mov_b64 v[80:81], 0
    v_mov_b64 v[82:83], 0
    v_rcp_f32 v22, v8
    s_nop 2
    v_cndmask_b32 v40, v44, v40, s[32:33]
    v_cndmask_b32 v41, v45, v41, s[32:33]
    v_cndmask_b32 v42, v46, v42, s[32:33]
    v_cndmask_b32 v43, v47, v43, s[32:33]
    v_pk_mul_f32 v[40:41], v[40:41], v[22:23] op_sel_hi:[1,0]
    v_pk_mul_f32 v[42:43], v[42:43], v[22:23] op_sel_hi:[1,0]
    v_cvt_pk_bf16_f32 v44, v40, v41
    v_cvt_pk_bf16_f32 v45, v42, v43
    ds_write_b64 v5, v[44:45]
    s_mov_b32 m0, s73
    s_add_u32 s28, s28, 0x80000
    buffer_load_dwordx4 v1, s[4:7], s28 offen lds
    buffer_load_dwordx4 v1, s[4:7], s28 offen offset:1024 lds
    v_and_b32 v9, 0x70, v1
    v_bfe_u32 v29, v1, 8, 1
    v_lshl_add_u32 v9, v29, 3, v9
    v_bfe_u32 v29, v1, 9, 1
    v_lshl_add_u32 v9, v29, 2, v9
    v_mov_b32 v29, 0x40000000
    s_waitcnt lgkmcnt(0)
    s_barrier
    ds_read_b128 v[12:15], v0 offset:0
    ds_read_b128 v[16:19], v0 offset:64
    ds_read_b128 v[20:23], v0 offset:128
    ds_read_b128 v[24:27], v0 offset:192
    v_cndmask_b32 v9, v29, v9, s[32:33]
    v_and_b32 v29, 16, v1
    v_lshlrev_b32 v29, v29, s38
    v_cndmask_b32 v88, 0, v29, s[44:45]
    v_cndmask_b32 v89, 0, v29, s[46:47]
    v_cndmask_b32 v90, 0, v29, s[48:49]
    v_cndmask_b32 v91, 0, v29, s[50:51]
    s_waitcnt lgkmcnt(3)
    v_smfmac_f32_16x16x64_bf16 v[72:75], v[12:15], a[160:167], v6
    s_waitcnt lgkmcnt(2)
    v_smfmac_f32_16x16x64_bf16 v[72:75], v[16:19], a[168:175], v6
    s_waitcnt lgkmcnt(1)
    v_smfmac_f32_16x16x64_bf16 v[72:75], v[20:23], a[176:183], v6
    s_waitcnt lgkmcnt(0)
    v_smfmac_f32_16x16x64_bf16 v[72:75], v[24:27], a[184:191], v6
    v_smfmac_f32_16x16x64_bf16 v[76:79], v[12:15], a[192:199], v6
    v_smfmac_f32_16x16x64_bf16 v[76:79], v[16:19], a[200:207], v6
    v_cvt_pk_bf16_f32 v72, v72, v73
    v_smfmac_f32_16x16x64_bf16 v[76:79], v[20:23], a[208:215], v6
    v_cvt_pk_bf16_f32 v73, v74, v75
    v_smfmac_f32_16x16x64_bf16 v[76:79], v[24:27], a[216:223], v6
    v_and_or_b32 v72, v72, -2, s16
    v_mfma_f32_16x16x32_bf16 v[80:83], v[12:15], a[224:227], 0
    buffer_store_dwordx2 v[72:73], v7, s[4:7], s23 offen sc1
    v_mfma_f32_16x16x32_bf16 v[80:83], v[16:19], a[228:231], v[80:83]
    v_mfma_f32_16x16x32_bf16 v[80:83], v[20:23], a[232:235], v[80:83]
    v_cvt_pk_bf16_f32 v76, v76, v77
    v_cvt_pk_bf16_f32 v77, v78, v79
    v_mfma_f32_16x16x32_bf16 v[80:83], v[24:27], a[236:239], v[80:83]
    v_and_or_b32 v76, v76, -2, s16
    buffer_store_dwordx2 v[76:77], v7, s[4:7], s25 offen sc1
    s_add_u32 s17, s17, 0x4000
    s_add_u32 s3, s3, 0x80000
    s_add_u32 s29, s29, 0x80000
    s_add_u32 s18, s18, 0x4000
    s_add_u32 s21, s21, 0x8000
    s_add_u32 s15, s15, 1
    s_nop 0
    v_cvt_pk_bf16_f32 v80, v80, v81
    v_cvt_pk_bf16_f32 v81, v82, v83
    v_and_or_b32 v80, v80, -2, s16
    s_mov_b64 exec, s[34:35]
    buffer_store_dwordx2 v[80:81], v7, s[4:7], s26 offen sc1
    s_mov_b64 exec, -1
    s_cmp_lg_u32 s42, 0
    s_cbranch_scc1 OWN_47
    s_cmp_lt_u32 s14, 2
    s_cbranch_scc1 IDLE_46
    s_branch REC_POLL_S
OWN_47:
    s_nop 15
    s_nop 13
    buffer_load_dwordx4 v[12:15], v1, s[4:7], s24 offen offset:0 sc1
    buffer_load_dwordx4 v[16:19], v1, s[4:7], s24 offen offset:1024 sc1
    buffer_load_dwordx4 v[20:23], v1, s[4:7], s24 offen offset:2048 sc1
    buffer_load_dwordx4 v[24:27], v1, s[4:7], s24 offen offset:3072 sc1
    ds_read_b128 v[56:59], v2 offset:0
    ds_read_b128 v[60:63], v2 offset:1024
    ds_read_b128 v[64:67], v2 offset:2048
    ds_read_b128 v[68:71], v2 offset:3072
    v_mov_b64 v[32:33], 0
    v_mov_b64 v[34:35], 0
    v_mov_b64 v[36:37], 0
    v_mov_b64 v[38:39], 0
    v_mov_b64 v[40:41], 0
    v_mov_b64 v[42:43], 0
    v_mov_b64 v[44:45], 0
    v_mov_b64 v[46:47], 0
    buffer_load_dwordx4 v[72:75], v1, s[4:7], s24 offen offset:0 sc1
    buffer_load_dwordx4 v[76:79], v1, s[4:7], s24 offen offset:1024 sc1
    buffer_load_dwordx4 v[80:83], v1, s[4:7], s24 offen offset:2048 sc1
    buffer_load_dwordx4 v[84:87], v1, s[4:7], s24 offen offset:3072 sc1
    v_mov_b64 v[48:49], 0
    v_mov_b64 v[50:51], 0
    v_mov_b64 v[52:53], 0
    v_mov_b64 v[54:55], 0
OPOLL_49:
    s_waitcnt vmcnt(7)
    v_mfma_f32_16x16x32_bf16 v[92:95], v[12:15], v[88:91], 0
    v_bitop3_b32 v10, v12, v14, s16 bitop3:0x7e
    s_waitcnt vmcnt(6)
    v_mfma_f32_16x16x32_bf16 v[92:95], v[16:19], v[88:91], v[92:95]
    v_bitop3_b32 v11, v16, v18, s16 bitop3:0x7e
    s_waitcnt vmcnt(5)
    v_mfma_f32_16x16x32_bf16 v[92:95], v[20:23], v[88:91], v[92:95]
    v_bitop3_b32 v30, v20, v22, s16 bitop3:0x7e
    s_waitcnt vmcnt(4)
    v_mfma_f32_16x16x32_bf16 v[92:95], v[24:27], v[88:91], v[92:95]
    v_bitop3_b32 v31, v24, v26, s16 bitop3:0x7e
    v_or3_b32 v10, v10, v11, v30
    v_bitop3_b32 v10, v10, v31, 1 bitop3:0xa8
    v_cmp_ne_u32 vcc, 0, v10
    s_nop 3
    s_cbranch_vccz ODONE_48
    s_add_u32 s40, s40, 1
    buffer_load_dwordx4 v[12:15], v1, s[4:7], s24 offen offset:0 sc1
    buffer_load_dwordx4 v[16:19], v1, s[4:7], s24 offen offset:1024 sc1
    buffer_load_dwordx4 v[20:23], v1, s[4:7], s24 offen offset:2048 sc1
    buffer_load_dwordx4 v[24:27], v1, s[4:7], s24 offen offset:3072 sc1
    s_waitcnt vmcnt(7)
    v_mfma_f32_16x16x32_bf16 v[92:95], v[72:75], v[88:91], 0
    v_bitop3_b32 v10, v72, v74, s16 bitop3:0x7e
    s_waitcnt vmcnt(6)
    v_mfma_f32_16x16x32_bf16 v[92:95], v[76:79], v[88:91], v[92:95]
    v_bitop3_b32 v11, v76, v78, s16 bitop3:0x7e
    s_waitcnt vmcnt(5)
    v_mfma_f32_16x16x32_bf16 v[92:95], v[80:83], v[88:91], v[92:95]
    v_bitop3_b32 v30, v80, v82, s16 bitop3:0x7e
    s_waitcnt vmcnt(4)
    v_mfma_f32_16x16x32_bf16 v[92:95], v[84:87], v[88:91], v[92:95]
    v_bitop3_b32 v31, v84, v86, s16 bitop3:0x7e
    v_or3_b32 v10, v10, v11, v30
    v_bitop3_b32 v10, v10, v31, 1 bitop3:0xa8
    v_cmp_ne_u32 vcc, 0, v10
    s_add_u32 s68, s68, 1
    s_cmp_gt_u32 s68, 262144
    s_cbranch_scc1 ODONE_48
    s_nop 0
    s_cbranch_vccz ODONE_48
    s_add_u32 s40, s40, 1
    buffer_load_dwordx4 v[72:75], v1, s[4:7], s24 offen offset:0 sc1
    buffer_load_dwordx4 v[76:79], v1, s[4:7], s24 offen offset:1024 sc1
    buffer_load_dwordx4 v[80:83], v1, s[4:7], s24 offen offset:2048 sc1
    buffer_load_dwordx4 v[84:87], v1, s[4:7], s24 offen offset:3072 sc1
    s_branch OPOLL_49
ODONE_48:
    v_permlane32_swap_b32 v92, v94
    v_permlane32_swap_b32 v93, v95
    v_add_f32 v92, v92, v94
    v_add_f32 v93, v93, v95
    v_cvt_pk_bf16_f32 v8, v92, v93
    buffer_store_dword v8, v9, s[4:7], s18 offen sc1
    s_cmp_eq_u32 s15, 63
    s_cselect_b32 s59, s55, 0
    s_barrier
    s_nop 15
    s_nop 15
    s_nop 12
    buffer_store_dword v8, v9, s[4:7], s21 offen sc1
    s_cmp_lt_u32 s15, 61
    s_cbranch_scc1 EFLG_50
    buffer_store_dword v6, off, s[4:7], s22 sc1
EFLG_50:
    s_xor_b32 s16, s16, 1
    s_waitcnt vmcnt(2) lgkmcnt(0)
    s_branch REC_LOOP_S
IDLE_46:
    s_barrier
    s_cmp_eq_u32 s15, 63
    s_cselect_b32 s59, s55, 0
    v_mov_b64 v[32:33], 0
    v_mov_b64 v[34:35], 0
    v_mov_b64 v[36:37], 0
    v_mov_b64 v[38:39], 0
    v_mov_b64 v[40:41], 0
    v_mov_b64 v[42:43], 0
    v_mov_b64 v[44:45], 0
    v_mov_b64 v[46:47], 0
    v_mov_b64 v[48:49], 0
    v_mov_b64 v[50:51], 0
    v_mov_b64 v[52:53], 0
    v_mov_b64 v[54:55], 0
    ds_read_b128 v[56:59], v2 offset:0
    ds_read_b128 v[60:63], v2 offset:1024
    ds_read_b128 v[64:67], v2 offset:2048
    ds_read_b128 v[68:71], v2 offset:3072
    s_xor_b32 s16, s16, 1
    s_waitcnt vmcnt(0)
    s_branch REC_LOOP_S
REC_TAIL_S:
RETRY_28:
SPIN_51:
    buffer_load_dwordx4 v[20:23], v1, s[4:7], s17 offen offset:2048 sc1
    buffer_load_dwordx4 v[24:27], v1, s[4:7], s17 offen offset:3072 sc1
    buffer_load_dwordx4 v[28:31], v1, s[4:7], s74 offen offset:0 sc1
    s_add_u32 s68, s68, 1
    s_add_u32 s40, s40, 1024
    s_cmp_gt_u32 s68, 262144
    s_waitcnt vmcnt(0)
    s_cbranch_scc1 BACK_29
    v_cmp_eq_u32 vcc, -1, v23
    s_cbranch_vccnz SPIN_51
    s_branch BACK_29
RETRY_30:
SPIN_52:
    buffer_load_dwordx4 v[24:27], v1, s[4:7], s17 offen offset:3072 sc1
    buffer_load_dwordx4 v[28:31], v1, s[4:7], s74 offen offset:0 sc1
    s_add_u32 s68, s68, 1
    s_add_u32 s40, s40, 1024
    s_cmp_gt_u32 s68, 262144
    s_waitcnt vmcnt(0)
    s_cbranch_scc1 BACK_31
    v_cmp_eq_u32 vcc, -1, v27
    s_cbranch_vccnz SPIN_52
    s_branch BACK_31
RETRY_32:
SPIN_53:
    buffer_load_dwordx4 v[28:31], v1, s[4:7], s74 offen offset:0 sc1
    s_add_u32 s68, s68, 1
    s_add_u32 s40, s40, 1024
    s_cmp_gt_u32 s68, 262144
    s_waitcnt vmcnt(0)
    s_cbranch_scc1 BACK_33
    v_cmp_eq_u32 vcc, -1, v31
    s_cbranch_vccnz SPIN_53
    s_branch BACK_33
RETRY_34:
SPIN_54:
    buffer_load_dwordx4 v[12:15], v1, s[4:7], s20 offen offset:0 sc1
    buffer_load_dwordx4 v[16:19], v1, s[4:7], s20 offen offset:1024 sc1
    buffer_load_dwordx4 v[20:23], v1, s[4:7], s20 offen offset:2048 sc1
    buffer_load_dwordx4 v[24:27], v1, s[4:7], s20 offen offset:3072 sc1
    s_add_u32 s68, s68, 1
    s_add_u32 s40, s40, 1048576
    s_cmp_gt_u32 s68, 262144
    s_waitcnt vmcnt(0)
    s_cbranch_scc1 BACK_35
    v_cmp_eq_u32 vcc, -1, v15
    s_cbranch_vccnz SPIN_54
    s_branch BACK_35
RETRY_36:
SPIN_55:
    buffer_load_dwordx4 v[16:19], v1, s[4:7], s20 offen offset:1024 sc1
    buffer_load_dwordx4 v[20:23], v1, s[4:7], s20 offen offset:2048 sc1
    buffer_load_dwordx4 v[24:27], v1, s[4:7], s20 offen offset:3072 sc1
    buffer_load_dwordx4 v[28:31], v1, s[4:7], s75 offen offset:0 sc1
    s_add_u32 s68, s68, 1
    s_add_u32 s40, s40, 1048576
    s_cmp_gt_u32 s68, 262144
    s_waitcnt vmcnt(0)
    s_cbranch_scc1 BACK_37
    v_cmp_eq_u32 vcc, -1, v19
    s_cbranch_vccnz SPIN_55
    s_branch BACK_37
RETRY_38:
SPIN_56:
    buffer_load_dwordx4 v[20:23], v1, s[4:7], s20 offen offset:2048 sc1
    buffer_load_dwordx4 v[24:27], v1, s[4:7], s20 offen offset:3072 sc1
    buffer_load_dwordx4 v[28:31], v1, s[4:7], s75 offen offset:0 sc1
    s_add_u32 s68, s68, 1
    s_add_u32 s40, s40, 1048576
    s_cmp_gt_u32 s68, 262144
    s_waitcnt vmcnt(0)
    s_cbranch_scc1 BACK_39
    v_cmp_eq_u32 vcc, -1, v23
    s_cbranch_vccnz SPIN_56
    s_branch BACK_39
RETRY_40:
SPIN_57:
    buffer_load_dwordx4 v[24:27], v1, s[4:7], s20 offen offset:3072 sc1
    buffer_load_dwordx4 v[28:31], v1, s[4:7], s75 offen offset:0 sc1
    s_add_u32 s68, s68, 1
    s_add_u32 s40, s40, 1048576
    s_cmp_gt_u32 s68, 262144
    s_waitcnt vmcnt(0)
    s_cbranch_scc1 BACK_41
    v_cmp_eq_u32 vcc, -1, v27
    s_cbranch_vccnz SPIN_57
    s_branch BACK_41
RETRY_42:
SPIN_58:
    buffer_load_dwordx4 v[28:31], v1, s[4:7], s75 offen offset:0 sc1
    s_add_u32 s68, s68, 1
    s_add_u32 s40, s40, 1048576
    s_cmp_gt_u32 s68, 262144
    s_waitcnt vmcnt(0)
    s_cbranch_scc1 BACK_43
    v_cmp_eq_u32 vcc, -1, v31
    s_cbranch_vccnz SPIN_58
    s_branch BACK_43
REC_POLL:
    s_cmp_eq_u32 s59, 0
    s_cbranch_scc1 NOFLG_59
    s_waitcnt vmcnt(0)
    v_lshrrev_b32 v29, 2, v1
    ds_read_b32 v12, v29 offset:15104
    s_add_u32 s64, s15, 2
    s_lshr_b32 s65, s64, 1
    s_add_u32 s67, s65, 1
    s_waitcnt lgkmcnt(0)
    v_cmp_ne_u32 vcc, 0, v12
    v_readlane_b32 s65, v12, s65
    v_readlane_b32 s67, v12, s67
    s_cmp_eq_u32 vcc_lo, -1
    s_cselect_b32 s58, 1, 0
    s_and_b32 s65, s65, s67
    s_cbranch_scc1 NOFLG_59
    s_lshl_b32 s64, s64, 7
    s_add_u32 s64, s64, s69
    v_mov_b32 v29, 0
FSPIN_61:
    buffer_load_dwordx2 v[12:13], v29, s[4:7], s64 offen sc1
    s_add_u32 s68, s68, 1
    s_waitcnt vmcnt(0)
    v_and_b32 v12, v12, v13
    v_cmp_eq_u32 vcc, 0, v12
    s_cbranch_vccz FDONE_62
    s_cmp_gt_u32 s68, 262144
    s_cbranch_scc0 FSPIN_61
FDONE_62:
NOFLG_59:
    s_add_u32 s64, s15, 3
    s_and_b32 s64, s64, 0x43
    s_or_b32 s64, s64, s58
    s_cmp_eq_u32 s64, 0
    s_cselect_b32 s59, 1, 0
    s_cmp_eq_u32 s15, 63
    s_cselect_b32 s59, s55, s59
    s_add_u32 s66, s17, s52
    v_add_u32 v10, s52, v1
    s_xor_b32 s16, s16, 1
    v_mov_b64 v[32:33], 0
    v_mov_b64 v[34:35], 0
    v_mov_b64 v[36:37], 0
    v_mov_b64 v[38:39], 0
    v_mov_b64 v[40:41], 0
    v_mov_b64 v[42:43], 0
    v_mov_b64 v[44:45], 0
    v_mov_b64 v[46:47], 0
    v_mov_b64 v[48:49], 0
    v_mov_b64 v[50:51], 0
    v_mov_b64 v[52:53], 0
    v_mov_b64 v[54:55], 0
    ds_read_b128 v[56:59], v2 offset:0
    ds_read_b128 v[60:63], v2 offset:1024
    ds_read_b128 v[64:67], v2 offset:2048
    ds_read_b128 v[68:71], v2 offset:3072
    s_barrier
    s_nop 14
    buffer_load_dwordx4 v[20:23], v1, s[4:7], s66 offen offset:0 sc1
    s_nop 7
    buffer_load_dwordx4 v[24:27], v1, s[4:7], s66 offen offset:0 sc1
    s_nop 7
    buffer_load_dwordx4 v[28:31], v1, s[4:7], s66 offen offset:0 sc1
IPOLL_64:
    s_waitcnt vmcnt(2)
    ds_write_b128 v10, v[20:23] offset:12800
    v_max3_u32 v11, v20, v21, v22
    v_max_u32 v11, v11, v23
    v_cmp_eq_u32 vcc, -1, v11
    s_cbranch_vccz IOK_63
    buffer_load_dwordx4 v[20:23], v1, s[4:7], s66 offen offset:0 sc1
    s_waitcnt vmcnt(2)
    ds_write_b128 v10, v[24:27] offset:12800
    v_max3_u32 v11, v24, v25, v26
    v_max_u32 v11, v11, v27
    v_cmp_eq_u32 vcc, -1, v11
    s_cbranch_vccz IOK_63
    buffer_load_dwordx4 v[24:27], v1, s[4:7], s66 offen offset:0 sc1
    s_waitcnt vmcnt(2)
    ds_write_b128 v10, v[28:31] offset:12800
    v_max3_u32 v11, v28, v29, v30
    v_max_u32 v11, v11, v31
    v_cmp_eq_u32 vcc, -1, v11
    s_add_u32 s68, s68, 1
    s_add_u32 s53, s53, 1
    s_cmp_gt_u32 s68, 262144
    s_cbranch_scc1 IOK_63
    s_cbranch_vccz IOK_63
    buffer_load_dwordx4 v[28:31], v1, s[4:7], s66 offen offset:0 sc1
    s_branch IPOLL_64
IOK_63:
    s_waitcnt lgkmcnt(0)
REC_LOOP:
    s_barrier
    ds_read_b128 v[12:15], v1 offset:12800
    ds_read_b128 v[16:19], v1 offset:13824
    buffer_load_dwordx4 v[20:23], v1, s[4:7], s17 offen offset:2048
    ds_read_b128 v[72:75], v2 offset:4096
    ds_read_b128 v[76:79], v2 offset:5120
    ds_read_b128 v[80:83], v2 offset:6144
    ds_read_b128 v[84:87], v2 offset:7168
    s_add_u32 s74, s17, 0x1000
    s_add_u32 s20, s20, 0x8000
    s_add_u32 s75, s20, 0x1000
    s_mov_b32 m0, 16128
    s_add_u32 s65, s20, s27
    s_waitcnt lgkmcnt(5)
    v_smfmac_f32_16x16x64_bf16 v[32:35], v[12:15], v[96:103], v6
    buffer_load_dwordx4 v[24:27], v1, s[4:7], s17 offen offset:3072
    v_smfmac_f32_16x16x64_bf16 v[36:39], v[12:15], v[104:111], v6
    v_smfmac_f32_16x16x64_bf16 v[40:43], v[12:15], v[56:63], v6
    buffer_load_dwordx4 v[28:31], v1, s[4:7], s74 offen offset:0
    ds_read_b128 v[56:59], v2 offset:8192
    ds_read_b128 v[60:63], v2 offset:9216
    v_smfmac_f32_16x16x64_bf16 v[44:47], v[12:15], v[64:71], v6
    ds_read_b128 v[64:67], v2 offset:10240
    ds_read_b128 v[68:71], v2 offset:11264
    s_waitcnt lgkmcnt(8)
    v_smfmac_f32_16x16x64_bf16 v[48:51], v[12:15], a[0:7], v6
    v_smfmac_f32_16x16x64_bf16 v[52:55], v[12:15], a[8:15], v6
    buffer_load_dwordx4 v[12:15], v1, s[4:7], s20 offen offset:0
    buffer_load_dword off, s[4:7], s65 lds
    v_smfmac_f32_16x16x64_bf16 v[32:35], v[16:19], v[112:119], v6
    v_smfmac_f32_16x16x64_bf16 v[36:39], v[16:19], v[120:127], v6
    s_waitcnt lgkmcnt(4)
    v_smfmac_f32_16x16x64_bf16 v[40:43], v[16:19], v[72:79], v6
    ds_read_b128 v[72:75], v2 offset:12288
    ds_read_b128 v[76:79], v2 offset:13312
    v_smfmac_f32_16x16x64_bf16 v[44:47], v[16:19], v[80:87], v6
    ds_read_b128 v[80:83], v2 offset:14336
    ds_read_b128 v[84:87], v2 offset:15360
    s_waitcnt vmcnt(4)
    v_cmp_eq_u32 vcc, -1, v23
    v_smfmac_f32_16x16x64_bf16 v[48:51], v[16:19], a[16:23], v6
    v_smfmac_f32_16x16x64_bf16 v[52:55], v[16:19], a[24:31], v6
    s_cbranch_vccnz RETRY_65
BACK_66:
    buffer_load_dwordx4 v[16:19], v1, s[4:7], s20 offen offset:1024
    v_smfmac_f32_16x16x64_bf16 v[32:35], v[20:23], v[128:135], v6
    v_smfmac_f32_16x16x64_bf16 v[36:39], v[20:23], v[136:143], v6
    s_waitcnt lgkmcnt(4)
    v_smfmac_f32_16x16x64_bf16 v[40:43], v[20:23], v[56:63], v6
    ds_read_b128 v[56:59], v2 offset:16384
    ds_read_b128 v[60:63], v2 offset:17408
    v_smfmac_f32_16x16x64_bf16 v[44:47], v[20:23], v[64:71], v6
    ds_read_b128 v[64:67], v2 offset:18432
    ds_read_b128 v[68:71], v2 offset:19456
    s_waitcnt vmcnt(4)
    v_cmp_eq_u32 vcc, -1, v27
    v_smfmac_f32_16x16x64_bf16 v[48:51], v[20:23], a[32:39], v6
    v_smfmac_f32_16x16x64_bf16 v[52:55], v[20:23], a[40:47], v6
    s_cbranch_vccnz RETRY_67
BACK_68:
    buffer_load_dwordx4 v[20:23], v1, s[4:7], s20 offen offset:2048
    v_smfmac_f32_16x16x64_bf16 v[32:35], v[24:27], v[144:151], v6
    v_smfmac_f32_16x16x64_bf16 v[36:39], v[24:27], v[152:159], v6
    s_waitcnt lgkmcnt(4)
    v_smfmac_f32_16x16x64_bf16 v[40:43], v[24:27], v[72:79], v6
    ds_read_b128 v[72:75], v2 offset:20480
    ds_read_b128 v[76:79], v2 offset:21504
    v_smfmac_f32_16x16x64_bf16 v[44:47], v[24:27], v[80:87], v6
    ds_read_b128 v[80:83], v2 offset:22528
    ds_read_b128 v[84:87], v2 offset:23552
    s_waitcnt vmcnt(4)
    v_cmp_eq_u32 vcc, -1, v31
    v_smfmac_f32_16x16x64_bf16 v[48:51], v[24:27], a[48:55], v6
    v_smfmac_f32_16x16x64_bf16 v[52:55], v[24:27], a[56:63], v6
    s_cbranch_vccnz RETRY_69
BACK_70:
    buffer_load_dwordx4 v[24:27], v1, s[4:7], s20 offen offset:3072
    v_smfmac_f32_16x16x64_bf16 v[32:35], v[28:31], v[160:167], v6
    v_smfmac_f32_16x16x64_bf16 v[36:39], v[28:31], v[168:175], v6
    s_waitcnt lgkmcnt(4)
    v_smfmac_f32_16x16x64_bf16 v[40:43], v[28:31], v[56:63], v6
    ds_read_b128 v[56:59], v2 offset:24576
    ds_read_b128 v[60:63], v2 offset:25600
    v_smfmac_f32_16x16x64_bf16 v[44:47], v[28:31], v[64:71], v6
    ds_read_b128 v[64:67], v2 offset:26624
    ds_read_b128 v[68:71], v2 offset:27648
    s_waitcnt vmcnt(4)
    v_cmp_eq_u32 vcc, -1, v15
    v_smfmac_f32_16x16x64_bf16 v[48:51], v[28:31], a[64:71], v6
    v_smfmac_f32_16x16x64_bf16 v[52:55], v[28:31], a[72:79], v6
    s_cbranch_vccnz RETRY_71
BACK_72:
    buffer_load_dwordx4 v[28:31], v1, s[4:7], s75 offen offset:0
    v_smfmac_f32_16x16x64_bf16 v[32:35], v[12:15], v[176:183], v6
    s_waitcnt vmcnt(3)
    v_cmp_eq_u32 vcc, -1, v19
    v_smfmac_f32_16x16x64_bf16 v[36:39], v[12:15], v[184:191], v6
    s_waitcnt lgkmcnt(4)
    v_smfmac_f32_16x16x64_bf16 v[40:43], v[12:15], v[72:79], v6
    ds_read_b128 v[72:75], v2 offset:28672
    ds_read_b128 v[76:79], v2 offset:29696
    v_smfmac_f32_16x16x64_bf16 v[44:47], v[12:15], v[80:87], v6
    ds_read_b128 v[80:83], v2 offset:30720
    ds_read_b128 v[84:87], v2 offset:31744
    buffer_load_dwordx4 v[88:91], v1, s[4:7], s29 offen offset:0
    s_cbranch_vccnz RETRY_73
BACK_74:
    v_smfmac_f32_16x16x64_bf16 v[32:35], v[16:19], v[192:199], v6
    s_waitcnt vmcnt(3)
    v_cmp_eq_u32 vcc, -1, v23
    v_smfmac_f32_16x16x64_bf16 v[36:39], v[16:19], v[200:207], v6
    s_waitcnt lgkmcnt(4)
    v_smfmac_f32_16x16x64_bf16 v[40:43], v[16:19], v[56:63], v6
    ds_read_b128 v[56:59], v2 offset:32768
    ds_read_b128 v[60:63], v2 offset:33792
    v_smfmac_f32_16x16x64_bf16 v[44:47], v[16:19], v[64:71], v6
    ds_read_b128 v[64:67], v2 offset:34816
    ds_read_b128 v[68:71], v2 offset:35840
    s_cbranch_vccnz RETRY_75
BACK_76:
    v_smfmac_f32_16x16x64_bf16 v[32:35], v[20:23], v[208:215], v6
    s_waitcnt vmcnt(2)
    v_cmp_eq_u32 vcc, -1, v27
    v_smfmac_f32_16x16x64_bf16 v[36:39], v[20:23], v[216:223], v6
    s_waitcnt lgkmcnt(4)
    v_smfmac_f32_16x16x64_bf16 v[40:43], v[20:23], v[72:79], v6
    ds_read_b128 v[72:75], v1 offset:0
    ds_read_b128 v[76:79], v1 offset:4096
    v_smfmac_f32_16x16x64_bf16 v[44:47], v[20:23], v[80:87], v6
    ds_read_b128 v[80:83], v1 offset:1024
    ds_read_b128 v[84:87], v1 offset:5120
    buffer_load_dwordx4 v[92:95], v1, s[4:7], s29 offen offset:1024
    s_cbranch_vccnz RETRY_77
BACK_78:
    v_smfmac_f32_16x16x64_bf16 v[32:35], v[24:27], v[224:231], v6
    s_waitcnt vmcnt(2)
    v_cmp_eq_u32 vcc, -1, v31
    v_smfmac_f32_16x16x64_bf16 v[36:39], v[24:27], v[232:239], v6
    s_waitcnt lgkmcnt(4)
    v_smfmac_f32_16x16x64_bf16 v[40:43], v[24:27], v[56:63], v6
    ds_read_b128 v[56:59], v1 offset:2048
    ds_read_b128 v[60:63], v1 offset:6144
    v_smfmac_f32_16x16x64_bf16 v[44:47], v[24:27], v[64:71], v6
    ds_read_b128 v[64:67], v1 offset:3072
    ds_read_b128 v[68:71], v1 offset:7168
    s_cbranch_vccnz RETRY_79
BACK_80:
    v_smfmac_f32_16x16x64_bf16 v[32:35], v[28:31], v[240:247], v6
    v_smfmac_f32_16x16x64_bf16 v[36:39], v[28:31], v[248:255], v6
    v_smfmac_f32_16x16x64_bf16 v[40:43], v[28:31], a[240:247], v6
    v_smfmac_f32_16x16x64_bf16 v[44:47], v[28:31], a[248:255], v6
    v_lshlrev_b32 v8, 2, v1
    s_add_u32 s65, s17, s19
    buffer_load_dword v8, s[4:7], s3 offen lds
    buffer_load_dword off, s[4:7], s65 sc1 lds
    buffer_store_dword v6, off, s[4:7], s22 sc1
    s_add_u32 s22, s22, 256
    s_cmp_eq_u32 s59, 0
    s_cbranch_scc1 KVLOOK_81
    s_cmp_eq_u32 s59, 1
    s_cbranch_scc1 KVL1_82
    s_lshl_b32 s64, s13, 13
    s_add_u32 s64, s64, 0x43c0000
    buffer_load_dwordx4 v[96:99], v1, s[4:7], s64 offen offset:0
    buffer_load_dwordx4 v[100:103], v1, s[4:7], s64 offen offset:1024
    buffer_load_dwordx4 v[104:107], v1, s[4:7], s64 offen offset:2048
    buffer_load_dwordx4 v[108:111], v1, s[4:7], s64 offen offset:3072
    s_add_u32 s64, s64, 0x1000
    buffer_load_dwordx4 v[112:115], v1, s[4:7], s64 offen offset:0
    buffer_load_dwordx4 v[116:119], v1, s[4:7], s64 offen offset:1024
    buffer_load_dwordx4 v[120:123], v1, s[4:7], s64 offen offset:2048
    buffer_load_dwordx4 v[124:127], v1, s[4:7], s64 offen offset:3072
    s_branch KVLOOK_81
KVL1_82:
    v_lshrrev_b32 v9, 5, v1
    v_lshlrev_b32 v9, 9, v9
    v_bfe_u32 v10, v1, 4, 1
    v_lshl_add_u32 v9, v10, 2, v9
    s_mov_b32 m0, 15104
    s_mov_b64 exec, s[34:35]
    buffer_load_dword v9, s[4:7], s69 offen sc1 lds
    s_mov_b64 exec, -1
    s_mov_b32 m0, 16128
KVLOOK_81:
    v_permlane32_swap_b32 v32, v36
    v_permlane32_swap_b32 v33, v37
    v_permlane32_swap_b32 v34, v38
    v_permlane32_swap_b32 v35, v39
    v_pk_add_f32 v[32:33], v[32:33], v[36:37]
    v_pk_add_f32 v[34:35], v[34:35], v[38:39]
    v_cvt_pk_bf16_f32 v36, v32, v33
    v_cvt_pk_bf16_f32 v37, v34, v35
    ds_write_b64 v3, v[36:37] offset:0
    v_permlane32_swap_b32 v40, v44
    v_permlane32_swap_b32 v41, v45
    v_permlane32_swap_b32 v42, v46
    v_permlane32_swap_b32 v43, v47
    v_pk_add_f32 v[40:41], v[40:41], v[44:45]
    v_pk_add_f32 v[42:43], v[42:43], v[46:47]
    v_cvt_pk_bf16_f32 v44, v40, v41
    v_cvt_pk_bf16_f32 v45, v42, v43
    ds_write_b64 v3, v[44:45] offset:2304
    v_smfmac_f32_16x16x64_bf16 v[48:51], v[12:15], a[80:87], v6
    v_smfmac_f32_16x16x64_bf16 v[52:55], v[12:15], a[88:95], v6
    v_smfmac_f32_16x16x64_bf16 v[48:51], v[16:19], a[96:103], v6
    v_smfmac_f32_16x16x64_bf16 v[52:55], v[16:19], a[104:111], v6
    s_waitcnt lgkmcnt(0)
    s_barrier
    ds_read_b64_tr_b16 v[32:33], v4 offset:0
    ds_read_b64_tr_b16 v[34:35], v4 offset:128
    ds_read_b64_tr_b16 v[36:37], v4 offset:256
    ds_read_b64_tr_b16 v[38:39], v4 offset:384
    s_cmp_eq_u32 s15, 63
    s_cbranch_scc1 REC_FINAL
    v_smfmac_f32_16x16x64_bf16 v[48:51], v[20:23], a[112:119], v6
    v_smfmac_f32_16x16x64_bf16 v[52:55], v[20:23], a[120:127], v6
    ds_read_b64_tr_b16 v[40:41], v4 offset:512
    ds_read_b64_tr_b16 v[42:43], v4 offset:640
    ds_read_b64_tr_b16 v[44:45], v4 offset:768
    ds_read_b64_tr_b16 v[46:47], v4 offset:896
    v_smfmac_f32_16x16x64_bf16 v[48:51], v[24:27], a[128:135], v6
    v_smfmac_f32_16x16x64_bf16 v[52:55], v[24:27], a[136:143], v6
    s_waitcnt lgkmcnt(4)
    v_mfma_f32_16x16x32_bf16 v[8:11], v[72:75], v[32:35], 0
    ds_read_b64_tr_b16 v[12:13], v4 offset:2304
    ds_read_b64_tr_b16 v[14:15], v4 offset:2432
    v_mfma_f32_16x16x32_bf16 v[8:11], v[80:83], v[36:39], v[8:11]
    ds_read_b64_tr_b16 v[16:17], v4 offset:2560
    ds_read_b64_tr_b16 v[18:19], v4 offset:2688
    s_waitcnt lgkmcnt(4)
    v_mfma_f32_16x16x32_bf16 v[8:11], v[56:59], v[40:43], v[8:11]
    ds_read_b64_tr_b16 v[56:57], v4 offset:2816
    ds_read_b64_tr_b16 v[58:59], v4 offset:2944
    v_mfma_f32_16x16x32_bf16 v[8:11], v[64:67], v[44:47], v[8:11]
    ds_read_b64_tr_b16 v[64:65], v4 offset:3072
    ds_read_b64_tr_b16 v[66:67], v4 offset:3200
    v_mfma_f32_16x16x32_bf16 v[72:75], v[76:79], v[32:35], 0
    v_mfma_f32_16x16x32_bf16 v[72:75], v[84:87], v[36:39], v[72:75]
    v_mfma_f32_16x16x32_bf16 v[72:75], v[60:63], v[40:43], v[72:75]
    v_mfma_f32_16x16x32_bf16 v[72:75], v[68:71], v[44:47], v[72:75]
    s_waitcnt lgkmcnt(4)
    v_mfma_f32_16x16x32_bf16 v[80:83], v[12:15], v[32:35], 0
    v_mfma_f32_16x16x32_bf16 v[80:83], v[16:19], v[36:39], v[80:83]
    s_waitcnt lgkmcnt(0)
    v_mfma_f32_16x16x32_bf16 v[80:83], v[56:59], v[40:43], v[80:83]
    v_mfma_f32_16x16x32_bf16 v[80:83], v[64:67], v[44:47], v[80:83]
    v_smfmac_f32_16x16x64_bf16 v[48:51], v[28:31], a[144:151], v6
    v_smfmac_f32_16x16x64_bf16 v[52:55], v[28:31], a[152:159], v6
    v_mov_b32 v24, 0x3f803f80
    v_mov_b32 v25, 0x3f803f80
    v_mov_b32 v26, 0x3f803f80
    v_mov_b32 v27, 0x3f803f80
    v_max3_f32 v20, v8, v9, v10
    v_max3_f32 v21, v11, v72, v73
    v_max3_f32 v20, v20, v21, v74
    v_max3_f32 v21, v80, v81, v82
    v_max3_f32 v20, v20, v75, v83
    v_max_f32 v20, v20, v21
    v_mov_b32 v21, v20
    v_cvt_pk_bf16_f32 v48, v48, v49
    v_cvt_pk_bf16_f32 v49, v50, v51
    v_permlane16_swap_b32 v20, v21
    v_max_f32 v20, v20, v21
    v_mov_b32 v21, v20
    v_cvt_pk_bf16_f32 v50, v52, v53
    v_cvt_pk_bf16_f32 v51, v54, v55
    v_permlane32_swap_b32 v20, v21
    v_max_f32 v20, v20, v21
    v_mul_f32 v22, s10, v20
    v_pk_fma_f32 v[8:9], v[8:9], s[10:11], v[22:23] op_sel_hi:[1,1,0] neg_lo:[0,0,1] neg_hi:[0,0,1]
    v_pk_fma_f32 v[10:11], v[10:11], s[10:11], v[22:23] op_sel_hi:[1,1,0] neg_lo:[0,0,1] neg_hi:[0,0,1]
    v_pk_fma_f32 v[72:73], v[72:73], s[10:11], v[22:23] op_sel_hi:[1,1,0] neg_lo:[0,0,1] neg_hi:[0,0,1]
    v_pk_fma_f32 v[74:75], v[74:75], s[10:11], v[22:23] op_sel_hi:[1,1,0] neg_lo:[0,0,1] neg_hi:[0,0,1]
    v_pk_fma_f32 v[80:81], v[80:81], s[10:11], v[22:23] op_sel_hi:[1,1,0] neg_lo:[0,0,1] neg_hi:[0,0,1]
    v_pk_fma_f32 v[82:83], v[82:83], s[10:11], v[22:23] op_sel_hi:[1,1,0] neg_lo:[0,0,1] neg_hi:[0,0,1]
    v_exp_f32 v8, v8
    v_exp_f32 v9, v9
    v_exp_f32 v10, v10
    v_exp_f32 v11, v11
    v_exp_f32 v72, v72
    v_exp_f32 v73, v73
    v_exp_f32 v74, v74
    v_exp_f32 v75, v75
    v_cvt_pk_bf16_f32 v32, v8, v9
    v_cvt_pk_bf16_f32 v33, v10, v11
    v_exp_f32 v80, v80
    v_exp_f32 v81, v81
    v_exp_f32 v82, v82
    v_exp_f32 v83, v83
    v_cvt_pk_bf16_f32 v34, v72, v73
    v_cvt_pk_bf16_f32 v35, v74, v75
    v_cndmask_b32 v12, 0, v24, s[34:35]
    v_cndmask_b32 v13, 0, v24, s[34:35]
    s_waitcnt vmcnt(3)
    v_mfma_f32_16x16x32_bf16 v[8:11], v[24:27], v[32:35], 0
    v_cvt_pk_bf16_f32 v36, v80, v81
    v_mfma_f32_16x16x32_bf16 v[40:43], v[88:91], v[32:35], 0
    v_cvt_pk_bf16_f32 v37, v82, v83
    v_mfma_f32_16x16x32_bf16 v[44:47], v[92:95], v[32:35], 0
    v_mfma_f32_16x16x16_bf16 v[8:11], v[12:13], v[36:37], v[8:11]
    v_mov_b64 v[72:73], 0
    v_mfma_f32_16x16x16_bf16 v[40:43], v[48:49], v[36:37], v[40:43]
    v_mov_b64 v[74:75], 0
    v_mfma_f32_16x16x16_bf16 v[44:47], v[50:51], v[36:37], v[44:47]
    v_mov_b64 v[76:77], 0
    v_mov_b64 v[78:79], 0
    v_mov_b64 v[80:81], 0
    v_mov_b64 v[82:83], 0
    v_rcp_f32 v22, v8
    s_nop 2
    v_cndmask_b32 v40, v44, v40, s[32:33]
    v_cndmask_b32 v41, v45, v41, s[32:33]
    v_cndmask_b32 v42, v46, v42, s[32:33]
    v_cndmask_b32 v43, v47, v43, s[32:33]
    v_pk_mul_f32 v[40:41], v[40:41], v[22:23] op_sel_hi:[1,0]
    v_pk_mul_f32 v[42:43], v[42:43], v[22:23] op_sel_hi:[1,0]
    v_cvt_pk_bf16_f32 v44, v40, v41
    v_cvt_pk_bf16_f32 v45, v42, v43
    ds_write_b64 v5, v[44:45]
    s_mov_b32 m0, s73
    s_add_u32 s28, s28, 0x80000
    buffer_load_dwordx4 v1, s[4:7], s28 offen lds
    buffer_load_dwordx4 v1, s[4:7], s28 offen offset:1024 lds
    v_and_b32 v9, 0x70, v1
    v_bfe_u32 v29, v1, 8, 1
    v_lshl_add_u32 v9, v29, 3, v9
    v_bfe_u32 v29, v1, 9, 1
    v_lshl_add_u32 v9, v29, 2, v9
    v_mov_b32 v29, 0x40000000
    s_waitcnt lgkmcnt(0)
    s_barrier
    ds_read_b128 v[12:15], v0 offset:0
    ds_read_b128 v[16:19], v0 offset:64
    ds_read_b128 v[20:23], v0 offset:128
    ds_read_b128 v[24:27], v0 offset:192
    v_cndmask_b32 v9, v29, v9, s[32:33]
    v_and_b32 v29, 16, v1
    v_lshlrev_b32 v29, v29, s38
    v_cndmask_b32 v88, 0, v29, s[44:45]
    v_cndmask_b32 v89, 0, v29, s[46:47]
    v_cndmask_b32 v90, 0, v29, s[48:49]
    v_cndmask_b32 v91, 0, v29, s[50:51]
    s_waitcnt lgkmcnt(3)
    v_smfmac_f32_16x16x64_bf16 v[72:75], v[12:15], a[160:167], v6
    s_waitcnt lgkmcnt(2)
    v_smfmac_f32_16x16x64_bf16 v[72:75], v[16:19], a[168:175], v6
    s_waitcnt lgkmcnt(1)
    v_smfmac_f32_16x16x64_bf16 v[72:75], v[20:23], a[176:183], v6
    s_waitcnt lgkmcnt(0)
    v_smfmac_f32_16x16x64_bf16 v[72:75], v[24:27], a[184:191], v6
    v_smfmac_f32_16x16x64_bf16 v[76:79], v[12:15], a[192:199], v6
    v_smfmac_f32_16x16x64_bf16 v[76:79], v[16:19], a[200:207], v6
    v_cvt_pk_bf16_f32 v72, v72, v73
    v_smfmac_f32_16x16x64_bf16 v[76:79], v[20:23], a[208:215], v6
    v_cvt_pk_bf16_f32 v73, v74, v75
    v_smfmac_f32_16x16x64_bf16 v[76:79], v[24:27], a[216:223], v6
    v_and_or_b32 v72, v72, -2, s16
    v_mfma_f32_16x16x32_bf16 v[80:83], v[12:15], a[224:227], 0
    buffer_store_dwordx2 v[72:73], v7, s[4:7], s23 offen
    v_mfma_f32_16x16x32_bf16 v[80:83], v[16:19], a[228:231], v[80:83]
    v_mfma_f32_16x16x32_bf16 v[80:83], v[20:23], a[232:235], v[80:83]
    v_cvt_pk_bf16_f32 v76, v76, v77
    v_cvt_pk_bf16_f32 v77, v78, v79
    v_mfma_f32_16x16x32_bf16 v[80:83], v[24:27], a[236:239], v[80:83]
    v_and_or_b32 v76, v76, -2, s16
    buffer_store_dwordx2 v[76:77], v7, s[4:7], s25 offen
    s_add_u32 s17, s17, 0x4000
    s_add_u32 s3, s3, 0x80000
    s_add_u32 s29, s29, 0x80000
    s_add_u32 s18, s18, 0x4000
    s_add_u32 s21, s21, 0x8000
    s_add_u32 s15, s15, 1
    s_nop 0
    v_cvt_pk_bf16_f32 v80, v80, v81
    v_cvt_pk_bf16_f32 v81, v82, v83
    v_and_or_b32 v80, v80, -2, s16
    s_mov_b64 exec, s[34:35]
    buffer_store_dwordx2 v[80:81], v7, s[4:7], s26 offen
    s_mov_b64 exec, -1
    s_cmp_lg_u32 s42, 0
    s_cbranch_scc1 OWN_84
    s_cmp_lt_u32 s14, 2
    s_cbranch_scc1 IDLE_83
    s_branch REC_POLL
OWN_84:
    s_nop 15
    s_nop 13
    buffer_load_dwordx4 v[12:15], v1, s[4:7], s24 offen offset:0 sc1
    buffer_load_dwordx4 v[16:19], v1, s[4:7], s24 offen offset:1024 sc1
    buffer_load_dwordx4 v[20:23], v1, s[4:7], s24 offen offset:2048 sc1
    buffer_load_dwordx4 v[24:27], v1, s[4:7], s24 offen offset:3072 sc1
    ds_read_b128 v[56:59], v2 offset:0
    ds_read_b128 v[60:63], v2 offset:1024
    ds_read_b128 v[64:67], v2 offset:2048
    ds_read_b128 v[68:71], v2 offset:3072
    v_mov_b64 v[32:33], 0
    v_mov_b64 v[34:35], 0
    v_mov_b64 v[36:37], 0
    v_mov_b64 v[38:39], 0
    v_mov_b64 v[40:41], 0
    v_mov_b64 v[42:43], 0
    v_mov_b64 v[44:45], 0
    v_mov_b64 v[46:47], 0
    buffer_load_dwordx4 v[72:75], v1, s[4:7], s24 offen offset:0 sc1
    buffer_load_dwordx4 v[76:79], v1, s[4:7], s24 offen offset:1024 sc1
    buffer_load_dwordx4 v[80:83], v1, s[4:7], s24 offen offset:2048 sc1
    buffer_load_dwordx4 v[84:87], v1, s[4:7], s24 offen offset:3072 sc1
    v_mov_b64 v[48:49], 0
    v_mov_b64 v[50:51], 0
    v_mov_b64 v[52:53], 0
    v_mov_b64 v[54:55], 0
OPOLL_86:
    s_waitcnt vmcnt(7)
    v_mfma_f32_16x16x32_bf16 v[92:95], v[12:15], v[88:91], 0
    v_bitop3_b32 v10, v12, v14, s16 bitop3:0x7e
    s_waitcnt vmcnt(6)
    v_mfma_f32_16x16x32_bf16 v[92:95], v[16:19], v[88:91], v[92:95]
    v_bitop3_b32 v11, v16, v18, s16 bitop3:0x7e
    s_waitcnt vmcnt(5)
    v_mfma_f32_16x16x32_bf16 v[92:95], v[20:23], v[88:91], v[92:95]
    v_bitop3_b32 v30, v20, v22, s16 bitop3:0x7e
    s_waitcnt vmcnt(4)
    v_mfma_f32_16x16x32_bf16 v[92:95], v[24:27], v[88:91], v[92:95]
    v_bitop3_b32 v31, v24, v26, s16 bitop3:0x7e
    v_or3_b32 v10, v10, v11, v30
    v_bitop3_b32 v10, v10, v31, 1 bitop3:0xa8
    v_cmp_ne_u32 vcc, 0, v10
    s_nop 3
    s_cbranch_vccz ODONE_85
    s_add_u32 s40, s40, 1
    buffer_load_dwordx4 v[12:15], v1, s[4:7], s24 offen offset:0 sc1
    buffer_load_dwordx4 v[16:19], v1, s[4:7], s24 offen offset:1024 sc1
    buffer_load_dwordx4 v[20:23], v1, s[4:7], s24 offen offset:2048 sc1
    buffer_load_dwordx4 v[24:27], v1, s[4:7], s24 offen offset:3072 sc1
    s_waitcnt vmcnt(7)
    v_mfma_f32_16x16x32_bf16 v[92:95], v[72:75], v[88:91], 0
    v_bitop3_b32 v10, v72, v74, s16 bitop3:0x7e
    s_waitcnt vmcnt(6)
    v_mfma_f32_16x16x32_bf16 v[92:95], v[76:79], v[88:91], v[92:95]
    v_bitop3_b32 v11, v76, v78, s16 bitop3:0x7e
    s_waitcnt vmcnt(5)
    v_mfma_f32_16x16x32_bf16 v[92:95], v[80:83], v[88:91], v[92:95]
    v_bitop3_b32 v30, v80, v82, s16 bitop3:0x7e
    s_waitcnt vmcnt(4)
    v_mfma_f32_16x16x32_bf16 v[92:95], v[84:87], v[88:91], v[92:95]
    v_bitop3_b32 v31, v84, v86, s16 bitop3:0x7e
    v_or3_b32 v10, v10, v11, v30
    v_bitop3_b32 v10, v10, v31, 1 bitop3:0xa8
    v_cmp_ne_u32 vcc, 0, v10
    s_add_u32 s68, s68, 1
    s_cmp_gt_u32 s68, 262144
    s_cbranch_scc1 ODONE_85
    s_nop 0
    s_cbranch_vccz ODONE_85
    s_add_u32 s40, s40, 1
    buffer_load_dwordx4 v[72:75], v1, s[4:7], s24 offen offset:0 sc1
    buffer_load_dwordx4 v[76:79], v1, s[4:7], s24 offen offset:1024 sc1
    buffer_load_dwordx4 v[80:83], v1, s[4:7], s24 offen offset:2048 sc1
    buffer_load_dwordx4 v[84:87], v1, s[4:7], s24 offen offset:3072 sc1
    s_branch OPOLL_86
ODONE_85:
    v_permlane32_swap_b32 v92, v94
    v_permlane32_swap_b32 v93, v95
    v_add_f32 v92, v92, v94
    v_add_f32 v93, v93, v95
    v_cvt_pk_bf16_f32 v8, v92, v93
    buffer_store_dword v8, v9, s[4:7], s18 offen
    s_cmp_eq_u32 s15, 63
    s_cselect_b32 s59, s55, 0
    s_barrier
    s_nop 15
    s_nop 15
    s_nop 12
    buffer_store_dword v8, v9, s[4:7], s21 offen sc1
    s_cmp_lt_u32 s15, 61
    s_cbranch_scc1 EFLG_87
    buffer_store_dword v6, off, s[4:7], s22 sc1
EFLG_87:
    s_xor_b32 s16, s16, 1
    s_waitcnt vmcnt(2) lgkmcnt(0)
    s_branch REC_LOOP
IDLE_83:
    s_barrier
    s_cmp_eq_u32 s15, 63
    s_cselect_b32 s59, s55, 0
    v_mov_b64 v[32:33], 0
    v_mov_b64 v[34:35], 0
    v_mov_b64 v[36:37], 0
    v_mov_b64 v[38:39], 0
    v_mov_b64 v[40:41], 0
    v_mov_b64 v[42:43], 0
    v_mov_b64 v[44:45], 0
    v_mov_b64 v[46:47], 0
    v_mov_b64 v[48:49], 0
    v_mov_b64 v[50:51], 0
    v_mov_b64 v[52:53], 0
    v_mov_b64 v[54:55], 0
    ds_read_b128 v[56:59], v2 offset:0
    ds_read_b128 v[60:63], v2 offset:1024
    ds_read_b128 v[64:67], v2 offset:2048
    ds_read_b128 v[68:71], v2 offset:3072
    s_xor_b32 s16, s16, 1
    s_waitcnt vmcnt(0)
    s_branch REC_LOOP
REC_TAIL:
RETRY_65:
SPIN_88:
    buffer_load_dwordx4 v[20:23], v1, s[4:7], s17 offen offset:2048 sc1
    buffer_load_dwordx4 v[24:27], v1, s[4:7], s17 offen offset:3072 sc1
    buffer_load_dwordx4 v[28:31], v1, s[4:7], s74 offen offset:0 sc1
    s_add_u32 s68, s68, 1
    s_add_u32 s40, s40, 1024
    s_cmp_gt_u32 s68, 262144
    s_waitcnt vmcnt(0)
    s_cbranch_scc1 BACK_66
    v_cmp_eq_u32 vcc, -1, v23
    s_cbranch_vccnz SPIN_88
    s_branch BACK_66
RETRY_67:
SPIN_89:
    buffer_load_dwordx4 v[24:27], v1, s[4:7], s17 offen offset:3072 sc1
    buffer_load_dwordx4 v[28:31], v1, s[4:7], s74 offen offset:0 sc1
    s_add_u32 s68, s68, 1
    s_add_u32 s40, s40, 1024
    s_cmp_gt_u32 s68, 262144
    s_waitcnt vmcnt(0)
    s_cbranch_scc1 BACK_68
    v_cmp_eq_u32 vcc, -1, v27
    s_cbranch_vccnz SPIN_89
    s_branch BACK_68
RETRY_69:
SPIN_90:
    buffer_load_dwordx4 v[28:31], v1, s[4:7], s74 offen offset:0 sc1
    s_add_u32 s68, s68, 1
    s_add_u32 s40, s40, 1024
    s_cmp_gt_u32 s68, 262144
    s_waitcnt vmcnt(0)
    s_cbranch_scc1 BACK_70
    v_cmp_eq_u32 vcc, -1, v31
    s_cbranch_vccnz SPIN_90
    s_branch BACK_70
RETRY_71:
SPIN_91:
    buffer_load_dwordx4 v[12:15], v1, s[4:7], s20 offen offset:0 sc1
    buffer_load_dwordx4 v[16:19], v1, s[4:7], s20 offen offset:1024 sc1
    buffer_load_dwordx4 v[20:23], v1, s[4:7], s20 offen offset:2048 sc1
    buffer_load_dwordx4 v[24:27], v1, s[4:7], s20 offen offset:3072 sc1
    s_add_u32 s68, s68, 1
    s_add_u32 s40, s40, 1048576
    s_cmp_gt_u32 s68, 262144
    s_waitcnt vmcnt(0)
    s_cbranch_scc1 BACK_72
    v_cmp_eq_u32 vcc, -1, v15
    s_cbranch_vccnz SPIN_91
    s_branch BACK_72
RETRY_73:
SPIN_92:
    buffer_load_dwordx4 v[16:19], v1, s[4:7], s20 offen offset:1024 sc1
    buffer_load_dwordx4 v[20:23], v1, s[4:7], s20 offen offset:2048 sc1
    buffer_load_dwordx4 v[24:27], v1, s[4:7], s20 offen offset:3072 sc1
    buffer_load_dwordx4 v[28:31], v1, s[4:7], s75 offen offset:0 sc1
    s_add_u32 s68, s68, 1
    s_add_u32 s40, s40, 1048576
    s_cmp_gt_u32 s68, 262144
    s_waitcnt vmcnt(0)
    s_cbranch_scc1 BACK_74
    v_cmp_eq_u32 vcc, -1, v19
    s_cbranch_vccnz SPIN_92
    s_branch BACK_74
RETRY_75:
SPIN_93:
    buffer_load_dwordx4 v[20:23], v1, s[4:7], s20 offen offset:2048 sc1
    buffer_load_dwordx4 v[24:27], v1, s[4:7], s20 offen offset:3072 sc1
    buffer_load_dwordx4 v[28:31], v1, s[4:7], s75 offen offset:0 sc1
    s_add_u32 s68, s68, 1
    s_add_u32 s40, s40, 1048576
    s_cmp_gt_u32 s68, 262144
    s_waitcnt vmcnt(0)
    s_cbranch_scc1 BACK_76
    v_cmp_eq_u32 vcc, -1, v23
    s_cbranch_vccnz SPIN_93
    s_branch BACK_76
RETRY_77:
SPIN_94:
    buffer_load_dwordx4 v[24:27], v1, s[4:7], s20 offen offset:3072 sc1
    buffer_load_dwordx4 v[28:31], v1, s[4:7], s75 offen offset:0 sc1
    s_add_u32 s68, s68, 1
    s_add_u32 s40, s40, 1048576
    s_cmp_gt_u32 s68, 262144
    s_waitcnt vmcnt(0)
    s_cbranch_scc1 BACK_78
    v_cmp_eq_u32 vcc, -1, v27
    s_cbranch_vccnz SPIN_94
    s_branch BACK_78
RETRY_79:
SPIN_95:
    buffer_load_dwordx4 v[28:31], v1, s[4:7], s75 offen offset:0 sc1
    s_add_u32 s68, s68, 1
    s_add_u32 s40, s40, 1048576
    s_cmp_gt_u32 s68, 262144
    s_waitcnt vmcnt(0)
    s_cbranch_scc1 BACK_80
    v_cmp_eq_u32 vcc, -1, v31
    s_cbranch_vccnz SPIN_95
    s_branch BACK_80
REC_FINAL:
    s_cmp_lg_u32 s12, 0
    s_cbranch_scc1 REC_END
    s_waitcnt lgkmcnt(0)
    v_smfmac_f32_16x16x64_bf16 v[48:51], v[20:23], a[112:119], v6
    v_smfmac_f32_16x16x64_bf16 v[52:55], v[20:23], a[120:127], v6
    v_smfmac_f32_16x16x64_bf16 v[48:51], v[24:27], a[128:135], v6
    v_smfmac_f32_16x16x64_bf16 v[52:55], v[24:27], a[136:143], v6
    v_smfmac_f32_16x16x64_bf16 v[48:51], v[28:31], a[144:151], v6
    v_smfmac_f32_16x16x64_bf16 v[52:55], v[28:31], a[152:159], v6
    ds_read_b64_tr_b16 v[192:193], v4 offset:2304
    ds_read_b64_tr_b16 v[194:195], v4 offset:2432
    ds_read_b64_tr_b16 v[196:197], v4 offset:2560
    ds_read_b64_tr_b16 v[198:199], v4 offset:2688
    ds_read_b64_tr_b16 v[200:201], v4 offset:2816
    ds_read_b64_tr_b16 v[202:203], v4 offset:2944
    ds_read_b64_tr_b16 v[204:205], v4 offset:3072
    ds_read_b64_tr_b16 v[206:207], v4 offset:3200
    ds_read_b128 v[160:163], v1 offset:0
    ds_read_b128 v[164:167], v1 offset:1024
    ds_read_b128 v[168:171], v1 offset:2048
    ds_read_b128 v[172:175], v1 offset:3072
    ds_read_b128 v[176:179], v1 offset:4096
    ds_read_b128 v[180:183], v1 offset:5120
    ds_read_b128 v[184:187], v1 offset:6144
    ds_read_b128 v[188:191], v1 offset:7168
    v_mbcnt_lo_u32_b32 v0, -1, 0
    v_mbcnt_hi_u32_b32 v0, -1, v0
    s_mov_b32 s34, 0x3e0293ee
    s_mov_b32 s35, 0x3e0293ee
    s_mov_b32 s36, -1
    s_mov_b32 s37, 0
    v_lshrrev_b32 v5, 4, v0
    v_lshlrev_b32 v5, 2, v5
    v_and_b32 v6, 15, v0
    v_add_u32 v7, 0, v5
    v_cmp_le_u32 s[38:39], v7, v6
    v_add_u32 v7, 1, v5
    v_cmp_le_u32 s[40:41], v7, v6
    v_add_u32 v7, 2, v5
    v_cmp_le_u32 s[42:43], v7, v6
    v_add_u32 v7, 3, v5
    v_cmp_le_u32 s[44:45], v7, v6
    v_mov_b32 v252, 0x3f803f80
    v_mov_b32 v253, 0x3f803f80
    v_mov_b32 v254, 0x3f803f80
    v_mov_b32 v255, 0x3f803f80
    v_permlane32_swap_b32 v48, v52
    v_permlane32_swap_b32 v49, v53
    v_permlane32_swap_b32 v50, v54
    v_permlane32_swap_b32 v51, v55
    v_pk_add_f32 v[48:49], v[48:49], v[52:53]
    v_pk_add_f32 v[50:51], v[50:51], v[54:55]
    v_cvt_pk_bf16_f32 v208, v48, v49
    v_cvt_pk_bf16_f32 v209, v50, v51
    v_mov_b32 v210, v208
    v_mov_b32 v211, v209
    s_nop 1
    v_permlane32_swap_b32 v208, v210
    v_permlane32_swap_b32 v209, v211
    s_mov_b32 s24, 63
    s_lshl_b32 s64, s24, 5
    s_add_u32 s64, s64, s13
    s_lshl_b32 s33, s64, 2
    s_add_u32 s33, s33, 0x296000
    s_lshl_b32 s32, s24, 18
    s_lshl_b32 s65, s13, 12
    s_add_u32 s32, s32, s65
    s_add_u32 s32, s32, 0x4400000
    s_lshl_b32 s64, s14, 10
    s_add_u32 s32, s32, s64
    s_waitcnt vmcnt(0) lgkmcnt(0)
    v_mfma_f32_16x16x32_bf16 v[228:231], v[160:163], v[96:99], 0
    v_mfma_f32_16x16x32_bf16 v[236:239], v[160:163], v[112:115], 0
    v_mfma_f32_16x16x32_bf16 v[240:243], v[176:179], v[112:115], 0
    v_mfma_f32_16x16x32_bf16 v[228:231], v[164:167], v[100:103], v[228:231]
    v_mfma_f32_16x16x32_bf16 v[236:239], v[164:167], v[116:119], v[236:239]
    v_mfma_f32_16x16x32_bf16 v[240:243], v[180:183], v[116:119], v[240:243]
    v_mfma_f32_16x16x32_bf16 v[228:231], v[168:171], v[104:107], v[228:231]
    v_mfma_f32_16x16x32_bf16 v[236:239], v[168:171], v[120:123], v[236:239]
    v_mfma_f32_16x16x32_bf16 v[240:243], v[184:187], v[120:123], v[240:243]
    v_mfma_f32_16x16x32_bf16 v[228:231], v[172:175], v[108:111], v[228:231]
    v_mfma_f32_16x16x32_bf16 v[236:239], v[172:175], v[124:127], v[236:239]
    v_mfma_f32_16x16x32_bf16 v[240:243], v[188:191], v[124:127], v[240:243]
    v_mfma_f32_16x16x32_bf16 v[224:227], v[192:195], v[96:99], 0
    v_mfma_f32_16x16x32_bf16 v[232:235], v[192:195], v[112:115], 0
    v_mfma_f32_16x16x32_bf16 v[224:227], v[196:199], v[100:103], v[224:227]
    v_mfma_f32_16x16x32_bf16 v[232:235], v[196:199], v[116:119], v[232:235]
    v_mfma_f32_16x16x32_bf16 v[224:227], v[200:203], v[104:107], v[224:227]
    v_mfma_f32_16x16x32_bf16 v[232:235], v[200:203], v[120:123], v[232:235]
    v_mfma_f32_16x16x32_bf16 v[224:227], v[204:207], v[108:111], v[224:227]
    v_mfma_f32_16x16x32_bf16 v[232:235], v[204:207], v[124:127], v[232:235]
    v_mov_b32 v11, 0xff800000
    s_nop 7
    v_cndmask_b32 v228, v11, v228, s[38:39]
    v_cndmask_b32 v240, v11, v240, s[38:39]
    v_cndmask_b32 v224, v11, v224, s[36:37]
    v_cndmask_b32 v232, v11, v232, s[36:37]
    v_cndmask_b32 v229, v11, v229, s[40:41]
    v_cndmask_b32 v241, v11, v241, s[40:41]
    v_cndmask_b32 v225, v11, v225, s[36:37]
    v_cndmask_b32 v233, v11, v233, s[36:37]
    v_cndmask_b32 v230, v11, v230, s[42:43]
    v_cndmask_b32 v242, v11, v242, s[42:43]
    v_cndmask_b32 v226, v11, v226, s[36:37]
    v_cndmask_b32 v234, v11, v234, s[36:37]
    v_cndmask_b32 v231, v11, v231, s[44:45]
    v_cndmask_b32 v243, v11, v243, s[44:45]
    v_cndmask_b32 v227, v11, v227, s[36:37]
    v_cndmask_b32 v235, v11, v235, s[36:37]
    v_max3_f32 v8, v224, v225, v226
    v_max3_f32 v8, v8, v227, v228
    v_max3_f32 v8, v8, v229, v230
    v_max_f32 v8, v8, v231
    v_mov_b32 v9, v8
    s_nop 1
    v_permlane16_swap_b32 v8, v9
    v_max_f32 v8, v8, v9
    v_mov_b32 v9, v8
    s_nop 1
    v_permlane32_swap_b32 v8, v9
    v_max_f32 v8, v8, v9
    v_mul_f32 v8, s34, v8
    v_fma_f32 v224, v224, s34, -v8
    v_fma_f32 v225, v225, s34, -v8
    v_fma_f32 v226, v226, s34, -v8
    v_fma_f32 v227, v227, s34, -v8
    v_fma_f32 v228, v228, s34, -v8
    v_fma_f32 v229, v229, s34, -v8
    v_fma_f32 v230, v230, s34, -v8
    v_fma_f32 v231, v231, s34, -v8
    v_exp_f32 v224, v224
    v_exp_f32 v225, v225
    v_exp_f32 v226, v226
    v_exp_f32 v227, v227
    v_exp_f32 v228, v228
    v_exp_f32 v229, v229
    v_exp_f32 v230, v230
    v_exp_f32 v231, v231
    s_nop 0
    v_cvt_pk_bf16_f32 v16, v228, v229
    v_cvt_pk_bf16_f32 v17, v230, v231
    v_mov_b32 v18, 0
    v_mov_b32 v19, 0
    v_cvt_pk_bf16_f32 v20, v224, v225
    v_cvt_pk_bf16_f32 v21, v226, v227
    v_max3_f32 v8, v232, v233, v234
    v_max3_f32 v8, v8, v235, v236
    v_max3_f32 v8, v8, v237, v238
    v_max3_f32 v8, v8, v239, v240
    v_max3_f32 v8, v8, v241, v242
    v_max_f32 v8, v8, v243
    v_mov_b32 v9, v8
    s_nop 1
    v_permlane16_swap_b32 v8, v9
    v_max_f32 v8, v8, v9
    v_mov_b32 v9, v8
    s_nop 1
    v_permlane32_swap_b32 v8, v9
    v_max_f32 v8, v8, v9
    v_mul_f32 v8, s34, v8
    v_fma_f32 v232, v232, s34, -v8
    v_fma_f32 v233, v233, s34, -v8
    v_fma_f32 v234, v234, s34, -v8
    v_fma_f32 v235, v235, s34, -v8
    v_fma_f32 v236, v236, s34, -v8
    v_fma_f32 v237, v237, s34, -v8
    v_fma_f32 v238, v238, s34, -v8
    v_fma_f32 v239, v239, s34, -v8
    v_fma_f32 v240, v240, s34, -v8
    v_fma_f32 v241, v241, s34, -v8
    v_fma_f32 v242, v242, s34, -v8
    v_fma_f32 v243, v243, s34, -v8
    v_exp_f32 v232, v232
    v_exp_f32 v233, v233
    v_exp_f32 v234, v234
    v_exp_f32 v235, v235
    v_exp_f32 v236, v236
    v_exp_f32 v237, v237
    v_exp_f32 v238, v238
    v_exp_f32 v239, v239
    v_exp_f32 v240, v240
    v_exp_f32 v241, v241
    v_exp_f32 v242, v242
    v_exp_f32 v243, v243
    s_nop 0
    v_cvt_pk_bf16_f32 v22, v236, v237
    v_cvt_pk_bf16_f32 v23, v238, v239
    v_cvt_pk_bf16_f32 v24, v240, v241
    v_cvt_pk_bf16_f32 v25, v242, v243
    v_cvt_pk_bf16_f32 v26, v232, v233
    v_cvt_pk_bf16_f32 v27, v234, v235
    v_mfma_f32_16x16x32_bf16 v[244:247], v[252:255], v[16:19], 0
    v_mfma_f32_16x16x32_bf16 v[248:251], v[252:255], v[22:25], 0
    v_mfma_f32_16x16x32_bf16 v[32:35], v[88:91], v[16:19], 0
    v_mfma_f32_16x16x32_bf16 v[36:39], v[88:91], v[22:25], 0
    v_mfma_f32_16x16x32_bf16 v[40:43], v[92:95], v[16:19], 0
    v_mfma_f32_16x16x32_bf16 v[44:47], v[92:95], v[22:25], 0
    v_mfma_f32_16x16x16_bf16 v[244:247], v[252:253], v[20:21], v[244:247]
    v_mfma_f32_16x16x16_bf16 v[248:251], v[252:253], v[26:27], v[248:251]
    v_mfma_f32_16x16x16_bf16 v[32:35], v[208:209], v[20:21], v[32:35]
    v_mfma_f32_16x16x16_bf16 v[36:39], v[208:209], v[26:27], v[36:39]
    v_mfma_f32_16x16x16_bf16 v[40:43], v[210:211], v[20:21], v[40:43]
    v_mfma_f32_16x16x16_bf16 v[44:47], v[210:211], v[26:27], v[44:47]
    v_rcp_f32 v8, v244
    v_rcp_f32 v9, v248
    s_nop 7
    v_mul_f32 v32, v32, v8
    v_mul_f32 v33, v33, v8
    v_mul_f32 v34, v34, v8
    v_mul_f32 v35, v35, v8
    v_cvt_pk_bf16_f32 v96, v32, v33
    v_cvt_pk_bf16_f32 v97, v34, v35
    v_mul_f32 v40, v40, v8
    v_mul_f32 v41, v41, v8
    v_mul_f32 v42, v42, v8
    v_mul_f32 v43, v43, v8
    v_cvt_pk_bf16_f32 v98, v40, v41
    v_cvt_pk_bf16_f32 v99, v42, v43
    s_add_u32 s64, s32, 0x0
    buffer_store_dwordx4 v[96:99], v1, s[4:7], s64 offen offset:0 sc1
    v_mul_f32 v36, v36, v9
    v_mul_f32 v37, v37, v9
    v_mul_f32 v38, v38, v9
    v_mul_f32 v39, v39, v9
    v_cvt_pk_bf16_f32 v100, v36, v37
    v_cvt_pk_bf16_f32 v101, v38, v39
    v_mul_f32 v44, v44, v9
    v_mul_f32 v45, v45, v9
    v_mul_f32 v46, v46, v9
    v_mul_f32 v47, v47, v9
    v_cvt_pk_bf16_f32 v102, v44, v45
    v_cvt_pk_bf16_f32 v103, v46, v47
    s_add_u32 s64, s32, 0x20000
    buffer_store_dwordx4 v[100:103], v1, s[4:7], s64 offen offset:0 sc1
    s_waitcnt vmcnt(0)
    s_barrier
    s_cmp_lg_u32 s14, 0
    s_cbranch_scc1 REC_END
    v_mov_b32 v7, 1
    v_mov_b32 v8, 0
    s_mov_b64 exec, 1
    buffer_store_dword v7, v8, s[4:7], s33 offen sc1
    s_mov_b64 exec, -1
    s_branch REC_END
REC_END:
    s_branch M_EXIT
M_HELP:
    v_mbcnt_lo_u32_b32 v0, -1, 0
    v_mbcnt_hi_u32_b32 v0, -1, v0
    s_and_b32 s12, s96, 1
    s_lshr_b32 s3, s96, 1
    s_and_b32 s13, s3, 31
    s_lshr_b32 s3, s3, 5
    s_load_dwordx4 s[48:51], s[0:1], 16
    s_load_dwordx2 s[52:53], s[0:1], 32
    s_waitcnt lgkmcnt(0)
    s_mov_b32 s46, 5242880
    s_mov_b32 s47, 0x00020000
    s_cmp_eq_u32 s3, 1
    s_cselect_b32 s44, s52, s50
    s_cselect_b32 s45, s53, s51
    s_cmp_eq_u32 s3, 2
    s_cselect_b32 s44, s48, s44
    s_cselect_b32 s45, s49, s45
    s_load_dwordx2 s[16:17], s[0:1], 0
    s_mov_b32 s18, 2621440
    s_mov_b32 s19, 0x00020000
    s_load_dwordx2 s[20:21], s[0:1], 64
    s_mov_b32 s22, 1280
    s_mov_b32 s23, 0x00020000
    s_load_dwordx2 s[24:25], s[0:1], 8
    s_mov_b32 s26, 10240
    s_mov_b32 s27, 0x00020000
    s_lshr_b32 s29, s96, 5
    s_sub_u32 s28, s96, s29
    s_lshl_b32 s28, s28, 2
    s_add_u32 s28, s28, s14
    s_mul_i32 s28, s28, 3
    v_lshlrev_b32 v3, 4, v0
    v_lshlrev_b32 v4, 2, v0
    s_waitcnt lgkmcnt(0)
    s_and_b32 s29, s96, 31
    s_cmp_eq_u32 s29, 31
    s_cbranch_scc1 INP2_96
    s_add_u32 s29, s28, 0
    s_mul_i32 s33, s29, 1280
    buffer_load_dwordx4 v[10:13], v3, s[16:19], s33 offen
    buffer_load_dword v14, v4, s[16:19], s33 offen offset:1024
    s_add_u32 s29, s28, 1
    s_mul_i32 s34, s29, 1280
    buffer_load_dwordx4 v[16:19], v3, s[16:19], s34 offen
    buffer_load_dword v20, v4, s[16:19], s34 offen offset:1024
    s_add_u32 s29, s28, 2
    s_mul_i32 s35, s29, 1280
    buffer_load_dwordx4 v[22:25], v3, s[16:19], s35 offen
    buffer_load_dword v26, v4, s[16:19], s35 offen offset:1024
    buffer_load_dwordx4 v[28:31], v3, s[20:23], 0 offen
    buffer_load_dword v32, v4, s[20:23], 0 offen offset:1024
    s_cmp_ge_u32 s96, 10
    s_cbranch_scc1 INM0_97
    v_and_b32 v5, 7, v0
    v_mul_u32_u24 v5, 1280, v5
    v_lshrrev_b32 v6, 4, v0
    v_lshl_add_u32 v5, v6, 5, v5
    v_bfe_u32 v6, v0, 3, 1
    v_lshl_add_u32 v5, v6, 4, v5
    s_lshl_b32 s29, s96, 7
    buffer_load_dwordx4 v[34:37], v5, s[24:27], s29 offen
INM0_97:
    s_waitcnt vmcnt(0)
    s_add_u32 s29, s28, 0
    s_cmp_ge_u32 s29, 2048
    s_cbranch_scc1 INR_98
    v_lshlrev_b32 v50, 16, v10
    v_and_b32 v60, 0xffff0000, v10
    v_lshlrev_b32 v51, 16, v11
    v_and_b32 v61, 0xffff0000, v11
    v_lshlrev_b32 v52, 16, v12
    v_and_b32 v62, 0xffff0000, v12
    v_lshlrev_b32 v53, 16, v13
    v_and_b32 v63, 0xffff0000, v13
    v_lshlrev_b32 v54, 16, v14
    v_and_b32 v64, 0xffff0000, v14
    v_add_f32 v70, v50, v60
    v_add_f32 v70, v70, v51
    v_add_f32 v70, v70, v61
    v_add_f32 v70, v70, v52
    v_add_f32 v70, v70, v62
    v_add_f32 v70, v70, v53
    v_add_f32 v70, v70, v63
    v_add_f32 v70, v70, v54
    v_add_f32 v70, v70, v64
    s_nop 1
    v_add_f32_dpp v70, v70, v70 quad_perm:[1,0,3,2] row_mask:0xf bank_mask:0xf
    s_nop 1
    v_add_f32_dpp v70, v70, v70 quad_perm:[2,3,0,1] row_mask:0xf bank_mask:0xf
    s_nop 1
    v_add_f32_dpp v70, v70, v70 row_half_mirror row_mask:0xf bank_mask:0xf
    s_nop 1
    v_add_f32_dpp v70, v70, v70 row_mirror row_mask:0xf bank_mask:0xf
    v_mov_b32 v71, v70
    s_nop 1
    v_permlane16_swap_b32 v70, v71
    v_add_f32 v70, v70, v71
    v_mov_b32 v71, v70
    s_nop 1
    v_permlane32_swap_b32 v70, v71
    v_add_f32 v70, v70, v71
    v_mul_f32 v72, 0x3acccccd, v70
    v_mov_b32 v73, 0
    v_sub_f32 v74, v50, v72
    v_fmac_f32 v73, v74, v74
    v_sub_f32 v74, v60, v72
    v_fmac_f32 v73, v74, v74
    v_sub_f32 v74, v51, v72
    v_fmac_f32 v73, v74, v74
    v_sub_f32 v74, v61, v72
    v_fmac_f32 v73, v74, v74
    v_sub_f32 v74, v52, v72
    v_fmac_f32 v73, v74, v74
    v_sub_f32 v74, v62, v72
    v_fmac_f32 v73, v74, v74
    v_sub_f32 v74, v53, v72
    v_fmac_f32 v73, v74, v74
    v_sub_f32 v74, v63, v72
    v_fmac_f32 v73, v74, v74
    v_sub_f32 v74, v54, v72
    v_fmac_f32 v73, v74, v74
    v_sub_f32 v74, v64, v72
    v_fmac_f32 v73, v74, v74
    s_nop 1
    v_add_f32_dpp v73, v73, v73 quad_perm:[1,0,3,2] row_mask:0xf bank_mask:0xf
    s_nop 1
    v_add_f32_dpp v73, v73, v73 quad_perm:[2,3,0,1] row_mask:0xf bank_mask:0xf
    s_nop 1
    v_add_f32_dpp v73, v73, v73 row_half_mirror row_mask:0xf bank_mask:0xf
    s_nop 1
    v_add_f32_dpp v73, v73, v73 row_mirror row_mask:0xf bank_mask:0xf
    v_mov_b32 v71, v73
    s_nop 1
    v_permlane16_swap_b32 v73, v71
    v_add_f32 v73, v73, v71
    v_mov_b32 v71, v73
    s_nop 1
    v_permlane32_swap_b32 v73, v71
    v_add_f32 v73, v73, v71
    v_mul_f32 v73, 0x3acccccd, v73
    v_cvt_pk_bf16_f32 v72, v72, v72
    v_lshlrev_b32 v72, 16, v72
    v_cvt_pk_bf16_f32 v73, v73, v73
    v_lshlrev_b32 v73, 16, v73
    v_add_f32 v73, 0x3727c5ac, v73
    v_cvt_pk_bf16_f32 v73, v73, v73
    v_lshlrev_b32 v73, 16, v73
    v_sqrt_f32 v73, v73
    s_nop 0
    v_cvt_pk_bf16_f32 v73, v73, v73
    v_lshlrev_b32 v73, 16, v73
    v_rcp_f32 v75, v73
    s_nop 0
    v_mov_b32 v76, 0
    v_sub_f32 v50, v50, v72
    v_cvt_pk_bf16_f32 v50, v50, v50
    v_lshlrev_b32 v50, 16, v50
    v_mul_f32 v74, v50, v75
    v_fma_f32 v77, -v74, v73, v50
    v_fma_f32 v50, v77, v75, v74
    v_sub_f32 v60, v60, v72
    v_cvt_pk_bf16_f32 v60, v60, v60
    v_lshlrev_b32 v60, 16, v60
    v_mul_f32 v74, v60, v75
    v_fma_f32 v77, -v74, v73, v60
    v_fma_f32 v60, v77, v75, v74
    v_cvt_pk_bf16_f32 v10, v50, v60
    v_lshlrev_b32 v74, 16, v10
    v_lshlrev_b32 v77, 16, v28
    v_fmac_f32 v76, v74, v77
    v_and_b32 v74, 0xffff0000, v10
    v_and_b32 v77, 0xffff0000, v28
    v_fmac_f32 v76, v74, v77
    v_sub_f32 v51, v51, v72
    v_cvt_pk_bf16_f32 v51, v51, v51
    v_lshlrev_b32 v51, 16, v51
    v_mul_f32 v74, v51, v75
    v_fma_f32 v77, -v74, v73, v51
    v_fma_f32 v51, v77, v75, v74
    v_sub_f32 v61, v61, v72
    v_cvt_pk_bf16_f32 v61, v61, v61
    v_lshlrev_b32 v61, 16, v61
    v_mul_f32 v74, v61, v75
    v_fma_f32 v77, -v74, v73, v61
    v_fma_f32 v61, v77, v75, v74
    v_cvt_pk_bf16_f32 v11, v51, v61
    v_lshlrev_b32 v74, 16, v11
    v_lshlrev_b32 v77, 16, v29
    v_fmac_f32 v76, v74, v77
    v_and_b32 v74, 0xffff0000, v11
    v_and_b32 v77, 0xffff0000, v29
    v_fmac_f32 v76, v74, v77
    v_sub_f32 v52, v52, v72
    v_cvt_pk_bf16_f32 v52, v52, v52
    v_lshlrev_b32 v52, 16, v52
    v_mul_f32 v74, v52, v75
    v_fma_f32 v77, -v74, v73, v52
    v_fma_f32 v52, v77, v75, v74
    v_sub_f32 v62, v62, v72
    v_cvt_pk_bf16_f32 v62, v62, v62
    v_lshlrev_b32 v62, 16, v62
    v_mul_f32 v74, v62, v75
    v_fma_f32 v77, -v74, v73, v62
    v_fma_f32 v62, v77, v75, v74
    v_cvt_pk_bf16_f32 v12, v52, v62
    v_lshlrev_b32 v74, 16, v12
    v_lshlrev_b32 v77, 16, v30
    v_fmac_f32 v76, v74, v77
    v_and_b32 v74, 0xffff0000, v12
    v_and_b32 v77, 0xffff0000, v30
    v_fmac_f32 v76, v74, v77
    v_sub_f32 v53, v53, v72
    v_cvt_pk_bf16_f32 v53, v53, v53
    v_lshlrev_b32 v53, 16, v53
    v_mul_f32 v74, v53, v75
    v_fma_f32 v77, -v74, v73, v53
    v_fma_f32 v53, v77, v75, v74
    v_sub_f32 v63, v63, v72
    v_cvt_pk_bf16_f32 v63, v63, v63
    v_lshlrev_b32 v63, 16, v63
    v_mul_f32 v74, v63, v75
    v_fma_f32 v77, -v74, v73, v63
    v_fma_f32 v63, v77, v75, v74
    v_cvt_pk_bf16_f32 v13, v53, v63
    v_lshlrev_b32 v74, 16, v13
    v_lshlrev_b32 v77, 16, v31
    v_fmac_f32 v76, v74, v77
    v_and_b32 v74, 0xffff0000, v13
    v_and_b32 v77, 0xffff0000, v31
    v_fmac_f32 v76, v74, v77
    v_sub_f32 v54, v54, v72
    v_cvt_pk_bf16_f32 v54, v54, v54
    v_lshlrev_b32 v54, 16, v54
    v_mul_f32 v74, v54, v75
    v_fma_f32 v77, -v74, v73, v54
    v_fma_f32 v54, v77, v75, v74
    v_sub_f32 v64, v64, v72
    v_cvt_pk_bf16_f32 v64, v64, v64
    v_lshlrev_b32 v64, 16, v64
    v_mul_f32 v74, v64, v75
    v_fma_f32 v77, -v74, v73, v64
    v_fma_f32 v64, v77, v75, v74
    v_cvt_pk_bf16_f32 v14, v54, v64
    v_lshlrev_b32 v74, 16, v14
    v_lshlrev_b32 v77, 16, v32
    v_fmac_f32 v76, v74, v77
    v_and_b32 v74, 0xffff0000, v14
    v_and_b32 v77, 0xffff0000, v32
    v_fmac_f32 v76, v74, v77
    s_add_u32 s30, s33, 0x0
    buffer_store_dwordx4 v[10:13], v3, s[4:7], s30 offen sc1
    buffer_store_dword v14, v4, s[4:7], s30 offen offset:1024 sc1
    s_nop 1
    v_add_f32_dpp v76, v76, v76 quad_perm:[1,0,3,2] row_mask:0xf bank_mask:0xf
    s_nop 1
    v_add_f32_dpp v76, v76, v76 quad_perm:[2,3,0,1] row_mask:0xf bank_mask:0xf
    s_nop 1
    v_add_f32_dpp v76, v76, v76 row_half_mirror row_mask:0xf bank_mask:0xf
    s_nop 1
    v_add_f32_dpp v76, v76, v76 row_mirror row_mask:0xf bank_mask:0xf
    v_mov_b32 v71, v76
    s_nop 1
    v_permlane16_swap_b32 v76, v71
    v_add_f32 v76, v76, v71
    v_mov_b32 v71, v76
    s_nop 1
    v_permlane32_swap_b32 v76, v71
    v_add_f32 v76, v76, v71
    v_cvt_pk_bf16_f32 v76, v76, v76
    v_lshlrev_b32 v76, 16, v76
    s_lshl_b32 s30, s29, 2
    s_add_u32 s30, s30, 0x280000
    s_mov_b64 exec, 1
    buffer_store_dword v76, off, s[4:7], s30 sc1
    s_mov_b64 exec, -1
INR_98:
    s_add_u32 s29, s28, 1
    s_cmp_ge_u32 s29, 2048
    s_cbranch_scc1 INR_99
    v_lshlrev_b32 v50, 16, v16
    v_and_b32 v60, 0xffff0000, v16
    v_lshlrev_b32 v51, 16, v17
    v_and_b32 v61, 0xffff0000, v17
    v_lshlrev_b32 v52, 16, v18
    v_and_b32 v62, 0xffff0000, v18
    v_lshlrev_b32 v53, 16, v19
    v_and_b32 v63, 0xffff0000, v19
    v_lshlrev_b32 v54, 16, v20
    v_and_b32 v64, 0xffff0000, v20
    v_add_f32 v70, v50, v60
    v_add_f32 v70, v70, v51
    v_add_f32 v70, v70, v61
    v_add_f32 v70, v70, v52
    v_add_f32 v70, v70, v62
    v_add_f32 v70, v70, v53
    v_add_f32 v70, v70, v63
    v_add_f32 v70, v70, v54
    v_add_f32 v70, v70, v64
    s_nop 1
    v_add_f32_dpp v70, v70, v70 quad_perm:[1,0,3,2] row_mask:0xf bank_mask:0xf
    s_nop 1
    v_add_f32_dpp v70, v70, v70 quad_perm:[2,3,0,1] row_mask:0xf bank_mask:0xf
    s_nop 1
    v_add_f32_dpp v70, v70, v70 row_half_mirror row_mask:0xf bank_mask:0xf
    s_nop 1
    v_add_f32_dpp v70, v70, v70 row_mirror row_mask:0xf bank_mask:0xf
    v_mov_b32 v71, v70
    s_nop 1
    v_permlane16_swap_b32 v70, v71
    v_add_f32 v70, v70, v71
    v_mov_b32 v71, v70
    s_nop 1
    v_permlane32_swap_b32 v70, v71
    v_add_f32 v70, v70, v71
    v_mul_f32 v72, 0x3acccccd, v70
    v_mov_b32 v73, 0
    v_sub_f32 v74, v50, v72
    v_fmac_f32 v73, v74, v74
    v_sub_f32 v74, v60, v72
    v_fmac_f32 v73, v74, v74
    v_sub_f32 v74, v51, v72
    v_fmac_f32 v73, v74, v74
    v_sub_f32 v74, v61, v72
    v_fmac_f32 v73, v74, v74
    v_sub_f32 v74, v52, v72
    v_fmac_f32 v73, v74, v74
    v_sub_f32 v74, v62, v72
    v_fmac_f32 v73, v74, v74
    v_sub_f32 v74, v53, v72
    v_fmac_f32 v73, v74, v74
    v_sub_f32 v74, v63, v72
    v_fmac_f32 v73, v74, v74
    v_sub_f32 v74, v54, v72
    v_fmac_f32 v73, v74, v74
    v_sub_f32 v74, v64, v72
    v_fmac_f32 v73, v74, v74
    s_nop 1
    v_add_f32_dpp v73, v73, v73 quad_perm:[1,0,3,2] row_mask:0xf bank_mask:0xf
    s_nop 1
    v_add_f32_dpp v73, v73, v73 quad_perm:[2,3,0,1] row_mask:0xf bank_mask:0xf
    s_nop 1
    v_add_f32_dpp v73, v73, v73 row_half_mirror row_mask:0xf bank_mask:0xf
    s_nop 1
    v_add_f32_dpp v73, v73, v73 row_mirror row_mask:0xf bank_mask:0xf
    v_mov_b32 v71, v73
    s_nop 1
    v_permlane16_swap_b32 v73, v71
    v_add_f32 v73, v73, v71
    v_mov_b32 v71, v73
    s_nop 1
    v_permlane32_swap_b32 v73, v71
    v_add_f32 v73, v73, v71
    v_mul_f32 v73, 0x3acccccd, v73
    v_cvt_pk_bf16_f32 v72, v72, v72
    v_lshlrev_b32 v72, 16, v72
    v_cvt_pk_bf16_f32 v73, v73, v73
    v_lshlrev_b32 v73, 16, v73
    v_add_f32 v73, 0x3727c5ac, v73
    v_cvt_pk_bf16_f32 v73, v73, v73
    v_lshlrev_b32 v73, 16, v73
    v_sqrt_f32 v73, v73
    s_nop 0
    v_cvt_pk_bf16_f32 v73, v73, v73
    v_lshlrev_b32 v73, 16, v73
    v_rcp_f32 v75, v73
    s_nop 0
    v_mov_b32 v76, 0
    v_sub_f32 v50, v50, v72
    v_cvt_pk_bf16_f32 v50, v50, v50
    v_lshlrev_b32 v50, 16, v50
    v_mul_f32 v74, v50, v75
    v_fma_f32 v77, -v74, v73, v50
    v_fma_f32 v50, v77, v75, v74
    v_sub_f32 v60, v60, v72
    v_cvt_pk_bf16_f32 v60, v60, v60
    v_lshlrev_b32 v60, 16, v60
    v_mul_f32 v74, v60, v75
    v_fma_f32 v77, -v74, v73, v60
    v_fma_f32 v60, v77, v75, v74
    v_cvt_pk_bf16_f32 v16, v50, v60
    v_lshlrev_b32 v74, 16, v16
    v_lshlrev_b32 v77, 16, v28
    v_fmac_f32 v76, v74, v77
    v_and_b32 v74, 0xffff0000, v16
    v_and_b32 v77, 0xffff0000, v28
    v_fmac_f32 v76, v74, v77
    v_sub_f32 v51, v51, v72
    v_cvt_pk_bf16_f32 v51, v51, v51
    v_lshlrev_b32 v51, 16, v51
    v_mul_f32 v74, v51, v75
    v_fma_f32 v77, -v74, v73, v51
    v_fma_f32 v51, v77, v75, v74
    v_sub_f32 v61, v61, v72
    v_cvt_pk_bf16_f32 v61, v61, v61
    v_lshlrev_b32 v61, 16, v61
    v_mul_f32 v74, v61, v75
    v_fma_f32 v77, -v74, v73, v61
    v_fma_f32 v61, v77, v75, v74
    v_cvt_pk_bf16_f32 v17, v51, v61
    v_lshlrev_b32 v74, 16, v17
    v_lshlrev_b32 v77, 16, v29
    v_fmac_f32 v76, v74, v77
    v_and_b32 v74, 0xffff0000, v17
    v_and_b32 v77, 0xffff0000, v29
    v_fmac_f32 v76, v74, v77
    v_sub_f32 v52, v52, v72
    v_cvt_pk_bf16_f32 v52, v52, v52
    v_lshlrev_b32 v52, 16, v52
    v_mul_f32 v74, v52, v75
    v_fma_f32 v77, -v74, v73, v52
    v_fma_f32 v52, v77, v75, v74
    v_sub_f32 v62, v62, v72
    v_cvt_pk_bf16_f32 v62, v62, v62
    v_lshlrev_b32 v62, 16, v62
    v_mul_f32 v74, v62, v75
    v_fma_f32 v77, -v74, v73, v62
    v_fma_f32 v62, v77, v75, v74
    v_cvt_pk_bf16_f32 v18, v52, v62
    v_lshlrev_b32 v74, 16, v18
    v_lshlrev_b32 v77, 16, v30
    v_fmac_f32 v76, v74, v77
    v_and_b32 v74, 0xffff0000, v18
    v_and_b32 v77, 0xffff0000, v30
    v_fmac_f32 v76, v74, v77
    v_sub_f32 v53, v53, v72
    v_cvt_pk_bf16_f32 v53, v53, v53
    v_lshlrev_b32 v53, 16, v53
    v_mul_f32 v74, v53, v75
    v_fma_f32 v77, -v74, v73, v53
    v_fma_f32 v53, v77, v75, v74
    v_sub_f32 v63, v63, v72
    v_cvt_pk_bf16_f32 v63, v63, v63
    v_lshlrev_b32 v63, 16, v63
    v_mul_f32 v74, v63, v75
    v_fma_f32 v77, -v74, v73, v63
    v_fma_f32 v63, v77, v75, v74
    v_cvt_pk_bf16_f32 v19, v53, v63
    v_lshlrev_b32 v74, 16, v19
    v_lshlrev_b32 v77, 16, v31
    v_fmac_f32 v76, v74, v77
    v_and_b32 v74, 0xffff0000, v19
    v_and_b32 v77, 0xffff0000, v31
    v_fmac_f32 v76, v74, v77
    v_sub_f32 v54, v54, v72
    v_cvt_pk_bf16_f32 v54, v54, v54
    v_lshlrev_b32 v54, 16, v54
    v_mul_f32 v74, v54, v75
    v_fma_f32 v77, -v74, v73, v54
    v_fma_f32 v54, v77, v75, v74
    v_sub_f32 v64, v64, v72
    v_cvt_pk_bf16_f32 v64, v64, v64
    v_lshlrev_b32 v64, 16, v64
    v_mul_f32 v74, v64, v75
    v_fma_f32 v77, -v74, v73, v64
    v_fma_f32 v64, v77, v75, v74
    v_cvt_pk_bf16_f32 v20, v54, v64
    v_lshlrev_b32 v74, 16, v20
    v_lshlrev_b32 v77, 16, v32
    v_fmac_f32 v76, v74, v77
    v_and_b32 v74, 0xffff0000, v20
    v_and_b32 v77, 0xffff0000, v32
    v_fmac_f32 v76, v74, v77
    s_add_u32 s30, s34, 0x0
    buffer_store_dwordx4 v[16:19], v3, s[4:7], s30 offen sc1
    buffer_store_dword v20, v4, s[4:7], s30 offen offset:1024 sc1
    s_nop 1
    v_add_f32_dpp v76, v76, v76 quad_perm:[1,0,3,2] row_mask:0xf bank_mask:0xf
    s_nop 1
    v_add_f32_dpp v76, v76, v76 quad_perm:[2,3,0,1] row_mask:0xf bank_mask:0xf
    s_nop 1
    v_add_f32_dpp v76, v76, v76 row_half_mirror row_mask:0xf bank_mask:0xf
    s_nop 1
    v_add_f32_dpp v76, v76, v76 row_mirror row_mask:0xf bank_mask:0xf
    v_mov_b32 v71, v76
    s_nop 1
    v_permlane16_swap_b32 v76, v71
    v_add_f32 v76, v76, v71
    v_mov_b32 v71, v76
    s_nop 1
    v_permlane32_swap_b32 v76, v71
    v_add_f32 v76, v76, v71
    v_cvt_pk_bf16_f32 v76, v76, v76
    v_lshlrev_b32 v76, 16, v76
    s_lshl_b32 s30, s29, 2
    s_add_u32 s30, s30, 0x280000
    s_mov_b64 exec, 1
    buffer_store_dword v76, off, s[4:7], s30 sc1
    s_mov_b64 exec, -1
INR_99:
    s_add_u32 s29, s28, 2
    s_cmp_ge_u32 s29, 2048
    s_cbranch_scc1 INR_100
    v_lshlrev_b32 v50, 16, v22
    v_and_b32 v60, 0xffff0000, v22
    v_lshlrev_b32 v51, 16, v23
    v_and_b32 v61, 0xffff0000, v23
    v_lshlrev_b32 v52, 16, v24
    v_and_b32 v62, 0xffff0000, v24
    v_lshlrev_b32 v53, 16, v25
    v_and_b32 v63, 0xffff0000, v25
    v_lshlrev_b32 v54, 16, v26
    v_and_b32 v64, 0xffff0000, v26
    v_add_f32 v70, v50, v60
    v_add_f32 v70, v70, v51
    v_add_f32 v70, v70, v61
    v_add_f32 v70, v70, v52
    v_add_f32 v70, v70, v62
    v_add_f32 v70, v70, v53
    v_add_f32 v70, v70, v63
    v_add_f32 v70, v70, v54
    v_add_f32 v70, v70, v64
    s_nop 1
    v_add_f32_dpp v70, v70, v70 quad_perm:[1,0,3,2] row_mask:0xf bank_mask:0xf
    s_nop 1
    v_add_f32_dpp v70, v70, v70 quad_perm:[2,3,0,1] row_mask:0xf bank_mask:0xf
    s_nop 1
    v_add_f32_dpp v70, v70, v70 row_half_mirror row_mask:0xf bank_mask:0xf
    s_nop 1
    v_add_f32_dpp v70, v70, v70 row_mirror row_mask:0xf bank_mask:0xf
    v_mov_b32 v71, v70
    s_nop 1
    v_permlane16_swap_b32 v70, v71
    v_add_f32 v70, v70, v71
    v_mov_b32 v71, v70
    s_nop 1
    v_permlane32_swap_b32 v70, v71
    v_add_f32 v70, v70, v71
    v_mul_f32 v72, 0x3acccccd, v70
    v_mov_b32 v73, 0
    v_sub_f32 v74, v50, v72
    v_fmac_f32 v73, v74, v74
    v_sub_f32 v74, v60, v72
    v_fmac_f32 v73, v74, v74
    v_sub_f32 v74, v51, v72
    v_fmac_f32 v73, v74, v74
    v_sub_f32 v74, v61, v72
    v_fmac_f32 v73, v74, v74
    v_sub_f32 v74, v52, v72
    v_fmac_f32 v73, v74, v74
    v_sub_f32 v74, v62, v72
    v_fmac_f32 v73, v74, v74
    v_sub_f32 v74, v53, v72
    v_fmac_f32 v73, v74, v74
    v_sub_f32 v74, v63, v72
    v_fmac_f32 v73, v74, v74
    v_sub_f32 v74, v54, v72
    v_fmac_f32 v73, v74, v74
    v_sub_f32 v74, v64, v72
    v_fmac_f32 v73, v74, v74
    s_nop 1
    v_add_f32_dpp v73, v73, v73 quad_perm:[1,0,3,2] row_mask:0xf bank_mask:0xf
    s_nop 1
    v_add_f32_dpp v73, v73, v73 quad_perm:[2,3,0,1] row_mask:0xf bank_mask:0xf
    s_nop 1
    v_add_f32_dpp v73, v73, v73 row_half_mirror row_mask:0xf bank_mask:0xf
    s_nop 1
    v_add_f32_dpp v73, v73, v73 row_mirror row_mask:0xf bank_mask:0xf
    v_mov_b32 v71, v73
    s_nop 1
    v_permlane16_swap_b32 v73, v71
    v_add_f32 v73, v73, v71
    v_mov_b32 v71, v73
    s_nop 1
    v_permlane32_swap_b32 v73, v71
    v_add_f32 v73, v73, v71
    v_mul_f32 v73, 0x3acccccd, v73
    v_cvt_pk_bf16_f32 v72, v72, v72
    v_lshlrev_b32 v72, 16, v72
    v_cvt_pk_bf16_f32 v73, v73, v73
    v_lshlrev_b32 v73, 16, v73
    v_add_f32 v73, 0x3727c5ac, v73
    v_cvt_pk_bf16_f32 v73, v73, v73
    v_lshlrev_b32 v73, 16, v73
    v_sqrt_f32 v73, v73
    s_nop 0
    v_cvt_pk_bf16_f32 v73, v73, v73
    v_lshlrev_b32 v73, 16, v73
    v_rcp_f32 v75, v73
    s_nop 0
    v_mov_b32 v76, 0
    v_sub_f32 v50, v50, v72
    v_cvt_pk_bf16_f32 v50, v50, v50
    v_lshlrev_b32 v50, 16, v50
    v_mul_f32 v74, v50, v75
    v_fma_f32 v77, -v74, v73, v50
    v_fma_f32 v50, v77, v75, v74
    v_sub_f32 v60, v60, v72
    v_cvt_pk_bf16_f32 v60, v60, v60
    v_lshlrev_b32 v60, 16, v60
    v_mul_f32 v74, v60, v75
    v_fma_f32 v77, -v74, v73, v60
    v_fma_f32 v60, v77, v75, v74
    v_cvt_pk_bf16_f32 v22, v50, v60
    v_lshlrev_b32 v74, 16, v22
    v_lshlrev_b32 v77, 16, v28
    v_fmac_f32 v76, v74, v77
    v_and_b32 v74, 0xffff0000, v22
    v_and_b32 v77, 0xffff0000, v28
    v_fmac_f32 v76, v74, v77
    v_sub_f32 v51, v51, v72
    v_cvt_pk_bf16_f32 v51, v51, v51
    v_lshlrev_b32 v51, 16, v51
    v_mul_f32 v74, v51, v75
    v_fma_f32 v77, -v74, v73, v51
    v_fma_f32 v51, v77, v75, v74
    v_sub_f32 v61, v61, v72
    v_cvt_pk_bf16_f32 v61, v61, v61
    v_lshlrev_b32 v61, 16, v61
    v_mul_f32 v74, v61, v75
    v_fma_f32 v77, -v74, v73, v61
    v_fma_f32 v61, v77, v75, v74
    v_cvt_pk_bf16_f32 v23, v51, v61
    v_lshlrev_b32 v74, 16, v23
    v_lshlrev_b32 v77, 16, v29
    v_fmac_f32 v76, v74, v77
    v_and_b32 v74, 0xffff0000, v23
    v_and_b32 v77, 0xffff0000, v29
    v_fmac_f32 v76, v74, v77
    v_sub_f32 v52, v52, v72
    v_cvt_pk_bf16_f32 v52, v52, v52
    v_lshlrev_b32 v52, 16, v52
    v_mul_f32 v74, v52, v75
    v_fma_f32 v77, -v74, v73, v52
    v_fma_f32 v52, v77, v75, v74
    v_sub_f32 v62, v62, v72
    v_cvt_pk_bf16_f32 v62, v62, v62
    v_lshlrev_b32 v62, 16, v62
    v_mul_f32 v74, v62, v75
    v_fma_f32 v77, -v74, v73, v62
    v_fma_f32 v62, v77, v75, v74
    v_cvt_pk_bf16_f32 v24, v52, v62
    v_lshlrev_b32 v74, 16, v24
    v_lshlrev_b32 v77, 16, v30
    v_fmac_f32 v76, v74, v77
    v_and_b32 v74, 0xffff0000, v24
    v_and_b32 v77, 0xffff0000, v30
    v_fmac_f32 v76, v74, v77
    v_sub_f32 v53, v53, v72
    v_cvt_pk_bf16_f32 v53, v53, v53
    v_lshlrev_b32 v53, 16, v53
    v_mul_f32 v74, v53, v75
    v_fma_f32 v77, -v74, v73, v53
    v_fma_f32 v53, v77, v75, v74
    v_sub_f32 v63, v63, v72
    v_cvt_pk_bf16_f32 v63, v63, v63
    v_lshlrev_b32 v63, 16, v63
    v_mul_f32 v74, v63, v75
    v_fma_f32 v77, -v74, v73, v63
    v_fma_f32 v63, v77, v75, v74
    v_cvt_pk_bf16_f32 v25, v53, v63
    v_lshlrev_b32 v74, 16, v25
    v_lshlrev_b32 v77, 16, v31
    v_fmac_f32 v76, v74, v77
    v_and_b32 v74, 0xffff0000, v25
    v_and_b32 v77, 0xffff0000, v31
    v_fmac_f32 v76, v74, v77
    v_sub_f32 v54, v54, v72
    v_cvt_pk_bf16_f32 v54, v54, v54
    v_lshlrev_b32 v54, 16, v54
    v_mul_f32 v74, v54, v75
    v_fma_f32 v77, -v74, v73, v54
    v_fma_f32 v54, v77, v75, v74
    v_sub_f32 v64, v64, v72
    v_cvt_pk_bf16_f32 v64, v64, v64
    v_lshlrev_b32 v64, 16, v64
    v_mul_f32 v74, v64, v75
    v_fma_f32 v77, -v74, v73, v64
    v_fma_f32 v64, v77, v75, v74
    v_cvt_pk_bf16_f32 v26, v54, v64
    v_lshlrev_b32 v74, 16, v26
    v_lshlrev_b32 v77, 16, v32
    v_fmac_f32 v76, v74, v77
    v_and_b32 v74, 0xffff0000, v26
    v_and_b32 v77, 0xffff0000, v32
    v_fmac_f32 v76, v74, v77
    s_add_u32 s30, s35, 0x0
    buffer_store_dwordx4 v[22:25], v3, s[4:7], s30 offen sc1
    buffer_store_dword v26, v4, s[4:7], s30 offen offset:1024 sc1
    s_nop 1
    v_add_f32_dpp v76, v76, v76 quad_perm:[1,0,3,2] row_mask:0xf bank_mask:0xf
    s_nop 1
    v_add_f32_dpp v76, v76, v76 quad_perm:[2,3,0,1] row_mask:0xf bank_mask:0xf
    s_nop 1
    v_add_f32_dpp v76, v76, v76 row_half_mirror row_mask:0xf bank_mask:0xf
    s_nop 1
    v_add_f32_dpp v76, v76, v76 row_mirror row_mask:0xf bank_mask:0xf
    v_mov_b32 v71, v76
    s_nop 1
    v_permlane16_swap_b32 v76, v71
    v_add_f32 v76, v76, v71
    v_mov_b32 v71, v76
    s_nop 1
    v_permlane32_swap_b32 v76, v71
    v_add_f32 v76, v76, v71
    v_cvt_pk_bf16_f32 v76, v76, v76
    v_lshlrev_b32 v76, 16, v76
    s_lshl_b32 s30, s29, 2
    s_add_u32 s30, s30, 0x280000
    s_mov_b64 exec, 1
    buffer_store_dword v76, off, s[4:7], s30 sc1
    s_mov_b64 exec, -1
INR_100:
    s_lshl_b32 s29, s96, 2
    s_add_u32 s29, s29, s14
    s_lshl_b32 s29, s29, 6
    v_add_u32 v5, s29, v0
    v_lshlrev_b32 v6, 4, v5
    v_mov_b32 v44, 0
    v_mov_b32 v45, 0
    v_mov_b32 v46, 0
    v_mov_b32 v47, 0
    v_cmp_gt_u32 vcc, 0x1000, v5
    s_nop 0
    s_and_saveexec_b64 s[38:39], vcc
    s_cbranch_execz INF_101
    s_mov_b32 s30, 0x290000
    buffer_store_dwordx4 v[44:47], v6, s[4:7], s30 offen sc1
INF_101:
    s_mov_b64 exec, s[38:39]
    s_waitcnt vmcnt(0)
    s_barrier
    s_cmp_lg_u32 s14, 0
    s_cbranch_scc1 INA_102
    v_mov_b32 v8, 1
    s_mov_b64 exec, 1
    buffer_atomic_add v8, off, s[60:63], s95 sc1
    s_mov_b64 exec, -1
INA_102:
INP2_96:
    s_lshl_b32 s29, s96, 2
    s_add_u32 s29, s29, s14
    s_lshl_b32 s29, s29, 6
    v_add_u32 v5, s29, v0
    v_lshlrev_b32 v6, 4, v5
    v_mov_b32 v40, -1
    v_mov_b32 v41, -1
    v_mov_b32 v42, -1
    v_mov_b32 v43, -1
    v_cmp_gt_u32 vcc, 0x5000, v5
    s_nop 0
    s_and_saveexec_b64 s[38:39], vcc
    s_cbranch_execz INF_103
    s_mov_b32 s30, 0x300000
    buffer_store_dwordx4 v[40:43], v6, s[4:7], s30 offen sc1
INF_103:
    s_mov_b64 exec, s[38:39]
    v_lshrrev_b32 v7, 6, v5
    v_mul_u32_u24 v7, 52429, v7
    v_lshrrev_b32 v7, 18, v7
    v_mul_u32_u24 v8, 320, v7
    v_sub_u32 v8, v5, v8
    v_lshlrev_b32 v48, 4, v8
    v_lshl_add_u32 v49, v7, 13, v48
    v_cmp_gt_u32 vcc, 0xa000, v5
    s_nop 0
    s_and_saveexec_b64 s[38:39], vcc
    s_cbranch_execz INF_104
    s_mov_b32 s30, 0x5904000
    buffer_store_dwordx4 v[40:43], v49, s[4:7], s30 offen sc1
INF_104:
    s_mov_b64 exec, s[38:39]
    s_cmp_ge_u32 s96, 10
    s_cbranch_scc1 INM1_105
    s_cmp_lg_u32 s14, 0
    s_cbranch_scc1 INM1_105
    s_cmp_ge_u32 s96, 5
    s_cselect_b32 s36, 1, 0
    s_mul_i32 s29, s36, 5
    s_sub_u32 s29, s96, s29
    s_lshl_b32 s29, s29, 10
    s_lshl_b32 s30, s36, 13
    s_add_u32 s30, s30, 0x5900000
    s_add_u32 s30, s30, s29
    buffer_store_dwordx4 v[34:37], v3, s[4:7], s30 offen sc1
INM1_105:
    s_lshl_b32 s40, s13, 8
    s_lshl_b32 s42, s14, 17
    s_add_u32 s40, s40, s42
    s_mul_i32 s41, s14, 40960
    v_lshrrev_b32 v81, 4, v0
    v_lshlrev_b32 v79, 13, v81
    v_lshlrev_b32 v81, 1, v81
    v_and_b32 v82, 15, v0
    v_xor_b32 v81, v81, v82
    v_xor_b32 v82, 8, v81
    v_lshl_add_u32 v80, v82, 4, v79
    v_lshl_add_u32 v79, v81, 4, v79
    s_add_u32 m0, s41, 0
    s_add_u32 s42, s40, 0x0
    buffer_load_dwordx4 v79, s[44:47], s42 offen lds
    s_add_u32 m0, s41, 1024
    s_add_u32 s42, s40, 0x8000
    buffer_load_dwordx4 v79, s[44:47], s42 offen lds
    s_add_u32 m0, s41, 2048
    s_add_u32 s42, s40, 0x10000
    buffer_load_dwordx4 v80, s[44:47], s42 offen lds
    s_add_u32 m0, s41, 3072
    s_add_u32 s42, s40, 0x18000
    buffer_load_dwordx4 v80, s[44:47], s42 offen lds
    s_add_u32 m0, s41, 4096
    s_add_u32 s42, s40, 0x80000
    buffer_load_dwordx4 v79, s[44:47], s42 offen lds
    s_add_u32 m0, s41, 5120
    s_add_u32 s42, s40, 0x88000
    buffer_load_dwordx4 v79, s[44:47], s42 offen lds
    s_add_u32 m0, s41, 6144
    s_add_u32 s42, s40, 0x90000
    buffer_load_dwordx4 v80, s[44:47], s42 offen lds
    s_add_u32 m0, s41, 7168
    s_add_u32 s42, s40, 0x98000
    buffer_load_dwordx4 v80, s[44:47], s42 offen lds
    s_add_u32 m0, s41, 8192
    s_add_u32 s42, s40, 0x100000
    buffer_load_dwordx4 v79, s[44:47], s42 offen lds
    s_add_u32 m0, s41, 9216
    s_add_u32 s42, s40, 0x108000
    buffer_load_dwordx4 v79, s[44:47], s42 offen lds
    s_add_u32 m0, s41, 10240
    s_add_u32 s42, s40, 0x110000
    buffer_load_dwordx4 v80, s[44:47], s42 offen lds
    s_add_u32 m0, s41, 11264
    s_add_u32 s42, s40, 0x118000
    buffer_load_dwordx4 v80, s[44:47], s42 offen lds
    s_add_u32 m0, s41, 12288
    s_add_u32 s42, s40, 0x180000
    buffer_load_dwordx4 v79, s[44:47], s42 offen lds
    s_add_u32 m0, s41, 13312
    s_add_u32 s42, s40, 0x188000
    buffer_load_dwordx4 v79, s[44:47], s42 offen lds
    s_add_u32 m0, s41, 14336
    s_add_u32 s42, s40, 0x190000
    buffer_load_dwordx4 v80, s[44:47], s42 offen lds
    s_add_u32 m0, s41, 15360
    s_add_u32 s42, s40, 0x198000
    buffer_load_dwordx4 v80, s[44:47], s42 offen lds
    s_add_u32 m0, s41, 16384
    s_add_u32 s42, s40, 0x200000
    buffer_load_dwordx4 v79, s[44:47], s42 offen lds
    s_add_u32 m0, s41, 17408
    s_add_u32 s42, s40, 0x208000
    buffer_load_dwordx4 v79, s[44:47], s42 offen lds
    s_add_u32 m0, s41, 18432
    s_add_u32 s42, s40, 0x210000
    buffer_load_dwordx4 v80, s[44:47], s42 offen lds
    s_add_u32 m0, s41, 19456
    s_add_u32 s42, s40, 0x218000
    buffer_load_dwordx4 v80, s[44:47], s42 offen lds
    s_add_u32 m0, s41, 20480
    s_add_u32 s42, s40, 0x280000
    buffer_load_dwordx4 v79, s[44:47], s42 offen lds
    s_add_u32 m0, s41, 21504
    s_add_u32 s42, s40, 0x288000
    buffer_load_dwordx4 v79, s[44:47], s42 offen lds
    s_add_u32 m0, s41, 22528
    s_add_u32 s42, s40, 0x290000
    buffer_load_dwordx4 v80, s[44:47], s42 offen lds
    s_add_u32 m0, s41, 23552
    s_add_u32 s42, s40, 0x298000
    buffer_load_dwordx4 v80, s[44:47], s42 offen lds
    s_add_u32 m0, s41, 24576
    s_add_u32 s42, s40, 0x300000
    buffer_load_dwordx4 v79, s[44:47], s42 offen lds
    s_add_u32 m0, s41, 25600
    s_add_u32 s42, s40, 0x308000
    buffer_load_dwordx4 v79, s[44:47], s42 offen lds
    s_add_u32 m0, s41, 26624
    s_add_u32 s42, s40, 0x310000
    buffer_load_dwordx4 v80, s[44:47], s42 offen lds
    s_add_u32 m0, s41, 27648
    s_add_u32 s42, s40, 0x318000
    buffer_load_dwordx4 v80, s[44:47], s42 offen lds
    s_add_u32 m0, s41, 28672
    s_add_u32 s42, s40, 0x380000
    buffer_load_dwordx4 v79, s[44:47], s42 offen lds
    s_add_u32 m0, s41, 29696
    s_add_u32 s42, s40, 0x388000
    buffer_load_dwordx4 v79, s[44:47], s42 offen lds
    s_add_u32 m0, s41, 30720
    s_add_u32 s42, s40, 0x390000
    buffer_load_dwordx4 v80, s[44:47], s42 offen lds
    s_add_u32 m0, s41, 31744
    s_add_u32 s42, s40, 0x398000
    buffer_load_dwordx4 v80, s[44:47], s42 offen lds
    s_add_u32 m0, s41, 32768
    s_add_u32 s42, s40, 0x400000
    buffer_load_dwordx4 v79, s[44:47], s42 offen lds
    s_add_u32 m0, s41, 33792
    s_add_u32 s42, s40, 0x408000
    buffer_load_dwordx4 v79, s[44:47], s42 offen lds
    s_add_u32 m0, s41, 34816
    s_add_u32 s42, s40, 0x410000
    buffer_load_dwordx4 v80, s[44:47], s42 offen lds
    s_add_u32 m0, s41, 35840
    s_add_u32 s42, s40, 0x418000
    buffer_load_dwordx4 v80, s[44:47], s42 offen lds
    s_add_u32 m0, s41, 36864
    s_add_u32 s42, s40, 0x480000
    buffer_load_dwordx4 v79, s[44:47], s42 offen lds
    s_add_u32 m0, s41, 37888
    s_add_u32 s42, s40, 0x488000
    buffer_load_dwordx4 v79, s[44:47], s42 offen lds
    s_add_u32 m0, s41, 38912
    s_add_u32 s42, s40, 0x490000
    buffer_load_dwordx4 v80, s[44:47], s42 offen lds
    s_add_u32 m0, s41, 39936
    s_add_u32 s42, s40, 0x498000
    buffer_load_dwordx4 v80, s[44:47], s42 offen lds
    v_mbcnt_lo_u32_b32 v0, -1, 0
    v_mbcnt_hi_u32_b32 v0, -1, v0
    s_cmp_eq_u32 s3, 0
    s_cbranch_scc1 H_E0
    s_cmp_eq_u32 s3, 1
    s_cbranch_scc1 H_E1
    s_cmp_eq_u32 s3, 2
    s_cbranch_scc1 H_E2
    s_branch M_EXIT
H_E0:
    s_lshl_b32 s16, s13, 14
    s_mov_b32 s17, 0x80000
    s_lshl_b32 s64, s14, 10
    s_add_u32 s16, s16, 0x1400000
    s_add_u32 s16, s16, s64
    s_mul_i32 s64, s12, s17
    s_lshl_b32 s64, s64, 2
    s_add_u32 s16, s16, s64
    s_lshl_b32 s18, s13, 4
    s_add_u32 s18, s18, 0x291000
    s_branch G_T
H_E1:
    s_lshl_b32 s16, s13, 14
    s_mov_b32 s17, 0x80000
    s_lshl_b32 s64, s14, 11
    s_add_u32 s16, s16, 0x1402000
    s_add_u32 s16, s16, s64
    s_mul_i32 s64, s12, s17
    s_lshl_b32 s64, s64, 2
    s_add_u32 s16, s16, s64
    s_lshl_b32 s18, s13, 4
    s_add_u32 s18, s18, 0x291004
    s_branch G_N
H_E2:
    s_lshl_b32 s16, s13, 13
    s_mov_b32 s17, 0x40000
    s_lshl_b32 s64, s14, 10
    s_add_u32 s16, s16, 0x3400000
    s_add_u32 s16, s16, s64
    s_mul_i32 s64, s12, s17
    s_lshl_b32 s64, s64, 2
    s_add_u32 s16, s16, s64
    s_lshl_b32 s18, s13, 4
    s_add_u32 s18, s18, 0x291008
    s_branch G_T
G_T:
    v_lshrrev_b32 v6, 5, v0
    v_mul_u32_u24 v7, 40960, v6
    v_bfe_u32 v6, v0, 4, 1
    v_lshl_add_u32 v7, v6, 11, v7
    v_lshlrev_b32 v8, 3, v6
    v_bfe_u32 v6, v0, 2, 2
    v_lshl_add_u32 v7, v6, 8, v7
    v_lshl_add_u32 v8, v6, 1, v8
    v_and_b32 v6, 1, v0
    v_lshl_add_u32 v7, v6, 3, v7
    v_bfe_u32 v6, v0, 1, 1
    s_lshl_b32 s64, s14, 2
    v_add_u32 v10, s64, v6
    v_add_u32 v6, 0, v10
    v_xor_b32 v6, v6, v8
    v_lshl_add_u32 v3, v6, 4, v7
    v_add_u32 v4, 81920, v3
    v_add_u32 v6, 2, v10
    v_xor_b32 v6, v6, v8
    v_lshl_add_u32 v5, v6, 4, v7
    v_add_u32 v9, 81920, v5
    s_waitcnt vmcnt(0)
    s_barrier
    ds_read_b64_tr_b16 v[96:97], v3 offset:0
    ds_read_b64_tr_b16 v[98:99], v3 offset:1024
    ds_read_b64_tr_b16 v[100:101], v5 offset:0
    ds_read_b64_tr_b16 v[102:103], v5 offset:1024
    ds_read_b64_tr_b16 v[104:105], v4 offset:0
    ds_read_b64_tr_b16 v[106:107], v4 offset:1024
    ds_read_b64_tr_b16 v[108:109], v9 offset:0
    ds_read_b64_tr_b16 v[110:111], v9 offset:1024
    ds_read_b64_tr_b16 v[112:113], v3 offset:4096
    ds_read_b64_tr_b16 v[114:115], v3 offset:5120
    ds_read_b64_tr_b16 v[116:117], v5 offset:4096
    ds_read_b64_tr_b16 v[118:119], v5 offset:5120
    ds_read_b64_tr_b16 v[120:121], v4 offset:4096
    ds_read_b64_tr_b16 v[122:123], v4 offset:5120
    ds_read_b64_tr_b16 v[124:125], v9 offset:4096
    ds_read_b64_tr_b16 v[126:127], v9 offset:5120
    s_waitcnt lgkmcnt(4)
    ds_read_b64_tr_b16 v[128:129], v3 offset:8192
    ds_read_b64_tr_b16 v[130:131], v3 offset:9216
    ds_read_b64_tr_b16 v[132:133], v5 offset:8192
    ds_read_b64_tr_b16 v[134:135], v5 offset:9216
    ds_read_b64_tr_b16 v[136:137], v4 offset:8192
    ds_read_b64_tr_b16 v[138:139], v4 offset:9216
    ds_read_b64_tr_b16 v[140:141], v9 offset:8192
    ds_read_b64_tr_b16 v[142:143], v9 offset:9216
    ds_read_b64_tr_b16 v[144:145], v3 offset:12288
    ds_read_b64_tr_b16 v[146:147], v3 offset:13312
    ds_read_b64_tr_b16 v[148:149], v5 offset:12288
    ds_read_b64_tr_b16 v[150:151], v5 offset:13312
    ds_read_b64_tr_b16 v[152:153], v4 offset:12288
    ds_read_b64_tr_b16 v[154:155], v4 offset:13312
    ds_read_b64_tr_b16 v[156:157], v9 offset:12288
    ds_read_b64_tr_b16 v[158:159], v9 offset:13312
    s_waitcnt lgkmcnt(4)
    ds_read_b64_tr_b16 v[160:161], v3 offset:16384
    ds_read_b64_tr_b16 v[162:163], v3 offset:17408
    ds_read_b64_tr_b16 v[164:165], v5 offset:16384
    ds_read_b64_tr_b16 v[166:167], v5 offset:17408
    ds_read_b64_tr_b16 v[168:169], v4 offset:16384
    ds_read_b64_tr_b16 v[170:171], v4 offset:17408
    ds_read_b64_tr_b16 v[172:173], v9 offset:16384
    ds_read_b64_tr_b16 v[174:175], v9 offset:17408
    ds_read_b64_tr_b16 v[176:177], v3 offset:20480
    ds_read_b64_tr_b16 v[178:179], v3 offset:21504
    ds_read_b64_tr_b16 v[180:181], v5 offset:20480
    ds_read_b64_tr_b16 v[182:183], v5 offset:21504
    ds_read_b64_tr_b16 v[184:185], v4 offset:20480
    ds_read_b64_tr_b16 v[186:187], v4 offset:21504
    ds_read_b64_tr_b16 v[188:189], v9 offset:20480
    ds_read_b64_tr_b16 v[190:191], v9 offset:21504
    s_waitcnt lgkmcnt(4)
    ds_read_b64_tr_b16 v[192:193], v3 offset:24576
    ds_read_b64_tr_b16 v[194:195], v3 offset:25600
    ds_read_b64_tr_b16 v[196:197], v5 offset:24576
    ds_read_b64_tr_b16 v[198:199], v5 offset:25600
    ds_read_b64_tr_b16 v[200:201], v4 offset:24576
    ds_read_b64_tr_b16 v[202:203], v4 offset:25600
    ds_read_b64_tr_b16 v[204:205], v9 offset:24576
    ds_read_b64_tr_b16 v[206:207], v9 offset:25600
    ds_read_b64_tr_b16 v[208:209], v3 offset:28672
    ds_read_b64_tr_b16 v[210:211], v3 offset:29696
    ds_read_b64_tr_b16 v[212:213], v5 offset:28672
    ds_read_b64_tr_b16 v[214:215], v5 offset:29696
    ds_read_b64_tr_b16 v[216:217], v4 offset:28672
    ds_read_b64_tr_b16 v[218:219], v4 offset:29696
    ds_read_b64_tr_b16 v[220:221], v9 offset:28672
    ds_read_b64_tr_b16 v[222:223], v9 offset:29696
    s_waitcnt lgkmcnt(4)
    ds_read_b64_tr_b16 v[224:225], v3 offset:32768
    ds_read_b64_tr_b16 v[226:227], v3 offset:33792
    ds_read_b64_tr_b16 v[228:229], v5 offset:32768
    ds_read_b64_tr_b16 v[230:231], v5 offset:33792
    ds_read_b64_tr_b16 v[232:233], v4 offset:32768
    ds_read_b64_tr_b16 v[234:235], v4 offset:33792
    ds_read_b64_tr_b16 v[236:237], v9 offset:32768
    ds_read_b64_tr_b16 v[238:239], v9 offset:33792
    ds_read_b64_tr_b16 v[240:241], v3 offset:36864
    ds_read_b64_tr_b16 v[242:243], v3 offset:37888
    ds_read_b64_tr_b16 v[244:245], v5 offset:36864
    ds_read_b64_tr_b16 v[246:247], v5 offset:37888
    ds_read_b64_tr_b16 v[248:249], v4 offset:36864
    ds_read_b64_tr_b16 v[250:251], v4 offset:37888
    ds_read_b64_tr_b16 v[252:253], v9 offset:36864
    ds_read_b64_tr_b16 v[254:255], v9 offset:37888
    s_waitcnt lgkmcnt(0)
    s_cmp_lg_u32 s97, 0
    s_cbranch_scc1 CM_106
    v_mbcnt_lo_u32_b32 v0, -1, 0
    v_mbcnt_hi_u32_b32 v0, -1, v0
    v_mul_u32_u24 v8, 32, v0
    s_mov_b32 s64, 0x0
    s_mov_b32 s65, 0
    s_mov_b64 exec, 0xff
TK_107:
    buffer_load_dword v9, v8, s[60:63], s64 offen sc1
    s_add_u32 s65, s65, 1
    s_waitcnt vmcnt(0)
    s_mov_b32 s66, 0
    v_readlane_b32 s67, v9, 0
    s_add_u32 s66, s66, s67
    v_readlane_b32 s67, v9, 1
    s_add_u32 s66, s66, s67
    v_readlane_b32 s67, v9, 2
    s_add_u32 s66, s66, s67
    v_readlane_b32 s67, v9, 3
    s_add_u32 s66, s66, s67
    v_readlane_b32 s67, v9, 4
    s_add_u32 s66, s66, s67
    v_readlane_b32 s67, v9, 5
    s_add_u32 s66, s66, s67
    v_readlane_b32 s67, v9, 6
    s_add_u32 s66, s66, s67
    v_readlane_b32 s67, v9, 7
    s_add_u32 s66, s66, s67
    s_cmp_ge_u32 s66, 256
    s_cbranch_scc1 TKD_108
    s_cmp_gt_u32 s65, 262144
    s_cbranch_scc0 TK_107
TKD_108:
    v_cmp_ne_u32 vcc, 32, v9
    s_mov_b64 exec, -1
    s_cbranch_vccnz M_SLOW
CM_106:
    s_mov_b32 s65, 0
GI_109:
    buffer_load_dword v8, off, s[60:63], s95 sc1
    s_add_u32 s65, s65, 1
    s_waitcnt vmcnt(0)
    v_readfirstlane_b32 s64, v8
    s_cmp_ge_u32 s64, 186
    s_cbranch_scc1 GID_110
    s_cmp_gt_u32 s65, 65536
    s_cbranch_scc1 GID_110
    s_sleep 4
    s_branch GI_109
GID_110:
    v_mbcnt_lo_u32_b32 v0, -1, 0
    v_mbcnt_hi_u32_b32 v0, -1, v0
    s_mov_b32 s65, 0
CW_111:
    buffer_load_dwordx2 v[8:9], off, s[60:63], 0 offset:132 sc1
    s_add_u32 s65, s65, 1
    s_waitcnt vmcnt(0)
    v_readfirstlane_b32 s30, v8
    v_readfirstlane_b32 s31, v9
    s_min_u32 s64, s30, s31
    s_cmp_lg_u32 s64, 0
    s_cbranch_scc1 CWD_112
    s_cmp_gt_u32 s65, 65536
    s_cbranch_scc1 CWD_112
    s_sleep 4
    s_branch CW_111
CWD_112:
    s_sub_u32 s30, s30, 1
    s_and_b32 s30, s30, 3
    s_sub_u32 s31, s31, 1
    s_and_b32 s31, s31, 3
    s_lshl_b32 s34, s96, 2
    s_add_u32 s34, s34, s14
    s_lshl_b32 s34, s34, 6
    v_add_u32 v5, s34, v0
    v_lshlrev_b32 v3, 4, v0
    v_mov_b32 v40, -1
    v_mov_b32 v41, -1
    v_mov_b32 v42, -1
    v_mov_b32 v43, -1
    v_lshrrev_b32 v7, 6, v5
    v_mul_u32_u24 v7, 52429, v7
    v_lshrrev_b32 v7, 18, v7
    v_mul_u32_u24 v8, 320, v7
    v_sub_u32 v8, v5, v8
    v_lshlrev_b32 v48, 4, v8
    s_lshl_b32 s30, s30, 13
    s_lshl_b32 s31, s31, 13
    s_add_u32 s31, s31, 0x200000
    v_and_b32 v8, 1, v7
    v_cmp_eq_u32 vcc, 1, v8
    v_mov_b32 v8, s30
    v_mov_b32 v9, s31
    v_cndmask_b32 v8, v8, v9, vcc
    v_lshrrev_b32 v9, 1, v7
    v_lshl_add_u32 v8, v9, 15, v8
    v_add_u32 v49, v8, v48
    v_cmp_le_u32 vcc, 640, v5
    v_mov_b32 v9, 0x40000000
    s_nop 0
    v_cndmask_b32 v49, v9, v49, vcc
    v_cmp_gt_u32 vcc, 0xa000, v5
    s_nop 0
    s_and_saveexec_b64 s[38:39], vcc
    s_cbranch_execz INF_113
    s_mov_b32 s35, 0x6000000
    buffer_store_dwordx4 v[40:43], v49, s[4:7], s35 offen sc1
INF_113:
    s_mov_b64 exec, s[38:39]
    s_cmp_ge_u32 s96, 10
    s_cbranch_scc1 INM2_114
    s_cmp_lg_u32 s14, 1
    s_cbranch_scc1 INM2_114
    s_cmp_ge_u32 s96, 5
    s_cselect_b32 s36, 1, 0
    s_mul_i32 s34, s36, 5
    s_sub_u32 s34, s96, s34
    s_lshl_b32 s34, s34, 10
    s_cmp_eq_u32 s36, 0
    s_cselect_b32 s37, s30, s31
    s_add_u32 s37, s37, 0x6000000
    s_add_u32 s37, s37, s34
    buffer_store_dwordx4 v[34:37], v3, s[4:7], s37 offen sc1
INM2_114:
    s_cmp_lg_u32 s3, 2
    s_cbranch_scc1 NOSEL_115
    s_or_b32 s64, s13, s12
    s_or_b32 s64, s64, s14
    s_cmp_lg_u32 s64, 0
    s_cbranch_scc1 NOSEL_115
    s_mov_b32 s29, 0
    v_lshlrev_b32 v1, 4, v0
    s_mov_b32 s64, 0x280000
    buffer_load_dwordx4 v[16:19], v1, s[4:7], s64 offen offset:0 sc1
    buffer_load_dwordx4 v[20:23], v1, s[4:7], s64 offen offset:1024 sc1
    buffer_load_dwordx4 v[24:27], v1, s[4:7], s64 offen offset:2048 sc1
    buffer_load_dwordx4 v[28:31], v1, s[4:7], s64 offen offset:3072 sc1
    s_add_u32 s64, s64, 4096
    buffer_load_dwordx4 v[32:35], v1, s[4:7], s64 offen offset:0 sc1
    buffer_load_dwordx4 v[36:39], v1, s[4:7], s64 offen offset:1024 sc1
    buffer_load_dwordx4 v[40:43], v1, s[4:7], s64 offen offset:2048 sc1
    buffer_load_dwordx4 v[44:47], v1, s[4:7], s64 offen offset:3072 sc1
    s_waitcnt vmcnt(0)
    v_lshlrev_b32 v2, 2, v0
    v_ashrrev_i32 v3, 31, v16
    v_or_b32 v3, 0x80000000, v3
    v_xor_b32 v16, v16, v3
    v_and_b32 v16, 0xffff0000, v16
    v_sub_u32 v3, 65535, v2
    v_or_b32 v16, v16, v3
    v_ashrrev_i32 v3, 31, v17
    v_or_b32 v3, 0x80000000, v3
    v_xor_b32 v17, v17, v3
    v_and_b32 v17, 0xffff0000, v17
    v_sub_u32 v3, 65534, v2
    v_or_b32 v17, v17, v3
    v_ashrrev_i32 v3, 31, v18
    v_or_b32 v3, 0x80000000, v3
    v_xor_b32 v18, v18, v3
    v_and_b32 v18, 0xffff0000, v18
    v_sub_u32 v3, 65533, v2
    v_or_b32 v18, v18, v3
    v_ashrrev_i32 v3, 31, v19
    v_or_b32 v3, 0x80000000, v3
    v_xor_b32 v19, v19, v3
    v_and_b32 v19, 0xffff0000, v19
    v_sub_u32 v3, 65532, v2
    v_or_b32 v19, v19, v3
    v_ashrrev_i32 v3, 31, v20
    v_or_b32 v3, 0x80000000, v3
    v_xor_b32 v20, v20, v3
    v_and_b32 v20, 0xffff0000, v20
    v_sub_u32 v3, 65279, v2
    v_or_b32 v20, v20, v3
    v_ashrrev_i32 v3, 31, v21
    v_or_b32 v3, 0x80000000, v3
    v_xor_b32 v21, v21, v3
    v_and_b32 v21, 0xffff0000, v21
    v_sub_u32 v3, 65278, v2
    v_or_b32 v21, v21, v3
    v_ashrrev_i32 v3, 31, v22
    v_or_b32 v3, 0x80000000, v3
    v_xor_b32 v22, v22, v3
    v_and_b32 v22, 0xffff0000, v22
    v_sub_u32 v3, 65277, v2
    v_or_b32 v22, v22, v3
    v_ashrrev_i32 v3, 31, v23
    v_or_b32 v3, 0x80000000, v3
    v_xor_b32 v23, v23, v3
    v_and_b32 v23, 0xffff0000, v23
    v_sub_u32 v3, 65276, v2
    v_or_b32 v23, v23, v3
    v_ashrrev_i32 v3, 31, v24
    v_or_b32 v3, 0x80000000, v3
    v_xor_b32 v24, v24, v3
    v_and_b32 v24, 0xffff0000, v24
    v_sub_u32 v3, 65023, v2
    v_or_b32 v24, v24, v3
    v_ashrrev_i32 v3, 31, v25
    v_or_b32 v3, 0x80000000, v3
    v_xor_b32 v25, v25, v3
    v_and_b32 v25, 0xffff0000, v25
    v_sub_u32 v3, 65022, v2
    v_or_b32 v25, v25, v3
    v_ashrrev_i32 v3, 31, v26
    v_or_b32 v3, 0x80000000, v3
    v_xor_b32 v26, v26, v3
    v_and_b32 v26, 0xffff0000, v26
    v_sub_u32 v3, 65021, v2
    v_or_b32 v26, v26, v3
    v_ashrrev_i32 v3, 31, v27
    v_or_b32 v3, 0x80000000, v3
    v_xor_b32 v27, v27, v3
    v_and_b32 v27, 0xffff0000, v27
    v_sub_u32 v3, 65020, v2
    v_or_b32 v27, v27, v3
    v_ashrrev_i32 v3, 31, v28
    v_or_b32 v3, 0x80000000, v3
    v_xor_b32 v28, v28, v3
    v_and_b32 v28, 0xffff0000, v28
    v_sub_u32 v3, 64767, v2
    v_or_b32 v28, v28, v3
    v_ashrrev_i32 v3, 31, v29
    v_or_b32 v3, 0x80000000, v3
    v_xor_b32 v29, v29, v3
    v_and_b32 v29, 0xffff0000, v29
    v_sub_u32 v3, 64766, v2
    v_or_b32 v29, v29, v3
    v_ashrrev_i32 v3, 31, v30
    v_or_b32 v3, 0x80000000, v3
    v_xor_b32 v30, v30, v3
    v_and_b32 v30, 0xffff0000, v30
    v_sub_u32 v3, 64765, v2
    v_or_b32 v30, v30, v3
    v_ashrrev_i32 v3, 31, v31
    v_or_b32 v3, 0x80000000, v3
    v_xor_b32 v31, v31, v3
    v_and_b32 v31, 0xffff0000, v31
    v_sub_u32 v3, 64764, v2
    v_or_b32 v31, v31, v3
    v_ashrrev_i32 v3, 31, v32
    v_or_b32 v3, 0x80000000, v3
    v_xor_b32 v32, v32, v3
    v_and_b32 v32, 0xffff0000, v32
    v_sub_u32 v3, 64511, v2
    v_or_b32 v32, v32, v3
    v_ashrrev_i32 v3, 31, v33
    v_or_b32 v3, 0x80000000, v3
    v_xor_b32 v33, v33, v3
    v_and_b32 v33, 0xffff0000, v33
    v_sub_u32 v3, 64510, v2
    v_or_b32 v33, v33, v3
    v_ashrrev_i32 v3, 31, v34
    v_or_b32 v3, 0x80000000, v3
    v_xor_b32 v34, v34, v3
    v_and_b32 v34, 0xffff0000, v34
    v_sub_u32 v3, 64509, v2
    v_or_b32 v34, v34, v3
    v_ashrrev_i32 v3, 31, v35
    v_or_b32 v3, 0x80000000, v3
    v_xor_b32 v35, v35, v3
    v_and_b32 v35, 0xffff0000, v35
    v_sub_u32 v3, 64508, v2
    v_or_b32 v35, v35, v3
    v_ashrrev_i32 v3, 31, v36
    v_or_b32 v3, 0x80000000, v3
    v_xor_b32 v36, v36, v3
    v_and_b32 v36, 0xffff0000, v36
    v_sub_u32 v3, 64255, v2
    v_or_b32 v36, v36, v3
    v_ashrrev_i32 v3, 31, v37
    v_or_b32 v3, 0x80000000, v3
    v_xor_b32 v37, v37, v3
    v_and_b32 v37, 0xffff0000, v37
    v_sub_u32 v3, 64254, v2
    v_or_b32 v37, v37, v3
    v_ashrrev_i32 v3, 31, v38
    v_or_b32 v3, 0x80000000, v3
    v_xor_b32 v38, v38, v3
    v_and_b32 v38, 0xffff0000, v38
    v_sub_u32 v3, 64253, v2
    v_or_b32 v38, v38, v3
    v_ashrrev_i32 v3, 31, v39
    v_or_b32 v3, 0x80000000, v3
    v_xor_b32 v39, v39, v3
    v_and_b32 v39, 0xffff0000, v39
    v_sub_u32 v3, 64252, v2
    v_or_b32 v39, v39, v3
    v_ashrrev_i32 v3, 31, v40
    v_or_b32 v3, 0x80000000, v3
    v_xor_b32 v40, v40, v3
    v_and_b32 v40, 0xffff0000, v40
    v_sub_u32 v3, 63999, v2
    v_or_b32 v40, v40, v3
    v_ashrrev_i32 v3, 31, v41
    v_or_b32 v3, 0x80000000, v3
    v_xor_b32 v41, v41, v3
    v_and_b32 v41, 0xffff0000, v41
    v_sub_u32 v3, 63998, v2
    v_or_b32 v41, v41, v3
    v_ashrrev_i32 v3, 31, v42
    v_or_b32 v3, 0x80000000, v3
    v_xor_b32 v42, v42, v3
    v_and_b32 v42, 0xffff0000, v42
    v_sub_u32 v3, 63997, v2
    v_or_b32 v42, v42, v3
    v_ashrrev_i32 v3, 31, v43
    v_or_b32 v3, 0x80000000, v3
    v_xor_b32 v43, v43, v3
    v_and_b32 v43, 0xffff0000, v43
    v_sub_u32 v3, 63996, v2
    v_or_b32 v43, v43, v3
    v_ashrrev_i32 v3, 31, v44
    v_or_b32 v3, 0x80000000, v3
    v_xor_b32 v44, v44, v3
    v_and_b32 v44, 0xffff0000, v44
    v_sub_u32 v3, 63743, v2
    v_or_b32 v44, v44, v3
    v_ashrrev_i32 v3, 31, v45
    v_or_b32 v3, 0x80000000, v3
    v_xor_b32 v45, v45, v3
    v_and_b32 v45, 0xffff0000, v45
    v_sub_u32 v3, 63742, v2
    v_or_b32 v45, v45, v3
    v_ashrrev_i32 v3, 31, v46
    v_or_b32 v3, 0x80000000, v3
    v_xor_b32 v46, v46, v3
    v_and_b32 v46, 0xffff0000, v46
    v_sub_u32 v3, 63741, v2
    v_or_b32 v46, v46, v3
    v_ashrrev_i32 v3, 31, v47
    v_or_b32 v3, 0x80000000, v3
    v_xor_b32 v47, v47, v3
    v_and_b32 v47, 0xffff0000, v47
    v_sub_u32 v3, 63740, v2
    v_or_b32 v47, v47, v3
    v_max3_u32 v4, v16, v17, v18
    v_max3_u32 v4, v4, v19, v20
    v_max3_u32 v4, v4, v21, v22
    v_max3_u32 v4, v4, v23, v24
    v_max3_u32 v4, v4, v25, v26
    v_max3_u32 v4, v4, v27, v28
    v_max3_u32 v4, v4, v29, v30
    v_max3_u32 v4, v4, v31, v32
    v_max3_u32 v4, v4, v33, v34
    v_max3_u32 v4, v4, v35, v36
    v_max3_u32 v4, v4, v37, v38
    v_max3_u32 v4, v4, v39, v40
    v_max3_u32 v4, v4, v41, v42
    v_max3_u32 v4, v4, v43, v44
    v_max3_u32 v4, v4, v45, v46
    v_max_u32 v4, v4, v47
    s_nop 1
    v_max_u32_dpp v4, v4, v4 quad_perm:[1,0,3,2] row_mask:0xf bank_mask:0xf
    s_nop 1
    v_max_u32_dpp v4, v4, v4 quad_perm:[2,3,0,1] row_mask:0xf bank_mask:0xf
    s_nop 1
    v_max_u32_dpp v4, v4, v4 row_half_mirror row_mask:0xf bank_mask:0xf
    s_nop 1
    v_max_u32_dpp v4, v4, v4 row_mirror row_mask:0xf bank_mask:0xf
    v_mov_b32 v5, v4
    s_nop 1
    v_permlane16_swap_b32 v4, v5
    v_max_u32 v4, v4, v5
    v_mov_b32 v5, v4
    s_nop 1
    v_permlane32_swap_b32 v4, v5
    v_max_u32 v4, v4, v5
    v_mov_b32 v56, v4
    v_cmp_eq_u32 vcc, v4, v16
    s_nop 1
    v_cndmask_b32 v16, v16, 0, vcc
    v_cmp_eq_u32 vcc, v4, v17
    s_nop 1
    v_cndmask_b32 v17, v17, 0, vcc
    v_cmp_eq_u32 vcc, v4, v18
    s_nop 1
    v_cndmask_b32 v18, v18, 0, vcc
    v_cmp_eq_u32 vcc, v4, v19
    s_nop 1
    v_cndmask_b32 v19, v19, 0, vcc
    v_cmp_eq_u32 vcc, v4, v20
    s_nop 1
    v_cndmask_b32 v20, v20, 0, vcc
    v_cmp_eq_u32 vcc, v4, v21
    s_nop 1
    v_cndmask_b32 v21, v21, 0, vcc
    v_cmp_eq_u32 vcc, v4, v22
    s_nop 1
    v_cndmask_b32 v22, v22, 0, vcc
    v_cmp_eq_u32 vcc, v4, v23
    s_nop 1
    v_cndmask_b32 v23, v23, 0, vcc
    v_cmp_eq_u32 vcc, v4, v24
    s_nop 1
    v_cndmask_b32 v24, v24, 0, vcc
    v_cmp_eq_u32 vcc, v4, v25
    s_nop 1
    v_cndmask_b32 v25, v25, 0, vcc
    v_cmp_eq_u32 vcc, v4, v26
    s_nop 1
    v_cndmask_b32 v26, v26, 0, vcc
    v_cmp_eq_u32 vcc, v4, v27
    s_nop 1
    v_cndmask_b32 v27, v27, 0, vcc
    v_cmp_eq_u32 vcc, v4, v28
    s_nop 1
    v_cndmask_b32 v28, v28, 0, vcc
    v_cmp_eq_u32 vcc, v4, v29
    s_nop 1
    v_cndmask_b32 v29, v29, 0, vcc
    v_cmp_eq_u32 vcc, v4, v30
    s_nop 1
    v_cndmask_b32 v30, v30, 0, vcc
    v_cmp_eq_u32 vcc, v4, v31
    s_nop 1
    v_cndmask_b32 v31, v31, 0, vcc
    v_cmp_eq_u32 vcc, v4, v32
    s_nop 1
    v_cndmask_b32 v32, v32, 0, vcc
    v_cmp_eq_u32 vcc, v4, v33
    s_nop 1
    v_cndmask_b32 v33, v33, 0, vcc
    v_cmp_eq_u32 vcc, v4, v34
    s_nop 1
    v_cndmask_b32 v34, v34, 0, vcc
    v_cmp_eq_u32 vcc, v4, v35
    s_nop 1
    v_cndmask_b32 v35, v35, 0, vcc
    v_cmp_eq_u32 vcc, v4, v36
    s_nop 1
    v_cndmask_b32 v36, v36, 0, vcc
    v_cmp_eq_u32 vcc, v4, v37
    s_nop 1
    v_cndmask_b32 v37, v37, 0, vcc
    v_cmp_eq_u32 vcc, v4, v38
    s_nop 1
    v_cndmask_b32 v38, v38, 0, vcc
    v_cmp_eq_u32 vcc, v4, v39
    s_nop 1
    v_cndmask_b32 v39, v39, 0, vcc
    v_cmp_eq_u32 vcc, v4, v40
    s_nop 1
    v_cndmask_b32 v40, v40, 0, vcc
    v_cmp_eq_u32 vcc, v4, v41
    s_nop 1
    v_cndmask_b32 v41, v41, 0, vcc
    v_cmp_eq_u32 vcc, v4, v42
    s_nop 1
    v_cndmask_b32 v42, v42, 0, vcc
    v_cmp_eq_u32 vcc, v4, v43
    s_nop 1
    v_cndmask_b32 v43, v43, 0, vcc
    v_cmp_eq_u32 vcc, v4, v44
    s_nop 1
    v_cndmask_b32 v44, v44, 0, vcc
    v_cmp_eq_u32 vcc, v4, v45
    s_nop 1
    v_cndmask_b32 v45, v45, 0, vcc
    v_cmp_eq_u32 vcc, v4, v46
    s_nop 1
    v_cndmask_b32 v46, v46, 0, vcc
    v_cmp_eq_u32 vcc, v4, v47
    s_nop 1
    v_cndmask_b32 v47, v47, 0, vcc
    v_max3_u32 v4, v16, v17, v18
    v_max3_u32 v4, v4, v19, v20
    v_max3_u32 v4, v4, v21, v22
    v_max3_u32 v4, v4, v23, v24
    v_max3_u32 v4, v4, v25, v26
    v_max3_u32 v4, v4, v27, v28
    v_max3_u32 v4, v4, v29, v30
    v_max3_u32 v4, v4, v31, v32
    v_max3_u32 v4, v4, v33, v34
    v_max3_u32 v4, v4, v35, v36
    v_max3_u32 v4, v4, v37, v38
    v_max3_u32 v4, v4, v39, v40
    v_max3_u32 v4, v4, v41, v42
    v_max3_u32 v4, v4, v43, v44
    v_max3_u32 v4, v4, v45, v46
    v_max_u32 v4, v4, v47
    s_nop 1
    v_max_u32_dpp v4, v4, v4 quad_perm:[1,0,3,2] row_mask:0xf bank_mask:0xf
    s_nop 1
    v_max_u32_dpp v4, v4, v4 quad_perm:[2,3,0,1] row_mask:0xf bank_mask:0xf
    s_nop 1
    v_max_u32_dpp v4, v4, v4 row_half_mirror row_mask:0xf bank_mask:0xf
    s_nop 1
    v_max_u32_dpp v4, v4, v4 row_mirror row_mask:0xf bank_mask:0xf
    v_mov_b32 v5, v4
    s_nop 1
    v_permlane16_swap_b32 v4, v5
    v_max_u32 v4, v4, v5
    v_mov_b32 v5, v4
    s_nop 1
    v_permlane32_swap_b32 v4, v5
    v_max_u32 v4, v4, v5
    v_mov_b32 v57, v4
    v_cmp_eq_u32 vcc, v4, v16
    s_nop 1
    v_cndmask_b32 v16, v16, 0, vcc
    v_cmp_eq_u32 vcc, v4, v17
    s_nop 1
    v_cndmask_b32 v17, v17, 0, vcc
    v_cmp_eq_u32 vcc, v4, v18
    s_nop 1
    v_cndmask_b32 v18, v18, 0, vcc
    v_cmp_eq_u32 vcc, v4, v19
    s_nop 1
    v_cndmask_b32 v19, v19, 0, vcc
    v_cmp_eq_u32 vcc, v4, v20
    s_nop 1
    v_cndmask_b32 v20, v20, 0, vcc
    v_cmp_eq_u32 vcc, v4, v21
    s_nop 1
    v_cndmask_b32 v21, v21, 0, vcc
    v_cmp_eq_u32 vcc, v4, v22
    s_nop 1
    v_cndmask_b32 v22, v22, 0, vcc
    v_cmp_eq_u32 vcc, v4, v23
    s_nop 1
    v_cndmask_b32 v23, v23, 0, vcc
    v_cmp_eq_u32 vcc, v4, v24
    s_nop 1
    v_cndmask_b32 v24, v24, 0, vcc
    v_cmp_eq_u32 vcc, v4, v25
    s_nop 1
    v_cndmask_b32 v25, v25, 0, vcc
    v_cmp_eq_u32 vcc, v4, v26
    s_nop 1
    v_cndmask_b32 v26, v26, 0, vcc
    v_cmp_eq_u32 vcc, v4, v27
    s_nop 1
    v_cndmask_b32 v27, v27, 0, vcc
    v_cmp_eq_u32 vcc, v4, v28
    s_nop 1
    v_cndmask_b32 v28, v28, 0, vcc
    v_cmp_eq_u32 vcc, v4, v29
    s_nop 1
    v_cndmask_b32 v29, v29, 0, vcc
    v_cmp_eq_u32 vcc, v4, v30
    s_nop 1
    v_cndmask_b32 v30, v30, 0, vcc
    v_cmp_eq_u32 vcc, v4, v31
    s_nop 1
    v_cndmask_b32 v31, v31, 0, vcc
    v_cmp_eq_u32 vcc, v4, v32
    s_nop 1
    v_cndmask_b32 v32, v32, 0, vcc
    v_cmp_eq_u32 vcc, v4, v33
    s_nop 1
    v_cndmask_b32 v33, v33, 0, vcc
    v_cmp_eq_u32 vcc, v4, v34
    s_nop 1
    v_cndmask_b32 v34, v34, 0, vcc
    v_cmp_eq_u32 vcc, v4, v35
    s_nop 1
    v_cndmask_b32 v35, v35, 0, vcc
    v_cmp_eq_u32 vcc, v4, v36
    s_nop 1
    v_cndmask_b32 v36, v36, 0, vcc
    v_cmp_eq_u32 vcc, v4, v37
    s_nop 1
    v_cndmask_b32 v37, v37, 0, vcc
    v_cmp_eq_u32 vcc, v4, v38
    s_nop 1
    v_cndmask_b32 v38, v38, 0, vcc
    v_cmp_eq_u32 vcc, v4, v39
    s_nop 1
    v_cndmask_b32 v39, v39, 0, vcc
    v_cmp_eq_u32 vcc, v4, v40
    s_nop 1
    v_cndmask_b32 v40, v40, 0, vcc
    v_cmp_eq_u32 vcc, v4, v41
    s_nop 1
    v_cndmask_b32 v41, v41, 0, vcc
    v_cmp_eq_u32 vcc, v4, v42
    s_nop 1
    v_cndmask_b32 v42, v42, 0, vcc
    v_cmp_eq_u32 vcc, v4, v43
    s_nop 1
    v_cndmask_b32 v43, v43, 0, vcc
    v_cmp_eq_u32 vcc, v4, v44
    s_nop 1
    v_cndmask_b32 v44, v44, 0, vcc
    v_cmp_eq_u32 vcc, v4, v45
    s_nop 1
    v_cndmask_b32 v45, v45, 0, vcc
    v_cmp_eq_u32 vcc, v4, v46
    s_nop 1
    v_cndmask_b32 v46, v46, 0, vcc
    v_cmp_eq_u32 vcc, v4, v47
    s_nop 1
    v_cndmask_b32 v47, v47, 0, vcc
    v_max3_u32 v4, v16, v17, v18
    v_max3_u32 v4, v4, v19, v20
    v_max3_u32 v4, v4, v21, v22
    v_max3_u32 v4, v4, v23, v24
    v_max3_u32 v4, v4, v25, v26
    v_max3_u32 v4, v4, v27, v28
    v_max3_u32 v4, v4, v29, v30
    v_max3_u32 v4, v4, v31, v32
    v_max3_u32 v4, v4, v33, v34
    v_max3_u32 v4, v4, v35, v36
    v_max3_u32 v4, v4, v37, v38
    v_max3_u32 v4, v4, v39, v40
    v_max3_u32 v4, v4, v41, v42
    v_max3_u32 v4, v4, v43, v44
    v_max3_u32 v4, v4, v45, v46
    v_max_u32 v4, v4, v47
    s_nop 1
    v_max_u32_dpp v4, v4, v4 quad_perm:[1,0,3,2] row_mask:0xf bank_mask:0xf
    s_nop 1
    v_max_u32_dpp v4, v4, v4 quad_perm:[2,3,0,1] row_mask:0xf bank_mask:0xf
    s_nop 1
    v_max_u32_dpp v4, v4, v4 row_half_mirror row_mask:0xf bank_mask:0xf
    s_nop 1
    v_max_u32_dpp v4, v4, v4 row_mirror row_mask:0xf bank_mask:0xf
    v_mov_b32 v5, v4
    s_nop 1
    v_permlane16_swap_b32 v4, v5
    v_max_u32 v4, v4, v5
    v_mov_b32 v5, v4
    s_nop 1
    v_permlane32_swap_b32 v4, v5
    v_max_u32 v4, v4, v5
    v_mov_b32 v58, v4
    v_cmp_eq_u32 vcc, v4, v16
    s_nop 1
    v_cndmask_b32 v16, v16, 0, vcc
    v_cmp_eq_u32 vcc, v4, v17
    s_nop 1
    v_cndmask_b32 v17, v17, 0, vcc
    v_cmp_eq_u32 vcc, v4, v18
    s_nop 1
    v_cndmask_b32 v18, v18, 0, vcc
    v_cmp_eq_u32 vcc, v4, v19
    s_nop 1
    v_cndmask_b32 v19, v19, 0, vcc
    v_cmp_eq_u32 vcc, v4, v20
    s_nop 1
    v_cndmask_b32 v20, v20, 0, vcc
    v_cmp_eq_u32 vcc, v4, v21
    s_nop 1
    v_cndmask_b32 v21, v21, 0, vcc
    v_cmp_eq_u32 vcc, v4, v22
    s_nop 1
    v_cndmask_b32 v22, v22, 0, vcc
    v_cmp_eq_u32 vcc, v4, v23
    s_nop 1
    v_cndmask_b32 v23, v23, 0, vcc
    v_cmp_eq_u32 vcc, v4, v24
    s_nop 1
    v_cndmask_b32 v24, v24, 0, vcc
    v_cmp_eq_u32 vcc, v4, v25
    s_nop 1
    v_cndmask_b32 v25, v25, 0, vcc
    v_cmp_eq_u32 vcc, v4, v26
    s_nop 1
    v_cndmask_b32 v26, v26, 0, vcc
    v_cmp_eq_u32 vcc, v4, v27
    s_nop 1
    v_cndmask_b32 v27, v27, 0, vcc
    v_cmp_eq_u32 vcc, v4, v28
    s_nop 1
    v_cndmask_b32 v28, v28, 0, vcc
    v_cmp_eq_u32 vcc, v4, v29
    s_nop 1
    v_cndmask_b32 v29, v29, 0, vcc
    v_cmp_eq_u32 vcc, v4, v30
    s_nop 1
    v_cndmask_b32 v30, v30, 0, vcc
    v_cmp_eq_u32 vcc, v4, v31
    s_nop 1
    v_cndmask_b32 v31, v31, 0, vcc
    v_cmp_eq_u32 vcc, v4, v32
    s_nop 1
    v_cndmask_b32 v32, v32, 0, vcc
    v_cmp_eq_u32 vcc, v4, v33
    s_nop 1
    v_cndmask_b32 v33, v33, 0, vcc
    v_cmp_eq_u32 vcc, v4, v34
    s_nop 1
    v_cndmask_b32 v34, v34, 0, vcc
    v_cmp_eq_u32 vcc, v4, v35
    s_nop 1
    v_cndmask_b32 v35, v35, 0, vcc
    v_cmp_eq_u32 vcc, v4, v36
    s_nop 1
    v_cndmask_b32 v36, v36, 0, vcc
    v_cmp_eq_u32 vcc, v4, v37
    s_nop 1
    v_cndmask_b32 v37, v37, 0, vcc
    v_cmp_eq_u32 vcc, v4, v38
    s_nop 1
    v_cndmask_b32 v38, v38, 0, vcc
    v_cmp_eq_u32 vcc, v4, v39
    s_nop 1
    v_cndmask_b32 v39, v39, 0, vcc
    v_cmp_eq_u32 vcc, v4, v40
    s_nop 1
    v_cndmask_b32 v40, v40, 0, vcc
    v_cmp_eq_u32 vcc, v4, v41
    s_nop 1
    v_cndmask_b32 v41, v41, 0, vcc
    v_cmp_eq_u32 vcc, v4, v42
    s_nop 1
    v_cndmask_b32 v42, v42, 0, vcc
    v_cmp_eq_u32 vcc, v4, v43
    s_nop 1
    v_cndmask_b32 v43, v43, 0, vcc
    v_cmp_eq_u32 vcc, v4, v44
    s_nop 1
    v_cndmask_b32 v44, v44, 0, vcc
    v_cmp_eq_u32 vcc, v4, v45
    s_nop 1
    v_cndmask_b32 v45, v45, 0, vcc
    v_cmp_eq_u32 vcc, v4, v46
    s_nop 1
    v_cndmask_b32 v46, v46, 0, vcc
    v_cmp_eq_u32 vcc, v4, v47
    s_nop 1
    v_cndmask_b32 v47, v47, 0, vcc
    v_max3_u32 v4, v16, v17, v18
    v_max3_u32 v4, v4, v19, v20
    v_max3_u32 v4, v4, v21, v22
    v_max3_u32 v4, v4, v23, v24
    v_max3_u32 v4, v4, v25, v26
    v_max3_u32 v4, v4, v27, v28
    v_max3_u32 v4, v4, v29, v30
    v_max3_u32 v4, v4, v31, v32
    v_max3_u32 v4, v4, v33, v34
    v_max3_u32 v4, v4, v35, v36
    v_max3_u32 v4, v4, v37, v38
    v_max3_u32 v4, v4, v39, v40
    v_max3_u32 v4, v4, v41, v42
    v_max3_u32 v4, v4, v43, v44
    v_max3_u32 v4, v4, v45, v46
    v_max_u32 v4, v4, v47
    s_nop 1
    v_max_u32_dpp v4, v4, v4 quad_perm:[1,0,3,2] row_mask:0xf bank_mask:0xf
    s_nop 1
    v_max_u32_dpp v4, v4, v4 quad_perm:[2,3,0,1] row_mask:0xf bank_mask:0xf
    s_nop 1
    v_max_u32_dpp v4, v4, v4 row_half_mirror row_mask:0xf bank_mask:0xf
    s_nop 1
    v_max_u32_dpp v4, v4, v4 row_mirror row_mask:0xf bank_mask:0xf
    v_mov_b32 v5, v4
    s_nop 1
    v_permlane16_swap_b32 v4, v5
    v_max_u32 v4, v4, v5
    v_mov_b32 v5, v4
    s_nop 1
    v_permlane32_swap_b32 v4, v5
    v_max_u32 v4, v4, v5
    v_mov_b32 v59, v4
    v_cmp_eq_u32 vcc, v4, v16
    s_nop 1
    v_cndmask_b32 v16, v16, 0, vcc
    v_cmp_eq_u32 vcc, v4, v17
    s_nop 1
    v_cndmask_b32 v17, v17, 0, vcc
    v_cmp_eq_u32 vcc, v4, v18
    s_nop 1
    v_cndmask_b32 v18, v18, 0, vcc
    v_cmp_eq_u32 vcc, v4, v19
    s_nop 1
    v_cndmask_b32 v19, v19, 0, vcc
    v_cmp_eq_u32 vcc, v4, v20
    s_nop 1
    v_cndmask_b32 v20, v20, 0, vcc
    v_cmp_eq_u32 vcc, v4, v21
    s_nop 1
    v_cndmask_b32 v21, v21, 0, vcc
    v_cmp_eq_u32 vcc, v4, v22
    s_nop 1
    v_cndmask_b32 v22, v22, 0, vcc
    v_cmp_eq_u32 vcc, v4, v23
    s_nop 1
    v_cndmask_b32 v23, v23, 0, vcc
    v_cmp_eq_u32 vcc, v4, v24
    s_nop 1
    v_cndmask_b32 v24, v24, 0, vcc
    v_cmp_eq_u32 vcc, v4, v25
    s_nop 1
    v_cndmask_b32 v25, v25, 0, vcc
    v_cmp_eq_u32 vcc, v4, v26
    s_nop 1
    v_cndmask_b32 v26, v26, 0, vcc
    v_cmp_eq_u32 vcc, v4, v27
    s_nop 1
    v_cndmask_b32 v27, v27, 0, vcc
    v_cmp_eq_u32 vcc, v4, v28
    s_nop 1
    v_cndmask_b32 v28, v28, 0, vcc
    v_cmp_eq_u32 vcc, v4, v29
    s_nop 1
    v_cndmask_b32 v29, v29, 0, vcc
    v_cmp_eq_u32 vcc, v4, v30
    s_nop 1
    v_cndmask_b32 v30, v30, 0, vcc
    v_cmp_eq_u32 vcc, v4, v31
    s_nop 1
    v_cndmask_b32 v31, v31, 0, vcc
    v_cmp_eq_u32 vcc, v4, v32
    s_nop 1
    v_cndmask_b32 v32, v32, 0, vcc
    v_cmp_eq_u32 vcc, v4, v33
    s_nop 1
    v_cndmask_b32 v33, v33, 0, vcc
    v_cmp_eq_u32 vcc, v4, v34
    s_nop 1
    v_cndmask_b32 v34, v34, 0, vcc
    v_cmp_eq_u32 vcc, v4, v35
    s_nop 1
    v_cndmask_b32 v35, v35, 0, vcc
    v_cmp_eq_u32 vcc, v4, v36
    s_nop 1
    v_cndmask_b32 v36, v36, 0, vcc
    v_cmp_eq_u32 vcc, v4, v37
    s_nop 1
    v_cndmask_b32 v37, v37, 0, vcc
    v_cmp_eq_u32 vcc, v4, v38
    s_nop 1
    v_cndmask_b32 v38, v38, 0, vcc
    v_cmp_eq_u32 vcc, v4, v39
    s_nop 1
    v_cndmask_b32 v39, v39, 0, vcc
    v_cmp_eq_u32 vcc, v4, v40
    s_nop 1
    v_cndmask_b32 v40, v40, 0, vcc
    v_cmp_eq_u32 vcc, v4, v41
    s_nop 1
    v_cndmask_b32 v41, v41, 0, vcc
    v_cmp_eq_u32 vcc, v4, v42
    s_nop 1
    v_cndmask_b32 v42, v42, 0, vcc
    v_cmp_eq_u32 vcc, v4, v43
    s_nop 1
    v_cndmask_b32 v43, v43, 0, vcc
    v_cmp_eq_u32 vcc, v4, v44
    s_nop 1
    v_cndmask_b32 v44, v44, 0, vcc
    v_cmp_eq_u32 vcc, v4, v45
    s_nop 1
    v_cndmask_b32 v45, v45, 0, vcc
    v_cmp_eq_u32 vcc, v4, v46
    s_nop 1
    v_cndmask_b32 v46, v46, 0, vcc
    v_cmp_eq_u32 vcc, v4, v47
    s_nop 1
    v_cndmask_b32 v47, v47, 0, vcc
    v_max3_u32 v4, v16, v17, v18
    v_max3_u32 v4, v4, v19, v20
    v_max3_u32 v4, v4, v21, v22
    v_max3_u32 v4, v4, v23, v24
    v_max3_u32 v4, v4, v25, v26
    v_max3_u32 v4, v4, v27, v28
    v_max3_u32 v4, v4, v29, v30
    v_max3_u32 v4, v4, v31, v32
    v_max3_u32 v4, v4, v33, v34
    v_max3_u32 v4, v4, v35, v36
    v_max3_u32 v4, v4, v37, v38
    v_max3_u32 v4, v4, v39, v40
    v_max3_u32 v4, v4, v41, v42
    v_max3_u32 v4, v4, v43, v44
    v_max3_u32 v4, v4, v45, v46
    v_max_u32 v4, v4, v47
    s_nop 1
    v_max_u32_dpp v4, v4, v4 quad_perm:[1,0,3,2] row_mask:0xf bank_mask:0xf
    s_nop 1
    v_max_u32_dpp v4, v4, v4 quad_perm:[2,3,0,1] row_mask:0xf bank_mask:0xf
    s_nop 1
    v_max_u32_dpp v4, v4, v4 row_half_mirror row_mask:0xf bank_mask:0xf
    s_nop 1
    v_max_u32_dpp v4, v4, v4 row_mirror row_mask:0xf bank_mask:0xf
    v_mov_b32 v5, v4
    s_nop 1
    v_permlane16_swap_b32 v4, v5
    v_max_u32 v4, v4, v5
    v_mov_b32 v5, v4
    s_nop 1
    v_permlane32_swap_b32 v4, v5
    v_max_u32 v4, v4, v5
    v_mov_b32 v60, v4
    v_cmp_eq_u32 vcc, v4, v16
    s_nop 1
    v_cndmask_b32 v16, v16, 0, vcc
    v_cmp_eq_u32 vcc, v4, v17
    s_nop 1
    v_cndmask_b32 v17, v17, 0, vcc
    v_cmp_eq_u32 vcc, v4, v18
    s_nop 1
    v_cndmask_b32 v18, v18, 0, vcc
    v_cmp_eq_u32 vcc, v4, v19
    s_nop 1
    v_cndmask_b32 v19, v19, 0, vcc
    v_cmp_eq_u32 vcc, v4, v20
    s_nop 1
    v_cndmask_b32 v20, v20, 0, vcc
    v_cmp_eq_u32 vcc, v4, v21
    s_nop 1
    v_cndmask_b32 v21, v21, 0, vcc
    v_cmp_eq_u32 vcc, v4, v22
    s_nop 1
    v_cndmask_b32 v22, v22, 0, vcc
    v_cmp_eq_u32 vcc, v4, v23
    s_nop 1
    v_cndmask_b32 v23, v23, 0, vcc
    v_cmp_eq_u32 vcc, v4, v24
    s_nop 1
    v_cndmask_b32 v24, v24, 0, vcc
    v_cmp_eq_u32 vcc, v4, v25
    s_nop 1
    v_cndmask_b32 v25, v25, 0, vcc
    v_cmp_eq_u32 vcc, v4, v26
    s_nop 1
    v_cndmask_b32 v26, v26, 0, vcc
    v_cmp_eq_u32 vcc, v4, v27
    s_nop 1
    v_cndmask_b32 v27, v27, 0, vcc
    v_cmp_eq_u32 vcc, v4, v28
    s_nop 1
    v_cndmask_b32 v28, v28, 0, vcc
    v_cmp_eq_u32 vcc, v4, v29
    s_nop 1
    v_cndmask_b32 v29, v29, 0, vcc
    v_cmp_eq_u32 vcc, v4, v30
    s_nop 1
    v_cndmask_b32 v30, v30, 0, vcc
    v_cmp_eq_u32 vcc, v4, v31
    s_nop 1
    v_cndmask_b32 v31, v31, 0, vcc
    v_cmp_eq_u32 vcc, v4, v32
    s_nop 1
    v_cndmask_b32 v32, v32, 0, vcc
    v_cmp_eq_u32 vcc, v4, v33
    s_nop 1
    v_cndmask_b32 v33, v33, 0, vcc
    v_cmp_eq_u32 vcc, v4, v34
    s_nop 1
    v_cndmask_b32 v34, v34, 0, vcc
    v_cmp_eq_u32 vcc, v4, v35
    s_nop 1
    v_cndmask_b32 v35, v35, 0, vcc
    v_cmp_eq_u32 vcc, v4, v36
    s_nop 1
    v_cndmask_b32 v36, v36, 0, vcc
    v_cmp_eq_u32 vcc, v4, v37
    s_nop 1
    v_cndmask_b32 v37, v37, 0, vcc
    v_cmp_eq_u32 vcc, v4, v38
    s_nop 1
    v_cndmask_b32 v38, v38, 0, vcc
    v_cmp_eq_u32 vcc, v4, v39
    s_nop 1
    v_cndmask_b32 v39, v39, 0, vcc
    v_cmp_eq_u32 vcc, v4, v40
    s_nop 1
    v_cndmask_b32 v40, v40, 0, vcc
    v_cmp_eq_u32 vcc, v4, v41
    s_nop 1
    v_cndmask_b32 v41, v41, 0, vcc
    v_cmp_eq_u32 vcc, v4, v42
    s_nop 1
    v_cndmask_b32 v42, v42, 0, vcc
    v_cmp_eq_u32 vcc, v4, v43
    s_nop 1
    v_cndmask_b32 v43, v43, 0, vcc
    v_cmp_eq_u32 vcc, v4, v44
    s_nop 1
    v_cndmask_b32 v44, v44, 0, vcc
    v_cmp_eq_u32 vcc, v4, v45
    s_nop 1
    v_cndmask_b32 v45, v45, 0, vcc
    v_cmp_eq_u32 vcc, v4, v46
    s_nop 1
    v_cndmask_b32 v46, v46, 0, vcc
    v_cmp_eq_u32 vcc, v4, v47
    s_nop 1
    v_cndmask_b32 v47, v47, 0, vcc
    v_max3_u32 v4, v16, v17, v18
    v_max3_u32 v4, v4, v19, v20
    v_max3_u32 v4, v4, v21, v22
    v_max3_u32 v4, v4, v23, v24
    v_max3_u32 v4, v4, v25, v26
    v_max3_u32 v4, v4, v27, v28
    v_max3_u32 v4, v4, v29, v30
    v_max3_u32 v4, v4, v31, v32
    v_max3_u32 v4, v4, v33, v34
    v_max3_u32 v4, v4, v35, v36
    v_max3_u32 v4, v4, v37, v38
    v_max3_u32 v4, v4, v39, v40
    v_max3_u32 v4, v4, v41, v42
    v_max3_u32 v4, v4, v43, v44
    v_max3_u32 v4, v4, v45, v46
    v_max_u32 v4, v4, v47
    s_nop 1
    v_max_u32_dpp v4, v4, v4 quad_perm:[1,0,3,2] row_mask:0xf bank_mask:0xf
    s_nop 1
    v_max_u32_dpp v4, v4, v4 quad_perm:[2,3,0,1] row_mask:0xf bank_mask:0xf
    s_nop 1
    v_max_u32_dpp v4, v4, v4 row_half_mirror row_mask:0xf bank_mask:0xf
    s_nop 1
    v_max_u32_dpp v4, v4, v4 row_mirror row_mask:0xf bank_mask:0xf
    v_mov_b32 v5, v4
    s_nop 1
    v_permlane16_swap_b32 v4, v5
    v_max_u32 v4, v4, v5
    v_mov_b32 v5, v4
    s_nop 1
    v_permlane32_swap_b32 v4, v5
    v_max_u32 v4, v4, v5
    v_mov_b32 v61, v4
    v_cmp_eq_u32 vcc, v4, v16
    s_nop 1
    v_cndmask_b32 v16, v16, 0, vcc
    v_cmp_eq_u32 vcc, v4, v17
    s_nop 1
    v_cndmask_b32 v17, v17, 0, vcc
    v_cmp_eq_u32 vcc, v4, v18
    s_nop 1
    v_cndmask_b32 v18, v18, 0, vcc
    v_cmp_eq_u32 vcc, v4, v19
    s_nop 1
    v_cndmask_b32 v19, v19, 0, vcc
    v_cmp_eq_u32 vcc, v4, v20
    s_nop 1
    v_cndmask_b32 v20, v20, 0, vcc
    v_cmp_eq_u32 vcc, v4, v21
    s_nop 1
    v_cndmask_b32 v21, v21, 0, vcc
    v_cmp_eq_u32 vcc, v4, v22
    s_nop 1
    v_cndmask_b32 v22, v22, 0, vcc
    v_cmp_eq_u32 vcc, v4, v23
    s_nop 1
    v_cndmask_b32 v23, v23, 0, vcc
    v_cmp_eq_u32 vcc, v4, v24
    s_nop 1
    v_cndmask_b32 v24, v24, 0, vcc
    v_cmp_eq_u32 vcc, v4, v25
    s_nop 1
    v_cndmask_b32 v25, v25, 0, vcc
    v_cmp_eq_u32 vcc, v4, v26
    s_nop 1
    v_cndmask_b32 v26, v26, 0, vcc
    v_cmp_eq_u32 vcc, v4, v27
    s_nop 1
    v_cndmask_b32 v27, v27, 0, vcc
    v_cmp_eq_u32 vcc, v4, v28
    s_nop 1
    v_cndmask_b32 v28, v28, 0, vcc
    v_cmp_eq_u32 vcc, v4, v29
    s_nop 1
    v_cndmask_b32 v29, v29, 0, vcc
    v_cmp_eq_u32 vcc, v4, v30
    s_nop 1
    v_cndmask_b32 v30, v30, 0, vcc
    v_cmp_eq_u32 vcc, v4, v31
    s_nop 1
    v_cndmask_b32 v31, v31, 0, vcc
    v_cmp_eq_u32 vcc, v4, v32
    s_nop 1
    v_cndmask_b32 v32, v32, 0, vcc
    v_cmp_eq_u32 vcc, v4, v33
    s_nop 1
    v_cndmask_b32 v33, v33, 0, vcc
    v_cmp_eq_u32 vcc, v4, v34
    s_nop 1
    v_cndmask_b32 v34, v34, 0, vcc
    v_cmp_eq_u32 vcc, v4, v35
    s_nop 1
    v_cndmask_b32 v35, v35, 0, vcc
    v_cmp_eq_u32 vcc, v4, v36
    s_nop 1
    v_cndmask_b32 v36, v36, 0, vcc
    v_cmp_eq_u32 vcc, v4, v37
    s_nop 1
    v_cndmask_b32 v37, v37, 0, vcc
    v_cmp_eq_u32 vcc, v4, v38
    s_nop 1
    v_cndmask_b32 v38, v38, 0, vcc
    v_cmp_eq_u32 vcc, v4, v39
    s_nop 1
    v_cndmask_b32 v39, v39, 0, vcc
    v_cmp_eq_u32 vcc, v4, v40
    s_nop 1
    v_cndmask_b32 v40, v40, 0, vcc
    v_cmp_eq_u32 vcc, v4, v41
    s_nop 1
    v_cndmask_b32 v41, v41, 0, vcc
    v_cmp_eq_u32 vcc, v4, v42
    s_nop 1
    v_cndmask_b32 v42, v42, 0, vcc
    v_cmp_eq_u32 vcc, v4, v43
    s_nop 1
    v_cndmask_b32 v43, v43, 0, vcc
    v_cmp_eq_u32 vcc, v4, v44
    s_nop 1
    v_cndmask_b32 v44, v44, 0, vcc
    v_cmp_eq_u32 vcc, v4, v45
    s_nop 1
    v_cndmask_b32 v45, v45, 0, vcc
    v_cmp_eq_u32 vcc, v4, v46
    s_nop 1
    v_cndmask_b32 v46, v46, 0, vcc
    v_cmp_eq_u32 vcc, v4, v47
    s_nop 1
    v_cndmask_b32 v47, v47, 0, vcc
    v_max3_u32 v4, v16, v17, v18
    v_max3_u32 v4, v4, v19, v20
    v_max3_u32 v4, v4, v21, v22
    v_max3_u32 v4, v4, v23, v24
    v_max3_u32 v4, v4, v25, v26
    v_max3_u32 v4, v4, v27, v28
    v_max3_u32 v4, v4, v29, v30
    v_max3_u32 v4, v4, v31, v32
    v_max3_u32 v4, v4, v33, v34
    v_max3_u32 v4, v4, v35, v36
    v_max3_u32 v4, v4, v37, v38
    v_max3_u32 v4, v4, v39, v40
    v_max3_u32 v4, v4, v41, v42
    v_max3_u32 v4, v4, v43, v44
    v_max3_u32 v4, v4, v45, v46
    v_max_u32 v4, v4, v47
    s_nop 1
    v_max_u32_dpp v4, v4, v4 quad_perm:[1,0,3,2] row_mask:0xf bank_mask:0xf
    s_nop 1
    v_max_u32_dpp v4, v4, v4 quad_perm:[2,3,0,1] row_mask:0xf bank_mask:0xf
    s_nop 1
    v_max_u32_dpp v4, v4, v4 row_half_mirror row_mask:0xf bank_mask:0xf
    s_nop 1
    v_max_u32_dpp v4, v4, v4 row_mirror row_mask:0xf bank_mask:0xf
    v_mov_b32 v5, v4
    s_nop 1
    v_permlane16_swap_b32 v4, v5
    v_max_u32 v4, v4, v5
    v_mov_b32 v5, v4
    s_nop 1
    v_permlane32_swap_b32 v4, v5
    v_max_u32 v4, v4, v5
    v_mov_b32 v62, v4
    v_cmp_eq_u32 vcc, v4, v16
    s_nop 1
    v_cndmask_b32 v16, v16, 0, vcc
    v_cmp_eq_u32 vcc, v4, v17
    s_nop 1
    v_cndmask_b32 v17, v17, 0, vcc
    v_cmp_eq_u32 vcc, v4, v18
    s_nop 1
    v_cndmask_b32 v18, v18, 0, vcc
    v_cmp_eq_u32 vcc, v4, v19
    s_nop 1
    v_cndmask_b32 v19, v19, 0, vcc
    v_cmp_eq_u32 vcc, v4, v20
    s_nop 1
    v_cndmask_b32 v20, v20, 0, vcc
    v_cmp_eq_u32 vcc, v4, v21
    s_nop 1
    v_cndmask_b32 v21, v21, 0, vcc
    v_cmp_eq_u32 vcc, v4, v22
    s_nop 1
    v_cndmask_b32 v22, v22, 0, vcc
    v_cmp_eq_u32 vcc, v4, v23
    s_nop 1
    v_cndmask_b32 v23, v23, 0, vcc
    v_cmp_eq_u32 vcc, v4, v24
    s_nop 1
    v_cndmask_b32 v24, v24, 0, vcc
    v_cmp_eq_u32 vcc, v4, v25
    s_nop 1
    v_cndmask_b32 v25, v25, 0, vcc
    v_cmp_eq_u32 vcc, v4, v26
    s_nop 1
    v_cndmask_b32 v26, v26, 0, vcc
    v_cmp_eq_u32 vcc, v4, v27
    s_nop 1
    v_cndmask_b32 v27, v27, 0, vcc
    v_cmp_eq_u32 vcc, v4, v28
    s_nop 1
    v_cndmask_b32 v28, v28, 0, vcc
    v_cmp_eq_u32 vcc, v4, v29
    s_nop 1
    v_cndmask_b32 v29, v29, 0, vcc
    v_cmp_eq_u32 vcc, v4, v30
    s_nop 1
    v_cndmask_b32 v30, v30, 0, vcc
    v_cmp_eq_u32 vcc, v4, v31
    s_nop 1
    v_cndmask_b32 v31, v31, 0, vcc
    v_cmp_eq_u32 vcc, v4, v32
    s_nop 1
    v_cndmask_b32 v32, v32, 0, vcc
    v_cmp_eq_u32 vcc, v4, v33
    s_nop 1
    v_cndmask_b32 v33, v33, 0, vcc
    v_cmp_eq_u32 vcc, v4, v34
    s_nop 1
    v_cndmask_b32 v34, v34, 0, vcc
    v_cmp_eq_u32 vcc, v4, v35
    s_nop 1
    v_cndmask_b32 v35, v35, 0, vcc
    v_cmp_eq_u32 vcc, v4, v36
    s_nop 1
    v_cndmask_b32 v36, v36, 0, vcc
    v_cmp_eq_u32 vcc, v4, v37
    s_nop 1
    v_cndmask_b32 v37, v37, 0, vcc
    v_cmp_eq_u32 vcc, v4, v38
    s_nop 1
    v_cndmask_b32 v38, v38, 0, vcc
    v_cmp_eq_u32 vcc, v4, v39
    s_nop 1
    v_cndmask_b32 v39, v39, 0, vcc
    v_cmp_eq_u32 vcc, v4, v40
    s_nop 1
    v_cndmask_b32 v40, v40, 0, vcc
    v_cmp_eq_u32 vcc, v4, v41
    s_nop 1
    v_cndmask_b32 v41, v41, 0, vcc
    v_cmp_eq_u32 vcc, v4, v42
    s_nop 1
    v_cndmask_b32 v42, v42, 0, vcc
    v_cmp_eq_u32 vcc, v4, v43
    s_nop 1
    v_cndmask_b32 v43, v43, 0, vcc
    v_cmp_eq_u32 vcc, v4, v44
    s_nop 1
    v_cndmask_b32 v44, v44, 0, vcc
    v_cmp_eq_u32 vcc, v4, v45
    s_nop 1
    v_cndmask_b32 v45, v45, 0, vcc
    v_cmp_eq_u32 vcc, v4, v46
    s_nop 1
    v_cndmask_b32 v46, v46, 0, vcc
    v_cmp_eq_u32 vcc, v4, v47
    s_nop 1
    v_cndmask_b32 v47, v47, 0, vcc
    v_max3_u32 v4, v16, v17, v18
    v_max3_u32 v4, v4, v19, v20
    v_max3_u32 v4, v4, v21, v22
    v_max3_u32 v4, v4, v23, v24
    v_max3_u32 v4, v4, v25, v26
    v_max3_u32 v4, v4, v27, v28
    v_max3_u32 v4, v4, v29, v30
    v_max3_u32 v4, v4, v31, v32
    v_max3_u32 v4, v4, v33, v34
    v_max3_u32 v4, v4, v35, v36
    v_max3_u32 v4, v4, v37, v38
    v_max3_u32 v4, v4, v39, v40
    v_max3_u32 v4, v4, v41, v42
    v_max3_u32 v4, v4, v43, v44
    v_max3_u32 v4, v4, v45, v46
    v_max_u32 v4, v4, v47
    s_nop 1
    v_max_u32_dpp v4, v4, v4 quad_perm:[1,0,3,2] row_mask:0xf bank_mask:0xf
    s_nop 1
    v_max_u32_dpp v4, v4, v4 quad_perm:[2,3,0,1] row_mask:0xf bank_mask:0xf
    s_nop 1
    v_max_u32_dpp v4, v4, v4 row_half_mirror row_mask:0xf bank_mask:0xf
    s_nop 1
    v_max_u32_dpp v4, v4, v4 row_mirror row_mask:0xf bank_mask:0xf
    v_mov_b32 v5, v4
    s_nop 1
    v_permlane16_swap_b32 v4, v5
    v_max_u32 v4, v4, v5
    v_mov_b32 v5, v4
    s_nop 1
    v_permlane32_swap_b32 v4, v5
    v_max_u32 v4, v4, v5
    v_mov_b32 v63, v4
    v_mov_b32 v4, v56
    v_cmp_eq_u32 vcc, 1, v0
    s_nop 1
    v_cndmask_b32 v4, v4, v57, vcc
    v_cmp_eq_u32 vcc, 2, v0
    s_nop 1
    v_cndmask_b32 v4, v4, v58, vcc
    v_cmp_eq_u32 vcc, 3, v0
    s_nop 1
    v_cndmask_b32 v4, v4, v59, vcc
    v_cmp_eq_u32 vcc, 4, v0
    s_nop 1
    v_cndmask_b32 v4, v4, v60, vcc
    v_cmp_eq_u32 vcc, 5, v0
    s_nop 1
    v_cndmask_b32 v4, v4, v61, vcc
    v_cmp_eq_u32 vcc, 6, v0
    s_nop 1
    v_cndmask_b32 v4, v4, v62, vcc
    v_cmp_eq_u32 vcc, 7, v0
    s_nop 1
    v_cndmask_b32 v4, v4, v63, vcc
    v_and_b32 v5, 0xffff, v4
    v_sub_u32 v5, 0xffff, v5
    v_and_b32 v4, 0xffff0000, v4
    v_ashrrev_i32 v3, 31, v4
    v_not_b32 v3, v3
    v_or_b32 v3, 0x80000000, v3
    v_xor_b32 v4, v4, v3
    v_and_b32 v4, 0xffff0000, v4
    v_mul_f32 v4, 0xbfb8aa3b, v4
    v_exp_f32 v4, v4
    s_nop 0
    v_add_f32 v4, 1.0, v4
    v_rcp_f32 v4, v4
    s_nop 0
    v_cvt_pk_bf16_f32 v4, v4, v4
    v_lshlrev_b32 v4, 16, v4
    v_lshlrev_b32 v6, 2, v0
    s_mov_b32 s64, 0x5400000
    s_mov_b64 exec, 0xff
    buffer_store_dword v5, v6, s[4:7], s64 offen sc1
    buffer_store_dword v4, v6, s[4:7], s64 offen offset:32 sc1
    s_mov_b64 exec, -1
    s_waitcnt vmcnt(0)
    v_mov_b32 v7, 1
    v_mov_b32 v8, 0
    s_mov_b32 s64, 0x298000
    s_mov_b64 exec, 1
    buffer_atomic_add v7, v8, s[4:7], s64 offen sc1
    s_mov_b64 exec, -1
    v_mbcnt_lo_u32_b32 v0, -1, 0
    v_mbcnt_hi_u32_b32 v0, -1, v0
NOSEL_115:
    v_lshlrev_b32 v1, 4, v0
    v_lshrrev_b32 v6, 3, v0
    v_mul_u32_u24 v2, 1280, v6
    v_and_b32 v7, 7, v0
    v_xor_b32 v7, v7, v6
    v_lshl_add_u32 v2, v7, 4, v2
    v_bfe_u32 v6, v0, 3, 1
    v_lshlrev_b32 v9, 10, v6
    v_and_b32 v6, 7, v0
    v_lshl_add_u32 v9, v6, 7, v9
    v_lshrrev_b32 v7, 4, v0
    v_xor_b32 v7, v7, v6
    v_lshl_add_u32 v3, v7, 4, v9
    v_xor_b32 v7, 4, v7
    v_lshl_add_u32 v4, v7, 4, v9
    v_add_u32 v6, 0x10000, v3
    v_add_u32 v9, 0x10000, v4
    s_barrier
    s_mul_i32 s20, s12, 163840
    s_mul_i32 s64, s14, 40960
    s_add_u32 s20, s20, s64
    s_add_u32 s20, s20, 0x0
    s_lshl_b32 s21, s14, 12
    s_add_u32 m0, s21, 0
    s_add_u32 s64, s20, 0x0
    buffer_load_dwordx4 v2, s[4:7], s64 offen lds
    s_add_u32 m0, s21, 1024
    s_add_u32 s64, s20, 0x2800
    buffer_load_dwordx4 v2, s[4:7], s64 offen lds
    s_add_u32 m0, s21, 2048
    s_add_u32 s64, s20, 0x5000
    buffer_load_dwordx4 v2, s[4:7], s64 offen lds
    s_add_u32 m0, s21, 3072
    s_add_u32 s64, s20, 0x7800
    buffer_load_dwordx4 v2, s[4:7], s64 offen lds
    s_add_u32 m0, s21, 16384
    s_add_u32 s64, s20, 0x80
    buffer_load_dwordx4 v2, s[4:7], s64 offen lds
    s_add_u32 m0, s21, 17408
    s_add_u32 s64, s20, 0x2880
    buffer_load_dwordx4 v2, s[4:7], s64 offen lds
    s_add_u32 m0, s21, 18432
    s_add_u32 s64, s20, 0x5080
    buffer_load_dwordx4 v2, s[4:7], s64 offen lds
    s_add_u32 m0, s21, 19456
    s_add_u32 s64, s20, 0x7880
    buffer_load_dwordx4 v2, s[4:7], s64 offen lds
    s_add_u32 m0, s21, 32768
    s_add_u32 s64, s20, 0x100
    buffer_load_dwordx4 v2, s[4:7], s64 offen lds
    s_add_u32 m0, s21, 33792
    s_add_u32 s64, s20, 0x2900
    buffer_load_dwordx4 v2, s[4:7], s64 offen lds
    s_add_u32 m0, s21, 34816
    s_add_u32 s64, s20, 0x5100
    buffer_load_dwordx4 v2, s[4:7], s64 offen lds
    s_add_u32 m0, s21, 35840
    s_add_u32 s64, s20, 0x7900
    buffer_load_dwordx4 v2, s[4:7], s64 offen lds
    s_add_u32 m0, s21, 49152
    s_add_u32 s64, s20, 0x180
    buffer_load_dwordx4 v2, s[4:7], s64 offen lds
    s_add_u32 m0, s21, 50176
    s_add_u32 s64, s20, 0x2980
    buffer_load_dwordx4 v2, s[4:7], s64 offen lds
    s_add_u32 m0, s21, 51200
    s_add_u32 s64, s20, 0x5180
    buffer_load_dwordx4 v2, s[4:7], s64 offen lds
    s_add_u32 m0, s21, 52224
    s_add_u32 s64, s20, 0x7980
    buffer_load_dwordx4 v2, s[4:7], s64 offen lds
    s_mov_b32 s64, 0x40000000
    buffer_store_dword v7, v1, s[4:7], s64 offen
    buffer_store_dword v7, v1, s[4:7], s64 offen
    buffer_store_dword v7, v1, s[4:7], s64 offen
    buffer_store_dword v7, v1, s[4:7], s64 offen
    buffer_store_dword v7, v1, s[4:7], s64 offen
    buffer_store_dword v7, v1, s[4:7], s64 offen
    buffer_store_dword v7, v1, s[4:7], s64 offen
    buffer_store_dword v7, v1, s[4:7], s64 offen
    s_waitcnt vmcnt(20)
    s_barrier
    ds_read_b128 a[0:3], v3 offset:0
    ds_read_b128 a[4:7], v3 offset:2048
    ds_read_b128 a[8:11], v3 offset:4096
    ds_read_b128 a[12:15], v3 offset:6144
    ds_read_b128 a[16:19], v3 offset:8192
    ds_read_b128 a[20:23], v3 offset:10240
    ds_read_b128 a[24:27], v3 offset:12288
    ds_read_b128 a[28:31], v3 offset:14336
    s_mov_b32 s19, 0
    s_mov_b32 s22, s16
    s_mov_b32 s23, 0x40000000
G_T_LOOP:
    s_waitcnt lgkmcnt(4)
    v_mfma_f32_16x16x32_bf16 v[16:19], v[96:99], a[0:3], 0
    v_mfma_f32_16x16x32_bf16 v[20:23], v[100:103], a[0:3], 0
    ds_read_b128 a[32:35], v4 offset:0
    v_mfma_f32_16x16x32_bf16 v[24:27], v[96:99], a[4:7], 0
    v_mfma_f32_16x16x32_bf16 v[28:31], v[100:103], a[4:7], 0
    ds_read_b128 a[36:39], v4 offset:2048
    v_mfma_f32_16x16x32_bf16 v[32:35], v[96:99], a[8:11], 0
    v_mfma_f32_16x16x32_bf16 v[36:39], v[100:103], a[8:11], 0
    ds_read_b128 a[40:43], v4 offset:4096
    v_mfma_f32_16x16x32_bf16 v[40:43], v[96:99], a[12:15], 0
    v_mfma_f32_16x16x32_bf16 v[44:47], v[100:103], a[12:15], 0
    ds_read_b128 a[44:47], v4 offset:6144
    s_waitcnt lgkmcnt(4)
    v_mfma_f32_16x16x32_bf16 v[48:51], v[96:99], a[16:19], 0
    v_mfma_f32_16x16x32_bf16 v[52:55], v[100:103], a[16:19], 0
    ds_read_b128 a[48:51], v4 offset:8192
    v_mfma_f32_16x16x32_bf16 v[56:59], v[96:99], a[20:23], 0
    v_mfma_f32_16x16x32_bf16 v[60:63], v[100:103], a[20:23], 0
    ds_read_b128 a[52:55], v4 offset:10240
    v_mfma_f32_16x16x32_bf16 v[64:67], v[96:99], a[24:27], 0
    v_mfma_f32_16x16x32_bf16 v[68:71], v[100:103], a[24:27], 0
    ds_read_b128 a[56:59], v4 offset:12288
    v_mfma_f32_16x16x32_bf16 v[72:75], v[96:99], a[28:31], 0
    v_mfma_f32_16x16x32_bf16 v[76:79], v[100:103], a[28:31], 0
    ds_read_b128 a[60:63], v4 offset:14336
    s_waitcnt vmcnt(16)
    s_barrier
    s_waitcnt lgkmcnt(4)
    v_mfma_f32_16x16x32_bf16 v[16:19], v[104:107], a[32:35], v[16:19]
    v_mfma_f32_16x16x32_bf16 v[20:23], v[108:111], a[32:35], v[20:23]
    ds_read_b128 a[0:3], v3 offset:16384
    s_add_u32 m0, s21, 65536
    v_mfma_f32_16x16x32_bf16 v[24:27], v[104:107], a[36:39], v[24:27]
    v_mfma_f32_16x16x32_bf16 v[28:31], v[108:111], a[36:39], v[28:31]
    ds_read_b128 a[4:7], v3 offset:18432
    s_add_u32 s64, s20, 0x200
    buffer_load_dwordx4 v2, s[4:7], s64 offen lds
    v_mfma_f32_16x16x32_bf16 v[32:35], v[104:107], a[40:43], v[32:35]
    v_mfma_f32_16x16x32_bf16 v[36:39], v[108:111], a[40:43], v[36:39]
    ds_read_b128 a[8:11], v3 offset:20480
    s_add_u32 m0, s21, 66560
    v_mfma_f32_16x16x32_bf16 v[40:43], v[104:107], a[44:47], v[40:43]
    v_mfma_f32_16x16x32_bf16 v[44:47], v[108:111], a[44:47], v[44:47]
    ds_read_b128 a[12:15], v3 offset:22528
    s_add_u32 s64, s20, 0x2a00
    buffer_load_dwordx4 v2, s[4:7], s64 offen lds
    s_waitcnt lgkmcnt(4)
    v_mfma_f32_16x16x32_bf16 v[48:51], v[104:107], a[48:51], v[48:51]
    v_mfma_f32_16x16x32_bf16 v[52:55], v[108:111], a[48:51], v[52:55]
    ds_read_b128 a[16:19], v3 offset:24576
    s_add_u32 m0, s21, 67584
    v_mfma_f32_16x16x32_bf16 v[56:59], v[104:107], a[52:55], v[56:59]
    v_mfma_f32_16x16x32_bf16 v[60:63], v[108:111], a[52:55], v[60:63]
    ds_read_b128 a[20:23], v3 offset:26624
    s_add_u32 s64, s20, 0x5200
    buffer_load_dwordx4 v2, s[4:7], s64 offen lds
    v_mfma_f32_16x16x32_bf16 v[64:67], v[104:107], a[56:59], v[64:67]
    v_mfma_f32_16x16x32_bf16 v[68:71], v[108:111], a[56:59], v[68:71]
    ds_read_b128 a[24:27], v3 offset:28672
    s_add_u32 m0, s21, 68608
    v_mfma_f32_16x16x32_bf16 v[72:75], v[104:107], a[60:63], v[72:75]
    v_mfma_f32_16x16x32_bf16 v[76:79], v[108:111], a[60:63], v[76:79]
    ds_read_b128 a[28:31], v3 offset:30720
    s_add_u32 s64, s20, 0x7a00
    buffer_load_dwordx4 v2, s[4:7], s64 offen lds
    s_waitcnt lgkmcnt(4)
    v_mfma_f32_16x16x32_bf16 v[16:19], v[112:115], a[0:3], v[16:19]
    v_mfma_f32_16x16x32_bf16 v[20:23], v[116:119], a[0:3], v[20:23]
    ds_read_b128 a[32:35], v4 offset:16384
    v_mfma_f32_16x16x32_bf16 v[24:27], v[112:115], a[4:7], v[24:27]
    v_mfma_f32_16x16x32_bf16 v[28:31], v[116:119], a[4:7], v[28:31]
    ds_read_b128 a[36:39], v4 offset:18432
    v_mfma_f32_16x16x32_bf16 v[32:35], v[112:115], a[8:11], v[32:35]
    v_mfma_f32_16x16x32_bf16 v[36:39], v[116:119], a[8:11], v[36:39]
    ds_read_b128 a[40:43], v4 offset:20480
    v_mfma_f32_16x16x32_bf16 v[40:43], v[112:115], a[12:15], v[40:43]
    v_mfma_f32_16x16x32_bf16 v[44:47], v[116:119], a[12:15], v[44:47]
    ds_read_b128 a[44:47], v4 offset:22528
    s_waitcnt lgkmcnt(4)
    v_mfma_f32_16x16x32_bf16 v[48:51], v[112:115], a[16:19], v[48:51]
    v_mfma_f32_16x16x32_bf16 v[52:55], v[116:119], a[16:19], v[52:55]
    ds_read_b128 a[48:51], v4 offset:24576
    v_mfma_f32_16x16x32_bf16 v[56:59], v[112:115], a[20:23], v[56:59]
    v_mfma_f32_16x16x32_bf16 v[60:63], v[116:119], a[20:23], v[60:63]
    ds_read_b128 a[52:55], v4 offset:26624
    v_mfma_f32_16x16x32_bf16 v[64:67], v[112:115], a[24:27], v[64:67]
    v_mfma_f32_16x16x32_bf16 v[68:71], v[116:119], a[24:27], v[68:71]
    ds_read_b128 a[56:59], v4 offset:28672
    v_mfma_f32_16x16x32_bf16 v[72:75], v[112:115], a[28:31], v[72:75]
    v_mfma_f32_16x16x32_bf16 v[76:79], v[116:119], a[28:31], v[76:79]
    ds_read_b128 a[60:63], v4 offset:30720
    s_waitcnt vmcnt(16)
    s_barrier
    s_cmp_lg_u32 s19, 0
    s_cbranch_scc1 GFD_116
    s_cmp_lg_u32 s14, 0
    s_cbranch_scc1 INE_117
    s_cmp_lg_u32 s96, 10
    s_cbranch_scc1 ING_118
    v_mov_b32 v7, 1
    v_lshlrev_b32 v8, 7, v0
    s_mov_b32 s65, 0x29a000
    s_mov_b64 exec, 3
    buffer_store_dword v7, v8, s[4:7], s65 offen sc1
    s_mov_b64 exec, -1
    s_waitcnt vmcnt(0)
ING_118:
    v_mov_b32 v8, 1
    s_mov_b32 s65, 0x290800
    s_mov_b64 exec, 1
    buffer_atomic_add v8, off, s[4:7], s65 sc1
    s_mov_b64 exec, -1
INE_117:
GFD_116:
    s_waitcnt lgkmcnt(4)
    v_mfma_f32_16x16x32_bf16 v[16:19], v[120:123], a[32:35], v[16:19]
    v_mfma_f32_16x16x32_bf16 v[20:23], v[124:127], a[32:35], v[20:23]
    ds_read_b128 a[0:3], v3 offset:32768
    s_add_u32 m0, s21, 0
    v_mfma_f32_16x16x32_bf16 v[24:27], v[120:123], a[36:39], v[24:27]
    v_mfma_f32_16x16x32_bf16 v[28:31], v[124:127], a[36:39], v[28:31]
    ds_read_b128 a[4:7], v3 offset:34816
    s_add_u32 s64, s20, 0x280
    buffer_load_dwordx4 v2, s[4:7], s64 offen lds
    v_mfma_f32_16x16x32_bf16 v[32:35], v[120:123], a[40:43], v[32:35]
    v_mfma_f32_16x16x32_bf16 v[36:39], v[124:127], a[40:43], v[36:39]
    ds_read_b128 a[8:11], v3 offset:36864
    s_add_u32 m0, s21, 1024
    v_mfma_f32_16x16x32_bf16 v[40:43], v[120:123], a[44:47], v[40:43]
    v_mfma_f32_16x16x32_bf16 v[44:47], v[124:127], a[44:47], v[44:47]
    ds_read_b128 a[12:15], v3 offset:38912
    s_add_u32 s64, s20, 0x2a80
    buffer_load_dwordx4 v2, s[4:7], s64 offen lds
    s_waitcnt lgkmcnt(4)
    v_mfma_f32_16x16x32_bf16 v[48:51], v[120:123], a[48:51], v[48:51]
    v_mfma_f32_16x16x32_bf16 v[52:55], v[124:127], a[48:51], v[52:55]
    ds_read_b128 a[16:19], v3 offset:40960
    s_add_u32 m0, s21, 2048
    v_mfma_f32_16x16x32_bf16 v[56:59], v[120:123], a[52:55], v[56:59]
    v_mfma_f32_16x16x32_bf16 v[60:63], v[124:127], a[52:55], v[60:63]
    ds_read_b128 a[20:23], v3 offset:43008
    s_add_u32 s64, s20, 0x5280
    buffer_load_dwordx4 v2, s[4:7], s64 offen lds
    v_mfma_f32_16x16x32_bf16 v[64:67], v[120:123], a[56:59], v[64:67]
    v_mfma_f32_16x16x32_bf16 v[68:71], v[124:127], a[56:59], v[68:71]
    ds_read_b128 a[24:27], v3 offset:45056
    s_add_u32 m0, s21, 3072
    v_mfma_f32_16x16x32_bf16 v[72:75], v[120:123], a[60:63], v[72:75]
    v_mfma_f32_16x16x32_bf16 v[76:79], v[124:127], a[60:63], v[76:79]
    ds_read_b128 a[28:31], v3 offset:47104
    s_add_u32 s64, s20, 0x7a80
    buffer_load_dwordx4 v2, s[4:7], s64 offen lds
    s_waitcnt lgkmcnt(4)
    v_mfma_f32_16x16x32_bf16 v[16:19], v[128:131], a[0:3], v[16:19]
    v_mfma_f32_16x16x32_bf16 v[20:23], v[132:135], a[0:3], v[20:23]
    ds_read_b128 a[32:35], v4 offset:32768
    v_mfma_f32_16x16x32_bf16 v[24:27], v[128:131], a[4:7], v[24:27]
    v_mfma_f32_16x16x32_bf16 v[28:31], v[132:135], a[4:7], v[28:31]
    ds_read_b128 a[36:39], v4 offset:34816
    v_mfma_f32_16x16x32_bf16 v[32:35], v[128:131], a[8:11], v[32:35]
    v_mfma_f32_16x16x32_bf16 v[36:39], v[132:135], a[8:11], v[36:39]
    ds_read_b128 a[40:43], v4 offset:36864
    v_mfma_f32_16x16x32_bf16 v[40:43], v[128:131], a[12:15], v[40:43]
    v_mfma_f32_16x16x32_bf16 v[44:47], v[132:135], a[12:15], v[44:47]
    ds_read_b128 a[44:47], v4 offset:38912
    s_waitcnt lgkmcnt(4)
    v_mfma_f32_16x16x32_bf16 v[48:51], v[128:131], a[16:19], v[48:51]
    v_mfma_f32_16x16x32_bf16 v[52:55], v[132:135], a[16:19], v[52:55]
    ds_read_b128 a[48:51], v4 offset:40960
    v_mfma_f32_16x16x32_bf16 v[56:59], v[128:131], a[20:23], v[56:59]
    v_mfma_f32_16x16x32_bf16 v[60:63], v[132:135], a[20:23], v[60:63]
    ds_read_b128 a[52:55], v4 offset:43008
    v_mfma_f32_16x16x32_bf16 v[64:67], v[128:131], a[24:27], v[64:67]
    v_mfma_f32_16x16x32_bf16 v[68:71], v[132:135], a[24:27], v[68:71]
    ds_read_b128 a[56:59], v4 offset:45056
    v_mfma_f32_16x16x32_bf16 v[72:75], v[128:131], a[28:31], v[72:75]
    v_mfma_f32_16x16x32_bf16 v[76:79], v[132:135], a[28:31], v[76:79]
    ds_read_b128 a[60:63], v4 offset:47104
    s_waitcnt vmcnt(16)
    s_barrier
    s_waitcnt lgkmcnt(4)
    v_mfma_f32_16x16x32_bf16 v[16:19], v[136:139], a[32:35], v[16:19]
    v_mfma_f32_16x16x32_bf16 v[20:23], v[140:143], a[32:35], v[20:23]
    ds_read_b128 a[0:3], v3 offset:49152
    s_add_u32 m0, s21, 16384
    v_mfma_f32_16x16x32_bf16 v[24:27], v[136:139], a[36:39], v[24:27]
    v_mfma_f32_16x16x32_bf16 v[28:31], v[140:143], a[36:39], v[28:31]
    ds_read_b128 a[4:7], v3 offset:51200
    s_add_u32 s64, s20, 0x300
    buffer_load_dwordx4 v2, s[4:7], s64 offen lds
    v_mfma_f32_16x16x32_bf16 v[32:35], v[136:139], a[40:43], v[32:35]
    v_mfma_f32_16x16x32_bf16 v[36:39], v[140:143], a[40:43], v[36:39]
    ds_read_b128 a[8:11], v3 offset:53248
    s_add_u32 m0, s21, 17408
    v_mfma_f32_16x16x32_bf16 v[40:43], v[136:139], a[44:47], v[40:43]
    v_mfma_f32_16x16x32_bf16 v[44:47], v[140:143], a[44:47], v[44:47]
    ds_read_b128 a[12:15], v3 offset:55296
    s_add_u32 s64, s20, 0x2b00
    buffer_load_dwordx4 v2, s[4:7], s64 offen lds
    s_waitcnt lgkmcnt(4)
    v_mfma_f32_16x16x32_bf16 v[48:51], v[136:139], a[48:51], v[48:51]
    v_mfma_f32_16x16x32_bf16 v[52:55], v[140:143], a[48:51], v[52:55]
    ds_read_b128 a[16:19], v3 offset:57344
    s_add_u32 m0, s21, 18432
    v_mfma_f32_16x16x32_bf16 v[56:59], v[136:139], a[52:55], v[56:59]
    v_mfma_f32_16x16x32_bf16 v[60:63], v[140:143], a[52:55], v[60:63]
    ds_read_b128 a[20:23], v3 offset:59392
    s_add_u32 s64, s20, 0x5300
    buffer_load_dwordx4 v2, s[4:7], s64 offen lds
    v_mfma_f32_16x16x32_bf16 v[64:67], v[136:139], a[56:59], v[64:67]
    v_mfma_f32_16x16x32_bf16 v[68:71], v[140:143], a[56:59], v[68:71]
    ds_read_b128 a[24:27], v3 offset:61440
    s_add_u32 m0, s21, 19456
    v_mfma_f32_16x16x32_bf16 v[72:75], v[136:139], a[60:63], v[72:75]
    v_mfma_f32_16x16x32_bf16 v[76:79], v[140:143], a[60:63], v[76:79]
    ds_read_b128 a[28:31], v3 offset:63488
    s_add_u32 s64, s20, 0x7b00
    buffer_load_dwordx4 v2, s[4:7], s64 offen lds
    s_waitcnt lgkmcnt(4)
    v_mfma_f32_16x16x32_bf16 v[16:19], v[144:147], a[0:3], v[16:19]
    v_mfma_f32_16x16x32_bf16 v[20:23], v[148:151], a[0:3], v[20:23]
    ds_read_b128 a[32:35], v4 offset:49152
    v_mfma_f32_16x16x32_bf16 v[24:27], v[144:147], a[4:7], v[24:27]
    v_mfma_f32_16x16x32_bf16 v[28:31], v[148:151], a[4:7], v[28:31]
    ds_read_b128 a[36:39], v4 offset:51200
    v_mfma_f32_16x16x32_bf16 v[32:35], v[144:147], a[8:11], v[32:35]
    v_mfma_f32_16x16x32_bf16 v[36:39], v[148:151], a[8:11], v[36:39]
    ds_read_b128 a[40:43], v4 offset:53248
    v_mfma_f32_16x16x32_bf16 v[40:43], v[144:147], a[12:15], v[40:43]
    v_mfma_f32_16x16x32_bf16 v[44:47], v[148:151], a[12:15], v[44:47]
    ds_read_b128 a[44:47], v4 offset:55296
    s_waitcnt lgkmcnt(4)
    v_mfma_f32_16x16x32_bf16 v[48:51], v[144:147], a[16:19], v[48:51]
    v_mfma_f32_16x16x32_bf16 v[52:55], v[148:151], a[16:19], v[52:55]
    ds_read_b128 a[48:51], v4 offset:57344
    v_mfma_f32_16x16x32_bf16 v[56:59], v[144:147], a[20:23], v[56:59]
    v_mfma_f32_16x16x32_bf16 v[60:63], v[148:151], a[20:23], v[60:63]
    ds_read_b128 a[52:55], v4 offset:59392
    v_mfma_f32_16x16x32_bf16 v[64:67], v[144:147], a[24:27], v[64:67]
    v_mfma_f32_16x16x32_bf16 v[68:71], v[148:151], a[24:27], v[68:71]
    ds_read_b128 a[56:59], v4 offset:61440
    v_mfma_f32_16x16x32_bf16 v[72:75], v[144:147], a[28:31], v[72:75]
    v_mfma_f32_16x16x32_bf16 v[76:79], v[148:151], a[28:31], v[76:79]
    ds_read_b128 a[60:63], v4 offset:63488
    s_waitcnt vmcnt(8)
    s_barrier
    s_cmp_lg_u32 s14, 0
    s_cbranch_scc1 GF_119
    v_mov_b32 v7, 1
    v_mov_b32 v8, 0
    s_mov_b64 exec, 1
    buffer_store_dword v7, v8, s[4:7], s23 offen sc1
    s_mov_b64 exec, -1
GF_119:
    s_waitcnt lgkmcnt(4)
    v_mfma_f32_16x16x32_bf16 v[16:19], v[152:155], a[32:35], v[16:19]
    v_mfma_f32_16x16x32_bf16 v[20:23], v[156:159], a[32:35], v[20:23]
    ds_read_b128 a[0:3], v6 offset:0
    s_add_u32 m0, s21, 32768
    v_mfma_f32_16x16x32_bf16 v[24:27], v[152:155], a[36:39], v[24:27]
    v_mfma_f32_16x16x32_bf16 v[28:31], v[156:159], a[36:39], v[28:31]
    ds_read_b128 a[4:7], v6 offset:2048
    s_add_u32 s64, s20, 0x380
    buffer_load_dwordx4 v2, s[4:7], s64 offen lds
    v_mfma_f32_16x16x32_bf16 v[32:35], v[152:155], a[40:43], v[32:35]
    v_mfma_f32_16x16x32_bf16 v[36:39], v[156:159], a[40:43], v[36:39]
    ds_read_b128 a[8:11], v6 offset:4096
    s_add_u32 m0, s21, 33792
    v_mfma_f32_16x16x32_bf16 v[40:43], v[152:155], a[44:47], v[40:43]
    v_mfma_f32_16x16x32_bf16 v[44:47], v[156:159], a[44:47], v[44:47]
    ds_read_b128 a[12:15], v6 offset:6144
    s_add_u32 s64, s20, 0x2b80
    buffer_load_dwordx4 v2, s[4:7], s64 offen lds
    s_waitcnt lgkmcnt(4)
    v_mfma_f32_16x16x32_bf16 v[48:51], v[152:155], a[48:51], v[48:51]
    v_mfma_f32_16x16x32_bf16 v[52:55], v[156:159], a[48:51], v[52:55]
    ds_read_b128 a[16:19], v6 offset:8192
    s_add_u32 m0, s21, 34816
    v_mfma_f32_16x16x32_bf16 v[56:59], v[152:155], a[52:55], v[56:59]
    v_mfma_f32_16x16x32_bf16 v[60:63], v[156:159], a[52:55], v[60:63]
    ds_read_b128 a[20:23], v6 offset:10240
    s_add_u32 s64, s20, 0x5380
    buffer_load_dwordx4 v2, s[4:7], s64 offen lds
    v_mfma_f32_16x16x32_bf16 v[64:67], v[152:155], a[56:59], v[64:67]
    v_mfma_f32_16x16x32_bf16 v[68:71], v[156:159], a[56:59], v[68:71]
    ds_read_b128 a[24:27], v6 offset:12288
    s_add_u32 m0, s21, 35840
    v_mfma_f32_16x16x32_bf16 v[72:75], v[152:155], a[60:63], v[72:75]
    v_mfma_f32_16x16x32_bf16 v[76:79], v[156:159], a[60:63], v[76:79]
    ds_read_b128 a[28:31], v6 offset:14336
    s_add_u32 s64, s20, 0x7b80
    buffer_load_dwordx4 v2, s[4:7], s64 offen lds
    s_waitcnt lgkmcnt(4)
    v_mfma_f32_16x16x32_bf16 v[16:19], v[160:163], a[0:3], v[16:19]
    v_mfma_f32_16x16x32_bf16 v[20:23], v[164:167], a[0:3], v[20:23]
    ds_read_b128 a[32:35], v9 offset:0
    v_mfma_f32_16x16x32_bf16 v[24:27], v[160:163], a[4:7], v[24:27]
    v_mfma_f32_16x16x32_bf16 v[28:31], v[164:167], a[4:7], v[28:31]
    ds_read_b128 a[36:39], v9 offset:2048
    v_mfma_f32_16x16x32_bf16 v[32:35], v[160:163], a[8:11], v[32:35]
    v_mfma_f32_16x16x32_bf16 v[36:39], v[164:167], a[8:11], v[36:39]
    ds_read_b128 a[40:43], v9 offset:4096
    v_mfma_f32_16x16x32_bf16 v[40:43], v[160:163], a[12:15], v[40:43]
    v_mfma_f32_16x16x32_bf16 v[44:47], v[164:167], a[12:15], v[44:47]
    ds_read_b128 a[44:47], v9 offset:6144
    s_waitcnt lgkmcnt(4)
    v_mfma_f32_16x16x32_bf16 v[48:51], v[160:163], a[16:19], v[48:51]
    v_mfma_f32_16x16x32_bf16 v[52:55], v[164:167], a[16:19], v[52:55]
    ds_read_b128 a[48:51], v9 offset:8192
    v_mfma_f32_16x16x32_bf16 v[56:59], v[160:163], a[20:23], v[56:59]
    v_mfma_f32_16x16x32_bf16 v[60:63], v[164:167], a[20:23], v[60:63]
    ds_read_b128 a[52:55], v9 offset:10240
    v_mfma_f32_16x16x32_bf16 v[64:67], v[160:163], a[24:27], v[64:67]
    v_mfma_f32_16x16x32_bf16 v[68:71], v[164:167], a[24:27], v[68:71]
    ds_read_b128 a[56:59], v9 offset:12288
    v_mfma_f32_16x16x32_bf16 v[72:75], v[160:163], a[28:31], v[72:75]
    v_mfma_f32_16x16x32_bf16 v[76:79], v[164:167], a[28:31], v[76:79]
    ds_read_b128 a[60:63], v9 offset:14336
    s_waitcnt vmcnt(8)
    s_barrier
    s_waitcnt lgkmcnt(4)
    v_mfma_f32_16x16x32_bf16 v[16:19], v[168:171], a[32:35], v[16:19]
    v_mfma_f32_16x16x32_bf16 v[20:23], v[172:175], a[32:35], v[20:23]
    ds_read_b128 a[0:3], v3 offset:0
    s_add_u32 m0, s21, 49152
    v_mfma_f32_16x16x32_bf16 v[24:27], v[168:171], a[36:39], v[24:27]
    v_mfma_f32_16x16x32_bf16 v[28:31], v[172:175], a[36:39], v[28:31]
    ds_read_b128 a[4:7], v3 offset:2048
    s_add_u32 s64, s20, 0x400
    buffer_load_dwordx4 v2, s[4:7], s64 offen lds
    v_mfma_f32_16x16x32_bf16 v[32:35], v[168:171], a[40:43], v[32:35]
    v_mfma_f32_16x16x32_bf16 v[36:39], v[172:175], a[40:43], v[36:39]
    ds_read_b128 a[8:11], v3 offset:4096
    s_add_u32 m0, s21, 50176
    v_mfma_f32_16x16x32_bf16 v[40:43], v[168:171], a[44:47], v[40:43]
    v_mfma_f32_16x16x32_bf16 v[44:47], v[172:175], a[44:47], v[44:47]
    ds_read_b128 a[12:15], v3 offset:6144
    s_add_u32 s64, s20, 0x2c00
    buffer_load_dwordx4 v2, s[4:7], s64 offen lds
    s_waitcnt lgkmcnt(4)
    v_mfma_f32_16x16x32_bf16 v[48:51], v[168:171], a[48:51], v[48:51]
    v_mfma_f32_16x16x32_bf16 v[52:55], v[172:175], a[48:51], v[52:55]
    ds_read_b128 a[16:19], v3 offset:8192
    s_add_u32 m0, s21, 51200
    v_mfma_f32_16x16x32_bf16 v[56:59], v[168:171], a[52:55], v[56:59]
    v_mfma_f32_16x16x32_bf16 v[60:63], v[172:175], a[52:55], v[60:63]
    ds_read_b128 a[20:23], v3 offset:10240
    s_add_u32 s64, s20, 0x5400
    buffer_load_dwordx4 v2, s[4:7], s64 offen lds
    v_mfma_f32_16x16x32_bf16 v[64:67], v[168:171], a[56:59], v[64:67]
    v_mfma_f32_16x16x32_bf16 v[68:71], v[172:175], a[56:59], v[68:71]
    ds_read_b128 a[24:27], v3 offset:12288
    s_add_u32 m0, s21, 52224
    v_mfma_f32_16x16x32_bf16 v[72:75], v[168:171], a[60:63], v[72:75]
    v_mfma_f32_16x16x32_bf16 v[76:79], v[172:175], a[60:63], v[76:79]
    ds_read_b128 a[28:31], v3 offset:14336
    s_add_u32 s64, s20, 0x7c00
    buffer_load_dwordx4 v2, s[4:7], s64 offen lds
    s_waitcnt lgkmcnt(4)
    v_mfma_f32_16x16x32_bf16 v[16:19], v[176:179], a[0:3], v[16:19]
    v_mfma_f32_16x16x32_bf16 v[20:23], v[180:183], a[0:3], v[20:23]
    ds_read_b128 a[32:35], v4 offset:0
    v_mfma_f32_16x16x32_bf16 v[24:27], v[176:179], a[4:7], v[24:27]
    v_mfma_f32_16x16x32_bf16 v[28:31], v[180:183], a[4:7], v[28:31]
    ds_read_b128 a[36:39], v4 offset:2048
    v_mfma_f32_16x16x32_bf16 v[32:35], v[176:179], a[8:11], v[32:35]
    v_mfma_f32_16x16x32_bf16 v[36:39], v[180:183], a[8:11], v[36:39]
    ds_read_b128 a[40:43], v4 offset:4096
    v_mfma_f32_16x16x32_bf16 v[40:43], v[176:179], a[12:15], v[40:43]
    v_mfma_f32_16x16x32_bf16 v[44:47], v[180:183], a[12:15], v[44:47]
    ds_read_b128 a[44:47], v4 offset:6144
    s_waitcnt lgkmcnt(4)
    v_mfma_f32_16x16x32_bf16 v[48:51], v[176:179], a[16:19], v[48:51]
    v_mfma_f32_16x16x32_bf16 v[52:55], v[180:183], a[16:19], v[52:55]
    ds_read_b128 a[48:51], v4 offset:8192
    v_mfma_f32_16x16x32_bf16 v[56:59], v[176:179], a[20:23], v[56:59]
    v_mfma_f32_16x16x32_bf16 v[60:63], v[180:183], a[20:23], v[60:63]
    ds_read_b128 a[52:55], v4 offset:10240
    v_mfma_f32_16x16x32_bf16 v[64:67], v[176:179], a[24:27], v[64:67]
    v_mfma_f32_16x16x32_bf16 v[68:71], v[180:183], a[24:27], v[68:71]
    ds_read_b128 a[56:59], v4 offset:12288
    v_mfma_f32_16x16x32_bf16 v[72:75], v[176:179], a[28:31], v[72:75]
    v_mfma_f32_16x16x32_bf16 v[76:79], v[180:183], a[28:31], v[76:79]
    ds_read_b128 a[60:63], v4 offset:14336
    s_waitcnt vmcnt(8)
    s_barrier
    s_waitcnt lgkmcnt(4)
    v_mfma_f32_16x16x32_bf16 v[16:19], v[184:187], a[32:35], v[16:19]
    v_mfma_f32_16x16x32_bf16 v[20:23], v[188:191], a[32:35], v[20:23]
    ds_read_b128 a[0:3], v3 offset:16384
    s_add_u32 m0, s21, 65536
    v_mfma_f32_16x16x32_bf16 v[24:27], v[184:187], a[36:39], v[24:27]
    v_mfma_f32_16x16x32_bf16 v[28:31], v[188:191], a[36:39], v[28:31]
    ds_read_b128 a[4:7], v3 offset:18432
    s_add_u32 s64, s20, 0x480
    buffer_load_dwordx4 v2, s[4:7], s64 offen lds
    v_mfma_f32_16x16x32_bf16 v[32:35], v[184:187], a[40:43], v[32:35]
    v_mfma_f32_16x16x32_bf16 v[36:39], v[188:191], a[40:43], v[36:39]
    ds_read_b128 a[8:11], v3 offset:20480
    s_add_u32 m0, s21, 66560
    v_mfma_f32_16x16x32_bf16 v[40:43], v[184:187], a[44:47], v[40:43]
    v_mfma_f32_16x16x32_bf16 v[44:47], v[188:191], a[44:47], v[44:47]
    ds_read_b128 a[12:15], v3 offset:22528
    s_add_u32 s64, s20, 0x2c80
    buffer_load_dwordx4 v2, s[4:7], s64 offen lds
    s_waitcnt lgkmcnt(4)
    v_mfma_f32_16x16x32_bf16 v[48:51], v[184:187], a[48:51], v[48:51]
    v_mfma_f32_16x16x32_bf16 v[52:55], v[188:191], a[48:51], v[52:55]
    ds_read_b128 a[16:19], v3 offset:24576
    s_add_u32 m0, s21, 67584
    v_mfma_f32_16x16x32_bf16 v[56:59], v[184:187], a[52:55], v[56:59]
    v_mfma_f32_16x16x32_bf16 v[60:63], v[188:191], a[52:55], v[60:63]
    ds_read_b128 a[20:23], v3 offset:26624
    s_add_u32 s64, s20, 0x5480
    buffer_load_dwordx4 v2, s[4:7], s64 offen lds
    v_mfma_f32_16x16x32_bf16 v[64:67], v[184:187], a[56:59], v[64:67]
    v_mfma_f32_16x16x32_bf16 v[68:71], v[188:191], a[56:59], v[68:71]
    ds_read_b128 a[24:27], v3 offset:28672
    s_add_u32 m0, s21, 68608
    v_mfma_f32_16x16x32_bf16 v[72:75], v[184:187], a[60:63], v[72:75]
    v_mfma_f32_16x16x32_bf16 v[76:79], v[188:191], a[60:63], v[76:79]
    ds_read_b128 a[28:31], v3 offset:30720
    s_add_u32 s64, s20, 0x7c80
    buffer_load_dwordx4 v2, s[4:7], s64 offen lds
    s_waitcnt lgkmcnt(4)
    v_mfma_f32_16x16x32_bf16 v[16:19], v[192:195], a[0:3], v[16:19]
    v_mfma_f32_16x16x32_bf16 v[20:23], v[196:199], a[0:3], v[20:23]
    ds_read_b128 a[32:35], v4 offset:16384
    v_mfma_f32_16x16x32_bf16 v[24:27], v[192:195], a[4:7], v[24:27]
    v_mfma_f32_16x16x32_bf16 v[28:31], v[196:199], a[4:7], v[28:31]
    ds_read_b128 a[36:39], v4 offset:18432
    v_mfma_f32_16x16x32_bf16 v[32:35], v[192:195], a[8:11], v[32:35]
    v_mfma_f32_16x16x32_bf16 v[36:39], v[196:199], a[8:11], v[36:39]
    ds_read_b128 a[40:43], v4 offset:20480
    v_mfma_f32_16x16x32_bf16 v[40:43], v[192:195], a[12:15], v[40:43]
    v_mfma_f32_16x16x32_bf16 v[44:47], v[196:199], a[12:15], v[44:47]
    ds_read_b128 a[44:47], v4 offset:22528
    s_waitcnt lgkmcnt(4)
    v_mfma_f32_16x16x32_bf16 v[48:51], v[192:195], a[16:19], v[48:51]
    v_mfma_f32_16x16x32_bf16 v[52:55], v[196:199], a[16:19], v[52:55]
    ds_read_b128 a[48:51], v4 offset:24576
    v_mfma_f32_16x16x32_bf16 v[56:59], v[192:195], a[20:23], v[56:59]
    v_mfma_f32_16x16x32_bf16 v[60:63], v[196:199], a[20:23], v[60:63]
    ds_read_b128 a[52:55], v4 offset:26624
    v_mfma_f32_16x16x32_bf16 v[64:67], v[192:195], a[24:27], v[64:67]
    v_mfma_f32_16x16x32_bf16 v[68:71], v[196:199], a[24:27], v[68:71]
    ds_read_b128 a[56:59], v4 offset:28672
    v_mfma_f32_16x16x32_bf16 v[72:75], v[192:195], a[28:31], v[72:75]
    v_mfma_f32_16x16x32_bf16 v[76:79], v[196:199], a[28:31], v[76:79]
    ds_read_b128 a[60:63], v4 offset:30720
    s_waitcnt vmcnt(8)
    s_barrier
    s_waitcnt lgkmcnt(4)
    v_mfma_f32_16x16x32_bf16 v[16:19], v[200:203], a[32:35], v[16:19]
    v_mfma_f32_16x16x32_bf16 v[20:23], v[204:207], a[32:35], v[20:23]
    ds_read_b128 a[0:3], v3 offset:32768
    s_add_u32 m0, s21, 0
    v_mfma_f32_16x16x32_bf16 v[24:27], v[200:203], a[36:39], v[24:27]
    v_mfma_f32_16x16x32_bf16 v[28:31], v[204:207], a[36:39], v[28:31]
    ds_read_b128 a[4:7], v3 offset:34816
    s_add_u32 s64, s20, 0x50000
    buffer_load_dwordx4 v2, s[4:7], s64 offen lds
    v_mfma_f32_16x16x32_bf16 v[32:35], v[200:203], a[40:43], v[32:35]
    v_mfma_f32_16x16x32_bf16 v[36:39], v[204:207], a[40:43], v[36:39]
    ds_read_b128 a[8:11], v3 offset:36864
    s_add_u32 m0, s21, 1024
    v_mfma_f32_16x16x32_bf16 v[40:43], v[200:203], a[44:47], v[40:43]
    v_mfma_f32_16x16x32_bf16 v[44:47], v[204:207], a[44:47], v[44:47]
    ds_read_b128 a[12:15], v3 offset:38912
    s_add_u32 s64, s20, 0x52800
    buffer_load_dwordx4 v2, s[4:7], s64 offen lds
    s_waitcnt lgkmcnt(4)
    v_mfma_f32_16x16x32_bf16 v[48:51], v[200:203], a[48:51], v[48:51]
    v_mfma_f32_16x16x32_bf16 v[52:55], v[204:207], a[48:51], v[52:55]
    ds_read_b128 a[16:19], v3 offset:40960
    s_add_u32 m0, s21, 2048
    v_mfma_f32_16x16x32_bf16 v[56:59], v[200:203], a[52:55], v[56:59]
    v_mfma_f32_16x16x32_bf16 v[60:63], v[204:207], a[52:55], v[60:63]
    ds_read_b128 a[20:23], v3 offset:43008
    s_add_u32 s64, s20, 0x55000
    buffer_load_dwordx4 v2, s[4:7], s64 offen lds
    v_mfma_f32_16x16x32_bf16 v[64:67], v[200:203], a[56:59], v[64:67]
    v_mfma_f32_16x16x32_bf16 v[68:71], v[204:207], a[56:59], v[68:71]
    ds_read_b128 a[24:27], v3 offset:45056
    s_add_u32 m0, s21, 3072
    v_mfma_f32_16x16x32_bf16 v[72:75], v[200:203], a[60:63], v[72:75]
    v_mfma_f32_16x16x32_bf16 v[76:79], v[204:207], a[60:63], v[76:79]
    ds_read_b128 a[28:31], v3 offset:47104
    s_add_u32 s64, s20, 0x57800
    buffer_load_dwordx4 v2, s[4:7], s64 offen lds
    s_waitcnt lgkmcnt(4)
    v_mfma_f32_16x16x32_bf16 v[16:19], v[208:211], a[0:3], v[16:19]
    v_mfma_f32_16x16x32_bf16 v[20:23], v[212:215], a[0:3], v[20:23]
    ds_read_b128 a[32:35], v4 offset:32768
    v_mfma_f32_16x16x32_bf16 v[24:27], v[208:211], a[4:7], v[24:27]
    v_mfma_f32_16x16x32_bf16 v[28:31], v[212:215], a[4:7], v[28:31]
    ds_read_b128 a[36:39], v4 offset:34816
    v_mfma_f32_16x16x32_bf16 v[32:35], v[208:211], a[8:11], v[32:35]
    v_mfma_f32_16x16x32_bf16 v[36:39], v[212:215], a[8:11], v[36:39]
    ds_read_b128 a[40:43], v4 offset:36864
    v_mfma_f32_16x16x32_bf16 v[40:43], v[208:211], a[12:15], v[40:43]
    v_mfma_f32_16x16x32_bf16 v[44:47], v[212:215], a[12:15], v[44:47]
    ds_read_b128 a[44:47], v4 offset:38912
    s_waitcnt lgkmcnt(4)
    v_mfma_f32_16x16x32_bf16 v[48:51], v[208:211], a[16:19], v[48:51]
    v_mfma_f32_16x16x32_bf16 v[52:55], v[212:215], a[16:19], v[52:55]
    ds_read_b128 a[48:51], v4 offset:40960
    v_mfma_f32_16x16x32_bf16 v[56:59], v[208:211], a[20:23], v[56:59]
    v_mfma_f32_16x16x32_bf16 v[60:63], v[212:215], a[20:23], v[60:63]
    ds_read_b128 a[52:55], v4 offset:43008
    v_mfma_f32_16x16x32_bf16 v[64:67], v[208:211], a[24:27], v[64:67]
    v_mfma_f32_16x16x32_bf16 v[68:71], v[212:215], a[24:27], v[68:71]
    ds_read_b128 a[56:59], v4 offset:45056
    v_mfma_f32_16x16x32_bf16 v[72:75], v[208:211], a[28:31], v[72:75]
    v_mfma_f32_16x16x32_bf16 v[76:79], v[212:215], a[28:31], v[76:79]
    ds_read_b128 a[60:63], v4 offset:47104
    s_waitcnt vmcnt(8)
    s_barrier
    s_waitcnt lgkmcnt(4)
    v_mfma_f32_16x16x32_bf16 v[16:19], v[216:219], a[32:35], v[16:19]
    v_mfma_f32_16x16x32_bf16 v[20:23], v[220:223], a[32:35], v[20:23]
    ds_read_b128 a[0:3], v3 offset:49152
    s_add_u32 m0, s21, 16384
    v_mfma_f32_16x16x32_bf16 v[24:27], v[216:219], a[36:39], v[24:27]
    v_mfma_f32_16x16x32_bf16 v[28:31], v[220:223], a[36:39], v[28:31]
    ds_read_b128 a[4:7], v3 offset:51200
    s_add_u32 s64, s20, 0x50080
    buffer_load_dwordx4 v2, s[4:7], s64 offen lds
    v_mfma_f32_16x16x32_bf16 v[32:35], v[216:219], a[40:43], v[32:35]
    v_mfma_f32_16x16x32_bf16 v[36:39], v[220:223], a[40:43], v[36:39]
    ds_read_b128 a[8:11], v3 offset:53248
    s_add_u32 m0, s21, 17408
    v_mfma_f32_16x16x32_bf16 v[40:43], v[216:219], a[44:47], v[40:43]
    v_mfma_f32_16x16x32_bf16 v[44:47], v[220:223], a[44:47], v[44:47]
    ds_read_b128 a[12:15], v3 offset:55296
    s_add_u32 s64, s20, 0x52880
    buffer_load_dwordx4 v2, s[4:7], s64 offen lds
    s_waitcnt lgkmcnt(4)
    v_mfma_f32_16x16x32_bf16 v[48:51], v[216:219], a[48:51], v[48:51]
    v_mfma_f32_16x16x32_bf16 v[52:55], v[220:223], a[48:51], v[52:55]
    ds_read_b128 a[16:19], v3 offset:57344
    s_add_u32 m0, s21, 18432
    v_mfma_f32_16x16x32_bf16 v[56:59], v[216:219], a[52:55], v[56:59]
    v_mfma_f32_16x16x32_bf16 v[60:63], v[220:223], a[52:55], v[60:63]
    ds_read_b128 a[20:23], v3 offset:59392
    s_add_u32 s64, s20, 0x55080
    buffer_load_dwordx4 v2, s[4:7], s64 offen lds
    v_mfma_f32_16x16x32_bf16 v[64:67], v[216:219], a[56:59], v[64:67]
    v_mfma_f32_16x16x32_bf16 v[68:71], v[220:223], a[56:59], v[68:71]
    ds_read_b128 a[24:27], v3 offset:61440
    s_add_u32 m0, s21, 19456
    v_mfma_f32_16x16x32_bf16 v[72:75], v[216:219], a[60:63], v[72:75]
    v_mfma_f32_16x16x32_bf16 v[76:79], v[220:223], a[60:63], v[76:79]
    ds_read_b128 a[28:31], v3 offset:63488
    s_add_u32 s64, s20, 0x57880
    buffer_load_dwordx4 v2, s[4:7], s64 offen lds
    s_waitcnt lgkmcnt(4)
    v_mfma_f32_16x16x32_bf16 v[16:19], v[224:227], a[0:3], v[16:19]
    v_mfma_f32_16x16x32_bf16 v[20:23], v[228:231], a[0:3], v[20:23]
    ds_read_b128 a[32:35], v4 offset:49152
    v_mfma_f32_16x16x32_bf16 v[24:27], v[224:227], a[4:7], v[24:27]
    v_mfma_f32_16x16x32_bf16 v[28:31], v[228:231], a[4:7], v[28:31]
    ds_read_b128 a[36:39], v4 offset:51200
    v_mfma_f32_16x16x32_bf16 v[32:35], v[224:227], a[8:11], v[32:35]
    v_mfma_f32_16x16x32_bf16 v[36:39], v[228:231], a[8:11], v[36:39]
    ds_read_b128 a[40:43], v4 offset:53248
    v_mfma_f32_16x16x32_bf16 v[40:43], v[224:227], a[12:15], v[40:43]
    v_mfma_f32_16x16x32_bf16 v[44:47], v[228:231], a[12:15], v[44:47]
    ds_read_b128 a[44:47], v4 offset:55296
    s_waitcnt lgkmcnt(4)
    v_mfma_f32_16x16x32_bf16 v[48:51], v[224:227], a[16:19], v[48:51]
    v_mfma_f32_16x16x32_bf16 v[52:55], v[228:231], a[16:19], v[52:55]
    ds_read_b128 a[48:51], v4 offset:57344
    v_mfma_f32_16x16x32_bf16 v[56:59], v[224:227], a[20:23], v[56:59]
    v_mfma_f32_16x16x32_bf16 v[60:63], v[228:231], a[20:23], v[60:63]
    ds_read_b128 a[52:55], v4 offset:59392
    v_mfma_f32_16x16x32_bf16 v[64:67], v[224:227], a[24:27], v[64:67]
    v_mfma_f32_16x16x32_bf16 v[68:71], v[228:231], a[24:27], v[68:71]
    ds_read_b128 a[56:59], v4 offset:61440
    v_mfma_f32_16x16x32_bf16 v[72:75], v[224:227], a[28:31], v[72:75]
    v_mfma_f32_16x16x32_bf16 v[76:79], v[228:231], a[28:31], v[76:79]
    ds_read_b128 a[60:63], v4 offset:63488
    s_waitcnt vmcnt(8)
    s_barrier
    s_waitcnt lgkmcnt(4)
    v_mfma_f32_16x16x32_bf16 v[16:19], v[232:235], a[32:35], v[16:19]
    v_mfma_f32_16x16x32_bf16 v[20:23], v[236:239], a[32:35], v[20:23]
    ds_read_b128 a[0:3], v6 offset:0
    s_add_u32 m0, s21, 32768
    v_mfma_f32_16x16x32_bf16 v[24:27], v[232:235], a[36:39], v[24:27]
    v_mfma_f32_16x16x32_bf16 v[28:31], v[236:239], a[36:39], v[28:31]
    ds_read_b128 a[4:7], v6 offset:2048
    s_add_u32 s64, s20, 0x50100
    buffer_load_dwordx4 v2, s[4:7], s64 offen lds
    v_mfma_f32_16x16x32_bf16 v[32:35], v[232:235], a[40:43], v[32:35]
    v_mfma_f32_16x16x32_bf16 v[36:39], v[236:239], a[40:43], v[36:39]
    ds_read_b128 a[8:11], v6 offset:4096
    s_add_u32 m0, s21, 33792
    v_mfma_f32_16x16x32_bf16 v[40:43], v[232:235], a[44:47], v[40:43]
    v_mfma_f32_16x16x32_bf16 v[44:47], v[236:239], a[44:47], v[44:47]
    ds_read_b128 a[12:15], v6 offset:6144
    s_add_u32 s64, s20, 0x52900
    buffer_load_dwordx4 v2, s[4:7], s64 offen lds
    s_waitcnt lgkmcnt(4)
    v_mfma_f32_16x16x32_bf16 v[48:51], v[232:235], a[48:51], v[48:51]
    v_mfma_f32_16x16x32_bf16 v[52:55], v[236:239], a[48:51], v[52:55]
    ds_read_b128 a[16:19], v6 offset:8192
    s_add_u32 m0, s21, 34816
    v_mfma_f32_16x16x32_bf16 v[56:59], v[232:235], a[52:55], v[56:59]
    v_mfma_f32_16x16x32_bf16 v[60:63], v[236:239], a[52:55], v[60:63]
    ds_read_b128 a[20:23], v6 offset:10240
    s_add_u32 s64, s20, 0x55100
    buffer_load_dwordx4 v2, s[4:7], s64 offen lds
    v_mfma_f32_16x16x32_bf16 v[64:67], v[232:235], a[56:59], v[64:67]
    v_mfma_f32_16x16x32_bf16 v[68:71], v[236:239], a[56:59], v[68:71]
    ds_read_b128 a[24:27], v6 offset:12288
    s_add_u32 m0, s21, 35840
    v_mfma_f32_16x16x32_bf16 v[72:75], v[232:235], a[60:63], v[72:75]
    v_mfma_f32_16x16x32_bf16 v[76:79], v[236:239], a[60:63], v[76:79]
    ds_read_b128 a[28:31], v6 offset:14336
    s_add_u32 s64, s20, 0x57900
    buffer_load_dwordx4 v2, s[4:7], s64 offen lds
    s_waitcnt lgkmcnt(4)
    v_mfma_f32_16x16x32_bf16 v[16:19], v[240:243], a[0:3], v[16:19]
    v_mfma_f32_16x16x32_bf16 v[20:23], v[244:247], a[0:3], v[20:23]
    ds_read_b128 a[32:35], v9 offset:0
    v_mfma_f32_16x16x32_bf16 v[24:27], v[240:243], a[4:7], v[24:27]
    v_mfma_f32_16x16x32_bf16 v[28:31], v[244:247], a[4:7], v[28:31]
    ds_read_b128 a[36:39], v9 offset:2048
    v_mfma_f32_16x16x32_bf16 v[32:35], v[240:243], a[8:11], v[32:35]
    v_mfma_f32_16x16x32_bf16 v[36:39], v[244:247], a[8:11], v[36:39]
    ds_read_b128 a[40:43], v9 offset:4096
    v_mfma_f32_16x16x32_bf16 v[40:43], v[240:243], a[12:15], v[40:43]
    v_mfma_f32_16x16x32_bf16 v[44:47], v[244:247], a[12:15], v[44:47]
    ds_read_b128 a[44:47], v9 offset:6144
    s_waitcnt lgkmcnt(4)
    v_mfma_f32_16x16x32_bf16 v[48:51], v[240:243], a[16:19], v[48:51]
    v_mfma_f32_16x16x32_bf16 v[52:55], v[244:247], a[16:19], v[52:55]
    ds_read_b128 a[48:51], v9 offset:8192
    v_mfma_f32_16x16x32_bf16 v[56:59], v[240:243], a[20:23], v[56:59]
    v_mfma_f32_16x16x32_bf16 v[60:63], v[244:247], a[20:23], v[60:63]
    ds_read_b128 a[52:55], v9 offset:10240
    v_mfma_f32_16x16x32_bf16 v[64:67], v[240:243], a[24:27], v[64:67]
    v_mfma_f32_16x16x32_bf16 v[68:71], v[244:247], a[24:27], v[68:71]
    ds_read_b128 a[56:59], v9 offset:12288
    v_mfma_f32_16x16x32_bf16 v[72:75], v[240:243], a[28:31], v[72:75]
    v_mfma_f32_16x16x32_bf16 v[76:79], v[244:247], a[28:31], v[76:79]
    ds_read_b128 a[60:63], v9 offset:14336
    s_waitcnt vmcnt(8)
    s_barrier
    s_waitcnt lgkmcnt(4)
    v_mfma_f32_16x16x32_bf16 v[16:19], v[248:251], a[32:35], v[16:19]
    v_mfma_f32_16x16x32_bf16 v[20:23], v[252:255], a[32:35], v[20:23]
    ds_read_b128 a[0:3], v3 offset:0
    s_add_u32 m0, s21, 49152
    v_mfma_f32_16x16x32_bf16 v[24:27], v[248:251], a[36:39], v[24:27]
    v_mfma_f32_16x16x32_bf16 v[28:31], v[252:255], a[36:39], v[28:31]
    ds_read_b128 a[4:7], v3 offset:2048
    s_add_u32 s64, s20, 0x50180
    buffer_load_dwordx4 v2, s[4:7], s64 offen lds
    v_mfma_f32_16x16x32_bf16 v[32:35], v[248:251], a[40:43], v[32:35]
    v_mfma_f32_16x16x32_bf16 v[36:39], v[252:255], a[40:43], v[36:39]
    ds_read_b128 a[8:11], v3 offset:4096
    s_add_u32 m0, s21, 50176
    v_mfma_f32_16x16x32_bf16 v[40:43], v[248:251], a[44:47], v[40:43]
    v_mfma_f32_16x16x32_bf16 v[44:47], v[252:255], a[44:47], v[44:47]
    ds_read_b128 a[12:15], v3 offset:6144
    s_add_u32 s64, s20, 0x52980
    buffer_load_dwordx4 v2, s[4:7], s64 offen lds
    s_waitcnt lgkmcnt(4)
    v_mfma_f32_16x16x32_bf16 v[48:51], v[248:251], a[48:51], v[48:51]
    v_mfma_f32_16x16x32_bf16 v[52:55], v[252:255], a[48:51], v[52:55]
    ds_read_b128 a[16:19], v3 offset:8192
    s_add_u32 m0, s21, 51200
    v_mfma_f32_16x16x32_bf16 v[56:59], v[248:251], a[52:55], v[56:59]
    v_mfma_f32_16x16x32_bf16 v[60:63], v[252:255], a[52:55], v[60:63]
    ds_read_b128 a[20:23], v3 offset:10240
    s_add_u32 s64, s20, 0x55180
    buffer_load_dwordx4 v2, s[4:7], s64 offen lds
    v_mfma_f32_16x16x32_bf16 v[64:67], v[248:251], a[56:59], v[64:67]
    v_mfma_f32_16x16x32_bf16 v[68:71], v[252:255], a[56:59], v[68:71]
    ds_read_b128 a[24:27], v3 offset:12288
    s_add_u32 m0, s21, 52224
    v_mfma_f32_16x16x32_bf16 v[72:75], v[248:251], a[60:63], v[72:75]
    v_mfma_f32_16x16x32_bf16 v[76:79], v[252:255], a[60:63], v[76:79]
    ds_read_b128 a[28:31], v3 offset:14336
    s_add_u32 s64, s20, 0x57980
    buffer_load_dwordx4 v2, s[4:7], s64 offen lds
    s_nop 5
    s_mul_i32 s65, s17, 0
    s_add_u32 s65, s65, s22
    s_add_u32 s64, s65, 0
    v_cvt_pk_bf16_f32 v80, v16, v17
    v_cvt_pk_bf16_f32 v81, v18, v19
    v_cvt_pk_bf16_f32 v82, v20, v21
    v_cvt_pk_bf16_f32 v83, v22, v23
    buffer_store_dwordx4 v[80:83], v1, s[4:7], s64 offen sc1
    s_add_u32 s64, s65, 4096
    v_cvt_pk_bf16_f32 v84, v24, v25
    v_cvt_pk_bf16_f32 v85, v26, v27
    v_cvt_pk_bf16_f32 v86, v28, v29
    v_cvt_pk_bf16_f32 v87, v30, v31
    buffer_store_dwordx4 v[84:87], v1, s[4:7], s64 offen sc1
    s_mul_i32 s65, s17, 1
    s_add_u32 s65, s65, s22
    s_add_u32 s64, s65, 0
    v_cvt_pk_bf16_f32 v88, v32, v33
    v_cvt_pk_bf16_f32 v89, v34, v35
    v_cvt_pk_bf16_f32 v90, v36, v37
    v_cvt_pk_bf16_f32 v91, v38, v39
    buffer_store_dwordx4 v[88:91], v1, s[4:7], s64 offen sc1
    s_add_u32 s64, s65, 4096
    v_cvt_pk_bf16_f32 v92, v40, v41
    v_cvt_pk_bf16_f32 v93, v42, v43
    v_cvt_pk_bf16_f32 v94, v44, v45
    v_cvt_pk_bf16_f32 v95, v46, v47
    buffer_store_dwordx4 v[92:95], v1, s[4:7], s64 offen sc1
    s_mul_i32 s65, s17, 2
    s_add_u32 s65, s65, s22
    s_add_u32 s64, s65, 0
    v_cvt_pk_bf16_f32 v80, v48, v49
    v_cvt_pk_bf16_f32 v81, v50, v51
    v_cvt_pk_bf16_f32 v82, v52, v53
    v_cvt_pk_bf16_f32 v83, v54, v55
    buffer_store_dwordx4 v[80:83], v1, s[4:7], s64 offen sc1
    s_add_u32 s64, s65, 4096
    v_cvt_pk_bf16_f32 v84, v56, v57
    v_cvt_pk_bf16_f32 v85, v58, v59
    v_cvt_pk_bf16_f32 v86, v60, v61
    v_cvt_pk_bf16_f32 v87, v62, v63
    buffer_store_dwordx4 v[84:87], v1, s[4:7], s64 offen sc1
    s_mul_i32 s65, s17, 3
    s_add_u32 s65, s65, s22
    s_add_u32 s64, s65, 0
    v_cvt_pk_bf16_f32 v88, v64, v65
    v_cvt_pk_bf16_f32 v89, v66, v67
    v_cvt_pk_bf16_f32 v90, v68, v69
    v_cvt_pk_bf16_f32 v91, v70, v71
    buffer_store_dwordx4 v[88:91], v1, s[4:7], s64 offen sc1
    s_add_u32 s64, s65, 4096
    v_cvt_pk_bf16_f32 v92, v72, v73
    v_cvt_pk_bf16_f32 v93, v74, v75
    v_cvt_pk_bf16_f32 v94, v76, v77
    v_cvt_pk_bf16_f32 v95, v78, v79
    buffer_store_dwordx4 v[92:95], v1, s[4:7], s64 offen sc1
    s_lshl_b32 s64, s19, 1
    s_add_u32 s64, s64, s12
    s_lshl_b32 s64, s64, 9
    s_add_u32 s23, s18, s64
    s_lshl_b32 s64, s17, 3
    s_add_u32 s22, s22, s64
    s_add_u32 s19, s19, 1
    s_add_u32 s20, s20, 0x50000
    s_cmp_lg_u32 s19, 1
    s_cbranch_scc1 GE0_120
    s_waitcnt vmcnt(0)
    s_barrier
    s_cmp_lg_u32 s14, 0
    s_cbranch_scc1 GF_121
    v_mov_b32 v7, 1
    v_mov_b32 v8, 0
    s_mov_b64 exec, 1
    buffer_store_dword v7, v8, s[4:7], s23 offen sc1
    s_mov_b64 exec, -1
GF_121:
GE0_120:
    s_cmp_lt_u32 s19, 8
    s_cbranch_scc1 G_T_LOOP
    s_waitcnt vmcnt(0) lgkmcnt(0)
    s_barrier
    s_cmp_lg_u32 s14, 0
    s_cbranch_scc1 GF_122
    v_mov_b32 v7, 1
    v_mov_b32 v8, 0
    s_mov_b64 exec, 1
    buffer_store_dword v7, v8, s[4:7], s23 offen sc1
    s_mov_b64 exec, -1
GF_122:
    s_cmp_eq_u32 s3, 2
    s_cbranch_scc1 H_Q
    s_cmp_eq_u32 s12, 1
    s_cbranch_scc1 H_OUT
    s_lshl_b32 s88, s3, 5
    s_add_u32 s88, s88, s13
    s_mov_b32 s29, 0
    v_lshlrev_b32 v1, 4, v0
    s_mov_b32 s65, 0
CW_123:
    buffer_load_dwordx2 v[8:9], off, s[60:63], 0 offset:132 sc1
    s_add_u32 s65, s65, 1
    s_waitcnt vmcnt(0)
    v_readfirstlane_b32 s66, v8
    v_readfirstlane_b32 s67, v9
    s_min_u32 s64, s66, s67
    s_cmp_lg_u32 s64, 0
    s_cbranch_scc1 CWD_124
    s_cmp_gt_u32 s65, 65536
    s_cbranch_scc1 CWD_124
    s_sleep 4
    s_branch CW_123
CWD_124:
    s_sub_u32 s66, s66, 1
    s_and_b32 s66, s66, 3
    s_sub_u32 s67, s67, 1
    s_and_b32 s67, s67, 3
    s_mov_b32 s64, s66
    s_mov_b32 s65, s67
    s_and_b32 s64, s64, 3
    s_lshl_b32 s64, s64, 13
    s_and_b32 s65, s65, 3
    s_lshl_b32 s65, s65, 13
    s_add_u32 s25, s64, 0x6000000
    s_add_u32 s30, s65, 0x6200000
    v_bfe_u32 v4, v0, 3, 1
    v_mul_u32_u24 v2, 0x8000, v4
    v_lshrrev_b32 v4, 5, v0
    v_lshl_add_u32 v2, v4, 8, v2
    v_bfe_u32 v4, v0, 4, 1
    v_lshl_add_u32 v2, v4, 7, v2
    v_and_b32 v4, 7, v0
    v_lshl_add_u32 v2, v4, 4, v2
    v_bfe_u32 v4, v0, 3, 1
    v_lshlrev_b32 v3, 16, v4
    v_lshrrev_b32 v4, 4, v0
    v_lshl_add_u32 v3, v4, 7, v3
    v_and_b32 v4, 7, v0
    v_lshl_add_u32 v3, v4, 4, v3
    s_lshl_b32 s26, s13, 11
    s_lshl_b32 s64, s14, 9
    s_add_u32 s26, s26, s64
    s_add_u32 s26, s26, 0x640000
    s_lshl_b32 s27, s13, 3
    s_add_u32 s27, s27, 0x294000
    s_mov_b32 s28, 0x29a000
    s_mov_b32 s24, 0
    v_lshlrev_b32 v6, 7, v0
MKT_LOOP:
    s_cmp_lg_u32 s24, 10
    s_cbranch_scc1 MKH_125
    v_mov_b32 v10, v2
    v_mov_b32 v11, v3
    s_cmp_ge_u32 s88, 60
    s_cbranch_scc1 NOWO_126
    s_mov_b32 s89, s13
    s_mul_hi_u32 s65, s88, 0xccccccd
    s_mul_i32 s65, s65, 20
    s_sub_u32 s13, s88, s65
    s_load_dwordx2 s[44:45], s[0:1], 40
    s_mov_b32 s46, 0x500000
    s_mov_b32 s47, 0x00020000
    s_waitcnt lgkmcnt(0)
    s_mul_i32 s21, s14, 36864
    v_lshrrev_b32 v7, 2, v0
    v_mul_u32_u24 v4, 1280, v7
    v_bfe_u32 v7, v0, 4, 1
    v_lshlrev_b32 v7, 1, v7
    v_and_b32 v8, 3, v0
    v_xor_b32 v7, v7, v8
    v_lshl_add_u32 v4, v7, 4, v4
    v_lshrrev_b32 v7, 4, v0
    v_lshlrev_b32 v2, 8, v7
    v_bfe_u32 v7, v0, 2, 2
    v_lshl_add_u32 v2, v7, 6, v2
    v_and_b32 v7, 3, v0
    v_lshl_add_u32 v2, v7, 3, v2
    v_add_u32 v2, s21, v2
    v_bfe_u32 v7, v0, 4, 1
    v_lshlrev_b32 v7, 5, v7
    v_sub_u32 v3, 32, v7
    v_add_u32 v3, v3, v2
    v_add_u32 v2, v2, v7
    s_mul_i32 s65, s14, 1310720
    s_lshl_b32 s66, s13, 6
    s_add_u32 s65, s65, s66
    s_add_u32 m0, s21, 0
    s_add_u32 s64, s65, 0x0
    buffer_load_dwordx4 v4, s[44:47], s64 offen lds
    s_add_u32 m0, s21, 1024
    s_add_u32 s64, s65, 0x5000
    buffer_load_dwordx4 v4, s[44:47], s64 offen lds
    s_add_u32 m0, s21, 2048
    s_add_u32 s64, s65, 0xa000
    buffer_load_dwordx4 v4, s[44:47], s64 offen lds
    s_add_u32 m0, s21, 3072
    s_add_u32 s64, s65, 0xf000
    buffer_load_dwordx4 v4, s[44:47], s64 offen lds
    s_add_u32 m0, s21, 4096
    s_add_u32 s64, s65, 0x14000
    buffer_load_dwordx4 v4, s[44:47], s64 offen lds
    s_add_u32 m0, s21, 5120
    s_add_u32 s64, s65, 0x19000
    buffer_load_dwordx4 v4, s[44:47], s64 offen lds
    s_add_u32 m0, s21, 6144
    s_add_u32 s64, s65, 0x1e000
    buffer_load_dwordx4 v4, s[44:47], s64 offen lds
    s_add_u32 m0, s21, 7168
    s_add_u32 s64, s65, 0x23000
    buffer_load_dwordx4 v4, s[44:47], s64 offen lds
    s_add_u32 m0, s21, 8192
    s_add_u32 s64, s65, 0x28000
    buffer_load_dwordx4 v4, s[44:47], s64 offen lds
    s_add_u32 m0, s21, 9216
    s_add_u32 s64, s65, 0x2d000
    buffer_load_dwordx4 v4, s[44:47], s64 offen lds
    s_add_u32 m0, s21, 10240
    s_add_u32 s64, s65, 0x32000
    buffer_load_dwordx4 v4, s[44:47], s64 offen lds
    s_add_u32 m0, s21, 11264
    s_add_u32 s64, s65, 0x37000
    buffer_load_dwordx4 v4, s[44:47], s64 offen lds
    s_add_u32 m0, s21, 12288
    s_add_u32 s64, s65, 0x3c000
    buffer_load_dwordx4 v4, s[44:47], s64 offen lds
    s_add_u32 m0, s21, 13312
    s_add_u32 s64, s65, 0x41000
    buffer_load_dwordx4 v4, s[44:47], s64 offen lds
    s_add_u32 m0, s21, 14336
    s_add_u32 s64, s65, 0x46000
    buffer_load_dwordx4 v4, s[44:47], s64 offen lds
    s_add_u32 m0, s21, 15360
    s_add_u32 s64, s65, 0x4b000
    buffer_load_dwordx4 v4, s[44:47], s64 offen lds
    s_add_u32 m0, s21, 16384
    s_add_u32 s64, s65, 0x50000
    buffer_load_dwordx4 v4, s[44:47], s64 offen lds
    s_add_u32 m0, s21, 17408
    s_add_u32 s64, s65, 0x55000
    buffer_load_dwordx4 v4, s[44:47], s64 offen lds
    s_add_u32 m0, s21, 18432
    s_add_u32 s64, s65, 0x5a000
    buffer_load_dwordx4 v4, s[44:47], s64 offen lds
    s_add_u32 m0, s21, 19456
    s_add_u32 s64, s65, 0x5f000
    buffer_load_dwordx4 v4, s[44:47], s64 offen lds
    s_add_u32 m0, s21, 20480
    s_add_u32 s64, s65, 0x64000
    buffer_load_dwordx4 v4, s[44:47], s64 offen lds
    s_add_u32 m0, s21, 21504
    s_add_u32 s64, s65, 0x69000
    buffer_load_dwordx4 v4, s[44:47], s64 offen lds
    s_add_u32 m0, s21, 22528
    s_add_u32 s64, s65, 0x6e000
    buffer_load_dwordx4 v4, s[44:47], s64 offen lds
    s_add_u32 m0, s21, 23552
    s_add_u32 s64, s65, 0x73000
    buffer_load_dwordx4 v4, s[44:47], s64 offen lds
    s_add_u32 m0, s21, 24576
    s_add_u32 s64, s65, 0x78000
    buffer_load_dwordx4 v4, s[44:47], s64 offen lds
    s_add_u32 m0, s21, 25600
    s_add_u32 s64, s65, 0x7d000
    buffer_load_dwordx4 v4, s[44:47], s64 offen lds
    s_add_u32 m0, s21, 26624
    s_add_u32 s64, s65, 0x82000
    buffer_load_dwordx4 v4, s[44:47], s64 offen lds
    s_add_u32 m0, s21, 27648
    s_add_u32 s64, s65, 0x87000
    buffer_load_dwordx4 v4, s[44:47], s64 offen lds
    s_add_u32 m0, s21, 28672
    s_add_u32 s64, s65, 0x8c000
    buffer_load_dwordx4 v4, s[44:47], s64 offen lds
    s_add_u32 m0, s21, 29696
    s_add_u32 s64, s65, 0x91000
    buffer_load_dwordx4 v4, s[44:47], s64 offen lds
    s_add_u32 m0, s21, 30720
    s_add_u32 s64, s65, 0x96000
    buffer_load_dwordx4 v4, s[44:47], s64 offen lds
    s_add_u32 m0, s21, 31744
    s_add_u32 s64, s65, 0x9b000
    buffer_load_dwordx4 v4, s[44:47], s64 offen lds
    s_add_u32 m0, s21, 32768
    s_add_u32 s64, s65, 0xa0000
    buffer_load_dwordx4 v4, s[44:47], s64 offen lds
    s_add_u32 m0, s21, 33792
    s_add_u32 s64, s65, 0xa5000
    buffer_load_dwordx4 v4, s[44:47], s64 offen lds
    s_add_u32 m0, s21, 34816
    s_add_u32 s64, s65, 0xaa000
    buffer_load_dwordx4 v4, s[44:47], s64 offen lds
    s_add_u32 m0, s21, 35840
    s_add_u32 s64, s65, 0xaf000
    buffer_load_dwordx4 v4, s[44:47], s64 offen lds
    s_waitcnt vmcnt(32)
    ds_read_b64_tr_b16 a[0:1], v2 offset:0
    ds_read_b64_tr_b16 a[2:3], v2 offset:1024
    ds_read_b64_tr_b16 a[4:5], v3 offset:0
    ds_read_b64_tr_b16 a[6:7], v3 offset:1024
    ds_read_b64_tr_b16 a[8:9], v2 offset:2048
    ds_read_b64_tr_b16 a[10:11], v2 offset:3072
    ds_read_b64_tr_b16 a[12:13], v3 offset:2048
    ds_read_b64_tr_b16 a[14:15], v3 offset:3072
    s_waitcnt lgkmcnt(0)
    s_add_u32 m0, s21, 0
    s_add_u32 s64, s65, 0xb4000
    buffer_load_dwordx4 v4, s[44:47], s64 offen lds
    s_add_u32 m0, s21, 1024
    s_add_u32 s64, s65, 0xb9000
    buffer_load_dwordx4 v4, s[44:47], s64 offen lds
    s_add_u32 m0, s21, 2048
    s_add_u32 s64, s65, 0xbe000
    buffer_load_dwordx4 v4, s[44:47], s64 offen lds
    s_add_u32 m0, s21, 3072
    s_add_u32 s64, s65, 0xc3000
    buffer_load_dwordx4 v4, s[44:47], s64 offen lds
    s_waitcnt vmcnt(32)
    ds_read_b64_tr_b16 a[16:17], v2 offset:4096
    ds_read_b64_tr_b16 a[18:19], v2 offset:5120
    ds_read_b64_tr_b16 a[20:21], v3 offset:4096
    ds_read_b64_tr_b16 a[22:23], v3 offset:5120
    ds_read_b64_tr_b16 a[24:25], v2 offset:6144
    ds_read_b64_tr_b16 a[26:27], v2 offset:7168
    ds_read_b64_tr_b16 a[28:29], v3 offset:6144
    ds_read_b64_tr_b16 a[30:31], v3 offset:7168
    s_waitcnt lgkmcnt(0)
    s_add_u32 m0, s21, 4096
    s_add_u32 s64, s65, 0xc8000
    buffer_load_dwordx4 v4, s[44:47], s64 offen lds
    s_add_u32 m0, s21, 5120
    s_add_u32 s64, s65, 0xcd000
    buffer_load_dwordx4 v4, s[44:47], s64 offen lds
    s_add_u32 m0, s21, 6144
    s_add_u32 s64, s65, 0xd2000
    buffer_load_dwordx4 v4, s[44:47], s64 offen lds
    s_add_u32 m0, s21, 7168
    s_add_u32 s64, s65, 0xd7000
    buffer_load_dwordx4 v4, s[44:47], s64 offen lds
    s_waitcnt vmcnt(32)
    ds_read_b64_tr_b16 a[32:33], v2 offset:8192
    ds_read_b64_tr_b16 a[34:35], v2 offset:9216
    ds_read_b64_tr_b16 a[36:37], v3 offset:8192
    ds_read_b64_tr_b16 a[38:39], v3 offset:9216
    ds_read_b64_tr_b16 a[40:41], v2 offset:10240
    ds_read_b64_tr_b16 a[42:43], v2 offset:11264
    ds_read_b64_tr_b16 a[44:45], v3 offset:10240
    ds_read_b64_tr_b16 a[46:47], v3 offset:11264
    s_waitcnt lgkmcnt(0)
    s_add_u32 m0, s21, 8192
    s_add_u32 s64, s65, 0xdc000
    buffer_load_dwordx4 v4, s[44:47], s64 offen lds
    s_add_u32 m0, s21, 9216
    s_add_u32 s64, s65, 0xe1000
    buffer_load_dwordx4 v4, s[44:47], s64 offen lds
    s_add_u32 m0, s21, 10240
    s_add_u32 s64, s65, 0xe6000
    buffer_load_dwordx4 v4, s[44:47], s64 offen lds
    s_add_u32 m0, s21, 11264
    s_add_u32 s64, s65, 0xeb000
    buffer_load_dwordx4 v4, s[44:47], s64 offen lds
    s_waitcnt vmcnt(32)
    ds_read_b64_tr_b16 a[48:49], v2 offset:12288
    ds_read_b64_tr_b16 a[50:51], v2 offset:13312
    ds_read_b64_tr_b16 a[52:53], v3 offset:12288
    ds_read_b64_tr_b16 a[54:55], v3 offset:13312
    ds_read_b64_tr_b16 a[56:57], v2 offset:14336
    ds_read_b64_tr_b16 a[58:59], v2 offset:15360
    ds_read_b64_tr_b16 a[60:61], v3 offset:14336
    ds_read_b64_tr_b16 a[62:63], v3 offset:15360
    s_waitcnt lgkmcnt(0)
    s_add_u32 m0, s21, 12288
    s_add_u32 s64, s65, 0xf0000
    buffer_load_dwordx4 v4, s[44:47], s64 offen lds
    s_add_u32 m0, s21, 13312
    s_add_u32 s64, s65, 0xf5000
    buffer_load_dwordx4 v4, s[44:47], s64 offen lds
    s_add_u32 m0, s21, 14336
    s_add_u32 s64, s65, 0xfa000
    buffer_load_dwordx4 v4, s[44:47], s64 offen lds
    s_add_u32 m0, s21, 15360
    s_add_u32 s64, s65, 0xff000
    buffer_load_dwordx4 v4, s[44:47], s64 offen lds
    s_waitcnt vmcnt(32)
    ds_read_b64_tr_b16 a[64:65], v2 offset:16384
    ds_read_b64_tr_b16 a[66:67], v2 offset:17408
    ds_read_b64_tr_b16 a[68:69], v3 offset:16384
    ds_read_b64_tr_b16 a[70:71], v3 offset:17408
    ds_read_b64_tr_b16 a[72:73], v2 offset:18432
    ds_read_b64_tr_b16 a[74:75], v2 offset:19456
    ds_read_b64_tr_b16 a[76:77], v3 offset:18432
    ds_read_b64_tr_b16 a[78:79], v3 offset:19456
    s_waitcnt lgkmcnt(0)
    s_add_u32 m0, s21, 16384
    s_add_u32 s64, s65, 0x104000
    buffer_load_dwordx4 v4, s[44:47], s64 offen lds
    s_add_u32 m0, s21, 17408
    s_add_u32 s64, s65, 0x109000
    buffer_load_dwordx4 v4, s[44:47], s64 offen lds
    s_add_u32 m0, s21, 18432
    s_add_u32 s64, s65, 0x10e000
    buffer_load_dwordx4 v4, s[44:47], s64 offen lds
    s_add_u32 m0, s21, 19456
    s_add_u32 s64, s65, 0x113000
    buffer_load_dwordx4 v4, s[44:47], s64 offen lds
    s_waitcnt vmcnt(32)
    ds_read_b64_tr_b16 a[80:81], v2 offset:20480
    ds_read_b64_tr_b16 a[82:83], v2 offset:21504
    ds_read_b64_tr_b16 a[84:85], v3 offset:20480
    ds_read_b64_tr_b16 a[86:87], v3 offset:21504
    ds_read_b64_tr_b16 a[88:89], v2 offset:22528
    ds_read_b64_tr_b16 a[90:91], v2 offset:23552
    ds_read_b64_tr_b16 a[92:93], v3 offset:22528
    ds_read_b64_tr_b16 a[94:95], v3 offset:23552
    s_waitcnt lgkmcnt(0)
    s_add_u32 m0, s21, 20480
    s_add_u32 s64, s65, 0x118000
    buffer_load_dwordx4 v4, s[44:47], s64 offen lds
    s_add_u32 m0, s21, 21504
    s_add_u32 s64, s65, 0x11d000
    buffer_load_dwordx4 v4, s[44:47], s64 offen lds
    s_add_u32 m0, s21, 22528
    s_add_u32 s64, s65, 0x122000
    buffer_load_dwordx4 v4, s[44:47], s64 offen lds
    s_add_u32 m0, s21, 23552
    s_add_u32 s64, s65, 0x127000
    buffer_load_dwordx4 v4, s[44:47], s64 offen lds
    s_waitcnt vmcnt(32)
    ds_read_b64_tr_b16 a[96:97], v2 offset:24576
    ds_read_b64_tr_b16 a[98:99], v2 offset:25600
    ds_read_b64_tr_b16 a[100:101], v3 offset:24576
    ds_read_b64_tr_b16 a[102:103], v3 offset:25600
    ds_read_b64_tr_b16 a[104:105], v2 offset:26624
    ds_read_b64_tr_b16 a[106:107], v2 offset:27648
    ds_read_b64_tr_b16 a[108:109], v3 offset:26624
    ds_read_b64_tr_b16 a[110:111], v3 offset:27648
    s_waitcnt lgkmcnt(0)
    s_add_u32 m0, s21, 24576
    s_add_u32 s64, s65, 0x12c000
    buffer_load_dwordx4 v4, s[44:47], s64 offen lds
    s_add_u32 m0, s21, 25600
    s_add_u32 s64, s65, 0x131000
    buffer_load_dwordx4 v4, s[44:47], s64 offen lds
    s_add_u32 m0, s21, 26624
    s_add_u32 s64, s65, 0x136000
    buffer_load_dwordx4 v4, s[44:47], s64 offen lds
    s_add_u32 m0, s21, 27648
    s_add_u32 s64, s65, 0x13b000
    buffer_load_dwordx4 v4, s[44:47], s64 offen lds
    s_waitcnt vmcnt(32)
    ds_read_b64_tr_b16 a[112:113], v2 offset:28672
    ds_read_b64_tr_b16 a[114:115], v2 offset:29696
    ds_read_b64_tr_b16 a[116:117], v3 offset:28672
    ds_read_b64_tr_b16 a[118:119], v3 offset:29696
    ds_read_b64_tr_b16 a[120:121], v2 offset:30720
    ds_read_b64_tr_b16 a[122:123], v2 offset:31744
    ds_read_b64_tr_b16 a[124:125], v3 offset:30720
    ds_read_b64_tr_b16 a[126:127], v3 offset:31744
    s_waitcnt lgkmcnt(0)
    s_waitcnt vmcnt(28)
    ds_read_b64_tr_b16 a[128:129], v2 offset:32768
    ds_read_b64_tr_b16 a[130:131], v2 offset:33792
    ds_read_b64_tr_b16 a[132:133], v3 offset:32768
    ds_read_b64_tr_b16 a[134:135], v3 offset:33792
    ds_read_b64_tr_b16 a[136:137], v2 offset:34816
    ds_read_b64_tr_b16 a[138:139], v2 offset:35840
    ds_read_b64_tr_b16 a[140:141], v3 offset:34816
    ds_read_b64_tr_b16 a[142:143], v3 offset:35840
    s_waitcnt lgkmcnt(0)
    s_waitcnt vmcnt(24)
    ds_read_b64_tr_b16 a[144:145], v2 offset:0
    ds_read_b64_tr_b16 a[146:147], v2 offset:1024
    ds_read_b64_tr_b16 a[148:149], v3 offset:0
    ds_read_b64_tr_b16 a[150:151], v3 offset:1024
    ds_read_b64_tr_b16 a[152:153], v2 offset:2048
    ds_read_b64_tr_b16 a[154:155], v2 offset:3072
    ds_read_b64_tr_b16 a[156:157], v3 offset:2048
    ds_read_b64_tr_b16 a[158:159], v3 offset:3072
    s_waitcnt lgkmcnt(0)
    s_waitcnt vmcnt(20)
    ds_read_b64_tr_b16 a[160:161], v2 offset:4096
    ds_read_b64_tr_b16 a[162:163], v2 offset:5120
    ds_read_b64_tr_b16 a[164:165], v3 offset:4096
    ds_read_b64_tr_b16 a[166:167], v3 offset:5120
    ds_read_b64_tr_b16 a[168:169], v2 offset:6144
    ds_read_b64_tr_b16 a[170:171], v2 offset:7168
    ds_read_b64_tr_b16 a[172:173], v3 offset:6144
    ds_read_b64_tr_b16 a[174:175], v3 offset:7168
    s_waitcnt lgkmcnt(0)
    s_waitcnt vmcnt(16)
    ds_read_b64_tr_b16 a[176:177], v2 offset:8192
    ds_read_b64_tr_b16 a[178:179], v2 offset:9216
    ds_read_b64_tr_b16 a[180:181], v3 offset:8192
    ds_read_b64_tr_b16 a[182:183], v3 offset:9216
    ds_read_b64_tr_b16 a[184:185], v2 offset:10240
    ds_read_b64_tr_b16 a[186:187], v2 offset:11264
    ds_read_b64_tr_b16 a[188:189], v3 offset:10240
    ds_read_b64_tr_b16 a[190:191], v3 offset:11264
    s_waitcnt lgkmcnt(0)
    s_waitcnt vmcnt(12)
    ds_read_b64_tr_b16 a[192:193], v2 offset:12288
    ds_read_b64_tr_b16 a[194:195], v2 offset:13312
    ds_read_b64_tr_b16 a[196:197], v3 offset:12288
    ds_read_b64_tr_b16 a[198:199], v3 offset:13312
    ds_read_b64_tr_b16 a[200:201], v2 offset:14336
    ds_read_b64_tr_b16 a[202:203], v2 offset:15360
    ds_read_b64_tr_b16 a[204:205], v3 offset:14336
    ds_read_b64_tr_b16 a[206:207], v3 offset:15360
    s_waitcnt lgkmcnt(0)
    s_waitcnt vmcnt(8)
    ds_read_b64_tr_b16 a[208:209], v2 offset:16384
    ds_read_b64_tr_b16 a[210:211], v2 offset:17408
    ds_read_b64_tr_b16 a[212:213], v3 offset:16384
    ds_read_b64_tr_b16 a[214:215], v3 offset:17408
    ds_read_b64_tr_b16 a[216:217], v2 offset:18432
    ds_read_b64_tr_b16 a[218:219], v2 offset:19456
    ds_read_b64_tr_b16 a[220:221], v3 offset:18432
    ds_read_b64_tr_b16 a[222:223], v3 offset:19456
    s_waitcnt lgkmcnt(0)
    s_waitcnt vmcnt(4)
    ds_read_b64_tr_b16 a[224:225], v2 offset:20480
    ds_read_b64_tr_b16 a[226:227], v2 offset:21504
    ds_read_b64_tr_b16 a[228:229], v3 offset:20480
    ds_read_b64_tr_b16 a[230:231], v3 offset:21504
    ds_read_b64_tr_b16 a[232:233], v2 offset:22528
    ds_read_b64_tr_b16 a[234:235], v2 offset:23552
    ds_read_b64_tr_b16 a[236:237], v3 offset:22528
    ds_read_b64_tr_b16 a[238:239], v3 offset:23552
    s_waitcnt lgkmcnt(0)
    s_waitcnt vmcnt(0)
    ds_read_b64_tr_b16 a[240:241], v2 offset:24576
    ds_read_b64_tr_b16 a[242:243], v2 offset:25600
    ds_read_b64_tr_b16 a[244:245], v3 offset:24576
    ds_read_b64_tr_b16 a[246:247], v3 offset:25600
    ds_read_b64_tr_b16 a[248:249], v2 offset:26624
    ds_read_b64_tr_b16 a[250:251], v2 offset:27648
    ds_read_b64_tr_b16 a[252:253], v3 offset:26624
    ds_read_b64_tr_b16 a[254:255], v3 offset:27648
    s_waitcnt lgkmcnt(0)
    s_mov_b32 s13, s89
NOWO_126:
    v_mov_b32 v2, v10
    v_mov_b32 v3, v11
MKH_125:
    s_cmp_lg_u32 s24, 31
    s_mov_b64 exec, 0xf
    s_cbranch_scc1 MKL_127
    s_mov_b64 exec, -1
    v_bfe_u32 v4, v0, 3, 1
    v_mul_u32_u24 v4, 0x8000, v4
    v_sub_u32 v2, v2, v4
    s_mov_b64 exec, 3
MKL_127:
MKT_M_128:
    buffer_load_dword v5, v6, s[4:7], s28 offen sc1
    s_add_u32 s29, s29, 1
    s_waitcnt vmcnt(0)
    v_cmp_eq_u32 vcc, 0, v5
    s_cbranch_vccz MKT_MD_129
    s_cmp_gt_u32 s29, 262144
    s_cbranch_scc1 MKT_MD_129
    s_sleep 1
    s_branch MKT_M_128
MKT_MD_129:
    s_mov_b64 exec, -1
MKR_130:
    s_add_u32 s64, s25, 0x0
    buffer_load_dwordx4 v[16:19], v2, s[4:7], s64 offen sc1
    s_add_u32 s64, s25, 0x200
    buffer_load_dwordx4 v[20:23], v2, s[4:7], s64 offen sc1
    s_add_u32 s64, s25, 0x400
    buffer_load_dwordx4 v[24:27], v2, s[4:7], s64 offen sc1
    s_add_u32 s64, s25, 0x600
    buffer_load_dwordx4 v[28:31], v2, s[4:7], s64 offen sc1
    s_add_u32 s64, s25, 0x800
    buffer_load_dwordx4 v[32:35], v2, s[4:7], s64 offen sc1
    s_add_u32 s64, s25, 0xa00
    buffer_load_dwordx4 v[36:39], v2, s[4:7], s64 offen sc1
    s_add_u32 s64, s25, 0xc00
    buffer_load_dwordx4 v[40:43], v2, s[4:7], s64 offen sc1
    s_add_u32 s64, s25, 0xe00
    buffer_load_dwordx4 v[44:47], v2, s[4:7], s64 offen sc1
    s_add_u32 s64, s25, 0x1000
    buffer_load_dwordx4 v[48:51], v2, s[4:7], s64 offen sc1
    s_add_u32 s64, s25, 0x1200
    buffer_load_dwordx4 v[52:55], v2, s[4:7], s64 offen sc1
    s_add_u32 s64, s30, 0x0
    buffer_load_dwordx4 v[56:59], v2, s[4:7], s64 offen sc1
    s_add_u32 s64, s30, 0x200
    buffer_load_dwordx4 v[60:63], v2, s[4:7], s64 offen sc1
    s_add_u32 s64, s30, 0x400
    buffer_load_dwordx4 v[64:67], v2, s[4:7], s64 offen sc1
    s_add_u32 s64, s30, 0x600
    buffer_load_dwordx4 v[68:71], v2, s[4:7], s64 offen sc1
    s_add_u32 s64, s30, 0x800
    buffer_load_dwordx4 v[72:75], v2, s[4:7], s64 offen sc1
    s_add_u32 s64, s30, 0xa00
    buffer_load_dwordx4 v[76:79], v2, s[4:7], s64 offen sc1
    s_add_u32 s64, s30, 0xc00
    buffer_load_dwordx4 v[80:83], v2, s[4:7], s64 offen sc1
    s_add_u32 s64, s30, 0xe00
    buffer_load_dwordx4 v[84:87], v2, s[4:7], s64 offen sc1
    s_add_u32 s64, s30, 0x1000
    buffer_load_dwordx4 v[88:91], v2, s[4:7], s64 offen sc1
    s_add_u32 s64, s30, 0x1200
    buffer_load_dwordx4 v[92:95], v2, s[4:7], s64 offen sc1
    s_add_u32 s29, s29, 1
    s_waitcnt vmcnt(0)
    v_max3_u32 v4, v19, v23, v27
    v_max3_u32 v4, v4, v31, v35
    v_max3_u32 v4, v4, v39, v43
    v_max3_u32 v4, v4, v47, v51
    v_max3_u32 v4, v4, v55, v59
    v_max3_u32 v4, v4, v63, v67
    v_max3_u32 v4, v4, v71, v75
    v_max3_u32 v4, v4, v79, v83
    v_max3_u32 v4, v4, v87, v91
    v_max_u32 v4, v4, v95
    v_cmp_eq_u32 vcc, -1, v4
    s_cbranch_vccz MKO_131
    s_cmp_gt_u32 s29, 262144
    s_cbranch_scc0 MKR_130
MKO_131:
    v_mfma_f32_16x16x32_bf16 v[8:11], v[96:99], v[16:19], 0
    v_mfma_f32_16x16x32_bf16 v[12:15], v[100:103], v[16:19], 0
    v_mfma_f32_16x16x32_bf16 v[8:11], v[104:107], v[20:23], v[8:11]
    v_mfma_f32_16x16x32_bf16 v[12:15], v[108:111], v[20:23], v[12:15]
    v_mfma_f32_16x16x32_bf16 v[8:11], v[112:115], v[24:27], v[8:11]
    v_mfma_f32_16x16x32_bf16 v[12:15], v[116:119], v[24:27], v[12:15]
    v_mfma_f32_16x16x32_bf16 v[8:11], v[120:123], v[28:31], v[8:11]
    v_mfma_f32_16x16x32_bf16 v[12:15], v[124:127], v[28:31], v[12:15]
    v_mfma_f32_16x16x32_bf16 v[8:11], v[128:131], v[32:35], v[8:11]
    v_mfma_f32_16x16x32_bf16 v[12:15], v[132:135], v[32:35], v[12:15]
    v_mfma_f32_16x16x32_bf16 v[8:11], v[136:139], v[36:39], v[8:11]
    v_mfma_f32_16x16x32_bf16 v[12:15], v[140:143], v[36:39], v[12:15]
    v_mfma_f32_16x16x32_bf16 v[8:11], v[144:147], v[40:43], v[8:11]
    v_mfma_f32_16x16x32_bf16 v[12:15], v[148:151], v[40:43], v[12:15]
    v_mfma_f32_16x16x32_bf16 v[8:11], v[152:155], v[44:47], v[8:11]
    v_mfma_f32_16x16x32_bf16 v[12:15], v[156:159], v[44:47], v[12:15]
    v_mfma_f32_16x16x32_bf16 v[8:11], v[160:163], v[48:51], v[8:11]
    v_mfma_f32_16x16x32_bf16 v[12:15], v[164:167], v[48:51], v[12:15]
    v_mfma_f32_16x16x32_bf16 v[8:11], v[168:171], v[52:55], v[8:11]
    v_mfma_f32_16x16x32_bf16 v[12:15], v[172:175], v[52:55], v[12:15]
    v_mfma_f32_16x16x32_bf16 v[8:11], v[176:179], v[56:59], v[8:11]
    v_mfma_f32_16x16x32_bf16 v[12:15], v[180:183], v[56:59], v[12:15]
    v_mfma_f32_16x16x32_bf16 v[8:11], v[184:187], v[60:63], v[8:11]
    v_mfma_f32_16x16x32_bf16 v[12:15], v[188:191], v[60:63], v[12:15]
    v_mfma_f32_16x16x32_bf16 v[8:11], v[192:195], v[64:67], v[8:11]
    v_mfma_f32_16x16x32_bf16 v[12:15], v[196:199], v[64:67], v[12:15]
    v_mfma_f32_16x16x32_bf16 v[8:11], v[200:203], v[68:71], v[8:11]
    v_mfma_f32_16x16x32_bf16 v[12:15], v[204:207], v[68:71], v[12:15]
    v_mfma_f32_16x16x32_bf16 v[8:11], v[208:211], v[72:75], v[8:11]
    v_mfma_f32_16x16x32_bf16 v[12:15], v[212:215], v[72:75], v[12:15]
    v_mfma_f32_16x16x32_bf16 v[8:11], v[216:219], v[76:79], v[8:11]
    v_mfma_f32_16x16x32_bf16 v[12:15], v[220:223], v[76:79], v[12:15]
    v_mfma_f32_16x16x32_bf16 v[8:11], v[224:227], v[80:83], v[8:11]
    v_mfma_f32_16x16x32_bf16 v[12:15], v[228:231], v[80:83], v[12:15]
    v_mfma_f32_16x16x32_bf16 v[8:11], v[232:235], v[84:87], v[8:11]
    v_mfma_f32_16x16x32_bf16 v[12:15], v[236:239], v[84:87], v[12:15]
    v_mfma_f32_16x16x32_bf16 v[8:11], v[240:243], v[88:91], v[8:11]
    v_mfma_f32_16x16x32_bf16 v[12:15], v[244:247], v[88:91], v[12:15]
    v_mfma_f32_16x16x32_bf16 v[8:11], v[248:251], v[92:95], v[8:11]
    v_mfma_f32_16x16x32_bf16 v[12:15], v[252:255], v[92:95], v[12:15]
    s_nop 7
    v_cvt_pk_bf16_f32 v16, v8, v9
    v_cvt_pk_bf16_f32 v17, v10, v11
    v_cvt_pk_bf16_f32 v18, v12, v13
    v_cvt_pk_bf16_f32 v19, v14, v15
    buffer_store_dwordx4 v[16:19], v3, s[4:7], s26 offen sc1
    s_waitcnt vmcnt(0)
    s_barrier
    s_cmp_lg_u32 s14, 0
    s_cbranch_scc1 GF_132
    v_mov_b32 v7, 1
    v_mov_b32 v8, 0
    s_mov_b64 exec, 1
    buffer_store_dword v7, v8, s[4:7], s27 offen sc1
    s_mov_b64 exec, -1
GF_132:
    s_add_u32 s25, s25, 0x10000
    s_add_u32 s30, s30, 0x10000
    s_add_u32 s26, s26, 0x20000
    s_add_u32 s27, s27, 256
    s_add_u32 s28, s28, 512
    s_add_u32 s24, s24, 1
    s_cmp_lt_u32 s24, 32
    s_cbranch_scc1 MKT_LOOP
    s_cmp_ge_u32 s88, 60
    s_cbranch_scc1 M_EXIT
    s_branch H_EXTRA
G_N:
    v_lshrrev_b32 v6, 5, v0
    v_mul_u32_u24 v7, 40960, v6
    v_bfe_u32 v6, v0, 4, 1
    v_lshl_add_u32 v7, v6, 11, v7
    v_lshlrev_b32 v8, 3, v6
    v_bfe_u32 v6, v0, 2, 2
    v_lshl_add_u32 v7, v6, 8, v7
    v_lshl_add_u32 v8, v6, 1, v8
    v_and_b32 v6, 1, v0
    v_lshl_add_u32 v7, v6, 3, v7
    v_bfe_u32 v6, v0, 1, 1
    s_lshl_b32 s64, s14, 2
    v_add_u32 v10, s64, v6
    v_add_u32 v6, 0, v10
    v_xor_b32 v6, v6, v8
    v_lshl_add_u32 v3, v6, 4, v7
    v_add_u32 v4, 81920, v3
    v_add_u32 v6, 2, v10
    v_xor_b32 v6, v6, v8
    v_lshl_add_u32 v5, v6, 4, v7
    v_add_u32 v9, 81920, v5
    s_waitcnt vmcnt(0)
    s_barrier
    ds_read_b64_tr_b16 v[96:97], v3 offset:0
    ds_read_b64_tr_b16 v[98:99], v3 offset:1024
    ds_read_b64_tr_b16 v[100:101], v5 offset:0
    ds_read_b64_tr_b16 v[102:103], v5 offset:1024
    ds_read_b64_tr_b16 v[104:105], v4 offset:0
    ds_read_b64_tr_b16 v[106:107], v4 offset:1024
    ds_read_b64_tr_b16 v[108:109], v9 offset:0
    ds_read_b64_tr_b16 v[110:111], v9 offset:1024
    ds_read_b64_tr_b16 v[112:113], v3 offset:4096
    ds_read_b64_tr_b16 v[114:115], v3 offset:5120
    ds_read_b64_tr_b16 v[116:117], v5 offset:4096
    ds_read_b64_tr_b16 v[118:119], v5 offset:5120
    ds_read_b64_tr_b16 v[120:121], v4 offset:4096
    ds_read_b64_tr_b16 v[122:123], v4 offset:5120
    ds_read_b64_tr_b16 v[124:125], v9 offset:4096
    ds_read_b64_tr_b16 v[126:127], v9 offset:5120
    s_waitcnt lgkmcnt(4)
    ds_read_b64_tr_b16 v[128:129], v3 offset:8192
    ds_read_b64_tr_b16 v[130:131], v3 offset:9216
    ds_read_b64_tr_b16 v[132:133], v5 offset:8192
    ds_read_b64_tr_b16 v[134:135], v5 offset:9216
    ds_read_b64_tr_b16 v[136:137], v4 offset:8192
    ds_read_b64_tr_b16 v[138:139], v4 offset:9216
    ds_read_b64_tr_b16 v[140:141], v9 offset:8192
    ds_read_b64_tr_b16 v[142:143], v9 offset:9216
    ds_read_b64_tr_b16 v[144:145], v3 offset:12288
    ds_read_b64_tr_b16 v[146:147], v3 offset:13312
    ds_read_b64_tr_b16 v[148:149], v5 offset:12288
    ds_read_b64_tr_b16 v[150:151], v5 offset:13312
    ds_read_b64_tr_b16 v[152:153], v4 offset:12288
    ds_read_b64_tr_b16 v[154:155], v4 offset:13312
    ds_read_b64_tr_b16 v[156:157], v9 offset:12288
    ds_read_b64_tr_b16 v[158:159], v9 offset:13312
    s_waitcnt lgkmcnt(4)
    ds_read_b64_tr_b16 v[160:161], v3 offset:16384
    ds_read_b64_tr_b16 v[162:163], v3 offset:17408
    ds_read_b64_tr_b16 v[164:165], v5 offset:16384
    ds_read_b64_tr_b16 v[166:167], v5 offset:17408
    ds_read_b64_tr_b16 v[168:169], v4 offset:16384
    ds_read_b64_tr_b16 v[170:171], v4 offset:17408
    ds_read_b64_tr_b16 v[172:173], v9 offset:16384
    ds_read_b64_tr_b16 v[174:175], v9 offset:17408
    ds_read_b64_tr_b16 v[176:177], v3 offset:20480
    ds_read_b64_tr_b16 v[178:179], v3 offset:21504
    ds_read_b64_tr_b16 v[180:181], v5 offset:20480
    ds_read_b64_tr_b16 v[182:183], v5 offset:21504
    ds_read_b64_tr_b16 v[184:185], v4 offset:20480
    ds_read_b64_tr_b16 v[186:187], v4 offset:21504
    ds_read_b64_tr_b16 v[188:189], v9 offset:20480
    ds_read_b64_tr_b16 v[190:191], v9 offset:21504
    s_waitcnt lgkmcnt(4)
    ds_read_b64_tr_b16 v[192:193], v3 offset:24576
    ds_read_b64_tr_b16 v[194:195], v3 offset:25600
    ds_read_b64_tr_b16 v[196:197], v5 offset:24576
    ds_read_b64_tr_b16 v[198:199], v5 offset:25600
    ds_read_b64_tr_b16 v[200:201], v4 offset:24576
    ds_read_b64_tr_b16 v[202:203], v4 offset:25600
    ds_read_b64_tr_b16 v[204:205], v9 offset:24576
    ds_read_b64_tr_b16 v[206:207], v9 offset:25600
    ds_read_b64_tr_b16 v[208:209], v3 offset:28672
    ds_read_b64_tr_b16 v[210:211], v3 offset:29696
    ds_read_b64_tr_b16 v[212:213], v5 offset:28672
    ds_read_b64_tr_b16 v[214:215], v5 offset:29696
    ds_read_b64_tr_b16 v[216:217], v4 offset:28672
    ds_read_b64_tr_b16 v[218:219], v4 offset:29696
    ds_read_b64_tr_b16 v[220:221], v9 offset:28672
    ds_read_b64_tr_b16 v[222:223], v9 offset:29696
    s_waitcnt lgkmcnt(4)
    ds_read_b64_tr_b16 v[224:225], v3 offset:32768
    ds_read_b64_tr_b16 v[226:227], v3 offset:33792
    ds_read_b64_tr_b16 v[228:229], v5 offset:32768
    ds_read_b64_tr_b16 v[230:231], v5 offset:33792
    ds_read_b64_tr_b16 v[232:233], v4 offset:32768
    ds_read_b64_tr_b16 v[234:235], v4 offset:33792
    ds_read_b64_tr_b16 v[236:237], v9 offset:32768
    ds_read_b64_tr_b16 v[238:239], v9 offset:33792
    ds_read_b64_tr_b16 v[240:241], v3 offset:36864
    ds_read_b64_tr_b16 v[242:243], v3 offset:37888
    ds_read_b64_tr_b16 v[244:245], v5 offset:36864
    ds_read_b64_tr_b16 v[246:247], v5 offset:37888
    ds_read_b64_tr_b16 v[248:249], v4 offset:36864
    ds_read_b64_tr_b16 v[250:251], v4 offset:37888
    ds_read_b64_tr_b16 v[252:253], v9 offset:36864
    ds_read_b64_tr_b16 v[254:255], v9 offset:37888
    s_waitcnt lgkmcnt(0)
    s_cmp_lg_u32 s97, 0
    s_cbranch_scc1 CM_133
    v_mbcnt_lo_u32_b32 v0, -1, 0
    v_mbcnt_hi_u32_b32 v0, -1, v0
    v_mul_u32_u24 v8, 32, v0
    s_mov_b32 s64, 0x0
    s_mov_b32 s65, 0
    s_mov_b64 exec, 0xff
TK_134:
    buffer_load_dword v9, v8, s[60:63], s64 offen sc1
    s_add_u32 s65, s65, 1
    s_waitcnt vmcnt(0)
    s_mov_b32 s66, 0
    v_readlane_b32 s67, v9, 0
    s_add_u32 s66, s66, s67
    v_readlane_b32 s67, v9, 1
    s_add_u32 s66, s66, s67
    v_readlane_b32 s67, v9, 2
    s_add_u32 s66, s66, s67
    v_readlane_b32 s67, v9, 3
    s_add_u32 s66, s66, s67
    v_readlane_b32 s67, v9, 4
    s_add_u32 s66, s66, s67
    v_readlane_b32 s67, v9, 5
    s_add_u32 s66, s66, s67
    v_readlane_b32 s67, v9, 6
    s_add_u32 s66, s66, s67
    v_readlane_b32 s67, v9, 7
    s_add_u32 s66, s66, s67
    s_cmp_ge_u32 s66, 256
    s_cbranch_scc1 TKD_135
    s_cmp_gt_u32 s65, 262144
    s_cbranch_scc0 TK_134
TKD_135:
    v_cmp_ne_u32 vcc, 32, v9
    s_mov_b64 exec, -1
    s_cbranch_vccnz M_SLOW
CM_133:
    s_mov_b32 s65, 0
GI_136:
    buffer_load_dword v8, off, s[60:63], s95 sc1
    s_add_u32 s65, s65, 1
    s_waitcnt vmcnt(0)
    v_readfirstlane_b32 s64, v8
    s_cmp_ge_u32 s64, 186
    s_cbranch_scc1 GID_137
    s_cmp_gt_u32 s65, 65536
    s_cbranch_scc1 GID_137
    s_sleep 4
    s_branch GI_136
GID_137:
    v_mbcnt_lo_u32_b32 v0, -1, 0
    v_mbcnt_hi_u32_b32 v0, -1, v0
    s_mov_b32 s65, 0
CW_138:
    buffer_load_dwordx2 v[8:9], off, s[60:63], 0 offset:132 sc1
    s_add_u32 s65, s65, 1
    s_waitcnt vmcnt(0)
    v_readfirstlane_b32 s30, v8
    v_readfirstlane_b32 s31, v9
    s_min_u32 s64, s30, s31
    s_cmp_lg_u32 s64, 0
    s_cbranch_scc1 CWD_139
    s_cmp_gt_u32 s65, 65536
    s_cbranch_scc1 CWD_139
    s_sleep 4
    s_branch CW_138
CWD_139:
    s_sub_u32 s30, s30, 1
    s_and_b32 s30, s30, 3
    s_sub_u32 s31, s31, 1
    s_and_b32 s31, s31, 3
    s_lshl_b32 s34, s96, 2
    s_add_u32 s34, s34, s14
    s_lshl_b32 s34, s34, 6
    v_add_u32 v5, s34, v0
    v_lshlrev_b32 v3, 4, v0
    v_mov_b32 v40, -1
    v_mov_b32 v41, -1
    v_mov_b32 v42, -1
    v_mov_b32 v43, -1
    v_lshrrev_b32 v7, 6, v5
    v_mul_u32_u24 v7, 52429, v7
    v_lshrrev_b32 v7, 18, v7
    v_mul_u32_u24 v8, 320, v7
    v_sub_u32 v8, v5, v8
    v_lshlrev_b32 v48, 4, v8
    s_lshl_b32 s30, s30, 13
    s_lshl_b32 s31, s31, 13
    s_add_u32 s31, s31, 0x200000
    v_and_b32 v8, 1, v7
    v_cmp_eq_u32 vcc, 1, v8
    v_mov_b32 v8, s30
    v_mov_b32 v9, s31
    v_cndmask_b32 v8, v8, v9, vcc
    v_lshrrev_b32 v9, 1, v7
    v_lshl_add_u32 v8, v9, 15, v8
    v_add_u32 v49, v8, v48
    v_cmp_le_u32 vcc, 640, v5
    v_mov_b32 v9, 0x40000000
    s_nop 0
    v_cndmask_b32 v49, v9, v49, vcc
    v_cmp_gt_u32 vcc, 0xa000, v5
    s_nop 0
    s_and_saveexec_b64 s[38:39], vcc
    s_cbranch_execz INF_140
    s_mov_b32 s35, 0x6000000
    buffer_store_dwordx4 v[40:43], v49, s[4:7], s35 offen sc1
INF_140:
    s_mov_b64 exec, s[38:39]
    s_cmp_ge_u32 s96, 10
    s_cbranch_scc1 INM2_141
    s_cmp_lg_u32 s14, 1
    s_cbranch_scc1 INM2_141
    s_cmp_ge_u32 s96, 5
    s_cselect_b32 s36, 1, 0
    s_mul_i32 s34, s36, 5
    s_sub_u32 s34, s96, s34
    s_lshl_b32 s34, s34, 10
    s_cmp_eq_u32 s36, 0
    s_cselect_b32 s37, s30, s31
    s_add_u32 s37, s37, 0x6000000
    s_add_u32 s37, s37, s34
    buffer_store_dwordx4 v[34:37], v3, s[4:7], s37 offen sc1
INM2_141:
    v_lshlrev_b32 v1, 4, v0
    v_lshrrev_b32 v6, 3, v0
    v_mul_u32_u24 v2, 1280, v6
    v_and_b32 v7, 7, v0
    v_xor_b32 v7, v7, v6
    v_lshl_add_u32 v2, v7, 4, v2
    v_bfe_u32 v6, v0, 3, 1
    v_lshlrev_b32 v9, 10, v6
    v_and_b32 v6, 7, v0
    v_lshl_add_u32 v9, v6, 7, v9
    v_lshrrev_b32 v7, 4, v0
    v_xor_b32 v7, v7, v6
    v_lshl_add_u32 v3, v7, 4, v9
    v_xor_b32 v7, 4, v7
    v_lshl_add_u32 v4, v7, 4, v9
    v_add_u32 v6, 0x10000, v3
    v_add_u32 v9, 0x10000, v4
    s_barrier
    s_mul_i32 s20, s12, 163840
    s_mul_i32 s64, s14, 40960
    s_add_u32 s20, s20, s64
    s_add_u32 s20, s20, 0x0
    s_lshl_b32 s21, s14, 12
    s_add_u32 m0, s21, 0
    s_add_u32 s64, s20, 0x0
    buffer_load_dwordx4 v2, s[4:7], s64 offen lds
    s_add_u32 m0, s21, 1024
    s_add_u32 s64, s20, 0x2800
    buffer_load_dwordx4 v2, s[4:7], s64 offen lds
    s_add_u32 m0, s21, 2048
    s_add_u32 s64, s20, 0x5000
    buffer_load_dwordx4 v2, s[4:7], s64 offen lds
    s_add_u32 m0, s21, 3072
    s_add_u32 s64, s20, 0x7800
    buffer_load_dwordx4 v2, s[4:7], s64 offen lds
    s_add_u32 m0, s21, 16384
    s_add_u32 s64, s20, 0x80
    buffer_load_dwordx4 v2, s[4:7], s64 offen lds
    s_add_u32 m0, s21, 17408
    s_add_u32 s64, s20, 0x2880
    buffer_load_dwordx4 v2, s[4:7], s64 offen lds
    s_add_u32 m0, s21, 18432
    s_add_u32 s64, s20, 0x5080
    buffer_load_dwordx4 v2, s[4:7], s64 offen lds
    s_add_u32 m0, s21, 19456
    s_add_u32 s64, s20, 0x7880
    buffer_load_dwordx4 v2, s[4:7], s64 offen lds
    s_add_u32 m0, s21, 32768
    s_add_u32 s64, s20, 0x100
    buffer_load_dwordx4 v2, s[4:7], s64 offen lds
    s_add_u32 m0, s21, 33792
    s_add_u32 s64, s20, 0x2900
    buffer_load_dwordx4 v2, s[4:7], s64 offen lds
    s_add_u32 m0, s21, 34816
    s_add_u32 s64, s20, 0x5100
    buffer_load_dwordx4 v2, s[4:7], s64 offen lds
    s_add_u32 m0, s21, 35840
    s_add_u32 s64, s20, 0x7900
    buffer_load_dwordx4 v2, s[4:7], s64 offen lds
    s_add_u32 m0, s21, 49152
    s_add_u32 s64, s20, 0x180
    buffer_load_dwordx4 v2, s[4:7], s64 offen lds
    s_add_u32 m0, s21, 50176
    s_add_u32 s64, s20, 0x2980
    buffer_load_dwordx4 v2, s[4:7], s64 offen lds
    s_add_u32 m0, s21, 51200
    s_add_u32 s64, s20, 0x5180
    buffer_load_dwordx4 v2, s[4:7], s64 offen lds
    s_add_u32 m0, s21, 52224
    s_add_u32 s64, s20, 0x7980
    buffer_load_dwordx4 v2, s[4:7], s64 offen lds
    s_mov_b32 s64, 0x40000000
    buffer_store_dword v7, v1, s[4:7], s64 offen
    buffer_store_dword v7, v1, s[4:7], s64 offen
    buffer_store_dword v7, v1, s[4:7], s64 offen
    buffer_store_dword v7, v1, s[4:7], s64 offen
    buffer_store_dword v7, v1, s[4:7], s64 offen
    buffer_store_dword v7, v1, s[4:7], s64 offen
    buffer_store_dword v7, v1, s[4:7], s64 offen
    buffer_store_dword v7, v1, s[4:7], s64 offen
    s_waitcnt vmcnt(20)
    s_barrier
    ds_read_b128 a[0:3], v3 offset:0
    ds_read_b128 a[4:7], v3 offset:2048
    ds_read_b128 a[8:11], v3 offset:4096
    ds_read_b128 a[12:15], v3 offset:6144
    ds_read_b128 a[16:19], v3 offset:8192
    ds_read_b128 a[20:23], v3 offset:10240
    ds_read_b128 a[24:27], v3 offset:12288
    ds_read_b128 a[28:31], v3 offset:14336
    s_mov_b32 s19, 0
    s_mov_b32 s22, s16
    s_mov_b32 s23, 0x40000000
G_N_LOOP:
    s_waitcnt lgkmcnt(4)
    v_mfma_f32_16x16x32_bf16 v[16:19], a[0:3], v[96:99], 0
    v_mfma_f32_16x16x32_bf16 v[20:23], a[0:3], v[100:103], 0
    ds_read_b128 a[32:35], v4 offset:0
    v_mfma_f32_16x16x32_bf16 v[24:27], a[4:7], v[96:99], 0
    v_mfma_f32_16x16x32_bf16 v[28:31], a[4:7], v[100:103], 0
    ds_read_b128 a[36:39], v4 offset:2048
    v_mfma_f32_16x16x32_bf16 v[32:35], a[8:11], v[96:99], 0
    v_mfma_f32_16x16x32_bf16 v[36:39], a[8:11], v[100:103], 0
    ds_read_b128 a[40:43], v4 offset:4096
    v_mfma_f32_16x16x32_bf16 v[40:43], a[12:15], v[96:99], 0
    v_mfma_f32_16x16x32_bf16 v[44:47], a[12:15], v[100:103], 0
    ds_read_b128 a[44:47], v4 offset:6144
    s_waitcnt lgkmcnt(4)
    v_mfma_f32_16x16x32_bf16 v[48:51], a[16:19], v[96:99], 0
    v_mfma_f32_16x16x32_bf16 v[52:55], a[16:19], v[100:103], 0
    ds_read_b128 a[48:51], v4 offset:8192
    v_mfma_f32_16x16x32_bf16 v[56:59], a[20:23], v[96:99], 0
    v_mfma_f32_16x16x32_bf16 v[60:63], a[20:23], v[100:103], 0
    ds_read_b128 a[52:55], v4 offset:10240
    v_mfma_f32_16x16x32_bf16 v[64:67], a[24:27], v[96:99], 0
    v_mfma_f32_16x16x32_bf16 v[68:71], a[24:27], v[100:103], 0
    ds_read_b128 a[56:59], v4 offset:12288
    v_mfma_f32_16x16x32_bf16 v[72:75], a[28:31], v[96:99], 0
    v_mfma_f32_16x16x32_bf16 v[76:79], a[28:31], v[100:103], 0
    ds_read_b128 a[60:63], v4 offset:14336
    s_waitcnt vmcnt(16)
    s_barrier
    s_waitcnt lgkmcnt(4)
    v_mfma_f32_16x16x32_bf16 v[16:19], a[32:35], v[104:107], v[16:19]
    v_mfma_f32_16x16x32_bf16 v[20:23], a[32:35], v[108:111], v[20:23]
    ds_read_b128 a[0:3], v3 offset:16384
    s_add_u32 m0, s21, 65536
    v_mfma_f32_16x16x32_bf16 v[24:27], a[36:39], v[104:107], v[24:27]
    v_mfma_f32_16x16x32_bf16 v[28:31], a[36:39], v[108:111], v[28:31]
    ds_read_b128 a[4:7], v3 offset:18432
    s_add_u32 s64, s20, 0x200
    buffer_load_dwordx4 v2, s[4:7], s64 offen lds
    v_mfma_f32_16x16x32_bf16 v[32:35], a[40:43], v[104:107], v[32:35]
    v_mfma_f32_16x16x32_bf16 v[36:39], a[40:43], v[108:111], v[36:39]
    ds_read_b128 a[8:11], v3 offset:20480
    s_add_u32 m0, s21, 66560
    v_mfma_f32_16x16x32_bf16 v[40:43], a[44:47], v[104:107], v[40:43]
    v_mfma_f32_16x16x32_bf16 v[44:47], a[44:47], v[108:111], v[44:47]
    ds_read_b128 a[12:15], v3 offset:22528
    s_add_u32 s64, s20, 0x2a00
    buffer_load_dwordx4 v2, s[4:7], s64 offen lds
    s_waitcnt lgkmcnt(4)
    v_mfma_f32_16x16x32_bf16 v[48:51], a[48:51], v[104:107], v[48:51]
    v_mfma_f32_16x16x32_bf16 v[52:55], a[48:51], v[108:111], v[52:55]
    ds_read_b128 a[16:19], v3 offset:24576
    s_add_u32 m0, s21, 67584
    v_mfma_f32_16x16x32_bf16 v[56:59], a[52:55], v[104:107], v[56:59]
    v_mfma_f32_16x16x32_bf16 v[60:63], a[52:55], v[108:111], v[60:63]
    ds_read_b128 a[20:23], v3 offset:26624
    s_add_u32 s64, s20, 0x5200
    buffer_load_dwordx4 v2, s[4:7], s64 offen lds
    v_mfma_f32_16x16x32_bf16 v[64:67], a[56:59], v[104:107], v[64:67]
    v_mfma_f32_16x16x32_bf16 v[68:71], a[56:59], v[108:111], v[68:71]
    ds_read_b128 a[24:27], v3 offset:28672
    s_add_u32 m0, s21, 68608
    v_mfma_f32_16x16x32_bf16 v[72:75], a[60:63], v[104:107], v[72:75]
    v_mfma_f32_16x16x32_bf16 v[76:79], a[60:63], v[108:111], v[76:79]
    ds_read_b128 a[28:31], v3 offset:30720
    s_add_u32 s64, s20, 0x7a00
    buffer_load_dwordx4 v2, s[4:7], s64 offen lds
    s_waitcnt lgkmcnt(4)
    v_mfma_f32_16x16x32_bf16 v[16:19], a[0:3], v[112:115], v[16:19]
    v_mfma_f32_16x16x32_bf16 v[20:23], a[0:3], v[116:119], v[20:23]
    ds_read_b128 a[32:35], v4 offset:16384
    v_mfma_f32_16x16x32_bf16 v[24:27], a[4:7], v[112:115], v[24:27]
    v_mfma_f32_16x16x32_bf16 v[28:31], a[4:7], v[116:119], v[28:31]
    ds_read_b128 a[36:39], v4 offset:18432
    v_mfma_f32_16x16x32_bf16 v[32:35], a[8:11], v[112:115], v[32:35]
    v_mfma_f32_16x16x32_bf16 v[36:39], a[8:11], v[116:119], v[36:39]
    ds_read_b128 a[40:43], v4 offset:20480
    v_mfma_f32_16x16x32_bf16 v[40:43], a[12:15], v[112:115], v[40:43]
    v_mfma_f32_16x16x32_bf16 v[44:47], a[12:15], v[116:119], v[44:47]
    ds_read_b128 a[44:47], v4 offset:22528
    s_waitcnt lgkmcnt(4)
    v_mfma_f32_16x16x32_bf16 v[48:51], a[16:19], v[112:115], v[48:51]
    v_mfma_f32_16x16x32_bf16 v[52:55], a[16:19], v[116:119], v[52:55]
    ds_read_b128 a[48:51], v4 offset:24576
    v_mfma_f32_16x16x32_bf16 v[56:59], a[20:23], v[112:115], v[56:59]
    v_mfma_f32_16x16x32_bf16 v[60:63], a[20:23], v[116:119], v[60:63]
    ds_read_b128 a[52:55], v4 offset:26624
    v_mfma_f32_16x16x32_bf16 v[64:67], a[24:27], v[112:115], v[64:67]
    v_mfma_f32_16x16x32_bf16 v[68:71], a[24:27], v[116:119], v[68:71]
    ds_read_b128 a[56:59], v4 offset:28672
    v_mfma_f32_16x16x32_bf16 v[72:75], a[28:31], v[112:115], v[72:75]
    v_mfma_f32_16x16x32_bf16 v[76:79], a[28:31], v[116:119], v[76:79]
    ds_read_b128 a[60:63], v4 offset:30720
    s_waitcnt vmcnt(16)
    s_barrier
    s_cmp_lg_u32 s19, 0
    s_cbranch_scc1 GFD_142
    s_cmp_lg_u32 s14, 0
    s_cbranch_scc1 INE_143
    s_cmp_lg_u32 s96, 10
    s_cbranch_scc1 ING_144
    v_mov_b32 v7, 1
    v_lshlrev_b32 v8, 7, v0
    s_mov_b32 s65, 0x29a000
    s_mov_b64 exec, 3
    buffer_store_dword v7, v8, s[4:7], s65 offen sc1
    s_mov_b64 exec, -1
    s_waitcnt vmcnt(0)
ING_144:
    v_mov_b32 v8, 1
    s_mov_b32 s65, 0x290800
    s_mov_b64 exec, 1
    buffer_atomic_add v8, off, s[4:7], s65 sc1
    s_mov_b64 exec, -1
INE_143:
GFD_142:
    s_waitcnt lgkmcnt(4)
    v_mfma_f32_16x16x32_bf16 v[16:19], a[32:35], v[120:123], v[16:19]
    v_mfma_f32_16x16x32_bf16 v[20:23], a[32:35], v[124:127], v[20:23]
    ds_read_b128 a[0:3], v3 offset:32768
    s_add_u32 m0, s21, 0
    v_mfma_f32_16x16x32_bf16 v[24:27], a[36:39], v[120:123], v[24:27]
    v_mfma_f32_16x16x32_bf16 v[28:31], a[36:39], v[124:127], v[28:31]
    ds_read_b128 a[4:7], v3 offset:34816
    s_add_u32 s64, s20, 0x280
    buffer_load_dwordx4 v2, s[4:7], s64 offen lds
    v_mfma_f32_16x16x32_bf16 v[32:35], a[40:43], v[120:123], v[32:35]
    v_mfma_f32_16x16x32_bf16 v[36:39], a[40:43], v[124:127], v[36:39]
    ds_read_b128 a[8:11], v3 offset:36864
    s_add_u32 m0, s21, 1024
    v_mfma_f32_16x16x32_bf16 v[40:43], a[44:47], v[120:123], v[40:43]
    v_mfma_f32_16x16x32_bf16 v[44:47], a[44:47], v[124:127], v[44:47]
    ds_read_b128 a[12:15], v3 offset:38912
    s_add_u32 s64, s20, 0x2a80
    buffer_load_dwordx4 v2, s[4:7], s64 offen lds
    s_waitcnt lgkmcnt(4)
    v_mfma_f32_16x16x32_bf16 v[48:51], a[48:51], v[120:123], v[48:51]
    v_mfma_f32_16x16x32_bf16 v[52:55], a[48:51], v[124:127], v[52:55]
    ds_read_b128 a[16:19], v3 offset:40960
    s_add_u32 m0, s21, 2048
    v_mfma_f32_16x16x32_bf16 v[56:59], a[52:55], v[120:123], v[56:59]
    v_mfma_f32_16x16x32_bf16 v[60:63], a[52:55], v[124:127], v[60:63]
    ds_read_b128 a[20:23], v3 offset:43008
    s_add_u32 s64, s20, 0x5280
    buffer_load_dwordx4 v2, s[4:7], s64 offen lds
    v_mfma_f32_16x16x32_bf16 v[64:67], a[56:59], v[120:123], v[64:67]
    v_mfma_f32_16x16x32_bf16 v[68:71], a[56:59], v[124:127], v[68:71]
    ds_read_b128 a[24:27], v3 offset:45056
    s_add_u32 m0, s21, 3072
    v_mfma_f32_16x16x32_bf16 v[72:75], a[60:63], v[120:123], v[72:75]
    v_mfma_f32_16x16x32_bf16 v[76:79], a[60:63], v[124:127], v[76:79]
    ds_read_b128 a[28:31], v3 offset:47104
    s_add_u32 s64, s20, 0x7a80
    buffer_load_dwordx4 v2, s[4:7], s64 offen lds
    s_waitcnt lgkmcnt(4)
    v_mfma_f32_16x16x32_bf16 v[16:19], a[0:3], v[128:131], v[16:19]
    v_mfma_f32_16x16x32_bf16 v[20:23], a[0:3], v[132:135], v[20:23]
    ds_read_b128 a[32:35], v4 offset:32768
    v_mfma_f32_16x16x32_bf16 v[24:27], a[4:7], v[128:131], v[24:27]
    v_mfma_f32_16x16x32_bf16 v[28:31], a[4:7], v[132:135], v[28:31]
    ds_read_b128 a[36:39], v4 offset:34816
    v_mfma_f32_16x16x32_bf16 v[32:35], a[8:11], v[128:131], v[32:35]
    v_mfma_f32_16x16x32_bf16 v[36:39], a[8:11], v[132:135], v[36:39]
    ds_read_b128 a[40:43], v4 offset:36864
    v_mfma_f32_16x16x32_bf16 v[40:43], a[12:15], v[128:131], v[40:43]
    v_mfma_f32_16x16x32_bf16 v[44:47], a[12:15], v[132:135], v[44:47]
    ds_read_b128 a[44:47], v4 offset:38912
    s_waitcnt lgkmcnt(4)
    v_mfma_f32_16x16x32_bf16 v[48:51], a[16:19], v[128:131], v[48:51]
    v_mfma_f32_16x16x32_bf16 v[52:55], a[16:19], v[132:135], v[52:55]
    ds_read_b128 a[48:51], v4 offset:40960
    v_mfma_f32_16x16x32_bf16 v[56:59], a[20:23], v[128:131], v[56:59]
    v_mfma_f32_16x16x32_bf16 v[60:63], a[20:23], v[132:135], v[60:63]
    ds_read_b128 a[52:55], v4 offset:43008
    v_mfma_f32_16x16x32_bf16 v[64:67], a[24:27], v[128:131], v[64:67]
    v_mfma_f32_16x16x32_bf16 v[68:71], a[24:27], v[132:135], v[68:71]
    ds_read_b128 a[56:59], v4 offset:45056
    v_mfma_f32_16x16x32_bf16 v[72:75], a[28:31], v[128:131], v[72:75]
    v_mfma_f32_16x16x32_bf16 v[76:79], a[28:31], v[132:135], v[76:79]
    ds_read_b128 a[60:63], v4 offset:47104
    s_waitcnt vmcnt(16)
    s_barrier
    s_waitcnt lgkmcnt(4)
    v_mfma_f32_16x16x32_bf16 v[16:19], a[32:35], v[136:139], v[16:19]
    v_mfma_f32_16x16x32_bf16 v[20:23], a[32:35], v[140:143], v[20:23]
    ds_read_b128 a[0:3], v3 offset:49152
    s_add_u32 m0, s21, 16384
    v_mfma_f32_16x16x32_bf16 v[24:27], a[36:39], v[136:139], v[24:27]
    v_mfma_f32_16x16x32_bf16 v[28:31], a[36:39], v[140:143], v[28:31]
    ds_read_b128 a[4:7], v3 offset:51200
    s_add_u32 s64, s20, 0x300
    buffer_load_dwordx4 v2, s[4:7], s64 offen lds
    v_mfma_f32_16x16x32_bf16 v[32:35], a[40:43], v[136:139], v[32:35]
    v_mfma_f32_16x16x32_bf16 v[36:39], a[40:43], v[140:143], v[36:39]
    ds_read_b128 a[8:11], v3 offset:53248
    s_add_u32 m0, s21, 17408
    v_mfma_f32_16x16x32_bf16 v[40:43], a[44:47], v[136:139], v[40:43]
    v_mfma_f32_16x16x32_bf16 v[44:47], a[44:47], v[140:143], v[44:47]
    ds_read_b128 a[12:15], v3 offset:55296
    s_add_u32 s64, s20, 0x2b00
    buffer_load_dwordx4 v2, s[4:7], s64 offen lds
    s_waitcnt lgkmcnt(4)
    v_mfma_f32_16x16x32_bf16 v[48:51], a[48:51], v[136:139], v[48:51]
    v_mfma_f32_16x16x32_bf16 v[52:55], a[48:51], v[140:143], v[52:55]
    ds_read_b128 a[16:19], v3 offset:57344
    s_add_u32 m0, s21, 18432
    v_mfma_f32_16x16x32_bf16 v[56:59], a[52:55], v[136:139], v[56:59]
    v_mfma_f32_16x16x32_bf16 v[60:63], a[52:55], v[140:143], v[60:63]
    ds_read_b128 a[20:23], v3 offset:59392
    s_add_u32 s64, s20, 0x5300
    buffer_load_dwordx4 v2, s[4:7], s64 offen lds
    v_mfma_f32_16x16x32_bf16 v[64:67], a[56:59], v[136:139], v[64:67]
    v_mfma_f32_16x16x32_bf16 v[68:71], a[56:59], v[140:143], v[68:71]
    ds_read_b128 a[24:27], v3 offset:61440
    s_add_u32 m0, s21, 19456
    v_mfma_f32_16x16x32_bf16 v[72:75], a[60:63], v[136:139], v[72:75]
    v_mfma_f32_16x16x32_bf16 v[76:79], a[60:63], v[140:143], v[76:79]
    ds_read_b128 a[28:31], v3 offset:63488
    s_add_u32 s64, s20, 0x7b00
    buffer_load_dwordx4 v2, s[4:7], s64 offen lds
    s_waitcnt lgkmcnt(4)
    v_mfma_f32_16x16x32_bf16 v[16:19], a[0:3], v[144:147], v[16:19]
    v_mfma_f32_16x16x32_bf16 v[20:23], a[0:3], v[148:151], v[20:23]
    ds_read_b128 a[32:35], v4 offset:49152
    v_mfma_f32_16x16x32_bf16 v[24:27], a[4:7], v[144:147], v[24:27]
    v_mfma_f32_16x16x32_bf16 v[28:31], a[4:7], v[148:151], v[28:31]
    ds_read_b128 a[36:39], v4 offset:51200
    v_mfma_f32_16x16x32_bf16 v[32:35], a[8:11], v[144:147], v[32:35]
    v_mfma_f32_16x16x32_bf16 v[36:39], a[8:11], v[148:151], v[36:39]
    ds_read_b128 a[40:43], v4 offset:53248
    v_mfma_f32_16x16x32_bf16 v[40:43], a[12:15], v[144:147], v[40:43]
    v_mfma_f32_16x16x32_bf16 v[44:47], a[12:15], v[148:151], v[44:47]
    ds_read_b128 a[44:47], v4 offset:55296
    s_waitcnt lgkmcnt(4)
    v_mfma_f32_16x16x32_bf16 v[48:51], a[16:19], v[144:147], v[48:51]
    v_mfma_f32_16x16x32_bf16 v[52:55], a[16:19], v[148:151], v[52:55]
    ds_read_b128 a[48:51], v4 offset:57344
    v_mfma_f32_16x16x32_bf16 v[56:59], a[20:23], v[144:147], v[56:59]
    v_mfma_f32_16x16x32_bf16 v[60:63], a[20:23], v[148:151], v[60:63]
    ds_read_b128 a[52:55], v4 offset:59392
    v_mfma_f32_16x16x32_bf16 v[64:67], a[24:27], v[144:147], v[64:67]
    v_mfma_f32_16x16x32_bf16 v[68:71], a[24:27], v[148:151], v[68:71]
    ds_read_b128 a[56:59], v4 offset:61440
    v_mfma_f32_16x16x32_bf16 v[72:75], a[28:31], v[144:147], v[72:75]
    v_mfma_f32_16x16x32_bf16 v[76:79], a[28:31], v[148:151], v[76:79]
    ds_read_b128 a[60:63], v4 offset:63488
    s_waitcnt vmcnt(8)
    s_barrier
    s_cmp_lg_u32 s14, 0
    s_cbranch_scc1 GF_145
    v_mov_b32 v7, 1
    v_mov_b32 v8, 0
    s_mov_b64 exec, 1
    buffer_store_dword v7, v8, s[4:7], s23 offen sc1
    s_mov_b64 exec, -1
GF_145:
    s_waitcnt lgkmcnt(4)
    v_mfma_f32_16x16x32_bf16 v[16:19], a[32:35], v[152:155], v[16:19]
    v_mfma_f32_16x16x32_bf16 v[20:23], a[32:35], v[156:159], v[20:23]
    ds_read_b128 a[0:3], v6 offset:0
    s_add_u32 m0, s21, 32768
    v_mfma_f32_16x16x32_bf16 v[24:27], a[36:39], v[152:155], v[24:27]
    v_mfma_f32_16x16x32_bf16 v[28:31], a[36:39], v[156:159], v[28:31]
    ds_read_b128 a[4:7], v6 offset:2048
    s_add_u32 s64, s20, 0x380
    buffer_load_dwordx4 v2, s[4:7], s64 offen lds
    v_mfma_f32_16x16x32_bf16 v[32:35], a[40:43], v[152:155], v[32:35]
    v_mfma_f32_16x16x32_bf16 v[36:39], a[40:43], v[156:159], v[36:39]
    ds_read_b128 a[8:11], v6 offset:4096
    s_add_u32 m0, s21, 33792
    v_mfma_f32_16x16x32_bf16 v[40:43], a[44:47], v[152:155], v[40:43]
    v_mfma_f32_16x16x32_bf16 v[44:47], a[44:47], v[156:159], v[44:47]
    ds_read_b128 a[12:15], v6 offset:6144
    s_add_u32 s64, s20, 0x2b80
    buffer_load_dwordx4 v2, s[4:7], s64 offen lds
    s_waitcnt lgkmcnt(4)
    v_mfma_f32_16x16x32_bf16 v[48:51], a[48:51], v[152:155], v[48:51]
    v_mfma_f32_16x16x32_bf16 v[52:55], a[48:51], v[156:159], v[52:55]
    ds_read_b128 a[16:19], v6 offset:8192
    s_add_u32 m0, s21, 34816
    v_mfma_f32_16x16x32_bf16 v[56:59], a[52:55], v[152:155], v[56:59]
    v_mfma_f32_16x16x32_bf16 v[60:63], a[52:55], v[156:159], v[60:63]
    ds_read_b128 a[20:23], v6 offset:10240
    s_add_u32 s64, s20, 0x5380
    buffer_load_dwordx4 v2, s[4:7], s64 offen lds
    v_mfma_f32_16x16x32_bf16 v[64:67], a[56:59], v[152:155], v[64:67]
    v_mfma_f32_16x16x32_bf16 v[68:71], a[56:59], v[156:159], v[68:71]
    ds_read_b128 a[24:27], v6 offset:12288
    s_add_u32 m0, s21, 35840
    v_mfma_f32_16x16x32_bf16 v[72:75], a[60:63], v[152:155], v[72:75]
    v_mfma_f32_16x16x32_bf16 v[76:79], a[60:63], v[156:159], v[76:79]
    ds_read_b128 a[28:31], v6 offset:14336
    s_add_u32 s64, s20, 0x7b80
    buffer_load_dwordx4 v2, s[4:7], s64 offen lds
    s_waitcnt lgkmcnt(4)
    v_mfma_f32_16x16x32_bf16 v[16:19], a[0:3], v[160:163], v[16:19]
    v_mfma_f32_16x16x32_bf16 v[20:23], a[0:3], v[164:167], v[20:23]
    ds_read_b128 a[32:35], v9 offset:0
    v_mfma_f32_16x16x32_bf16 v[24:27], a[4:7], v[160:163], v[24:27]
    v_mfma_f32_16x16x32_bf16 v[28:31], a[4:7], v[164:167], v[28:31]
    ds_read_b128 a[36:39], v9 offset:2048
    v_mfma_f32_16x16x32_bf16 v[32:35], a[8:11], v[160:163], v[32:35]
    v_mfma_f32_16x16x32_bf16 v[36:39], a[8:11], v[164:167], v[36:39]
    ds_read_b128 a[40:43], v9 offset:4096
    v_mfma_f32_16x16x32_bf16 v[40:43], a[12:15], v[160:163], v[40:43]
    v_mfma_f32_16x16x32_bf16 v[44:47], a[12:15], v[164:167], v[44:47]
    ds_read_b128 a[44:47], v9 offset:6144
    s_waitcnt lgkmcnt(4)
    v_mfma_f32_16x16x32_bf16 v[48:51], a[16:19], v[160:163], v[48:51]
    v_mfma_f32_16x16x32_bf16 v[52:55], a[16:19], v[164:167], v[52:55]
    ds_read_b128 a[48:51], v9 offset:8192
    v_mfma_f32_16x16x32_bf16 v[56:59], a[20:23], v[160:163], v[56:59]
    v_mfma_f32_16x16x32_bf16 v[60:63], a[20:23], v[164:167], v[60:63]
    ds_read_b128 a[52:55], v9 offset:10240
    v_mfma_f32_16x16x32_bf16 v[64:67], a[24:27], v[160:163], v[64:67]
    v_mfma_f32_16x16x32_bf16 v[68:71], a[24:27], v[164:167], v[68:71]
    ds_read_b128 a[56:59], v9 offset:12288
    v_mfma_f32_16x16x32_bf16 v[72:75], a[28:31], v[160:163], v[72:75]
    v_mfma_f32_16x16x32_bf16 v[76:79], a[28:31], v[164:167], v[76:79]
    ds_read_b128 a[60:63], v9 offset:14336
    s_waitcnt vmcnt(8)
    s_barrier
    s_waitcnt lgkmcnt(4)
    v_mfma_f32_16x16x32_bf16 v[16:19], a[32:35], v[168:171], v[16:19]
    v_mfma_f32_16x16x32_bf16 v[20:23], a[32:35], v[172:175], v[20:23]
    ds_read_b128 a[0:3], v3 offset:0
    s_add_u32 m0, s21, 49152
    v_mfma_f32_16x16x32_bf16 v[24:27], a[36:39], v[168:171], v[24:27]
    v_mfma_f32_16x16x32_bf16 v[28:31], a[36:39], v[172:175], v[28:31]
    ds_read_b128 a[4:7], v3 offset:2048
    s_add_u32 s64, s20, 0x400
    buffer_load_dwordx4 v2, s[4:7], s64 offen lds
    v_mfma_f32_16x16x32_bf16 v[32:35], a[40:43], v[168:171], v[32:35]
    v_mfma_f32_16x16x32_bf16 v[36:39], a[40:43], v[172:175], v[36:39]
    ds_read_b128 a[8:11], v3 offset:4096
    s_add_u32 m0, s21, 50176
    v_mfma_f32_16x16x32_bf16 v[40:43], a[44:47], v[168:171], v[40:43]
    v_mfma_f32_16x16x32_bf16 v[44:47], a[44:47], v[172:175], v[44:47]
    ds_read_b128 a[12:15], v3 offset:6144
    s_add_u32 s64, s20, 0x2c00
    buffer_load_dwordx4 v2, s[4:7], s64 offen lds
    s_waitcnt lgkmcnt(4)
    v_mfma_f32_16x16x32_bf16 v[48:51], a[48:51], v[168:171], v[48:51]
    v_mfma_f32_16x16x32_bf16 v[52:55], a[48:51], v[172:175], v[52:55]
    ds_read_b128 a[16:19], v3 offset:8192
    s_add_u32 m0, s21, 51200
    v_mfma_f32_16x16x32_bf16 v[56:59], a[52:55], v[168:171], v[56:59]
    v_mfma_f32_16x16x32_bf16 v[60:63], a[52:55], v[172:175], v[60:63]
    ds_read_b128 a[20:23], v3 offset:10240
    s_add_u32 s64, s20, 0x5400
    buffer_load_dwordx4 v2, s[4:7], s64 offen lds
    v_mfma_f32_16x16x32_bf16 v[64:67], a[56:59], v[168:171], v[64:67]
    v_mfma_f32_16x16x32_bf16 v[68:71], a[56:59], v[172:175], v[68:71]
    ds_read_b128 a[24:27], v3 offset:12288
    s_add_u32 m0, s21, 52224
    v_mfma_f32_16x16x32_bf16 v[72:75], a[60:63], v[168:171], v[72:75]
    v_mfma_f32_16x16x32_bf16 v[76:79], a[60:63], v[172:175], v[76:79]
    ds_read_b128 a[28:31], v3 offset:14336
    s_add_u32 s64, s20, 0x7c00
    buffer_load_dwordx4 v2, s[4:7], s64 offen lds
    s_waitcnt lgkmcnt(4)
    v_mfma_f32_16x16x32_bf16 v[16:19], a[0:3], v[176:179], v[16:19]
    v_mfma_f32_16x16x32_bf16 v[20:23], a[0:3], v[180:183], v[20:23]
    ds_read_b128 a[32:35], v4 offset:0
    v_mfma_f32_16x16x32_bf16 v[24:27], a[4:7], v[176:179], v[24:27]
    v_mfma_f32_16x16x32_bf16 v[28:31], a[4:7], v[180:183], v[28:31]
    ds_read_b128 a[36:39], v4 offset:2048
    v_mfma_f32_16x16x32_bf16 v[32:35], a[8:11], v[176:179], v[32:35]
    v_mfma_f32_16x16x32_bf16 v[36:39], a[8:11], v[180:183], v[36:39]
    ds_read_b128 a[40:43], v4 offset:4096
    v_mfma_f32_16x16x32_bf16 v[40:43], a[12:15], v[176:179], v[40:43]
    v_mfma_f32_16x16x32_bf16 v[44:47], a[12:15], v[180:183], v[44:47]
    ds_read_b128 a[44:47], v4 offset:6144
    s_waitcnt lgkmcnt(4)
    v_mfma_f32_16x16x32_bf16 v[48:51], a[16:19], v[176:179], v[48:51]
    v_mfma_f32_16x16x32_bf16 v[52:55], a[16:19], v[180:183], v[52:55]
    ds_read_b128 a[48:51], v4 offset:8192
    v_mfma_f32_16x16x32_bf16 v[56:59], a[20:23], v[176:179], v[56:59]
    v_mfma_f32_16x16x32_bf16 v[60:63], a[20:23], v[180:183], v[60:63]
    ds_read_b128 a[52:55], v4 offset:10240
    v_mfma_f32_16x16x32_bf16 v[64:67], a[24:27], v[176:179], v[64:67]
    v_mfma_f32_16x16x32_bf16 v[68:71], a[24:27], v[180:183], v[68:71]
    ds_read_b128 a[56:59], v4 offset:12288
    v_mfma_f32_16x16x32_bf16 v[72:75], a[28:31], v[176:179], v[72:75]
    v_mfma_f32_16x16x32_bf16 v[76:79], a[28:31], v[180:183], v[76:79]
    ds_read_b128 a[60:63], v4 offset:14336
    s_waitcnt vmcnt(8)
    s_barrier
    s_waitcnt lgkmcnt(4)
    v_mfma_f32_16x16x32_bf16 v[16:19], a[32:35], v[184:187], v[16:19]
    v_mfma_f32_16x16x32_bf16 v[20:23], a[32:35], v[188:191], v[20:23]
    ds_read_b128 a[0:3], v3 offset:16384
    s_add_u32 m0, s21, 65536
    v_mfma_f32_16x16x32_bf16 v[24:27], a[36:39], v[184:187], v[24:27]
    v_mfma_f32_16x16x32_bf16 v[28:31], a[36:39], v[188:191], v[28:31]
    ds_read_b128 a[4:7], v3 offset:18432
    s_add_u32 s64, s20, 0x480
    buffer_load_dwordx4 v2, s[4:7], s64 offen lds
    v_mfma_f32_16x16x32_bf16 v[32:35], a[40:43], v[184:187], v[32:35]
    v_mfma_f32_16x16x32_bf16 v[36:39], a[40:43], v[188:191], v[36:39]
    ds_read_b128 a[8:11], v3 offset:20480
    s_add_u32 m0, s21, 66560
    v_mfma_f32_16x16x32_bf16 v[40:43], a[44:47], v[184:187], v[40:43]
    v_mfma_f32_16x16x32_bf16 v[44:47], a[44:47], v[188:191], v[44:47]
    ds_read_b128 a[12:15], v3 offset:22528
    s_add_u32 s64, s20, 0x2c80
    buffer_load_dwordx4 v2, s[4:7], s64 offen lds
    s_waitcnt lgkmcnt(4)
    v_mfma_f32_16x16x32_bf16 v[48:51], a[48:51], v[184:187], v[48:51]
    v_mfma_f32_16x16x32_bf16 v[52:55], a[48:51], v[188:191], v[52:55]
    ds_read_b128 a[16:19], v3 offset:24576
    s_add_u32 m0, s21, 67584
    v_mfma_f32_16x16x32_bf16 v[56:59], a[52:55], v[184:187], v[56:59]
    v_mfma_f32_16x16x32_bf16 v[60:63], a[52:55], v[188:191], v[60:63]
    ds_read_b128 a[20:23], v3 offset:26624
    s_add_u32 s64, s20, 0x5480
    buffer_load_dwordx4 v2, s[4:7], s64 offen lds
    v_mfma_f32_16x16x32_bf16 v[64:67], a[56:59], v[184:187], v[64:67]
    v_mfma_f32_16x16x32_bf16 v[68:71], a[56:59], v[188:191], v[68:71]
    ds_read_b128 a[24:27], v3 offset:28672
    s_add_u32 m0, s21, 68608
    v_mfma_f32_16x16x32_bf16 v[72:75], a[60:63], v[184:187], v[72:75]
    v_mfma_f32_16x16x32_bf16 v[76:79], a[60:63], v[188:191], v[76:79]
    ds_read_b128 a[28:31], v3 offset:30720
    s_add_u32 s64, s20, 0x7c80
    buffer_load_dwordx4 v2, s[4:7], s64 offen lds
    s_waitcnt lgkmcnt(4)
    v_mfma_f32_16x16x32_bf16 v[16:19], a[0:3], v[192:195], v[16:19]
    v_mfma_f32_16x16x32_bf16 v[20:23], a[0:3], v[196:199], v[20:23]
    ds_read_b128 a[32:35], v4 offset:16384
    v_mfma_f32_16x16x32_bf16 v[24:27], a[4:7], v[192:195], v[24:27]
    v_mfma_f32_16x16x32_bf16 v[28:31], a[4:7], v[196:199], v[28:31]
    ds_read_b128 a[36:39], v4 offset:18432
    v_mfma_f32_16x16x32_bf16 v[32:35], a[8:11], v[192:195], v[32:35]
    v_mfma_f32_16x16x32_bf16 v[36:39], a[8:11], v[196:199], v[36:39]
    ds_read_b128 a[40:43], v4 offset:20480
    v_mfma_f32_16x16x32_bf16 v[40:43], a[12:15], v[192:195], v[40:43]
    v_mfma_f32_16x16x32_bf16 v[44:47], a[12:15], v[196:199], v[44:47]
    ds_read_b128 a[44:47], v4 offset:22528
    s_waitcnt lgkmcnt(4)
    v_mfma_f32_16x16x32_bf16 v[48:51], a[16:19], v[192:195], v[48:51]
    v_mfma_f32_16x16x32_bf16 v[52:55], a[16:19], v[196:199], v[52:55]
    ds_read_b128 a[48:51], v4 offset:24576
    v_mfma_f32_16x16x32_bf16 v[56:59], a[20:23], v[192:195], v[56:59]
    v_mfma_f32_16x16x32_bf16 v[60:63], a[20:23], v[196:199], v[60:63]
    ds_read_b128 a[52:55], v4 offset:26624
    v_mfma_f32_16x16x32_bf16 v[64:67], a[24:27], v[192:195], v[64:67]
    v_mfma_f32_16x16x32_bf16 v[68:71], a[24:27], v[196:199], v[68:71]
    ds_read_b128 a[56:59], v4 offset:28672
    v_mfma_f32_16x16x32_bf16 v[72:75], a[28:31], v[192:195], v[72:75]
    v_mfma_f32_16x16x32_bf16 v[76:79], a[28:31], v[196:199], v[76:79]
    ds_read_b128 a[60:63], v4 offset:30720
    s_waitcnt vmcnt(8)
    s_barrier
    s_waitcnt lgkmcnt(4)
    v_mfma_f32_16x16x32_bf16 v[16:19], a[32:35], v[200:203], v[16:19]
    v_mfma_f32_16x16x32_bf16 v[20:23], a[32:35], v[204:207], v[20:23]
    ds_read_b128 a[0:3], v3 offset:32768
    s_add_u32 m0, s21, 0
    v_mfma_f32_16x16x32_bf16 v[24:27], a[36:39], v[200:203], v[24:27]
    v_mfma_f32_16x16x32_bf16 v[28:31], a[36:39], v[204:207], v[28:31]
    ds_read_b128 a[4:7], v3 offset:34816
    s_add_u32 s64, s20, 0x50000
    buffer_load_dwordx4 v2, s[4:7], s64 offen lds
    v_mfma_f32_16x16x32_bf16 v[32:35], a[40:43], v[200:203], v[32:35]
    v_mfma_f32_16x16x32_bf16 v[36:39], a[40:43], v[204:207], v[36:39]
    ds_read_b128 a[8:11], v3 offset:36864
    s_add_u32 m0, s21, 1024
    v_mfma_f32_16x16x32_bf16 v[40:43], a[44:47], v[200:203], v[40:43]
    v_mfma_f32_16x16x32_bf16 v[44:47], a[44:47], v[204:207], v[44:47]
    ds_read_b128 a[12:15], v3 offset:38912
    s_add_u32 s64, s20, 0x52800
    buffer_load_dwordx4 v2, s[4:7], s64 offen lds
    s_waitcnt lgkmcnt(4)
    v_mfma_f32_16x16x32_bf16 v[48:51], a[48:51], v[200:203], v[48:51]
    v_mfma_f32_16x16x32_bf16 v[52:55], a[48:51], v[204:207], v[52:55]
    ds_read_b128 a[16:19], v3 offset:40960
    s_add_u32 m0, s21, 2048
    v_mfma_f32_16x16x32_bf16 v[56:59], a[52:55], v[200:203], v[56:59]
    v_mfma_f32_16x16x32_bf16 v[60:63], a[52:55], v[204:207], v[60:63]
    ds_read_b128 a[20:23], v3 offset:43008
    s_add_u32 s64, s20, 0x55000
    buffer_load_dwordx4 v2, s[4:7], s64 offen lds
    v_mfma_f32_16x16x32_bf16 v[64:67], a[56:59], v[200:203], v[64:67]
    v_mfma_f32_16x16x32_bf16 v[68:71], a[56:59], v[204:207], v[68:71]
    ds_read_b128 a[24:27], v3 offset:45056
    s_add_u32 m0, s21, 3072
    v_mfma_f32_16x16x32_bf16 v[72:75], a[60:63], v[200:203], v[72:75]
    v_mfma_f32_16x16x32_bf16 v[76:79], a[60:63], v[204:207], v[76:79]
    ds_read_b128 a[28:31], v3 offset:47104
    s_add_u32 s64, s20, 0x57800
    buffer_load_dwordx4 v2, s[4:7], s64 offen lds
    s_waitcnt lgkmcnt(4)
    v_mfma_f32_16x16x32_bf16 v[16:19], a[0:3], v[208:211], v[16:19]
    v_mfma_f32_16x16x32_bf16 v[20:23], a[0:3], v[212:215], v[20:23]
    ds_read_b128 a[32:35], v4 offset:32768
    v_mfma_f32_16x16x32_bf16 v[24:27], a[4:7], v[208:211], v[24:27]
    v_mfma_f32_16x16x32_bf16 v[28:31], a[4:7], v[212:215], v[28:31]
    ds_read_b128 a[36:39], v4 offset:34816
    v_mfma_f32_16x16x32_bf16 v[32:35], a[8:11], v[208:211], v[32:35]
    v_mfma_f32_16x16x32_bf16 v[36:39], a[8:11], v[212:215], v[36:39]
    ds_read_b128 a[40:43], v4 offset:36864
    v_mfma_f32_16x16x32_bf16 v[40:43], a[12:15], v[208:211], v[40:43]
    v_mfma_f32_16x16x32_bf16 v[44:47], a[12:15], v[212:215], v[44:47]
    ds_read_b128 a[44:47], v4 offset:38912
    s_waitcnt lgkmcnt(4)
    v_mfma_f32_16x16x32_bf16 v[48:51], a[16:19], v[208:211], v[48:51]
    v_mfma_f32_16x16x32_bf16 v[52:55], a[16:19], v[212:215], v[52:55]
    ds_read_b128 a[48:51], v4 offset:40960
    v_mfma_f32_16x16x32_bf16 v[56:59], a[20:23], v[208:211], v[56:59]
    v_mfma_f32_16x16x32_bf16 v[60:63], a[20:23], v[212:215], v[60:63]
    ds_read_b128 a[52:55], v4 offset:43008
    v_mfma_f32_16x16x32_bf16 v[64:67], a[24:27], v[208:211], v[64:67]
    v_mfma_f32_16x16x32_bf16 v[68:71], a[24:27], v[212:215], v[68:71]
    ds_read_b128 a[56:59], v4 offset:45056
    v_mfma_f32_16x16x32_bf16 v[72:75], a[28:31], v[208:211], v[72:75]
    v_mfma_f32_16x16x32_bf16 v[76:79], a[28:31], v[212:215], v[76:79]
    ds_read_b128 a[60:63], v4 offset:47104
    s_waitcnt vmcnt(8)
    s_barrier
    s_waitcnt lgkmcnt(4)
    v_mfma_f32_16x16x32_bf16 v[16:19], a[32:35], v[216:219], v[16:19]
    v_mfma_f32_16x16x32_bf16 v[20:23], a[32:35], v[220:223], v[20:23]
    ds_read_b128 a[0:3], v3 offset:49152
    s_add_u32 m0, s21, 16384
    v_mfma_f32_16x16x32_bf16 v[24:27], a[36:39], v[216:219], v[24:27]
    v_mfma_f32_16x16x32_bf16 v[28:31], a[36:39], v[220:223], v[28:31]
    ds_read_b128 a[4:7], v3 offset:51200
    s_add_u32 s64, s20, 0x50080
    buffer_load_dwordx4 v2, s[4:7], s64 offen lds
    v_mfma_f32_16x16x32_bf16 v[32:35], a[40:43], v[216:219], v[32:35]
    v_mfma_f32_16x16x32_bf16 v[36:39], a[40:43], v[220:223], v[36:39]
    ds_read_b128 a[8:11], v3 offset:53248
    s_add_u32 m0, s21, 17408
    v_mfma_f32_16x16x32_bf16 v[40:43], a[44:47], v[216:219], v[40:43]
    v_mfma_f32_16x16x32_bf16 v[44:47], a[44:47], v[220:223], v[44:47]
    ds_read_b128 a[12:15], v3 offset:55296
    s_add_u32 s64, s20, 0x52880
    buffer_load_dwordx4 v2, s[4:7], s64 offen lds
    s_waitcnt lgkmcnt(4)
    v_mfma_f32_16x16x32_bf16 v[48:51], a[48:51], v[216:219], v[48:51]
    v_mfma_f32_16x16x32_bf16 v[52:55], a[48:51], v[220:223], v[52:55]
    ds_read_b128 a[16:19], v3 offset:57344
    s_add_u32 m0, s21, 18432
    v_mfma_f32_16x16x32_bf16 v[56:59], a[52:55], v[216:219], v[56:59]
    v_mfma_f32_16x16x32_bf16 v[60:63], a[52:55], v[220:223], v[60:63]
    ds_read_b128 a[20:23], v3 offset:59392
    s_add_u32 s64, s20, 0x55080
    buffer_load_dwordx4 v2, s[4:7], s64 offen lds
    v_mfma_f32_16x16x32_bf16 v[64:67], a[56:59], v[216:219], v[64:67]
    v_mfma_f32_16x16x32_bf16 v[68:71], a[56:59], v[220:223], v[68:71]
    ds_read_b128 a[24:27], v3 offset:61440
    s_add_u32 m0, s21, 19456
    v_mfma_f32_16x16x32_bf16 v[72:75], a[60:63], v[216:219], v[72:75]
    v_mfma_f32_16x16x32_bf16 v[76:79], a[60:63], v[220:223], v[76:79]
    ds_read_b128 a[28:31], v3 offset:63488
    s_add_u32 s64, s20, 0x57880
    buffer_load_dwordx4 v2, s[4:7], s64 offen lds
    s_waitcnt lgkmcnt(4)
    v_mfma_f32_16x16x32_bf16 v[16:19], a[0:3], v[224:227], v[16:19]
    v_mfma_f32_16x16x32_bf16 v[20:23], a[0:3], v[228:231], v[20:23]
    ds_read_b128 a[32:35], v4 offset:49152
    v_mfma_f32_16x16x32_bf16 v[24:27], a[4:7], v[224:227], v[24:27]
    v_mfma_f32_16x16x32_bf16 v[28:31], a[4:7], v[228:231], v[28:31]
    ds_read_b128 a[36:39], v4 offset:51200
    v_mfma_f32_16x16x32_bf16 v[32:35], a[8:11], v[224:227], v[32:35]
    v_mfma_f32_16x16x32_bf16 v[36:39], a[8:11], v[228:231], v[36:39]
    ds_read_b128 a[40:43], v4 offset:53248
    v_mfma_f32_16x16x32_bf16 v[40:43], a[12:15], v[224:227], v[40:43]
    v_mfma_f32_16x16x32_bf16 v[44:47], a[12:15], v[228:231], v[44:47]
    ds_read_b128 a[44:47], v4 offset:55296
    s_waitcnt lgkmcnt(4)
    v_mfma_f32_16x16x32_bf16 v[48:51], a[16:19], v[224:227], v[48:51]
    v_mfma_f32_16x16x32_bf16 v[52:55], a[16:19], v[228:231], v[52:55]
    ds_read_b128 a[48:51], v4 offset:57344
    v_mfma_f32_16x16x32_bf16 v[56:59], a[20:23], v[224:227], v[56:59]
    v_mfma_f32_16x16x32_bf16 v[60:63], a[20:23], v[228:231], v[60:63]
    ds_read_b128 a[52:55], v4 offset:59392
    v_mfma_f32_16x16x32_bf16 v[64:67], a[24:27], v[224:227], v[64:67]
    v_mfma_f32_16x16x32_bf16 v[68:71], a[24:27], v[228:231], v[68:71]
    ds_read_b128 a[56:59], v4 offset:61440
    v_mfma_f32_16x16x32_bf16 v[72:75], a[28:31], v[224:227], v[72:75]
    v_mfma_f32_16x16x32_bf16 v[76:79], a[28:31], v[228:231], v[76:79]
    ds_read_b128 a[60:63], v4 offset:63488
    s_waitcnt vmcnt(8)
    s_barrier
    s_waitcnt lgkmcnt(4)
    v_mfma_f32_16x16x32_bf16 v[16:19], a[32:35], v[232:235], v[16:19]
    v_mfma_f32_16x16x32_bf16 v[20:23], a[32:35], v[236:239], v[20:23]
    ds_read_b128 a[0:3], v6 offset:0
    s_add_u32 m0, s21, 32768
    v_mfma_f32_16x16x32_bf16 v[24:27], a[36:39], v[232:235], v[24:27]
    v_mfma_f32_16x16x32_bf16 v[28:31], a[36:39], v[236:239], v[28:31]
    ds_read_b128 a[4:7], v6 offset:2048
    s_add_u32 s64, s20, 0x50100
    buffer_load_dwordx4 v2, s[4:7], s64 offen lds
    v_mfma_f32_16x16x32_bf16 v[32:35], a[40:43], v[232:235], v[32:35]
    v_mfma_f32_16x16x32_bf16 v[36:39], a[40:43], v[236:239], v[36:39]
    ds_read_b128 a[8:11], v6 offset:4096
    s_add_u32 m0, s21, 33792
    v_mfma_f32_16x16x32_bf16 v[40:43], a[44:47], v[232:235], v[40:43]
    v_mfma_f32_16x16x32_bf16 v[44:47], a[44:47], v[236:239], v[44:47]
    ds_read_b128 a[12:15], v6 offset:6144
    s_add_u32 s64, s20, 0x52900
    buffer_load_dwordx4 v2, s[4:7], s64 offen lds
    s_waitcnt lgkmcnt(4)
    v_mfma_f32_16x16x32_bf16 v[48:51], a[48:51], v[232:235], v[48:51]
    v_mfma_f32_16x16x32_bf16 v[52:55], a[48:51], v[236:239], v[52:55]
    ds_read_b128 a[16:19], v6 offset:8192
    s_add_u32 m0, s21, 34816
    v_mfma_f32_16x16x32_bf16 v[56:59], a[52:55], v[232:235], v[56:59]
    v_mfma_f32_16x16x32_bf16 v[60:63], a[52:55], v[236:239], v[60:63]
    ds_read_b128 a[20:23], v6 offset:10240
    s_add_u32 s64, s20, 0x55100
    buffer_load_dwordx4 v2, s[4:7], s64 offen lds
    v_mfma_f32_16x16x32_bf16 v[64:67], a[56:59], v[232:235], v[64:67]
    v_mfma_f32_16x16x32_bf16 v[68:71], a[56:59], v[236:239], v[68:71]
    ds_read_b128 a[24:27], v6 offset:12288
    s_add_u32 m0, s21, 35840
    v_mfma_f32_16x16x32_bf16 v[72:75], a[60:63], v[232:235], v[72:75]
    v_mfma_f32_16x16x32_bf16 v[76:79], a[60:63], v[236:239], v[76:79]
    ds_read_b128 a[28:31], v6 offset:14336
    s_add_u32 s64, s20, 0x57900
    buffer_load_dwordx4 v2, s[4:7], s64 offen lds
    s_waitcnt lgkmcnt(4)
    v_mfma_f32_16x16x32_bf16 v[16:19], a[0:3], v[240:243], v[16:19]
    v_mfma_f32_16x16x32_bf16 v[20:23], a[0:3], v[244:247], v[20:23]
    ds_read_b128 a[32:35], v9 offset:0
    v_mfma_f32_16x16x32_bf16 v[24:27], a[4:7], v[240:243], v[24:27]
    v_mfma_f32_16x16x32_bf16 v[28:31], a[4:7], v[244:247], v[28:31]
    ds_read_b128 a[36:39], v9 offset:2048
    v_mfma_f32_16x16x32_bf16 v[32:35], a[8:11], v[240:243], v[32:35]
    v_mfma_f32_16x16x32_bf16 v[36:39], a[8:11], v[244:247], v[36:39]
    ds_read_b128 a[40:43], v9 offset:4096
    v_mfma_f32_16x16x32_bf16 v[40:43], a[12:15], v[240:243], v[40:43]
    v_mfma_f32_16x16x32_bf16 v[44:47], a[12:15], v[244:247], v[44:47]
    ds_read_b128 a[44:47], v9 offset:6144
    s_waitcnt lgkmcnt(4)
    v_mfma_f32_16x16x32_bf16 v[48:51], a[16:19], v[240:243], v[48:51]
    v_mfma_f32_16x16x32_bf16 v[52:55], a[16:19], v[244:247], v[52:55]
    ds_read_b128 a[48:51], v9 offset:8192
    v_mfma_f32_16x16x32_bf16 v[56:59], a[20:23], v[240:243], v[56:59]
    v_mfma_f32_16x16x32_bf16 v[60:63], a[20:23], v[244:247], v[60:63]
    ds_read_b128 a[52:55], v9 offset:10240
    v_mfma_f32_16x16x32_bf16 v[64:67], a[24:27], v[240:243], v[64:67]
    v_mfma_f32_16x16x32_bf16 v[68:71], a[24:27], v[244:247], v[68:71]
    ds_read_b128 a[56:59], v9 offset:12288
    v_mfma_f32_16x16x32_bf16 v[72:75], a[28:31], v[240:243], v[72:75]
    v_mfma_f32_16x16x32_bf16 v[76:79], a[28:31], v[244:247], v[76:79]
    ds_read_b128 a[60:63], v9 offset:14336
    s_waitcnt vmcnt(8)
    s_barrier
    s_waitcnt lgkmcnt(4)
    v_mfma_f32_16x16x32_bf16 v[16:19], a[32:35], v[248:251], v[16:19]
    v_mfma_f32_16x16x32_bf16 v[20:23], a[32:35], v[252:255], v[20:23]
    ds_read_b128 a[0:3], v3 offset:0
    s_add_u32 m0, s21, 49152
    v_mfma_f32_16x16x32_bf16 v[24:27], a[36:39], v[248:251], v[24:27]
    v_mfma_f32_16x16x32_bf16 v[28:31], a[36:39], v[252:255], v[28:31]
    ds_read_b128 a[4:7], v3 offset:2048
    s_add_u32 s64, s20, 0x50180
    buffer_load_dwordx4 v2, s[4:7], s64 offen lds
    v_mfma_f32_16x16x32_bf16 v[32:35], a[40:43], v[248:251], v[32:35]
    v_mfma_f32_16x16x32_bf16 v[36:39], a[40:43], v[252:255], v[36:39]
    ds_read_b128 a[8:11], v3 offset:4096
    s_add_u32 m0, s21, 50176
    v_mfma_f32_16x16x32_bf16 v[40:43], a[44:47], v[248:251], v[40:43]
    v_mfma_f32_16x16x32_bf16 v[44:47], a[44:47], v[252:255], v[44:47]
    ds_read_b128 a[12:15], v3 offset:6144
    s_add_u32 s64, s20, 0x52980
    buffer_load_dwordx4 v2, s[4:7], s64 offen lds
    s_waitcnt lgkmcnt(4)
    v_mfma_f32_16x16x32_bf16 v[48:51], a[48:51], v[248:251], v[48:51]
    v_mfma_f32_16x16x32_bf16 v[52:55], a[48:51], v[252:255], v[52:55]
    ds_read_b128 a[16:19], v3 offset:8192
    s_add_u32 m0, s21, 51200
    v_mfma_f32_16x16x32_bf16 v[56:59], a[52:55], v[248:251], v[56:59]
    v_mfma_f32_16x16x32_bf16 v[60:63], a[52:55], v[252:255], v[60:63]
    ds_read_b128 a[20:23], v3 offset:10240
    s_add_u32 s64, s20, 0x55180
    buffer_load_dwordx4 v2, s[4:7], s64 offen lds
    v_mfma_f32_16x16x32_bf16 v[64:67], a[56:59], v[248:251], v[64:67]
    v_mfma_f32_16x16x32_bf16 v[68:71], a[56:59], v[252:255], v[68:71]
    ds_read_b128 a[24:27], v3 offset:12288
    s_add_u32 m0, s21, 52224
    v_mfma_f32_16x16x32_bf16 v[72:75], a[60:63], v[248:251], v[72:75]
    v_mfma_f32_16x16x32_bf16 v[76:79], a[60:63], v[252:255], v[76:79]
    ds_read_b128 a[28:31], v3 offset:14336
    s_add_u32 s64, s20, 0x57980
    buffer_load_dwordx4 v2, s[4:7], s64 offen lds
    s_nop 5
    s_mul_i32 s65, s17, 0
    s_add_u32 s65, s65, s22
    s_add_u32 s64, s65, 0
    v_cvt_pk_bf16_f32 v80, v16, v17
    v_cvt_pk_bf16_f32 v81, v18, v19
    v_cvt_pk_bf16_f32 v82, v24, v25
    v_cvt_pk_bf16_f32 v83, v26, v27
    buffer_store_dwordx4 v[80:83], v1, s[4:7], s64 offen sc1
    s_add_u32 s64, s65, 1024
    v_cvt_pk_bf16_f32 v84, v20, v21
    v_cvt_pk_bf16_f32 v85, v22, v23
    v_cvt_pk_bf16_f32 v86, v28, v29
    v_cvt_pk_bf16_f32 v87, v30, v31
    buffer_store_dwordx4 v[84:87], v1, s[4:7], s64 offen sc1
    s_mul_i32 s65, s17, 1
    s_add_u32 s65, s65, s22
    s_add_u32 s64, s65, 0
    v_cvt_pk_bf16_f32 v88, v32, v33
    v_cvt_pk_bf16_f32 v89, v34, v35
    v_cvt_pk_bf16_f32 v90, v40, v41
    v_cvt_pk_bf16_f32 v91, v42, v43
    buffer_store_dwordx4 v[88:91], v1, s[4:7], s64 offen sc1
    s_add_u32 s64, s65, 1024
    v_cvt_pk_bf16_f32 v92, v36, v37
    v_cvt_pk_bf16_f32 v93, v38, v39
    v_cvt_pk_bf16_f32 v94, v44, v45
    v_cvt_pk_bf16_f32 v95, v46, v47
    buffer_store_dwordx4 v[92:95], v1, s[4:7], s64 offen sc1
    s_mul_i32 s65, s17, 2
    s_add_u32 s65, s65, s22
    s_add_u32 s64, s65, 0
    v_cvt_pk_bf16_f32 v80, v48, v49
    v_cvt_pk_bf16_f32 v81, v50, v51
    v_cvt_pk_bf16_f32 v82, v56, v57
    v_cvt_pk_bf16_f32 v83, v58, v59
    buffer_store_dwordx4 v[80:83], v1, s[4:7], s64 offen sc1
    s_add_u32 s64, s65, 1024
    v_cvt_pk_bf16_f32 v84, v52, v53
    v_cvt_pk_bf16_f32 v85, v54, v55
    v_cvt_pk_bf16_f32 v86, v60, v61
    v_cvt_pk_bf16_f32 v87, v62, v63
    buffer_store_dwordx4 v[84:87], v1, s[4:7], s64 offen sc1
    s_mul_i32 s65, s17, 3
    s_add_u32 s65, s65, s22
    s_add_u32 s64, s65, 0
    v_cvt_pk_bf16_f32 v88, v64, v65
    v_cvt_pk_bf16_f32 v89, v66, v67
    v_cvt_pk_bf16_f32 v90, v72, v73
    v_cvt_pk_bf16_f32 v91, v74, v75
    buffer_store_dwordx4 v[88:91], v1, s[4:7], s64 offen sc1
    s_add_u32 s64, s65, 1024
    v_cvt_pk_bf16_f32 v92, v68, v69
    v_cvt_pk_bf16_f32 v93, v70, v71
    v_cvt_pk_bf16_f32 v94, v76, v77
    v_cvt_pk_bf16_f32 v95, v78, v79
    buffer_store_dwordx4 v[92:95], v1, s[4:7], s64 offen sc1
    s_lshl_b32 s64, s19, 1
    s_add_u32 s64, s64, s12
    s_lshl_b32 s64, s64, 9
    s_add_u32 s23, s18, s64
    s_lshl_b32 s64, s17, 3
    s_add_u32 s22, s22, s64
    s_add_u32 s19, s19, 1
    s_add_u32 s20, s20, 0x50000
    s_cmp_lg_u32 s19, 1
    s_cbranch_scc1 GE0_146
    s_waitcnt vmcnt(0)
    s_barrier
    s_cmp_lg_u32 s14, 0
    s_cbranch_scc1 GF_147
    v_mov_b32 v7, 1
    v_mov_b32 v8, 0
    s_mov_b64 exec, 1
    buffer_store_dword v7, v8, s[4:7], s23 offen sc1
    s_mov_b64 exec, -1
GF_147:
GE0_146:
    s_cmp_lt_u32 s19, 8
    s_cbranch_scc1 G_N_LOOP
    s_waitcnt vmcnt(0) lgkmcnt(0)
    s_barrier
    s_cmp_lg_u32 s14, 0
    s_cbranch_scc1 GF_148
    v_mov_b32 v7, 1
    v_mov_b32 v8, 0
    s_mov_b64 exec, 1
    buffer_store_dword v7, v8, s[4:7], s23 offen sc1
    s_mov_b64 exec, -1
GF_148:
    s_cmp_eq_u32 s12, 1
    s_cbranch_scc1 H_OUT
    s_lshl_b32 s88, s3, 5
    s_add_u32 s88, s88, s13
    s_mov_b32 s29, 0
    v_lshlrev_b32 v1, 4, v0
    s_mov_b32 s65, 0
CW_149:
    buffer_load_dwordx2 v[8:9], off, s[60:63], 0 offset:132 sc1
    s_add_u32 s65, s65, 1
    s_waitcnt vmcnt(0)
    v_readfirstlane_b32 s66, v8
    v_readfirstlane_b32 s67, v9
    s_min_u32 s64, s66, s67
    s_cmp_lg_u32 s64, 0
    s_cbranch_scc1 CWD_150
    s_cmp_gt_u32 s65, 65536
    s_cbranch_scc1 CWD_150
    s_sleep 4
    s_branch CW_149
CWD_150:
    s_sub_u32 s66, s66, 1
    s_and_b32 s66, s66, 3
    s_sub_u32 s67, s67, 1
    s_and_b32 s67, s67, 3
    s_mov_b32 s64, s66
    s_mov_b32 s65, s67
    s_and_b32 s64, s64, 3
    s_lshl_b32 s64, s64, 13
    s_and_b32 s65, s65, 3
    s_lshl_b32 s65, s65, 13
    s_add_u32 s25, s64, 0x6000000
    s_add_u32 s30, s65, 0x6200000
    v_bfe_u32 v4, v0, 3, 1
    v_mul_u32_u24 v2, 0x8000, v4
    v_lshrrev_b32 v4, 5, v0
    v_lshl_add_u32 v2, v4, 8, v2
    v_bfe_u32 v4, v0, 4, 1
    v_lshl_add_u32 v2, v4, 7, v2
    v_and_b32 v4, 7, v0
    v_lshl_add_u32 v2, v4, 4, v2
    v_lshrrev_b32 v4, 5, v0
    v_lshlrev_b32 v3, 16, v4
    v_bfe_u32 v4, v0, 4, 1
    v_lshl_add_u32 v3, v4, 7, v3
    v_and_b32 v4, 15, v0
    v_lshl_add_u32 v3, v4, 3, v3
    s_lshl_b32 s26, s13, 11
    s_lshl_b32 s64, s14, 9
    s_add_u32 s26, s26, s64
    s_add_u32 s26, s26, 0xa40000
    s_lshl_b32 s27, s13, 3
    s_add_u32 s27, s27, 0x294004
    s_mov_b32 s28, 0x29a000
    s_mov_b32 s24, 0
    v_lshlrev_b32 v6, 7, v0
MKN_LOOP:
    s_cmp_lg_u32 s24, 10
    s_cbranch_scc1 MKH_151
    v_mov_b32 v10, v2
    v_mov_b32 v11, v3
    s_cmp_ge_u32 s88, 60
    s_cbranch_scc1 NOWO_152
    s_mov_b32 s89, s13
    s_mul_hi_u32 s65, s88, 0xccccccd
    s_mul_i32 s65, s65, 20
    s_sub_u32 s13, s88, s65
    s_load_dwordx2 s[44:45], s[0:1], 40
    s_mov_b32 s46, 0x500000
    s_mov_b32 s47, 0x00020000
    s_waitcnt lgkmcnt(0)
    s_mul_i32 s21, s14, 36864
    v_lshrrev_b32 v7, 2, v0
    v_mul_u32_u24 v4, 1280, v7
    v_bfe_u32 v7, v0, 4, 1
    v_lshlrev_b32 v7, 1, v7
    v_and_b32 v8, 3, v0
    v_xor_b32 v7, v7, v8
    v_lshl_add_u32 v4, v7, 4, v4
    v_lshrrev_b32 v7, 4, v0
    v_lshlrev_b32 v2, 8, v7
    v_bfe_u32 v7, v0, 2, 2
    v_lshl_add_u32 v2, v7, 6, v2
    v_and_b32 v7, 3, v0
    v_lshl_add_u32 v2, v7, 3, v2
    v_add_u32 v2, s21, v2
    v_bfe_u32 v7, v0, 4, 1
    v_lshlrev_b32 v7, 5, v7
    v_sub_u32 v3, 32, v7
    v_add_u32 v3, v3, v2
    v_add_u32 v2, v2, v7
    s_mul_i32 s65, s14, 1310720
    s_lshl_b32 s66, s13, 6
    s_add_u32 s65, s65, s66
    s_add_u32 m0, s21, 0
    s_add_u32 s64, s65, 0x0
    buffer_load_dwordx4 v4, s[44:47], s64 offen lds
    s_add_u32 m0, s21, 1024
    s_add_u32 s64, s65, 0x5000
    buffer_load_dwordx4 v4, s[44:47], s64 offen lds
    s_add_u32 m0, s21, 2048
    s_add_u32 s64, s65, 0xa000
    buffer_load_dwordx4 v4, s[44:47], s64 offen lds
    s_add_u32 m0, s21, 3072
    s_add_u32 s64, s65, 0xf000
    buffer_load_dwordx4 v4, s[44:47], s64 offen lds
    s_add_u32 m0, s21, 4096
    s_add_u32 s64, s65, 0x14000
    buffer_load_dwordx4 v4, s[44:47], s64 offen lds
    s_add_u32 m0, s21, 5120
    s_add_u32 s64, s65, 0x19000
    buffer_load_dwordx4 v4, s[44:47], s64 offen lds
    s_add_u32 m0, s21, 6144
    s_add_u32 s64, s65, 0x1e000
    buffer_load_dwordx4 v4, s[44:47], s64 offen lds
    s_add_u32 m0, s21, 7168
    s_add_u32 s64, s65, 0x23000
    buffer_load_dwordx4 v4, s[44:47], s64 offen lds
    s_add_u32 m0, s21, 8192
    s_add_u32 s64, s65, 0x28000
    buffer_load_dwordx4 v4, s[44:47], s64 offen lds
    s_add_u32 m0, s21, 9216
    s_add_u32 s64, s65, 0x2d000
    buffer_load_dwordx4 v4, s[44:47], s64 offen lds
    s_add_u32 m0, s21, 10240
    s_add_u32 s64, s65, 0x32000
    buffer_load_dwordx4 v4, s[44:47], s64 offen lds
    s_add_u32 m0, s21, 11264
    s_add_u32 s64, s65, 0x37000
    buffer_load_dwordx4 v4, s[44:47], s64 offen lds
    s_add_u32 m0, s21, 12288
    s_add_u32 s64, s65, 0x3c000
    buffer_load_dwordx4 v4, s[44:47], s64 offen lds
    s_add_u32 m0, s21, 13312
    s_add_u32 s64, s65, 0x41000
    buffer_load_dwordx4 v4, s[44:47], s64 offen lds
    s_add_u32 m0, s21, 14336
    s_add_u32 s64, s65, 0x46000
    buffer_load_dwordx4 v4, s[44:47], s64 offen lds
    s_add_u32 m0, s21, 15360
    s_add_u32 s64, s65, 0x4b000
    buffer_load_dwordx4 v4, s[44:47], s64 offen lds
    s_add_u32 m0, s21, 16384
    s_add_u32 s64, s65, 0x50000
    buffer_load_dwordx4 v4, s[44:47], s64 offen lds
    s_add_u32 m0, s21, 17408
    s_add_u32 s64, s65, 0x55000
    buffer_load_dwordx4 v4, s[44:47], s64 offen lds
    s_add_u32 m0, s21, 18432
    s_add_u32 s64, s65, 0x5a000
    buffer_load_dwordx4 v4, s[44:47], s64 offen lds
    s_add_u32 m0, s21, 19456
    s_add_u32 s64, s65, 0x5f000
    buffer_load_dwordx4 v4, s[44:47], s64 offen lds
    s_add_u32 m0, s21, 20480
    s_add_u32 s64, s65, 0x64000
    buffer_load_dwordx4 v4, s[44:47], s64 offen lds
    s_add_u32 m0, s21, 21504
    s_add_u32 s64, s65, 0x69000
    buffer_load_dwordx4 v4, s[44:47], s64 offen lds
    s_add_u32 m0, s21, 22528
    s_add_u32 s64, s65, 0x6e000
    buffer_load_dwordx4 v4, s[44:47], s64 offen lds
    s_add_u32 m0, s21, 23552
    s_add_u32 s64, s65, 0x73000
    buffer_load_dwordx4 v4, s[44:47], s64 offen lds
    s_add_u32 m0, s21, 24576
    s_add_u32 s64, s65, 0x78000
    buffer_load_dwordx4 v4, s[44:47], s64 offen lds
    s_add_u32 m0, s21, 25600
    s_add_u32 s64, s65, 0x7d000
    buffer_load_dwordx4 v4, s[44:47], s64 offen lds
    s_add_u32 m0, s21, 26624
    s_add_u32 s64, s65, 0x82000
    buffer_load_dwordx4 v4, s[44:47], s64 offen lds
    s_add_u32 m0, s21, 27648
    s_add_u32 s64, s65, 0x87000
    buffer_load_dwordx4 v4, s[44:47], s64 offen lds
    s_add_u32 m0, s21, 28672
    s_add_u32 s64, s65, 0x8c000
    buffer_load_dwordx4 v4, s[44:47], s64 offen lds
    s_add_u32 m0, s21, 29696
    s_add_u32 s64, s65, 0x91000
    buffer_load_dwordx4 v4, s[44:47], s64 offen lds
    s_add_u32 m0, s21, 30720
    s_add_u32 s64, s65, 0x96000
    buffer_load_dwordx4 v4, s[44:47], s64 offen lds
    s_add_u32 m0, s21, 31744
    s_add_u32 s64, s65, 0x9b000
    buffer_load_dwordx4 v4, s[44:47], s64 offen lds
    s_add_u32 m0, s21, 32768
    s_add_u32 s64, s65, 0xa0000
    buffer_load_dwordx4 v4, s[44:47], s64 offen lds
    s_add_u32 m0, s21, 33792
    s_add_u32 s64, s65, 0xa5000
    buffer_load_dwordx4 v4, s[44:47], s64 offen lds
    s_add_u32 m0, s21, 34816
    s_add_u32 s64, s65, 0xaa000
    buffer_load_dwordx4 v4, s[44:47], s64 offen lds
    s_add_u32 m0, s21, 35840
    s_add_u32 s64, s65, 0xaf000
    buffer_load_dwordx4 v4, s[44:47], s64 offen lds
    s_waitcnt vmcnt(32)
    ds_read_b64_tr_b16 a[0:1], v2 offset:0
    ds_read_b64_tr_b16 a[2:3], v2 offset:1024
    ds_read_b64_tr_b16 a[4:5], v3 offset:0
    ds_read_b64_tr_b16 a[6:7], v3 offset:1024
    ds_read_b64_tr_b16 a[8:9], v2 offset:2048
    ds_read_b64_tr_b16 a[10:11], v2 offset:3072
    ds_read_b64_tr_b16 a[12:13], v3 offset:2048
    ds_read_b64_tr_b16 a[14:15], v3 offset:3072
    s_waitcnt lgkmcnt(0)
    s_add_u32 m0, s21, 0
    s_add_u32 s64, s65, 0xb4000
    buffer_load_dwordx4 v4, s[44:47], s64 offen lds
    s_add_u32 m0, s21, 1024
    s_add_u32 s64, s65, 0xb9000
    buffer_load_dwordx4 v4, s[44:47], s64 offen lds
    s_add_u32 m0, s21, 2048
    s_add_u32 s64, s65, 0xbe000
    buffer_load_dwordx4 v4, s[44:47], s64 offen lds
    s_add_u32 m0, s21, 3072
    s_add_u32 s64, s65, 0xc3000
    buffer_load_dwordx4 v4, s[44:47], s64 offen lds
    s_waitcnt vmcnt(32)
    ds_read_b64_tr_b16 a[16:17], v2 offset:4096
    ds_read_b64_tr_b16 a[18:19], v2 offset:5120
    ds_read_b64_tr_b16 a[20:21], v3 offset:4096
    ds_read_b64_tr_b16 a[22:23], v3 offset:5120
    ds_read_b64_tr_b16 a[24:25], v2 offset:6144
    ds_read_b64_tr_b16 a[26:27], v2 offset:7168
    ds_read_b64_tr_b16 a[28:29], v3 offset:6144
    ds_read_b64_tr_b16 a[30:31], v3 offset:7168
    s_waitcnt lgkmcnt(0)
    s_add_u32 m0, s21, 4096
    s_add_u32 s64, s65, 0xc8000
    buffer_load_dwordx4 v4, s[44:47], s64 offen lds
    s_add_u32 m0, s21, 5120
    s_add_u32 s64, s65, 0xcd000
    buffer_load_dwordx4 v4, s[44:47], s64 offen lds
    s_add_u32 m0, s21, 6144
    s_add_u32 s64, s65, 0xd2000
    buffer_load_dwordx4 v4, s[44:47], s64 offen lds
    s_add_u32 m0, s21, 7168
    s_add_u32 s64, s65, 0xd7000
    buffer_load_dwordx4 v4, s[44:47], s64 offen lds
    s_waitcnt vmcnt(32)
    ds_read_b64_tr_b16 a[32:33], v2 offset:8192
    ds_read_b64_tr_b16 a[34:35], v2 offset:9216
    ds_read_b64_tr_b16 a[36:37], v3 offset:8192
    ds_read_b64_tr_b16 a[38:39], v3 offset:9216
    ds_read_b64_tr_b16 a[40:41], v2 offset:10240
    ds_read_b64_tr_b16 a[42:43], v2 offset:11264
    ds_read_b64_tr_b16 a[44:45], v3 offset:10240
    ds_read_b64_tr_b16 a[46:47], v3 offset:11264
    s_waitcnt lgkmcnt(0)
    s_add_u32 m0, s21, 8192
    s_add_u32 s64, s65, 0xdc000
    buffer_load_dwordx4 v4, s[44:47], s64 offen lds
    s_add_u32 m0, s21, 9216
    s_add_u32 s64, s65, 0xe1000
    buffer_load_dwordx4 v4, s[44:47], s64 offen lds
    s_add_u32 m0, s21, 10240
    s_add_u32 s64, s65, 0xe6000
    buffer_load_dwordx4 v4, s[44:47], s64 offen lds
    s_add_u32 m0, s21, 11264
    s_add_u32 s64, s65, 0xeb000
    buffer_load_dwordx4 v4, s[44:47], s64 offen lds
    s_waitcnt vmcnt(32)
    ds_read_b64_tr_b16 a[48:49], v2 offset:12288
    ds_read_b64_tr_b16 a[50:51], v2 offset:13312
    ds_read_b64_tr_b16 a[52:53], v3 offset:12288
    ds_read_b64_tr_b16 a[54:55], v3 offset:13312
    ds_read_b64_tr_b16 a[56:57], v2 offset:14336
    ds_read_b64_tr_b16 a[58:59], v2 offset:15360
    ds_read_b64_tr_b16 a[60:61], v3 offset:14336
    ds_read_b64_tr_b16 a[62:63], v3 offset:15360
    s_waitcnt lgkmcnt(0)
    s_add_u32 m0, s21, 12288
    s_add_u32 s64, s65, 0xf0000
    buffer_load_dwordx4 v4, s[44:47], s64 offen lds
    s_add_u32 m0, s21, 13312
    s_add_u32 s64, s65, 0xf5000
    buffer_load_dwordx4 v4, s[44:47], s64 offen lds
    s_add_u32 m0, s21, 14336
    s_add_u32 s64, s65, 0xfa000
    buffer_load_dwordx4 v4, s[44:47], s64 offen lds
    s_add_u32 m0, s21, 15360
    s_add_u32 s64, s65, 0xff000
    buffer_load_dwordx4 v4, s[44:47], s64 offen lds
    s_waitcnt vmcnt(32)
    ds_read_b64_tr_b16 a[64:65], v2 offset:16384
    ds_read_b64_tr_b16 a[66:67], v2 offset:17408
    ds_read_b64_tr_b16 a[68:69], v3 offset:16384
    ds_read_b64_tr_b16 a[70:71], v3 offset:17408
    ds_read_b64_tr_b16 a[72:73], v2 offset:18432
    ds_read_b64_tr_b16 a[74:75], v2 offset:19456
    ds_read_b64_tr_b16 a[76:77], v3 offset:18432
    ds_read_b64_tr_b16 a[78:79], v3 offset:19456
    s_waitcnt lgkmcnt(0)
    s_add_u32 m0, s21, 16384
    s_add_u32 s64, s65, 0x104000
    buffer_load_dwordx4 v4, s[44:47], s64 offen lds
    s_add_u32 m0, s21, 17408
    s_add_u32 s64, s65, 0x109000
    buffer_load_dwordx4 v4, s[44:47], s64 offen lds
    s_add_u32 m0, s21, 18432
    s_add_u32 s64, s65, 0x10e000
    buffer_load_dwordx4 v4, s[44:47], s64 offen lds
    s_add_u32 m0, s21, 19456
    s_add_u32 s64, s65, 0x113000
    buffer_load_dwordx4 v4, s[44:47], s64 offen lds
    s_waitcnt vmcnt(32)
    ds_read_b64_tr_b16 a[80:81], v2 offset:20480
    ds_read_b64_tr_b16 a[82:83], v2 offset:21504
    ds_read_b64_tr_b16 a[84:85], v3 offset:20480
    ds_read_b64_tr_b16 a[86:87], v3 offset:21504
    ds_read_b64_tr_b16 a[88:89], v2 offset:22528
    ds_read_b64_tr_b16 a[90:91], v2 offset:23552
    ds_read_b64_tr_b16 a[92:93], v3 offset:22528
    ds_read_b64_tr_b16 a[94:95], v3 offset:23552
    s_waitcnt lgkmcnt(0)
    s_add_u32 m0, s21, 20480
    s_add_u32 s64, s65, 0x118000
    buffer_load_dwordx4 v4, s[44:47], s64 offen lds
    s_add_u32 m0, s21, 21504
    s_add_u32 s64, s65, 0x11d000
    buffer_load_dwordx4 v4, s[44:47], s64 offen lds
    s_add_u32 m0, s21, 22528
    s_add_u32 s64, s65, 0x122000
    buffer_load_dwordx4 v4, s[44:47], s64 offen lds
    s_add_u32 m0, s21, 23552
    s_add_u32 s64, s65, 0x127000
    buffer_load_dwordx4 v4, s[44:47], s64 offen lds
    s_waitcnt vmcnt(32)
    ds_read_b64_tr_b16 a[96:97], v2 offset:24576
    ds_read_b64_tr_b16 a[98:99], v2 offset:25600
    ds_read_b64_tr_b16 a[100:101], v3 offset:24576
    ds_read_b64_tr_b16 a[102:103], v3 offset:25600
    ds_read_b64_tr_b16 a[104:105], v2 offset:26624
    ds_read_b64_tr_b16 a[106:107], v2 offset:27648
    ds_read_b64_tr_b16 a[108:109], v3 offset:26624
    ds_read_b64_tr_b16 a[110:111], v3 offset:27648
    s_waitcnt lgkmcnt(0)
    s_add_u32 m0, s21, 24576
    s_add_u32 s64, s65, 0x12c000
    buffer_load_dwordx4 v4, s[44:47], s64 offen lds
    s_add_u32 m0, s21, 25600
    s_add_u32 s64, s65, 0x131000
    buffer_load_dwordx4 v4, s[44:47], s64 offen lds
    s_add_u32 m0, s21, 26624
    s_add_u32 s64, s65, 0x136000
    buffer_load_dwordx4 v4, s[44:47], s64 offen lds
    s_add_u32 m0, s21, 27648
    s_add_u32 s64, s65, 0x13b000
    buffer_load_dwordx4 v4, s[44:47], s64 offen lds
    s_waitcnt vmcnt(32)
    ds_read_b64_tr_b16 a[112:113], v2 offset:28672
    ds_read_b64_tr_b16 a[114:115], v2 offset:29696
    ds_read_b64_tr_b16 a[116:117], v3 offset:28672
    ds_read_b64_tr_b16 a[118:119], v3 offset:29696
    ds_read_b64_tr_b16 a[120:121], v2 offset:30720
    ds_read_b64_tr_b16 a[122:123], v2 offset:31744
    ds_read_b64_tr_b16 a[124:125], v3 offset:30720
    ds_read_b64_tr_b16 a[126:127], v3 offset:31744
    s_waitcnt lgkmcnt(0)
    s_waitcnt vmcnt(28)
    ds_read_b64_tr_b16 a[128:129], v2 offset:32768
    ds_read_b64_tr_b16 a[130:131], v2 offset:33792
    ds_read_b64_tr_b16 a[132:133], v3 offset:32768
    ds_read_b64_tr_b16 a[134:135], v3 offset:33792
    ds_read_b64_tr_b16 a[136:137], v2 offset:34816
    ds_read_b64_tr_b16 a[138:139], v2 offset:35840
    ds_read_b64_tr_b16 a[140:141], v3 offset:34816
    ds_read_b64_tr_b16 a[142:143], v3 offset:35840
    s_waitcnt lgkmcnt(0)
    s_waitcnt vmcnt(24)
    ds_read_b64_tr_b16 a[144:145], v2 offset:0
    ds_read_b64_tr_b16 a[146:147], v2 offset:1024
    ds_read_b64_tr_b16 a[148:149], v3 offset:0
    ds_read_b64_tr_b16 a[150:151], v3 offset:1024
    ds_read_b64_tr_b16 a[152:153], v2 offset:2048
    ds_read_b64_tr_b16 a[154:155], v2 offset:3072
    ds_read_b64_tr_b16 a[156:157], v3 offset:2048
    ds_read_b64_tr_b16 a[158:159], v3 offset:3072
    s_waitcnt lgkmcnt(0)
    s_waitcnt vmcnt(20)
    ds_read_b64_tr_b16 a[160:161], v2 offset:4096
    ds_read_b64_tr_b16 a[162:163], v2 offset:5120
    ds_read_b64_tr_b16 a[164:165], v3 offset:4096
    ds_read_b64_tr_b16 a[166:167], v3 offset:5120
    ds_read_b64_tr_b16 a[168:169], v2 offset:6144
    ds_read_b64_tr_b16 a[170:171], v2 offset:7168
    ds_read_b64_tr_b16 a[172:173], v3 offset:6144
    ds_read_b64_tr_b16 a[174:175], v3 offset:7168
    s_waitcnt lgkmcnt(0)
    s_waitcnt vmcnt(16)
    ds_read_b64_tr_b16 a[176:177], v2 offset:8192
    ds_read_b64_tr_b16 a[178:179], v2 offset:9216
    ds_read_b64_tr_b16 a[180:181], v3 offset:8192
    ds_read_b64_tr_b16 a[182:183], v3 offset:9216
    ds_read_b64_tr_b16 a[184:185], v2 offset:10240
    ds_read_b64_tr_b16 a[186:187], v2 offset:11264
    ds_read_b64_tr_b16 a[188:189], v3 offset:10240
    ds_read_b64_tr_b16 a[190:191], v3 offset:11264
    s_waitcnt lgkmcnt(0)
    s_waitcnt vmcnt(12)
    ds_read_b64_tr_b16 a[192:193], v2 offset:12288
    ds_read_b64_tr_b16 a[194:195], v2 offset:13312
    ds_read_b64_tr_b16 a[196:197], v3 offset:12288
    ds_read_b64_tr_b16 a[198:199], v3 offset:13312
    ds_read_b64_tr_b16 a[200:201], v2 offset:14336
    ds_read_b64_tr_b16 a[202:203], v2 offset:15360
    ds_read_b64_tr_b16 a[204:205], v3 offset:14336
    ds_read_b64_tr_b16 a[206:207], v3 offset:15360
    s_waitcnt lgkmcnt(0)
    s_waitcnt vmcnt(8)
    ds_read_b64_tr_b16 a[208:209], v2 offset:16384
    ds_read_b64_tr_b16 a[210:211], v2 offset:17408
    ds_read_b64_tr_b16 a[212:213], v3 offset:16384
    ds_read_b64_tr_b16 a[214:215], v3 offset:17408
    ds_read_b64_tr_b16 a[216:217], v2 offset:18432
    ds_read_b64_tr_b16 a[218:219], v2 offset:19456
    ds_read_b64_tr_b16 a[220:221], v3 offset:18432
    ds_read_b64_tr_b16 a[222:223], v3 offset:19456
    s_waitcnt lgkmcnt(0)
    s_waitcnt vmcnt(4)
    ds_read_b64_tr_b16 a[224:225], v2 offset:20480
    ds_read_b64_tr_b16 a[226:227], v2 offset:21504
    ds_read_b64_tr_b16 a[228:229], v3 offset:20480
    ds_read_b64_tr_b16 a[230:231], v3 offset:21504
    ds_read_b64_tr_b16 a[232:233], v2 offset:22528
    ds_read_b64_tr_b16 a[234:235], v2 offset:23552
    ds_read_b64_tr_b16 a[236:237], v3 offset:22528
    ds_read_b64_tr_b16 a[238:239], v3 offset:23552
    s_waitcnt lgkmcnt(0)
    s_waitcnt vmcnt(0)
    ds_read_b64_tr_b16 a[240:241], v2 offset:24576
    ds_read_b64_tr_b16 a[242:243], v2 offset:25600
    ds_read_b64_tr_b16 a[244:245], v3 offset:24576
    ds_read_b64_tr_b16 a[246:247], v3 offset:25600
    ds_read_b64_tr_b16 a[248:249], v2 offset:26624
    ds_read_b64_tr_b16 a[250:251], v2 offset:27648
    ds_read_b64_tr_b16 a[252:253], v3 offset:26624
    ds_read_b64_tr_b16 a[254:255], v3 offset:27648
    s_waitcnt lgkmcnt(0)
    s_mov_b32 s13, s89
NOWO_152:
    v_mov_b32 v2, v10
    v_mov_b32 v3, v11
MKH_151:
    s_cmp_lg_u32 s24, 31
    s_mov_b64 exec, 0xf
    s_cbranch_scc1 MKL_153
    s_mov_b64 exec, -1
    v_bfe_u32 v4, v0, 3, 1
    v_mul_u32_u24 v4, 0x8000, v4
    v_sub_u32 v2, v2, v4
    s_mov_b64 exec, 3
MKL_153:
MKN_M_154:
    buffer_load_dword v5, v6, s[4:7], s28 offen sc1
    s_add_u32 s29, s29, 1
    s_waitcnt vmcnt(0)
    v_cmp_eq_u32 vcc, 0, v5
    s_cbranch_vccz MKN_MD_155
    s_cmp_gt_u32 s29, 262144
    s_cbranch_scc1 MKN_MD_155
    s_sleep 1
    s_branch MKN_M_154
MKN_MD_155:
    s_mov_b64 exec, -1
MKR_156:
    s_add_u32 s64, s25, 0x0
    buffer_load_dwordx4 v[16:19], v2, s[4:7], s64 offen sc1
    s_add_u32 s64, s25, 0x200
    buffer_load_dwordx4 v[20:23], v2, s[4:7], s64 offen sc1
    s_add_u32 s64, s25, 0x400
    buffer_load_dwordx4 v[24:27], v2, s[4:7], s64 offen sc1
    s_add_u32 s64, s25, 0x600
    buffer_load_dwordx4 v[28:31], v2, s[4:7], s64 offen sc1
    s_add_u32 s64, s25, 0x800
    buffer_load_dwordx4 v[32:35], v2, s[4:7], s64 offen sc1
    s_add_u32 s64, s25, 0xa00
    buffer_load_dwordx4 v[36:39], v2, s[4:7], s64 offen sc1
    s_add_u32 s64, s25, 0xc00
    buffer_load_dwordx4 v[40:43], v2, s[4:7], s64 offen sc1
    s_add_u32 s64, s25, 0xe00
    buffer_load_dwordx4 v[44:47], v2, s[4:7], s64 offen sc1
    s_add_u32 s64, s25, 0x1000
    buffer_load_dwordx4 v[48:51], v2, s[4:7], s64 offen sc1
    s_add_u32 s64, s25, 0x1200
    buffer_load_dwordx4 v[52:55], v2, s[4:7], s64 offen sc1
    s_add_u32 s64, s30, 0x0
    buffer_load_dwordx4 v[56:59], v2, s[4:7], s64 offen sc1
    s_add_u32 s64, s30, 0x200
    buffer_load_dwordx4 v[60:63], v2, s[4:7], s64 offen sc1
    s_add_u32 s64, s30, 0x400
    buffer_load_dwordx4 v[64:67], v2, s[4:7], s64 offen sc1
    s_add_u32 s64, s30, 0x600
    buffer_load_dwordx4 v[68:71], v2, s[4:7], s64 offen sc1
    s_add_u32 s64, s30, 0x800
    buffer_load_dwordx4 v[72:75], v2, s[4:7], s64 offen sc1
    s_add_u32 s64, s30, 0xa00
    buffer_load_dwordx4 v[76:79], v2, s[4:7], s64 offen sc1
    s_add_u32 s64, s30, 0xc00
    buffer_load_dwordx4 v[80:83], v2, s[4:7], s64 offen sc1
    s_add_u32 s64, s30, 0xe00
    buffer_load_dwordx4 v[84:87], v2, s[4:7], s64 offen sc1
    s_add_u32 s64, s30, 0x1000
    buffer_load_dwordx4 v[88:91], v2, s[4:7], s64 offen sc1
    s_add_u32 s64, s30, 0x1200
    buffer_load_dwordx4 v[92:95], v2, s[4:7], s64 offen sc1
    s_add_u32 s29, s29, 1
    s_waitcnt vmcnt(0)
    v_max3_u32 v4, v19, v23, v27
    v_max3_u32 v4, v4, v31, v35
    v_max3_u32 v4, v4, v39, v43
    v_max3_u32 v4, v4, v47, v51
    v_max3_u32 v4, v4, v55, v59
    v_max3_u32 v4, v4, v63, v67
    v_max3_u32 v4, v4, v71, v75
    v_max3_u32 v4, v4, v79, v83
    v_max3_u32 v4, v4, v87, v91
    v_max_u32 v4, v4, v95
    v_cmp_eq_u32 vcc, -1, v4
    s_cbranch_vccz MKO_157
    s_cmp_gt_u32 s29, 262144
    s_cbranch_scc0 MKR_156
MKO_157:
    v_mfma_f32_16x16x32_bf16 v[8:11], v[16:19], v[96:99], 0
    v_mfma_f32_16x16x32_bf16 v[12:15], v[16:19], v[100:103], 0
    v_mfma_f32_16x16x32_bf16 v[8:11], v[20:23], v[104:107], v[8:11]
    v_mfma_f32_16x16x32_bf16 v[12:15], v[20:23], v[108:111], v[12:15]
    v_mfma_f32_16x16x32_bf16 v[8:11], v[24:27], v[112:115], v[8:11]
    v_mfma_f32_16x16x32_bf16 v[12:15], v[24:27], v[116:119], v[12:15]
    v_mfma_f32_16x16x32_bf16 v[8:11], v[28:31], v[120:123], v[8:11]
    v_mfma_f32_16x16x32_bf16 v[12:15], v[28:31], v[124:127], v[12:15]
    v_mfma_f32_16x16x32_bf16 v[8:11], v[32:35], v[128:131], v[8:11]
    v_mfma_f32_16x16x32_bf16 v[12:15], v[32:35], v[132:135], v[12:15]
    v_mfma_f32_16x16x32_bf16 v[8:11], v[36:39], v[136:139], v[8:11]
    v_mfma_f32_16x16x32_bf16 v[12:15], v[36:39], v[140:143], v[12:15]
    v_mfma_f32_16x16x32_bf16 v[8:11], v[40:43], v[144:147], v[8:11]
    v_mfma_f32_16x16x32_bf16 v[12:15], v[40:43], v[148:151], v[12:15]
    v_mfma_f32_16x16x32_bf16 v[8:11], v[44:47], v[152:155], v[8:11]
    v_mfma_f32_16x16x32_bf16 v[12:15], v[44:47], v[156:159], v[12:15]
    v_mfma_f32_16x16x32_bf16 v[8:11], v[48:51], v[160:163], v[8:11]
    v_mfma_f32_16x16x32_bf16 v[12:15], v[48:51], v[164:167], v[12:15]
    v_mfma_f32_16x16x32_bf16 v[8:11], v[52:55], v[168:171], v[8:11]
    v_mfma_f32_16x16x32_bf16 v[12:15], v[52:55], v[172:175], v[12:15]
    v_mfma_f32_16x16x32_bf16 v[8:11], v[56:59], v[176:179], v[8:11]
    v_mfma_f32_16x16x32_bf16 v[12:15], v[56:59], v[180:183], v[12:15]
    v_mfma_f32_16x16x32_bf16 v[8:11], v[60:63], v[184:187], v[8:11]
    v_mfma_f32_16x16x32_bf16 v[12:15], v[60:63], v[188:191], v[12:15]
    v_mfma_f32_16x16x32_bf16 v[8:11], v[64:67], v[192:195], v[8:11]
    v_mfma_f32_16x16x32_bf16 v[12:15], v[64:67], v[196:199], v[12:15]
    v_mfma_f32_16x16x32_bf16 v[8:11], v[68:71], v[200:203], v[8:11]
    v_mfma_f32_16x16x32_bf16 v[12:15], v[68:71], v[204:207], v[12:15]
    v_mfma_f32_16x16x32_bf16 v[8:11], v[72:75], v[208:211], v[8:11]
    v_mfma_f32_16x16x32_bf16 v[12:15], v[72:75], v[212:215], v[12:15]
    v_mfma_f32_16x16x32_bf16 v[8:11], v[76:79], v[216:219], v[8:11]
    v_mfma_f32_16x16x32_bf16 v[12:15], v[76:79], v[220:223], v[12:15]
    v_mfma_f32_16x16x32_bf16 v[8:11], v[80:83], v[224:227], v[8:11]
    v_mfma_f32_16x16x32_bf16 v[12:15], v[80:83], v[228:231], v[12:15]
    v_mfma_f32_16x16x32_bf16 v[8:11], v[84:87], v[232:235], v[8:11]
    v_mfma_f32_16x16x32_bf16 v[12:15], v[84:87], v[236:239], v[12:15]
    v_mfma_f32_16x16x32_bf16 v[8:11], v[88:91], v[240:243], v[8:11]
    v_mfma_f32_16x16x32_bf16 v[12:15], v[88:91], v[244:247], v[12:15]
    v_mfma_f32_16x16x32_bf16 v[8:11], v[92:95], v[248:251], v[8:11]
    v_mfma_f32_16x16x32_bf16 v[12:15], v[92:95], v[252:255], v[12:15]
    s_nop 7
    v_cvt_pk_bf16_f32 v16, v8, v9
    v_cvt_pk_bf16_f32 v17, v10, v11
    v_cvt_pk_bf16_f32 v18, v12, v13
    v_cvt_pk_bf16_f32 v19, v14, v15
    buffer_store_dwordx2 v[16:17], v3, s[4:7], s26 offen sc1
    buffer_store_dwordx2 v[18:19], v3, s[4:7], s26 offen offset:256 sc1
    s_waitcnt vmcnt(0)
    s_barrier
    s_cmp_lg_u32 s14, 0
    s_cbranch_scc1 GF_158
    v_mov_b32 v7, 1
    v_mov_b32 v8, 0
    s_mov_b64 exec, 1
    buffer_store_dword v7, v8, s[4:7], s27 offen sc1
    s_mov_b64 exec, -1
GF_158:
    s_add_u32 s25, s25, 0x10000
    s_add_u32 s30, s30, 0x10000
    s_add_u32 s26, s26, 0x20000
    s_add_u32 s27, s27, 256
    s_add_u32 s28, s28, 512
    s_add_u32 s24, s24, 1
    s_cmp_lt_u32 s24, 32
    s_cbranch_scc1 MKN_LOOP
    s_cmp_ge_u32 s88, 60
    s_cbranch_scc1 M_EXIT
    s_branch H_EXTRA
H_OUT:
    s_lshl_b32 s64, s3, 5
    s_add_u32 s64, s64, s13
    s_cmp_ge_u32 s64, 60
    s_cbranch_scc1 M_EXIT
    s_mul_hi_u32 s12, s64, 0xccccccd
    s_mul_i32 s65, s12, 20
    s_sub_u32 s13, s64, s65
    s_load_dwordx2 s[44:45], s[0:1], 40
    s_mov_b32 s46, 0x500000
    s_mov_b32 s47, 0x00020000
    s_load_dwordx2 s[48:49], s[0:1], 0
    s_mov_b32 s50, 0x280000
    s_mov_b32 s51, 0x00020000
    s_load_dwordx2 s[52:53], s[0:1], 96
    s_mov_b32 s54, 0x280000
    s_mov_b32 s55, 0x00020000
    s_mov_b32 s36, -1
    s_mov_b32 s37, 0
    s_waitcnt lgkmcnt(0)
    s_mul_i32 s21, s14, 36864
    v_lshrrev_b32 v7, 2, v0
    v_mul_u32_u24 v4, 1280, v7
    v_bfe_u32 v7, v0, 4, 1
    v_lshlrev_b32 v7, 1, v7
    v_and_b32 v8, 3, v0
    v_xor_b32 v7, v7, v8
    v_lshl_add_u32 v4, v7, 4, v4
    v_lshrrev_b32 v7, 4, v0
    v_lshlrev_b32 v2, 8, v7
    v_bfe_u32 v7, v0, 2, 2
    v_lshl_add_u32 v2, v7, 6, v2
    v_and_b32 v7, 3, v0
    v_lshl_add_u32 v2, v7, 3, v2
    v_add_u32 v2, s21, v2
    v_bfe_u32 v7, v0, 4, 1
    v_lshlrev_b32 v7, 5, v7
    v_sub_u32 v3, 32, v7
    v_add_u32 v3, v3, v2
    v_add_u32 v2, v2, v7
    s_mul_i32 s65, s14, 1310720
    s_lshl_b32 s66, s13, 6
    s_add_u32 s65, s65, s66
    s_add_u32 m0, s21, 0
    s_add_u32 s64, s65, 0x0
    buffer_load_dwordx4 v4, s[44:47], s64 offen lds
    s_add_u32 m0, s21, 1024
    s_add_u32 s64, s65, 0x5000
    buffer_load_dwordx4 v4, s[44:47], s64 offen lds
    s_add_u32 m0, s21, 2048
    s_add_u32 s64, s65, 0xa000
    buffer_load_dwordx4 v4, s[44:47], s64 offen lds
    s_add_u32 m0, s21, 3072
    s_add_u32 s64, s65, 0xf000
    buffer_load_dwordx4 v4, s[44:47], s64 offen lds
    s_add_u32 m0, s21, 4096
    s_add_u32 s64, s65, 0x14000
    buffer_load_dwordx4 v4, s[44:47], s64 offen lds
    s_add_u32 m0, s21, 5120
    s_add_u32 s64, s65, 0x19000
    buffer_load_dwordx4 v4, s[44:47], s64 offen lds
    s_add_u32 m0, s21, 6144
    s_add_u32 s64, s65, 0x1e000
    buffer_load_dwordx4 v4, s[44:47], s64 offen lds
    s_add_u32 m0, s21, 7168
    s_add_u32 s64, s65, 0x23000
    buffer_load_dwordx4 v4, s[44:47], s64 offen lds
    s_add_u32 m0, s21, 8192
    s_add_u32 s64, s65, 0x28000
    buffer_load_dwordx4 v4, s[44:47], s64 offen lds
    s_add_u32 m0, s21, 9216
    s_add_u32 s64, s65, 0x2d000
    buffer_load_dwordx4 v4, s[44:47], s64 offen lds
    s_add_u32 m0, s21, 10240
    s_add_u32 s64, s65, 0x32000
    buffer_load_dwordx4 v4, s[44:47], s64 offen lds
    s_add_u32 m0, s21, 11264
    s_add_u32 s64, s65, 0x37000
    buffer_load_dwordx4 v4, s[44:47], s64 offen lds
    s_add_u32 m0, s21, 12288
    s_add_u32 s64, s65, 0x3c000
    buffer_load_dwordx4 v4, s[44:47], s64 offen lds
    s_add_u32 m0, s21, 13312
    s_add_u32 s64, s65, 0x41000
    buffer_load_dwordx4 v4, s[44:47], s64 offen lds
    s_add_u32 m0, s21, 14336
    s_add_u32 s64, s65, 0x46000
    buffer_load_dwordx4 v4, s[44:47], s64 offen lds
    s_add_u32 m0, s21, 15360
    s_add_u32 s64, s65, 0x4b000
    buffer_load_dwordx4 v4, s[44:47], s64 offen lds
    s_add_u32 m0, s21, 16384
    s_add_u32 s64, s65, 0x50000
    buffer_load_dwordx4 v4, s[44:47], s64 offen lds
    s_add_u32 m0, s21, 17408
    s_add_u32 s64, s65, 0x55000
    buffer_load_dwordx4 v4, s[44:47], s64 offen lds
    s_add_u32 m0, s21, 18432
    s_add_u32 s64, s65, 0x5a000
    buffer_load_dwordx4 v4, s[44:47], s64 offen lds
    s_add_u32 m0, s21, 19456
    s_add_u32 s64, s65, 0x5f000
    buffer_load_dwordx4 v4, s[44:47], s64 offen lds
    s_add_u32 m0, s21, 20480
    s_add_u32 s64, s65, 0x64000
    buffer_load_dwordx4 v4, s[44:47], s64 offen lds
    s_add_u32 m0, s21, 21504
    s_add_u32 s64, s65, 0x69000
    buffer_load_dwordx4 v4, s[44:47], s64 offen lds
    s_add_u32 m0, s21, 22528
    s_add_u32 s64, s65, 0x6e000
    buffer_load_dwordx4 v4, s[44:47], s64 offen lds
    s_add_u32 m0, s21, 23552
    s_add_u32 s64, s65, 0x73000
    buffer_load_dwordx4 v4, s[44:47], s64 offen lds
    s_add_u32 m0, s21, 24576
    s_add_u32 s64, s65, 0x78000
    buffer_load_dwordx4 v4, s[44:47], s64 offen lds
    s_add_u32 m0, s21, 25600
    s_add_u32 s64, s65, 0x7d000
    buffer_load_dwordx4 v4, s[44:47], s64 offen lds
    s_add_u32 m0, s21, 26624
    s_add_u32 s64, s65, 0x82000
    buffer_load_dwordx4 v4, s[44:47], s64 offen lds
    s_add_u32 m0, s21, 27648
    s_add_u32 s64, s65, 0x87000
    buffer_load_dwordx4 v4, s[44:47], s64 offen lds
    s_add_u32 m0, s21, 28672
    s_add_u32 s64, s65, 0x8c000
    buffer_load_dwordx4 v4, s[44:47], s64 offen lds
    s_add_u32 m0, s21, 29696
    s_add_u32 s64, s65, 0x91000
    buffer_load_dwordx4 v4, s[44:47], s64 offen lds
    s_add_u32 m0, s21, 30720
    s_add_u32 s64, s65, 0x96000
    buffer_load_dwordx4 v4, s[44:47], s64 offen lds
    s_add_u32 m0, s21, 31744
    s_add_u32 s64, s65, 0x9b000
    buffer_load_dwordx4 v4, s[44:47], s64 offen lds
    s_add_u32 m0, s21, 32768
    s_add_u32 s64, s65, 0xa0000
    buffer_load_dwordx4 v4, s[44:47], s64 offen lds
    s_add_u32 m0, s21, 33792
    s_add_u32 s64, s65, 0xa5000
    buffer_load_dwordx4 v4, s[44:47], s64 offen lds
    s_add_u32 m0, s21, 34816
    s_add_u32 s64, s65, 0xaa000
    buffer_load_dwordx4 v4, s[44:47], s64 offen lds
    s_add_u32 m0, s21, 35840
    s_add_u32 s64, s65, 0xaf000
    buffer_load_dwordx4 v4, s[44:47], s64 offen lds
    s_waitcnt vmcnt(32)
    ds_read_b64_tr_b16 a[0:1], v2 offset:0
    ds_read_b64_tr_b16 a[2:3], v2 offset:1024
    ds_read_b64_tr_b16 a[4:5], v3 offset:0
    ds_read_b64_tr_b16 a[6:7], v3 offset:1024
    ds_read_b64_tr_b16 a[8:9], v2 offset:2048
    ds_read_b64_tr_b16 a[10:11], v2 offset:3072
    ds_read_b64_tr_b16 a[12:13], v3 offset:2048
    ds_read_b64_tr_b16 a[14:15], v3 offset:3072
    s_waitcnt lgkmcnt(0)
    s_add_u32 m0, s21, 0
    s_add_u32 s64, s65, 0xb4000
    buffer_load_dwordx4 v4, s[44:47], s64 offen lds
    s_add_u32 m0, s21, 1024
    s_add_u32 s64, s65, 0xb9000
    buffer_load_dwordx4 v4, s[44:47], s64 offen lds
    s_add_u32 m0, s21, 2048
    s_add_u32 s64, s65, 0xbe000
    buffer_load_dwordx4 v4, s[44:47], s64 offen lds
    s_add_u32 m0, s21, 3072
    s_add_u32 s64, s65, 0xc3000
    buffer_load_dwordx4 v4, s[44:47], s64 offen lds
    s_waitcnt vmcnt(32)
    ds_read_b64_tr_b16 a[16:17], v2 offset:4096
    ds_read_b64_tr_b16 a[18:19], v2 offset:5120
    ds_read_b64_tr_b16 a[20:21], v3 offset:4096
    ds_read_b64_tr_b16 a[22:23], v3 offset:5120
    ds_read_b64_tr_b16 a[24:25], v2 offset:6144
    ds_read_b64_tr_b16 a[26:27], v2 offset:7168
    ds_read_b64_tr_b16 a[28:29], v3 offset:6144
    ds_read_b64_tr_b16 a[30:31], v3 offset:7168
    s_waitcnt lgkmcnt(0)
    s_add_u32 m0, s21, 4096
    s_add_u32 s64, s65, 0xc8000
    buffer_load_dwordx4 v4, s[44:47], s64 offen lds
    s_add_u32 m0, s21, 5120
    s_add_u32 s64, s65, 0xcd000
    buffer_load_dwordx4 v4, s[44:47], s64 offen lds
    s_add_u32 m0, s21, 6144
    s_add_u32 s64, s65, 0xd2000
    buffer_load_dwordx4 v4, s[44:47], s64 offen lds
    s_add_u32 m0, s21, 7168
    s_add_u32 s64, s65, 0xd7000
    buffer_load_dwordx4 v4, s[44:47], s64 offen lds
    s_waitcnt vmcnt(32)
    ds_read_b64_tr_b16 a[32:33], v2 offset:8192
    ds_read_b64_tr_b16 a[34:35], v2 offset:9216
    ds_read_b64_tr_b16 a[36:37], v3 offset:8192
    ds_read_b64_tr_b16 a[38:39], v3 offset:9216
    ds_read_b64_tr_b16 a[40:41], v2 offset:10240
    ds_read_b64_tr_b16 a[42:43], v2 offset:11264
    ds_read_b64_tr_b16 a[44:45], v3 offset:10240
    ds_read_b64_tr_b16 a[46:47], v3 offset:11264
    s_waitcnt lgkmcnt(0)
    s_add_u32 m0, s21, 8192
    s_add_u32 s64, s65, 0xdc000
    buffer_load_dwordx4 v4, s[44:47], s64 offen lds
    s_add_u32 m0, s21, 9216
    s_add_u32 s64, s65, 0xe1000
    buffer_load_dwordx4 v4, s[44:47], s64 offen lds
    s_add_u32 m0, s21, 10240
    s_add_u32 s64, s65, 0xe6000
    buffer_load_dwordx4 v4, s[44:47], s64 offen lds
    s_add_u32 m0, s21, 11264
    s_add_u32 s64, s65, 0xeb000
    buffer_load_dwordx4 v4, s[44:47], s64 offen lds
    s_waitcnt vmcnt(32)
    ds_read_b64_tr_b16 a[48:49], v2 offset:12288
    ds_read_b64_tr_b16 a[50:51], v2 offset:13312
    ds_read_b64_tr_b16 a[52:53], v3 offset:12288
    ds_read_b64_tr_b16 a[54:55], v3 offset:13312
    ds_read_b64_tr_b16 a[56:57], v2 offset:14336
    ds_read_b64_tr_b16 a[58:59], v2 offset:15360
    ds_read_b64_tr_b16 a[60:61], v3 offset:14336
    ds_read_b64_tr_b16 a[62:63], v3 offset:15360
    s_waitcnt lgkmcnt(0)
    s_add_u32 m0, s21, 12288
    s_add_u32 s64, s65, 0xf0000
    buffer_load_dwordx4 v4, s[44:47], s64 offen lds
    s_add_u32 m0, s21, 13312
    s_add_u32 s64, s65, 0xf5000
    buffer_load_dwordx4 v4, s[44:47], s64 offen lds
    s_add_u32 m0, s21, 14336
    s_add_u32 s64, s65, 0xfa000
    buffer_load_dwordx4 v4, s[44:47], s64 offen lds
    s_add_u32 m0, s21, 15360
    s_add_u32 s64, s65, 0xff000
    buffer_load_dwordx4 v4, s[44:47], s64 offen lds
    s_waitcnt vmcnt(32)
    ds_read_b64_tr_b16 a[64:65], v2 offset:16384
    ds_read_b64_tr_b16 a[66:67], v2 offset:17408
    ds_read_b64_tr_b16 a[68:69], v3 offset:16384
    ds_read_b64_tr_b16 a[70:71], v3 offset:17408
    ds_read_b64_tr_b16 a[72:73], v2 offset:18432
    ds_read_b64_tr_b16 a[74:75], v2 offset:19456
    ds_read_b64_tr_b16 a[76:77], v3 offset:18432
    ds_read_b64_tr_b16 a[78:79], v3 offset:19456
    s_waitcnt lgkmcnt(0)
    s_add_u32 m0, s21, 16384
    s_add_u32 s64, s65, 0x104000
    buffer_load_dwordx4 v4, s[44:47], s64 offen lds
    s_add_u32 m0, s21, 17408
    s_add_u32 s64, s65, 0x109000
    buffer_load_dwordx4 v4, s[44:47], s64 offen lds
    s_add_u32 m0, s21, 18432
    s_add_u32 s64, s65, 0x10e000
    buffer_load_dwordx4 v4, s[44:47], s64 offen lds
    s_add_u32 m0, s21, 19456
    s_add_u32 s64, s65, 0x113000
    buffer_load_dwordx4 v4, s[44:47], s64 offen lds
    s_waitcnt vmcnt(32)
    ds_read_b64_tr_b16 a[80:81], v2 offset:20480
    ds_read_b64_tr_b16 a[82:83], v2 offset:21504
    ds_read_b64_tr_b16 a[84:85], v3 offset:20480
    ds_read_b64_tr_b16 a[86:87], v3 offset:21504
    ds_read_b64_tr_b16 a[88:89], v2 offset:22528
    ds_read_b64_tr_b16 a[90:91], v2 offset:23552
    ds_read_b64_tr_b16 a[92:93], v3 offset:22528
    ds_read_b64_tr_b16 a[94:95], v3 offset:23552
    s_waitcnt lgkmcnt(0)
    s_add_u32 m0, s21, 20480
    s_add_u32 s64, s65, 0x118000
    buffer_load_dwordx4 v4, s[44:47], s64 offen lds
    s_add_u32 m0, s21, 21504
    s_add_u32 s64, s65, 0x11d000
    buffer_load_dwordx4 v4, s[44:47], s64 offen lds
    s_add_u32 m0, s21, 22528
    s_add_u32 s64, s65, 0x122000
    buffer_load_dwordx4 v4, s[44:47], s64 offen lds
    s_add_u32 m0, s21, 23552
    s_add_u32 s64, s65, 0x127000
    buffer_load_dwordx4 v4, s[44:47], s64 offen lds
    s_waitcnt vmcnt(32)
    ds_read_b64_tr_b16 a[96:97], v2 offset:24576
    ds_read_b64_tr_b16 a[98:99], v2 offset:25600
    ds_read_b64_tr_b16 a[100:101], v3 offset:24576
    ds_read_b64_tr_b16 a[102:103], v3 offset:25600
    ds_read_b64_tr_b16 a[104:105], v2 offset:26624
    ds_read_b64_tr_b16 a[106:107], v2 offset:27648
    ds_read_b64_tr_b16 a[108:109], v3 offset:26624
    ds_read_b64_tr_b16 a[110:111], v3 offset:27648
    s_waitcnt lgkmcnt(0)
    s_add_u32 m0, s21, 24576
    s_add_u32 s64, s65, 0x12c000
    buffer_load_dwordx4 v4, s[44:47], s64 offen lds
    s_add_u32 m0, s21, 25600
    s_add_u32 s64, s65, 0x131000
    buffer_load_dwordx4 v4, s[44:47], s64 offen lds
    s_add_u32 m0, s21, 26624
    s_add_u32 s64, s65, 0x136000
    buffer_load_dwordx4 v4, s[44:47], s64 offen lds
    s_add_u32 m0, s21, 27648
    s_add_u32 s64, s65, 0x13b000
    buffer_load_dwordx4 v4, s[44:47], s64 offen lds
    s_waitcnt vmcnt(32)
    ds_read_b64_tr_b16 a[112:113], v2 offset:28672
    ds_read_b64_tr_b16 a[114:115], v2 offset:29696
    ds_read_b64_tr_b16 a[116:117], v3 offset:28672
    ds_read_b64_tr_b16 a[118:119], v3 offset:29696
    ds_read_b64_tr_b16 a[120:121], v2 offset:30720
    ds_read_b64_tr_b16 a[122:123], v2 offset:31744
    ds_read_b64_tr_b16 a[124:125], v3 offset:30720
    ds_read_b64_tr_b16 a[126:127], v3 offset:31744
    s_waitcnt lgkmcnt(0)
    s_waitcnt vmcnt(28)
    ds_read_b64_tr_b16 a[128:129], v2 offset:32768
    ds_read_b64_tr_b16 a[130:131], v2 offset:33792
    ds_read_b64_tr_b16 a[132:133], v3 offset:32768
    ds_read_b64_tr_b16 a[134:135], v3 offset:33792
    ds_read_b64_tr_b16 a[136:137], v2 offset:34816
    ds_read_b64_tr_b16 a[138:139], v2 offset:35840
    ds_read_b64_tr_b16 a[140:141], v3 offset:34816
    ds_read_b64_tr_b16 a[142:143], v3 offset:35840
    s_waitcnt lgkmcnt(0)
    s_waitcnt vmcnt(24)
    ds_read_b64_tr_b16 a[144:145], v2 offset:0
    ds_read_b64_tr_b16 a[146:147], v2 offset:1024
    ds_read_b64_tr_b16 a[148:149], v3 offset:0
    ds_read_b64_tr_b16 a[150:151], v3 offset:1024
    ds_read_b64_tr_b16 a[152:153], v2 offset:2048
    ds_read_b64_tr_b16 a[154:155], v2 offset:3072
    ds_read_b64_tr_b16 a[156:157], v3 offset:2048
    ds_read_b64_tr_b16 a[158:159], v3 offset:3072
    s_waitcnt lgkmcnt(0)
    s_waitcnt vmcnt(20)
    ds_read_b64_tr_b16 a[160:161], v2 offset:4096
    ds_read_b64_tr_b16 a[162:163], v2 offset:5120
    ds_read_b64_tr_b16 a[164:165], v3 offset:4096
    ds_read_b64_tr_b16 a[166:167], v3 offset:5120
    ds_read_b64_tr_b16 a[168:169], v2 offset:6144
    ds_read_b64_tr_b16 a[170:171], v2 offset:7168
    ds_read_b64_tr_b16 a[172:173], v3 offset:6144
    ds_read_b64_tr_b16 a[174:175], v3 offset:7168
    s_waitcnt lgkmcnt(0)
    s_waitcnt vmcnt(16)
    ds_read_b64_tr_b16 a[176:177], v2 offset:8192
    ds_read_b64_tr_b16 a[178:179], v2 offset:9216
    ds_read_b64_tr_b16 a[180:181], v3 offset:8192
    ds_read_b64_tr_b16 a[182:183], v3 offset:9216
    ds_read_b64_tr_b16 a[184:185], v2 offset:10240
    ds_read_b64_tr_b16 a[186:187], v2 offset:11264
    ds_read_b64_tr_b16 a[188:189], v3 offset:10240
    ds_read_b64_tr_b16 a[190:191], v3 offset:11264
    s_waitcnt lgkmcnt(0)
    s_waitcnt vmcnt(12)
    ds_read_b64_tr_b16 a[192:193], v2 offset:12288
    ds_read_b64_tr_b16 a[194:195], v2 offset:13312
    ds_read_b64_tr_b16 a[196:197], v3 offset:12288
    ds_read_b64_tr_b16 a[198:199], v3 offset:13312
    ds_read_b64_tr_b16 a[200:201], v2 offset:14336
    ds_read_b64_tr_b16 a[202:203], v2 offset:15360
    ds_read_b64_tr_b16 a[204:205], v3 offset:14336
    ds_read_b64_tr_b16 a[206:207], v3 offset:15360
    s_waitcnt lgkmcnt(0)
    s_waitcnt vmcnt(8)
    ds_read_b64_tr_b16 a[208:209], v2 offset:16384
    ds_read_b64_tr_b16 a[210:211], v2 offset:17408
    ds_read_b64_tr_b16 a[212:213], v3 offset:16384
    ds_read_b64_tr_b16 a[214:215], v3 offset:17408
    ds_read_b64_tr_b16 a[216:217], v2 offset:18432
    ds_read_b64_tr_b16 a[218:219], v2 offset:19456
    ds_read_b64_tr_b16 a[220:221], v3 offset:18432
    ds_read_b64_tr_b16 a[222:223], v3 offset:19456
    s_waitcnt lgkmcnt(0)
    s_waitcnt vmcnt(4)
    ds_read_b64_tr_b16 a[224:225], v2 offset:20480
    ds_read_b64_tr_b16 a[226:227], v2 offset:21504
    ds_read_b64_tr_b16 a[228:229], v3 offset:20480
    ds_read_b64_tr_b16 a[230:231], v3 offset:21504
    ds_read_b64_tr_b16 a[232:233], v2 offset:22528
    ds_read_b64_tr_b16 a[234:235], v2 offset:23552
    ds_read_b64_tr_b16 a[236:237], v3 offset:22528
    ds_read_b64_tr_b16 a[238:239], v3 offset:23552
    s_waitcnt lgkmcnt(0)
    s_waitcnt vmcnt(0)
    ds_read_b64_tr_b16 a[240:241], v2 offset:24576
    ds_read_b64_tr_b16 a[242:243], v2 offset:25600
    ds_read_b64_tr_b16 a[244:245], v3 offset:24576
    ds_read_b64_tr_b16 a[246:247], v3 offset:25600
    ds_read_b64_tr_b16 a[248:249], v2 offset:26624
    ds_read_b64_tr_b16 a[250:251], v2 offset:27648
    ds_read_b64_tr_b16 a[252:253], v3 offset:26624
    ds_read_b64_tr_b16 a[254:255], v3 offset:27648
    s_waitcnt lgkmcnt(0)
    s_barrier
    s_mov_b32 s29, 0
    v_lshlrev_b32 v1, 4, v0
    v_mov_b32 v8, 0
    s_mov_b32 s64, 0x298000
OUS_159:
    buffer_load_dword v7, v8, s[4:7], s64 offen sc1
    s_add_u32 s29, s29, 1
    s_waitcnt vmcnt(0)
    v_cmp_gt_u32 vcc, 1, v7
    s_cbranch_vccz OUSD_160
    s_cmp_gt_u32 s29, 262144
    s_cbranch_scc1 OUSD_160
    s_sleep 8
    s_branch OUS_159
OUSD_160:
    v_lshlrev_b32 v6, 2, v0
    s_mov_b32 s64, 0x5400000
    buffer_load_dword v7, v6, s[4:7], s64 offen sc1
    s_waitcnt vmcnt(0)
    v_readlane_b32 s72, v7, 0
    v_readlane_b32 s73, v7, 1
    v_readlane_b32 s74, v7, 2
    v_readlane_b32 s75, v7, 3
    v_readlane_b32 s76, v7, 4
    v_readlane_b32 s77, v7, 5
    v_readlane_b32 s78, v7, 6
    v_readlane_b32 s79, v7, 7
    s_and_b32 s64, s14, 1
    s_lshl_b32 s64, s64, 4
    v_and_b32 v6, 15, v0
    v_add_u32 v6, s64, v6
    v_mov_b32 v9, v6
    v_mul_u32_u24 v5, 1280, v6
    v_lshrrev_b32 v6, 4, v0
    v_lshl_add_u32 v5, v6, 3, v5
    s_lshr_b32 s64, s14, 1
    s_lshl_b32 s64, s64, 5
    s_lshl_b32 s65, s13, 6
    s_add_u32 s64, s64, s65
    v_add_u32 v5, s64, v5
    v_lshlrev_b32 v6, 2, v0
    s_mov_b32 s80, 0x49249249
    s_mov_b32 s81, 0x92492492
    s_lshl_b64 s[80:81], s[80:81], s12
    s_bitset0_b64 s[80:81], 63
    s_bitset0_b64 s[80:81], 62
    s_mov_b64 s[82:83], 0
    s_lshr_b32 s64, s72, 5
    s_bitset1_b64 s[82:83], s64
    s_lshr_b32 s64, s73, 5
    s_bitset1_b64 s[82:83], s64
    s_lshr_b32 s64, s74, 5
    s_bitset1_b64 s[82:83], s64
    s_lshr_b32 s64, s75, 5
    s_bitset1_b64 s[82:83], s64
    s_lshr_b32 s64, s76, 5
    s_bitset1_b64 s[82:83], s64
    s_lshr_b32 s64, s77, 5
    s_bitset1_b64 s[82:83], s64
    s_lshr_b32 s64, s78, 5
    s_bitset1_b64 s[82:83], s64
    s_lshr_b32 s64, s79, 5
    s_bitset1_b64 s[82:83], s64
OU_LOOP:
    s_cmp_eq_u64 s[80:81], 0
    s_cbranch_scc1 OU_END
    s_andn2_b64 s[84:85], s[80:81], s[82:83]
    s_cbranch_scc0 OU_WM
    s_ff1_i32_b64 s24, s[84:85]
    s_branch OU_GO
OU_WM:
    v_mov_b32 v8, 0
    s_mov_b32 s64, 0x298100
OUW_161:
    buffer_load_dword v7, v8, s[4:7], s64 offen sc1
    s_add_u32 s29, s29, 1
    s_waitcnt vmcnt(0)
    v_cmp_gt_u32 vcc, 40, v7
    s_cbranch_vccz OUWD_162
    s_cmp_gt_u32 s29, 262144
    s_cbranch_scc1 OUWD_162
    s_sleep 8
    s_branch OUW_161
OUWD_162:
    s_mov_b64 s[82:83], 0
    s_branch OU_LOOP
OU_GO:
    s_bitset0_b64 s[80:81], s24
    s_lshr_b32 s86, s14, 1
    s_mul_i32 s67, s24, 40960
    buffer_load_dwordx2 v[160:161], v5, s[48:51], s67 offen
    s_add_u32 s64, s67, 0x0
    buffer_load_dwordx2 v[162:163], v5, s[4:7], s64 offen
    s_mov_b32 s64, 0x298100
    buffer_load_dword v12, off, s[4:7], s64 sc1
    s_lshl_b32 s64, s24, 7
    s_add_u32 s64, s64, 0x296000
    s_mov_b64 exec, s[36:37]
OU_F_163:
    buffer_load_dword v7, v6, s[4:7], s64 offen sc1
    s_add_u32 s29, s29, 1
    s_waitcnt vmcnt(0)
    v_cmp_eq_u32 vcc, 0, v7
    s_cbranch_vccz OU_FD_164
    s_cmp_gt_u32 s29, 262144
    s_cbranch_scc1 OU_FD_164
    s_sleep 1
    s_branch OU_F_163
OU_FD_164:
    s_mov_b64 exec, -1
    s_lshl_b32 s25, s24, 18
    s_lshl_b32 s64, s14, 15
    s_add_u32 s25, s25, s64
    s_add_u32 s25, s25, 0x4400000
    s_add_u32 s64, s25, 0x0
    buffer_load_dwordx4 v[16:19], v1, s[4:7], s64 offen
    s_add_u32 s64, s25, 0x20000
    buffer_load_dwordx4 v[20:23], v1, s[4:7], s64 offen
    s_add_u32 s64, s25, 0x400
    buffer_load_dwordx4 v[24:27], v1, s[4:7], s64 offen
    s_add_u32 s64, s25, 0x20400
    buffer_load_dwordx4 v[28:31], v1, s[4:7], s64 offen
    s_add_u32 s64, s25, 0x800
    buffer_load_dwordx4 v[32:35], v1, s[4:7], s64 offen
    s_add_u32 s64, s25, 0x20800
    buffer_load_dwordx4 v[36:39], v1, s[4:7], s64 offen
    s_add_u32 s64, s25, 0xc00
    buffer_load_dwordx4 v[40:43], v1, s[4:7], s64 offen
    s_add_u32 s64, s25, 0x20c00
    buffer_load_dwordx4 v[44:47], v1, s[4:7], s64 offen
    s_add_u32 s64, s25, 0x1000
    buffer_load_dwordx4 v[48:51], v1, s[4:7], s64 offen
    s_add_u32 s64, s25, 0x21000
    buffer_load_dwordx4 v[52:55], v1, s[4:7], s64 offen
    s_add_u32 s64, s25, 0x1400
    buffer_load_dwordx4 v[56:59], v1, s[4:7], s64 offen
    s_add_u32 s64, s25, 0x21400
    buffer_load_dwordx4 v[60:63], v1, s[4:7], s64 offen
    s_add_u32 s64, s25, 0x1800
    buffer_load_dwordx4 v[64:67], v1, s[4:7], s64 offen
    s_add_u32 s64, s25, 0x21800
    buffer_load_dwordx4 v[68:71], v1, s[4:7], s64 offen
    s_add_u32 s64, s25, 0x1c00
    buffer_load_dwordx4 v[72:75], v1, s[4:7], s64 offen
    s_add_u32 s64, s25, 0x21c00
    buffer_load_dwordx4 v[76:79], v1, s[4:7], s64 offen
    s_add_u32 s64, s25, 0x2000
    buffer_load_dwordx4 v[80:83], v1, s[4:7], s64 offen
    s_add_u32 s64, s25, 0x22000
    buffer_load_dwordx4 v[84:87], v1, s[4:7], s64 offen
    s_add_u32 s64, s25, 0x2400
    buffer_load_dwordx4 v[88:91], v1, s[4:7], s64 offen
    s_add_u32 s64, s25, 0x22400
    buffer_load_dwordx4 v[92:95], v1, s[4:7], s64 offen
    s_add_u32 s64, s25, 0x2800
    buffer_load_dwordx4 v[96:99], v1, s[4:7], s64 offen
    s_add_u32 s64, s25, 0x22800
    buffer_load_dwordx4 v[100:103], v1, s[4:7], s64 offen
    s_add_u32 s64, s25, 0x2c00
    buffer_load_dwordx4 v[104:107], v1, s[4:7], s64 offen
    s_add_u32 s64, s25, 0x22c00
    buffer_load_dwordx4 v[108:111], v1, s[4:7], s64 offen
    s_add_u32 s64, s25, 0x3000
    buffer_load_dwordx4 v[112:115], v1, s[4:7], s64 offen
    s_add_u32 s64, s25, 0x23000
    buffer_load_dwordx4 v[116:119], v1, s[4:7], s64 offen
    s_add_u32 s64, s25, 0x3400
    buffer_load_dwordx4 v[120:123], v1, s[4:7], s64 offen
    s_add_u32 s64, s25, 0x23400
    buffer_load_dwordx4 v[124:127], v1, s[4:7], s64 offen
    s_add_u32 s64, s25, 0x3800
    buffer_load_dwordx4 v[128:131], v1, s[4:7], s64 offen
    s_add_u32 s64, s25, 0x23800
    buffer_load_dwordx4 v[132:135], v1, s[4:7], s64 offen
    s_add_u32 s64, s25, 0x3c00
    buffer_load_dwordx4 v[136:139], v1, s[4:7], s64 offen
    s_add_u32 s64, s25, 0x23c00
    buffer_load_dwordx4 v[140:143], v1, s[4:7], s64 offen
    s_waitcnt vmcnt(30)
    v_mfma_f32_16x16x32_bf16 v[144:147], a[0:3], v[16:19], 0
    v_mfma_f32_16x16x32_bf16 v[148:151], a[0:3], v[20:23], 0
    v_mfma_f32_16x16x32_bf16 v[152:155], a[4:7], v[16:19], 0
    v_mfma_f32_16x16x32_bf16 v[156:159], a[4:7], v[20:23], 0
    s_add_u32 s64, s25, 0x4000
    buffer_load_dwordx4 v[16:19], v1, s[4:7], s64 offen
    s_add_u32 s64, s25, 0x24000
    buffer_load_dwordx4 v[20:23], v1, s[4:7], s64 offen
    s_waitcnt vmcnt(30)
    v_mfma_f32_16x16x32_bf16 v[144:147], a[8:11], v[24:27], v[144:147]
    v_mfma_f32_16x16x32_bf16 v[148:151], a[8:11], v[28:31], v[148:151]
    v_mfma_f32_16x16x32_bf16 v[152:155], a[12:15], v[24:27], v[152:155]
    v_mfma_f32_16x16x32_bf16 v[156:159], a[12:15], v[28:31], v[156:159]
    s_add_u32 s64, s25, 0x4400
    buffer_load_dwordx4 v[24:27], v1, s[4:7], s64 offen
    s_add_u32 s64, s25, 0x24400
    buffer_load_dwordx4 v[28:31], v1, s[4:7], s64 offen
    s_waitcnt vmcnt(30)
    v_mfma_f32_16x16x32_bf16 v[144:147], a[16:19], v[32:35], v[144:147]
    v_mfma_f32_16x16x32_bf16 v[148:151], a[16:19], v[36:39], v[148:151]
    v_mfma_f32_16x16x32_bf16 v[152:155], a[20:23], v[32:35], v[152:155]
    v_mfma_f32_16x16x32_bf16 v[156:159], a[20:23], v[36:39], v[156:159]
    s_add_u32 s64, s25, 0x4800
    buffer_load_dwordx4 v[32:35], v1, s[4:7], s64 offen
    s_add_u32 s64, s25, 0x24800
    buffer_load_dwordx4 v[36:39], v1, s[4:7], s64 offen
    s_waitcnt vmcnt(30)
    v_mfma_f32_16x16x32_bf16 v[144:147], a[24:27], v[40:43], v[144:147]
    v_mfma_f32_16x16x32_bf16 v[148:151], a[24:27], v[44:47], v[148:151]
    v_mfma_f32_16x16x32_bf16 v[152:155], a[28:31], v[40:43], v[152:155]
    v_mfma_f32_16x16x32_bf16 v[156:159], a[28:31], v[44:47], v[156:159]
    s_add_u32 s64, s25, 0x4c00
    buffer_load_dwordx4 v[40:43], v1, s[4:7], s64 offen
    s_add_u32 s64, s25, 0x24c00
    buffer_load_dwordx4 v[44:47], v1, s[4:7], s64 offen
    s_waitcnt vmcnt(30)
    v_mfma_f32_16x16x32_bf16 v[144:147], a[32:35], v[48:51], v[144:147]
    v_mfma_f32_16x16x32_bf16 v[148:151], a[32:35], v[52:55], v[148:151]
    v_mfma_f32_16x16x32_bf16 v[152:155], a[36:39], v[48:51], v[152:155]
    v_mfma_f32_16x16x32_bf16 v[156:159], a[36:39], v[52:55], v[156:159]
    s_add_u32 s64, s25, 0x5000
    buffer_load_dwordx4 v[48:51], v1, s[4:7], s64 offen
    s_add_u32 s64, s25, 0x25000
    buffer_load_dwordx4 v[52:55], v1, s[4:7], s64 offen
    s_waitcnt vmcnt(30)
    v_mfma_f32_16x16x32_bf16 v[144:147], a[40:43], v[56:59], v[144:147]
    v_mfma_f32_16x16x32_bf16 v[148:151], a[40:43], v[60:63], v[148:151]
    v_mfma_f32_16x16x32_bf16 v[152:155], a[44:47], v[56:59], v[152:155]
    v_mfma_f32_16x16x32_bf16 v[156:159], a[44:47], v[60:63], v[156:159]
    s_add_u32 s64, s25, 0x5400
    buffer_load_dwordx4 v[56:59], v1, s[4:7], s64 offen
    s_add_u32 s64, s25, 0x25400
    buffer_load_dwordx4 v[60:63], v1, s[4:7], s64 offen
    s_waitcnt vmcnt(30)
    v_mfma_f32_16x16x32_bf16 v[144:147], a[48:51], v[64:67], v[144:147]
    v_mfma_f32_16x16x32_bf16 v[148:151], a[48:51], v[68:71], v[148:151]
    v_mfma_f32_16x16x32_bf16 v[152:155], a[52:55], v[64:67], v[152:155]
    v_mfma_f32_16x16x32_bf16 v[156:159], a[52:55], v[68:71], v[156:159]
    s_add_u32 s64, s25, 0x5800
    buffer_load_dwordx4 v[64:67], v1, s[4:7], s64 offen
    s_add_u32 s64, s25, 0x25800
    buffer_load_dwordx4 v[68:71], v1, s[4:7], s64 offen
    s_waitcnt vmcnt(30)
    v_mfma_f32_16x16x32_bf16 v[144:147], a[56:59], v[72:75], v[144:147]
    v_mfma_f32_16x16x32_bf16 v[148:151], a[56:59], v[76:79], v[148:151]
    v_mfma_f32_16x16x32_bf16 v[152:155], a[60:63], v[72:75], v[152:155]
    v_mfma_f32_16x16x32_bf16 v[156:159], a[60:63], v[76:79], v[156:159]
    s_add_u32 s64, s25, 0x5c00
    buffer_load_dwordx4 v[72:75], v1, s[4:7], s64 offen
    s_add_u32 s64, s25, 0x25c00
    buffer_load_dwordx4 v[76:79], v1, s[4:7], s64 offen
    s_waitcnt vmcnt(30)
    v_mfma_f32_16x16x32_bf16 v[144:147], a[64:67], v[80:83], v[144:147]
    v_mfma_f32_16x16x32_bf16 v[148:151], a[64:67], v[84:87], v[148:151]
    v_mfma_f32_16x16x32_bf16 v[152:155], a[68:71], v[80:83], v[152:155]
    v_mfma_f32_16x16x32_bf16 v[156:159], a[68:71], v[84:87], v[156:159]
    s_add_u32 s64, s25, 0x6000
    buffer_load_dwordx4 v[80:83], v1, s[4:7], s64 offen
    s_add_u32 s64, s25, 0x26000
    buffer_load_dwordx4 v[84:87], v1, s[4:7], s64 offen
    s_waitcnt vmcnt(30)
    v_mfma_f32_16x16x32_bf16 v[144:147], a[72:75], v[88:91], v[144:147]
    v_mfma_f32_16x16x32_bf16 v[148:151], a[72:75], v[92:95], v[148:151]
    v_mfma_f32_16x16x32_bf16 v[152:155], a[76:79], v[88:91], v[152:155]
    v_mfma_f32_16x16x32_bf16 v[156:159], a[76:79], v[92:95], v[156:159]
    s_add_u32 s64, s25, 0x6400
    buffer_load_dwordx4 v[88:91], v1, s[4:7], s64 offen
    s_add_u32 s64, s25, 0x26400
    buffer_load_dwordx4 v[92:95], v1, s[4:7], s64 offen
    s_waitcnt vmcnt(30)
    v_mfma_f32_16x16x32_bf16 v[144:147], a[80:83], v[96:99], v[144:147]
    v_mfma_f32_16x16x32_bf16 v[148:151], a[80:83], v[100:103], v[148:151]
    v_mfma_f32_16x16x32_bf16 v[152:155], a[84:87], v[96:99], v[152:155]
    v_mfma_f32_16x16x32_bf16 v[156:159], a[84:87], v[100:103], v[156:159]
    s_add_u32 s64, s25, 0x6800
    buffer_load_dwordx4 v[96:99], v1, s[4:7], s64 offen
    s_add_u32 s64, s25, 0x26800
    buffer_load_dwordx4 v[100:103], v1, s[4:7], s64 offen
    s_waitcnt vmcnt(30)
    v_mfma_f32_16x16x32_bf16 v[144:147], a[88:91], v[104:107], v[144:147]
    v_mfma_f32_16x16x32_bf16 v[148:151], a[88:91], v[108:111], v[148:151]
    v_mfma_f32_16x16x32_bf16 v[152:155], a[92:95], v[104:107], v[152:155]
    v_mfma_f32_16x16x32_bf16 v[156:159], a[92:95], v[108:111], v[156:159]
    s_add_u32 s64, s25, 0x6c00
    buffer_load_dwordx4 v[104:107], v1, s[4:7], s64 offen
    s_add_u32 s64, s25, 0x26c00
    buffer_load_dwordx4 v[108:111], v1, s[4:7], s64 offen
    s_waitcnt vmcnt(30)
    v_mfma_f32_16x16x32_bf16 v[144:147], a[96:99], v[112:115], v[144:147]
    v_mfma_f32_16x16x32_bf16 v[148:151], a[96:99], v[116:119], v[148:151]
    v_mfma_f32_16x16x32_bf16 v[152:155], a[100:103], v[112:115], v[152:155]
    v_mfma_f32_16x16x32_bf16 v[156:159], a[100:103], v[116:119], v[156:159]
    s_add_u32 s64, s25, 0x7000
    buffer_load_dwordx4 v[112:115], v1, s[4:7], s64 offen
    s_add_u32 s64, s25, 0x27000
    buffer_load_dwordx4 v[116:119], v1, s[4:7], s64 offen
    s_waitcnt vmcnt(30)
    v_mfma_f32_16x16x32_bf16 v[144:147], a[104:107], v[120:123], v[144:147]
    v_mfma_f32_16x16x32_bf16 v[148:151], a[104:107], v[124:127], v[148:151]
    v_mfma_f32_16x16x32_bf16 v[152:155], a[108:111], v[120:123], v[152:155]
    v_mfma_f32_16x16x32_bf16 v[156:159], a[108:111], v[124:127], v[156:159]
    s_add_u32 s64, s25, 0x7400
    buffer_load_dwordx4 v[120:123], v1, s[4:7], s64 offen
    s_add_u32 s64, s25, 0x27400
    buffer_load_dwordx4 v[124:127], v1, s[4:7], s64 offen
    s_waitcnt vmcnt(30)
    v_mfma_f32_16x16x32_bf16 v[144:147], a[112:115], v[128:131], v[144:147]
    v_mfma_f32_16x16x32_bf16 v[148:151], a[112:115], v[132:135], v[148:151]
    v_mfma_f32_16x16x32_bf16 v[152:155], a[116:119], v[128:131], v[152:155]
    v_mfma_f32_16x16x32_bf16 v[156:159], a[116:119], v[132:135], v[156:159]
    s_add_u32 s64, s25, 0x7800
    buffer_load_dwordx4 v[128:131], v1, s[4:7], s64 offen
    s_add_u32 s64, s25, 0x27800
    buffer_load_dwordx4 v[132:135], v1, s[4:7], s64 offen
    s_waitcnt vmcnt(30)
    v_mfma_f32_16x16x32_bf16 v[144:147], a[120:123], v[136:139], v[144:147]
    v_mfma_f32_16x16x32_bf16 v[148:151], a[120:123], v[140:143], v[148:151]
    v_mfma_f32_16x16x32_bf16 v[152:155], a[124:127], v[136:139], v[152:155]
    v_mfma_f32_16x16x32_bf16 v[156:159], a[124:127], v[140:143], v[156:159]
    s_add_u32 s64, s25, 0x7c00
    buffer_load_dwordx4 v[136:139], v1, s[4:7], s64 offen
    s_add_u32 s64, s25, 0x27c00
    buffer_load_dwordx4 v[140:143], v1, s[4:7], s64 offen
    s_waitcnt vmcnt(30)
    v_mfma_f32_16x16x32_bf16 v[144:147], a[128:131], v[16:19], v[144:147]
    v_mfma_f32_16x16x32_bf16 v[148:151], a[128:131], v[20:23], v[148:151]
    v_mfma_f32_16x16x32_bf16 v[152:155], a[132:135], v[16:19], v[152:155]
    v_mfma_f32_16x16x32_bf16 v[156:159], a[132:135], v[20:23], v[156:159]
    s_waitcnt vmcnt(28)
    v_mfma_f32_16x16x32_bf16 v[144:147], a[136:139], v[24:27], v[144:147]
    v_mfma_f32_16x16x32_bf16 v[148:151], a[136:139], v[28:31], v[148:151]
    v_mfma_f32_16x16x32_bf16 v[152:155], a[140:143], v[24:27], v[152:155]
    v_mfma_f32_16x16x32_bf16 v[156:159], a[140:143], v[28:31], v[156:159]
    s_waitcnt vmcnt(26)
    v_mfma_f32_16x16x32_bf16 v[144:147], a[144:147], v[32:35], v[144:147]
    v_mfma_f32_16x16x32_bf16 v[148:151], a[144:147], v[36:39], v[148:151]
    v_mfma_f32_16x16x32_bf16 v[152:155], a[148:151], v[32:35], v[152:155]
    v_mfma_f32_16x16x32_bf16 v[156:159], a[148:151], v[36:39], v[156:159]
    s_waitcnt vmcnt(24)
    v_mfma_f32_16x16x32_bf16 v[144:147], a[152:155], v[40:43], v[144:147]
    v_mfma_f32_16x16x32_bf16 v[148:151], a[152:155], v[44:47], v[148:151]
    v_mfma_f32_16x16x32_bf16 v[152:155], a[156:159], v[40:43], v[152:155]
    v_mfma_f32_16x16x32_bf16 v[156:159], a[156:159], v[44:47], v[156:159]
    s_waitcnt vmcnt(22)
    v_mfma_f32_16x16x32_bf16 v[144:147], a[160:163], v[48:51], v[144:147]
    v_mfma_f32_16x16x32_bf16 v[148:151], a[160:163], v[52:55], v[148:151]
    v_mfma_f32_16x16x32_bf16 v[152:155], a[164:167], v[48:51], v[152:155]
    v_mfma_f32_16x16x32_bf16 v[156:159], a[164:167], v[52:55], v[156:159]
    s_waitcnt vmcnt(20)
    v_mfma_f32_16x16x32_bf16 v[144:147], a[168:171], v[56:59], v[144:147]
    v_mfma_f32_16x16x32_bf16 v[148:151], a[168:171], v[60:63], v[148:151]
    v_mfma_f32_16x16x32_bf16 v[152:155], a[172:175], v[56:59], v[152:155]
    v_mfma_f32_16x16x32_bf16 v[156:159], a[172:175], v[60:63], v[156:159]
    s_waitcnt vmcnt(18)
    v_mfma_f32_16x16x32_bf16 v[144:147], a[176:179], v[64:67], v[144:147]
    v_mfma_f32_16x16x32_bf16 v[148:151], a[176:179], v[68:71], v[148:151]
    v_mfma_f32_16x16x32_bf16 v[152:155], a[180:183], v[64:67], v[152:155]
    v_mfma_f32_16x16x32_bf16 v[156:159], a[180:183], v[68:71], v[156:159]
    s_waitcnt vmcnt(16)
    v_mfma_f32_16x16x32_bf16 v[144:147], a[184:187], v[72:75], v[144:147]
    v_mfma_f32_16x16x32_bf16 v[148:151], a[184:187], v[76:79], v[148:151]
    v_mfma_f32_16x16x32_bf16 v[152:155], a[188:191], v[72:75], v[152:155]
    v_mfma_f32_16x16x32_bf16 v[156:159], a[188:191], v[76:79], v[156:159]
    s_waitcnt vmcnt(14)
    v_mfma_f32_16x16x32_bf16 v[144:147], a[192:195], v[80:83], v[144:147]
    v_mfma_f32_16x16x32_bf16 v[148:151], a[192:195], v[84:87], v[148:151]
    v_mfma_f32_16x16x32_bf16 v[152:155], a[196:199], v[80:83], v[152:155]
    v_mfma_f32_16x16x32_bf16 v[156:159], a[196:199], v[84:87], v[156:159]
    s_waitcnt vmcnt(12)
    v_mfma_f32_16x16x32_bf16 v[144:147], a[200:203], v[88:91], v[144:147]
    v_mfma_f32_16x16x32_bf16 v[148:151], a[200:203], v[92:95], v[148:151]
    v_mfma_f32_16x16x32_bf16 v[152:155], a[204:207], v[88:91], v[152:155]
    v_mfma_f32_16x16x32_bf16 v[156:159], a[204:207], v[92:95], v[156:159]
    s_waitcnt vmcnt(10)
    v_mfma_f32_16x16x32_bf16 v[144:147], a[208:211], v[96:99], v[144:147]
    v_mfma_f32_16x16x32_bf16 v[148:151], a[208:211], v[100:103], v[148:151]
    v_mfma_f32_16x16x32_bf16 v[152:155], a[212:215], v[96:99], v[152:155]
    v_mfma_f32_16x16x32_bf16 v[156:159], a[212:215], v[100:103], v[156:159]
    s_waitcnt vmcnt(8)
    v_mfma_f32_16x16x32_bf16 v[144:147], a[216:219], v[104:107], v[144:147]
    v_mfma_f32_16x16x32_bf16 v[148:151], a[216:219], v[108:111], v[148:151]
    v_mfma_f32_16x16x32_bf16 v[152:155], a[220:223], v[104:107], v[152:155]
    v_mfma_f32_16x16x32_bf16 v[156:159], a[220:223], v[108:111], v[156:159]
    s_waitcnt vmcnt(6)
    v_mfma_f32_16x16x32_bf16 v[144:147], a[224:227], v[112:115], v[144:147]
    v_mfma_f32_16x16x32_bf16 v[148:151], a[224:227], v[116:119], v[148:151]
    v_mfma_f32_16x16x32_bf16 v[152:155], a[228:231], v[112:115], v[152:155]
    v_mfma_f32_16x16x32_bf16 v[156:159], a[228:231], v[116:119], v[156:159]
    s_waitcnt vmcnt(4)
    v_mfma_f32_16x16x32_bf16 v[144:147], a[232:235], v[120:123], v[144:147]
    v_mfma_f32_16x16x32_bf16 v[148:151], a[232:235], v[124:127], v[148:151]
    v_mfma_f32_16x16x32_bf16 v[152:155], a[236:239], v[120:123], v[152:155]
    v_mfma_f32_16x16x32_bf16 v[156:159], a[236:239], v[124:127], v[156:159]
    s_waitcnt vmcnt(2)
    v_mfma_f32_16x16x32_bf16 v[144:147], a[240:243], v[128:131], v[144:147]
    v_mfma_f32_16x16x32_bf16 v[148:151], a[240:243], v[132:135], v[148:151]
    v_mfma_f32_16x16x32_bf16 v[152:155], a[244:247], v[128:131], v[152:155]
    v_mfma_f32_16x16x32_bf16 v[156:159], a[244:247], v[132:135], v[156:159]
    s_waitcnt vmcnt(0)
    v_mfma_f32_16x16x32_bf16 v[144:147], a[248:251], v[136:139], v[144:147]
    v_mfma_f32_16x16x32_bf16 v[148:151], a[248:251], v[140:143], v[148:151]
    v_mfma_f32_16x16x32_bf16 v[152:155], a[252:255], v[136:139], v[152:155]
    v_mfma_f32_16x16x32_bf16 v[156:159], a[252:255], v[140:143], v[156:159]
    s_lshl_b32 s64, s14, 12
    v_add_u32 v7, s64, v1
    s_barrier
    s_nop 3
    ds_write_b128 v7, v[144:147] offset:0
    ds_write_b128 v7, v[148:151] offset:1024
    ds_write_b128 v7, v[152:155] offset:2048
    ds_write_b128 v7, v[156:159] offset:3072
    v_mov_b32 v13, 16384
    s_cmp_lg_u32 s14, 0
    s_cbranch_scc1 OW0_165
    ds_write_b32 v13, v12
OW0_165:
    s_waitcnt lgkmcnt(0)
    s_barrier
    ds_read_b32 v12, v13
    s_waitcnt lgkmcnt(0)
    v_readfirstlane_b32 s64, v12
    s_cmp_lt_u32 s64, 40
    s_cselect_b64 s[82:83], s[82:83], 0
    s_lshl_b32 s64, s14, 10
    v_add_u32 v7, s64, v1
    ds_read_b128 v[16:19], v7 offset:0
    ds_read_b128 v[20:23], v7 offset:4096
    ds_read_b128 v[24:27], v7 offset:8192
    ds_read_b128 v[28:31], v7 offset:12288
    s_waitcnt lgkmcnt(0)
    v_add_f32 v16, v16, v20
    v_add_f32 v24, v24, v28
    v_add_f32 v16, v16, v24
    v_add_f32 v17, v17, v21
    v_add_f32 v25, v25, v29
    v_add_f32 v17, v17, v25
    v_add_f32 v18, v18, v22
    v_add_f32 v26, v26, v30
    v_add_f32 v18, v18, v26
    v_add_f32 v19, v19, v23
    v_add_f32 v27, v27, v31
    v_add_f32 v19, v19, v27
    v_cvt_pk_bf16_f32 v16, v16, v16
    v_lshlrev_b32 v16, 16, v16
    v_cvt_pk_bf16_f32 v17, v17, v17
    v_lshlrev_b32 v17, 16, v17
    v_cvt_pk_bf16_f32 v18, v18, v18
    v_lshlrev_b32 v18, 16, v18
    v_cvt_pk_bf16_f32 v19, v19, v19
    v_lshlrev_b32 v19, 16, v19
    v_lshlrev_b32 v20, 16, v162
    v_and_b32 v21, 0xffff0000, v162
    v_lshlrev_b32 v24, 16, v160
    v_and_b32 v25, 0xffff0000, v160
    v_lshlrev_b32 v22, 16, v163
    v_and_b32 v23, 0xffff0000, v163
    v_lshlrev_b32 v26, 16, v161
    v_and_b32 v27, 0xffff0000, v161
    s_lshl_b32 s64, s24, 5
    v_add_u32 v8, s64, v9
    v_mov_b32 v10, -1
    v_cmp_eq_u32 vcc, s72, v8
    s_nop 1
    v_cndmask_b32 v10, v10, 0, vcc
    v_cmp_eq_u32 vcc, s73, v8
    s_nop 1
    v_cndmask_b32 v10, v10, 1, vcc
    v_cmp_eq_u32 vcc, s74, v8
    s_nop 1
    v_cndmask_b32 v10, v10, 2, vcc
    v_cmp_eq_u32 vcc, s75, v8
    s_nop 1
    v_cndmask_b32 v10, v10, 3, vcc
    v_cmp_eq_u32 vcc, s76, v8
    s_nop 1
    v_cndmask_b32 v10, v10, 4, vcc
    v_cmp_eq_u32 vcc, s77, v8
    s_nop 1
    v_cndmask_b32 v10, v10, 5, vcc
    v_cmp_eq_u32 vcc, s78, v8
    s_nop 1
    v_cndmask_b32 v10, v10, 6, vcc
    v_cmp_eq_u32 vcc, s79, v8
    s_nop 1
    v_cndmask_b32 v10, v10, 7, vcc
    v_cmp_le_i32 vcc, 0, v10
    s_and_saveexec_b64 s[68:69], vcc
    s_cbranch_execz NOUPD_167
    v_mul_u32_u24 v10, 2560, v10
    v_lshrrev_b32 v11, 4, v0
    v_lshl_add_u32 v10, v11, 4, v10
    s_lshl_b32 s64, s86, 6
    s_lshl_b32 s65, s13, 7
    s_add_u32 s64, s64, s65
    s_add_u32 s64, s64, 0x5410000
    buffer_load_dwordx4 v[164:167], v10, s[4:7], s64 offen sc1
    s_waitcnt vmcnt(0)
    v_add_f32 v20, v20, v164
    v_cvt_pk_bf16_f32 v20, v20, v20
    v_lshlrev_b32 v20, 16, v20
    v_add_f32 v21, v21, v165
    v_cvt_pk_bf16_f32 v21, v21, v21
    v_lshlrev_b32 v21, 16, v21
    v_add_f32 v22, v22, v166
    v_cvt_pk_bf16_f32 v22, v22, v22
    v_lshlrev_b32 v22, 16, v22
    v_add_f32 v23, v23, v167
    v_cvt_pk_bf16_f32 v23, v23, v23
    v_lshlrev_b32 v23, 16, v23
NOUPD_167:
    s_mov_b64 exec, -1
    v_mul_f32 v28, 0xbfb8aa3b, v20
    v_exp_f32 v28, v28
    s_nop 0
    v_add_f32 v28, 1.0, v28
    v_rcp_f32 v28, v28
    s_nop 0
    v_mul_f32 v28, v28, v20
    v_cvt_pk_bf16_f32 v28, v28, v28
    v_lshlrev_b32 v28, 16, v28
    v_mul_f32 v28, v28, v16
    v_cvt_pk_bf16_f32 v28, v28, v28
    v_lshlrev_b32 v28, 16, v28
    v_add_f32 v28, v28, v24
    v_mul_f32 v29, 0xbfb8aa3b, v21
    v_exp_f32 v29, v29
    s_nop 0
    v_add_f32 v29, 1.0, v29
    v_rcp_f32 v29, v29
    s_nop 0
    v_mul_f32 v29, v29, v21
    v_cvt_pk_bf16_f32 v29, v29, v29
    v_lshlrev_b32 v29, 16, v29
    v_mul_f32 v29, v29, v17
    v_cvt_pk_bf16_f32 v29, v29, v29
    v_lshlrev_b32 v29, 16, v29
    v_add_f32 v29, v29, v25
    v_mul_f32 v30, 0xbfb8aa3b, v22
    v_exp_f32 v30, v30
    s_nop 0
    v_add_f32 v30, 1.0, v30
    v_rcp_f32 v30, v30
    s_nop 0
    v_mul_f32 v30, v30, v22
    v_cvt_pk_bf16_f32 v30, v30, v30
    v_lshlrev_b32 v30, 16, v30
    v_mul_f32 v30, v30, v18
    v_cvt_pk_bf16_f32 v30, v30, v30
    v_lshlrev_b32 v30, 16, v30
    v_add_f32 v30, v30, v26
    v_mul_f32 v31, 0xbfb8aa3b, v23
    v_exp_f32 v31, v31
    s_nop 0
    v_add_f32 v31, 1.0, v31
    v_rcp_f32 v31, v31
    s_nop 0
    v_mul_f32 v31, v31, v23
    v_cvt_pk_bf16_f32 v31, v31, v31
    v_lshlrev_b32 v31, 16, v31
    v_mul_f32 v31, v31, v19
    v_cvt_pk_bf16_f32 v31, v31, v31
    v_lshlrev_b32 v31, 16, v31
    v_add_f32 v31, v31, v27
    v_cvt_pk_bf16_f32 v164, v28, v29
    v_cvt_pk_bf16_f32 v165, v30, v31
    buffer_store_dwordx2 v[164:165], v5, s[52:55], s67 offen
OTD_166:
    s_branch OU_LOOP
OU_END:
    s_cmp_lg_u32 s12, 2
    s_cbranch_scc1 OU_X
    v_mov_b32 v8, 0
    s_mov_b32 s64, 0x298100
OUW_168:
    buffer_load_dword v7, v8, s[4:7], s64 offen sc1
    s_add_u32 s29, s29, 1
    s_waitcnt vmcnt(0)
    v_cmp_gt_u32 vcc, 40, v7
    s_cbranch_vccz OUWD_169
    s_cmp_gt_u32 s29, 262144
    s_cbranch_scc1 OUWD_169
    s_sleep 8
    s_branch OUW_168
OUWD_169:
    s_mov_b32 s24, 62
    s_mov_b32 s87, 0
    s_and_b32 s86, s14, 1
    s_lshl_b32 s64, s87, 4
    v_and_b32 v6, 15, v0
    v_add_u32 v6, s64, v6
    v_mov_b32 v9, v6
    v_mul_u32_u24 v5, 1280, v6
    v_lshrrev_b32 v6, 4, v0
    v_lshl_add_u32 v5, v6, 3, v5
    s_and_b32 s64, s14, 1
    s_lshl_b32 s64, s64, 5
    s_lshl_b32 s65, s13, 6
    s_add_u32 s64, s64, s65
    v_add_u32 v5, s64, v5
    v_lshlrev_b32 v6, 2, v0
    s_mul_i32 s67, s24, 40960
    buffer_load_dwordx2 v[160:161], v5, s[48:51], s67 offen
    s_add_u32 s64, s67, 0x0
    buffer_load_dwordx2 v[162:163], v5, s[4:7], s64 offen
    s_lshl_b32 s64, s24, 7
    s_add_u32 s64, s64, 0x296000
    s_mov_b64 exec, s[36:37]
OUH_F_170:
    buffer_load_dword v7, v6, s[4:7], s64 offen sc1
    s_add_u32 s29, s29, 1
    s_waitcnt vmcnt(0)
    v_cmp_eq_u32 vcc, 0, v7
    s_cbranch_vccz OUH_FD_171
    s_cmp_gt_u32 s29, 262144
    s_cbranch_scc1 OUH_FD_171
    s_sleep 1
    s_branch OUH_F_170
OUH_FD_171:
    s_mov_b64 exec, -1
    s_lshl_b32 s25, s24, 18
    s_lshl_b32 s64, s14, 15
    s_add_u32 s25, s25, s64
    s_add_u32 s25, s25, 0x4400000
    s_lshl_b32 s64, s87, 17
    s_add_u32 s25, s25, s64
    s_add_u32 s64, s25, 0x0
    buffer_load_dwordx4 v[16:19], v1, s[4:7], s64 offen
    s_add_u32 s64, s25, 0x400
    buffer_load_dwordx4 v[20:23], v1, s[4:7], s64 offen
    s_add_u32 s64, s25, 0x800
    buffer_load_dwordx4 v[24:27], v1, s[4:7], s64 offen
    s_add_u32 s64, s25, 0xc00
    buffer_load_dwordx4 v[28:31], v1, s[4:7], s64 offen
    s_add_u32 s64, s25, 0x1000
    buffer_load_dwordx4 v[32:35], v1, s[4:7], s64 offen
    s_add_u32 s64, s25, 0x1400
    buffer_load_dwordx4 v[36:39], v1, s[4:7], s64 offen
    s_add_u32 s64, s25, 0x1800
    buffer_load_dwordx4 v[40:43], v1, s[4:7], s64 offen
    s_add_u32 s64, s25, 0x1c00
    buffer_load_dwordx4 v[44:47], v1, s[4:7], s64 offen
    s_add_u32 s64, s25, 0x2000
    buffer_load_dwordx4 v[48:51], v1, s[4:7], s64 offen
    s_add_u32 s64, s25, 0x2400
    buffer_load_dwordx4 v[52:55], v1, s[4:7], s64 offen
    s_add_u32 s64, s25, 0x2800
    buffer_load_dwordx4 v[56:59], v1, s[4:7], s64 offen
    s_add_u32 s64, s25, 0x2c00
    buffer_load_dwordx4 v[60:63], v1, s[4:7], s64 offen
    s_add_u32 s64, s25, 0x3000
    buffer_load_dwordx4 v[64:67], v1, s[4:7], s64 offen
    s_add_u32 s64, s25, 0x3400
    buffer_load_dwordx4 v[68:71], v1, s[4:7], s64 offen
    s_add_u32 s64, s25, 0x3800
    buffer_load_dwordx4 v[72:75], v1, s[4:7], s64 offen
    s_add_u32 s64, s25, 0x3c00
    buffer_load_dwordx4 v[76:79], v1, s[4:7], s64 offen
    s_add_u32 s64, s25, 0x4000
    buffer_load_dwordx4 v[80:83], v1, s[4:7], s64 offen
    s_add_u32 s64, s25, 0x4400
    buffer_load_dwordx4 v[84:87], v1, s[4:7], s64 offen
    s_add_u32 s64, s25, 0x4800
    buffer_load_dwordx4 v[88:91], v1, s[4:7], s64 offen
    s_add_u32 s64, s25, 0x4c00
    buffer_load_dwordx4 v[92:95], v1, s[4:7], s64 offen
    s_add_u32 s64, s25, 0x5000
    buffer_load_dwordx4 v[96:99], v1, s[4:7], s64 offen
    s_add_u32 s64, s25, 0x5400
    buffer_load_dwordx4 v[100:103], v1, s[4:7], s64 offen
    s_add_u32 s64, s25, 0x5800
    buffer_load_dwordx4 v[104:107], v1, s[4:7], s64 offen
    s_add_u32 s64, s25, 0x5c00
    buffer_load_dwordx4 v[108:111], v1, s[4:7], s64 offen
    s_add_u32 s64, s25, 0x6000
    buffer_load_dwordx4 v[112:115], v1, s[4:7], s64 offen
    s_add_u32 s64, s25, 0x6400
    buffer_load_dwordx4 v[116:119], v1, s[4:7], s64 offen
    s_add_u32 s64, s25, 0x6800
    buffer_load_dwordx4 v[120:123], v1, s[4:7], s64 offen
    s_add_u32 s64, s25, 0x6c00
    buffer_load_dwordx4 v[124:127], v1, s[4:7], s64 offen
    s_add_u32 s64, s25, 0x7000
    buffer_load_dwordx4 v[128:131], v1, s[4:7], s64 offen
    s_add_u32 s64, s25, 0x7400
    buffer_load_dwordx4 v[132:135], v1, s[4:7], s64 offen
    s_add_u32 s64, s25, 0x7800
    buffer_load_dwordx4 v[136:139], v1, s[4:7], s64 offen
    s_add_u32 s64, s25, 0x7c00
    buffer_load_dwordx4 v[140:143], v1, s[4:7], s64 offen
    s_waitcnt vmcnt(31)
    v_mfma_f32_16x16x32_bf16 v[144:147], a[0:3], v[16:19], 0
    v_mfma_f32_16x16x32_bf16 v[148:151], a[4:7], v[16:19], 0
    s_waitcnt vmcnt(30)
    v_mfma_f32_16x16x32_bf16 v[144:147], a[8:11], v[20:23], v[144:147]
    v_mfma_f32_16x16x32_bf16 v[148:151], a[12:15], v[20:23], v[148:151]
    s_waitcnt vmcnt(29)
    v_mfma_f32_16x16x32_bf16 v[144:147], a[16:19], v[24:27], v[144:147]
    v_mfma_f32_16x16x32_bf16 v[148:151], a[20:23], v[24:27], v[148:151]
    s_waitcnt vmcnt(28)
    v_mfma_f32_16x16x32_bf16 v[144:147], a[24:27], v[28:31], v[144:147]
    v_mfma_f32_16x16x32_bf16 v[148:151], a[28:31], v[28:31], v[148:151]
    s_waitcnt vmcnt(27)
    v_mfma_f32_16x16x32_bf16 v[144:147], a[32:35], v[32:35], v[144:147]
    v_mfma_f32_16x16x32_bf16 v[148:151], a[36:39], v[32:35], v[148:151]
    s_waitcnt vmcnt(26)
    v_mfma_f32_16x16x32_bf16 v[144:147], a[40:43], v[36:39], v[144:147]
    v_mfma_f32_16x16x32_bf16 v[148:151], a[44:47], v[36:39], v[148:151]
    s_waitcnt vmcnt(25)
    v_mfma_f32_16x16x32_bf16 v[144:147], a[48:51], v[40:43], v[144:147]
    v_mfma_f32_16x16x32_bf16 v[148:151], a[52:55], v[40:43], v[148:151]
    s_waitcnt vmcnt(24)
    v_mfma_f32_16x16x32_bf16 v[144:147], a[56:59], v[44:47], v[144:147]
    v_mfma_f32_16x16x32_bf16 v[148:151], a[60:63], v[44:47], v[148:151]
    s_waitcnt vmcnt(23)
    v_mfma_f32_16x16x32_bf16 v[144:147], a[64:67], v[48:51], v[144:147]
    v_mfma_f32_16x16x32_bf16 v[148:151], a[68:71], v[48:51], v[148:151]
    s_waitcnt vmcnt(22)
    v_mfma_f32_16x16x32_bf16 v[144:147], a[72:75], v[52:55], v[144:147]
    v_mfma_f32_16x16x32_bf16 v[148:151], a[76:79], v[52:55], v[148:151]
    s_waitcnt vmcnt(21)
    v_mfma_f32_16x16x32_bf16 v[144:147], a[80:83], v[56:59], v[144:147]
    v_mfma_f32_16x16x32_bf16 v[148:151], a[84:87], v[56:59], v[148:151]
    s_waitcnt vmcnt(20)
    v_mfma_f32_16x16x32_bf16 v[144:147], a[88:91], v[60:63], v[144:147]
    v_mfma_f32_16x16x32_bf16 v[148:151], a[92:95], v[60:63], v[148:151]
    s_waitcnt vmcnt(19)
    v_mfma_f32_16x16x32_bf16 v[144:147], a[96:99], v[64:67], v[144:147]
    v_mfma_f32_16x16x32_bf16 v[148:151], a[100:103], v[64:67], v[148:151]
    s_waitcnt vmcnt(18)
    v_mfma_f32_16x16x32_bf16 v[144:147], a[104:107], v[68:71], v[144:147]
    v_mfma_f32_16x16x32_bf16 v[148:151], a[108:111], v[68:71], v[148:151]
    s_waitcnt vmcnt(17)
    v_mfma_f32_16x16x32_bf16 v[144:147], a[112:115], v[72:75], v[144:147]
    v_mfma_f32_16x16x32_bf16 v[148:151], a[116:119], v[72:75], v[148:151]
    s_waitcnt vmcnt(16)
    v_mfma_f32_16x16x32_bf16 v[144:147], a[120:123], v[76:79], v[144:147]
    v_mfma_f32_16x16x32_bf16 v[148:151], a[124:127], v[76:79], v[148:151]
    s_waitcnt vmcnt(15)
    v_mfma_f32_16x16x32_bf16 v[144:147], a[128:131], v[80:83], v[144:147]
    v_mfma_f32_16x16x32_bf16 v[148:151], a[132:135], v[80:83], v[148:151]
    s_waitcnt vmcnt(14)
    v_mfma_f32_16x16x32_bf16 v[144:147], a[136:139], v[84:87], v[144:147]
    v_mfma_f32_16x16x32_bf16 v[148:151], a[140:143], v[84:87], v[148:151]
    s_waitcnt vmcnt(13)
    v_mfma_f32_16x16x32_bf16 v[144:147], a[144:147], v[88:91], v[144:147]
    v_mfma_f32_16x16x32_bf16 v[148:151], a[148:151], v[88:91], v[148:151]
    s_waitcnt vmcnt(12)
    v_mfma_f32_16x16x32_bf16 v[144:147], a[152:155], v[92:95], v[144:147]
    v_mfma_f32_16x16x32_bf16 v[148:151], a[156:159], v[92:95], v[148:151]
    s_waitcnt vmcnt(11)
    v_mfma_f32_16x16x32_bf16 v[144:147], a[160:163], v[96:99], v[144:147]
    v_mfma_f32_16x16x32_bf16 v[148:151], a[164:167], v[96:99], v[148:151]
    s_waitcnt vmcnt(10)
    v_mfma_f32_16x16x32_bf16 v[144:147], a[168:171], v[100:103], v[144:147]
    v_mfma_f32_16x16x32_bf16 v[148:151], a[172:175], v[100:103], v[148:151]
    s_waitcnt vmcnt(9)
    v_mfma_f32_16x16x32_bf16 v[144:147], a[176:179], v[104:107], v[144:147]
    v_mfma_f32_16x16x32_bf16 v[148:151], a[180:183], v[104:107], v[148:151]
    s_waitcnt vmcnt(8)
    v_mfma_f32_16x16x32_bf16 v[144:147], a[184:187], v[108:111], v[144:147]
    v_mfma_f32_16x16x32_bf16 v[148:151], a[188:191], v[108:111], v[148:151]
    s_waitcnt vmcnt(7)
    v_mfma_f32_16x16x32_bf16 v[144:147], a[192:195], v[112:115], v[144:147]
    v_mfma_f32_16x16x32_bf16 v[148:151], a[196:199], v[112:115], v[148:151]
    s_waitcnt vmcnt(6)
    v_mfma_f32_16x16x32_bf16 v[144:147], a[200:203], v[116:119], v[144:147]
    v_mfma_f32_16x16x32_bf16 v[148:151], a[204:207], v[116:119], v[148:151]
    s_waitcnt vmcnt(5)
    v_mfma_f32_16x16x32_bf16 v[144:147], a[208:211], v[120:123], v[144:147]
    v_mfma_f32_16x16x32_bf16 v[148:151], a[212:215], v[120:123], v[148:151]
    s_waitcnt vmcnt(4)
    v_mfma_f32_16x16x32_bf16 v[144:147], a[216:219], v[124:127], v[144:147]
    v_mfma_f32_16x16x32_bf16 v[148:151], a[220:223], v[124:127], v[148:151]
    s_waitcnt vmcnt(3)
    v_mfma_f32_16x16x32_bf16 v[144:147], a[224:227], v[128:131], v[144:147]
    v_mfma_f32_16x16x32_bf16 v[148:151], a[228:231], v[128:131], v[148:151]
    s_waitcnt vmcnt(2)
    v_mfma_f32_16x16x32_bf16 v[144:147], a[232:235], v[132:135], v[144:147]
    v_mfma_f32_16x16x32_bf16 v[148:151], a[236:239], v[132:135], v[148:151]
    s_waitcnt vmcnt(1)
    v_mfma_f32_16x16x32_bf16 v[144:147], a[240:243], v[136:139], v[144:147]
    v_mfma_f32_16x16x32_bf16 v[148:151], a[244:247], v[136:139], v[148:151]
    s_waitcnt vmcnt(0)
    v_mfma_f32_16x16x32_bf16 v[144:147], a[248:251], v[140:143], v[144:147]
    v_mfma_f32_16x16x32_bf16 v[148:151], a[252:255], v[140:143], v[148:151]
    s_lshl_b32 s64, s14, 12
    v_add_u32 v7, s64, v1
    s_barrier
    s_nop 3
    ds_write_b128 v7, v[144:147] offset:0
    ds_write_b128 v7, v[148:151] offset:1024
    s_waitcnt lgkmcnt(0)
    s_barrier
    s_cmp_ge_u32 s14, 2
    s_cbranch_scc1 OTD_172
    s_lshl_b32 s64, s14, 10
    v_add_u32 v7, s64, v1
    ds_read_b128 v[16:19], v7 offset:0
    ds_read_b128 v[20:23], v7 offset:4096
    ds_read_b128 v[24:27], v7 offset:8192
    ds_read_b128 v[28:31], v7 offset:12288
    s_waitcnt lgkmcnt(0)
    v_add_f32 v16, v16, v20
    v_add_f32 v24, v24, v28
    v_add_f32 v16, v16, v24
    v_add_f32 v17, v17, v21
    v_add_f32 v25, v25, v29
    v_add_f32 v17, v17, v25
    v_add_f32 v18, v18, v22
    v_add_f32 v26, v26, v30
    v_add_f32 v18, v18, v26
    v_add_f32 v19, v19, v23
    v_add_f32 v27, v27, v31
    v_add_f32 v19, v19, v27
    v_cvt_pk_bf16_f32 v16, v16, v16
    v_lshlrev_b32 v16, 16, v16
    v_cvt_pk_bf16_f32 v17, v17, v17
    v_lshlrev_b32 v17, 16, v17
    v_cvt_pk_bf16_f32 v18, v18, v18
    v_lshlrev_b32 v18, 16, v18
    v_cvt_pk_bf16_f32 v19, v19, v19
    v_lshlrev_b32 v19, 16, v19
    v_lshlrev_b32 v20, 16, v162
    v_and_b32 v21, 0xffff0000, v162
    v_lshlrev_b32 v24, 16, v160
    v_and_b32 v25, 0xffff0000, v160
    v_lshlrev_b32 v22, 16, v163
    v_and_b32 v23, 0xffff0000, v163
    v_lshlrev_b32 v26, 16, v161
    v_and_b32 v27, 0xffff0000, v161
    s_lshl_b32 s64, s24, 5
    v_add_u32 v8, s64, v9
    v_mov_b32 v10, -1
    v_cmp_eq_u32 vcc, s72, v8
    s_nop 1
    v_cndmask_b32 v10, v10, 0, vcc
    v_cmp_eq_u32 vcc, s73, v8
    s_nop 1
    v_cndmask_b32 v10, v10, 1, vcc
    v_cmp_eq_u32 vcc, s74, v8
    s_nop 1
    v_cndmask_b32 v10, v10, 2, vcc
    v_cmp_eq_u32 vcc, s75, v8
    s_nop 1
    v_cndmask_b32 v10, v10, 3, vcc
    v_cmp_eq_u32 vcc, s76, v8
    s_nop 1
    v_cndmask_b32 v10, v10, 4, vcc
    v_cmp_eq_u32 vcc, s77, v8
    s_nop 1
    v_cndmask_b32 v10, v10, 5, vcc
    v_cmp_eq_u32 vcc, s78, v8
    s_nop 1
    v_cndmask_b32 v10, v10, 6, vcc
    v_cmp_eq_u32 vcc, s79, v8
    s_nop 1
    v_cndmask_b32 v10, v10, 7, vcc
    v_cmp_le_i32 vcc, 0, v10
    s_and_saveexec_b64 s[68:69], vcc
    s_cbranch_execz NOUPD_173
    v_mul_u32_u24 v10, 2560, v10
    v_lshrrev_b32 v11, 4, v0
    v_lshl_add_u32 v10, v11, 4, v10
    s_lshl_b32 s64, s86, 6
    s_lshl_b32 s65, s13, 7
    s_add_u32 s64, s64, s65
    s_add_u32 s64, s64, 0x5410000
    buffer_load_dwordx4 v[164:167], v10, s[4:7], s64 offen sc1
    s_waitcnt vmcnt(0)
    v_add_f32 v20, v20, v164
    v_cvt_pk_bf16_f32 v20, v20, v20
    v_lshlrev_b32 v20, 16, v20
    v_add_f32 v21, v21, v165
    v_cvt_pk_bf16_f32 v21, v21, v21
    v_lshlrev_b32 v21, 16, v21
    v_add_f32 v22, v22, v166
    v_cvt_pk_bf16_f32 v22, v22, v22
    v_lshlrev_b32 v22, 16, v22
    v_add_f32 v23, v23, v167
    v_cvt_pk_bf16_f32 v23, v23, v23
    v_lshlrev_b32 v23, 16, v23
NOUPD_173:
    s_mov_b64 exec, -1
    v_mul_f32 v28, 0xbfb8aa3b, v20
    v_exp_f32 v28, v28
    s_nop 0
    v_add_f32 v28, 1.0, v28
    v_rcp_f32 v28, v28
    s_nop 0
    v_mul_f32 v28, v28, v20
    v_cvt_pk_bf16_f32 v28, v28, v28
    v_lshlrev_b32 v28, 16, v28
    v_mul_f32 v28, v28, v16
    v_cvt_pk_bf16_f32 v28, v28, v28
    v_lshlrev_b32 v28, 16, v28
    v_add_f32 v28, v28, v24
    v_mul_f32 v29, 0xbfb8aa3b, v21
    v_exp_f32 v29, v29
    s_nop 0
    v_add_f32 v29, 1.0, v29
    v_rcp_f32 v29, v29
    s_nop 0
    v_mul_f32 v29, v29, v21
    v_cvt_pk_bf16_f32 v29, v29, v29
    v_lshlrev_b32 v29, 16, v29
    v_mul_f32 v29, v29, v17
    v_cvt_pk_bf16_f32 v29, v29, v29
    v_lshlrev_b32 v29, 16, v29
    v_add_f32 v29, v29, v25
    v_mul_f32 v30, 0xbfb8aa3b, v22
    v_exp_f32 v30, v30
    s_nop 0
    v_add_f32 v30, 1.0, v30
    v_rcp_f32 v30, v30
    s_nop 0
    v_mul_f32 v30, v30, v22
    v_cvt_pk_bf16_f32 v30, v30, v30
    v_lshlrev_b32 v30, 16, v30
    v_mul_f32 v30, v30, v18
    v_cvt_pk_bf16_f32 v30, v30, v30
    v_lshlrev_b32 v30, 16, v30
    v_add_f32 v30, v30, v26
    v_mul_f32 v31, 0xbfb8aa3b, v23
    v_exp_f32 v31, v31
    s_nop 0
    v_add_f32 v31, 1.0, v31
    v_rcp_f32 v31, v31
    s_nop 0
    v_mul_f32 v31, v31, v23
    v_cvt_pk_bf16_f32 v31, v31, v31
    v_lshlrev_b32 v31, 16, v31
    v_mul_f32 v31, v31, v19
    v_cvt_pk_bf16_f32 v31, v31, v31
    v_lshlrev_b32 v31, 16, v31
    v_add_f32 v31, v31, v27
    v_cvt_pk_bf16_f32 v164, v28, v29
    v_cvt_pk_bf16_f32 v165, v30, v31
    buffer_store_dwordx2 v[164:165], v5, s[52:55], s67 offen
OTD_172:
OU_X:
    s_branch M_EXIT
H_EXTRA:
    s_mul_hi_u32 s12, s88, 0xccccccd
    s_mul_i32 s65, s12, 20
    s_sub_u32 s13, s88, s65
    s_add_u32 s12, s12, 3
    s_load_dwordx2 s[48:49], s[0:1], 0
    s_mov_b32 s50, 0x280000
    s_mov_b32 s51, 0x00020000
    s_load_dwordx2 s[52:53], s[0:1], 96
    s_mov_b32 s54, 0x280000
    s_mov_b32 s55, 0x00020000
    s_mov_b32 s36, -1
    s_mov_b32 s37, 0
    s_waitcnt lgkmcnt(0)
    v_mbcnt_lo_u32_b32 v0, -1, 0
    v_mbcnt_hi_u32_b32 v0, -1, v0
    s_mov_b32 s29, 0
    v_lshlrev_b32 v1, 4, v0
    v_lshlrev_b32 v6, 2, v0
    v_mov_b32 v8, 0
    s_mov_b32 s64, 0x298100
OXW_174:
    buffer_load_dword v7, v8, s[4:7], s64 offen sc1
    s_add_u32 s29, s29, 1
    s_waitcnt vmcnt(0)
    v_cmp_gt_u32 vcc, 40, v7
    s_cbranch_vccz OXWD_175
    s_cmp_gt_u32 s29, 262144
    s_cbranch_scc1 OXWD_175
    s_sleep 8
    s_branch OXW_174
OXWD_175:
    v_lshlrev_b32 v6, 2, v0
    s_mov_b32 s64, 0x5400000
    buffer_load_dword v7, v6, s[4:7], s64 offen sc1
    s_waitcnt vmcnt(0)
    v_readlane_b32 s72, v7, 0
    v_readlane_b32 s73, v7, 1
    v_readlane_b32 s74, v7, 2
    v_readlane_b32 s75, v7, 3
    v_readlane_b32 s76, v7, 4
    v_readlane_b32 s77, v7, 5
    v_readlane_b32 s78, v7, 6
    v_readlane_b32 s79, v7, 7
    s_cmp_eq_u32 s12, 3
    s_cselect_b32 s24, 62, 63
    s_cmp_eq_u32 s12, 4
    s_cselect_b32 s87, 0, 1
    s_and_b32 s86, s14, 1
    s_lshl_b32 s64, s87, 4
    v_and_b32 v6, 15, v0
    v_add_u32 v6, s64, v6
    v_mov_b32 v9, v6
    v_mul_u32_u24 v5, 1280, v6
    v_lshrrev_b32 v6, 4, v0
    v_lshl_add_u32 v5, v6, 3, v5
    s_and_b32 s64, s14, 1
    s_lshl_b32 s64, s64, 5
    s_lshl_b32 s65, s13, 6
    s_add_u32 s64, s64, s65
    v_add_u32 v5, s64, v5
    v_lshlrev_b32 v6, 2, v0
    s_mul_i32 s67, s24, 40960
    buffer_load_dwordx2 v[160:161], v5, s[48:51], s67 offen
    s_add_u32 s64, s67, 0x0
    buffer_load_dwordx2 v[162:163], v5, s[4:7], s64 offen
    s_lshl_b32 s64, s24, 7
    s_add_u32 s64, s64, 0x296000
    s_mov_b64 exec, s[36:37]
OX_F_176:
    buffer_load_dword v7, v6, s[4:7], s64 offen sc1
    s_add_u32 s29, s29, 1
    s_waitcnt vmcnt(0)
    v_cmp_eq_u32 vcc, 0, v7
    s_cbranch_vccz OX_FD_177
    s_cmp_gt_u32 s29, 262144
    s_cbranch_scc1 OX_FD_177
    s_sleep 1
    s_branch OX_F_176
OX_FD_177:
    s_mov_b64 exec, -1
    s_lshl_b32 s25, s24, 18
    s_lshl_b32 s64, s14, 15
    s_add_u32 s25, s25, s64
    s_add_u32 s25, s25, 0x4400000
    s_lshl_b32 s64, s87, 17
    s_add_u32 s25, s25, s64
    s_add_u32 s64, s25, 0x0
    buffer_load_dwordx4 v[16:19], v1, s[4:7], s64 offen
    s_add_u32 s64, s25, 0x400
    buffer_load_dwordx4 v[20:23], v1, s[4:7], s64 offen
    s_add_u32 s64, s25, 0x800
    buffer_load_dwordx4 v[24:27], v1, s[4:7], s64 offen
    s_add_u32 s64, s25, 0xc00
    buffer_load_dwordx4 v[28:31], v1, s[4:7], s64 offen
    s_add_u32 s64, s25, 0x1000
    buffer_load_dwordx4 v[32:35], v1, s[4:7], s64 offen
    s_add_u32 s64, s25, 0x1400
    buffer_load_dwordx4 v[36:39], v1, s[4:7], s64 offen
    s_add_u32 s64, s25, 0x1800
    buffer_load_dwordx4 v[40:43], v1, s[4:7], s64 offen
    s_add_u32 s64, s25, 0x1c00
    buffer_load_dwordx4 v[44:47], v1, s[4:7], s64 offen
    s_add_u32 s64, s25, 0x2000
    buffer_load_dwordx4 v[48:51], v1, s[4:7], s64 offen
    s_add_u32 s64, s25, 0x2400
    buffer_load_dwordx4 v[52:55], v1, s[4:7], s64 offen
    s_add_u32 s64, s25, 0x2800
    buffer_load_dwordx4 v[56:59], v1, s[4:7], s64 offen
    s_add_u32 s64, s25, 0x2c00
    buffer_load_dwordx4 v[60:63], v1, s[4:7], s64 offen
    s_add_u32 s64, s25, 0x3000
    buffer_load_dwordx4 v[64:67], v1, s[4:7], s64 offen
    s_add_u32 s64, s25, 0x3400
    buffer_load_dwordx4 v[68:71], v1, s[4:7], s64 offen
    s_add_u32 s64, s25, 0x3800
    buffer_load_dwordx4 v[72:75], v1, s[4:7], s64 offen
    s_add_u32 s64, s25, 0x3c00
    buffer_load_dwordx4 v[76:79], v1, s[4:7], s64 offen
    s_add_u32 s64, s25, 0x4000
    buffer_load_dwordx4 v[80:83], v1, s[4:7], s64 offen
    s_add_u32 s64, s25, 0x4400
    buffer_load_dwordx4 v[84:87], v1, s[4:7], s64 offen
    s_add_u32 s64, s25, 0x4800
    buffer_load_dwordx4 v[88:91], v1, s[4:7], s64 offen
    s_add_u32 s64, s25, 0x4c00
    buffer_load_dwordx4 v[92:95], v1, s[4:7], s64 offen
    s_add_u32 s64, s25, 0x5000
    buffer_load_dwordx4 v[96:99], v1, s[4:7], s64 offen
    s_add_u32 s64, s25, 0x5400
    buffer_load_dwordx4 v[100:103], v1, s[4:7], s64 offen
    s_add_u32 s64, s25, 0x5800
    buffer_load_dwordx4 v[104:107], v1, s[4:7], s64 offen
    s_add_u32 s64, s25, 0x5c00
    buffer_load_dwordx4 v[108:111], v1, s[4:7], s64 offen
    s_add_u32 s64, s25, 0x6000
    buffer_load_dwordx4 v[112:115], v1, s[4:7], s64 offen
    s_add_u32 s64, s25, 0x6400
    buffer_load_dwordx4 v[116:119], v1, s[4:7], s64 offen
    s_add_u32 s64, s25, 0x6800
    buffer_load_dwordx4 v[120:123], v1, s[4:7], s64 offen
    s_add_u32 s64, s25, 0x6c00
    buffer_load_dwordx4 v[124:127], v1, s[4:7], s64 offen
    s_add_u32 s64, s25, 0x7000
    buffer_load_dwordx4 v[128:131], v1, s[4:7], s64 offen
    s_add_u32 s64, s25, 0x7400
    buffer_load_dwordx4 v[132:135], v1, s[4:7], s64 offen
    s_add_u32 s64, s25, 0x7800
    buffer_load_dwordx4 v[136:139], v1, s[4:7], s64 offen
    s_add_u32 s64, s25, 0x7c00
    buffer_load_dwordx4 v[140:143], v1, s[4:7], s64 offen
    s_waitcnt vmcnt(31)
    v_mfma_f32_16x16x32_bf16 v[144:147], a[0:3], v[16:19], 0
    v_mfma_f32_16x16x32_bf16 v[148:151], a[4:7], v[16:19], 0
    s_waitcnt vmcnt(30)
    v_mfma_f32_16x16x32_bf16 v[144:147], a[8:11], v[20:23], v[144:147]
    v_mfma_f32_16x16x32_bf16 v[148:151], a[12:15], v[20:23], v[148:151]
    s_waitcnt vmcnt(29)
    v_mfma_f32_16x16x32_bf16 v[144:147], a[16:19], v[24:27], v[144:147]
    v_mfma_f32_16x16x32_bf16 v[148:151], a[20:23], v[24:27], v[148:151]
    s_waitcnt vmcnt(28)
    v_mfma_f32_16x16x32_bf16 v[144:147], a[24:27], v[28:31], v[144:147]
    v_mfma_f32_16x16x32_bf16 v[148:151], a[28:31], v[28:31], v[148:151]
    s_waitcnt vmcnt(27)
    v_mfma_f32_16x16x32_bf16 v[144:147], a[32:35], v[32:35], v[144:147]
    v_mfma_f32_16x16x32_bf16 v[148:151], a[36:39], v[32:35], v[148:151]
    s_waitcnt vmcnt(26)
    v_mfma_f32_16x16x32_bf16 v[144:147], a[40:43], v[36:39], v[144:147]
    v_mfma_f32_16x16x32_bf16 v[148:151], a[44:47], v[36:39], v[148:151]
    s_waitcnt vmcnt(25)
    v_mfma_f32_16x16x32_bf16 v[144:147], a[48:51], v[40:43], v[144:147]
    v_mfma_f32_16x16x32_bf16 v[148:151], a[52:55], v[40:43], v[148:151]
    s_waitcnt vmcnt(24)
    v_mfma_f32_16x16x32_bf16 v[144:147], a[56:59], v[44:47], v[144:147]
    v_mfma_f32_16x16x32_bf16 v[148:151], a[60:63], v[44:47], v[148:151]
    s_waitcnt vmcnt(23)
    v_mfma_f32_16x16x32_bf16 v[144:147], a[64:67], v[48:51], v[144:147]
    v_mfma_f32_16x16x32_bf16 v[148:151], a[68:71], v[48:51], v[148:151]
    s_waitcnt vmcnt(22)
    v_mfma_f32_16x16x32_bf16 v[144:147], a[72:75], v[52:55], v[144:147]
    v_mfma_f32_16x16x32_bf16 v[148:151], a[76:79], v[52:55], v[148:151]
    s_waitcnt vmcnt(21)
    v_mfma_f32_16x16x32_bf16 v[144:147], a[80:83], v[56:59], v[144:147]
    v_mfma_f32_16x16x32_bf16 v[148:151], a[84:87], v[56:59], v[148:151]
    s_waitcnt vmcnt(20)
    v_mfma_f32_16x16x32_bf16 v[144:147], a[88:91], v[60:63], v[144:147]
    v_mfma_f32_16x16x32_bf16 v[148:151], a[92:95], v[60:63], v[148:151]
    s_waitcnt vmcnt(19)
    v_mfma_f32_16x16x32_bf16 v[144:147], a[96:99], v[64:67], v[144:147]
    v_mfma_f32_16x16x32_bf16 v[148:151], a[100:103], v[64:67], v[148:151]
    s_waitcnt vmcnt(18)
    v_mfma_f32_16x16x32_bf16 v[144:147], a[104:107], v[68:71], v[144:147]
    v_mfma_f32_16x16x32_bf16 v[148:151], a[108:111], v[68:71], v[148:151]
    s_waitcnt vmcnt(17)
    v_mfma_f32_16x16x32_bf16 v[144:147], a[112:115], v[72:75], v[144:147]
    v_mfma_f32_16x16x32_bf16 v[148:151], a[116:119], v[72:75], v[148:151]
    s_waitcnt vmcnt(16)
    v_mfma_f32_16x16x32_bf16 v[144:147], a[120:123], v[76:79], v[144:147]
    v_mfma_f32_16x16x32_bf16 v[148:151], a[124:127], v[76:79], v[148:151]
    s_waitcnt vmcnt(15)
    v_mfma_f32_16x16x32_bf16 v[144:147], a[128:131], v[80:83], v[144:147]
    v_mfma_f32_16x16x32_bf16 v[148:151], a[132:135], v[80:83], v[148:151]
    s_waitcnt vmcnt(14)
    v_mfma_f32_16x16x32_bf16 v[144:147], a[136:139], v[84:87], v[144:147]
    v_mfma_f32_16x16x32_bf16 v[148:151], a[140:143], v[84:87], v[148:151]
    s_waitcnt vmcnt(13)
    v_mfma_f32_16x16x32_bf16 v[144:147], a[144:147], v[88:91], v[144:147]
    v_mfma_f32_16x16x32_bf16 v[148:151], a[148:151], v[88:91], v[148:151]
    s_waitcnt vmcnt(12)
    v_mfma_f32_16x16x32_bf16 v[144:147], a[152:155], v[92:95], v[144:147]
    v_mfma_f32_16x16x32_bf16 v[148:151], a[156:159], v[92:95], v[148:151]
    s_waitcnt vmcnt(11)
    v_mfma_f32_16x16x32_bf16 v[144:147], a[160:163], v[96:99], v[144:147]
    v_mfma_f32_16x16x32_bf16 v[148:151], a[164:167], v[96:99], v[148:151]
    s_waitcnt vmcnt(10)
    v_mfma_f32_16x16x32_bf16 v[144:147], a[168:171], v[100:103], v[144:147]
    v_mfma_f32_16x16x32_bf16 v[148:151], a[172:175], v[100:103], v[148:151]
    s_waitcnt vmcnt(9)
    v_mfma_f32_16x16x32_bf16 v[144:147], a[176:179], v[104:107], v[144:147]
    v_mfma_f32_16x16x32_bf16 v[148:151], a[180:183], v[104:107], v[148:151]
    s_waitcnt vmcnt(8)
    v_mfma_f32_16x16x32_bf16 v[144:147], a[184:187], v[108:111], v[144:147]
    v_mfma_f32_16x16x32_bf16 v[148:151], a[188:191], v[108:111], v[148:151]
    s_waitcnt vmcnt(7)
    v_mfma_f32_16x16x32_bf16 v[144:147], a[192:195], v[112:115], v[144:147]
    v_mfma_f32_16x16x32_bf16 v[148:151], a[196:199], v[112:115], v[148:151]
    s_waitcnt vmcnt(6)
    v_mfma_f32_16x16x32_bf16 v[144:147], a[200:203], v[116:119], v[144:147]
    v_mfma_f32_16x16x32_bf16 v[148:151], a[204:207], v[116:119], v[148:151]
    s_waitcnt vmcnt(5)
    v_mfma_f32_16x16x32_bf16 v[144:147], a[208:211], v[120:123], v[144:147]
    v_mfma_f32_16x16x32_bf16 v[148:151], a[212:215], v[120:123], v[148:151]
    s_waitcnt vmcnt(4)
    v_mfma_f32_16x16x32_bf16 v[144:147], a[216:219], v[124:127], v[144:147]
    v_mfma_f32_16x16x32_bf16 v[148:151], a[220:223], v[124:127], v[148:151]
    s_waitcnt vmcnt(3)
    v_mfma_f32_16x16x32_bf16 v[144:147], a[224:227], v[128:131], v[144:147]
    v_mfma_f32_16x16x32_bf16 v[148:151], a[228:231], v[128:131], v[148:151]
    s_waitcnt vmcnt(2)
    v_mfma_f32_16x16x32_bf16 v[144:147], a[232:235], v[132:135], v[144:147]
    v_mfma_f32_16x16x32_bf16 v[148:151], a[236:239], v[132:135], v[148:151]
    s_waitcnt vmcnt(1)
    v_mfma_f32_16x16x32_bf16 v[144:147], a[240:243], v[136:139], v[144:147]
    v_mfma_f32_16x16x32_bf16 v[148:151], a[244:247], v[136:139], v[148:151]
    s_waitcnt vmcnt(0)
    v_mfma_f32_16x16x32_bf16 v[144:147], a[248:251], v[140:143], v[144:147]
    v_mfma_f32_16x16x32_bf16 v[148:151], a[252:255], v[140:143], v[148:151]
    s_lshl_b32 s64, s14, 12
    v_add_u32 v7, s64, v1
    s_barrier
    s_nop 3
    ds_write_b128 v7, v[144:147] offset:0
    ds_write_b128 v7, v[148:151] offset:1024
    s_waitcnt lgkmcnt(0)
    s_barrier
    s_cmp_ge_u32 s14, 2
    s_cbranch_scc1 OTD_178
    s_lshl_b32 s64, s14, 10
    v_add_u32 v7, s64, v1
    ds_read_b128 v[16:19], v7 offset:0
    ds_read_b128 v[20:23], v7 offset:4096
    ds_read_b128 v[24:27], v7 offset:8192
    ds_read_b128 v[28:31], v7 offset:12288
    s_waitcnt lgkmcnt(0)
    v_add_f32 v16, v16, v20
    v_add_f32 v24, v24, v28
    v_add_f32 v16, v16, v24
    v_add_f32 v17, v17, v21
    v_add_f32 v25, v25, v29
    v_add_f32 v17, v17, v25
    v_add_f32 v18, v18, v22
    v_add_f32 v26, v26, v30
    v_add_f32 v18, v18, v26
    v_add_f32 v19, v19, v23
    v_add_f32 v27, v27, v31
    v_add_f32 v19, v19, v27
    v_cvt_pk_bf16_f32 v16, v16, v16
    v_lshlrev_b32 v16, 16, v16
    v_cvt_pk_bf16_f32 v17, v17, v17
    v_lshlrev_b32 v17, 16, v17
    v_cvt_pk_bf16_f32 v18, v18, v18
    v_lshlrev_b32 v18, 16, v18
    v_cvt_pk_bf16_f32 v19, v19, v19
    v_lshlrev_b32 v19, 16, v19
    v_lshlrev_b32 v20, 16, v162
    v_and_b32 v21, 0xffff0000, v162
    v_lshlrev_b32 v24, 16, v160
    v_and_b32 v25, 0xffff0000, v160
    v_lshlrev_b32 v22, 16, v163
    v_and_b32 v23, 0xffff0000, v163
    v_lshlrev_b32 v26, 16, v161
    v_and_b32 v27, 0xffff0000, v161
    s_lshl_b32 s64, s24, 5
    v_add_u32 v8, s64, v9
    v_mov_b32 v10, -1
    v_cmp_eq_u32 vcc, s72, v8
    s_nop 1
    v_cndmask_b32 v10, v10, 0, vcc
    v_cmp_eq_u32 vcc, s73, v8
    s_nop 1
    v_cndmask_b32 v10, v10, 1, vcc
    v_cmp_eq_u32 vcc, s74, v8
    s_nop 1
    v_cndmask_b32 v10, v10, 2, vcc
    v_cmp_eq_u32 vcc, s75, v8
    s_nop 1
    v_cndmask_b32 v10, v10, 3, vcc
    v_cmp_eq_u32 vcc, s76, v8
    s_nop 1
    v_cndmask_b32 v10, v10, 4, vcc
    v_cmp_eq_u32 vcc, s77, v8
    s_nop 1
    v_cndmask_b32 v10, v10, 5, vcc
    v_cmp_eq_u32 vcc, s78, v8
    s_nop 1
    v_cndmask_b32 v10, v10, 6, vcc
    v_cmp_eq_u32 vcc, s79, v8
    s_nop 1
    v_cndmask_b32 v10, v10, 7, vcc
    v_cmp_le_i32 vcc, 0, v10
    s_and_saveexec_b64 s[68:69], vcc
    s_cbranch_execz NOUPD_179
    v_mul_u32_u24 v10, 2560, v10
    v_lshrrev_b32 v11, 4, v0
    v_lshl_add_u32 v10, v11, 4, v10
    s_lshl_b32 s64, s86, 6
    s_lshl_b32 s65, s13, 7
    s_add_u32 s64, s64, s65
    s_add_u32 s64, s64, 0x5410000
    buffer_load_dwordx4 v[164:167], v10, s[4:7], s64 offen sc1
    s_waitcnt vmcnt(0)
    v_add_f32 v20, v20, v164
    v_cvt_pk_bf16_f32 v20, v20, v20
    v_lshlrev_b32 v20, 16, v20
    v_add_f32 v21, v21, v165
    v_cvt_pk_bf16_f32 v21, v21, v21
    v_lshlrev_b32 v21, 16, v21
    v_add_f32 v22, v22, v166
    v_cvt_pk_bf16_f32 v22, v22, v22
    v_lshlrev_b32 v22, 16, v22
    v_add_f32 v23, v23, v167
    v_cvt_pk_bf16_f32 v23, v23, v23
    v_lshlrev_b32 v23, 16, v23
NOUPD_179:
    s_mov_b64 exec, -1
    v_mul_f32 v28, 0xbfb8aa3b, v20
    v_exp_f32 v28, v28
    s_nop 0
    v_add_f32 v28, 1.0, v28
    v_rcp_f32 v28, v28
    s_nop 0
    v_mul_f32 v28, v28, v20
    v_cvt_pk_bf16_f32 v28, v28, v28
    v_lshlrev_b32 v28, 16, v28
    v_mul_f32 v28, v28, v16
    v_cvt_pk_bf16_f32 v28, v28, v28
    v_lshlrev_b32 v28, 16, v28
    v_add_f32 v28, v28, v24
    v_mul_f32 v29, 0xbfb8aa3b, v21
    v_exp_f32 v29, v29
    s_nop 0
    v_add_f32 v29, 1.0, v29
    v_rcp_f32 v29, v29
    s_nop 0
    v_mul_f32 v29, v29, v21
    v_cvt_pk_bf16_f32 v29, v29, v29
    v_lshlrev_b32 v29, 16, v29
    v_mul_f32 v29, v29, v17
    v_cvt_pk_bf16_f32 v29, v29, v29
    v_lshlrev_b32 v29, 16, v29
    v_add_f32 v29, v29, v25
    v_mul_f32 v30, 0xbfb8aa3b, v22
    v_exp_f32 v30, v30
    s_nop 0
    v_add_f32 v30, 1.0, v30
    v_rcp_f32 v30, v30
    s_nop 0
    v_mul_f32 v30, v30, v22
    v_cvt_pk_bf16_f32 v30, v30, v30
    v_lshlrev_b32 v30, 16, v30
    v_mul_f32 v30, v30, v18
    v_cvt_pk_bf16_f32 v30, v30, v30
    v_lshlrev_b32 v30, 16, v30
    v_add_f32 v30, v30, v26
    v_mul_f32 v31, 0xbfb8aa3b, v23
    v_exp_f32 v31, v31
    s_nop 0
    v_add_f32 v31, 1.0, v31
    v_rcp_f32 v31, v31
    s_nop 0
    v_mul_f32 v31, v31, v23
    v_cvt_pk_bf16_f32 v31, v31, v31
    v_lshlrev_b32 v31, 16, v31
    v_mul_f32 v31, v31, v19
    v_cvt_pk_bf16_f32 v31, v31, v31
    v_lshlrev_b32 v31, 16, v31
    v_add_f32 v31, v31, v27
    v_cvt_pk_bf16_f32 v164, v28, v29
    v_cvt_pk_bf16_f32 v165, v30, v31
    buffer_store_dwordx2 v[164:165], v5, s[52:55], s67 offen
OTD_178:
    s_branch M_EXIT
H_Q:
    s_mov_b32 s29, 0
    v_lshlrev_b32 v1, 4, v0
    v_lshrrev_b32 v5, 4, v0
    v_lshlrev_b32 v2, 7, v5
    v_and_b32 v5, 7, v0
    v_lshl_add_u32 v2, v5, 4, v2
    v_bfe_u32 v5, v0, 4, 1
    v_lshlrev_b32 v3, 7, v5
    v_and_b32 v5, 15, v0
    v_lshl_add_u32 v3, v5, 3, v3
    s_mov_b32 s34, 0x3e0293ee
    s_mov_b32 s35, 0x3e0293ee
    s_mov_b32 s36, -1
    s_mov_b32 s37, 0
    v_lshrrev_b32 v5, 4, v0
    v_lshlrev_b32 v5, 2, v5
    v_and_b32 v6, 15, v0
    v_add_u32 v7, 0, v5
    v_cmp_le_u32 s[38:39], v7, v6
    v_add_u32 v7, 1, v5
    v_cmp_le_u32 s[40:41], v7, v6
    v_add_u32 v7, 2, v5
    v_cmp_le_u32 s[42:43], v7, v6
    v_add_u32 v7, 3, v5
    v_cmp_le_u32 s[44:45], v7, v6
    v_mov_b32 v248, 0x3f803f80
    v_mov_b32 v249, 0x3f803f80
    v_mov_b32 v250, 0x3f803f80
    v_mov_b32 v251, 0x3f803f80
    s_lshl_b32 s24, s12, 2
    s_add_u32 s24, s24, s14
    s_mov_b32 s25, 0
AT0_LOOP:
    s_cmp_eq_u32 s24, 63
    s_cbranch_scc1 AT0_END
    s_lshl_b32 s64, s24, 5
    s_add_u32 s64, s64, s13
    s_lshl_b32 s26, s64, 13
    s_add_u32 s26, s26, 0x3400000
    s_lshl_b32 s27, s64, 14
    s_add_u32 s27, s27, 0x1400000
    s_lshl_b32 s65, s64, 11
    s_add_u32 s30, s65, 0x640000
    s_add_u32 s31, s65, 0xa40000
    s_lshl_b32 s33, s64, 2
    s_add_u32 s33, s33, 0x296000
    s_lshl_b32 s32, s24, 18
    s_lshl_b32 s65, s13, 12
    s_add_u32 s32, s32, s65
    s_add_u32 s32, s32, 0x4400000
    s_lshr_b32 s65, s24, 2
    s_lshl_b32 s65, s65, 9
    s_lshl_b32 s66, s13, 4
    s_add_u32 s65, s65, s66
    s_add_u32 s65, s65, 0x291000
    s_lshr_b32 s66, s24, 1
    s_lshl_b32 s66, s66, 8
    s_lshl_b32 s64, s13, 3
    s_add_u32 s66, s66, s64
    s_add_u32 s66, s66, 0x293ff4
    v_lshlrev_b32 v5, 2, v0
    v_mov_b32 v6, s65
    v_mov_b32 v7, s66
    v_cmp_gt_u32 vcc, 3, v0
    s_nop 1
    v_cndmask_b32 v6, v7, v6, vcc
    v_add_u32 v4, v5, v6
    s_mov_b32 s64, 0
    s_mov_b64 exec, 7
AT0_F_180:
    buffer_load_dword v5, v4, s[4:7], s64 offen sc1
    s_add_u32 s29, s29, 1
    s_waitcnt vmcnt(0)
    v_cmp_eq_u32 vcc, 0, v5
    s_cbranch_vccz AT0_FD_181
    s_cmp_gt_u32 s29, 262144
    s_cbranch_scc1 AT0_FD_181
    s_sleep 1
    s_branch AT0_F_180
AT0_FD_181:
    s_mov_b64 exec, -1
    buffer_load_dwordx4 v[16:19], v1, s[4:7], s26 offen offset:0
    buffer_load_dwordx4 v[20:23], v1, s[4:7], s26 offen offset:1024
    buffer_load_dwordx4 v[24:27], v1, s[4:7], s26 offen offset:2048
    buffer_load_dwordx4 v[28:31], v1, s[4:7], s26 offen offset:3072
    s_add_u32 s26, s26, 4096
    buffer_load_dwordx4 v[32:35], v1, s[4:7], s26 offen offset:0
    buffer_load_dwordx4 v[36:39], v1, s[4:7], s26 offen offset:1024
    buffer_load_dwordx4 v[40:43], v1, s[4:7], s26 offen offset:2048
    buffer_load_dwordx4 v[44:47], v1, s[4:7], s26 offen offset:3072
    buffer_load_dwordx4 v[48:51], v1, s[4:7], s27 offen offset:0
    buffer_load_dwordx4 v[52:55], v1, s[4:7], s27 offen offset:1024
    buffer_load_dwordx4 v[56:59], v1, s[4:7], s27 offen offset:2048
    buffer_load_dwordx4 v[60:63], v1, s[4:7], s27 offen offset:3072
    s_add_u32 s27, s27, 4096
    buffer_load_dwordx4 v[64:67], v1, s[4:7], s27 offen offset:0
    buffer_load_dwordx4 v[68:71], v1, s[4:7], s27 offen offset:1024
    buffer_load_dwordx4 v[72:75], v1, s[4:7], s27 offen offset:2048
    buffer_load_dwordx4 v[76:79], v1, s[4:7], s27 offen offset:3072
    s_add_u32 s27, s27, 4096
    buffer_load_dwordx4 v[80:83], v1, s[4:7], s27 offen offset:0
    buffer_load_dwordx4 v[84:87], v1, s[4:7], s27 offen offset:1024
    buffer_load_dwordx4 v[88:91], v1, s[4:7], s27 offen offset:2048
    buffer_load_dwordx4 v[92:95], v1, s[4:7], s27 offen offset:3072
    s_add_u32 s27, s27, 4096
    buffer_load_dwordx4 v[96:99], v1, s[4:7], s27 offen offset:0
    buffer_load_dwordx4 v[100:103], v1, s[4:7], s27 offen offset:1024
    buffer_load_dwordx4 v[104:107], v1, s[4:7], s27 offen offset:2048
    buffer_load_dwordx4 v[108:111], v1, s[4:7], s27 offen offset:3072
    s_mov_b64 exec, 0x18
AT0_G_182:
    buffer_load_dword v5, v4, s[4:7], s64 offen sc1
    s_add_u32 s29, s29, 1
    s_waitcnt vmcnt(0)
    v_cmp_eq_u32 vcc, 0, v5
    s_cbranch_vccz AT0_GD_183
    s_cmp_gt_u32 s29, 262144
    s_cbranch_scc1 AT0_GD_183
    s_sleep 1
    s_branch AT0_G_182
AT0_GD_183:
    s_mov_b64 exec, -1
    buffer_load_dwordx4 v[112:115], v2, s[4:7], s30 offen offset:0
    buffer_load_dwordx4 v[116:119], v2, s[4:7], s30 offen offset:512
    buffer_load_dwordx4 v[120:123], v2, s[4:7], s30 offen offset:1024
    buffer_load_dwordx4 v[124:127], v2, s[4:7], s30 offen offset:1536
    buffer_load_dwordx2 v[128:129], v3, s[4:7], s31 offen offset:0
    buffer_load_dwordx2 v[130:131], v3, s[4:7], s31 offen offset:256
    buffer_load_dwordx2 v[132:133], v3, s[4:7], s31 offen offset:512
    buffer_load_dwordx2 v[134:135], v3, s[4:7], s31 offen offset:768
    buffer_load_dwordx2 v[136:137], v3, s[4:7], s31 offen offset:1024
    buffer_load_dwordx2 v[138:139], v3, s[4:7], s31 offen offset:1280
    buffer_load_dwordx2 v[140:141], v3, s[4:7], s31 offen offset:1536
    buffer_load_dwordx2 v[142:143], v3, s[4:7], s31 offen offset:1792
    v_mfma_f32_16x16x32_bf16 v[148:151], v[48:51], v[16:19], 0
    v_mfma_f32_16x16x32_bf16 v[156:159], v[48:51], v[32:35], 0
    v_mfma_f32_16x16x32_bf16 v[160:163], v[64:67], v[32:35], 0
    v_mfma_f32_16x16x32_bf16 v[148:151], v[52:55], v[20:23], v[148:151]
    v_mfma_f32_16x16x32_bf16 v[156:159], v[52:55], v[36:39], v[156:159]
    v_mfma_f32_16x16x32_bf16 v[160:163], v[68:71], v[36:39], v[160:163]
    v_mfma_f32_16x16x32_bf16 v[148:151], v[56:59], v[24:27], v[148:151]
    v_mfma_f32_16x16x32_bf16 v[156:159], v[56:59], v[40:43], v[156:159]
    v_mfma_f32_16x16x32_bf16 v[160:163], v[72:75], v[40:43], v[160:163]
    v_mfma_f32_16x16x32_bf16 v[148:151], v[60:63], v[28:31], v[148:151]
    v_mfma_f32_16x16x32_bf16 v[156:159], v[60:63], v[44:47], v[156:159]
    v_mfma_f32_16x16x32_bf16 v[160:163], v[76:79], v[44:47], v[160:163]
    s_waitcnt vmcnt(8)
    v_mfma_f32_16x16x32_bf16 v[144:147], v[112:115], v[16:19], 0
    v_mfma_f32_16x16x32_bf16 v[152:155], v[112:115], v[32:35], 0
    v_mfma_f32_16x16x32_bf16 v[144:147], v[116:119], v[20:23], v[144:147]
    v_mfma_f32_16x16x32_bf16 v[152:155], v[116:119], v[36:39], v[152:155]
    v_mfma_f32_16x16x32_bf16 v[144:147], v[120:123], v[24:27], v[144:147]
    v_mfma_f32_16x16x32_bf16 v[152:155], v[120:123], v[40:43], v[152:155]
    v_mfma_f32_16x16x32_bf16 v[144:147], v[124:127], v[28:31], v[144:147]
    v_mfma_f32_16x16x32_bf16 v[152:155], v[124:127], v[44:47], v[152:155]
    v_mov_b32 v11, 0xff800000
    s_nop 7
    v_cndmask_b32 v148, v11, v148, s[38:39]
    v_cndmask_b32 v160, v11, v160, s[38:39]
    v_cndmask_b32 v144, v11, v144, s[36:37]
    v_cndmask_b32 v152, v11, v152, s[36:37]
    v_cndmask_b32 v149, v11, v149, s[40:41]
    v_cndmask_b32 v161, v11, v161, s[40:41]
    v_cndmask_b32 v145, v11, v145, s[36:37]
    v_cndmask_b32 v153, v11, v153, s[36:37]
    v_cndmask_b32 v150, v11, v150, s[42:43]
    v_cndmask_b32 v162, v11, v162, s[42:43]
    v_cndmask_b32 v146, v11, v146, s[36:37]
    v_cndmask_b32 v154, v11, v154, s[36:37]
    v_cndmask_b32 v151, v11, v151, s[44:45]
    v_cndmask_b32 v163, v11, v163, s[44:45]
    v_cndmask_b32 v147, v11, v147, s[36:37]
    v_cndmask_b32 v155, v11, v155, s[36:37]
    v_max3_f32 v8, v144, v145, v146
    v_max3_f32 v8, v8, v147, v148
    v_max3_f32 v8, v8, v149, v150
    v_max_f32 v8, v8, v151
    v_mov_b32 v9, v8
    s_nop 1
    v_permlane16_swap_b32 v8, v9
    v_max_f32 v8, v8, v9
    v_mov_b32 v9, v8
    s_nop 1
    v_permlane32_swap_b32 v8, v9
    v_max_f32 v8, v8, v9
    v_mul_f32 v8, s34, v8
    v_fma_f32 v144, v144, s34, -v8
    v_fma_f32 v145, v145, s34, -v8
    v_fma_f32 v146, v146, s34, -v8
    v_fma_f32 v147, v147, s34, -v8
    v_fma_f32 v148, v148, s34, -v8
    v_fma_f32 v149, v149, s34, -v8
    v_fma_f32 v150, v150, s34, -v8
    v_fma_f32 v151, v151, s34, -v8
    v_exp_f32 v144, v144
    v_exp_f32 v145, v145
    v_exp_f32 v146, v146
    v_exp_f32 v147, v147
    v_exp_f32 v148, v148
    v_exp_f32 v149, v149
    v_exp_f32 v150, v150
    v_exp_f32 v151, v151
    s_nop 0
    v_cvt_pk_bf16_f32 v164, v148, v149
    v_cvt_pk_bf16_f32 v165, v150, v151
    v_mov_b32 v166, 0
    v_mov_b32 v167, 0
    v_cvt_pk_bf16_f32 v168, v144, v145
    v_cvt_pk_bf16_f32 v169, v146, v147
    v_max3_f32 v8, v152, v153, v154
    v_max3_f32 v8, v8, v155, v156
    v_max3_f32 v8, v8, v157, v158
    v_max3_f32 v8, v8, v159, v160
    v_max3_f32 v8, v8, v161, v162
    v_max_f32 v8, v8, v163
    v_mov_b32 v9, v8
    s_nop 1
    v_permlane16_swap_b32 v8, v9
    v_max_f32 v8, v8, v9
    v_mov_b32 v9, v8
    s_nop 1
    v_permlane32_swap_b32 v8, v9
    v_max_f32 v8, v8, v9
    v_mul_f32 v8, s34, v8
    v_fma_f32 v152, v152, s34, -v8
    v_fma_f32 v153, v153, s34, -v8
    v_fma_f32 v154, v154, s34, -v8
    v_fma_f32 v155, v155, s34, -v8
    v_fma_f32 v156, v156, s34, -v8
    v_fma_f32 v157, v157, s34, -v8
    v_fma_f32 v158, v158, s34, -v8
    v_fma_f32 v159, v159, s34, -v8
    v_fma_f32 v160, v160, s34, -v8
    v_fma_f32 v161, v161, s34, -v8
    v_fma_f32 v162, v162, s34, -v8
    v_fma_f32 v163, v163, s34, -v8
    v_exp_f32 v152, v152
    v_exp_f32 v153, v153
    v_exp_f32 v154, v154
    v_exp_f32 v155, v155
    v_exp_f32 v156, v156
    v_exp_f32 v157, v157
    v_exp_f32 v158, v158
    v_exp_f32 v159, v159
    v_exp_f32 v160, v160
    v_exp_f32 v161, v161
    v_exp_f32 v162, v162
    v_exp_f32 v163, v163
    s_nop 0
    v_cvt_pk_bf16_f32 v170, v156, v157
    v_cvt_pk_bf16_f32 v171, v158, v159
    v_cvt_pk_bf16_f32 v172, v160, v161
    v_cvt_pk_bf16_f32 v173, v162, v163
    v_cvt_pk_bf16_f32 v174, v152, v153
    v_cvt_pk_bf16_f32 v175, v154, v155
    s_waitcnt vmcnt(0)
    v_mfma_f32_16x16x32_bf16 v[240:243], v[248:251], v[164:167], 0
    v_mfma_f32_16x16x32_bf16 v[244:247], v[248:251], v[170:173], 0
    v_mfma_f32_16x16x32_bf16 v[176:179], v[80:83], v[164:167], 0
    v_mfma_f32_16x16x32_bf16 v[180:183], v[80:83], v[170:173], 0
    v_mfma_f32_16x16x32_bf16 v[184:187], v[84:87], v[164:167], 0
    v_mfma_f32_16x16x32_bf16 v[188:191], v[84:87], v[170:173], 0
    v_mfma_f32_16x16x32_bf16 v[192:195], v[88:91], v[164:167], 0
    v_mfma_f32_16x16x32_bf16 v[196:199], v[88:91], v[170:173], 0
    v_mfma_f32_16x16x32_bf16 v[200:203], v[92:95], v[164:167], 0
    v_mfma_f32_16x16x32_bf16 v[204:207], v[92:95], v[170:173], 0
    v_mfma_f32_16x16x32_bf16 v[208:211], v[96:99], v[164:167], 0
    v_mfma_f32_16x16x32_bf16 v[212:215], v[96:99], v[170:173], 0
    v_mfma_f32_16x16x32_bf16 v[216:219], v[100:103], v[164:167], 0
    v_mfma_f32_16x16x32_bf16 v[220:223], v[100:103], v[170:173], 0
    v_mfma_f32_16x16x32_bf16 v[224:227], v[104:107], v[164:167], 0
    v_mfma_f32_16x16x32_bf16 v[228:231], v[104:107], v[170:173], 0
    v_mfma_f32_16x16x32_bf16 v[232:235], v[108:111], v[164:167], 0
    v_mfma_f32_16x16x32_bf16 v[236:239], v[108:111], v[170:173], 0
    v_mfma_f32_16x16x16_bf16 v[240:243], v[248:249], v[168:169], v[240:243]
    v_mfma_f32_16x16x16_bf16 v[244:247], v[248:249], v[174:175], v[244:247]
    v_mfma_f32_16x16x16_bf16 v[176:179], v[128:129], v[168:169], v[176:179]
    v_mfma_f32_16x16x16_bf16 v[180:183], v[128:129], v[174:175], v[180:183]
    v_mfma_f32_16x16x16_bf16 v[184:187], v[130:131], v[168:169], v[184:187]
    v_mfma_f32_16x16x16_bf16 v[188:191], v[130:131], v[174:175], v[188:191]
    v_mfma_f32_16x16x16_bf16 v[192:195], v[132:133], v[168:169], v[192:195]
    v_mfma_f32_16x16x16_bf16 v[196:199], v[132:133], v[174:175], v[196:199]
    v_mfma_f32_16x16x16_bf16 v[200:203], v[134:135], v[168:169], v[200:203]
    v_mfma_f32_16x16x16_bf16 v[204:207], v[134:135], v[174:175], v[204:207]
    v_mfma_f32_16x16x16_bf16 v[208:211], v[136:137], v[168:169], v[208:211]
    v_mfma_f32_16x16x16_bf16 v[212:215], v[136:137], v[174:175], v[212:215]
    v_mfma_f32_16x16x16_bf16 v[216:219], v[138:139], v[168:169], v[216:219]
    v_mfma_f32_16x16x16_bf16 v[220:223], v[138:139], v[174:175], v[220:223]
    v_mfma_f32_16x16x16_bf16 v[224:227], v[140:141], v[168:169], v[224:227]
    v_mfma_f32_16x16x16_bf16 v[228:231], v[140:141], v[174:175], v[228:231]
    v_mfma_f32_16x16x16_bf16 v[232:235], v[142:143], v[168:169], v[232:235]
    v_mfma_f32_16x16x16_bf16 v[236:239], v[142:143], v[174:175], v[236:239]
    v_rcp_f32 v8, v240
    v_rcp_f32 v9, v244
    s_nop 7
    v_mul_f32 v176, v176, v8
    v_mul_f32 v177, v177, v8
    v_mul_f32 v178, v178, v8
    v_mul_f32 v179, v179, v8
    v_cvt_pk_bf16_f32 v16, v176, v177
    v_cvt_pk_bf16_f32 v17, v178, v179
    v_mul_f32 v184, v184, v8
    v_mul_f32 v185, v185, v8
    v_mul_f32 v186, v186, v8
    v_mul_f32 v187, v187, v8
    v_cvt_pk_bf16_f32 v18, v184, v185
    v_cvt_pk_bf16_f32 v19, v186, v187
    s_add_u32 s64, s32, 0x0
    buffer_store_dwordx4 v[16:19], v1, s[4:7], s64 offen offset:0 sc1
    v_mul_f32 v192, v192, v8
    v_mul_f32 v193, v193, v8
    v_mul_f32 v194, v194, v8
    v_mul_f32 v195, v195, v8
    v_cvt_pk_bf16_f32 v20, v192, v193
    v_cvt_pk_bf16_f32 v21, v194, v195
    v_mul_f32 v200, v200, v8
    v_mul_f32 v201, v201, v8
    v_mul_f32 v202, v202, v8
    v_mul_f32 v203, v203, v8
    v_cvt_pk_bf16_f32 v22, v200, v201
    v_cvt_pk_bf16_f32 v23, v202, v203
    s_add_u32 s64, s32, 0x0
    buffer_store_dwordx4 v[20:23], v1, s[4:7], s64 offen offset:1024 sc1
    v_mul_f32 v208, v208, v8
    v_mul_f32 v209, v209, v8
    v_mul_f32 v210, v210, v8
    v_mul_f32 v211, v211, v8
    v_cvt_pk_bf16_f32 v24, v208, v209
    v_cvt_pk_bf16_f32 v25, v210, v211
    v_mul_f32 v216, v216, v8
    v_mul_f32 v217, v217, v8
    v_mul_f32 v218, v218, v8
    v_mul_f32 v219, v219, v8
    v_cvt_pk_bf16_f32 v26, v216, v217
    v_cvt_pk_bf16_f32 v27, v218, v219
    s_add_u32 s64, s32, 0x0
    buffer_store_dwordx4 v[24:27], v1, s[4:7], s64 offen offset:2048 sc1
    v_mul_f32 v224, v224, v8
    v_mul_f32 v225, v225, v8
    v_mul_f32 v226, v226, v8
    v_mul_f32 v227, v227, v8
    v_cvt_pk_bf16_f32 v28, v224, v225
    v_cvt_pk_bf16_f32 v29, v226, v227
    v_mul_f32 v232, v232, v8
    v_mul_f32 v233, v233, v8
    v_mul_f32 v234, v234, v8
    v_mul_f32 v235, v235, v8
    v_cvt_pk_bf16_f32 v30, v232, v233
    v_cvt_pk_bf16_f32 v31, v234, v235
    s_add_u32 s64, s32, 0x0
    buffer_store_dwordx4 v[28:31], v1, s[4:7], s64 offen offset:3072 sc1
    v_mul_f32 v180, v180, v9
    v_mul_f32 v181, v181, v9
    v_mul_f32 v182, v182, v9
    v_mul_f32 v183, v183, v9
    v_cvt_pk_bf16_f32 v32, v180, v181
    v_cvt_pk_bf16_f32 v33, v182, v183
    v_mul_f32 v188, v188, v9
    v_mul_f32 v189, v189, v9
    v_mul_f32 v190, v190, v9
    v_mul_f32 v191, v191, v9
    v_cvt_pk_bf16_f32 v34, v188, v189
    v_cvt_pk_bf16_f32 v35, v190, v191
    s_add_u32 s64, s32, 0x20000
    buffer_store_dwordx4 v[32:35], v1, s[4:7], s64 offen offset:0 sc1
    v_mul_f32 v196, v196, v9
    v_mul_f32 v197, v197, v9
    v_mul_f32 v198, v198, v9
    v_mul_f32 v199, v199, v9
    v_cvt_pk_bf16_f32 v36, v196, v197
    v_cvt_pk_bf16_f32 v37, v198, v199
    v_mul_f32 v204, v204, v9
    v_mul_f32 v205, v205, v9
    v_mul_f32 v206, v206, v9
    v_mul_f32 v207, v207, v9
    v_cvt_pk_bf16_f32 v38, v204, v205
    v_cvt_pk_bf16_f32 v39, v206, v207
    s_add_u32 s64, s32, 0x20000
    buffer_store_dwordx4 v[36:39], v1, s[4:7], s64 offen offset:1024 sc1
    v_mul_f32 v212, v212, v9
    v_mul_f32 v213, v213, v9
    v_mul_f32 v214, v214, v9
    v_mul_f32 v215, v215, v9
    v_cvt_pk_bf16_f32 v40, v212, v213
    v_cvt_pk_bf16_f32 v41, v214, v215
    v_mul_f32 v220, v220, v9
    v_mul_f32 v221, v221, v9
    v_mul_f32 v222, v222, v9
    v_mul_f32 v223, v223, v9
    v_cvt_pk_bf16_f32 v42, v220, v221
    v_cvt_pk_bf16_f32 v43, v222, v223
    s_add_u32 s64, s32, 0x20000
    buffer_store_dwordx4 v[40:43], v1, s[4:7], s64 offen offset:2048 sc1
    v_mul_f32 v228, v228, v9
    v_mul_f32 v229, v229, v9
    v_mul_f32 v230, v230, v9
    v_mul_f32 v231, v231, v9
    v_cvt_pk_bf16_f32 v44, v228, v229
    v_cvt_pk_bf16_f32 v45, v230, v231
    v_mul_f32 v236, v236, v9
    v_mul_f32 v237, v237, v9
    v_mul_f32 v238, v238, v9
    v_mul_f32 v239, v239, v9
    v_cvt_pk_bf16_f32 v46, v236, v237
    v_cvt_pk_bf16_f32 v47, v238, v239
    s_add_u32 s64, s32, 0x20000
    buffer_store_dwordx4 v[44:47], v1, s[4:7], s64 offen offset:3072 sc1
    s_waitcnt vmcnt(0)
    v_mov_b32 v7, 1
    v_mov_b32 v8, 0
    s_mov_b64 exec, 1
    buffer_store_dword v7, v8, s[4:7], s33 offen sc1
    s_mov_b64 exec, -1
    s_add_u32 s24, s24, 8
    s_add_u32 s25, s25, 1
    s_cmp_lt_u32 s25, 1
    s_cbranch_scc1 AT0_LOOP
AT0_END:
    s_lshl_b32 s70, s13, 1
    s_add_u32 s70, s70, s12
    s_load_dwordx2 s[44:45], s[0:1], 72
    s_mov_b32 s46, 0x21c000
    s_mov_b32 s47, 0x00020000
    s_load_dwordx2 s[48:49], s[0:1], 80
    s_mov_b32 s50, 0x21c000
    s_mov_b32 s51, 0x00020000
    s_load_dwordx2 s[52:53], s[0:1], 88
    s_mov_b32 s54, 0x21c000
    s_mov_b32 s55, 0x00020000
    s_mov_b32 s29, 0
    s_waitcnt lgkmcnt(0)
    v_mbcnt_lo_u32_b32 v0, -1, 0
    v_mbcnt_hi_u32_b32 v0, -1, v0
    s_lshl_b32 s24, s70, 2
    s_add_u32 s24, s24, s14
    s_cmp_ge_u32 s24, 108
    s_cbranch_scc1 H_A1
    v_mov_b32 v8, 0
    s_mov_b32 s64, 0x298000
F1W_184:
    buffer_load_dword v7, v8, s[4:7], s64 offen sc1
    s_add_u32 s29, s29, 1
    s_waitcnt vmcnt(0)
    v_cmp_gt_u32 vcc, 1, v7
    s_cbranch_vccz F1WD_185
    s_cmp_gt_u32 s29, 262144
    s_cbranch_scc1 F1WD_185
    s_sleep 8
    s_branch F1W_184
F1WD_185:
    s_mul_i32 s25, s14, 40960
    v_lshrrev_b32 v7, 1, v0
    v_mul_u32_u24 v2, 3456, v7
    v_and_b32 v7, 1, v0
    v_lshl_add_u32 v2, v7, 4, v2
    v_lshrrev_b32 v7, 4, v0
    v_lshlrev_b32 v3, 8, v7
    v_bfe_u32 v7, v0, 2, 2
    v_lshl_add_u32 v3, v7, 5, v3
    v_and_b32 v7, 3, v0
    v_lshl_add_u32 v3, v7, 3, v3
    v_add_u32 v3, s25, v3
    v_and_b32 v7, 7, v0
    v_lshlrev_b32 v7, 2, v7
    s_mov_b32 s64, 0x5400000
    buffer_load_dword v4, v7, s[4:7], s64 offen sc1
    s_waitcnt vmcnt(0)
    v_mul_u32_u24 v4, 1280, v4
    v_lshrrev_b32 v7, 4, v0
    v_lshl_add_u32 v4, v7, 4, v4
    s_mov_b32 s65, 0x0
    buffer_load_dwordx4 v[16:19], v4, s[4:7], s65 offen offset:0 sc1
    buffer_load_dwordx4 v[20:23], v4, s[4:7], s65 offen offset:64 sc1
    buffer_load_dwordx4 v[24:27], v4, s[4:7], s65 offen offset:128 sc1
    buffer_load_dwordx4 v[28:31], v4, s[4:7], s65 offen offset:192 sc1
    buffer_load_dwordx4 v[32:35], v4, s[4:7], s65 offen offset:256 sc1
    buffer_load_dwordx4 v[36:39], v4, s[4:7], s65 offen offset:320 sc1
    buffer_load_dwordx4 v[40:43], v4, s[4:7], s65 offen offset:384 sc1
    buffer_load_dwordx4 v[44:47], v4, s[4:7], s65 offen offset:448 sc1
    buffer_load_dwordx4 v[48:51], v4, s[4:7], s65 offen offset:512 sc1
    buffer_load_dwordx4 v[52:55], v4, s[4:7], s65 offen offset:576 sc1
    buffer_load_dwordx4 v[56:59], v4, s[4:7], s65 offen offset:640 sc1
    buffer_load_dwordx4 v[60:63], v4, s[4:7], s65 offen offset:704 sc1
    buffer_load_dwordx4 v[64:67], v4, s[4:7], s65 offen offset:768 sc1
    buffer_load_dwordx4 v[68:71], v4, s[4:7], s65 offen offset:832 sc1
    buffer_load_dwordx4 v[72:75], v4, s[4:7], s65 offen offset:896 sc1
    buffer_load_dwordx4 v[76:79], v4, s[4:7], s65 offen offset:960 sc1
    buffer_load_dwordx4 v[80:83], v4, s[4:7], s65 offen offset:1024 sc1
    buffer_load_dwordx4 v[84:87], v4, s[4:7], s65 offen offset:1088 sc1
    buffer_load_dwordx4 v[88:91], v4, s[4:7], s65 offen offset:1152 sc1
    buffer_load_dwordx4 v[92:95], v4, s[4:7], s65 offen offset:1216 sc1
    s_lshl_b32 s26, s24, 5
    s_add_u32 m0, s25, 0
    s_add_u32 s64, s26, 0x0
    buffer_load_dwordx4 v2, s[44:47], s64 offen lds
    s_add_u32 m0, s25, 1024
    s_add_u32 s64, s26, 0x1b000
    buffer_load_dwordx4 v2, s[44:47], s64 offen lds
    s_add_u32 m0, s25, 2048
    s_add_u32 s64, s26, 0x36000
    buffer_load_dwordx4 v2, s[44:47], s64 offen lds
    s_add_u32 m0, s25, 3072
    s_add_u32 s64, s26, 0x51000
    buffer_load_dwordx4 v2, s[44:47], s64 offen lds
    s_add_u32 m0, s25, 4096
    s_add_u32 s64, s26, 0x6c000
    buffer_load_dwordx4 v2, s[44:47], s64 offen lds
    s_add_u32 m0, s25, 5120
    s_add_u32 s64, s26, 0x87000
    buffer_load_dwordx4 v2, s[44:47], s64 offen lds
    s_add_u32 m0, s25, 6144
    s_add_u32 s64, s26, 0xa2000
    buffer_load_dwordx4 v2, s[44:47], s64 offen lds
    s_add_u32 m0, s25, 7168
    s_add_u32 s64, s26, 0xbd000
    buffer_load_dwordx4 v2, s[44:47], s64 offen lds
    s_add_u32 m0, s25, 8192
    s_add_u32 s64, s26, 0xd8000
    buffer_load_dwordx4 v2, s[44:47], s64 offen lds
    s_add_u32 m0, s25, 9216
    s_add_u32 s64, s26, 0xf3000
    buffer_load_dwordx4 v2, s[44:47], s64 offen lds
    s_add_u32 m0, s25, 10240
    s_add_u32 s64, s26, 0x10e000
    buffer_load_dwordx4 v2, s[44:47], s64 offen lds
    s_add_u32 m0, s25, 11264
    s_add_u32 s64, s26, 0x129000
    buffer_load_dwordx4 v2, s[44:47], s64 offen lds
    s_add_u32 m0, s25, 12288
    s_add_u32 s64, s26, 0x144000
    buffer_load_dwordx4 v2, s[44:47], s64 offen lds
    s_add_u32 m0, s25, 13312
    s_add_u32 s64, s26, 0x15f000
    buffer_load_dwordx4 v2, s[44:47], s64 offen lds
    s_add_u32 m0, s25, 14336
    s_add_u32 s64, s26, 0x17a000
    buffer_load_dwordx4 v2, s[44:47], s64 offen lds
    s_add_u32 m0, s25, 15360
    s_add_u32 s64, s26, 0x195000
    buffer_load_dwordx4 v2, s[44:47], s64 offen lds
    s_add_u32 m0, s25, 16384
    s_add_u32 s64, s26, 0x1b0000
    buffer_load_dwordx4 v2, s[44:47], s64 offen lds
    s_add_u32 m0, s25, 17408
    s_add_u32 s64, s26, 0x1cb000
    buffer_load_dwordx4 v2, s[44:47], s64 offen lds
    s_add_u32 m0, s25, 18432
    s_add_u32 s64, s26, 0x1e6000
    buffer_load_dwordx4 v2, s[44:47], s64 offen lds
    s_add_u32 m0, s25, 19456
    s_add_u32 s64, s26, 0x201000
    buffer_load_dwordx4 v2, s[44:47], s64 offen lds
    s_waitcnt vmcnt(0)
    ds_read_b64_tr_b16 v[96:97], v3 offset:0
    ds_read_b64_tr_b16 v[98:99], v3 offset:128
    ds_read_b64_tr_b16 v[100:101], v3 offset:1024
    ds_read_b64_tr_b16 v[102:103], v3 offset:1152
    ds_read_b64_tr_b16 v[104:105], v3 offset:2048
    ds_read_b64_tr_b16 v[106:107], v3 offset:2176
    ds_read_b64_tr_b16 v[108:109], v3 offset:3072
    ds_read_b64_tr_b16 v[110:111], v3 offset:3200
    ds_read_b64_tr_b16 v[112:113], v3 offset:4096
    ds_read_b64_tr_b16 v[114:115], v3 offset:4224
    ds_read_b64_tr_b16 v[116:117], v3 offset:5120
    ds_read_b64_tr_b16 v[118:119], v3 offset:5248
    s_waitcnt lgkmcnt(4)
    ds_read_b64_tr_b16 v[120:121], v3 offset:6144
    ds_read_b64_tr_b16 v[122:123], v3 offset:6272
    ds_read_b64_tr_b16 v[124:125], v3 offset:7168
    ds_read_b64_tr_b16 v[126:127], v3 offset:7296
    ds_read_b64_tr_b16 v[128:129], v3 offset:8192
    ds_read_b64_tr_b16 v[130:131], v3 offset:8320
    ds_read_b64_tr_b16 v[132:133], v3 offset:9216
    ds_read_b64_tr_b16 v[134:135], v3 offset:9344
    ds_read_b64_tr_b16 v[136:137], v3 offset:10240
    ds_read_b64_tr_b16 v[138:139], v3 offset:10368
    ds_read_b64_tr_b16 v[140:141], v3 offset:11264
    ds_read_b64_tr_b16 v[142:143], v3 offset:11392
    s_waitcnt lgkmcnt(4)
    ds_read_b64_tr_b16 v[144:145], v3 offset:12288
    ds_read_b64_tr_b16 v[146:147], v3 offset:12416
    ds_read_b64_tr_b16 v[148:149], v3 offset:13312
    ds_read_b64_tr_b16 v[150:151], v3 offset:13440
    ds_read_b64_tr_b16 v[152:153], v3 offset:14336
    ds_read_b64_tr_b16 v[154:155], v3 offset:14464
    ds_read_b64_tr_b16 v[156:157], v3 offset:15360
    ds_read_b64_tr_b16 v[158:159], v3 offset:15488
    ds_read_b64_tr_b16 v[160:161], v3 offset:16384
    ds_read_b64_tr_b16 v[162:163], v3 offset:16512
    ds_read_b64_tr_b16 v[164:165], v3 offset:17408
    ds_read_b64_tr_b16 v[166:167], v3 offset:17536
    s_waitcnt lgkmcnt(4)
    ds_read_b64_tr_b16 v[168:169], v3 offset:18432
    ds_read_b64_tr_b16 v[170:171], v3 offset:18560
    ds_read_b64_tr_b16 v[172:173], v3 offset:19456
    ds_read_b64_tr_b16 v[174:175], v3 offset:19584
    s_waitcnt lgkmcnt(0)
    s_add_u32 s25, s25, 20480
    v_add_u32 v3, 20480, v3
    s_add_u32 m0, s25, 0
    s_add_u32 s64, s26, 0x0
    buffer_load_dwordx4 v2, s[48:51], s64 offen lds
    s_add_u32 m0, s25, 1024
    s_add_u32 s64, s26, 0x1b000
    buffer_load_dwordx4 v2, s[48:51], s64 offen lds
    s_add_u32 m0, s25, 2048
    s_add_u32 s64, s26, 0x36000
    buffer_load_dwordx4 v2, s[48:51], s64 offen lds
    s_add_u32 m0, s25, 3072
    s_add_u32 s64, s26, 0x51000
    buffer_load_dwordx4 v2, s[48:51], s64 offen lds
    s_add_u32 m0, s25, 4096
    s_add_u32 s64, s26, 0x6c000
    buffer_load_dwordx4 v2, s[48:51], s64 offen lds
    s_add_u32 m0, s25, 5120
    s_add_u32 s64, s26, 0x87000
    buffer_load_dwordx4 v2, s[48:51], s64 offen lds
    s_add_u32 m0, s25, 6144
    s_add_u32 s64, s26, 0xa2000
    buffer_load_dwordx4 v2, s[48:51], s64 offen lds
    s_add_u32 m0, s25, 7168
    s_add_u32 s64, s26, 0xbd000
    buffer_load_dwordx4 v2, s[48:51], s64 offen lds
    s_add_u32 m0, s25, 8192
    s_add_u32 s64, s26, 0xd8000
    buffer_load_dwordx4 v2, s[48:51], s64 offen lds
    s_add_u32 m0, s25, 9216
    s_add_u32 s64, s26, 0xf3000
    buffer_load_dwordx4 v2, s[48:51], s64 offen lds
    s_add_u32 m0, s25, 10240
    s_add_u32 s64, s26, 0x10e000
    buffer_load_dwordx4 v2, s[48:51], s64 offen lds
    s_add_u32 m0, s25, 11264
    s_add_u32 s64, s26, 0x129000
    buffer_load_dwordx4 v2, s[48:51], s64 offen lds
    s_add_u32 m0, s25, 12288
    s_add_u32 s64, s26, 0x144000
    buffer_load_dwordx4 v2, s[48:51], s64 offen lds
    s_add_u32 m0, s25, 13312
    s_add_u32 s64, s26, 0x15f000
    buffer_load_dwordx4 v2, s[48:51], s64 offen lds
    s_add_u32 m0, s25, 14336
    s_add_u32 s64, s26, 0x17a000
    buffer_load_dwordx4 v2, s[48:51], s64 offen lds
    s_add_u32 m0, s25, 15360
    s_add_u32 s64, s26, 0x195000
    buffer_load_dwordx4 v2, s[48:51], s64 offen lds
    s_add_u32 m0, s25, 16384
    s_add_u32 s64, s26, 0x1b0000
    buffer_load_dwordx4 v2, s[48:51], s64 offen lds
    s_add_u32 m0, s25, 17408
    s_add_u32 s64, s26, 0x1cb000
    buffer_load_dwordx4 v2, s[48:51], s64 offen lds
    s_add_u32 m0, s25, 18432
    s_add_u32 s64, s26, 0x1e6000
    buffer_load_dwordx4 v2, s[48:51], s64 offen lds
    s_add_u32 m0, s25, 19456
    s_add_u32 s64, s26, 0x201000
    buffer_load_dwordx4 v2, s[48:51], s64 offen lds
    s_waitcnt vmcnt(0)
    ds_read_b64_tr_b16 v[176:177], v3 offset:0
    ds_read_b64_tr_b16 v[178:179], v3 offset:128
    ds_read_b64_tr_b16 v[180:181], v3 offset:1024
    ds_read_b64_tr_b16 v[182:183], v3 offset:1152
    ds_read_b64_tr_b16 v[184:185], v3 offset:2048
    ds_read_b64_tr_b16 v[186:187], v3 offset:2176
    ds_read_b64_tr_b16 v[188:189], v3 offset:3072
    ds_read_b64_tr_b16 v[190:191], v3 offset:3200
    ds_read_b64_tr_b16 v[192:193], v3 offset:4096
    ds_read_b64_tr_b16 v[194:195], v3 offset:4224
    ds_read_b64_tr_b16 v[196:197], v3 offset:5120
    ds_read_b64_tr_b16 v[198:199], v3 offset:5248
    s_waitcnt lgkmcnt(4)
    ds_read_b64_tr_b16 v[200:201], v3 offset:6144
    ds_read_b64_tr_b16 v[202:203], v3 offset:6272
    ds_read_b64_tr_b16 v[204:205], v3 offset:7168
    ds_read_b64_tr_b16 v[206:207], v3 offset:7296
    ds_read_b64_tr_b16 v[208:209], v3 offset:8192
    ds_read_b64_tr_b16 v[210:211], v3 offset:8320
    ds_read_b64_tr_b16 v[212:213], v3 offset:9216
    ds_read_b64_tr_b16 v[214:215], v3 offset:9344
    ds_read_b64_tr_b16 v[216:217], v3 offset:10240
    ds_read_b64_tr_b16 v[218:219], v3 offset:10368
    ds_read_b64_tr_b16 v[220:221], v3 offset:11264
    ds_read_b64_tr_b16 v[222:223], v3 offset:11392
    s_waitcnt lgkmcnt(4)
    ds_read_b64_tr_b16 v[224:225], v3 offset:12288
    ds_read_b64_tr_b16 v[226:227], v3 offset:12416
    ds_read_b64_tr_b16 v[228:229], v3 offset:13312
    ds_read_b64_tr_b16 v[230:231], v3 offset:13440
    ds_read_b64_tr_b16 v[232:233], v3 offset:14336
    ds_read_b64_tr_b16 v[234:235], v3 offset:14464
    ds_read_b64_tr_b16 v[236:237], v3 offset:15360
    ds_read_b64_tr_b16 v[238:239], v3 offset:15488
    ds_read_b64_tr_b16 v[240:241], v3 offset:16384
    ds_read_b64_tr_b16 v[242:243], v3 offset:16512
    ds_read_b64_tr_b16 v[244:245], v3 offset:17408
    ds_read_b64_tr_b16 v[246:247], v3 offset:17536
    s_waitcnt lgkmcnt(4)
    ds_read_b64_tr_b16 v[248:249], v3 offset:18432
    ds_read_b64_tr_b16 v[250:251], v3 offset:18560
    ds_read_b64_tr_b16 v[252:253], v3 offset:19456
    ds_read_b64_tr_b16 v[254:255], v3 offset:19584
    s_waitcnt lgkmcnt(0)
    v_mfma_f32_16x16x32_bf16 v[8:11], v[96:99], v[16:19], 0
    v_mfma_f32_16x16x32_bf16 v[12:15], v[176:179], v[16:19], 0
    v_mfma_f32_16x16x32_bf16 v[8:11], v[100:103], v[20:23], v[8:11]
    v_mfma_f32_16x16x32_bf16 v[12:15], v[180:183], v[20:23], v[12:15]
    v_mfma_f32_16x16x32_bf16 v[8:11], v[104:107], v[24:27], v[8:11]
    v_mfma_f32_16x16x32_bf16 v[12:15], v[184:187], v[24:27], v[12:15]
    v_mfma_f32_16x16x32_bf16 v[8:11], v[108:111], v[28:31], v[8:11]
    v_mfma_f32_16x16x32_bf16 v[12:15], v[188:191], v[28:31], v[12:15]
    v_mfma_f32_16x16x32_bf16 v[8:11], v[112:115], v[32:35], v[8:11]
    v_mfma_f32_16x16x32_bf16 v[12:15], v[192:195], v[32:35], v[12:15]
    v_mfma_f32_16x16x32_bf16 v[8:11], v[116:119], v[36:39], v[8:11]
    v_mfma_f32_16x16x32_bf16 v[12:15], v[196:199], v[36:39], v[12:15]
    v_mfma_f32_16x16x32_bf16 v[8:11], v[120:123], v[40:43], v[8:11]
    v_mfma_f32_16x16x32_bf16 v[12:15], v[200:203], v[40:43], v[12:15]
    v_mfma_f32_16x16x32_bf16 v[8:11], v[124:127], v[44:47], v[8:11]
    v_mfma_f32_16x16x32_bf16 v[12:15], v[204:207], v[44:47], v[12:15]
    v_mfma_f32_16x16x32_bf16 v[8:11], v[128:131], v[48:51], v[8:11]
    v_mfma_f32_16x16x32_bf16 v[12:15], v[208:211], v[48:51], v[12:15]
    v_mfma_f32_16x16x32_bf16 v[8:11], v[132:135], v[52:55], v[8:11]
    v_mfma_f32_16x16x32_bf16 v[12:15], v[212:215], v[52:55], v[12:15]
    v_mfma_f32_16x16x32_bf16 v[8:11], v[136:139], v[56:59], v[8:11]
    v_mfma_f32_16x16x32_bf16 v[12:15], v[216:219], v[56:59], v[12:15]
    v_mfma_f32_16x16x32_bf16 v[8:11], v[140:143], v[60:63], v[8:11]
    v_mfma_f32_16x16x32_bf16 v[12:15], v[220:223], v[60:63], v[12:15]
    v_mfma_f32_16x16x32_bf16 v[8:11], v[144:147], v[64:67], v[8:11]
    v_mfma_f32_16x16x32_bf16 v[12:15], v[224:227], v[64:67], v[12:15]
    v_mfma_f32_16x16x32_bf16 v[8:11], v[148:151], v[68:71], v[8:11]
    v_mfma_f32_16x16x32_bf16 v[12:15], v[228:231], v[68:71], v[12:15]
    v_mfma_f32_16x16x32_bf16 v[8:11], v[152:155], v[72:75], v[8:11]
    v_mfma_f32_16x16x32_bf16 v[12:15], v[232:235], v[72:75], v[12:15]
    v_mfma_f32_16x16x32_bf16 v[8:11], v[156:159], v[76:79], v[8:11]
    v_mfma_f32_16x16x32_bf16 v[12:15], v[236:239], v[76:79], v[12:15]
    v_mfma_f32_16x16x32_bf16 v[8:11], v[160:163], v[80:83], v[8:11]
    v_mfma_f32_16x16x32_bf16 v[12:15], v[240:243], v[80:83], v[12:15]
    v_mfma_f32_16x16x32_bf16 v[8:11], v[164:167], v[84:87], v[8:11]
    v_mfma_f32_16x16x32_bf16 v[12:15], v[244:247], v[84:87], v[12:15]
    v_mfma_f32_16x16x32_bf16 v[8:11], v[168:171], v[88:91], v[8:11]
    v_mfma_f32_16x16x32_bf16 v[12:15], v[248:251], v[88:91], v[12:15]
    v_mfma_f32_16x16x32_bf16 v[8:11], v[172:175], v[92:95], v[8:11]
    v_mfma_f32_16x16x32_bf16 v[12:15], v[252:255], v[92:95], v[12:15]
    s_nop 7
    v_cvt_pk_bf16_f32 v8, v8, v8
    v_lshlrev_b32 v8, 16, v8
    v_cvt_pk_bf16_f32 v12, v12, v12
    v_lshlrev_b32 v12, 16, v12
    v_mul_f32 v16, 0xbfb8aa3b, v8
    v_exp_f32 v16, v16
    s_nop 0
    v_add_f32 v16, 1.0, v16
    v_rcp_f32 v16, v16
    s_nop 0
    v_mul_f32 v8, v8, v16
    v_cvt_pk_bf16_f32 v8, v8, v8
    v_lshlrev_b32 v8, 16, v8
    v_mul_f32 v8, v8, v12
    v_cvt_pk_bf16_f32 v9, v9, v9
    v_lshlrev_b32 v9, 16, v9
    v_cvt_pk_bf16_f32 v13, v13, v13
    v_lshlrev_b32 v13, 16, v13
    v_mul_f32 v17, 0xbfb8aa3b, v9
    v_exp_f32 v17, v17
    s_nop 0
    v_add_f32 v17, 1.0, v17
    v_rcp_f32 v17, v17
    s_nop 0
    v_mul_f32 v9, v9, v17
    v_cvt_pk_bf16_f32 v9, v9, v9
    v_lshlrev_b32 v9, 16, v9
    v_mul_f32 v9, v9, v13
    v_cvt_pk_bf16_f32 v10, v10, v10
    v_lshlrev_b32 v10, 16, v10
    v_cvt_pk_bf16_f32 v14, v14, v14
    v_lshlrev_b32 v14, 16, v14
    v_mul_f32 v18, 0xbfb8aa3b, v10
    v_exp_f32 v18, v18
    s_nop 0
    v_add_f32 v18, 1.0, v18
    v_rcp_f32 v18, v18
    s_nop 0
    v_mul_f32 v10, v10, v18
    v_cvt_pk_bf16_f32 v10, v10, v10
    v_lshlrev_b32 v10, 16, v10
    v_mul_f32 v10, v10, v14
    v_cvt_pk_bf16_f32 v11, v11, v11
    v_lshlrev_b32 v11, 16, v11
    v_cvt_pk_bf16_f32 v15, v15, v15
    v_lshlrev_b32 v15, 16, v15
    v_mul_f32 v19, 0xbfb8aa3b, v11
    v_exp_f32 v19, v19
    s_nop 0
    v_add_f32 v19, 1.0, v19
    v_rcp_f32 v19, v19
    s_nop 0
    v_mul_f32 v11, v11, v19
    v_cvt_pk_bf16_f32 v11, v11, v11
    v_lshlrev_b32 v11, 16, v11
    v_mul_f32 v11, v11, v15
    v_cvt_pk_bf16_f32 v16, v8, v9
    v_cvt_pk_bf16_f32 v17, v10, v11
    s_lshr_b32 s65, s24, 1
    s_lshl_b32 s65, s65, 10
    s_and_b32 s66, s24, 1
    s_lshl_b32 s66, s66, 3
    s_add_u32 s65, s65, s66
    s_add_u32 s65, s65, 0x5401000
    v_lshlrev_b32 v4, 4, v0
    buffer_store_dwordx2 v[16:17], v4, s[4:7], s65 offen sc1
    s_waitcnt vmcnt(0)
    v_mov_b32 v7, 1
    v_mov_b32 v8, 0
    s_mov_b32 s64, 0x298080
    s_mov_b64 exec, 1
    buffer_atomic_add v7, v8, s[4:7], s64 offen sc1
    s_mov_b64 exec, -1
H_A1:
    v_mbcnt_lo_u32_b32 v0, -1, 0
    v_mbcnt_hi_u32_b32 v0, -1, v0
    s_mov_b32 s29, 0
    v_lshlrev_b32 v1, 4, v0
    v_lshrrev_b32 v5, 4, v0
    v_lshlrev_b32 v2, 7, v5
    v_and_b32 v5, 7, v0
    v_lshl_add_u32 v2, v5, 4, v2
    v_bfe_u32 v5, v0, 4, 1
    v_lshlrev_b32 v3, 7, v5
    v_and_b32 v5, 15, v0
    v_lshl_add_u32 v3, v5, 3, v3
    s_mov_b32 s34, 0x3e0293ee
    s_mov_b32 s35, 0x3e0293ee
    s_mov_b32 s36, -1
    s_mov_b32 s37, 0
    v_lshrrev_b32 v5, 4, v0
    v_lshlrev_b32 v5, 2, v5
    v_and_b32 v6, 15, v0
    v_add_u32 v7, 0, v5
    v_cmp_le_u32 s[38:39], v7, v6
    v_add_u32 v7, 1, v5
    v_cmp_le_u32 s[40:41], v7, v6
    v_add_u32 v7, 2, v5
    v_cmp_le_u32 s[42:43], v7, v6
    v_add_u32 v7, 3, v5
    v_cmp_le_u32 s[44:45], v7, v6
    v_mov_b32 v248, 0x3f803f80
    v_mov_b32 v249, 0x3f803f80
    v_mov_b32 v250, 0x3f803f80
    v_mov_b32 v251, 0x3f803f80
    s_lshl_b32 s24, s12, 2
    s_add_u32 s24, s24, s14
    s_add_u32 s24, s24, 8
    s_mov_b32 s25, 1
AT1_LOOP:
    s_cmp_eq_u32 s24, 63
    s_cbranch_scc1 AT1_END
    s_lshl_b32 s64, s24, 5
    s_add_u32 s64, s64, s13
    s_lshl_b32 s26, s64, 13
    s_add_u32 s26, s26, 0x3400000
    s_lshl_b32 s27, s64, 14
    s_add_u32 s27, s27, 0x1400000
    s_lshl_b32 s65, s64, 11
    s_add_u32 s30, s65, 0x640000
    s_add_u32 s31, s65, 0xa40000
    s_lshl_b32 s33, s64, 2
    s_add_u32 s33, s33, 0x296000
    s_lshl_b32 s32, s24, 18
    s_lshl_b32 s65, s13, 12
    s_add_u32 s32, s32, s65
    s_add_u32 s32, s32, 0x4400000
    s_lshr_b32 s65, s24, 2
    s_lshl_b32 s65, s65, 9
    s_lshl_b32 s66, s13, 4
    s_add_u32 s65, s65, s66
    s_add_u32 s65, s65, 0x291000
    s_lshr_b32 s66, s24, 1
    s_lshl_b32 s66, s66, 8
    s_lshl_b32 s64, s13, 3
    s_add_u32 s66, s66, s64
    s_add_u32 s66, s66, 0x293ff4
    v_lshlrev_b32 v5, 2, v0
    v_mov_b32 v6, s65
    v_mov_b32 v7, s66
    v_cmp_gt_u32 vcc, 3, v0
    s_nop 1
    v_cndmask_b32 v6, v7, v6, vcc
    v_add_u32 v4, v5, v6
    s_mov_b32 s64, 0
    s_mov_b64 exec, 7
AT1_F_186:
    buffer_load_dword v5, v4, s[4:7], s64 offen sc1
    s_add_u32 s29, s29, 1
    s_waitcnt vmcnt(0)
    v_cmp_eq_u32 vcc, 0, v5
    s_cbranch_vccz AT1_FD_187
    s_cmp_gt_u32 s29, 262144
    s_cbranch_scc1 AT1_FD_187
    s_sleep 1
    s_branch AT1_F_186
AT1_FD_187:
    s_mov_b64 exec, -1
    buffer_load_dwordx4 v[16:19], v1, s[4:7], s26 offen offset:0
    buffer_load_dwordx4 v[20:23], v1, s[4:7], s26 offen offset:1024
    buffer_load_dwordx4 v[24:27], v1, s[4:7], s26 offen offset:2048
    buffer_load_dwordx4 v[28:31], v1, s[4:7], s26 offen offset:3072
    s_add_u32 s26, s26, 4096
    buffer_load_dwordx4 v[32:35], v1, s[4:7], s26 offen offset:0
    buffer_load_dwordx4 v[36:39], v1, s[4:7], s26 offen offset:1024
    buffer_load_dwordx4 v[40:43], v1, s[4:7], s26 offen offset:2048
    buffer_load_dwordx4 v[44:47], v1, s[4:7], s26 offen offset:3072
    buffer_load_dwordx4 v[48:51], v1, s[4:7], s27 offen offset:0
    buffer_load_dwordx4 v[52:55], v1, s[4:7], s27 offen offset:1024
    buffer_load_dwordx4 v[56:59], v1, s[4:7], s27 offen offset:2048
    buffer_load_dwordx4 v[60:63], v1, s[4:7], s27 offen offset:3072
    s_add_u32 s27, s27, 4096
    buffer_load_dwordx4 v[64:67], v1, s[4:7], s27 offen offset:0
    buffer_load_dwordx4 v[68:71], v1, s[4:7], s27 offen offset:1024
    buffer_load_dwordx4 v[72:75], v1, s[4:7], s27 offen offset:2048
    buffer_load_dwordx4 v[76:79], v1, s[4:7], s27 offen offset:3072
    s_add_u32 s27, s27, 4096
    buffer_load_dwordx4 v[80:83], v1, s[4:7], s27 offen offset:0
    buffer_load_dwordx4 v[84:87], v1, s[4:7], s27 offen offset:1024
    buffer_load_dwordx4 v[88:91], v1, s[4:7], s27 offen offset:2048
    buffer_load_dwordx4 v[92:95], v1, s[4:7], s27 offen offset:3072
    s_add_u32 s27, s27, 4096
    buffer_load_dwordx4 v[96:99], v1, s[4:7], s27 offen offset:0
    buffer_load_dwordx4 v[100:103], v1, s[4:7], s27 offen offset:1024
    buffer_load_dwordx4 v[104:107], v1, s[4:7], s27 offen offset:2048
    buffer_load_dwordx4 v[108:111], v1, s[4:7], s27 offen offset:3072
    s_mov_b64 exec, 0x18
AT1_G_188:
    buffer_load_dword v5, v4, s[4:7], s64 offen sc1
    s_add_u32 s29, s29, 1
    s_waitcnt vmcnt(0)
    v_cmp_eq_u32 vcc, 0, v5
    s_cbranch_vccz AT1_GD_189
    s_cmp_gt_u32 s29, 262144
    s_cbranch_scc1 AT1_GD_189
    s_sleep 1
    s_branch AT1_G_188
AT1_GD_189:
    s_mov_b64 exec, -1
    buffer_load_dwordx4 v[112:115], v2, s[4:7], s30 offen offset:0
    buffer_load_dwordx4 v[116:119], v2, s[4:7], s30 offen offset:512
    buffer_load_dwordx4 v[120:123], v2, s[4:7], s30 offen offset:1024
    buffer_load_dwordx4 v[124:127], v2, s[4:7], s30 offen offset:1536
    buffer_load_dwordx2 v[128:129], v3, s[4:7], s31 offen offset:0
    buffer_load_dwordx2 v[130:131], v3, s[4:7], s31 offen offset:256
    buffer_load_dwordx2 v[132:133], v3, s[4:7], s31 offen offset:512
    buffer_load_dwordx2 v[134:135], v3, s[4:7], s31 offen offset:768
    buffer_load_dwordx2 v[136:137], v3, s[4:7], s31 offen offset:1024
    buffer_load_dwordx2 v[138:139], v3, s[4:7], s31 offen offset:1280
    buffer_load_dwordx2 v[140:141], v3, s[4:7], s31 offen offset:1536
    buffer_load_dwordx2 v[142:143], v3, s[4:7], s31 offen offset:1792
    v_mfma_f32_16x16x32_bf16 v[148:151], v[48:51], v[16:19], 0
    v_mfma_f32_16x16x32_bf16 v[156:159], v[48:51], v[32:35], 0
    v_mfma_f32_16x16x32_bf16 v[160:163], v[64:67], v[32:35], 0
    v_mfma_f32_16x16x32_bf16 v[148:151], v[52:55], v[20:23], v[148:151]
    v_mfma_f32_16x16x32_bf16 v[156:159], v[52:55], v[36:39], v[156:159]
    v_mfma_f32_16x16x32_bf16 v[160:163], v[68:71], v[36:39], v[160:163]
    v_mfma_f32_16x16x32_bf16 v[148:151], v[56:59], v[24:27], v[148:151]
    v_mfma_f32_16x16x32_bf16 v[156:159], v[56:59], v[40:43], v[156:159]
    v_mfma_f32_16x16x32_bf16 v[160:163], v[72:75], v[40:43], v[160:163]
    v_mfma_f32_16x16x32_bf16 v[148:151], v[60:63], v[28:31], v[148:151]
    v_mfma_f32_16x16x32_bf16 v[156:159], v[60:63], v[44:47], v[156:159]
    v_mfma_f32_16x16x32_bf16 v[160:163], v[76:79], v[44:47], v[160:163]
    s_waitcnt vmcnt(8)
    v_mfma_f32_16x16x32_bf16 v[144:147], v[112:115], v[16:19], 0
    v_mfma_f32_16x16x32_bf16 v[152:155], v[112:115], v[32:35], 0
    v_mfma_f32_16x16x32_bf16 v[144:147], v[116:119], v[20:23], v[144:147]
    v_mfma_f32_16x16x32_bf16 v[152:155], v[116:119], v[36:39], v[152:155]
    v_mfma_f32_16x16x32_bf16 v[144:147], v[120:123], v[24:27], v[144:147]
    v_mfma_f32_16x16x32_bf16 v[152:155], v[120:123], v[40:43], v[152:155]
    v_mfma_f32_16x16x32_bf16 v[144:147], v[124:127], v[28:31], v[144:147]
    v_mfma_f32_16x16x32_bf16 v[152:155], v[124:127], v[44:47], v[152:155]
    v_mov_b32 v11, 0xff800000
    s_nop 7
    v_cndmask_b32 v148, v11, v148, s[38:39]
    v_cndmask_b32 v160, v11, v160, s[38:39]
    v_cndmask_b32 v144, v11, v144, s[36:37]
    v_cndmask_b32 v152, v11, v152, s[36:37]
    v_cndmask_b32 v149, v11, v149, s[40:41]
    v_cndmask_b32 v161, v11, v161, s[40:41]
    v_cndmask_b32 v145, v11, v145, s[36:37]
    v_cndmask_b32 v153, v11, v153, s[36:37]
    v_cndmask_b32 v150, v11, v150, s[42:43]
    v_cndmask_b32 v162, v11, v162, s[42:43]
    v_cndmask_b32 v146, v11, v146, s[36:37]
    v_cndmask_b32 v154, v11, v154, s[36:37]
    v_cndmask_b32 v151, v11, v151, s[44:45]
    v_cndmask_b32 v163, v11, v163, s[44:45]
    v_cndmask_b32 v147, v11, v147, s[36:37]
    v_cndmask_b32 v155, v11, v155, s[36:37]
    v_max3_f32 v8, v144, v145, v146
    v_max3_f32 v8, v8, v147, v148
    v_max3_f32 v8, v8, v149, v150
    v_max_f32 v8, v8, v151
    v_mov_b32 v9, v8
    s_nop 1
    v_permlane16_swap_b32 v8, v9
    v_max_f32 v8, v8, v9
    v_mov_b32 v9, v8
    s_nop 1
    v_permlane32_swap_b32 v8, v9
    v_max_f32 v8, v8, v9
    v_mul_f32 v8, s34, v8
    v_fma_f32 v144, v144, s34, -v8
    v_fma_f32 v145, v145, s34, -v8
    v_fma_f32 v146, v146, s34, -v8
    v_fma_f32 v147, v147, s34, -v8
    v_fma_f32 v148, v148, s34, -v8
    v_fma_f32 v149, v149, s34, -v8
    v_fma_f32 v150, v150, s34, -v8
    v_fma_f32 v151, v151, s34, -v8
    v_exp_f32 v144, v144
    v_exp_f32 v145, v145
    v_exp_f32 v146, v146
    v_exp_f32 v147, v147
    v_exp_f32 v148, v148
    v_exp_f32 v149, v149
    v_exp_f32 v150, v150
    v_exp_f32 v151, v151
    s_nop 0
    v_cvt_pk_bf16_f32 v164, v148, v149
    v_cvt_pk_bf16_f32 v165, v150, v151
    v_mov_b32 v166, 0
    v_mov_b32 v167, 0
    v_cvt_pk_bf16_f32 v168, v144, v145
    v_cvt_pk_bf16_f32 v169, v146, v147
    v_max3_f32 v8, v152, v153, v154
    v_max3_f32 v8, v8, v155, v156
    v_max3_f32 v8, v8, v157, v158
    v_max3_f32 v8, v8, v159, v160
    v_max3_f32 v8, v8, v161, v162
    v_max_f32 v8, v8, v163
    v_mov_b32 v9, v8
    s_nop 1
    v_permlane16_swap_b32 v8, v9
    v_max_f32 v8, v8, v9
    v_mov_b32 v9, v8
    s_nop 1
    v_permlane32_swap_b32 v8, v9
    v_max_f32 v8, v8, v9
    v_mul_f32 v8, s34, v8
    v_fma_f32 v152, v152, s34, -v8
    v_fma_f32 v153, v153, s34, -v8
    v_fma_f32 v154, v154, s34, -v8
    v_fma_f32 v155, v155, s34, -v8
    v_fma_f32 v156, v156, s34, -v8
    v_fma_f32 v157, v157, s34, -v8
    v_fma_f32 v158, v158, s34, -v8
    v_fma_f32 v159, v159, s34, -v8
    v_fma_f32 v160, v160, s34, -v8
    v_fma_f32 v161, v161, s34, -v8
    v_fma_f32 v162, v162, s34, -v8
    v_fma_f32 v163, v163, s34, -v8
    v_exp_f32 v152, v152
    v_exp_f32 v153, v153
    v_exp_f32 v154, v154
    v_exp_f32 v155, v155
    v_exp_f32 v156, v156
    v_exp_f32 v157, v157
    v_exp_f32 v158, v158
    v_exp_f32 v159, v159
    v_exp_f32 v160, v160
    v_exp_f32 v161, v161
    v_exp_f32 v162, v162
    v_exp_f32 v163, v163
    s_nop 0
    v_cvt_pk_bf16_f32 v170, v156, v157
    v_cvt_pk_bf16_f32 v171, v158, v159
    v_cvt_pk_bf16_f32 v172, v160, v161
    v_cvt_pk_bf16_f32 v173, v162, v163
    v_cvt_pk_bf16_f32 v174, v152, v153
    v_cvt_pk_bf16_f32 v175, v154, v155
    s_waitcnt vmcnt(0)
    v_mfma_f32_16x16x32_bf16 v[240:243], v[248:251], v[164:167], 0
    v_mfma_f32_16x16x32_bf16 v[244:247], v[248:251], v[170:173], 0
    v_mfma_f32_16x16x32_bf16 v[176:179], v[80:83], v[164:167], 0
    v_mfma_f32_16x16x32_bf16 v[180:183], v[80:83], v[170:173], 0
    v_mfma_f32_16x16x32_bf16 v[184:187], v[84:87], v[164:167], 0
    v_mfma_f32_16x16x32_bf16 v[188:191], v[84:87], v[170:173], 0
    v_mfma_f32_16x16x32_bf16 v[192:195], v[88:91], v[164:167], 0
    v_mfma_f32_16x16x32_bf16 v[196:199], v[88:91], v[170:173], 0
    v_mfma_f32_16x16x32_bf16 v[200:203], v[92:95], v[164:167], 0
    v_mfma_f32_16x16x32_bf16 v[204:207], v[92:95], v[170:173], 0
    v_mfma_f32_16x16x32_bf16 v[208:211], v[96:99], v[164:167], 0
    v_mfma_f32_16x16x32_bf16 v[212:215], v[96:99], v[170:173], 0
    v_mfma_f32_16x16x32_bf16 v[216:219], v[100:103], v[164:167], 0
    v_mfma_f32_16x16x32_bf16 v[220:223], v[100:103], v[170:173], 0
    v_mfma_f32_16x16x32_bf16 v[224:227], v[104:107], v[164:167], 0
    v_mfma_f32_16x16x32_bf16 v[228:231], v[104:107], v[170:173], 0
    v_mfma_f32_16x16x32_bf16 v[232:235], v[108:111], v[164:167], 0
    v_mfma_f32_16x16x32_bf16 v[236:239], v[108:111], v[170:173], 0
    v_mfma_f32_16x16x16_bf16 v[240:243], v[248:249], v[168:169], v[240:243]
    v_mfma_f32_16x16x16_bf16 v[244:247], v[248:249], v[174:175], v[244:247]
    v_mfma_f32_16x16x16_bf16 v[176:179], v[128:129], v[168:169], v[176:179]
    v_mfma_f32_16x16x16_bf16 v[180:183], v[128:129], v[174:175], v[180:183]
    v_mfma_f32_16x16x16_bf16 v[184:187], v[130:131], v[168:169], v[184:187]
    v_mfma_f32_16x16x16_bf16 v[188:191], v[130:131], v[174:175], v[188:191]
    v_mfma_f32_16x16x16_bf16 v[192:195], v[132:133], v[168:169], v[192:195]
    v_mfma_f32_16x16x16_bf16 v[196:199], v[132:133], v[174:175], v[196:199]
    v_mfma_f32_16x16x16_bf16 v[200:203], v[134:135], v[168:169], v[200:203]
    v_mfma_f32_16x16x16_bf16 v[204:207], v[134:135], v[174:175], v[204:207]
    v_mfma_f32_16x16x16_bf16 v[208:211], v[136:137], v[168:169], v[208:211]
    v_mfma_f32_16x16x16_bf16 v[212:215], v[136:137], v[174:175], v[212:215]
    v_mfma_f32_16x16x16_bf16 v[216:219], v[138:139], v[168:169], v[216:219]
    v_mfma_f32_16x16x16_bf16 v[220:223], v[138:139], v[174:175], v[220:223]
    v_mfma_f32_16x16x16_bf16 v[224:227], v[140:141], v[168:169], v[224:227]
    v_mfma_f32_16x16x16_bf16 v[228:231], v[140:141], v[174:175], v[228:231]
    v_mfma_f32_16x16x16_bf16 v[232:235], v[142:143], v[168:169], v[232:235]
    v_mfma_f32_16x16x16_bf16 v[236:239], v[142:143], v[174:175], v[236:239]
    v_rcp_f32 v8, v240
    v_rcp_f32 v9, v244
    s_nop 7
    v_mul_f32 v176, v176, v8
    v_mul_f32 v177, v177, v8
    v_mul_f32 v178, v178, v8
    v_mul_f32 v179, v179, v8
    v_cvt_pk_bf16_f32 v16, v176, v177
    v_cvt_pk_bf16_f32 v17, v178, v179
    v_mul_f32 v184, v184, v8
    v_mul_f32 v185, v185, v8
    v_mul_f32 v186, v186, v8
    v_mul_f32 v187, v187, v8
    v_cvt_pk_bf16_f32 v18, v184, v185
    v_cvt_pk_bf16_f32 v19, v186, v187
    s_add_u32 s64, s32, 0x0
    buffer_store_dwordx4 v[16:19], v1, s[4:7], s64 offen offset:0 sc1
    v_mul_f32 v192, v192, v8
    v_mul_f32 v193, v193, v8
    v_mul_f32 v194, v194, v8
    v_mul_f32 v195, v195, v8
    v_cvt_pk_bf16_f32 v20, v192, v193
    v_cvt_pk_bf16_f32 v21, v194, v195
    v_mul_f32 v200, v200, v8
    v_mul_f32 v201, v201, v8
    v_mul_f32 v202, v202, v8
    v_mul_f32 v203, v203, v8
    v_cvt_pk_bf16_f32 v22, v200, v201
    v_cvt_pk_bf16_f32 v23, v202, v203
    s_add_u32 s64, s32, 0x0
    buffer_store_dwordx4 v[20:23], v1, s[4:7], s64 offen offset:1024 sc1
    v_mul_f32 v208, v208, v8
    v_mul_f32 v209, v209, v8
    v_mul_f32 v210, v210, v8
    v_mul_f32 v211, v211, v8
    v_cvt_pk_bf16_f32 v24, v208, v209
    v_cvt_pk_bf16_f32 v25, v210, v211
    v_mul_f32 v216, v216, v8
    v_mul_f32 v217, v217, v8
    v_mul_f32 v218, v218, v8
    v_mul_f32 v219, v219, v8
    v_cvt_pk_bf16_f32 v26, v216, v217
    v_cvt_pk_bf16_f32 v27, v218, v219
    s_add_u32 s64, s32, 0x0
    buffer_store_dwordx4 v[24:27], v1, s[4:7], s64 offen offset:2048 sc1
    v_mul_f32 v224, v224, v8
    v_mul_f32 v225, v225, v8
    v_mul_f32 v226, v226, v8
    v_mul_f32 v227, v227, v8
    v_cvt_pk_bf16_f32 v28, v224, v225
    v_cvt_pk_bf16_f32 v29, v226, v227
    v_mul_f32 v232, v232, v8
    v_mul_f32 v233, v233, v8
    v_mul_f32 v234, v234, v8
    v_mul_f32 v235, v235, v8
    v_cvt_pk_bf16_f32 v30, v232, v233
    v_cvt_pk_bf16_f32 v31, v234, v235
    s_add_u32 s64, s32, 0x0
    buffer_store_dwordx4 v[28:31], v1, s[4:7], s64 offen offset:3072 sc1
    v_mul_f32 v180, v180, v9
    v_mul_f32 v181, v181, v9
    v_mul_f32 v182, v182, v9
    v_mul_f32 v183, v183, v9
    v_cvt_pk_bf16_f32 v32, v180, v181
    v_cvt_pk_bf16_f32 v33, v182, v183
    v_mul_f32 v188, v188, v9
    v_mul_f32 v189, v189, v9
    v_mul_f32 v190, v190, v9
    v_mul_f32 v191, v191, v9
    v_cvt_pk_bf16_f32 v34, v188, v189
    v_cvt_pk_bf16_f32 v35, v190, v191
    s_add_u32 s64, s32, 0x20000
    buffer_store_dwordx4 v[32:35], v1, s[4:7], s64 offen offset:0 sc1
    v_mul_f32 v196, v196, v9
    v_mul_f32 v197, v197, v9
    v_mul_f32 v198, v198, v9
    v_mul_f32 v199, v199, v9
    v_cvt_pk_bf16_f32 v36, v196, v197
    v_cvt_pk_bf16_f32 v37, v198, v199
    v_mul_f32 v204, v204, v9
    v_mul_f32 v205, v205, v9
    v_mul_f32 v206, v206, v9
    v_mul_f32 v207, v207, v9
    v_cvt_pk_bf16_f32 v38, v204, v205
    v_cvt_pk_bf16_f32 v39, v206, v207
    s_add_u32 s64, s32, 0x20000
    buffer_store_dwordx4 v[36:39], v1, s[4:7], s64 offen offset:1024 sc1
    v_mul_f32 v212, v212, v9
    v_mul_f32 v213, v213, v9
    v_mul_f32 v214, v214, v9
    v_mul_f32 v215, v215, v9
    v_cvt_pk_bf16_f32 v40, v212, v213
    v_cvt_pk_bf16_f32 v41, v214, v215
    v_mul_f32 v220, v220, v9
    v_mul_f32 v221, v221, v9
    v_mul_f32 v222, v222, v9
    v_mul_f32 v223, v223, v9
    v_cvt_pk_bf16_f32 v42, v220, v221
    v_cvt_pk_bf16_f32 v43, v222, v223
    s_add_u32 s64, s32, 0x20000
    buffer_store_dwordx4 v[40:43], v1, s[4:7], s64 offen offset:2048 sc1
    v_mul_f32 v228, v228, v9
    v_mul_f32 v229, v229, v9
    v_mul_f32 v230, v230, v9
    v_mul_f32 v231, v231, v9
    v_cvt_pk_bf16_f32 v44, v228, v229
    v_cvt_pk_bf16_f32 v45, v230, v231
    v_mul_f32 v236, v236, v9
    v_mul_f32 v237, v237, v9
    v_mul_f32 v238, v238, v9
    v_mul_f32 v239, v239, v9
    v_cvt_pk_bf16_f32 v46, v236, v237
    v_cvt_pk_bf16_f32 v47, v238, v239
    s_add_u32 s64, s32, 0x20000
    buffer_store_dwordx4 v[44:47], v1, s[4:7], s64 offen offset:3072 sc1
    s_waitcnt vmcnt(0)
    v_mov_b32 v7, 1
    v_mov_b32 v8, 0
    s_mov_b64 exec, 1
    buffer_store_dword v7, v8, s[4:7], s33 offen sc1
    s_mov_b64 exec, -1
    s_add_u32 s24, s24, 8
    s_add_u32 s25, s25, 1
    s_cmp_lt_u32 s25, 2
    s_cbranch_scc1 AT1_LOOP
AT1_END:
    s_lshl_b32 s70, s13, 1
    s_add_u32 s70, s70, s12
    s_load_dwordx2 s[44:45], s[0:1], 72
    s_mov_b32 s46, 0x21c000
    s_mov_b32 s47, 0x00020000
    s_load_dwordx2 s[48:49], s[0:1], 80
    s_mov_b32 s50, 0x21c000
    s_mov_b32 s51, 0x00020000
    s_load_dwordx2 s[52:53], s[0:1], 88
    s_mov_b32 s54, 0x21c000
    s_mov_b32 s55, 0x00020000
    s_mov_b32 s29, 0
    s_waitcnt lgkmcnt(0)
    v_mbcnt_lo_u32_b32 v0, -1, 0
    v_mbcnt_hi_u32_b32 v0, -1, v0
    s_cmp_lg_u32 s14, 0
    s_cbranch_scc1 H_ATT
    s_cmp_ge_u32 s70, 40
    s_cbranch_scc1 H_ATT
    s_mov_b32 s24, s70
    v_mov_b32 v8, 0
    s_mov_b32 s64, 0x298080
F2W_190:
    buffer_load_dword v7, v8, s[4:7], s64 offen sc1
    s_add_u32 s29, s29, 1
    s_waitcnt vmcnt(0)
    v_mov_b32 v9, 108
    v_cmp_gt_u32 vcc, v9, v7
    s_cbranch_vccz F2WD_191
    s_cmp_gt_u32 s29, 262144
    s_cbranch_scc1 F2WD_191
    s_sleep 8
    s_branch F2W_190
F2WD_191:
    s_mov_b32 s25, 0
    v_lshrrev_b32 v7, 1, v0
    v_mul_u32_u24 v2, 1280, v7
    v_and_b32 v7, 1, v0
    v_lshl_add_u32 v2, v7, 4, v2
    v_lshrrev_b32 v7, 4, v0
    v_lshlrev_b32 v3, 7, v7
    v_bfe_u32 v7, v0, 2, 2
    v_lshl_add_u32 v3, v7, 5, v3
    v_and_b32 v7, 3, v0
    v_lshl_add_u32 v3, v7, 3, v3
    v_add_u32 v3, s25, v3
    v_lshlrev_b32 v4, 4, v0
    s_mov_b32 s65, 0x5401000
    buffer_load_dwordx4 v[16:19], v4, s[4:7], s65 offen offset:0 sc1
    buffer_load_dwordx4 v[20:23], v4, s[4:7], s65 offen offset:1024 sc1
    buffer_load_dwordx4 v[24:27], v4, s[4:7], s65 offen offset:2048 sc1
    buffer_load_dwordx4 v[28:31], v4, s[4:7], s65 offen offset:3072 sc1
    s_add_u32 s65, s65, 4096
    buffer_load_dwordx4 v[32:35], v4, s[4:7], s65 offen offset:0 sc1
    buffer_load_dwordx4 v[36:39], v4, s[4:7], s65 offen offset:1024 sc1
    buffer_load_dwordx4 v[40:43], v4, s[4:7], s65 offen offset:2048 sc1
    buffer_load_dwordx4 v[44:47], v4, s[4:7], s65 offen offset:3072 sc1
    s_add_u32 s65, s65, 4096
    buffer_load_dwordx4 v[48:51], v4, s[4:7], s65 offen offset:0 sc1
    buffer_load_dwordx4 v[52:55], v4, s[4:7], s65 offen offset:1024 sc1
    buffer_load_dwordx4 v[56:59], v4, s[4:7], s65 offen offset:2048 sc1
    buffer_load_dwordx4 v[60:63], v4, s[4:7], s65 offen offset:3072 sc1
    s_add_u32 s65, s65, 4096
    buffer_load_dwordx4 v[64:67], v4, s[4:7], s65 offen offset:0 sc1
    buffer_load_dwordx4 v[68:71], v4, s[4:7], s65 offen offset:1024 sc1
    buffer_load_dwordx4 v[72:75], v4, s[4:7], s65 offen offset:2048 sc1
    buffer_load_dwordx4 v[76:79], v4, s[4:7], s65 offen offset:3072 sc1
    s_add_u32 s65, s65, 4096
    buffer_load_dwordx4 v[80:83], v4, s[4:7], s65 offen offset:0 sc1
    buffer_load_dwordx4 v[84:87], v4, s[4:7], s65 offen offset:1024 sc1
    buffer_load_dwordx4 v[88:91], v4, s[4:7], s65 offen offset:2048 sc1
    buffer_load_dwordx4 v[92:95], v4, s[4:7], s65 offen offset:3072 sc1
    s_add_u32 s65, s65, 4096
    buffer_load_dwordx4 v[96:99], v4, s[4:7], s65 offen offset:0 sc1
    buffer_load_dwordx4 v[100:103], v4, s[4:7], s65 offen offset:1024 sc1
    buffer_load_dwordx4 v[104:107], v4, s[4:7], s65 offen offset:2048 sc1
    buffer_load_dwordx4 v[108:111], v4, s[4:7], s65 offen offset:3072 sc1
    s_add_u32 s65, s65, 4096
    buffer_load_dwordx4 v[112:115], v4, s[4:7], s65 offen offset:0 sc1
    buffer_load_dwordx4 v[116:119], v4, s[4:7], s65 offen offset:1024 sc1
    buffer_load_dwordx4 v[120:123], v4, s[4:7], s65 offen offset:2048 sc1
    buffer_load_dwordx4 v[124:127], v4, s[4:7], s65 offen offset:3072 sc1
    s_add_u32 s65, s65, 4096
    buffer_load_dwordx4 v[128:131], v4, s[4:7], s65 offen offset:0 sc1
    buffer_load_dwordx4 v[132:135], v4, s[4:7], s65 offen offset:1024 sc1
    buffer_load_dwordx4 v[136:139], v4, s[4:7], s65 offen offset:2048 sc1
    buffer_load_dwordx4 v[140:143], v4, s[4:7], s65 offen offset:3072 sc1
    s_add_u32 s65, s65, 4096
    buffer_load_dwordx4 v[144:147], v4, s[4:7], s65 offen offset:0 sc1
    buffer_load_dwordx4 v[148:151], v4, s[4:7], s65 offen offset:1024 sc1
    buffer_load_dwordx4 v[152:155], v4, s[4:7], s65 offen offset:2048 sc1
    buffer_load_dwordx4 v[156:159], v4, s[4:7], s65 offen offset:3072 sc1
    s_add_u32 s65, s65, 4096
    buffer_load_dwordx4 v[160:163], v4, s[4:7], s65 offen offset:0 sc1
    buffer_load_dwordx4 v[164:167], v4, s[4:7], s65 offen offset:1024 sc1
    buffer_load_dwordx4 v[168:171], v4, s[4:7], s65 offen offset:2048 sc1
    buffer_load_dwordx4 v[172:175], v4, s[4:7], s65 offen offset:3072 sc1
    s_add_u32 s65, s65, 4096
    buffer_load_dwordx4 v[176:179], v4, s[4:7], s65 offen offset:0 sc1
    s_waitcnt vmcnt(20)
    buffer_load_dwordx4 v[180:183], v4, s[4:7], s65 offen offset:1024 sc1
    buffer_load_dwordx4 v[184:187], v4, s[4:7], s65 offen offset:2048 sc1
    buffer_load_dwordx4 v[188:191], v4, s[4:7], s65 offen offset:3072 sc1
    s_add_u32 s65, s65, 4096
    buffer_load_dwordx4 v[192:195], v4, s[4:7], s65 offen offset:0 sc1
    buffer_load_dwordx4 v[196:199], v4, s[4:7], s65 offen offset:1024 sc1
    buffer_load_dwordx4 v[200:203], v4, s[4:7], s65 offen offset:2048 sc1
    buffer_load_dwordx4 v[204:207], v4, s[4:7], s65 offen offset:3072 sc1
    s_add_u32 s65, s65, 4096
    buffer_load_dwordx4 v[208:211], v4, s[4:7], s65 offen offset:0 sc1
    buffer_load_dwordx4 v[212:215], v4, s[4:7], s65 offen offset:1024 sc1
    buffer_load_dwordx4 v[216:219], v4, s[4:7], s65 offen offset:2048 sc1
    buffer_load_dwordx4 v[220:223], v4, s[4:7], s65 offen offset:3072 sc1
    s_add_u32 s65, s65, 4096
    buffer_load_dwordx4 v[224:227], v4, s[4:7], s65 offen offset:0 sc1
    buffer_load_dwordx4 v[228:231], v4, s[4:7], s65 offen offset:1024 sc1
    s_waitcnt vmcnt(0)
    s_lshl_b32 s26, s24, 5
    s_add_u32 m0, s25, 0
    s_add_u32 s64, s26, 0x0
    buffer_load_dwordx4 v2, s[52:55], s64 offen lds
    s_add_u32 m0, s25, 1024
    s_add_u32 s64, s26, 0xa000
    buffer_load_dwordx4 v2, s[52:55], s64 offen lds
    s_add_u32 m0, s25, 2048
    s_add_u32 s64, s26, 0x14000
    buffer_load_dwordx4 v2, s[52:55], s64 offen lds
    s_add_u32 m0, s25, 3072
    s_add_u32 s64, s26, 0x1e000
    buffer_load_dwordx4 v2, s[52:55], s64 offen lds
    s_add_u32 m0, s25, 4096
    s_add_u32 s64, s26, 0x28000
    buffer_load_dwordx4 v2, s[52:55], s64 offen lds
    s_add_u32 m0, s25, 5120
    s_add_u32 s64, s26, 0x32000
    buffer_load_dwordx4 v2, s[52:55], s64 offen lds
    s_add_u32 m0, s25, 6144
    s_add_u32 s64, s26, 0x3c000
    buffer_load_dwordx4 v2, s[52:55], s64 offen lds
    s_add_u32 m0, s25, 7168
    s_add_u32 s64, s26, 0x46000
    buffer_load_dwordx4 v2, s[52:55], s64 offen lds
    s_add_u32 m0, s25, 8192
    s_add_u32 s64, s26, 0x50000
    buffer_load_dwordx4 v2, s[52:55], s64 offen lds
    s_add_u32 m0, s25, 9216
    s_add_u32 s64, s26, 0x5a000
    buffer_load_dwordx4 v2, s[52:55], s64 offen lds
    s_add_u32 m0, s25, 10240
    s_add_u32 s64, s26, 0x64000
    buffer_load_dwordx4 v2, s[52:55], s64 offen lds
    s_add_u32 m0, s25, 11264
    s_add_u32 s64, s26, 0x6e000
    buffer_load_dwordx4 v2, s[52:55], s64 offen lds
    s_add_u32 m0, s25, 12288
    s_add_u32 s64, s26, 0x78000
    buffer_load_dwordx4 v2, s[52:55], s64 offen lds
    s_add_u32 m0, s25, 13312
    s_add_u32 s64, s26, 0x82000
    buffer_load_dwordx4 v2, s[52:55], s64 offen lds
    s_add_u32 m0, s25, 14336
    s_add_u32 s64, s26, 0x8c000
    buffer_load_dwordx4 v2, s[52:55], s64 offen lds
    s_add_u32 m0, s25, 15360
    s_add_u32 s64, s26, 0x96000
    buffer_load_dwordx4 v2, s[52:55], s64 offen lds
    s_add_u32 m0, s25, 16384
    s_add_u32 s64, s26, 0xa0000
    buffer_load_dwordx4 v2, s[52:55], s64 offen lds
    s_add_u32 m0, s25, 17408
    s_add_u32 s64, s26, 0xaa000
    buffer_load_dwordx4 v2, s[52:55], s64 offen lds
    s_add_u32 m0, s25, 18432
    s_add_u32 s64, s26, 0xb4000
    buffer_load_dwordx4 v2, s[52:55], s64 offen lds
    s_add_u32 m0, s25, 19456
    s_add_u32 s64, s26, 0xbe000
    buffer_load_dwordx4 v2, s[52:55], s64 offen lds
    s_add_u32 m0, s25, 20480
    s_add_u32 s64, s26, 0xc8000
    buffer_load_dwordx4 v2, s[52:55], s64 offen lds
    s_add_u32 m0, s25, 21504
    s_add_u32 s64, s26, 0xd2000
    buffer_load_dwordx4 v2, s[52:55], s64 offen lds
    s_add_u32 m0, s25, 22528
    s_add_u32 s64, s26, 0xdc000
    buffer_load_dwordx4 v2, s[52:55], s64 offen lds
    s_add_u32 m0, s25, 23552
    s_add_u32 s64, s26, 0xe6000
    buffer_load_dwordx4 v2, s[52:55], s64 offen lds
    s_add_u32 m0, s25, 24576
    s_add_u32 s64, s26, 0xf0000
    buffer_load_dwordx4 v2, s[52:55], s64 offen lds
    s_add_u32 m0, s25, 25600
    s_add_u32 s64, s26, 0xfa000
    buffer_load_dwordx4 v2, s[52:55], s64 offen lds
    s_add_u32 m0, s25, 26624
    s_add_u32 s64, s26, 0x104000
    buffer_load_dwordx4 v2, s[52:55], s64 offen lds
    s_add_u32 m0, s25, 27648
    s_add_u32 s64, s26, 0x10e000
    buffer_load_dwordx4 v2, s[52:55], s64 offen lds
    s_add_u32 m0, s25, 28672
    s_add_u32 s64, s26, 0x118000
    buffer_load_dwordx4 v2, s[52:55], s64 offen lds
    s_add_u32 m0, s25, 29696
    s_add_u32 s64, s26, 0x122000
    buffer_load_dwordx4 v2, s[52:55], s64 offen lds
    s_add_u32 m0, s25, 30720
    s_add_u32 s64, s26, 0x12c000
    buffer_load_dwordx4 v2, s[52:55], s64 offen lds
    s_add_u32 m0, s25, 31744
    s_add_u32 s64, s26, 0x136000
    buffer_load_dwordx4 v2, s[52:55], s64 offen lds
    s_add_u32 m0, s25, 32768
    s_add_u32 s64, s26, 0x140000
    buffer_load_dwordx4 v2, s[52:55], s64 offen lds
    s_add_u32 m0, s25, 33792
    s_add_u32 s64, s26, 0x14a000
    buffer_load_dwordx4 v2, s[52:55], s64 offen lds
    s_add_u32 m0, s25, 34816
    s_add_u32 s64, s26, 0x154000
    buffer_load_dwordx4 v2, s[52:55], s64 offen lds
    s_add_u32 m0, s25, 35840
    s_add_u32 s64, s26, 0x15e000
    buffer_load_dwordx4 v2, s[52:55], s64 offen lds
    s_add_u32 m0, s25, 36864
    s_add_u32 s64, s26, 0x168000
    buffer_load_dwordx4 v2, s[52:55], s64 offen lds
    s_add_u32 m0, s25, 37888
    s_add_u32 s64, s26, 0x172000
    buffer_load_dwordx4 v2, s[52:55], s64 offen lds
    s_add_u32 m0, s25, 38912
    s_add_u32 s64, s26, 0x17c000
    buffer_load_dwordx4 v2, s[52:55], s64 offen lds
    s_add_u32 m0, s25, 39936
    s_add_u32 s64, s26, 0x186000
    buffer_load_dwordx4 v2, s[52:55], s64 offen lds
    s_add_u32 m0, s25, 40960
    s_add_u32 s64, s26, 0x190000
    buffer_load_dwordx4 v2, s[52:55], s64 offen lds
    s_waitcnt vmcnt(20)
    s_add_u32 m0, s25, 41984
    s_add_u32 s64, s26, 0x19a000
    buffer_load_dwordx4 v2, s[52:55], s64 offen lds
    s_add_u32 m0, s25, 43008
    s_add_u32 s64, s26, 0x1a4000
    buffer_load_dwordx4 v2, s[52:55], s64 offen lds
    s_add_u32 m0, s25, 44032
    s_add_u32 s64, s26, 0x1ae000
    buffer_load_dwordx4 v2, s[52:55], s64 offen lds
    s_add_u32 m0, s25, 45056
    s_add_u32 s64, s26, 0x1b8000
    buffer_load_dwordx4 v2, s[52:55], s64 offen lds
    s_add_u32 m0, s25, 46080
    s_add_u32 s64, s26, 0x1c2000
    buffer_load_dwordx4 v2, s[52:55], s64 offen lds
    s_add_u32 m0, s25, 47104
    s_add_u32 s64, s26, 0x1cc000
    buffer_load_dwordx4 v2, s[52:55], s64 offen lds
    s_add_u32 m0, s25, 48128
    s_add_u32 s64, s26, 0x1d6000
    buffer_load_dwordx4 v2, s[52:55], s64 offen lds
    s_add_u32 m0, s25, 49152
    s_add_u32 s64, s26, 0x1e0000
    buffer_load_dwordx4 v2, s[52:55], s64 offen lds
    s_add_u32 m0, s25, 50176
    s_add_u32 s64, s26, 0x1ea000
    buffer_load_dwordx4 v2, s[52:55], s64 offen lds
    s_add_u32 m0, s25, 51200
    s_add_u32 s64, s26, 0x1f4000
    buffer_load_dwordx4 v2, s[52:55], s64 offen lds
    s_add_u32 m0, s25, 52224
    s_add_u32 s64, s26, 0x1fe000
    buffer_load_dwordx4 v2, s[52:55], s64 offen lds
    s_add_u32 m0, s25, 53248
    s_add_u32 s64, s26, 0x208000
    buffer_load_dwordx4 v2, s[52:55], s64 offen lds
    s_add_u32 m0, s25, 54272
    s_add_u32 s64, s26, 0x212000
    buffer_load_dwordx4 v2, s[52:55], s64 offen lds
    s_waitcnt vmcnt(0)
    ds_read_b64_tr_b16 v[232:233], v3 offset:0
    ds_read_b64_tr_b16 v[234:235], v3 offset:512
    s_waitcnt lgkmcnt(0)
    v_mfma_f32_16x16x32_bf16 v[8:11], v[232:235], v[16:19], 0
    ds_read_b64_tr_b16 v[236:237], v3 offset:1024
    ds_read_b64_tr_b16 v[238:239], v3 offset:1536
    s_waitcnt lgkmcnt(0)
    v_mfma_f32_16x16x32_bf16 v[8:11], v[236:239], v[20:23], v[8:11]
    ds_read_b64_tr_b16 v[240:241], v3 offset:2048
    ds_read_b64_tr_b16 v[242:243], v3 offset:2560
    s_waitcnt lgkmcnt(0)
    v_mfma_f32_16x16x32_bf16 v[8:11], v[240:243], v[24:27], v[8:11]
    ds_read_b64_tr_b16 v[244:245], v3 offset:3072
    ds_read_b64_tr_b16 v[246:247], v3 offset:3584
    s_waitcnt lgkmcnt(0)
    v_mfma_f32_16x16x32_bf16 v[8:11], v[244:247], v[28:31], v[8:11]
    ds_read_b64_tr_b16 v[232:233], v3 offset:4096
    ds_read_b64_tr_b16 v[234:235], v3 offset:4608
    s_waitcnt lgkmcnt(0)
    v_mfma_f32_16x16x32_bf16 v[8:11], v[232:235], v[32:35], v[8:11]
    ds_read_b64_tr_b16 v[236:237], v3 offset:5120
    ds_read_b64_tr_b16 v[238:239], v3 offset:5632
    s_waitcnt lgkmcnt(0)
    v_mfma_f32_16x16x32_bf16 v[8:11], v[236:239], v[36:39], v[8:11]
    ds_read_b64_tr_b16 v[240:241], v3 offset:6144
    ds_read_b64_tr_b16 v[242:243], v3 offset:6656
    s_waitcnt lgkmcnt(0)
    v_mfma_f32_16x16x32_bf16 v[8:11], v[240:243], v[40:43], v[8:11]
    ds_read_b64_tr_b16 v[244:245], v3 offset:7168
    ds_read_b64_tr_b16 v[246:247], v3 offset:7680
    s_waitcnt lgkmcnt(0)
    v_mfma_f32_16x16x32_bf16 v[8:11], v[244:247], v[44:47], v[8:11]
    ds_read_b64_tr_b16 v[232:233], v3 offset:8192
    ds_read_b64_tr_b16 v[234:235], v3 offset:8704
    s_waitcnt lgkmcnt(0)
    v_mfma_f32_16x16x32_bf16 v[8:11], v[232:235], v[48:51], v[8:11]
    ds_read_b64_tr_b16 v[236:237], v3 offset:9216
    ds_read_b64_tr_b16 v[238:239], v3 offset:9728
    s_waitcnt lgkmcnt(0)
    v_mfma_f32_16x16x32_bf16 v[8:11], v[236:239], v[52:55], v[8:11]
    ds_read_b64_tr_b16 v[240:241], v3 offset:10240
    ds_read_b64_tr_b16 v[242:243], v3 offset:10752
    s_waitcnt lgkmcnt(0)
    v_mfma_f32_16x16x32_bf16 v[8:11], v[240:243], v[56:59], v[8:11]
    ds_read_b64_tr_b16 v[244:245], v3 offset:11264
    ds_read_b64_tr_b16 v[246:247], v3 offset:11776
    s_waitcnt lgkmcnt(0)
    v_mfma_f32_16x16x32_bf16 v[8:11], v[244:247], v[60:63], v[8:11]
    ds_read_b64_tr_b16 v[232:233], v3 offset:12288
    ds_read_b64_tr_b16 v[234:235], v3 offset:12800
    s_waitcnt lgkmcnt(0)
    v_mfma_f32_16x16x32_bf16 v[8:11], v[232:235], v[64:67], v[8:11]
    ds_read_b64_tr_b16 v[236:237], v3 offset:13312
    ds_read_b64_tr_b16 v[238:239], v3 offset:13824
    s_waitcnt lgkmcnt(0)
    v_mfma_f32_16x16x32_bf16 v[8:11], v[236:239], v[68:71], v[8:11]
    ds_read_b64_tr_b16 v[240:241], v3 offset:14336
    ds_read_b64_tr_b16 v[242:243], v3 offset:14848
    s_waitcnt lgkmcnt(0)
    v_mfma_f32_16x16x32_bf16 v[8:11], v[240:243], v[72:75], v[8:11]
    ds_read_b64_tr_b16 v[244:245], v3 offset:15360
    ds_read_b64_tr_b16 v[246:247], v3 offset:15872
    s_waitcnt lgkmcnt(0)
    v_mfma_f32_16x16x32_bf16 v[8:11], v[244:247], v[76:79], v[8:11]
    ds_read_b64_tr_b16 v[232:233], v3 offset:16384
    ds_read_b64_tr_b16 v[234:235], v3 offset:16896
    s_waitcnt lgkmcnt(0)
    v_mfma_f32_16x16x32_bf16 v[8:11], v[232:235], v[80:83], v[8:11]
    ds_read_b64_tr_b16 v[236:237], v3 offset:17408
    ds_read_b64_tr_b16 v[238:239], v3 offset:17920
    s_waitcnt lgkmcnt(0)
    v_mfma_f32_16x16x32_bf16 v[8:11], v[236:239], v[84:87], v[8:11]
    ds_read_b64_tr_b16 v[240:241], v3 offset:18432
    ds_read_b64_tr_b16 v[242:243], v3 offset:18944
    s_waitcnt lgkmcnt(0)
    v_mfma_f32_16x16x32_bf16 v[8:11], v[240:243], v[88:91], v[8:11]
    ds_read_b64_tr_b16 v[244:245], v3 offset:19456
    ds_read_b64_tr_b16 v[246:247], v3 offset:19968
    s_waitcnt lgkmcnt(0)
    v_mfma_f32_16x16x32_bf16 v[8:11], v[244:247], v[92:95], v[8:11]
    ds_read_b64_tr_b16 v[232:233], v3 offset:20480
    ds_read_b64_tr_b16 v[234:235], v3 offset:20992
    s_waitcnt lgkmcnt(0)
    v_mfma_f32_16x16x32_bf16 v[8:11], v[232:235], v[96:99], v[8:11]
    ds_read_b64_tr_b16 v[236:237], v3 offset:21504
    ds_read_b64_tr_b16 v[238:239], v3 offset:22016
    s_waitcnt lgkmcnt(0)
    v_mfma_f32_16x16x32_bf16 v[8:11], v[236:239], v[100:103], v[8:11]
    ds_read_b64_tr_b16 v[240:241], v3 offset:22528
    ds_read_b64_tr_b16 v[242:243], v3 offset:23040
    s_waitcnt lgkmcnt(0)
    v_mfma_f32_16x16x32_bf16 v[8:11], v[240:243], v[104:107], v[8:11]
    ds_read_b64_tr_b16 v[244:245], v3 offset:23552
    ds_read_b64_tr_b16 v[246:247], v3 offset:24064
    s_waitcnt lgkmcnt(0)
    v_mfma_f32_16x16x32_bf16 v[8:11], v[244:247], v[108:111], v[8:11]
    ds_read_b64_tr_b16 v[232:233], v3 offset:24576
    ds_read_b64_tr_b16 v[234:235], v3 offset:25088
    s_waitcnt lgkmcnt(0)
    v_mfma_f32_16x16x32_bf16 v[8:11], v[232:235], v[112:115], v[8:11]
    ds_read_b64_tr_b16 v[236:237], v3 offset:25600
    ds_read_b64_tr_b16 v[238:239], v3 offset:26112
    s_waitcnt lgkmcnt(0)
    v_mfma_f32_16x16x32_bf16 v[8:11], v[236:239], v[116:119], v[8:11]
    ds_read_b64_tr_b16 v[240:241], v3 offset:26624
    ds_read_b64_tr_b16 v[242:243], v3 offset:27136
    s_waitcnt lgkmcnt(0)
    v_mfma_f32_16x16x32_bf16 v[8:11], v[240:243], v[120:123], v[8:11]
    ds_read_b64_tr_b16 v[244:245], v3 offset:27648
    ds_read_b64_tr_b16 v[246:247], v3 offset:28160
    s_waitcnt lgkmcnt(0)
    v_mfma_f32_16x16x32_bf16 v[8:11], v[244:247], v[124:127], v[8:11]
    ds_read_b64_tr_b16 v[232:233], v3 offset:28672
    ds_read_b64_tr_b16 v[234:235], v3 offset:29184
    s_waitcnt lgkmcnt(0)
    v_mfma_f32_16x16x32_bf16 v[8:11], v[232:235], v[128:131], v[8:11]
    ds_read_b64_tr_b16 v[236:237], v3 offset:29696
    ds_read_b64_tr_b16 v[238:239], v3 offset:30208
    s_waitcnt lgkmcnt(0)
    v_mfma_f32_16x16x32_bf16 v[8:11], v[236:239], v[132:135], v[8:11]
    ds_read_b64_tr_b16 v[240:241], v3 offset:30720
    ds_read_b64_tr_b16 v[242:243], v3 offset:31232
    s_waitcnt lgkmcnt(0)
    v_mfma_f32_16x16x32_bf16 v[8:11], v[240:243], v[136:139], v[8:11]
    ds_read_b64_tr_b16 v[244:245], v3 offset:31744
    ds_read_b64_tr_b16 v[246:247], v3 offset:32256
    s_waitcnt lgkmcnt(0)
    v_mfma_f32_16x16x32_bf16 v[8:11], v[244:247], v[140:143], v[8:11]
    ds_read_b64_tr_b16 v[232:233], v3 offset:32768
    ds_read_b64_tr_b16 v[234:235], v3 offset:33280
    s_waitcnt lgkmcnt(0)
    v_mfma_f32_16x16x32_bf16 v[8:11], v[232:235], v[144:147], v[8:11]
    ds_read_b64_tr_b16 v[236:237], v3 offset:33792
    ds_read_b64_tr_b16 v[238:239], v3 offset:34304
    s_waitcnt lgkmcnt(0)
    v_mfma_f32_16x16x32_bf16 v[8:11], v[236:239], v[148:151], v[8:11]
    ds_read_b64_tr_b16 v[240:241], v3 offset:34816
    ds_read_b64_tr_b16 v[242:243], v3 offset:35328
    s_waitcnt lgkmcnt(0)
    v_mfma_f32_16x16x32_bf16 v[8:11], v[240:243], v[152:155], v[8:11]
    ds_read_b64_tr_b16 v[244:245], v3 offset:35840
    ds_read_b64_tr_b16 v[246:247], v3 offset:36352
    s_waitcnt lgkmcnt(0)
    v_mfma_f32_16x16x32_bf16 v[8:11], v[244:247], v[156:159], v[8:11]
    ds_read_b64_tr_b16 v[232:233], v3 offset:36864
    ds_read_b64_tr_b16 v[234:235], v3 offset:37376
    s_waitcnt lgkmcnt(0)
    v_mfma_f32_16x16x32_bf16 v[8:11], v[232:235], v[160:163], v[8:11]
    ds_read_b64_tr_b16 v[236:237], v3 offset:37888
    ds_read_b64_tr_b16 v[238:239], v3 offset:38400
    s_waitcnt lgkmcnt(0)
    v_mfma_f32_16x16x32_bf16 v[8:11], v[236:239], v[164:167], v[8:11]
    ds_read_b64_tr_b16 v[240:241], v3 offset:38912
    ds_read_b64_tr_b16 v[242:243], v3 offset:39424
    s_waitcnt lgkmcnt(0)
    v_mfma_f32_16x16x32_bf16 v[8:11], v[240:243], v[168:171], v[8:11]
    ds_read_b64_tr_b16 v[244:245], v3 offset:39936
    ds_read_b64_tr_b16 v[246:247], v3 offset:40448
    s_waitcnt lgkmcnt(0)
    v_mfma_f32_16x16x32_bf16 v[8:11], v[244:247], v[172:175], v[8:11]
    ds_read_b64_tr_b16 v[232:233], v3 offset:40960
    ds_read_b64_tr_b16 v[234:235], v3 offset:41472
    s_waitcnt lgkmcnt(0)
    v_mfma_f32_16x16x32_bf16 v[8:11], v[232:235], v[176:179], v[8:11]
    ds_read_b64_tr_b16 v[236:237], v3 offset:41984
    ds_read_b64_tr_b16 v[238:239], v3 offset:42496
    s_waitcnt lgkmcnt(0)
    v_mfma_f32_16x16x32_bf16 v[8:11], v[236:239], v[180:183], v[8:11]
    ds_read_b64_tr_b16 v[240:241], v3 offset:43008
    ds_read_b64_tr_b16 v[242:243], v3 offset:43520
    s_waitcnt lgkmcnt(0)
    v_mfma_f32_16x16x32_bf16 v[8:11], v[240:243], v[184:187], v[8:11]
    ds_read_b64_tr_b16 v[244:245], v3 offset:44032
    ds_read_b64_tr_b16 v[246:247], v3 offset:44544
    s_waitcnt lgkmcnt(0)
    v_mfma_f32_16x16x32_bf16 v[8:11], v[244:247], v[188:191], v[8:11]
    ds_read_b64_tr_b16 v[232:233], v3 offset:45056
    ds_read_b64_tr_b16 v[234:235], v3 offset:45568
    s_waitcnt lgkmcnt(0)
    v_mfma_f32_16x16x32_bf16 v[8:11], v[232:235], v[192:195], v[8:11]
    ds_read_b64_tr_b16 v[236:237], v3 offset:46080
    ds_read_b64_tr_b16 v[238:239], v3 offset:46592
    s_waitcnt lgkmcnt(0)
    v_mfma_f32_16x16x32_bf16 v[8:11], v[236:239], v[196:199], v[8:11]
    ds_read_b64_tr_b16 v[240:241], v3 offset:47104
    ds_read_b64_tr_b16 v[242:243], v3 offset:47616
    s_waitcnt lgkmcnt(0)
    v_mfma_f32_16x16x32_bf16 v[8:11], v[240:243], v[200:203], v[8:11]
    ds_read_b64_tr_b16 v[244:245], v3 offset:48128
    ds_read_b64_tr_b16 v[246:247], v3 offset:48640
    s_waitcnt lgkmcnt(0)
    v_mfma_f32_16x16x32_bf16 v[8:11], v[244:247], v[204:207], v[8:11]
    ds_read_b64_tr_b16 v[232:233], v3 offset:49152
    ds_read_b64_tr_b16 v[234:235], v3 offset:49664
    s_waitcnt lgkmcnt(0)
    v_mfma_f32_16x16x32_bf16 v[8:11], v[232:235], v[208:211], v[8:11]
    ds_read_b64_tr_b16 v[236:237], v3 offset:50176
    ds_read_b64_tr_b16 v[238:239], v3 offset:50688
    s_waitcnt lgkmcnt(0)
    v_mfma_f32_16x16x32_bf16 v[8:11], v[236:239], v[212:215], v[8:11]
    ds_read_b64_tr_b16 v[240:241], v3 offset:51200
    ds_read_b64_tr_b16 v[242:243], v3 offset:51712
    s_waitcnt lgkmcnt(0)
    v_mfma_f32_16x16x32_bf16 v[8:11], v[240:243], v[216:219], v[8:11]
    ds_read_b64_tr_b16 v[244:245], v3 offset:52224
    ds_read_b64_tr_b16 v[246:247], v3 offset:52736
    s_waitcnt lgkmcnt(0)
    v_mfma_f32_16x16x32_bf16 v[8:11], v[244:247], v[220:223], v[8:11]
    ds_read_b64_tr_b16 v[232:233], v3 offset:53248
    ds_read_b64_tr_b16 v[234:235], v3 offset:53760
    s_waitcnt lgkmcnt(0)
    v_mfma_f32_16x16x32_bf16 v[8:11], v[232:235], v[224:227], v[8:11]
    ds_read_b64_tr_b16 v[236:237], v3 offset:54272
    ds_read_b64_tr_b16 v[238:239], v3 offset:54784
    s_waitcnt lgkmcnt(0)
    v_mfma_f32_16x16x32_bf16 v[8:11], v[236:239], v[228:231], v[8:11]
    v_and_b32 v7, 7, v0
    v_lshlrev_b32 v7, 2, v7
    s_mov_b32 s64, 0x5400020
    buffer_load_dword v12, v7, s[4:7], s64 offen sc1
    s_waitcnt vmcnt(0)
    s_nop 7
    v_cvt_pk_bf16_f32 v8, v8, v8
    v_lshlrev_b32 v8, 16, v8
    v_mul_f32 v8, v8, v12
    v_cvt_pk_bf16_f32 v8, v8, v8
    v_lshlrev_b32 v8, 16, v8
    v_cvt_pk_bf16_f32 v9, v9, v9
    v_lshlrev_b32 v9, 16, v9
    v_mul_f32 v9, v9, v12
    v_cvt_pk_bf16_f32 v9, v9, v9
    v_lshlrev_b32 v9, 16, v9
    v_cvt_pk_bf16_f32 v10, v10, v10
    v_lshlrev_b32 v10, 16, v10
    v_mul_f32 v10, v10, v12
    v_cvt_pk_bf16_f32 v10, v10, v10
    v_lshlrev_b32 v10, 16, v10
    v_cvt_pk_bf16_f32 v11, v11, v11
    v_lshlrev_b32 v11, 16, v11
    v_mul_f32 v11, v11, v12
    v_cvt_pk_bf16_f32 v11, v11, v11
    v_lshlrev_b32 v11, 16, v11
    v_and_b32 v7, 7, v0
    v_mul_u32_u24 v7, 2560, v7
    v_lshrrev_b32 v13, 4, v0
    v_lshl_add_u32 v7, v13, 4, v7
    s_lshl_b32 s64, s24, 6
    s_add_u32 s64, s64, 0x5410000
    s_mov_b32 s68, 0x00ff00ff
    s_mov_b32 s69, 0x00ff00ff
    s_mov_b64 exec, s[68:69]
    buffer_store_dwordx4 v[8:11], v7, s[4:7], s64 offen sc1
    s_mov_b64 exec, -1
    s_waitcnt vmcnt(0)
    v_mov_b32 v7, 1
    v_mov_b32 v8, 0
    s_mov_b32 s64, 0x298100
    s_mov_b64 exec, 1
    buffer_atomic_add v7, v8, s[4:7], s64 offen sc1
    s_mov_b64 exec, -1
H_ATT:
    v_mbcnt_lo_u32_b32 v0, -1, 0
    v_mbcnt_hi_u32_b32 v0, -1, v0
    s_mov_b32 s29, 0
    v_lshlrev_b32 v1, 4, v0
    v_lshrrev_b32 v5, 4, v0
    v_lshlrev_b32 v2, 7, v5
    v_and_b32 v5, 7, v0
    v_lshl_add_u32 v2, v5, 4, v2
    v_bfe_u32 v5, v0, 4, 1
    v_lshlrev_b32 v3, 7, v5
    v_and_b32 v5, 15, v0
    v_lshl_add_u32 v3, v5, 3, v3
    s_mov_b32 s34, 0x3e0293ee
    s_mov_b32 s35, 0x3e0293ee
    s_mov_b32 s36, -1
    s_mov_b32 s37, 0
    v_lshrrev_b32 v5, 4, v0
    v_lshlrev_b32 v5, 2, v5
    v_and_b32 v6, 15, v0
    v_add_u32 v7, 0, v5
    v_cmp_le_u32 s[38:39], v7, v6
    v_add_u32 v7, 1, v5
    v_cmp_le_u32 s[40:41], v7, v6
    v_add_u32 v7, 2, v5
    v_cmp_le_u32 s[42:43], v7, v6
    v_add_u32 v7, 3, v5
    v_cmp_le_u32 s[44:45], v7, v6
    v_mov_b32 v248, 0x3f803f80
    v_mov_b32 v249, 0x3f803f80
    v_mov_b32 v250, 0x3f803f80
    v_mov_b32 v251, 0x3f803f80
    s_lshl_b32 s24, s12, 2
    s_add_u32 s24, s24, s14
    s_add_u32 s24, s24, 16
    s_mov_b32 s25, 2
AT2_LOOP:
    s_cmp_eq_u32 s24, 63
    s_cbranch_scc1 AT2_END
    s_lshl_b32 s64, s24, 5
    s_add_u32 s64, s64, s13
    s_lshl_b32 s26, s64, 13
    s_add_u32 s26, s26, 0x3400000
    s_lshl_b32 s27, s64, 14
    s_add_u32 s27, s27, 0x1400000
    s_lshl_b32 s65, s64, 11
    s_add_u32 s30, s65, 0x640000
    s_add_u32 s31, s65, 0xa40000
    s_lshl_b32 s33, s64, 2
    s_add_u32 s33, s33, 0x296000
    s_lshl_b32 s32, s24, 18
    s_lshl_b32 s65, s13, 12
    s_add_u32 s32, s32, s65
    s_add_u32 s32, s32, 0x4400000
    s_lshr_b32 s65, s24, 2
    s_lshl_b32 s65, s65, 9
    s_lshl_b32 s66, s13, 4
    s_add_u32 s65, s65, s66
    s_add_u32 s65, s65, 0x291000
    s_lshr_b32 s66, s24, 1
    s_lshl_b32 s66, s66, 8
    s_lshl_b32 s64, s13, 3
    s_add_u32 s66, s66, s64
    s_add_u32 s66, s66, 0x293ff4
    v_lshlrev_b32 v5, 2, v0
    v_mov_b32 v6, s65
    v_mov_b32 v7, s66
    v_cmp_gt_u32 vcc, 3, v0
    s_nop 1
    v_cndmask_b32 v6, v7, v6, vcc
    v_add_u32 v4, v5, v6
    s_mov_b32 s64, 0
    s_mov_b64 exec, 7
AT2_F_192:
    buffer_load_dword v5, v4, s[4:7], s64 offen sc1
    s_add_u32 s29, s29, 1
    s_waitcnt vmcnt(0)
    v_cmp_eq_u32 vcc, 0, v5
    s_cbranch_vccz AT2_FD_193
    s_cmp_gt_u32 s29, 262144
    s_cbranch_scc1 AT2_FD_193
    s_sleep 1
    s_branch AT2_F_192
AT2_FD_193:
    s_mov_b64 exec, -1
    buffer_load_dwordx4 v[16:19], v1, s[4:7], s26 offen offset:0
    buffer_load_dwordx4 v[20:23], v1, s[4:7], s26 offen offset:1024
    buffer_load_dwordx4 v[24:27], v1, s[4:7], s26 offen offset:2048
    buffer_load_dwordx4 v[28:31], v1, s[4:7], s26 offen offset:3072
    s_add_u32 s26, s26, 4096
    buffer_load_dwordx4 v[32:35], v1, s[4:7], s26 offen offset:0
    buffer_load_dwordx4 v[36:39], v1, s[4:7], s26 offen offset:1024
    buffer_load_dwordx4 v[40:43], v1, s[4:7], s26 offen offset:2048
    buffer_load_dwordx4 v[44:47], v1, s[4:7], s26 offen offset:3072
    buffer_load_dwordx4 v[48:51], v1, s[4:7], s27 offen offset:0
    buffer_load_dwordx4 v[52:55], v1, s[4:7], s27 offen offset:1024
    buffer_load_dwordx4 v[56:59], v1, s[4:7], s27 offen offset:2048
    buffer_load_dwordx4 v[60:63], v1, s[4:7], s27 offen offset:3072
    s_add_u32 s27, s27, 4096
    buffer_load_dwordx4 v[64:67], v1, s[4:7], s27 offen offset:0
    buffer_load_dwordx4 v[68:71], v1, s[4:7], s27 offen offset:1024
    buffer_load_dwordx4 v[72:75], v1, s[4:7], s27 offen offset:2048
    buffer_load_dwordx4 v[76:79], v1, s[4:7], s27 offen offset:3072
    s_add_u32 s27, s27, 4096
    buffer_load_dwordx4 v[80:83], v1, s[4:7], s27 offen offset:0
    buffer_load_dwordx4 v[84:87], v1, s[4:7], s27 offen offset:1024
    buffer_load_dwordx4 v[88:91], v1, s[4:7], s27 offen offset:2048
    buffer_load_dwordx4 v[92:95], v1, s[4:7], s27 offen offset:3072
    s_add_u32 s27, s27, 4096
    buffer_load_dwordx4 v[96:99], v1, s[4:7], s27 offen offset:0
    buffer_load_dwordx4 v[100:103], v1, s[4:7], s27 offen offset:1024
    buffer_load_dwordx4 v[104:107], v1, s[4:7], s27 offen offset:2048
    buffer_load_dwordx4 v[108:111], v1, s[4:7], s27 offen offset:3072
    s_mov_b64 exec, 0x18
AT2_G_194:
    buffer_load_dword v5, v4, s[4:7], s64 offen sc1
    s_add_u32 s29, s29, 1
    s_waitcnt vmcnt(0)
    v_cmp_eq_u32 vcc, 0, v5
    s_cbranch_vccz AT2_GD_195
    s_cmp_gt_u32 s29, 262144
    s_cbranch_scc1 AT2_GD_195
    s_sleep 1
    s_branch AT2_G_194
AT2_GD_195:
    s_mov_b64 exec, -1
    buffer_load_dwordx4 v[112:115], v2, s[4:7], s30 offen offset:0
    buffer_load_dwordx4 v[116:119], v2, s[4:7], s30 offen offset:512
    buffer_load_dwordx4 v[120:123], v2, s[4:7], s30 offen offset:1024
    buffer_load_dwordx4 v[124:127], v2, s[4:7], s30 offen offset:1536
    buffer_load_dwordx2 v[128:129], v3, s[4:7], s31 offen offset:0
    buffer_load_dwordx2 v[130:131], v3, s[4:7], s31 offen offset:256
    buffer_load_dwordx2 v[132:133], v3, s[4:7], s31 offen offset:512
    buffer_load_dwordx2 v[134:135], v3, s[4:7], s31 offen offset:768
    buffer_load_dwordx2 v[136:137], v3, s[4:7], s31 offen offset:1024
    buffer_load_dwordx2 v[138:139], v3, s[4:7], s31 offen offset:1280
    buffer_load_dwordx2 v[140:141], v3, s[4:7], s31 offen offset:1536
    buffer_load_dwordx2 v[142:143], v3, s[4:7], s31 offen offset:1792
    v_mfma_f32_16x16x32_bf16 v[148:151], v[48:51], v[16:19], 0
    v_mfma_f32_16x16x32_bf16 v[156:159], v[48:51], v[32:35], 0
    v_mfma_f32_16x16x32_bf16 v[160:163], v[64:67], v[32:35], 0
    v_mfma_f32_16x16x32_bf16 v[148:151], v[52:55], v[20:23], v[148:151]
    v_mfma_f32_16x16x32_bf16 v[156:159], v[52:55], v[36:39], v[156:159]
    v_mfma_f32_16x16x32_bf16 v[160:163], v[68:71], v[36:39], v[160:163]
    v_mfma_f32_16x16x32_bf16 v[148:151], v[56:59], v[24:27], v[148:151]
    v_mfma_f32_16x16x32_bf16 v[156:159], v[56:59], v[40:43], v[156:159]
    v_mfma_f32_16x16x32_bf16 v[160:163], v[72:75], v[40:43], v[160:163]
    v_mfma_f32_16x16x32_bf16 v[148:151], v[60:63], v[28:31], v[148:151]
    v_mfma_f32_16x16x32_bf16 v[156:159], v[60:63], v[44:47], v[156:159]
    v_mfma_f32_16x16x32_bf16 v[160:163], v[76:79], v[44:47], v[160:163]
    s_waitcnt vmcnt(8)
    v_mfma_f32_16x16x32_bf16 v[144:147], v[112:115], v[16:19], 0
    v_mfma_f32_16x16x32_bf16 v[152:155], v[112:115], v[32:35], 0
    v_mfma_f32_16x16x32_bf16 v[144:147], v[116:119], v[20:23], v[144:147]
    v_mfma_f32_16x16x32_bf16 v[152:155], v[116:119], v[36:39], v[152:155]
    v_mfma_f32_16x16x32_bf16 v[144:147], v[120:123], v[24:27], v[144:147]
    v_mfma_f32_16x16x32_bf16 v[152:155], v[120:123], v[40:43], v[152:155]
    v_mfma_f32_16x16x32_bf16 v[144:147], v[124:127], v[28:31], v[144:147]
    v_mfma_f32_16x16x32_bf16 v[152:155], v[124:127], v[44:47], v[152:155]
    v_mov_b32 v11, 0xff800000
    s_nop 7
    v_cndmask_b32 v148, v11, v148, s[38:39]
    v_cndmask_b32 v160, v11, v160, s[38:39]
    v_cndmask_b32 v144, v11, v144, s[36:37]
    v_cndmask_b32 v152, v11, v152, s[36:37]
    v_cndmask_b32 v149, v11, v149, s[40:41]
    v_cndmask_b32 v161, v11, v161, s[40:41]
    v_cndmask_b32 v145, v11, v145, s[36:37]
    v_cndmask_b32 v153, v11, v153, s[36:37]
    v_cndmask_b32 v150, v11, v150, s[42:43]
    v_cndmask_b32 v162, v11, v162, s[42:43]
    v_cndmask_b32 v146, v11, v146, s[36:37]
    v_cndmask_b32 v154, v11, v154, s[36:37]
    v_cndmask_b32 v151, v11, v151, s[44:45]
    v_cndmask_b32 v163, v11, v163, s[44:45]
    v_cndmask_b32 v147, v11, v147, s[36:37]
    v_cndmask_b32 v155, v11, v155, s[36:37]
    v_max3_f32 v8, v144, v145, v146
    v_max3_f32 v8, v8, v147, v148
    v_max3_f32 v8, v8, v149, v150
    v_max_f32 v8, v8, v151
    v_mov_b32 v9, v8
    s_nop 1
    v_permlane16_swap_b32 v8, v9
    v_max_f32 v8, v8, v9
    v_mov_b32 v9, v8
    s_nop 1
    v_permlane32_swap_b32 v8, v9
    v_max_f32 v8, v8, v9
    v_mul_f32 v8, s34, v8
    v_fma_f32 v144, v144, s34, -v8
    v_fma_f32 v145, v145, s34, -v8
    v_fma_f32 v146, v146, s34, -v8
    v_fma_f32 v147, v147, s34, -v8
    v_fma_f32 v148, v148, s34, -v8
    v_fma_f32 v149, v149, s34, -v8
    v_fma_f32 v150, v150, s34, -v8
    v_fma_f32 v151, v151, s34, -v8
    v_exp_f32 v144, v144
    v_exp_f32 v145, v145
    v_exp_f32 v146, v146
    v_exp_f32 v147, v147
    v_exp_f32 v148, v148
    v_exp_f32 v149, v149
    v_exp_f32 v150, v150
    v_exp_f32 v151, v151
    s_nop 0
    v_cvt_pk_bf16_f32 v164, v148, v149
    v_cvt_pk_bf16_f32 v165, v150, v151
    v_mov_b32 v166, 0
    v_mov_b32 v167, 0
    v_cvt_pk_bf16_f32 v168, v144, v145
    v_cvt_pk_bf16_f32 v169, v146, v147
    v_max3_f32 v8, v152, v153, v154
    v_max3_f32 v8, v8, v155, v156
    v_max3_f32 v8, v8, v157, v158
    v_max3_f32 v8, v8, v159, v160
    v_max3_f32 v8, v8, v161, v162
    v_max_f32 v8, v8, v163
    v_mov_b32 v9, v8
    s_nop 1
    v_permlane16_swap_b32 v8, v9
    v_max_f32 v8, v8, v9
    v_mov_b32 v9, v8
    s_nop 1
    v_permlane32_swap_b32 v8, v9
    v_max_f32 v8, v8, v9
    v_mul_f32 v8, s34, v8
    v_fma_f32 v152, v152, s34, -v8
    v_fma_f32 v153, v153, s34, -v8
    v_fma_f32 v154, v154, s34, -v8
    v_fma_f32 v155, v155, s34, -v8
    v_fma_f32 v156, v156, s34, -v8
    v_fma_f32 v157, v157, s34, -v8
    v_fma_f32 v158, v158, s34, -v8
    v_fma_f32 v159, v159, s34, -v8
    v_fma_f32 v160, v160, s34, -v8
    v_fma_f32 v161, v161, s34, -v8
    v_fma_f32 v162, v162, s34, -v8
    v_fma_f32 v163, v163, s34, -v8
    v_exp_f32 v152, v152
    v_exp_f32 v153, v153
    v_exp_f32 v154, v154
    v_exp_f32 v155, v155
    v_exp_f32 v156, v156
    v_exp_f32 v157, v157
    v_exp_f32 v158, v158
    v_exp_f32 v159, v159
    v_exp_f32 v160, v160
    v_exp_f32 v161, v161
    v_exp_f32 v162, v162
    v_exp_f32 v163, v163
    s_nop 0
    v_cvt_pk_bf16_f32 v170, v156, v157
    v_cvt_pk_bf16_f32 v171, v158, v159
    v_cvt_pk_bf16_f32 v172, v160, v161
    v_cvt_pk_bf16_f32 v173, v162, v163
    v_cvt_pk_bf16_f32 v174, v152, v153
    v_cvt_pk_bf16_f32 v175, v154, v155
    s_waitcnt vmcnt(0)
    v_mfma_f32_16x16x32_bf16 v[240:243], v[248:251], v[164:167], 0
    v_mfma_f32_16x16x32_bf16 v[244:247], v[248:251], v[170:173], 0
    v_mfma_f32_16x16x32_bf16 v[176:179], v[80:83], v[164:167], 0
    v_mfma_f32_16x16x32_bf16 v[180:183], v[80:83], v[170:173], 0
    v_mfma_f32_16x16x32_bf16 v[184:187], v[84:87], v[164:167], 0
    v_mfma_f32_16x16x32_bf16 v[188:191], v[84:87], v[170:173], 0
    v_mfma_f32_16x16x32_bf16 v[192:195], v[88:91], v[164:167], 0
    v_mfma_f32_16x16x32_bf16 v[196:199], v[88:91], v[170:173], 0
    v_mfma_f32_16x16x32_bf16 v[200:203], v[92:95], v[164:167], 0
    v_mfma_f32_16x16x32_bf16 v[204:207], v[92:95], v[170:173], 0
    v_mfma_f32_16x16x32_bf16 v[208:211], v[96:99], v[164:167], 0
    v_mfma_f32_16x16x32_bf16 v[212:215], v[96:99], v[170:173], 0
    v_mfma_f32_16x16x32_bf16 v[216:219], v[100:103], v[164:167], 0
    v_mfma_f32_16x16x32_bf16 v[220:223], v[100:103], v[170:173], 0
    v_mfma_f32_16x16x32_bf16 v[224:227], v[104:107], v[164:167], 0
    v_mfma_f32_16x16x32_bf16 v[228:231], v[104:107], v[170:173], 0
    v_mfma_f32_16x16x32_bf16 v[232:235], v[108:111], v[164:167], 0
    v_mfma_f32_16x16x32_bf16 v[236:239], v[108:111], v[170:173], 0
    v_mfma_f32_16x16x16_bf16 v[240:243], v[248:249], v[168:169], v[240:243]
    v_mfma_f32_16x16x16_bf16 v[244:247], v[248:249], v[174:175], v[244:247]
    v_mfma_f32_16x16x16_bf16 v[176:179], v[128:129], v[168:169], v[176:179]
    v_mfma_f32_16x16x16_bf16 v[180:183], v[128:129], v[174:175], v[180:183]
    v_mfma_f32_16x16x16_bf16 v[184:187], v[130:131], v[168:169], v[184:187]
    v_mfma_f32_16x16x16_bf16 v[188:191], v[130:131], v[174:175], v[188:191]
    v_mfma_f32_16x16x16_bf16 v[192:195], v[132:133], v[168:169], v[192:195]
    v_mfma_f32_16x16x16_bf16 v[196:199], v[132:133], v[174:175], v[196:199]
    v_mfma_f32_16x16x16_bf16 v[200:203], v[134:135], v[168:169], v[200:203]
    v_mfma_f32_16x16x16_bf16 v[204:207], v[134:135], v[174:175], v[204:207]
    v_mfma_f32_16x16x16_bf16 v[208:211], v[136:137], v[168:169], v[208:211]
    v_mfma_f32_16x16x16_bf16 v[212:215], v[136:137], v[174:175], v[212:215]
    v_mfma_f32_16x16x16_bf16 v[216:219], v[138:139], v[168:169], v[216:219]
    v_mfma_f32_16x16x16_bf16 v[220:223], v[138:139], v[174:175], v[220:223]
    v_mfma_f32_16x16x16_bf16 v[224:227], v[140:141], v[168:169], v[224:227]
    v_mfma_f32_16x16x16_bf16 v[228:231], v[140:141], v[174:175], v[228:231]
    v_mfma_f32_16x16x16_bf16 v[232:235], v[142:143], v[168:169], v[232:235]
    v_mfma_f32_16x16x16_bf16 v[236:239], v[142:143], v[174:175], v[236:239]
    v_rcp_f32 v8, v240
    v_rcp_f32 v9, v244
    s_nop 7
    v_mul_f32 v176, v176, v8
    v_mul_f32 v177, v177, v8
    v_mul_f32 v178, v178, v8
    v_mul_f32 v179, v179, v8
    v_cvt_pk_bf16_f32 v16, v176, v177
    v_cvt_pk_bf16_f32 v17, v178, v179
    v_mul_f32 v184, v184, v8
    v_mul_f32 v185, v185, v8
    v_mul_f32 v186, v186, v8
    v_mul_f32 v187, v187, v8
    v_cvt_pk_bf16_f32 v18, v184, v185
    v_cvt_pk_bf16_f32 v19, v186, v187
    s_add_u32 s64, s32, 0x0
    buffer_store_dwordx4 v[16:19], v1, s[4:7], s64 offen offset:0 sc1
    v_mul_f32 v192, v192, v8
    v_mul_f32 v193, v193, v8
    v_mul_f32 v194, v194, v8
    v_mul_f32 v195, v195, v8
    v_cvt_pk_bf16_f32 v20, v192, v193
    v_cvt_pk_bf16_f32 v21, v194, v195
    v_mul_f32 v200, v200, v8
    v_mul_f32 v201, v201, v8
    v_mul_f32 v202, v202, v8
    v_mul_f32 v203, v203, v8
    v_cvt_pk_bf16_f32 v22, v200, v201
    v_cvt_pk_bf16_f32 v23, v202, v203
    s_add_u32 s64, s32, 0x0
    buffer_store_dwordx4 v[20:23], v1, s[4:7], s64 offen offset:1024 sc1
    v_mul_f32 v208, v208, v8
    v_mul_f32 v209, v209, v8
    v_mul_f32 v210, v210, v8
    v_mul_f32 v211, v211, v8
    v_cvt_pk_bf16_f32 v24, v208, v209
    v_cvt_pk_bf16_f32 v25, v210, v211
    v_mul_f32 v216, v216, v8
    v_mul_f32 v217, v217, v8
    v_mul_f32 v218, v218, v8
    v_mul_f32 v219, v219, v8
    v_cvt_pk_bf16_f32 v26, v216, v217
    v_cvt_pk_bf16_f32 v27, v218, v219
    s_add_u32 s64, s32, 0x0
    buffer_store_dwordx4 v[24:27], v1, s[4:7], s64 offen offset:2048 sc1
    v_mul_f32 v224, v224, v8
    v_mul_f32 v225, v225, v8
    v_mul_f32 v226, v226, v8
    v_mul_f32 v227, v227, v8
    v_cvt_pk_bf16_f32 v28, v224, v225
    v_cvt_pk_bf16_f32 v29, v226, v227
    v_mul_f32 v232, v232, v8
    v_mul_f32 v233, v233, v8
    v_mul_f32 v234, v234, v8
    v_mul_f32 v235, v235, v8
    v_cvt_pk_bf16_f32 v30, v232, v233
    v_cvt_pk_bf16_f32 v31, v234, v235
    s_add_u32 s64, s32, 0x0
    buffer_store_dwordx4 v[28:31], v1, s[4:7], s64 offen offset:3072 sc1
    v_mul_f32 v180, v180, v9
    v_mul_f32 v181, v181, v9
    v_mul_f32 v182, v182, v9
    v_mul_f32 v183, v183, v9
    v_cvt_pk_bf16_f32 v32, v180, v181
    v_cvt_pk_bf16_f32 v33, v182, v183
    v_mul_f32 v188, v188, v9
    v_mul_f32 v189, v189, v9
    v_mul_f32 v190, v190, v9
    v_mul_f32 v191, v191, v9
    v_cvt_pk_bf16_f32 v34, v188, v189
    v_cvt_pk_bf16_f32 v35, v190, v191
    s_add_u32 s64, s32, 0x20000
    buffer_store_dwordx4 v[32:35], v1, s[4:7], s64 offen offset:0 sc1
    v_mul_f32 v196, v196, v9
    v_mul_f32 v197, v197, v9
    v_mul_f32 v198, v198, v9
    v_mul_f32 v199, v199, v9
    v_cvt_pk_bf16_f32 v36, v196, v197
    v_cvt_pk_bf16_f32 v37, v198, v199
    v_mul_f32 v204, v204, v9
    v_mul_f32 v205, v205, v9
    v_mul_f32 v206, v206, v9
    v_mul_f32 v207, v207, v9
    v_cvt_pk_bf16_f32 v38, v204, v205
    v_cvt_pk_bf16_f32 v39, v206, v207
    s_add_u32 s64, s32, 0x20000
    buffer_store_dwordx4 v[36:39], v1, s[4:7], s64 offen offset:1024 sc1
    v_mul_f32 v212, v212, v9
    v_mul_f32 v213, v213, v9
    v_mul_f32 v214, v214, v9
    v_mul_f32 v215, v215, v9
    v_cvt_pk_bf16_f32 v40, v212, v213
    v_cvt_pk_bf16_f32 v41, v214, v215
    v_mul_f32 v220, v220, v9
    v_mul_f32 v221, v221, v9
    v_mul_f32 v222, v222, v9
    v_mul_f32 v223, v223, v9
    v_cvt_pk_bf16_f32 v42, v220, v221
    v_cvt_pk_bf16_f32 v43, v222, v223
    s_add_u32 s64, s32, 0x20000
    buffer_store_dwordx4 v[40:43], v1, s[4:7], s64 offen offset:2048 sc1
    v_mul_f32 v228, v228, v9
    v_mul_f32 v229, v229, v9
    v_mul_f32 v230, v230, v9
    v_mul_f32 v231, v231, v9
    v_cvt_pk_bf16_f32 v44, v228, v229
    v_cvt_pk_bf16_f32 v45, v230, v231
    v_mul_f32 v236, v236, v9
    v_mul_f32 v237, v237, v9
    v_mul_f32 v238, v238, v9
    v_mul_f32 v239, v239, v9
    v_cvt_pk_bf16_f32 v46, v236, v237
    v_cvt_pk_bf16_f32 v47, v238, v239
    s_add_u32 s64, s32, 0x20000
    buffer_store_dwordx4 v[44:47], v1, s[4:7], s64 offen offset:3072 sc1
    s_waitcnt vmcnt(0)
    v_mov_b32 v7, 1
    v_mov_b32 v8, 0
    s_mov_b64 exec, 1
    buffer_store_dword v7, v8, s[4:7], s33 offen sc1
    s_mov_b64 exec, -1
    s_add_u32 s24, s24, 8
    s_add_u32 s25, s25, 1
    s_cmp_lt_u32 s25, 8
    s_cbranch_scc1 AT2_LOOP
AT2_END:
M_EXIT:
    s_endpgm
.section .rodata,"a"
.p2align 6
.amdhsa_kernel main_kernel
  .amdhsa_next_free_vgpr 512
  .amdhsa_next_free_sgpr 102
  .amdhsa_accum_offset 256
  .amdhsa_group_segment_fixed_size 0
  .amdhsa_kernarg_size 120
  .amdhsa_user_sgpr_count 2
  .amdhsa_user_sgpr_kernarg_segment_ptr 1
  .amdhsa_system_sgpr_workgroup_id_x 1
.end_amdhsa_kernel
```

```asm
; @launch grid=(256,1,1) block=(256,1,1) lds=163840
.amdgcn_target "amdgcn-amd-amdhsa--gfx950"
.text
.globl recurrent_scan__memory_aug_recurrent_mem_tr__moe_arch_mod__prompt_kernel
.p2align 8
.type recurrent_scan__memory_aug_recurrent_mem_tr__moe_arch_mod__prompt_kernel,@function
recurrent_scan__memory_aug_recurrent_mem_tr__moe_arch_mod__prompt_kernel:
    s_cmp_ge_u32 s2, 256
    s_cbranch_scc1 M_EXIT
    s_load_dwordx2 s[4:5], s[0:1], 112
    s_mov_b32 s6, 0x10000000
    s_mov_b32 s7, 0x00020000
    s_load_dwordx2 s[60:61], s[0:1], 104
    s_mov_b32 s62, 256
    s_mov_b32 s63, 0x00020000
    s_load_dwordx2 s[44:45], s[0:1], 16
    s_mov_b32 s46, 0x500000
    s_mov_b32 s47, 0x00020000
    s_load_dwordx2 s[48:49], s[0:1], 24
    s_mov_b32 s50, 0x500000
    s_mov_b32 s51, 0x00020000
    s_load_dwordx2 s[52:53], s[0:1], 32
    s_mov_b32 s54, 0x500000
    s_mov_b32 s55, 0x00020000
    s_load_dwordx2 s[56:57], s[0:1], 40
    s_mov_b32 s58, 0x500000
    s_mov_b32 s59, 0x00020000
    v_lshrrev_b32 v1, 6, v0
    v_and_b32 v0, 63, v0
    s_nop 0
    v_readfirstlane_b32 s14, v1
    s_getreg_b32 s98, hwreg(HW_REG_XCC_ID)
    s_and_b32 s98, s98, 7
    s_mov_b32 s97, 0
    s_mov_b32 s95, 4
    s_waitcnt lgkmcnt(0)
    s_cmp_lg_u32 s14, 0
    s_cbranch_scc1 NOMEAS_1
    s_and_b32 s64, s2, 0xfffffffd
    s_cmp_lg_u32 s64, 1
    s_cbranch_scc1 NOMEAS_1
    s_lshr_b32 s70, s2, 1
    s_mov_b32 s72, s60
    s_mov_b32 s73, s61
    s_mov_b32 s74, s62
    s_mov_b32 s75, s63
    s_lshl_b32 s60, s70, 21
    s_add_u32 s60, s60, 0x6001800
    v_mov_b32 v60, 0
    v_mov_b32 v61, -1
    s_mov_b32 s66, 0x7fffffff
    s_mov_b32 s67, 0x7fffffff
    s_mov_b32 s68, 0x7fffffff
    s_mov_b32 s69, 0x7fffffff
    s_mov_b64 exec, 1
    s_add_u32 s61, s60, 0
    s_memtime s[62:63]
    s_waitcnt lgkmcnt(0)
    buffer_store_dword v61, v60, s[4:7], s61 offen offset:0 sc1
    s_waitcnt vmcnt(0)
    s_memtime s[64:65]
    s_waitcnt lgkmcnt(0)
    s_sub_u32 s62, s64, s62
    s_min_u32 s66, s66, s62
    s_add_u32 s61, s60, 8192
    s_memtime s[62:63]
    s_waitcnt lgkmcnt(0)
    buffer_store_dword v61, v60, s[4:7], s61 offen offset:0 sc1
    s_waitcnt vmcnt(0)
    s_memtime s[64:65]
    s_waitcnt lgkmcnt(0)
    s_sub_u32 s62, s64, s62
    s_min_u32 s67, s67, s62
    s_add_u32 s61, s60, 16384
    s_memtime s[62:63]
    s_waitcnt lgkmcnt(0)
    buffer_store_dword v61, v60, s[4:7], s61 offen offset:0 sc1
    s_waitcnt vmcnt(0)
    s_memtime s[64:65]
    s_waitcnt lgkmcnt(0)
    s_sub_u32 s62, s64, s62
    s_min_u32 s68, s68, s62
    s_add_u32 s61, s60, 24576
    s_memtime s[62:63]
    s_waitcnt lgkmcnt(0)
    buffer_store_dword v61, v60, s[4:7], s61 offen offset:0 sc1
    s_waitcnt vmcnt(0)
    s_memtime s[64:65]
    s_waitcnt lgkmcnt(0)
    s_sub_u32 s62, s64, s62
    s_min_u32 s69, s69, s62
    s_add_u32 s61, s60, 0
    s_memtime s[62:63]
    s_waitcnt lgkmcnt(0)
    buffer_store_dword v61, v60, s[4:7], s61 offen offset:128 sc1
    s_waitcnt vmcnt(0)
    s_memtime s[64:65]
    s_waitcnt lgkmcnt(0)
    s_sub_u32 s62, s64, s62
    s_min_u32 s66, s66, s62
    s_add_u32 s61, s60, 8192
    s_memtime s[62:63]
    s_waitcnt lgkmcnt(0)
    buffer_store_dword v61, v60, s[4:7], s61 offen offset:128 sc1
    s_waitcnt vmcnt(0)
    s_memtime s[64:65]
    s_waitcnt lgkmcnt(0)
    s_sub_u32 s62, s64, s62
    s_min_u32 s67, s67, s62
    s_add_u32 s61, s60, 16384
    s_memtime s[62:63]
    s_waitcnt lgkmcnt(0)
    buffer_store_dword v61, v60, s[4:7], s61 offen offset:128 sc1
    s_waitcnt vmcnt(0)
    s_memtime s[64:65]
    s_waitcnt lgkmcnt(0)
    s_sub_u32 s62, s64, s62
    s_min_u32 s68, s68, s62
    s_add_u32 s61, s60, 24576
    s_memtime s[62:63]
    s_waitcnt lgkmcnt(0)
    buffer_store_dword v61, v60, s[4:7], s61 offen offset:128 sc1
    s_waitcnt vmcnt(0)
    s_memtime s[64:65]
    s_waitcnt lgkmcnt(0)
    s_sub_u32 s62, s64, s62
    s_min_u32 s69, s69, s62
    s_mov_b64 exec, -1
    s_mov_b32 s60, 0
    s_mov_b32 s61, s66
    s_cmp_lt_u32 s67, s61
    s_cselect_b32 s60, 1, s60
    s_min_u32 s61, s61, s67
    s_cmp_lt_u32 s68, s61
    s_cselect_b32 s60, 2, s60
    s_min_u32 s61, s61, s68
    s_cmp_lt_u32 s69, s61
    s_cselect_b32 s60, 3, s60
    s_min_u32 s61, s61, s69
    s_and_b32 s61, s98, 1
    s_lshl_b32 s61, s61, 1
    s_lshr_b32 s62, s98, 2
    s_add_u32 s61, s61, s62
    s_xor_b32 s60, s60, s61
    s_add_u32 s71, s60, 1
    s_mov_b32 s60, s72
    s_mov_b32 s61, s73
    s_mov_b32 s62, s74
    s_mov_b32 s63, s75
    s_lshl_b32 s70, s70, 2
    s_add_u32 s70, s70, 132
    v_mov_b32 v61, s71
    s_mov_b64 exec, 1
    buffer_store_dword v61, off, s[60:63], s70 sc1
    s_mov_b64 exec, -1
NOMEAS_1:
    s_cmp_eq_u32 s98, 0
    s_cselect_b32 s80, 1, 0
    s_cmp_eq_u32 s98, 2
    s_cselect_b32 s80, 1, s80
    s_mov_b32 s94, 0
    s_lshr_b32 s13, s2, 3
    s_and_b32 s13, s13, 31
    s_cmp_eq_u32 s14, 0
    s_cbranch_scc1 M_TICK0
    s_cmp_eq_u32 s80, 1
    s_cbranch_scc1 M_GUESS
    s_branch M_TICKW
M_TICK0:
    s_mul_i32 s64, s98, 32
    s_add_u32 s64, s64, 0x0
    v_mov_b32 v1, 0
    v_mov_b32 v70, 1
    s_mov_b64 exec, 1
    s_cmp_eq_u32 s98, 0
    s_cselect_b32 s65, 24, 28
    s_cmp_eq_u32 s80, 1
    s_cselect_b32 s65, s65, 0x1000
    s_lshl_b32 s66, 1, s13
    v_mov_b32 v4, s66
    buffer_atomic_or v4, off, s[60:63], s65 sc1
    buffer_atomic_add v70, v1, s[60:63], s64 offen sc0
    s_mov_b64 exec, -1
    s_getpc_b64 s[76:77]
M_PCREF:
    s_cmp_eq_u32 s80, 1
    s_mov_b32 s82, M_REC-M_PCREF
    s_mov_b32 s83, M_HELP-M_PCREF
    s_cselect_b32 s81, s82, s83
    s_mov_b32 s82, M_HELP-M_REC
    s_mov_b32 s83, M_EXIT-M_HELP
    s_cselect_b32 s78, s82, s83
    s_add_u32 s76, s76, s81
    s_addc_u32 s77, s77, 0
    s_and_b32 s77, s77, 0xffff
    s_mov_b32 s79, 0x00020000
    s_lshr_b32 s81, s2, 3
    s_and_b32 s81, s81, 3
    s_lshl_b32 s81, s81, 12
    v_mbcnt_lo_u32_b32 v3, -1, 0
    v_mbcnt_hi_u32_b32 v3, -1, v3
    v_lshlrev_b32 v3, 6, v3
    s_mov_b32 m0, 1024
    s_nop 0
    buffer_load_dword v3, s[76:79], s81 offen lds
    s_add_u32 s81, s81, 16384
    buffer_load_dword v3, s[76:79], s81 offen lds
    s_add_u32 s81, s81, 16384
    buffer_load_dword v3, s[76:79], s81 offen lds
    s_add_u32 s81, s81, 16384
    buffer_load_dword v3, s[76:79], s81 offen lds
    s_add_u32 s81, s81, 16384
    buffer_load_dword v3, s[76:79], s81 offen lds
    s_add_u32 s81, s81, 16384
    s_cmp_eq_u32 s80, 1
    s_cbranch_scc1 M_GUESS
    s_mov_b64 exec, 1
    s_waitcnt vmcnt(5)
    ds_write_b32 v1, v70
    s_waitcnt lgkmcnt(0)
    s_mov_b64 exec, -1
M_TICKW:
    s_barrier
    v_mov_b32 v1, 0
    ds_read_b32 v2, v1
    s_waitcnt lgkmcnt(0)
    v_readfirstlane_b32 s99, v2
    s_barrier
    s_cmp_ge_u32 s99, 32
    s_cbranch_scc1 M_SLOW0
    s_mov_b32 s12, s98
    s_cmp_eq_u32 s12, 0
    s_cbranch_scc1 XOK_2
    s_cmp_eq_u32 s12, 2
    s_cbranch_scc0 M_FH
    s_mov_b32 s12, 1
XOK_2:
    s_mov_b32 s13, s99
    s_branch M_REC
M_FH:
    s_sub_u32 s96, s98, 1
    s_cmp_gt_u32 s98, 2
    s_cselect_b32 s64, 1, 0
    s_sub_u32 s96, s96, s64
    s_lshl_b32 s96, s96, 5
    s_add_u32 s96, s96, s99
    s_branch M_HELP
M_GUESS:
    s_mov_b32 s94, 1
    s_cmp_eq_u32 s98, 0
    s_cselect_b32 s12, 0, 1
    s_branch M_REC
M_GFAIL:
    s_waitcnt vmcnt(0) lgkmcnt(0)
    s_barrier
    s_cmp_lg_u32 s14, 0
    s_cbranch_scc1 M_GF1
    v_mov_b32 v1, 0
    s_mov_b64 exec, 1
    ds_write_b32 v1, v70
    s_waitcnt lgkmcnt(0)
    s_mov_b64 exec, -1
M_GF1:
    s_barrier
    v_mov_b32 v1, 0
    ds_read_b32 v2, v1
    s_waitcnt lgkmcnt(0)
    v_readfirstlane_b32 s99, v2
    s_barrier
    s_mov_b32 s94, 0
    s_cmp_ge_u32 s99, 32
    s_cbranch_scc1 M_SLOW0
    s_mov_b32 s13, s99
    v_mbcnt_lo_u32_b32 v0, -1, 0
    v_mbcnt_hi_u32_b32 v0, -1, v0
    s_branch M_REC
M_SLOW0:
    v_mbcnt_lo_u32_b32 v0, -1, 0
    v_mbcnt_hi_u32_b32 v0, -1, v0
    v_mul_u32_u24 v8, 32, v0
    s_mov_b32 s64, 0x0
    s_mov_b32 s65, 0
    s_mov_b64 exec, 0xff
TK_3:
    buffer_load_dword v9, v8, s[60:63], s64 offen sc1
    s_add_u32 s65, s65, 1
    s_waitcnt vmcnt(0)
    s_mov_b32 s66, 0
    v_readlane_b32 s67, v9, 0
    s_add_u32 s66, s66, s67
    v_readlane_b32 s67, v9, 1
    s_add_u32 s66, s66, s67
    v_readlane_b32 s67, v9, 2
    s_add_u32 s66, s66, s67
    v_readlane_b32 s67, v9, 3
    s_add_u32 s66, s66, s67
    v_readlane_b32 s67, v9, 4
    s_add_u32 s66, s66, s67
    v_readlane_b32 s67, v9, 5
    s_add_u32 s66, s66, s67
    v_readlane_b32 s67, v9, 6
    s_add_u32 s66, s66, s67
    v_readlane_b32 s67, v9, 7
    s_add_u32 s66, s66, s67
    s_cmp_ge_u32 s66, 256
    s_cbranch_scc1 TKD_4
    s_cmp_gt_u32 s65, 262144
    s_cbranch_scc0 TK_3
TKD_4:
    v_cmp_ne_u32 vcc, 32, v9
    s_mov_b64 exec, -1
M_SLOW:
    s_waitcnt vmcnt(0) lgkmcnt(0)
    s_barrier
    s_cmp_lg_u32 s14, 0
    s_cbranch_scc1 M_SLOWB
    v_mov_b32 v8, 1
    s_mov_b64 exec, 1
    buffer_atomic_add v8, off, s[60:63], 12 sc1
    s_mov_b64 exec, -1
M_SLOWB:
    s_mov_b32 s95, 12
    s_mov_b32 s65, 0
SB_5:
    buffer_load_dword v8, off, s[60:63], s95 sc1
    s_add_u32 s65, s65, 1
    s_waitcnt vmcnt(0)
    v_readfirstlane_b32 s64, v8
    s_cmp_ge_u32 s64, 256
    s_cbranch_scc1 SBD_6
    s_cmp_gt_u32 s65, 65536
    s_cbranch_scc1 SBD_6
    s_sleep 4
    s_branch SB_5
SBD_6:
    s_mov_b32 s95, 8
    s_mov_b32 s97, 1
    s_mov_b32 s94, 0
    s_cmp_lt_u32 s2, 64
    s_cbranch_scc0 M_SH
    s_load_dwordx2 s[44:45], s[0:1], 16
    s_mov_b32 s46, 0x500000
    s_mov_b32 s47, 0x00020000
    s_load_dwordx2 s[48:49], s[0:1], 24
    s_mov_b32 s50, 0x500000
    s_mov_b32 s51, 0x00020000
    s_load_dwordx2 s[52:53], s[0:1], 32
    s_mov_b32 s54, 0x500000
    s_mov_b32 s55, 0x00020000
    s_load_dwordx2 s[56:57], s[0:1], 40
    s_mov_b32 s58, 0x500000
    s_mov_b32 s59, 0x00020000
    s_waitcnt lgkmcnt(0)
    s_lshr_b32 s12, s2, 5
    s_and_b32 s13, s2, 31
    s_branch M_REC
M_SH:
    s_sub_u32 s96, s2, 64
    s_branch M_HELP
M_REC:
    v_mbcnt_lo_u32_b32 v0, -1, 0
    v_mbcnt_hi_u32_b32 v0, -1, v0
    v_and_b32 v0, 63, v0
    s_mul_i32 s40, s14, 36864
    s_add_u32 s40, s40, 16384
    v_lshrrev_b32 v95, 4, v0
    v_lshlrev_b32 v8, 13, v95
    v_and_b32 v95, 1, v95
    v_lshlrev_b32 v95, 1, v95
    v_and_b32 v9, 15, v0
    v_xor_b32 v9, v9, v95
    v_xor_b32 v95, 0, v9
    v_lshl_add_u32 v76, v95, 4, v8
    v_xor_b32 v95, 4, v9
    v_lshl_add_u32 v77, v95, 4, v8
    v_xor_b32 v95, 8, v9
    v_lshl_add_u32 v78, v95, 4, v8
    v_xor_b32 v95, 12, v9
    v_lshl_add_u32 v79, v95, 4, v8
    s_lshl_b32 s64, s13, 8
    s_lshl_b32 s65, s14, 17
    s_add_u32 s64, s64, s65
    s_mul_i32 s65, s12, 2621440
    s_add_u32 s71, s64, s65
    s_sub_u32 s65, 2621440, s65
    s_add_u32 s72, s64, s65
    s_add_u32 m0, s40, 0
    s_add_u32 s64, s71, 0x0
    buffer_load_dwordx4 v76, s[44:47], s64 offen lds
    s_add_u32 m0, s40, 1024
    s_add_u32 s64, s71, 0x8000
    buffer_load_dwordx4 v77, s[44:47], s64 offen lds
    s_add_u32 m0, s40, 2048
    s_add_u32 s64, s71, 0x10000
    buffer_load_dwordx4 v78, s[44:47], s64 offen lds
    s_add_u32 m0, s40, 3072
    s_add_u32 s64, s71, 0x18000
    buffer_load_dwordx4 v79, s[44:47], s64 offen lds
    s_add_u32 m0, s40, 4096
    s_add_u32 s64, s71, 0x80000
    buffer_load_dwordx4 v76, s[44:47], s64 offen lds
    s_add_u32 m0, s40, 5120
    s_add_u32 s64, s71, 0x88000
    buffer_load_dwordx4 v77, s[44:47], s64 offen lds
    s_add_u32 m0, s40, 6144
    s_add_u32 s64, s71, 0x90000
    buffer_load_dwordx4 v78, s[44:47], s64 offen lds
    s_add_u32 m0, s40, 7168
    s_add_u32 s64, s71, 0x98000
    buffer_load_dwordx4 v79, s[44:47], s64 offen lds
    s_add_u32 m0, s40, 8192
    s_add_u32 s64, s71, 0x100000
    buffer_load_dwordx4 v76, s[44:47], s64 offen lds
    s_add_u32 m0, s40, 9216
    s_add_u32 s64, s71, 0x108000
    buffer_load_dwordx4 v77, s[44:47], s64 offen lds
    s_add_u32 m0, s40, 10240
    s_add_u32 s64, s71, 0x110000
    buffer_load_dwordx4 v78, s[44:47], s64 offen lds
    s_add_u32 m0, s40, 11264
    s_add_u32 s64, s71, 0x118000
    buffer_load_dwordx4 v79, s[44:47], s64 offen lds
    s_add_u32 m0, s40, 12288
    s_add_u32 s64, s71, 0x180000
    buffer_load_dwordx4 v76, s[44:47], s64 offen lds
    s_add_u32 m0, s40, 13312
    s_add_u32 s64, s71, 0x188000
    buffer_load_dwordx4 v77, s[44:47], s64 offen lds
    s_add_u32 m0, s40, 14336
    s_add_u32 s64, s71, 0x190000
    buffer_load_dwordx4 v78, s[44:47], s64 offen lds
    s_add_u32 m0, s40, 15360
    s_add_u32 s64, s71, 0x198000
    buffer_load_dwordx4 v79, s[44:47], s64 offen lds
    s_add_u32 m0, s40, 16384
    s_add_u32 s64, s71, 0x200000
    buffer_load_dwordx4 v76, s[44:47], s64 offen lds
    s_add_u32 m0, s40, 17408
    s_add_u32 s64, s71, 0x208000
    buffer_load_dwordx4 v77, s[44:47], s64 offen lds
    s_add_u32 m0, s40, 18432
    s_add_u32 s64, s71, 0x210000
    buffer_load_dwordx4 v78, s[44:47], s64 offen lds
    s_add_u32 m0, s40, 19456
    s_add_u32 s64, s71, 0x218000
    buffer_load_dwordx4 v79, s[44:47], s64 offen lds
    s_add_u32 m0, s40, 20480
    s_add_u32 s64, s72, 0x0
    buffer_load_dwordx4 v76, s[44:47], s64 offen lds
    s_add_u32 m0, s40, 21504
    s_add_u32 s64, s72, 0x8000
    buffer_load_dwordx4 v77, s[44:47], s64 offen lds
    s_add_u32 m0, s40, 22528
    s_add_u32 s64, s72, 0x10000
    buffer_load_dwordx4 v78, s[44:47], s64 offen lds
    s_add_u32 m0, s40, 23552
    s_add_u32 s64, s72, 0x18000
    buffer_load_dwordx4 v79, s[44:47], s64 offen lds
    s_add_u32 m0, s40, 24576
    s_add_u32 s64, s72, 0x80000
    buffer_load_dwordx4 v76, s[44:47], s64 offen lds
    s_add_u32 m0, s40, 25600
    s_add_u32 s64, s72, 0x88000
    buffer_load_dwordx4 v77, s[44:47], s64 offen lds
    s_add_u32 m0, s40, 26624
    s_add_u32 s64, s72, 0x90000
    buffer_load_dwordx4 v78, s[44:47], s64 offen lds
    s_add_u32 m0, s40, 27648
    s_add_u32 s64, s72, 0x98000
    buffer_load_dwordx4 v79, s[44:47], s64 offen lds
    s_add_u32 m0, s40, 28672
    s_add_u32 s64, s72, 0x100000
    buffer_load_dwordx4 v76, s[44:47], s64 offen lds
    s_add_u32 m0, s40, 29696
    s_add_u32 s64, s72, 0x108000
    buffer_load_dwordx4 v77, s[44:47], s64 offen lds
    s_add_u32 m0, s40, 30720
    s_add_u32 s64, s72, 0x110000
    buffer_load_dwordx4 v78, s[44:47], s64 offen lds
    s_add_u32 m0, s40, 31744
    s_add_u32 s64, s72, 0x118000
    buffer_load_dwordx4 v79, s[44:47], s64 offen lds
    v_lshrrev_b32 v95, 5, v0
    v_mul_u32_u24 v8, 36864, v95
    v_bfe_u32 v95, v0, 3, 1
    v_lshl_add_u32 v8, v95, 11, v8
    v_lshlrev_b32 v9, 3, v95
    v_bfe_u32 v95, v0, 4, 1
    v_lshl_add_u32 v8, v95, 10, v8
    v_lshl_add_u32 v9, v95, 2, v9
    v_bfe_u32 v95, v0, 2, 1
    v_lshl_add_u32 v8, v95, 8, v8
    v_lshl_add_u32 v9, v95, 1, v9
    v_and_b32 v95, 1, v0
    v_lshl_add_u32 v8, v95, 3, v8
    v_add_u32 v8, 16384, v8
    v_bfe_u32 v95, v0, 1, 1
    s_lshl_b32 s64, s14, 2
    v_add_u32 v10, s64, v95
    v_add_u32 v95, 0, v10
    v_xor_b32 v95, v95, v9
    v_lshl_add_u32 v72, v95, 4, v8
    v_add_u32 v73, 73728, v72
    v_add_u32 v95, 2, v10
    v_xor_b32 v95, v95, v9
    v_lshl_add_u32 v74, v95, 4, v8
    v_add_u32 v75, 73728, v74
    v_bfe_u32 v95, v0, 2, 1
    v_mov_b32 v8, v95
    v_bfe_u32 v95, v0, 3, 1
    v_lshl_add_u32 v8, v95, 2, v8
    v_bfe_u32 v95, v0, 4, 1
    v_lshl_add_u32 v8, v95, 1, v8
    v_bfe_u32 v95, v0, 5, 1
    v_lshl_add_u32 v8, v95, 3, v8
    v_mul_u32_u24 v8, 1280, v8
    v_and_b32 v95, 3, v0
    v_lshl_add_u32 v89, v95, 4, v8
    v_lshrrev_b32 v95, 1, v0
    v_mul_u32_u24 v8, 1280, v95
    v_and_b32 v95, 1, v0
    v_lshl_add_u32 v90, v95, 4, v8
    v_lshrrev_b32 v95, 5, v0
    v_lshlrev_b32 v93, 9, v95
    v_bfe_u32 v95, v0, 4, 1
    v_lshl_add_u32 v93, v95, 7, v93
    v_bfe_u32 v95, v0, 2, 1
    v_lshl_add_u32 v93, v95, 6, v93
    v_bfe_u32 v95, v0, 3, 1
    v_lshl_add_u32 v93, v95, 5, v93
    v_and_b32 v95, 3, v0
    v_lshl_add_u32 v93, v95, 3, v93
    v_add_u32 v93, s40, v93
    v_lshrrev_b32 v95, 4, v0
    v_lshlrev_b32 v94, 8, v95
    v_bfe_u32 v95, v0, 2, 2
    v_lshl_add_u32 v94, v95, 5, v94
    v_and_b32 v95, 3, v0
    v_lshl_add_u32 v94, v95, 3, v94
    v_add_u32 v94, s40, v94
    s_mul_i32 s39, s13, 163840
    s_mul_i32 s64, s12, 640
    s_add_u32 s39, s39, s64
    s_lshl_b32 s64, s14, 5
    s_add_u32 s41, s39, s64
    s_add_u32 s41, s41, 0x200
    s_lshl_b32 s64, s14, 6
    s_add_u32 s39, s39, s64
    v_and_b32 v0, 63, v0
    v_lshlrev_b32 v1, 4, v0
    s_mul_i32 s64, s14, 36864
    s_add_u32 s64, s64, 16384
    v_add_u32 v2, s64, v1
    v_bfe_u32 v8, v0, 4, 1
    v_mul_u32_u24 v8, 1152, v8
    v_lshrrev_b32 v9, 5, v0
    v_lshlrev_b32 v9, 4, v9
    v_and_b32 v10, 15, v0
    v_add_u32 v9, v9, v10
    s_lshl_b32 s64, s14, 5
    v_add_u32 v9, s64, v9
    v_lshl_add_u32 v8, v9, 3, v8
    v_add_u32 v3, 8192, v8
    v_and_b32 v8, 1, v0
    v_mul_u32_u24 v8, 1152, v8
    v_lshrrev_b32 v9, 4, v0
    v_lshlrev_b32 v9, 2, v9
    v_bfe_u32 v10, v0, 2, 2
    v_add_u32 v9, v9, v10
    v_lshl_add_u32 v8, v9, 3, v8
    v_add_u32 v4, 8192, v8
    v_and_b32 v8, 7, v0
    v_mul_u32_u24 v8, 288, v8
    v_bfe_u32 v9, v0, 3, 1
    v_lshl_add_u32 v8, v9, 5, v8
    v_lshrrev_b32 v9, 4, v0
    v_lshl_add_u32 v8, v9, 3, v8
    s_lshl_b32 s64, s14, 6
    s_add_u32 s64, s64, 12800
    v_add_u32 v5, s64, v8
    s_mov_b32 s32, 0x00ff00ff
    s_mov_b32 s33, 0x00ff00ff
    s_mov_b32 s34, -1
    s_mov_b32 s35, 0
    s_mov_b32 s36, 0x00010001
    s_mov_b32 s37, 0x00010001
    v_mov_b32 v8, 0xeeee
    v_mov_b32 v9, 0x4444
    v_cndmask_b32 v6, v8, v9, s[32:33]
    v_lshrrev_b32 v8, 5, v0
    v_lshlrev_b32 v8, 13, v8
    v_bfe_u32 v9, v0, 3, 1
    v_lshl_add_u32 v8, v9, 12, v8
    v_and_b32 v9, 7, v0
    v_lshl_add_u32 v8, v9, 4, v8
    v_bfe_u32 v9, v0, 4, 1
    v_lshl_add_u32 v7, v9, 3, v8
    s_mov_b32 s10, 0x3e0293ee
    s_mov_b32 s11, 0x3e0293ee
    s_cmp_eq_u32 s14, 0
    s_cselect_b32 s42, 1, 0
    s_cmp_ge_u32 s13, 24
    s_cselect_b32 s65, 1, 0
    s_cmp_eq_u32 s14, 1
    s_cselect_b32 s65, s65, 0
    s_or_b32 s42, s42, s65
    s_lshl_b32 s65, s65, 3
    s_add_u32 s64, s13, s65
    s_cmp_eq_u32 s64, 39
    s_cselect_b32 s22, s42, 0
    s_mul_i32 s24, s12, 163840
    s_add_u32 s24, s24, 0x300000
    s_lshl_b32 s67, s13, 7
    s_add_u32 s26, s24, s67
    s_lshl_b32 s67, s14, 14
    s_add_u32 s23, s26, s67
    s_add_u32 s25, s23, 0x10000
    s_lshl_b32 s67, s14, 13
    s_add_u32 s26, s26, s67
    s_add_u32 s26, s26, 0x20000
    s_lshl_b32 s67, s64, 12
    s_add_u32 s24, s24, s67
    s_lshl_b32 s64, s64, 7
    s_lshl_b32 s65, s12, 13
    s_add_u32 s17, s65, 0x5900000
    s_add_u32 s18, s17, s64
    s_lshl_b32 s65, s12, 21
    s_add_u32 s66, s65, 0x6000000
    s_add_u32 s21, s66, s64
    s_xor_b32 s65, s65, 0x200000
    s_add_u32 s20, s65, 0x5ff8000
    s_and_b32 s64, s13, 1
    s_cmp_eq_u32 s64, s12
    s_cselect_b32 s43, 1, 0
    s_mov_b32 s43, 0
    s_lshl_b32 s64, s13, 4
    s_add_u32 s69, s64, 0x291000
    s_lshl_b32 s64, s13, 2
    s_add_u32 s70, s64, 0x294000
    s_lshl_b32 s64, s13, 14
    s_lshl_b32 s73, s14, 11
    s_lshl_b32 s65, s14, 12
    s_add_u32 s65, s65, s64
    s_add_u32 s3, s65, 0x1500000
    s_add_u32 s64, s64, s73
    s_add_u32 s28, s64, 0x1400000
    s_add_u32 s29, s64, 0x1402000
    s_lshl_b32 s64, s13, 11
    s_add_u32 s30, s64, 0x640000
    s_lshl_b32 s64, s13, 12
    s_lshl_b32 s65, s14, 10
    s_add_u32 s64, s64, s65
    s_add_u32 s31, s64, 0xa40000
    s_waitcnt vmcnt(28)
    s_barrier
    s_add_u32 m0, s40, 32768
    s_add_u32 s64, s72, 0x180000
    buffer_load_dwordx4 v76, s[44:47], s64 offen lds
    s_add_u32 m0, s40, 33792
    s_add_u32 s64, s72, 0x188000
    buffer_load_dwordx4 v77, s[44:47], s64 offen lds
    s_add_u32 m0, s40, 34816
    s_add_u32 s64, s72, 0x190000
    buffer_load_dwordx4 v78, s[44:47], s64 offen lds
    s_add_u32 m0, s40, 35840
    s_add_u32 s64, s72, 0x198000
    buffer_load_dwordx4 v79, s[44:47], s64 offen lds
    ds_read_b64_tr_b16 v[96:97], v72 offset:0
    ds_read_b64_tr_b16 v[98:99], v72 offset:512
    ds_read_b64_tr_b16 v[100:101], v73 offset:0
    ds_read_b64_tr_b16 v[102:103], v73 offset:512
    ds_read_b64_tr_b16 v[104:105], v74 offset:0
    ds_read_b64_tr_b16 v[106:107], v74 offset:512
    ds_read_b64_tr_b16 v[108:109], v75 offset:0
    ds_read_b64_tr_b16 v[110:111], v75 offset:512
    s_waitcnt lgkmcnt(0)
    s_waitcnt vmcnt(28)
    s_barrier
    s_add_u32 m0, s40, 0
    s_add_u32 s64, s72, 0x200000
    buffer_load_dwordx4 v76, s[44:47], s64 offen lds
    s_add_u32 m0, s40, 1024
    s_add_u32 s64, s72, 0x208000
    buffer_load_dwordx4 v77, s[44:47], s64 offen lds
    s_add_u32 m0, s40, 2048
    s_add_u32 s64, s72, 0x210000
    buffer_load_dwordx4 v78, s[44:47], s64 offen lds
    s_add_u32 m0, s40, 3072
    s_add_u32 s64, s72, 0x218000
    buffer_load_dwordx4 v79, s[44:47], s64 offen lds
    ds_read_b64_tr_b16 v[112:113], v72 offset:4096
    ds_read_b64_tr_b16 v[114:115], v72 offset:4608
    ds_read_b64_tr_b16 v[116:117], v73 offset:4096
    ds_read_b64_tr_b16 v[118:119], v73 offset:4608
    ds_read_b64_tr_b16 v[120:121], v74 offset:4096
    ds_read_b64_tr_b16 v[122:123], v74 offset:4608
    ds_read_b64_tr_b16 v[124:125], v75 offset:4096
    ds_read_b64_tr_b16 v[126:127], v75 offset:4608
    s_waitcnt lgkmcnt(0)
    s_waitcnt vmcnt(28)
    s_barrier
    s_add_u32 m0, s40, 4096
    s_add_u32 s64, s72, 0x200000
    buffer_load_dwordx4 v76, s[48:51], s64 offen lds
    s_add_u32 m0, s40, 5120
    s_add_u32 s64, s72, 0x208000
    buffer_load_dwordx4 v77, s[48:51], s64 offen lds
    s_add_u32 m0, s40, 6144
    s_add_u32 s64, s72, 0x210000
    buffer_load_dwordx4 v78, s[48:51], s64 offen lds
    s_add_u32 m0, s40, 7168
    s_add_u32 s64, s72, 0x218000
    buffer_load_dwordx4 v79, s[48:51], s64 offen lds
    ds_read_b64_tr_b16 v[128:129], v72 offset:8192
    ds_read_b64_tr_b16 v[130:131], v72 offset:8704
    ds_read_b64_tr_b16 v[132:133], v73 offset:8192
    ds_read_b64_tr_b16 v[134:135], v73 offset:8704
    ds_read_b64_tr_b16 v[136:137], v74 offset:8192
    ds_read_b64_tr_b16 v[138:139], v74 offset:8704
    ds_read_b64_tr_b16 v[140:141], v75 offset:8192
    ds_read_b64_tr_b16 v[142:143], v75 offset:8704
    s_waitcnt lgkmcnt(0)
    s_waitcnt vmcnt(28)
    s_barrier
    s_add_u32 m0, s40, 8192
    s_add_u32 s64, s71, 0x0
    buffer_load_dwordx4 v76, s[52:55], s64 offen lds
    s_add_u32 m0, s40, 9216
    s_add_u32 s64, s71, 0x8000
    buffer_load_dwordx4 v77, s[52:55], s64 offen lds
    s_add_u32 m0, s40, 10240
    s_add_u32 s64, s71, 0x10000
    buffer_load_dwordx4 v78, s[52:55], s64 offen lds
    s_add_u32 m0, s40, 11264
    s_add_u32 s64, s71, 0x18000
    buffer_load_dwordx4 v79, s[52:55], s64 offen lds
    ds_read_b64_tr_b16 v[144:145], v72 offset:12288
    ds_read_b64_tr_b16 v[146:147], v72 offset:12800
    ds_read_b64_tr_b16 v[148:149], v73 offset:12288
    ds_read_b64_tr_b16 v[150:151], v73 offset:12800
    ds_read_b64_tr_b16 v[152:153], v74 offset:12288
    ds_read_b64_tr_b16 v[154:155], v74 offset:12800
    ds_read_b64_tr_b16 v[156:157], v75 offset:12288
    ds_read_b64_tr_b16 v[158:159], v75 offset:12800
    s_waitcnt lgkmcnt(0)
    s_waitcnt vmcnt(28)
    s_barrier
    s_add_u32 m0, s40, 12288
    s_add_u32 s64, s71, 0x80000
    buffer_load_dwordx4 v76, s[52:55], s64 offen lds
    s_add_u32 m0, s40, 13312
    s_add_u32 s64, s71, 0x88000
    buffer_load_dwordx4 v77, s[52:55], s64 offen lds
    s_add_u32 m0, s40, 14336
    s_add_u32 s64, s71, 0x90000
    buffer_load_dwordx4 v78, s[52:55], s64 offen lds
    s_add_u32 m0, s40, 15360
    s_add_u32 s64, s71, 0x98000
    buffer_load_dwordx4 v79, s[52:55], s64 offen lds
    ds_read_b64_tr_b16 v[160:161], v72 offset:16384
    ds_read_b64_tr_b16 v[162:163], v72 offset:16896
    ds_read_b64_tr_b16 v[164:165], v73 offset:16384
    ds_read_b64_tr_b16 v[166:167], v73 offset:16896
    ds_read_b64_tr_b16 v[168:169], v74 offset:16384
    ds_read_b64_tr_b16 v[170:171], v74 offset:16896
    ds_read_b64_tr_b16 v[172:173], v75 offset:16384
    ds_read_b64_tr_b16 v[174:175], v75 offset:16896
    s_waitcnt lgkmcnt(0)
    s_waitcnt vmcnt(28)
    s_barrier
    s_add_u32 m0, s40, 16384
    s_add_u32 s64, s71, 0x100000
    buffer_load_dwordx4 v76, s[52:55], s64 offen lds
    s_add_u32 m0, s40, 17408
    s_add_u32 s64, s71, 0x108000
    buffer_load_dwordx4 v77, s[52:55], s64 offen lds
    s_add_u32 m0, s40, 18432
    s_add_u32 s64, s71, 0x110000
    buffer_load_dwordx4 v78, s[52:55], s64 offen lds
    s_add_u32 m0, s40, 19456
    s_add_u32 s64, s71, 0x118000
    buffer_load_dwordx4 v79, s[52:55], s64 offen lds
    ds_read_b64_tr_b16 v[176:177], v72 offset:20480
    ds_read_b64_tr_b16 v[178:179], v72 offset:20992
    ds_read_b64_tr_b16 v[180:181], v73 offset:20480
    ds_read_b64_tr_b16 v[182:183], v73 offset:20992
    ds_read_b64_tr_b16 v[184:185], v74 offset:20480
    ds_read_b64_tr_b16 v[186:187], v74 offset:20992
    ds_read_b64_tr_b16 v[188:189], v75 offset:20480
    ds_read_b64_tr_b16 v[190:191], v75 offset:20992
    s_waitcnt lgkmcnt(0)
    s_waitcnt vmcnt(28)
    s_barrier
    s_add_u32 m0, s40, 20480
    s_add_u32 s64, s71, 0x180000
    buffer_load_dwordx4 v76, s[52:55], s64 offen lds
    s_add_u32 m0, s40, 21504
    s_add_u32 s64, s71, 0x188000
    buffer_load_dwordx4 v77, s[52:55], s64 offen lds
    s_add_u32 m0, s40, 22528
    s_add_u32 s64, s71, 0x190000
    buffer_load_dwordx4 v78, s[52:55], s64 offen lds
    s_add_u32 m0, s40, 23552
    s_add_u32 s64, s71, 0x198000
    buffer_load_dwordx4 v79, s[52:55], s64 offen lds
    ds_read_b64_tr_b16 v[192:193], v72 offset:24576
    ds_read_b64_tr_b16 v[194:195], v72 offset:25088
    ds_read_b64_tr_b16 v[196:197], v73 offset:24576
    ds_read_b64_tr_b16 v[198:199], v73 offset:25088
    ds_read_b64_tr_b16 v[200:201], v74 offset:24576
    ds_read_b64_tr_b16 v[202:203], v74 offset:25088
    ds_read_b64_tr_b16 v[204:205], v75 offset:24576
    ds_read_b64_tr_b16 v[206:207], v75 offset:25088
    s_waitcnt lgkmcnt(0)
    s_waitcnt vmcnt(28)
    s_barrier
    s_add_u32 m0, s40, 24576
    s_add_u32 s64, s71, 0x200000
    buffer_load_dwordx4 v76, s[52:55], s64 offen lds
    s_add_u32 m0, s40, 25600
    s_add_u32 s64, s71, 0x208000
    buffer_load_dwordx4 v77, s[52:55], s64 offen lds
    s_add_u32 m0, s40, 26624
    s_add_u32 s64, s71, 0x210000
    buffer_load_dwordx4 v78, s[52:55], s64 offen lds
    s_add_u32 m0, s40, 27648
    s_add_u32 s64, s71, 0x218000
    buffer_load_dwordx4 v79, s[52:55], s64 offen lds
    ds_read_b64_tr_b16 v[208:209], v72 offset:28672
    ds_read_b64_tr_b16 v[210:211], v72 offset:29184
    ds_read_b64_tr_b16 v[212:213], v73 offset:28672
    ds_read_b64_tr_b16 v[214:215], v73 offset:29184
    ds_read_b64_tr_b16 v[216:217], v74 offset:28672
    ds_read_b64_tr_b16 v[218:219], v74 offset:29184
    ds_read_b64_tr_b16 v[220:221], v75 offset:28672
    ds_read_b64_tr_b16 v[222:223], v75 offset:29184
    s_waitcnt lgkmcnt(0)
    s_waitcnt vmcnt(28)
    s_barrier
    s_add_u32 m0, s40, 28672
    s_add_u32 s64, s72, 0x0
    buffer_load_dwordx4 v76, s[52:55], s64 offen lds
    s_add_u32 m0, s40, 29696
    s_add_u32 s64, s72, 0x8000
    buffer_load_dwordx4 v77, s[52:55], s64 offen lds
    s_add_u32 m0, s40, 30720
    s_add_u32 s64, s72, 0x10000
    buffer_load_dwordx4 v78, s[52:55], s64 offen lds
    s_add_u32 m0, s40, 31744
    s_add_u32 s64, s72, 0x18000
    buffer_load_dwordx4 v79, s[52:55], s64 offen lds
    ds_read_b64_tr_b16 v[224:225], v72 offset:32768
    ds_read_b64_tr_b16 v[226:227], v72 offset:33280
    ds_read_b64_tr_b16 v[228:229], v73 offset:32768
    ds_read_b64_tr_b16 v[230:231], v73 offset:33280
    ds_read_b64_tr_b16 v[232:233], v74 offset:32768
    ds_read_b64_tr_b16 v[234:235], v74 offset:33280
    ds_read_b64_tr_b16 v[236:237], v75 offset:32768
    ds_read_b64_tr_b16 v[238:239], v75 offset:33280
    s_waitcnt lgkmcnt(0)
    s_waitcnt vmcnt(28)
    s_barrier
    s_add_u32 m0, s40, 32768
    s_add_u32 s64, s72, 0x80000
    buffer_load_dwordx4 v76, s[52:55], s64 offen lds
    s_add_u32 m0, s40, 33792
    s_add_u32 s64, s72, 0x88000
    buffer_load_dwordx4 v77, s[52:55], s64 offen lds
    s_add_u32 m0, s40, 34816
    s_add_u32 s64, s72, 0x90000
    buffer_load_dwordx4 v78, s[52:55], s64 offen lds
    s_add_u32 m0, s40, 35840
    s_add_u32 s64, s72, 0x98000
    buffer_load_dwordx4 v79, s[52:55], s64 offen lds
    ds_read_b64_tr_b16 v[240:241], v72 offset:0
    ds_read_b64_tr_b16 v[242:243], v72 offset:512
    ds_read_b64_tr_b16 v[244:245], v73 offset:0
    ds_read_b64_tr_b16 v[246:247], v73 offset:512
    ds_read_b64_tr_b16 v[248:249], v74 offset:0
    ds_read_b64_tr_b16 v[250:251], v74 offset:512
    ds_read_b64_tr_b16 v[252:253], v75 offset:0
    ds_read_b64_tr_b16 v[254:255], v75 offset:512
    s_waitcnt lgkmcnt(0)
    s_waitcnt vmcnt(28)
    s_barrier
    s_add_u32 m0, s40, 0
    s_add_u32 s64, s72, 0x100000
    buffer_load_dwordx4 v76, s[52:55], s64 offen lds
    s_add_u32 m0, s40, 1024
    s_add_u32 s64, s72, 0x108000
    buffer_load_dwordx4 v77, s[52:55], s64 offen lds
    s_add_u32 m0, s40, 2048
    s_add_u32 s64, s72, 0x110000
    buffer_load_dwordx4 v78, s[52:55], s64 offen lds
    s_add_u32 m0, s40, 3072
    s_add_u32 s64, s72, 0x118000
    buffer_load_dwordx4 v79, s[52:55], s64 offen lds
    ds_read_b64_tr_b16 a[240:241], v72 offset:4096
    ds_read_b64_tr_b16 a[242:243], v72 offset:4608
    ds_read_b64_tr_b16 a[244:245], v73 offset:4096
    ds_read_b64_tr_b16 a[246:247], v73 offset:4608
    ds_read_b64_tr_b16 a[248:249], v74 offset:4096
    ds_read_b64_tr_b16 a[250:251], v74 offset:4608
    ds_read_b64_tr_b16 a[252:253], v75 offset:4096
    ds_read_b64_tr_b16 a[254:255], v75 offset:4608
    s_waitcnt lgkmcnt(0)
    s_waitcnt vmcnt(28)
    s_barrier
    s_add_u32 m0, s40, 4096
    s_add_u32 s64, s72, 0x180000
    buffer_load_dwordx4 v76, s[52:55], s64 offen lds
    s_add_u32 m0, s40, 5120
    s_add_u32 s64, s72, 0x188000
    buffer_load_dwordx4 v77, s[52:55], s64 offen lds
    s_add_u32 m0, s40, 6144
    s_add_u32 s64, s72, 0x190000
    buffer_load_dwordx4 v78, s[52:55], s64 offen lds
    s_add_u32 m0, s40, 7168
    s_add_u32 s64, s72, 0x198000
    buffer_load_dwordx4 v79, s[52:55], s64 offen lds
    ds_read_b64_tr_b16 a[0:1], v72 offset:8192
    ds_read_b64_tr_b16 a[2:3], v72 offset:8704
    ds_read_b64_tr_b16 a[4:5], v73 offset:8192
    ds_read_b64_tr_b16 a[6:7], v73 offset:8704
    ds_read_b64_tr_b16 a[8:9], v74 offset:8192
    ds_read_b64_tr_b16 a[10:11], v74 offset:8704
    ds_read_b64_tr_b16 a[12:13], v75 offset:8192
    ds_read_b64_tr_b16 a[14:15], v75 offset:8704
    s_waitcnt lgkmcnt(0)
    s_waitcnt vmcnt(28)
    s_barrier
    s_add_u32 m0, s40, 8192
    s_add_u32 s64, s72, 0x200000
    buffer_load_dwordx4 v76, s[52:55], s64 offen lds
    s_add_u32 m0, s40, 9216
    s_add_u32 s64, s72, 0x208000
    buffer_load_dwordx4 v77, s[52:55], s64 offen lds
    s_add_u32 m0, s40, 10240
    s_add_u32 s64, s72, 0x210000
    buffer_load_dwordx4 v78, s[52:55], s64 offen lds
    s_add_u32 m0, s40, 11264
    s_add_u32 s64, s72, 0x218000
    buffer_load_dwordx4 v79, s[52:55], s64 offen lds
    ds_read_b64_tr_b16 a[16:17], v72 offset:12288
    ds_read_b64_tr_b16 a[18:19], v72 offset:12800
    ds_read_b64_tr_b16 a[20:21], v73 offset:12288
    ds_read_b64_tr_b16 a[22:23], v73 offset:12800
    ds_read_b64_tr_b16 a[24:25], v74 offset:12288
    ds_read_b64_tr_b16 a[26:27], v74 offset:12800
    ds_read_b64_tr_b16 a[28:29], v75 offset:12288
    ds_read_b64_tr_b16 a[30:31], v75 offset:12800
    s_waitcnt lgkmcnt(0)
    s_waitcnt vmcnt(28)
    s_barrier
    s_add_u32 m0, s40, 12288
    s_add_u32 s64, s39, 0x0
    buffer_load_dwordx4 v89, s[56:59], s64 offen lds
    s_add_u32 m0, s40, 13312
    s_add_u32 s64, s39, 0x5000
    buffer_load_dwordx4 v89, s[56:59], s64 offen lds
    s_add_u32 m0, s40, 14336
    s_add_u32 s64, s39, 0xa000
    buffer_load_dwordx4 v89, s[56:59], s64 offen lds
    s_add_u32 m0, s40, 15360
    s_add_u32 s64, s39, 0xf000
    buffer_load_dwordx4 v89, s[56:59], s64 offen lds
    ds_read_b64_tr_b16 a[32:33], v72 offset:16384
    ds_read_b64_tr_b16 a[34:35], v72 offset:16896
    ds_read_b64_tr_b16 a[36:37], v73 offset:16384
    ds_read_b64_tr_b16 a[38:39], v73 offset:16896
    ds_read_b64_tr_b16 a[40:41], v74 offset:16384
    ds_read_b64_tr_b16 a[42:43], v74 offset:16896
    ds_read_b64_tr_b16 a[44:45], v75 offset:16384
    ds_read_b64_tr_b16 a[46:47], v75 offset:16896
    s_waitcnt lgkmcnt(0)
    s_waitcnt vmcnt(28)
    s_barrier
    s_add_u32 m0, s40, 16384
    s_add_u32 s64, s39, 0x14000
    buffer_load_dwordx4 v89, s[56:59], s64 offen lds
    s_add_u32 m0, s40, 17408
    s_add_u32 s64, s39, 0x19000
    buffer_load_dwordx4 v89, s[56:59], s64 offen lds
    s_add_u32 m0, s40, 18432
    s_add_u32 s64, s39, 0x1e000
    buffer_load_dwordx4 v89, s[56:59], s64 offen lds
    s_add_u32 m0, s40, 19456
    s_add_u32 s64, s39, 0x23000
    buffer_load_dwordx4 v89, s[56:59], s64 offen lds
    ds_read_b64_tr_b16 a[48:49], v72 offset:20480
    ds_read_b64_tr_b16 a[50:51], v72 offset:20992
    ds_read_b64_tr_b16 a[52:53], v73 offset:20480
    ds_read_b64_tr_b16 a[54:55], v73 offset:20992
    ds_read_b64_tr_b16 a[56:57], v74 offset:20480
    ds_read_b64_tr_b16 a[58:59], v74 offset:20992
    ds_read_b64_tr_b16 a[60:61], v75 offset:20480
    ds_read_b64_tr_b16 a[62:63], v75 offset:20992
    s_waitcnt lgkmcnt(0)
    s_waitcnt vmcnt(28)
    s_barrier
    s_add_u32 m0, s40, 20480
    s_add_u32 s64, s39, 0x100
    buffer_load_dwordx4 v89, s[56:59], s64 offen lds
    s_add_u32 m0, s40, 21504
    s_add_u32 s64, s39, 0x5100
    buffer_load_dwordx4 v89, s[56:59], s64 offen lds
    s_add_u32 m0, s40, 22528
    s_add_u32 s64, s39, 0xa100
    buffer_load_dwordx4 v89, s[56:59], s64 offen lds
    s_add_u32 m0, s40, 23552
    s_add_u32 s64, s39, 0xf100
    buffer_load_dwordx4 v89, s[56:59], s64 offen lds
    ds_read_b64_tr_b16 a[64:65], v72 offset:24576
    ds_read_b64_tr_b16 a[66:67], v72 offset:25088
    ds_read_b64_tr_b16 a[68:69], v73 offset:24576
    ds_read_b64_tr_b16 a[70:71], v73 offset:25088
    ds_read_b64_tr_b16 a[72:73], v74 offset:24576
    ds_read_b64_tr_b16 a[74:75], v74 offset:25088
    ds_read_b64_tr_b16 a[76:77], v75 offset:24576
    ds_read_b64_tr_b16 a[78:79], v75 offset:25088
    s_waitcnt lgkmcnt(0)
    s_waitcnt vmcnt(28)
    s_barrier
    s_add_u32 m0, s40, 24576
    s_add_u32 s64, s39, 0x14100
    buffer_load_dwordx4 v89, s[56:59], s64 offen lds
    s_add_u32 m0, s40, 25600
    s_add_u32 s64, s39, 0x19100
    buffer_load_dwordx4 v89, s[56:59], s64 offen lds
    s_add_u32 m0, s40, 26624
    s_add_u32 s64, s39, 0x1e100
    buffer_load_dwordx4 v89, s[56:59], s64 offen lds
    s_add_u32 m0, s40, 27648
    s_add_u32 s64, s39, 0x23100
    buffer_load_dwordx4 v89, s[56:59], s64 offen lds
    ds_read_b64_tr_b16 a[80:81], v72 offset:28672
    ds_read_b64_tr_b16 a[82:83], v72 offset:29184
    ds_read_b64_tr_b16 a[84:85], v73 offset:28672
    ds_read_b64_tr_b16 a[86:87], v73 offset:29184
    ds_read_b64_tr_b16 a[88:89], v74 offset:28672
    ds_read_b64_tr_b16 a[90:91], v74 offset:29184
    ds_read_b64_tr_b16 a[92:93], v75 offset:28672
    ds_read_b64_tr_b16 a[94:95], v75 offset:29184
    s_waitcnt lgkmcnt(0)
    s_waitcnt vmcnt(28)
    s_barrier
    s_add_u32 m0, s40, 28672
    s_add_u32 s64, s41, 0x0
    buffer_load_dwordx4 v90, s[56:59], s64 offen lds
    s_add_u32 m0, s40, 29696
    s_add_u32 s64, s41, 0xa000
    buffer_load_dwordx4 v90, s[56:59], s64 offen lds
    s_add_u32 m0, s40, 30720
    s_add_u32 s64, s41, 0x14000
    buffer_load_dwordx4 v90, s[56:59], s64 offen lds
    s_add_u32 m0, s40, 31744
    s_add_u32 s64, s41, 0x1e000
    buffer_load_dwordx4 v90, s[56:59], s64 offen lds
    ds_read_b64_tr_b16 a[96:97], v72 offset:32768
    ds_read_b64_tr_b16 a[98:99], v72 offset:33280
    ds_read_b64_tr_b16 a[100:101], v73 offset:32768
    ds_read_b64_tr_b16 a[102:103], v73 offset:33280
    ds_read_b64_tr_b16 a[104:105], v74 offset:32768
    ds_read_b64_tr_b16 a[106:107], v74 offset:33280
    ds_read_b64_tr_b16 a[108:109], v75 offset:32768
    ds_read_b64_tr_b16 a[110:111], v75 offset:33280
    s_waitcnt lgkmcnt(0)
    s_waitcnt vmcnt(28)
    s_barrier
    s_add_u32 m0, s40, 32768
    s_add_u32 s64, s72, 0x180000
    buffer_load_dwordx4 v76, s[48:51], s64 offen lds
    s_add_u32 m0, s40, 33792
    s_add_u32 s64, s72, 0x188000
    buffer_load_dwordx4 v77, s[48:51], s64 offen lds
    s_add_u32 m0, s40, 34816
    s_add_u32 s64, s72, 0x190000
    buffer_load_dwordx4 v78, s[48:51], s64 offen lds
    s_add_u32 m0, s40, 35840
    s_add_u32 s64, s72, 0x198000
    buffer_load_dwordx4 v79, s[48:51], s64 offen lds
    v_lshlrev_b32 v80, 2, v0
    buffer_load_dword v81, v80, s[60:63], 0 offen sc1
    ds_read_b64_tr_b16 a[112:113], v72 offset:0
    ds_read_b64_tr_b16 a[114:115], v72 offset:512
    ds_read_b64_tr_b16 a[116:117], v73 offset:0
    ds_read_b64_tr_b16 a[118:119], v73 offset:512
    ds_read_b64_tr_b16 a[120:121], v74 offset:0
    ds_read_b64_tr_b16 a[122:123], v74 offset:512
    ds_read_b64_tr_b16 a[124:125], v75 offset:0
    ds_read_b64_tr_b16 a[126:127], v75 offset:512
    s_waitcnt lgkmcnt(0)
    s_waitcnt vmcnt(29)
    s_barrier
    s_add_u32 m0, s40, 0
    s_add_u32 s64, s71, 0x0
    buffer_load_dwordx4 v76, s[48:51], s64 offen lds
    s_add_u32 m0, s40, 1024
    s_add_u32 s64, s71, 0x8000
    buffer_load_dwordx4 v77, s[48:51], s64 offen lds
    s_add_u32 m0, s40, 2048
    s_add_u32 s64, s71, 0x10000
    buffer_load_dwordx4 v78, s[48:51], s64 offen lds
    s_add_u32 m0, s40, 3072
    s_add_u32 s64, s71, 0x18000
    buffer_load_dwordx4 v79, s[48:51], s64 offen lds
    ds_read_b64_tr_b16 a[128:129], v72 offset:4096
    ds_read_b64_tr_b16 a[130:131], v72 offset:4608
    ds_read_b64_tr_b16 a[132:133], v73 offset:4096
    ds_read_b64_tr_b16 a[134:135], v73 offset:4608
    ds_read_b64_tr_b16 a[136:137], v74 offset:4096
    ds_read_b64_tr_b16 a[138:139], v74 offset:4608
    ds_read_b64_tr_b16 a[140:141], v75 offset:4096
    ds_read_b64_tr_b16 a[142:143], v75 offset:4608
    s_waitcnt lgkmcnt(0)
    s_waitcnt vmcnt(29)
    s_barrier
    s_add_u32 m0, s40, 4096
    s_add_u32 s64, s71, 0x80000
    buffer_load_dwordx4 v76, s[48:51], s64 offen lds
    s_add_u32 m0, s40, 5120
    s_add_u32 s64, s71, 0x88000
    buffer_load_dwordx4 v77, s[48:51], s64 offen lds
    s_add_u32 m0, s40, 6144
    s_add_u32 s64, s71, 0x90000
    buffer_load_dwordx4 v78, s[48:51], s64 offen lds
    s_add_u32 m0, s40, 7168
    s_add_u32 s64, s71, 0x98000
    buffer_load_dwordx4 v79, s[48:51], s64 offen lds
    ds_read_b64_tr_b16 a[144:145], v72 offset:8192
    ds_read_b64_tr_b16 a[146:147], v72 offset:8704
    ds_read_b64_tr_b16 a[148:149], v73 offset:8192
    ds_read_b64_tr_b16 a[150:151], v73 offset:8704
    ds_read_b64_tr_b16 a[152:153], v74 offset:8192
    ds_read_b64_tr_b16 a[154:155], v74 offset:8704
    ds_read_b64_tr_b16 a[156:157], v75 offset:8192
    ds_read_b64_tr_b16 a[158:159], v75 offset:8704
    s_waitcnt lgkmcnt(0)
    s_waitcnt vmcnt(29)
    s_barrier
    s_add_u32 m0, s40, 8192
    s_add_u32 s64, s71, 0x100000
    buffer_load_dwordx4 v76, s[48:51], s64 offen lds
    s_add_u32 m0, s40, 9216
    s_add_u32 s64, s71, 0x108000
    buffer_load_dwordx4 v77, s[48:51], s64 offen lds
    s_add_u32 m0, s40, 10240
    s_add_u32 s64, s71, 0x110000
    buffer_load_dwordx4 v78, s[48:51], s64 offen lds
    s_add_u32 m0, s40, 11264
    s_add_u32 s64, s71, 0x118000
    buffer_load_dwordx4 v79, s[48:51], s64 offen lds
    ds_read_b64_tr_b16 a[160:161], v93 offset:12288
    ds_read_b64_tr_b16 a[162:163], v93 offset:12544
    ds_read_b64_tr_b16 a[164:165], v93 offset:13312
    ds_read_b64_tr_b16 a[166:167], v93 offset:13568
    ds_read_b64_tr_b16 a[168:169], v93 offset:14336
    ds_read_b64_tr_b16 a[170:171], v93 offset:14592
    ds_read_b64_tr_b16 a[172:173], v93 offset:15360
    ds_read_b64_tr_b16 a[174:175], v93 offset:15616
    s_waitcnt lgkmcnt(0)
    s_waitcnt vmcnt(29)
    s_barrier
    s_add_u32 m0, s40, 12288
    s_add_u32 s64, s71, 0x180000
    buffer_load_dwordx4 v76, s[48:51], s64 offen lds
    s_add_u32 m0, s40, 13312
    s_add_u32 s64, s71, 0x188000
    buffer_load_dwordx4 v77, s[48:51], s64 offen lds
    s_add_u32 m0, s40, 14336
    s_add_u32 s64, s71, 0x190000
    buffer_load_dwordx4 v78, s[48:51], s64 offen lds
    s_add_u32 m0, s40, 15360
    s_add_u32 s64, s71, 0x198000
    buffer_load_dwordx4 v79, s[48:51], s64 offen lds
    ds_read_b64_tr_b16 a[176:177], v93 offset:16384
    ds_read_b64_tr_b16 a[178:179], v93 offset:16640
    ds_read_b64_tr_b16 a[180:181], v93 offset:17408
    ds_read_b64_tr_b16 a[182:183], v93 offset:17664
    ds_read_b64_tr_b16 a[184:185], v93 offset:18432
    ds_read_b64_tr_b16 a[186:187], v93 offset:18688
    ds_read_b64_tr_b16 a[188:189], v93 offset:19456
    ds_read_b64_tr_b16 a[190:191], v93 offset:19712
    s_waitcnt lgkmcnt(0)
    s_waitcnt vmcnt(29)
    s_barrier
    s_add_u32 m0, s40, 16384
    s_add_u32 s64, s71, 0x200000
    buffer_load_dwordx4 v76, s[48:51], s64 offen lds
    s_add_u32 m0, s40, 17408
    s_add_u32 s64, s71, 0x208000
    buffer_load_dwordx4 v77, s[48:51], s64 offen lds
    s_add_u32 m0, s40, 18432
    s_add_u32 s64, s71, 0x210000
    buffer_load_dwordx4 v78, s[48:51], s64 offen lds
    s_add_u32 m0, s40, 19456
    s_add_u32 s64, s71, 0x218000
    buffer_load_dwordx4 v79, s[48:51], s64 offen lds
    ds_read_b64_tr_b16 a[192:193], v93 offset:20480
    ds_read_b64_tr_b16 a[194:195], v93 offset:20736
    ds_read_b64_tr_b16 a[196:197], v93 offset:21504
    ds_read_b64_tr_b16 a[198:199], v93 offset:21760
    ds_read_b64_tr_b16 a[200:201], v93 offset:22528
    ds_read_b64_tr_b16 a[202:203], v93 offset:22784
    ds_read_b64_tr_b16 a[204:205], v93 offset:23552
    ds_read_b64_tr_b16 a[206:207], v93 offset:23808
    s_waitcnt lgkmcnt(0)
    s_waitcnt vmcnt(29)
    s_barrier
    s_add_u32 m0, s40, 20480
    s_add_u32 s64, s72, 0x0
    buffer_load_dwordx4 v76, s[48:51], s64 offen lds
    s_add_u32 m0, s40, 21504
    s_add_u32 s64, s72, 0x8000
    buffer_load_dwordx4 v77, s[48:51], s64 offen lds
    s_add_u32 m0, s40, 22528
    s_add_u32 s64, s72, 0x10000
    buffer_load_dwordx4 v78, s[48:51], s64 offen lds
    s_add_u32 m0, s40, 23552
    s_add_u32 s64, s72, 0x18000
    buffer_load_dwordx4 v79, s[48:51], s64 offen lds
    ds_read_b64_tr_b16 a[208:209], v93 offset:24576
    ds_read_b64_tr_b16 a[210:211], v93 offset:24832
    ds_read_b64_tr_b16 a[212:213], v93 offset:25600
    ds_read_b64_tr_b16 a[214:215], v93 offset:25856
    ds_read_b64_tr_b16 a[216:217], v93 offset:26624
    ds_read_b64_tr_b16 a[218:219], v93 offset:26880
    ds_read_b64_tr_b16 a[220:221], v93 offset:27648
    ds_read_b64_tr_b16 a[222:223], v93 offset:27904
    s_waitcnt lgkmcnt(0)
    s_waitcnt vmcnt(29)
    s_barrier
    s_add_u32 m0, s40, 24576
    s_add_u32 s64, s72, 0x80000
    buffer_load_dwordx4 v76, s[48:51], s64 offen lds
    s_add_u32 m0, s40, 25600
    s_add_u32 s64, s72, 0x88000
    buffer_load_dwordx4 v77, s[48:51], s64 offen lds
    s_add_u32 m0, s40, 26624
    s_add_u32 s64, s72, 0x90000
    buffer_load_dwordx4 v78, s[48:51], s64 offen lds
    s_add_u32 m0, s40, 27648
    s_add_u32 s64, s72, 0x98000
    buffer_load_dwordx4 v79, s[48:51], s64 offen lds
    ds_read_b64_tr_b16 a[224:225], v94 offset:28672
    ds_read_b64_tr_b16 a[226:227], v94 offset:28800
    ds_read_b64_tr_b16 a[228:229], v94 offset:29696
    ds_read_b64_tr_b16 a[230:231], v94 offset:29824
    ds_read_b64_tr_b16 a[232:233], v94 offset:30720
    ds_read_b64_tr_b16 a[234:235], v94 offset:30848
    ds_read_b64_tr_b16 a[236:237], v94 offset:31744
    ds_read_b64_tr_b16 a[238:239], v94 offset:31872
    s_waitcnt lgkmcnt(0)
    s_waitcnt vmcnt(29)
    s_barrier
    s_add_u32 m0, s40, 28672
    s_add_u32 s64, s72, 0x100000
    buffer_load_dwordx4 v76, s[48:51], s64 offen lds
    s_add_u32 m0, s40, 29696
    s_add_u32 s64, s72, 0x108000
    buffer_load_dwordx4 v77, s[48:51], s64 offen lds
    s_add_u32 m0, s40, 30720
    s_add_u32 s64, s72, 0x110000
    buffer_load_dwordx4 v78, s[48:51], s64 offen lds
    s_add_u32 m0, s40, 31744
    s_add_u32 s64, s72, 0x118000
    buffer_load_dwordx4 v79, s[48:51], s64 offen lds
    s_mov_b32 s65, 0x290800
    buffer_load_dword v84, off, s[4:7], s65 sc1
    buffer_load_dwordx2 v[82:83], off, s[4:7], s69 sc1
    ds_read_b64_tr_b16 v[12:13], v72 offset:32768
    ds_read_b64_tr_b16 v[14:15], v72 offset:33280
    ds_read_b64_tr_b16 v[16:17], v73 offset:32768
    ds_read_b64_tr_b16 v[18:19], v73 offset:33280
    ds_read_b64_tr_b16 v[20:21], v74 offset:32768
    ds_read_b64_tr_b16 v[22:23], v74 offset:33280
    ds_read_b64_tr_b16 v[24:25], v75 offset:32768
    ds_read_b64_tr_b16 v[26:27], v75 offset:33280
    s_waitcnt lgkmcnt(0)
    s_barrier
    ds_write_b128 v2, v[12:15] offset:32768
    ds_write_b128 v2, v[16:19] offset:33792
    ds_write_b128 v2, v[20:23] offset:34816
    ds_write_b128 v2, v[24:27] offset:35840
    s_waitcnt lgkmcnt(0)
    s_waitcnt vmcnt(30)
    s_barrier
    ds_read_b64_tr_b16 v[12:13], v72 offset:0
    ds_read_b64_tr_b16 v[14:15], v72 offset:512
    ds_read_b64_tr_b16 v[16:17], v73 offset:0
    ds_read_b64_tr_b16 v[18:19], v73 offset:512
    ds_read_b64_tr_b16 v[20:21], v74 offset:0
    ds_read_b64_tr_b16 v[22:23], v74 offset:512
    ds_read_b64_tr_b16 v[24:25], v75 offset:0
    ds_read_b64_tr_b16 v[26:27], v75 offset:512
    s_waitcnt lgkmcnt(0)
    s_barrier
    ds_write_b128 v2, v[12:15] offset:0
    ds_write_b128 v2, v[16:19] offset:1024
    ds_write_b128 v2, v[20:23] offset:2048
    ds_write_b128 v2, v[24:27] offset:3072
    s_waitcnt lgkmcnt(0)
    s_waitcnt vmcnt(26)
    s_barrier
    ds_read_b64_tr_b16 v[12:13], v72 offset:4096
    ds_read_b64_tr_b16 v[14:15], v72 offset:4608
    ds_read_b64_tr_b16 v[16:17], v73 offset:4096
    ds_read_b64_tr_b16 v[18:19], v73 offset:4608
    ds_read_b64_tr_b16 v[20:21], v74 offset:4096
    ds_read_b64_tr_b16 v[22:23], v74 offset:4608
    ds_read_b64_tr_b16 v[24:25], v75 offset:4096
    ds_read_b64_tr_b16 v[26:27], v75 offset:4608
    s_waitcnt lgkmcnt(0)
    s_barrier
    ds_write_b128 v2, v[12:15] offset:4096
    ds_write_b128 v2, v[16:19] offset:5120
    ds_write_b128 v2, v[20:23] offset:6144
    ds_write_b128 v2, v[24:27] offset:7168
    s_waitcnt lgkmcnt(0)
    s_waitcnt vmcnt(22)
    s_barrier
    ds_read_b64_tr_b16 v[12:13], v72 offset:8192
    ds_read_b64_tr_b16 v[14:15], v72 offset:8704
    ds_read_b64_tr_b16 v[16:17], v73 offset:8192
    ds_read_b64_tr_b16 v[18:19], v73 offset:8704
    ds_read_b64_tr_b16 v[20:21], v74 offset:8192
    ds_read_b64_tr_b16 v[22:23], v74 offset:8704
    ds_read_b64_tr_b16 v[24:25], v75 offset:8192
    ds_read_b64_tr_b16 v[26:27], v75 offset:8704
    s_waitcnt lgkmcnt(0)
    s_barrier
    ds_write_b128 v2, v[12:15] offset:8192
    ds_write_b128 v2, v[16:19] offset:9216
    ds_write_b128 v2, v[20:23] offset:10240
    ds_write_b128 v2, v[24:27] offset:11264
    s_waitcnt lgkmcnt(0)
    s_waitcnt vmcnt(18)
    s_barrier
    ds_read_b64_tr_b16 v[12:13], v72 offset:12288
    ds_read_b64_tr_b16 v[14:15], v72 offset:12800
    ds_read_b64_tr_b16 v[16:17], v73 offset:12288
    ds_read_b64_tr_b16 v[18:19], v73 offset:12800
    ds_read_b64_tr_b16 v[20:21], v74 offset:12288
    ds_read_b64_tr_b16 v[22:23], v74 offset:12800
    ds_read_b64_tr_b16 v[24:25], v75 offset:12288
    ds_read_b64_tr_b16 v[26:27], v75 offset:12800
    s_waitcnt lgkmcnt(0)
    s_barrier
    ds_write_b128 v2, v[12:15] offset:12288
    ds_write_b128 v2, v[16:19] offset:13312
    ds_write_b128 v2, v[20:23] offset:14336
    ds_write_b128 v2, v[24:27] offset:15360
    s_waitcnt lgkmcnt(0)
    s_waitcnt vmcnt(14)
    s_barrier
    ds_read_b64_tr_b16 v[12:13], v72 offset:16384
    ds_read_b64_tr_b16 v[14:15], v72 offset:16896
    ds_read_b64_tr_b16 v[16:17], v73 offset:16384
    ds_read_b64_tr_b16 v[18:19], v73 offset:16896
    ds_read_b64_tr_b16 v[20:21], v74 offset:16384
    ds_read_b64_tr_b16 v[22:23], v74 offset:16896
    ds_read_b64_tr_b16 v[24:25], v75 offset:16384
    ds_read_b64_tr_b16 v[26:27], v75 offset:16896
    s_waitcnt lgkmcnt(0)
    s_barrier
    ds_write_b128 v2, v[12:15] offset:16384
    ds_write_b128 v2, v[16:19] offset:17408
    ds_write_b128 v2, v[20:23] offset:18432
    ds_write_b128 v2, v[24:27] offset:19456
    s_waitcnt lgkmcnt(0)
    s_waitcnt vmcnt(10)
    s_barrier
    ds_read_b64_tr_b16 v[12:13], v72 offset:20480
    ds_read_b64_tr_b16 v[14:15], v72 offset:20992
    ds_read_b64_tr_b16 v[16:17], v73 offset:20480
    ds_read_b64_tr_b16 v[18:19], v73 offset:20992
    ds_read_b64_tr_b16 v[20:21], v74 offset:20480
    ds_read_b64_tr_b16 v[22:23], v74 offset:20992
    ds_read_b64_tr_b16 v[24:25], v75 offset:20480
    ds_read_b64_tr_b16 v[26:27], v75 offset:20992
    s_waitcnt lgkmcnt(0)
    s_barrier
    ds_write_b128 v2, v[12:15] offset:20480
    ds_write_b128 v2, v[16:19] offset:21504
    ds_write_b128 v2, v[20:23] offset:22528
    ds_write_b128 v2, v[24:27] offset:23552
    s_waitcnt lgkmcnt(0)
    s_waitcnt vmcnt(6)
    s_barrier
    ds_read_b64_tr_b16 v[12:13], v72 offset:24576
    ds_read_b64_tr_b16 v[14:15], v72 offset:25088
    ds_read_b64_tr_b16 v[16:17], v73 offset:24576
    ds_read_b64_tr_b16 v[18:19], v73 offset:25088
    ds_read_b64_tr_b16 v[20:21], v74 offset:24576
    ds_read_b64_tr_b16 v[22:23], v74 offset:25088
    ds_read_b64_tr_b16 v[24:25], v75 offset:24576
    ds_read_b64_tr_b16 v[26:27], v75 offset:25088
    s_waitcnt lgkmcnt(0)
    s_barrier
    ds_write_b128 v2, v[12:15] offset:24576
    ds_write_b128 v2, v[16:19] offset:25600
    ds_write_b128 v2, v[20:23] offset:26624
    ds_write_b128 v2, v[24:27] offset:27648
    s_waitcnt lgkmcnt(0)
    s_waitcnt vmcnt(2)
    s_barrier
    ds_read_b64_tr_b16 v[12:13], v72 offset:28672
    ds_read_b64_tr_b16 v[14:15], v72 offset:29184
    ds_read_b64_tr_b16 v[16:17], v73 offset:28672
    ds_read_b64_tr_b16 v[18:19], v73 offset:29184
    ds_read_b64_tr_b16 v[20:21], v74 offset:28672
    ds_read_b64_tr_b16 v[22:23], v74 offset:29184
    ds_read_b64_tr_b16 v[24:25], v75 offset:28672
    ds_read_b64_tr_b16 v[26:27], v75 offset:29184
    s_waitcnt lgkmcnt(0)
    s_barrier
    ds_write_b128 v2, v[12:15] offset:28672
    ds_write_b128 v2, v[16:19] offset:29696
    ds_write_b128 v2, v[20:23] offset:30720
    ds_write_b128 v2, v[24:27] offset:31744
    s_waitcnt lgkmcnt(0)
    s_waitcnt vmcnt(0)
    s_cmp_lg_u32 s97, 0
    s_cbranch_scc1 NOTEARLY_8
    v_cmp_ne_u32 vcc, 32, v81
    v_readlane_b32 s64, v81, 1
    v_readlane_b32 s66, v81, 33
    v_readlane_b32 s67, v81, 34
    s_and_b32 s65, vcc_lo, 0x01010101
    s_cbranch_scc1 NOTEARLY_8
    s_and_b32 s65, vcc_hi, 0x01010101
    s_cbranch_scc1 NOTEARLY_8
    s_cmp_lt_u32 s64, 186
    s_cbranch_scc1 NOTEARLY_8
    v_readfirstlane_b32 s64, v84
    s_cmp_lt_u32 s64, 192
    s_cbranch_scc1 NOTEARLY_8
    s_min_u32 s65, s66, s67
    s_cmp_eq_u32 s65, 0
    s_cbranch_scc1 NOTEARLY_8
    v_readlane_b32 s64, v81, 6
    v_readlane_b32 s65, v81, 7
    s_and_b32 s64, s64, s65
    s_cmp_eq_u32 s64, -1
    s_cselect_b32 s64, 0, s94
    s_cmp_lg_u32 s64, 0
    s_cbranch_scc1 M_GFAIL
    s_sub_u32 s66, s66, 1
    s_sub_u32 s67, s67, 1
    s_branch EARLY_7
NOTEARLY_8:
    s_cmp_lg_u32 s97, 0
    s_cbranch_scc1 CM_9
    v_mbcnt_lo_u32_b32 v0, -1, 0
    v_mbcnt_hi_u32_b32 v0, -1, v0
    v_mul_u32_u24 v8, 32, v0
    s_mov_b32 s64, 0x0
    s_mov_b32 s65, 0
    s_mov_b64 exec, 0xff
TK_10:
    buffer_load_dword v9, v8, s[60:63], s64 offen sc1
    s_add_u32 s65, s65, 1
    s_waitcnt vmcnt(0)
    s_mov_b32 s66, 0
    v_readlane_b32 s67, v9, 0
    s_add_u32 s66, s66, s67
    v_readlane_b32 s67, v9, 1
    s_add_u32 s66, s66, s67
    v_readlane_b32 s67, v9, 2
    s_add_u32 s66, s66, s67
    v_readlane_b32 s67, v9, 3
    s_add_u32 s66, s66, s67
    v_readlane_b32 s67, v9, 4
    s_add_u32 s66, s66, s67
    v_readlane_b32 s67, v9, 5
    s_add_u32 s66, s66, s67
    v_readlane_b32 s67, v9, 6
    s_add_u32 s66, s66, s67
    v_readlane_b32 s67, v9, 7
    s_add_u32 s66, s66, s67
    s_cmp_ge_u32 s66, 256
    s_cbranch_scc1 TKD_11
    s_cmp_gt_u32 s65, 262144
    s_cbranch_scc0 TK_10
TKD_11:
    v_cmp_ne_u32 vcc, 32, v9
    s_mov_b64 exec, -1
    s_cbranch_vccnz M_SLOW
CM_9:
    s_mov_b32 s65, 0
RI_12:
    buffer_load_dword v8, off, s[60:63], s95 sc1
    s_add_u32 s65, s65, 1
    s_waitcnt vmcnt(0)
    v_readfirstlane_b32 s64, v8
    s_cmp_ge_u32 s64, 186
    s_cbranch_scc1 RID_13
    s_cmp_gt_u32 s65, 65536
    s_cbranch_scc1 RID_13
    s_sleep 4
    s_branch RI_12
RID_13:
    s_mov_b32 s65, 0
    s_mov_b32 s66, 0x290800
RB_14:
    buffer_load_dword v8, off, s[4:7], s66 sc1
    s_add_u32 s65, s65, 1
    s_waitcnt vmcnt(0)
    v_readfirstlane_b32 s64, v8
    s_cmp_ge_u32 s64, 192
    s_cbranch_scc1 RBD_15
    s_cmp_gt_u32 s65, 65536
    s_cbranch_scc1 RBD_15
    s_sleep 8
    s_branch RB_14
RBD_15:
    s_cmp_eq_u32 s94, 0
    s_cbranch_scc1 GOK_16
    buffer_load_dwordx2 v[8:9], off, s[60:63], 0 offset:24 sc1
    s_waitcnt vmcnt(0)
    v_and_b32 v8, v8, v9
    s_nop 0
    v_readfirstlane_b32 s64, v8
    s_cmp_lg_u32 s64, -1
    s_cbranch_scc1 M_GFAIL
GOK_16:
    s_mov_b32 s65, 0
CW_17:
    buffer_load_dwordx2 v[8:9], off, s[60:63], 0 offset:132 sc1
    s_add_u32 s65, s65, 1
    s_waitcnt vmcnt(0)
    v_readfirstlane_b32 s66, v8
    v_readfirstlane_b32 s67, v9
    s_min_u32 s64, s66, s67
    s_cmp_lg_u32 s64, 0
    s_cbranch_scc1 CWD_18
    s_cmp_gt_u32 s65, 65536
    s_cbranch_scc1 CWD_18
    s_sleep 4
    s_branch CW_17
CWD_18:
    s_sub_u32 s66, s66, 1
    s_and_b32 s66, s66, 3
    s_sub_u32 s67, s67, 1
    s_and_b32 s67, s67, 3
EARLY_7:
    s_mov_b32 s56, s66
    s_mov_b32 s57, s67
    s_mov_b32 s38, 0x3f80
    s_mov_b32 s53, 0
    s_cmp_eq_u32 s14, 2
    s_cselect_b32 s52, 1024, 0
    s_cmp_eq_u32 s14, 3
    s_cselect_b32 s58, 0, 1
    s_mov_b32 s59, 0
    s_cmp_eq_u32 s12, 0
    s_cselect_b32 s55, 2, 0
    s_mov_b32 s44, 0x3030303
    s_mov_b32 s45, 0x3030303
    s_mov_b32 s46, 0xc0c0c0c
    s_mov_b32 s47, 0xc0c0c0c
    s_mov_b32 s48, 0x30303030
    s_mov_b32 s49, 0x30303030
    s_mov_b32 s50, 0xc0c0c0c0
    s_mov_b32 s51, 0xc0c0c0c0
    v_and_b32 v8, 7, v0
    v_mul_u32_u24 v8, 288, v8
    v_lshrrev_b32 v9, 4, v0
    v_lshl_add_u32 v8, v9, 4, v8
    v_add_u32 v0, 12800, v8
    s_mov_b32 s68, 0
    s_mov_b32 s40, 0
    s_mov_b32 s64, s56
    s_mov_b32 s65, s57
    s_cmp_eq_u32 s12, 0
    s_cselect_b32 s66, s65, s64
    s_cselect_b32 s64, s64, s65
    s_and_b32 s64, s64, 3
    s_lshl_b32 s64, s64, 13
    s_and_b32 s66, s66, 3
    s_lshl_b32 s66, s66, 13
    s_add_u32 s21, s21, s64
    s_add_u32 s20, s20, s66
    s_cmp_eq_u32 s42, 0
    s_cselect_b32 s18, 0x40000000, s18
    s_cselect_b32 s21, 0x40000000, s21
    s_lshl_b32 s65, s12, 7
    s_add_u32 s65, s65, 0x29a000
    s_cmp_eq_u32 s22, 0
    s_cselect_b32 s22, 0x40000000, s65
    s_lshl_b32 s64, s13, 2
    s_add_u32 s64, s64, s14
    s_cmp_ge_u32 s64, 40
    s_cselect_b32 s65, 40, 0
    s_sub_u32 s64, s64, s65
    s_cmp_ge_u32 s64, 40
    s_cselect_b32 s65, 40, 0
    s_sub_u32 s64, s64, s65
    s_cmp_ge_u32 s64, 40
    s_cselect_b32 s65, 40, 0
    s_sub_u32 s64, s64, s65
    s_lshl_b32 s27, s64, 7
    s_add_u32 s19, s27, 0x4000
    v_and_b32 v82, v82, v83
    v_cmp_eq_u32 vcc, 0, v82
    s_cmp_lg_u32 s97, 0
    s_cselect_b64 vcc, -1, vcc
    s_cbranch_vccz KVOK_19
    v_mov_b32 v29, 0
FSPIN_20:
    buffer_load_dwordx2 v[12:13], v29, s[4:7], s69 offen sc1
    s_add_u32 s68, s68, 1
    s_waitcnt vmcnt(0)
    v_and_b32 v12, v12, v13
    v_cmp_eq_u32 vcc, 0, v12
    s_cbranch_vccz FDONE_21
    s_cmp_gt_u32 s68, 262144
    s_cbranch_scc0 FSPIN_20
FDONE_21:
KVOK_19:
    s_barrier
    s_mov_b32 m0, s73
    s_nop 0
    buffer_load_dwordx4 v1, s[4:7], s28 offen lds
    buffer_load_dwordx4 v1, s[4:7], s28 offen offset:1024 lds
    s_mov_b32 m0, 16128
    v_lshlrev_b32 v12, 2, v1
    s_add_u32 s65, s3, 0xfff80000
    buffer_load_dword v12, s[4:7], s65 offen lds
    s_mov_b32 s15, 0
    s_mov_b32 s16, 0
    s_add_u32 s66, s17, s52
    buffer_load_dwordx4 v[12:15], v1, s[4:7], s66 offen sc1
    buffer_load_dwordx4 v[16:19], v1, s[4:7], s17 offen offset:2048 sc1
    v_add_u32 v29, s52, v1
    s_waitcnt vmcnt(0)
    ds_write_b128 v29, v[12:15] offset:12800
    ds_write_b128 v1, v[16:19] offset:15104
    s_waitcnt lgkmcnt(0)
    v_mov_b64 v[32:33], 0
    v_mov_b64 v[34:35], 0
    v_mov_b64 v[36:37], 0
    v_mov_b64 v[38:39], 0
    v_mov_b64 v[40:41], 0
    v_mov_b64 v[42:43], 0
    v_mov_b64 v[44:45], 0
    v_mov_b64 v[46:47], 0
    v_mov_b64 v[48:49], 0
    v_mov_b64 v[50:51], 0
    v_mov_b64 v[52:53], 0
    v_mov_b64 v[54:55], 0
    v_mov_b32 v9, 0x40000000
    ds_read_b128 v[56:59], v2 offset:0
    ds_read_b128 v[60:63], v2 offset:1024
    ds_read_b128 v[64:67], v2 offset:2048
    ds_read_b128 v[68:71], v2 offset:3072
    s_cmp_eq_u32 s97, 0
    s_cbranch_scc1 REC_LOOP
    s_branch REC_LOOP_S
REC_POLL_S:
    s_cmp_eq_u32 s59, 0
    s_cbranch_scc1 NOFLG_22
    s_waitcnt vmcnt(0)
    v_lshrrev_b32 v29, 2, v1
    ds_read_b32 v12, v29 offset:15104
    s_add_u32 s64, s15, 2
    s_lshr_b32 s65, s64, 1
    s_add_u32 s67, s65, 1
    s_waitcnt lgkmcnt(0)
    v_cmp_ne_u32 vcc, 0, v12
    v_readlane_b32 s65, v12, s65
    v_readlane_b32 s67, v12, s67
    s_cmp_eq_u32 vcc_lo, -1
    s_cselect_b32 s58, 1, 0
    s_and_b32 s65, s65, s67
    s_cbranch_scc1 NOFLG_22
    s_lshl_b32 s64, s64, 7
    s_add_u32 s64, s64, s69
    v_mov_b32 v29, 0
FSPIN_24:
    buffer_load_dwordx2 v[12:13], v29, s[4:7], s64 offen sc1
    s_add_u32 s68, s68, 1
    s_waitcnt vmcnt(0)
    v_and_b32 v12, v12, v13
    v_cmp_eq_u32 vcc, 0, v12
    s_cbranch_vccz FDONE_25
    s_cmp_gt_u32 s68, 262144
    s_cbranch_scc0 FSPIN_24
FDONE_25:
NOFLG_22:
    s_add_u32 s64, s15, 3
    s_and_b32 s64, s64, 0x43
    s_or_b32 s64, s64, s58
    s_cmp_eq_u32 s64, 0
    s_cselect_b32 s59, 1, 0
    s_cmp_eq_u32 s15, 63
    s_cselect_b32 s59, s55, s59
    s_add_u32 s66, s17, s52
    v_add_u32 v10, s52, v1
    s_xor_b32 s16, s16, 1
    v_mov_b64 v[32:33], 0
    v_mov_b64 v[34:35], 0
    v_mov_b64 v[36:37], 0
    v_mov_b64 v[38:39], 0
    v_mov_b64 v[40:41], 0
    v_mov_b64 v[42:43], 0
    v_mov_b64 v[44:45], 0
    v_mov_b64 v[46:47], 0
    v_mov_b64 v[48:49], 0
    v_mov_b64 v[50:51], 0
    v_mov_b64 v[52:53], 0
    v_mov_b64 v[54:55], 0
    ds_read_b128 v[56:59], v2 offset:0
    ds_read_b128 v[60:63], v2 offset:1024
    ds_read_b128 v[64:67], v2 offset:2048
    ds_read_b128 v[68:71], v2 offset:3072
    s_barrier
    s_nop 14
    buffer_load_dwordx4 v[20:23], v1, s[4:7], s66 offen offset:0 sc1
    s_nop 7
    buffer_load_dwordx4 v[24:27], v1, s[4:7], s66 offen offset:0 sc1
    s_nop 7
    buffer_load_dwordx4 v[28:31], v1, s[4:7], s66 offen offset:0 sc1
IPOLL_27:
    s_waitcnt vmcnt(2)
    ds_write_b128 v10, v[20:23] offset:12800
    v_max3_u32 v11, v20, v21, v22
    v_max_u32 v11, v11, v23
    v_cmp_eq_u32 vcc, -1, v11
    s_cbranch_vccz IOK_26
    buffer_load_dwordx4 v[20:23], v1, s[4:7], s66 offen offset:0 sc1
    s_waitcnt vmcnt(2)
    ds_write_b128 v10, v[24:27] offset:12800
    v_max3_u32 v11, v24, v25, v26
    v_max_u32 v11, v11, v27
    v_cmp_eq_u32 vcc, -1, v11
    s_cbranch_vccz IOK_26
    buffer_load_dwordx4 v[24:27], v1, s[4:7], s66 offen offset:0 sc1
    s_waitcnt vmcnt(2)
    ds_write_b128 v10, v[28:31] offset:12800
    v_max3_u32 v11, v28, v29, v30
    v_max_u32 v11, v11, v31
    v_cmp_eq_u32 vcc, -1, v11
    s_add_u32 s68, s68, 1
    s_add_u32 s53, s53, 1
    s_cmp_gt_u32 s68, 262144
    s_cbranch_scc1 IOK_26
    s_cbranch_vccz IOK_26
    buffer_load_dwordx4 v[28:31], v1, s[4:7], s66 offen offset:0 sc1
    s_branch IPOLL_27
IOK_26:
    s_waitcnt lgkmcnt(0)
REC_LOOP_S:
    s_barrier
    ds_read_b128 v[12:15], v1 offset:12800
    ds_read_b128 v[16:19], v1 offset:13824
    buffer_load_dwordx4 v[20:23], v1, s[4:7], s17 offen offset:2048
    ds_read_b128 v[72:75], v2 offset:4096
    ds_read_b128 v[76:79], v2 offset:5120
    ds_read_b128 v[80:83], v2 offset:6144
    ds_read_b128 v[84:87], v2 offset:7168
    s_add_u32 s74, s17, 0x1000
    s_add_u32 s20, s20, 0x8000
    s_add_u32 s75, s20, 0x1000
    s_mov_b32 m0, 16128
    s_add_u32 s65, s20, s27
    s_waitcnt lgkmcnt(5)
    v_smfmac_f32_16x16x64_bf16 v[32:35], v[12:15], v[96:103], v6
    buffer_load_dwordx4 v[24:27], v1, s[4:7], s17 offen offset:3072
    v_smfmac_f32_16x16x64_bf16 v[36:39], v[12:15], v[104:111], v6
    v_smfmac_f32_16x16x64_bf16 v[40:43], v[12:15], v[56:63], v6
    buffer_load_dwordx4 v[28:31], v1, s[4:7], s74 offen offset:0
    ds_read_b128 v[56:59], v2 offset:8192
    ds_read_b128 v[60:63], v2 offset:9216
    v_smfmac_f32_16x16x64_bf16 v[44:47], v[12:15], v[64:71], v6
    ds_read_b128 v[64:67], v2 offset:10240
    ds_read_b128 v[68:71], v2 offset:11264
    s_waitcnt lgkmcnt(8)
    v_smfmac_f32_16x16x64_bf16 v[48:51], v[12:15], a[0:7], v6
    v_smfmac_f32_16x16x64_bf16 v[52:55], v[12:15], a[8:15], v6
    buffer_load_dwordx4 v[12:15], v1, s[4:7], s20 offen offset:0
    buffer_load_dword off, s[4:7], s65 lds
    v_smfmac_f32_16x16x64_bf16 v[32:35], v[16:19], v[112:119], v6
    v_smfmac_f32_16x16x64_bf16 v[36:39], v[16:19], v[120:127], v6
    s_waitcnt lgkmcnt(4)
    v_smfmac_f32_16x16x64_bf16 v[40:43], v[16:19], v[72:79], v6
    ds_read_b128 v[72:75], v2 offset:12288
    ds_read_b128 v[76:79], v2 offset:13312
    v_smfmac_f32_16x16x64_bf16 v[44:47], v[16:19], v[80:87], v6
    ds_read_b128 v[80:83], v2 offset:14336
    ds_read_b128 v[84:87], v2 offset:15360
    s_waitcnt vmcnt(4)
    v_cmp_eq_u32 vcc, -1, v23
    v_smfmac_f32_16x16x64_bf16 v[48:51], v[16:19], a[16:23], v6
    v_smfmac_f32_16x16x64_bf16 v[52:55], v[16:19], a[24:31], v6
    s_cbranch_vccnz RETRY_28
BACK_29:
    buffer_load_dwordx4 v[16:19], v1, s[4:7], s20 offen offset:1024
    v_smfmac_f32_16x16x64_bf16 v[32:35], v[20:23], v[128:135], v6
    v_smfmac_f32_16x16x64_bf16 v[36:39], v[20:23], v[136:143], v6
    s_waitcnt lgkmcnt(4)
    v_smfmac_f32_16x16x64_bf16 v[40:43], v[20:23], v[56:63], v6
    ds_read_b128 v[56:59], v2 offset:16384
    ds_read_b128 v[60:63], v2 offset:17408
    v_smfmac_f32_16x16x64_bf16 v[44:47], v[20:23], v[64:71], v6
    ds_read_b128 v[64:67], v2 offset:18432
    ds_read_b128 v[68:71], v2 offset:19456
    s_waitcnt vmcnt(4)
    v_cmp_eq_u32 vcc, -1, v27
    v_smfmac_f32_16x16x64_bf16 v[48:51], v[20:23], a[32:39], v6
    v_smfmac_f32_16x16x64_bf16 v[52:55], v[20:23], a[40:47], v6
    s_cbranch_vccnz RETRY_30
BACK_31:
    buffer_load_dwordx4 v[20:23], v1, s[4:7], s20 offen offset:2048
    v_smfmac_f32_16x16x64_bf16 v[32:35], v[24:27], v[144:151], v6
    v_smfmac_f32_16x16x64_bf16 v[36:39], v[24:27], v[152:159], v6
    s_waitcnt lgkmcnt(4)
    v_smfmac_f32_16x16x64_bf16 v[40:43], v[24:27], v[72:79], v6
    ds_read_b128 v[72:75], v2 offset:20480
    ds_read_b128 v[76:79], v2 offset:21504
    v_smfmac_f32_16x16x64_bf16 v[44:47], v[24:27], v[80:87], v6
    ds_read_b128 v[80:83], v2 offset:22528
    ds_read_b128 v[84:87], v2 offset:23552
    s_waitcnt vmcnt(4)
    v_cmp_eq_u32 vcc, -1, v31
    v_smfmac_f32_16x16x64_bf16 v[48:51], v[24:27], a[48:55], v6
    v_smfmac_f32_16x16x64_bf16 v[52:55], v[24:27], a[56:63], v6
    s_cbranch_vccnz RETRY_32
BACK_33:
    buffer_load_dwordx4 v[24:27], v1, s[4:7], s20 offen offset:3072
    v_smfmac_f32_16x16x64_bf16 v[32:35], v[28:31], v[160:167], v6
    v_smfmac_f32_16x16x64_bf16 v[36:39], v[28:31], v[168:175], v6
    s_waitcnt lgkmcnt(4)
    v_smfmac_f32_16x16x64_bf16 v[40:43], v[28:31], v[56:63], v6
    ds_read_b128 v[56:59], v2 offset:24576
    ds_read_b128 v[60:63], v2 offset:25600
    v_smfmac_f32_16x16x64_bf16 v[44:47], v[28:31], v[64:71], v6
    ds_read_b128 v[64:67], v2 offset:26624
    ds_read_b128 v[68:71], v2 offset:27648
    s_waitcnt vmcnt(4)
    v_cmp_eq_u32 vcc, -1, v15
    v_smfmac_f32_16x16x64_bf16 v[48:51], v[28:31], a[64:71], v6
    v_smfmac_f32_16x16x64_bf16 v[52:55], v[28:31], a[72:79], v6
    s_cbranch_vccnz RETRY_34
BACK_35:
    buffer_load_dwordx4 v[28:31], v1, s[4:7], s75 offen offset:0
    v_smfmac_f32_16x16x64_bf16 v[32:35], v[12:15], v[176:183], v6
    s_waitcnt vmcnt(3)
    v_cmp_eq_u32 vcc, -1, v19
    v_smfmac_f32_16x16x64_bf16 v[36:39], v[12:15], v[184:191], v6
    s_waitcnt lgkmcnt(4)
    v_smfmac_f32_16x16x64_bf16 v[40:43], v[12:15], v[72:79], v6
    ds_read_b128 v[72:75], v2 offset:28672
    ds_read_b128 v[76:79], v2 offset:29696
    v_smfmac_f32_16x16x64_bf16 v[44:47], v[12:15], v[80:87], v6
    ds_read_b128 v[80:83], v2 offset:30720
    ds_read_b128 v[84:87], v2 offset:31744
    buffer_load_dwordx4 v[88:91], v1, s[4:7], s29 offen offset:0
    s_cbranch_vccnz RETRY_36
BACK_37:
    v_smfmac_f32_16x16x64_bf16 v[32:35], v[16:19], v[192:199], v6
    s_waitcnt vmcnt(3)
    v_cmp_eq_u32 vcc, -1, v23
    v_smfmac_f32_16x16x64_bf16 v[36:39], v[16:19], v[200:207], v6
    s_waitcnt lgkmcnt(4)
    v_smfmac_f32_16x16x64_bf16 v[40:43], v[16:19], v[56:63], v6
    ds_read_b128 v[56:59], v2 offset:32768
    ds_read_b128 v[60:63], v2 offset:33792
    v_smfmac_f32_16x16x64_bf16 v[44:47], v[16:19], v[64:71], v6
    ds_read_b128 v[64:67], v2 offset:34816
    ds_read_b128 v[68:71], v2 offset:35840
    s_cbranch_vccnz RETRY_38
BACK_39:
    v_smfmac_f32_16x16x64_bf16 v[32:35], v[20:23], v[208:215], v6
    s_waitcnt vmcnt(2)
    v_cmp_eq_u32 vcc, -1, v27
    v_smfmac_f32_16x16x64_bf16 v[36:39], v[20:23], v[216:223], v6
    s_waitcnt lgkmcnt(4)
    v_smfmac_f32_16x16x64_bf16 v[40:43], v[20:23], v[72:79], v6
    ds_read_b128 v[72:75], v1 offset:0
    ds_read_b128 v[76:79], v1 offset:4096
    v_smfmac_f32_16x16x64_bf16 v[44:47], v[20:23], v[80:87], v6
    ds_read_b128 v[80:83], v1 offset:1024
    ds_read_b128 v[84:87], v1 offset:5120
    buffer_load_dwordx4 v[92:95], v1, s[4:7], s29 offen offset:1024
    s_cbranch_vccnz RETRY_40
BACK_41:
    v_smfmac_f32_16x16x64_bf16 v[32:35], v[24:27], v[224:231], v6
    s_waitcnt vmcnt(2)
    v_cmp_eq_u32 vcc, -1, v31
    v_smfmac_f32_16x16x64_bf16 v[36:39], v[24:27], v[232:239], v6
    s_waitcnt lgkmcnt(4)
    v_smfmac_f32_16x16x64_bf16 v[40:43], v[24:27], v[56:63], v6
    ds_read_b128 v[56:59], v1 offset:2048
    ds_read_b128 v[60:63], v1 offset:6144
    v_smfmac_f32_16x16x64_bf16 v[44:47], v[24:27], v[64:71], v6
    ds_read_b128 v[64:67], v1 offset:3072
    ds_read_b128 v[68:71], v1 offset:7168
    s_cbranch_vccnz RETRY_42
BACK_43:
    v_smfmac_f32_16x16x64_bf16 v[32:35], v[28:31], v[240:247], v6
    v_smfmac_f32_16x16x64_bf16 v[36:39], v[28:31], v[248:255], v6
    v_smfmac_f32_16x16x64_bf16 v[40:43], v[28:31], a[240:247], v6
    v_smfmac_f32_16x16x64_bf16 v[44:47], v[28:31], a[248:255], v6
    v_lshlrev_b32 v8, 2, v1
    s_add_u32 s65, s17, s19
    buffer_load_dword v8, s[4:7], s3 offen lds
    buffer_load_dword off, s[4:7], s65 sc1 lds
    buffer_store_dword v6, off, s[4:7], s22 sc1
    s_add_u32 s22, s22, 256
    s_cmp_eq_u32 s59, 0
    s_cbranch_scc1 KVLOOK_44
    s_cmp_eq_u32 s59, 1
    s_cbranch_scc1 KVL1_45
    s_lshl_b32 s64, s13, 13
    s_add_u32 s64, s64, 0x43c0000
    buffer_load_dwordx4 v[96:99], v1, s[4:7], s64 offen offset:0
    buffer_load_dwordx4 v[100:103], v1, s[4:7], s64 offen offset:1024
    buffer_load_dwordx4 v[104:107], v1, s[4:7], s64 offen offset:2048
    buffer_load_dwordx4 v[108:111], v1, s[4:7], s64 offen offset:3072
    s_add_u32 s64, s64, 0x1000
    buffer_load_dwordx4 v[112:115], v1, s[4:7], s64 offen offset:0
    buffer_load_dwordx4 v[116:119], v1, s[4:7], s64 offen offset:1024
    buffer_load_dwordx4 v[120:123], v1, s[4:7], s64 offen offset:2048
    buffer_load_dwordx4 v[124:127], v1, s[4:7], s64 offen offset:3072
    s_branch KVLOOK_44
KVL1_45:
    v_lshrrev_b32 v9, 5, v1
    v_lshlrev_b32 v9, 9, v9
    v_bfe_u32 v10, v1, 4, 1
    v_lshl_add_u32 v9, v10, 2, v9
    s_mov_b32 m0, 15104
    s_mov_b64 exec, s[34:35]
    buffer_load_dword v9, s[4:7], s69 offen sc1 lds
    s_mov_b64 exec, -1
    s_mov_b32 m0, 16128
KVLOOK_44:
    v_permlane32_swap_b32 v32, v36
    v_permlane32_swap_b32 v33, v37
    v_permlane32_swap_b32 v34, v38
    v_permlane32_swap_b32 v35, v39
    v_pk_add_f32 v[32:33], v[32:33], v[36:37]
    v_pk_add_f32 v[34:35], v[34:35], v[38:39]
    v_cvt_pk_bf16_f32 v36, v32, v33
    v_cvt_pk_bf16_f32 v37, v34, v35
    ds_write_b64 v3, v[36:37] offset:0
    v_permlane32_swap_b32 v40, v44
    v_permlane32_swap_b32 v41, v45
    v_permlane32_swap_b32 v42, v46
    v_permlane32_swap_b32 v43, v47
    v_pk_add_f32 v[40:41], v[40:41], v[44:45]
    v_pk_add_f32 v[42:43], v[42:43], v[46:47]
    v_cvt_pk_bf16_f32 v44, v40, v41
    v_cvt_pk_bf16_f32 v45, v42, v43
    ds_write_b64 v3, v[44:45] offset:2304
    v_smfmac_f32_16x16x64_bf16 v[48:51], v[12:15], a[80:87], v6
    v_smfmac_f32_16x16x64_bf16 v[52:55], v[12:15], a[88:95], v6
    v_smfmac_f32_16x16x64_bf16 v[48:51], v[16:19], a[96:103], v6
    v_smfmac_f32_16x16x64_bf16 v[52:55], v[16:19], a[104:111], v6
    s_waitcnt lgkmcnt(0)
    s_barrier
    ds_read_b64_tr_b16 v[32:33], v4 offset:0
    ds_read_b64_tr_b16 v[34:35], v4 offset:128
    ds_read_b64_tr_b16 v[36:37], v4 offset:256
    ds_read_b64_tr_b16 v[38:39], v4 offset:384
    s_cmp_eq_u32 s15, 63
    s_cbranch_scc1 REC_FINAL
    v_smfmac_f32_16x16x64_bf16 v[48:51], v[20:23], a[112:119], v6
    v_smfmac_f32_16x16x64_bf16 v[52:55], v[20:23], a[120:127], v6
    ds_read_b64_tr_b16 v[40:41], v4 offset:512
    ds_read_b64_tr_b16 v[42:43], v4 offset:640
    ds_read_b64_tr_b16 v[44:45], v4 offset:768
    ds_read_b64_tr_b16 v[46:47], v4 offset:896
    v_smfmac_f32_16x16x64_bf16 v[48:51], v[24:27], a[128:135], v6
    v_smfmac_f32_16x16x64_bf16 v[52:55], v[24:27], a[136:143], v6
    s_waitcnt lgkmcnt(4)
    v_mfma_f32_16x16x32_bf16 v[8:11], v[72:75], v[32:35], 0
    ds_read_b64_tr_b16 v[12:13], v4 offset:2304
    ds_read_b64_tr_b16 v[14:15], v4 offset:2432
    v_mfma_f32_16x16x32_bf16 v[8:11], v[80:83], v[36:39], v[8:11]
    ds_read_b64_tr_b16 v[16:17], v4 offset:2560
    ds_read_b64_tr_b16 v[18:19], v4 offset:2688
    s_waitcnt lgkmcnt(4)
    v_mfma_f32_16x16x32_bf16 v[8:11], v[56:59], v[40:43], v[8:11]
    ds_read_b64_tr_b16 v[56:57], v4 offset:2816
    ds_read_b64_tr_b16 v[58:59], v4 offset:2944
    v_mfma_f32_16x16x32_bf16 v[8:11], v[64:67], v[44:47], v[8:11]
    ds_read_b64_tr_b16 v[64:65], v4 offset:3072
    ds_read_b64_tr_b16 v[66:67], v4 offset:3200
    v_mfma_f32_16x16x32_bf16 v[72:75], v[76:79], v[32:35], 0
    v_mfma_f32_16x16x32_bf16 v[72:75], v[84:87], v[36:39], v[72:75]
    v_mfma_f32_16x16x32_bf16 v[72:75], v[60:63], v[40:43], v[72:75]
    v_mfma_f32_16x16x32_bf16 v[72:75], v[68:71], v[44:47], v[72:75]
    s_waitcnt lgkmcnt(4)
    v_mfma_f32_16x16x32_bf16 v[80:83], v[12:15], v[32:35], 0
    v_mfma_f32_16x16x32_bf16 v[80:83], v[16:19], v[36:39], v[80:83]
    s_waitcnt lgkmcnt(0)
    v_mfma_f32_16x16x32_bf16 v[80:83], v[56:59], v[40:43], v[80:83]
    v_mfma_f32_16x16x32_bf16 v[80:83], v[64:67], v[44:47], v[80:83]
    v_smfmac_f32_16x16x64_bf16 v[48:51], v[28:31], a[144:151], v6
    v_smfmac_f32_16x16x64_bf16 v[52:55], v[28:31], a[152:159], v6
    v_mov_b32 v24, 0x3f803f80
    v_mov_b32 v25, 0x3f803f80
    v_mov_b32 v26, 0x3f803f80
    v_mov_b32 v27, 0x3f803f80
    v_max3_f32 v20, v8, v9, v10
    v_max3_f32 v21, v11, v72, v73
    v_max3_f32 v20, v20, v21, v74
    v_max3_f32 v21, v80, v81, v82
    v_max3_f32 v20, v20, v75, v83
    v_max_f32 v20, v20, v21
    v_mov_b32 v21, v20
    v_cvt_pk_bf16_f32 v48, v48, v49
    v_cvt_pk_bf16_f32 v49, v50, v51
    v_permlane16_swap_b32 v20, v21
    v_max_f32 v20, v20, v21
    v_mov_b32 v21, v20
    v_cvt_pk_bf16_f32 v50, v52, v53
    v_cvt_pk_bf16_f32 v51, v54, v55
    v_permlane32_swap_b32 v20, v21
    v_max_f32 v20, v20, v21
    v_mul_f32 v22, s10, v20
    v_pk_fma_f32 v[8:9], v[8:9], s[10:11], v[22:23] op_sel_hi:[1,1,0] neg_lo:[0,0,1] neg_hi:[0,0,1]
    v_pk_fma_f32 v[10:11], v[10:11], s[10:11], v[22:23] op_sel_hi:[1,1,0] neg_lo:[0,0,1] neg_hi:[0,0,1]
    v_pk_fma_f32 v[72:73], v[72:73], s[10:11], v[22:23] op_sel_hi:[1,1,0] neg_lo:[0,0,1] neg_hi:[0,0,1]
    v_pk_fma_f32 v[74:75], v[74:75], s[10:11], v[22:23] op_sel_hi:[1,1,0] neg_lo:[0,0,1] neg_hi:[0,0,1]
    v_pk_fma_f32 v[80:81], v[80:81], s[10:11], v[22:23] op_sel_hi:[1,1,0] neg_lo:[0,0,1] neg_hi:[0,0,1]
    v_pk_fma_f32 v[82:83], v[82:83], s[10:11], v[22:23] op_sel_hi:[1,1,0] neg_lo:[0,0,1] neg_hi:[0,0,1]
    v_exp_f32 v8, v8
    v_exp_f32 v9, v9
    v_exp_f32 v10, v10
    v_exp_f32 v11, v11
    v_exp_f32 v72, v72
    v_exp_f32 v73, v73
    v_exp_f32 v74, v74
    v_exp_f32 v75, v75
    v_cvt_pk_bf16_f32 v32, v8, v9
    v_cvt_pk_bf16_f32 v33, v10, v11
    v_exp_f32 v80, v80
    v_exp_f32 v81, v81
    v_exp_f32 v82, v82
    v_exp_f32 v83, v83
    v_cvt_pk_bf16_f32 v34, v72, v73
    v_cvt_pk_bf16_f32 v35, v74, v75
    v_cndmask_b32 v12, 0, v24, s[34:35]
    v_cndmask_b32 v13, 0, v24, s[34:35]
    s_waitcnt vmcnt(3)
    v_mfma_f32_16x16x32_bf16 v[8:11], v[24:27], v[32:35], 0
    v_cvt_pk_bf16_f32 v36, v80, v81
    v_mfma_f32_16x16x32_bf16 v[40:43], v[88:91], v[32:35], 0
    v_cvt_pk_bf16_f32 v37, v82, v83
    v_mfma_f32_16x16x32_bf16 v[44:47], v[92:95], v[32:35], 0
    v_mfma_f32_16x16x16_bf16 v[8:11], v[12:13], v[36:37], v[8:11]
    v_mov_b64 v[72:73], 0
    v_mfma_f32_16x16x16_bf16 v[40:43], v[48:49], v[36:37], v[40:43]
    v_mov_b64 v[74:75], 0
    v_mfma_f32_16x16x16_bf16 v[44:47], v[50:51], v[36:37], v[44:47]
    v_mov_b64 v[76:77], 0
    v_mov_b64 v[78:79], 0
    v_mov_b64 v[80:81], 0
    v_mov_b64 v[82:83], 0
    v_rcp_f32 v22, v8
    s_nop 2
    v_cndmask_b32 v40, v44, v40, s[32:33]
    v_cndmask_b32 v41, v45, v41, s[32:33]
    v_cndmask_b32 v42, v46, v42, s[32:33]
    v_cndmask_b32 v43, v47, v43, s[32:33]
    v_pk_mul_f32 v[40:41], v[40:41], v[22:23] op_sel_hi:[1,0]
    v_pk_mul_f32 v[42:43], v[42:43], v[22:23] op_sel_hi:[1,0]
    v_cvt_pk_bf16_f32 v44, v40, v41
    v_cvt_pk_bf16_f32 v45, v42, v43
    ds_write_b64 v5, v[44:45]
    s_mov_b32 m0, s73
    s_add_u32 s28, s28, 0x80000
    buffer_load_dwordx4 v1, s[4:7], s28 offen lds
    buffer_load_dwordx4 v1, s[4:7], s28 offen offset:1024 lds
    v_and_b32 v9, 0x70, v1
    v_bfe_u32 v29, v1, 8, 1
    v_lshl_add_u32 v9, v29, 3, v9
    v_bfe_u32 v29, v1, 9, 1
    v_lshl_add_u32 v9, v29, 2, v9
    v_mov_b32 v29, 0x40000000
    s_waitcnt lgkmcnt(0)
    s_barrier
    ds_read_b128 v[12:15], v0 offset:0
    ds_read_b128 v[16:19], v0 offset:64
    ds_read_b128 v[20:23], v0 offset:128
    ds_read_b128 v[24:27], v0 offset:192
    v_cndmask_b32 v9, v29, v9, s[32:33]
    v_and_b32 v29, 16, v1
    v_lshlrev_b32 v29, v29, s38
    v_cndmask_b32 v88, 0, v29, s[44:45]
    v_cndmask_b32 v89, 0, v29, s[46:47]
    v_cndmask_b32 v90, 0, v29, s[48:49]
    v_cndmask_b32 v91, 0, v29, s[50:51]
    s_waitcnt lgkmcnt(3)
    v_smfmac_f32_16x16x64_bf16 v[72:75], v[12:15], a[160:167], v6
    s_waitcnt lgkmcnt(2)
    v_smfmac_f32_16x16x64_bf16 v[72:75], v[16:19], a[168:175], v6
    s_waitcnt lgkmcnt(1)
    v_smfmac_f32_16x16x64_bf16 v[72:75], v[20:23], a[176:183], v6
    s_waitcnt lgkmcnt(0)
    v_smfmac_f32_16x16x64_bf16 v[72:75], v[24:27], a[184:191], v6
    v_smfmac_f32_16x16x64_bf16 v[76:79], v[12:15], a[192:199], v6
    v_smfmac_f32_16x16x64_bf16 v[76:79], v[16:19], a[200:207], v6
    v_cvt_pk_bf16_f32 v72, v72, v73
    v_smfmac_f32_16x16x64_bf16 v[76:79], v[20:23], a[208:215], v6
    v_cvt_pk_bf16_f32 v73, v74, v75
    v_smfmac_f32_16x16x64_bf16 v[76:79], v[24:27], a[216:223], v6
    v_and_or_b32 v72, v72, -2, s16
    v_mfma_f32_16x16x32_bf16 v[80:83], v[12:15], a[224:227], 0
    buffer_store_dwordx2 v[72:73], v7, s[4:7], s23 offen sc1
    v_mfma_f32_16x16x32_bf16 v[80:83], v[16:19], a[228:231], v[80:83]
    v_mfma_f32_16x16x32_bf16 v[80:83], v[20:23], a[232:235], v[80:83]
    v_cvt_pk_bf16_f32 v76, v76, v77
    v_cvt_pk_bf16_f32 v77, v78, v79
    v_mfma_f32_16x16x32_bf16 v[80:83], v[24:27], a[236:239], v[80:83]
    v_and_or_b32 v76, v76, -2, s16
    buffer_store_dwordx2 v[76:77], v7, s[4:7], s25 offen sc1
    s_add_u32 s17, s17, 0x4000
    s_add_u32 s3, s3, 0x80000
    s_add_u32 s29, s29, 0x80000
    s_add_u32 s18, s18, 0x4000
    s_add_u32 s21, s21, 0x8000
    s_add_u32 s15, s15, 1
    s_nop 0
    v_cvt_pk_bf16_f32 v80, v80, v81
    v_cvt_pk_bf16_f32 v81, v82, v83
    v_and_or_b32 v80, v80, -2, s16
    s_mov_b64 exec, s[34:35]
    buffer_store_dwordx2 v[80:81], v7, s[4:7], s26 offen sc1
    s_mov_b64 exec, -1
    s_cmp_lg_u32 s42, 0
    s_cbranch_scc1 OWN_47
    s_cmp_lt_u32 s14, 2
    s_cbranch_scc1 IDLE_46
    s_branch REC_POLL_S
OWN_47:
    s_nop 15
    s_nop 13
    buffer_load_dwordx4 v[12:15], v1, s[4:7], s24 offen offset:0 sc1
    buffer_load_dwordx4 v[16:19], v1, s[4:7], s24 offen offset:1024 sc1
    buffer_load_dwordx4 v[20:23], v1, s[4:7], s24 offen offset:2048 sc1
    buffer_load_dwordx4 v[24:27], v1, s[4:7], s24 offen offset:3072 sc1
    ds_read_b128 v[56:59], v2 offset:0
    ds_read_b128 v[60:63], v2 offset:1024
    ds_read_b128 v[64:67], v2 offset:2048
    ds_read_b128 v[68:71], v2 offset:3072
    v_mov_b64 v[32:33], 0
    v_mov_b64 v[34:35], 0
    v_mov_b64 v[36:37], 0
    v_mov_b64 v[38:39], 0
    v_mov_b64 v[40:41], 0
    v_mov_b64 v[42:43], 0
    v_mov_b64 v[44:45], 0
    v_mov_b64 v[46:47], 0
    buffer_load_dwordx4 v[72:75], v1, s[4:7], s24 offen offset:0 sc1
    buffer_load_dwordx4 v[76:79], v1, s[4:7], s24 offen offset:1024 sc1
    buffer_load_dwordx4 v[80:83], v1, s[4:7], s24 offen offset:2048 sc1
    buffer_load_dwordx4 v[84:87], v1, s[4:7], s24 offen offset:3072 sc1
    v_mov_b64 v[48:49], 0
    v_mov_b64 v[50:51], 0
    v_mov_b64 v[52:53], 0
    v_mov_b64 v[54:55], 0
OPOLL_49:
    s_waitcnt vmcnt(7)
    v_mfma_f32_16x16x32_bf16 v[92:95], v[12:15], v[88:91], 0
    v_bitop3_b32 v10, v12, v14, s16 bitop3:0x7e
    s_waitcnt vmcnt(6)
    v_mfma_f32_16x16x32_bf16 v[92:95], v[16:19], v[88:91], v[92:95]
    v_bitop3_b32 v11, v16, v18, s16 bitop3:0x7e
    s_waitcnt vmcnt(5)
    v_mfma_f32_16x16x32_bf16 v[92:95], v[20:23], v[88:91], v[92:95]
    v_bitop3_b32 v30, v20, v22, s16 bitop3:0x7e
    s_waitcnt vmcnt(4)
    v_mfma_f32_16x16x32_bf16 v[92:95], v[24:27], v[88:91], v[92:95]
    v_bitop3_b32 v31, v24, v26, s16 bitop3:0x7e
    v_or3_b32 v10, v10, v11, v30
    v_bitop3_b32 v10, v10, v31, 1 bitop3:0xa8
    v_cmp_ne_u32 vcc, 0, v10
    s_nop 3
    s_cbranch_vccz ODONE_48
    s_add_u32 s40, s40, 1
    buffer_load_dwordx4 v[12:15], v1, s[4:7], s24 offen offset:0 sc1
    buffer_load_dwordx4 v[16:19], v1, s[4:7], s24 offen offset:1024 sc1
    buffer_load_dwordx4 v[20:23], v1, s[4:7], s24 offen offset:2048 sc1
    buffer_load_dwordx4 v[24:27], v1, s[4:7], s24 offen offset:3072 sc1
    s_waitcnt vmcnt(7)
    v_mfma_f32_16x16x32_bf16 v[92:95], v[72:75], v[88:91], 0
    v_bitop3_b32 v10, v72, v74, s16 bitop3:0x7e
    s_waitcnt vmcnt(6)
    v_mfma_f32_16x16x32_bf16 v[92:95], v[76:79], v[88:91], v[92:95]
    v_bitop3_b32 v11, v76, v78, s16 bitop3:0x7e
    s_waitcnt vmcnt(5)
    v_mfma_f32_16x16x32_bf16 v[92:95], v[80:83], v[88:91], v[92:95]
    v_bitop3_b32 v30, v80, v82, s16 bitop3:0x7e
    s_waitcnt vmcnt(4)
    v_mfma_f32_16x16x32_bf16 v[92:95], v[84:87], v[88:91], v[92:95]
    v_bitop3_b32 v31, v84, v86, s16 bitop3:0x7e
    v_or3_b32 v10, v10, v11, v30
    v_bitop3_b32 v10, v10, v31, 1 bitop3:0xa8
    v_cmp_ne_u32 vcc, 0, v10
    s_add_u32 s68, s68, 1
    s_cmp_gt_u32 s68, 262144
    s_cbranch_scc1 ODONE_48
    s_nop 0
    s_cbranch_vccz ODONE_48
    s_add_u32 s40, s40, 1
    buffer_load_dwordx4 v[72:75], v1, s[4:7], s24 offen offset:0 sc1
    buffer_load_dwordx4 v[76:79], v1, s[4:7], s24 offen offset:1024 sc1
    buffer_load_dwordx4 v[80:83], v1, s[4:7], s24 offen offset:2048 sc1
    buffer_load_dwordx4 v[84:87], v1, s[4:7], s24 offen offset:3072 sc1
    s_branch OPOLL_49
ODONE_48:
    v_permlane32_swap_b32 v92, v94
    v_permlane32_swap_b32 v93, v95
    v_add_f32 v92, v92, v94
    v_add_f32 v93, v93, v95
    v_cvt_pk_bf16_f32 v8, v92, v93
    buffer_store_dword v8, v9, s[4:7], s18 offen sc1
    s_cmp_eq_u32 s15, 63
    s_cselect_b32 s59, s55, 0
    s_barrier
    s_nop 15
    s_nop 15
    s_nop 12
    buffer_store_dword v8, v9, s[4:7], s21 offen sc1
    s_cmp_lt_u32 s15, 61
    s_cbranch_scc1 EFLG_50
    buffer_store_dword v6, off, s[4:7], s22 sc1
EFLG_50:
    s_xor_b32 s16, s16, 1
    s_waitcnt vmcnt(2) lgkmcnt(0)
    s_branch REC_LOOP_S
IDLE_46:
    s_barrier
    s_cmp_eq_u32 s15, 63
    s_cselect_b32 s59, s55, 0
    v_mov_b64 v[32:33], 0
    v_mov_b64 v[34:35], 0
    v_mov_b64 v[36:37], 0
    v_mov_b64 v[38:39], 0
    v_mov_b64 v[40:41], 0
    v_mov_b64 v[42:43], 0
    v_mov_b64 v[44:45], 0
    v_mov_b64 v[46:47], 0
    v_mov_b64 v[48:49], 0
    v_mov_b64 v[50:51], 0
    v_mov_b64 v[52:53], 0
    v_mov_b64 v[54:55], 0
    ds_read_b128 v[56:59], v2 offset:0
    ds_read_b128 v[60:63], v2 offset:1024
    ds_read_b128 v[64:67], v2 offset:2048
    ds_read_b128 v[68:71], v2 offset:3072
    s_xor_b32 s16, s16, 1
    s_waitcnt vmcnt(0)
    s_branch REC_LOOP_S
REC_TAIL_S:
RETRY_28:
SPIN_51:
    buffer_load_dwordx4 v[20:23], v1, s[4:7], s17 offen offset:2048 sc1
    buffer_load_dwordx4 v[24:27], v1, s[4:7], s17 offen offset:3072 sc1
    buffer_load_dwordx4 v[28:31], v1, s[4:7], s74 offen offset:0 sc1
    s_add_u32 s68, s68, 1
    s_add_u32 s40, s40, 1024
    s_cmp_gt_u32 s68, 262144
    s_waitcnt vmcnt(0)
    s_cbranch_scc1 BACK_29
    v_cmp_eq_u32 vcc, -1, v23
    s_cbranch_vccnz SPIN_51
    s_branch BACK_29
RETRY_30:
SPIN_52:
    buffer_load_dwordx4 v[24:27], v1, s[4:7], s17 offen offset:3072 sc1
    buffer_load_dwordx4 v[28:31], v1, s[4:7], s74 offen offset:0 sc1
    s_add_u32 s68, s68, 1
    s_add_u32 s40, s40, 1024
    s_cmp_gt_u32 s68, 262144
    s_waitcnt vmcnt(0)
    s_cbranch_scc1 BACK_31
    v_cmp_eq_u32 vcc, -1, v27
    s_cbranch_vccnz SPIN_52
    s_branch BACK_31
RETRY_32:
SPIN_53:
    buffer_load_dwordx4 v[28:31], v1, s[4:7], s74 offen offset:0 sc1
    s_add_u32 s68, s68, 1
    s_add_u32 s40, s40, 1024
    s_cmp_gt_u32 s68, 262144
    s_waitcnt vmcnt(0)
    s_cbranch_scc1 BACK_33
    v_cmp_eq_u32 vcc, -1, v31
    s_cbranch_vccnz SPIN_53
    s_branch BACK_33
RETRY_34:
SPIN_54:
    buffer_load_dwordx4 v[12:15], v1, s[4:7], s20 offen offset:0 sc1
    buffer_load_dwordx4 v[16:19], v1, s[4:7], s20 offen offset:1024 sc1
    buffer_load_dwordx4 v[20:23], v1, s[4:7], s20 offen offset:2048 sc1
    buffer_load_dwordx4 v[24:27], v1, s[4:7], s20 offen offset:3072 sc1
    s_add_u32 s68, s68, 1
    s_add_u32 s40, s40, 1048576
    s_cmp_gt_u32 s68, 262144
    s_waitcnt vmcnt(0)
    s_cbranch_scc1 BACK_35
    v_cmp_eq_u32 vcc, -1, v15
    s_cbranch_vccnz SPIN_54
    s_branch BACK_35
RETRY_36:
SPIN_55:
    buffer_load_dwordx4 v[16:19], v1, s[4:7], s20 offen offset:1024 sc1
    buffer_load_dwordx4 v[20:23], v1, s[4:7], s20 offen offset:2048 sc1
    buffer_load_dwordx4 v[24:27], v1, s[4:7], s20 offen offset:3072 sc1
    buffer_load_dwordx4 v[28:31], v1, s[4:7], s75 offen offset:0 sc1
    s_add_u32 s68, s68, 1
    s_add_u32 s40, s40, 1048576
    s_cmp_gt_u32 s68, 262144
    s_waitcnt vmcnt(0)
    s_cbranch_scc1 BACK_37
    v_cmp_eq_u32 vcc, -1, v19
    s_cbranch_vccnz SPIN_55
    s_branch BACK_37
RETRY_38:
SPIN_56:
    buffer_load_dwordx4 v[20:23], v1, s[4:7], s20 offen offset:2048 sc1
    buffer_load_dwordx4 v[24:27], v1, s[4:7], s20 offen offset:3072 sc1
    buffer_load_dwordx4 v[28:31], v1, s[4:7], s75 offen offset:0 sc1
    s_add_u32 s68, s68, 1
    s_add_u32 s40, s40, 1048576
    s_cmp_gt_u32 s68, 262144
    s_waitcnt vmcnt(0)
    s_cbranch_scc1 BACK_39
    v_cmp_eq_u32 vcc, -1, v23
    s_cbranch_vccnz SPIN_56
    s_branch BACK_39
RETRY_40:
SPIN_57:
    buffer_load_dwordx4 v[24:27], v1, s[4:7], s20 offen offset:3072 sc1
    buffer_load_dwordx4 v[28:31], v1, s[4:7], s75 offen offset:0 sc1
    s_add_u32 s68, s68, 1
    s_add_u32 s40, s40, 1048576
    s_cmp_gt_u32 s68, 262144
    s_waitcnt vmcnt(0)
    s_cbranch_scc1 BACK_41
    v_cmp_eq_u32 vcc, -1, v27
    s_cbranch_vccnz SPIN_57
    s_branch BACK_41
RETRY_42:
SPIN_58:
    buffer_load_dwordx4 v[28:31], v1, s[4:7], s75 offen offset:0 sc1
    s_add_u32 s68, s68, 1
    s_add_u32 s40, s40, 1048576
    s_cmp_gt_u32 s68, 262144
    s_waitcnt vmcnt(0)
    s_cbranch_scc1 BACK_43
    v_cmp_eq_u32 vcc, -1, v31
    s_cbranch_vccnz SPIN_58
    s_branch BACK_43
REC_POLL:
    s_cmp_eq_u32 s59, 0
    s_cbranch_scc1 NOFLG_59
    s_waitcnt vmcnt(0)
    v_lshrrev_b32 v29, 2, v1
    ds_read_b32 v12, v29 offset:15104
    s_add_u32 s64, s15, 2
    s_lshr_b32 s65, s64, 1
    s_add_u32 s67, s65, 1
    s_waitcnt lgkmcnt(0)
    v_cmp_ne_u32 vcc, 0, v12
    v_readlane_b32 s65, v12, s65
    v_readlane_b32 s67, v12, s67
    s_cmp_eq_u32 vcc_lo, -1
    s_cselect_b32 s58, 1, 0
    s_and_b32 s65, s65, s67
    s_cbranch_scc1 NOFLG_59
    s_lshl_b32 s64, s64, 7
    s_add_u32 s64, s64, s69
    v_mov_b32 v29, 0
FSPIN_61:
    buffer_load_dwordx2 v[12:13], v29, s[4:7], s64 offen sc1
    s_add_u32 s68, s68, 1
    s_waitcnt vmcnt(0)
    v_and_b32 v12, v12, v13
    v_cmp_eq_u32 vcc, 0, v12
    s_cbranch_vccz FDONE_62
    s_cmp_gt_u32 s68, 262144
    s_cbranch_scc0 FSPIN_61
FDONE_62:
NOFLG_59:
    s_add_u32 s64, s15, 3
    s_and_b32 s64, s64, 0x43
    s_or_b32 s64, s64, s58
    s_cmp_eq_u32 s64, 0
    s_cselect_b32 s59, 1, 0
    s_cmp_eq_u32 s15, 63
    s_cselect_b32 s59, s55, s59
    s_add_u32 s66, s17, s52
    v_add_u32 v10, s52, v1
    s_xor_b32 s16, s16, 1
    v_mov_b64 v[32:33], 0
    v_mov_b64 v[34:35], 0
    v_mov_b64 v[36:37], 0
    v_mov_b64 v[38:39], 0
    v_mov_b64 v[40:41], 0
    v_mov_b64 v[42:43], 0
    v_mov_b64 v[44:45], 0
    v_mov_b64 v[46:47], 0
    v_mov_b64 v[48:49], 0
    v_mov_b64 v[50:51], 0
    v_mov_b64 v[52:53], 0
    v_mov_b64 v[54:55], 0
    ds_read_b128 v[56:59], v2 offset:0
    ds_read_b128 v[60:63], v2 offset:1024
    ds_read_b128 v[64:67], v2 offset:2048
    ds_read_b128 v[68:71], v2 offset:3072
    s_barrier
    s_nop 14
    buffer_load_dwordx4 v[20:23], v1, s[4:7], s66 offen offset:0 sc1
    s_nop 7
    buffer_load_dwordx4 v[24:27], v1, s[4:7], s66 offen offset:0 sc1
    s_nop 7
    buffer_load_dwordx4 v[28:31], v1, s[4:7], s66 offen offset:0 sc1
IPOLL_64:
    s_waitcnt vmcnt(2)
    ds_write_b128 v10, v[20:23] offset:12800
    v_max3_u32 v11, v20, v21, v22
    v_max_u32 v11, v11, v23
    v_cmp_eq_u32 vcc, -1, v11
    s_cbranch_vccz IOK_63
    buffer_load_dwordx4 v[20:23], v1, s[4:7], s66 offen offset:0 sc1
    s_waitcnt vmcnt(2)
    ds_write_b128 v10, v[24:27] offset:12800
    v_max3_u32 v11, v24, v25, v26
    v_max_u32 v11, v11, v27
    v_cmp_eq_u32 vcc, -1, v11
    s_cbranch_vccz IOK_63
    buffer_load_dwordx4 v[24:27], v1, s[4:7], s66 offen offset:0 sc1
    s_waitcnt vmcnt(2)
    ds_write_b128 v10, v[28:31] offset:12800
    v_max3_u32 v11, v28, v29, v30
    v_max_u32 v11, v11, v31
    v_cmp_eq_u32 vcc, -1, v11
    s_add_u32 s68, s68, 1
    s_add_u32 s53, s53, 1
    s_cmp_gt_u32 s68, 262144
    s_cbranch_scc1 IOK_63
    s_cbranch_vccz IOK_63
    buffer_load_dwordx4 v[28:31], v1, s[4:7], s66 offen offset:0 sc1
    s_branch IPOLL_64
IOK_63:
    s_waitcnt lgkmcnt(0)
REC_LOOP:
    s_barrier
    ds_read_b128 v[12:15], v1 offset:12800
    ds_read_b128 v[16:19], v1 offset:13824
    buffer_load_dwordx4 v[20:23], v1, s[4:7], s17 offen offset:2048
    ds_read_b128 v[72:75], v2 offset:4096
    ds_read_b128 v[76:79], v2 offset:5120
    ds_read_b128 v[80:83], v2 offset:6144
    ds_read_b128 v[84:87], v2 offset:7168
    s_add_u32 s74, s17, 0x1000
    s_add_u32 s20, s20, 0x8000
    s_add_u32 s75, s20, 0x1000
    s_mov_b32 m0, 16128
    s_add_u32 s65, s20, s27
    s_waitcnt lgkmcnt(5)
    v_smfmac_f32_16x16x64_bf16 v[32:35], v[12:15], v[96:103], v6
    buffer_load_dwordx4 v[24:27], v1, s[4:7], s17 offen offset:3072
    v_smfmac_f32_16x16x64_bf16 v[36:39], v[12:15], v[104:111], v6
    v_smfmac_f32_16x16x64_bf16 v[40:43], v[12:15], v[56:63], v6
    buffer_load_dwordx4 v[28:31], v1, s[4:7], s74 offen offset:0
    ds_read_b128 v[56:59], v2 offset:8192
    ds_read_b128 v[60:63], v2 offset:9216
    v_smfmac_f32_16x16x64_bf16 v[44:47], v[12:15], v[64:71], v6
    ds_read_b128 v[64:67], v2 offset:10240
    ds_read_b128 v[68:71], v2 offset:11264
    s_waitcnt lgkmcnt(8)
    v_smfmac_f32_16x16x64_bf16 v[48:51], v[12:15], a[0:7], v6
    v_smfmac_f32_16x16x64_bf16 v[52:55], v[12:15], a[8:15], v6
    buffer_load_dwordx4 v[12:15], v1, s[4:7], s20 offen offset:0
    buffer_load_dword off, s[4:7], s65 lds
    v_smfmac_f32_16x16x64_bf16 v[32:35], v[16:19], v[112:119], v6
    v_smfmac_f32_16x16x64_bf16 v[36:39], v[16:19], v[120:127], v6
    s_waitcnt lgkmcnt(4)
    v_smfmac_f32_16x16x64_bf16 v[40:43], v[16:19], v[72:79], v6
    ds_read_b128 v[72:75], v2 offset:12288
    ds_read_b128 v[76:79], v2 offset:13312
    v_smfmac_f32_16x16x64_bf16 v[44:47], v[16:19], v[80:87], v6
    ds_read_b128 v[80:83], v2 offset:14336
    ds_read_b128 v[84:87], v2 offset:15360
    s_waitcnt vmcnt(4)
    v_cmp_eq_u32 vcc, -1, v23
    v_smfmac_f32_16x16x64_bf16 v[48:51], v[16:19], a[16:23], v6
    v_smfmac_f32_16x16x64_bf16 v[52:55], v[16:19], a[24:31], v6
    s_cbranch_vccnz RETRY_65
BACK_66:
    buffer_load_dwordx4 v[16:19], v1, s[4:7], s20 offen offset:1024
    v_smfmac_f32_16x16x64_bf16 v[32:35], v[20:23], v[128:135], v6
    v_smfmac_f32_16x16x64_bf16 v[36:39], v[20:23], v[136:143], v6
    s_waitcnt lgkmcnt(4)
    v_smfmac_f32_16x16x64_bf16 v[40:43], v[20:23], v[56:63], v6
    ds_read_b128 v[56:59], v2 offset:16384
    ds_read_b128 v[60:63], v2 offset:17408
    v_smfmac_f32_16x16x64_bf16 v[44:47], v[20:23], v[64:71], v6
    ds_read_b128 v[64:67], v2 offset:18432
    ds_read_b128 v[68:71], v2 offset:19456
    s_waitcnt vmcnt(4)
    v_cmp_eq_u32 vcc, -1, v27
    v_smfmac_f32_16x16x64_bf16 v[48:51], v[20:23], a[32:39], v6
    v_smfmac_f32_16x16x64_bf16 v[52:55], v[20:23], a[40:47], v6
    s_cbranch_vccnz RETRY_67
BACK_68:
    buffer_load_dwordx4 v[20:23], v1, s[4:7], s20 offen offset:2048
    v_smfmac_f32_16x16x64_bf16 v[32:35], v[24:27], v[144:151], v6
    v_smfmac_f32_16x16x64_bf16 v[36:39], v[24:27], v[152:159], v6
    s_waitcnt lgkmcnt(4)
    v_smfmac_f32_16x16x64_bf16 v[40:43], v[24:27], v[72:79], v6
    ds_read_b128 v[72:75], v2 offset:20480
    ds_read_b128 v[76:79], v2 offset:21504
    v_smfmac_f32_16x16x64_bf16 v[44:47], v[24:27], v[80:87], v6
    ds_read_b128 v[80:83], v2 offset:22528
    ds_read_b128 v[84:87], v2 offset:23552
    s_waitcnt vmcnt(4)
    v_cmp_eq_u32 vcc, -1, v31
    v_smfmac_f32_16x16x64_bf16 v[48:51], v[24:27], a[48:55], v6
    v_smfmac_f32_16x16x64_bf16 v[52:55], v[24:27], a[56:63], v6
    s_cbranch_vccnz RETRY_69
BACK_70:
    buffer_load_dwordx4 v[24:27], v1, s[4:7], s20 offen offset:3072
    v_smfmac_f32_16x16x64_bf16 v[32:35], v[28:31], v[160:167], v6
    v_smfmac_f32_16x16x64_bf16 v[36:39], v[28:31], v[168:175], v6
    s_waitcnt lgkmcnt(4)
    v_smfmac_f32_16x16x64_bf16 v[40:43], v[28:31], v[56:63], v6
    ds_read_b128 v[56:59], v2 offset:24576
    ds_read_b128 v[60:63], v2 offset:25600
    v_smfmac_f32_16x16x64_bf16 v[44:47], v[28:31], v[64:71], v6
    ds_read_b128 v[64:67], v2 offset:26624
    ds_read_b128 v[68:71], v2 offset:27648
    s_waitcnt vmcnt(4)
    v_cmp_eq_u32 vcc, -1, v15
    v_smfmac_f32_16x16x64_bf16 v[48:51], v[28:31], a[64:71], v6
    v_smfmac_f32_16x16x64_bf16 v[52:55], v[28:31], a[72:79], v6
    s_cbranch_vccnz RETRY_71
BACK_72:
    buffer_load_dwordx4 v[28:31], v1, s[4:7], s75 offen offset:0
    v_smfmac_f32_16x16x64_bf16 v[32:35], v[12:15], v[176:183], v6
    s_waitcnt vmcnt(3)
    v_cmp_eq_u32 vcc, -1, v19
    v_smfmac_f32_16x16x64_bf16 v[36:39], v[12:15], v[184:191], v6
    s_waitcnt lgkmcnt(4)
    v_smfmac_f32_16x16x64_bf16 v[40:43], v[12:15], v[72:79], v6
    ds_read_b128 v[72:75], v2 offset:28672
    ds_read_b128 v[76:79], v2 offset:29696
    v_smfmac_f32_16x16x64_bf16 v[44:47], v[12:15], v[80:87], v6
    ds_read_b128 v[80:83], v2 offset:30720
    ds_read_b128 v[84:87], v2 offset:31744
    buffer_load_dwordx4 v[88:91], v1, s[4:7], s29 offen offset:0
    s_cbranch_vccnz RETRY_73
BACK_74:
    v_smfmac_f32_16x16x64_bf16 v[32:35], v[16:19], v[192:199], v6
    s_waitcnt vmcnt(3)
    v_cmp_eq_u32 vcc, -1, v23
    v_smfmac_f32_16x16x64_bf16 v[36:39], v[16:19], v[200:207], v6
    s_waitcnt lgkmcnt(4)
    v_smfmac_f32_16x16x64_bf16 v[40:43], v[16:19], v[56:63], v6
    ds_read_b128 v[56:59], v2 offset:32768
    ds_read_b128 v[60:63], v2 offset:33792
    v_smfmac_f32_16x16x64_bf16 v[44:47], v[16:19], v[64:71], v6
    ds_read_b128 v[64:67], v2 offset:34816
    ds_read_b128 v[68:71], v2 offset:35840
    s_cbranch_vccnz RETRY_75
BACK_76:
    v_smfmac_f32_16x16x64_bf16 v[32:35], v[20:23], v[208:215], v6
    s_waitcnt vmcnt(2)
    v_cmp_eq_u32 vcc, -1, v27
    v_smfmac_f32_16x16x64_bf16 v[36:39], v[20:23], v[216:223], v6
    s_waitcnt lgkmcnt(4)
    v_smfmac_f32_16x16x64_bf16 v[40:43], v[20:23], v[72:79], v6
    ds_read_b128 v[72:75], v1 offset:0
    ds_read_b128 v[76:79], v1 offset:4096
    v_smfmac_f32_16x16x64_bf16 v[44:47], v[20:23], v[80:87], v6
    ds_read_b128 v[80:83], v1 offset:1024
    ds_read_b128 v[84:87], v1 offset:5120
    buffer_load_dwordx4 v[92:95], v1, s[4:7], s29 offen offset:1024
    s_cbranch_vccnz RETRY_77
BACK_78:
    v_smfmac_f32_16x16x64_bf16 v[32:35], v[24:27], v[224:231], v6
    s_waitcnt vmcnt(2)
    v_cmp_eq_u32 vcc, -1, v31
    v_smfmac_f32_16x16x64_bf16 v[36:39], v[24:27], v[232:239], v6
    s_waitcnt lgkmcnt(4)
    v_smfmac_f32_16x16x64_bf16 v[40:43], v[24:27], v[56:63], v6
    ds_read_b128 v[56:59], v1 offset:2048
    ds_read_b128 v[60:63], v1 offset:6144
    v_smfmac_f32_16x16x64_bf16 v[44:47], v[24:27], v[64:71], v6
    ds_read_b128 v[64:67], v1 offset:3072
    ds_read_b128 v[68:71], v1 offset:7168
    s_cbranch_vccnz RETRY_79
BACK_80:
    v_smfmac_f32_16x16x64_bf16 v[32:35], v[28:31], v[240:247], v6
    v_smfmac_f32_16x16x64_bf16 v[36:39], v[28:31], v[248:255], v6
    v_smfmac_f32_16x16x64_bf16 v[40:43], v[28:31], a[240:247], v6
    v_smfmac_f32_16x16x64_bf16 v[44:47], v[28:31], a[248:255], v6
    v_lshlrev_b32 v8, 2, v1
    s_add_u32 s65, s17, s19
    buffer_load_dword v8, s[4:7], s3 offen lds
    buffer_load_dword off, s[4:7], s65 sc1 lds
    buffer_store_dword v6, off, s[4:7], s22 sc1
    s_add_u32 s22, s22, 256
    s_cmp_eq_u32 s59, 0
    s_cbranch_scc1 KVLOOK_81
    s_cmp_eq_u32 s59, 1
    s_cbranch_scc1 KVL1_82
    s_lshl_b32 s64, s13, 13
    s_add_u32 s64, s64, 0x43c0000
    buffer_load_dwordx4 v[96:99], v1, s[4:7], s64 offen offset:0
    buffer_load_dwordx4 v[100:103], v1, s[4:7], s64 offen offset:1024
    buffer_load_dwordx4 v[104:107], v1, s[4:7], s64 offen offset:2048
    buffer_load_dwordx4 v[108:111], v1, s[4:7], s64 offen offset:3072
    s_add_u32 s64, s64, 0x1000
    buffer_load_dwordx4 v[112:115], v1, s[4:7], s64 offen offset:0
    buffer_load_dwordx4 v[116:119], v1, s[4:7], s64 offen offset:1024
    buffer_load_dwordx4 v[120:123], v1, s[4:7], s64 offen offset:2048
    buffer_load_dwordx4 v[124:127], v1, s[4:7], s64 offen offset:3072
    s_branch KVLOOK_81
KVL1_82:
    v_lshrrev_b32 v9, 5, v1
    v_lshlrev_b32 v9, 9, v9
    v_bfe_u32 v10, v1, 4, 1
    v_lshl_add_u32 v9, v10, 2, v9
    s_mov_b32 m0, 15104
    s_mov_b64 exec, s[34:35]
    buffer_load_dword v9, s[4:7], s69 offen sc1 lds
    s_mov_b64 exec, -1
    s_mov_b32 m0, 16128
KVLOOK_81:
    v_permlane32_swap_b32 v32, v36
    v_permlane32_swap_b32 v33, v37
    v_permlane32_swap_b32 v34, v38
    v_permlane32_swap_b32 v35, v39
    v_pk_add_f32 v[32:33], v[32:33], v[36:37]
    v_pk_add_f32 v[34:35], v[34:35], v[38:39]
    v_cvt_pk_bf16_f32 v36, v32, v33
    v_cvt_pk_bf16_f32 v37, v34, v35
    ds_write_b64 v3, v[36:37] offset:0
    v_permlane32_swap_b32 v40, v44
    v_permlane32_swap_b32 v41, v45
    v_permlane32_swap_b32 v42, v46
    v_permlane32_swap_b32 v43, v47
    v_pk_add_f32 v[40:41], v[40:41], v[44:45]
    v_pk_add_f32 v[42:43], v[42:43], v[46:47]
    v_cvt_pk_bf16_f32 v44, v40, v41
    v_cvt_pk_bf16_f32 v45, v42, v43
    ds_write_b64 v3, v[44:45] offset:2304
    v_smfmac_f32_16x16x64_bf16 v[48:51], v[12:15], a[80:87], v6
    v_smfmac_f32_16x16x64_bf16 v[52:55], v[12:15], a[88:95], v6
    v_smfmac_f32_16x16x64_bf16 v[48:51], v[16:19], a[96:103], v6
    v_smfmac_f32_16x16x64_bf16 v[52:55], v[16:19], a[104:111], v6
    s_waitcnt lgkmcnt(0)
    s_barrier
    ds_read_b64_tr_b16 v[32:33], v4 offset:0
    ds_read_b64_tr_b16 v[34:35], v4 offset:128
    ds_read_b64_tr_b16 v[36:37], v4 offset:256
    ds_read_b64_tr_b16 v[38:39], v4 offset:384
    s_cmp_eq_u32 s15, 63
    s_cbranch_scc1 REC_FINAL
    v_smfmac_f32_16x16x64_bf16 v[48:51], v[20:23], a[112:119], v6
    v_smfmac_f32_16x16x64_bf16 v[52:55], v[20:23], a[120:127], v6
    ds_read_b64_tr_b16 v[40:41], v4 offset:512
    ds_read_b64_tr_b16 v[42:43], v4 offset:640
    ds_read_b64_tr_b16 v[44:45], v4 offset:768
    ds_read_b64_tr_b16 v[46:47], v4 offset:896
    v_smfmac_f32_16x16x64_bf16 v[48:51], v[24:27], a[128:135], v6
    v_smfmac_f32_16x16x64_bf16 v[52:55], v[24:27], a[136:143], v6
    s_waitcnt lgkmcnt(4)
    v_mfma_f32_16x16x32_bf16 v[8:11], v[72:75], v[32:35], 0
    ds_read_b64_tr_b16 v[12:13], v4 offset:2304
    ds_read_b64_tr_b16 v[14:15], v4 offset:2432
    v_mfma_f32_16x16x32_bf16 v[8:11], v[80:83], v[36:39], v[8:11]
    ds_read_b64_tr_b16 v[16:17], v4 offset:2560
    ds_read_b64_tr_b16 v[18:19], v4 offset:2688
    s_waitcnt lgkmcnt(4)
    v_mfma_f32_16x16x32_bf16 v[8:11], v[56:59], v[40:43], v[8:11]
    ds_read_b64_tr_b16 v[56:57], v4 offset:2816
    ds_read_b64_tr_b16 v[58:59], v4 offset:2944
    v_mfma_f32_16x16x32_bf16 v[8:11], v[64:67], v[44:47], v[8:11]
    ds_read_b64_tr_b16 v[64:65], v4 offset:3072
    ds_read_b64_tr_b16 v[66:67], v4 offset:3200
    v_mfma_f32_16x16x32_bf16 v[72:75], v[76:79], v[32:35], 0
    v_mfma_f32_16x16x32_bf16 v[72:75], v[84:87], v[36:39], v[72:75]
    v_mfma_f32_16x16x32_bf16 v[72:75], v[60:63], v[40:43], v[72:75]
    v_mfma_f32_16x16x32_bf16 v[72:75], v[68:71], v[44:47], v[72:75]
    s_waitcnt lgkmcnt(4)
    v_mfma_f32_16x16x32_bf16 v[80:83], v[12:15], v[32:35], 0
    v_mfma_f32_16x16x32_bf16 v[80:83], v[16:19], v[36:39], v[80:83]
    s_waitcnt lgkmcnt(0)
    v_mfma_f32_16x16x32_bf16 v[80:83], v[56:59], v[40:43], v[80:83]
    v_mfma_f32_16x16x32_bf16 v[80:83], v[64:67], v[44:47], v[80:83]
    v_smfmac_f32_16x16x64_bf16 v[48:51], v[28:31], a[144:151], v6
    v_smfmac_f32_16x16x64_bf16 v[52:55], v[28:31], a[152:159], v6
    v_mov_b32 v24, 0x3f803f80
    v_mov_b32 v25, 0x3f803f80
    v_mov_b32 v26, 0x3f803f80
    v_mov_b32 v27, 0x3f803f80
    v_max3_f32 v20, v8, v9, v10
    v_max3_f32 v21, v11, v72, v73
    v_max3_f32 v20, v20, v21, v74
    v_max3_f32 v21, v80, v81, v82
    v_max3_f32 v20, v20, v75, v83
    v_max_f32 v20, v20, v21
    v_mov_b32 v21, v20
    v_cvt_pk_bf16_f32 v48, v48, v49
    v_cvt_pk_bf16_f32 v49, v50, v51
    v_permlane16_swap_b32 v20, v21
    v_max_f32 v20, v20, v21
    v_mov_b32 v21, v20
    v_cvt_pk_bf16_f32 v50, v52, v53
    v_cvt_pk_bf16_f32 v51, v54, v55
    v_permlane32_swap_b32 v20, v21
    v_max_f32 v20, v20, v21
    v_mul_f32 v22, s10, v20
    v_pk_fma_f32 v[8:9], v[8:9], s[10:11], v[22:23] op_sel_hi:[1,1,0] neg_lo:[0,0,1] neg_hi:[0,0,1]
    v_pk_fma_f32 v[10:11], v[10:11], s[10:11], v[22:23] op_sel_hi:[1,1,0] neg_lo:[0,0,1] neg_hi:[0,0,1]
    v_pk_fma_f32 v[72:73], v[72:73], s[10:11], v[22:23] op_sel_hi:[1,1,0] neg_lo:[0,0,1] neg_hi:[0,0,1]
    v_pk_fma_f32 v[74:75], v[74:75], s[10:11], v[22:23] op_sel_hi:[1,1,0] neg_lo:[0,0,1] neg_hi:[0,0,1]
    v_pk_fma_f32 v[80:81], v[80:81], s[10:11], v[22:23] op_sel_hi:[1,1,0] neg_lo:[0,0,1] neg_hi:[0,0,1]
    v_pk_fma_f32 v[82:83], v[82:83], s[10:11], v[22:23] op_sel_hi:[1,1,0] neg_lo:[0,0,1] neg_hi:[0,0,1]
    v_exp_f32 v8, v8
    v_exp_f32 v9, v9
    v_exp_f32 v10, v10
    v_exp_f32 v11, v11
    v_exp_f32 v72, v72
    v_exp_f32 v73, v73
    v_exp_f32 v74, v74
    v_exp_f32 v75, v75
    v_cvt_pk_bf16_f32 v32, v8, v9
    v_cvt_pk_bf16_f32 v33, v10, v11
    v_exp_f32 v80, v80
    v_exp_f32 v81, v81
    v_exp_f32 v82, v82
    v_exp_f32 v83, v83
    v_cvt_pk_bf16_f32 v34, v72, v73
    v_cvt_pk_bf16_f32 v35, v74, v75
    v_cndmask_b32 v12, 0, v24, s[34:35]
    v_cndmask_b32 v13, 0, v24, s[34:35]
    s_waitcnt vmcnt(3)
    v_mfma_f32_16x16x32_bf16 v[8:11], v[24:27], v[32:35], 0
    v_cvt_pk_bf16_f32 v36, v80, v81
    v_mfma_f32_16x16x32_bf16 v[40:43], v[88:91], v[32:35], 0
    v_cvt_pk_bf16_f32 v37, v82, v83
    v_mfma_f32_16x16x32_bf16 v[44:47], v[92:95], v[32:35], 0
    v_mfma_f32_16x16x16_bf16 v[8:11], v[12:13], v[36:37], v[8:11]
    v_mov_b64 v[72:73], 0
    v_mfma_f32_16x16x16_bf16 v[40:43], v[48:49], v[36:37], v[40:43]
    v_mov_b64 v[74:75], 0
    v_mfma_f32_16x16x16_bf16 v[44:47], v[50:51], v[36:37], v[44:47]
    v_mov_b64 v[76:77], 0
    v_mov_b64 v[78:79], 0
    v_mov_b64 v[80:81], 0
    v_mov_b64 v[82:83], 0
    v_rcp_f32 v22, v8
    s_nop 2
    v_cndmask_b32 v40, v44, v40, s[32:33]
    v_cndmask_b32 v41, v45, v41, s[32:33]
    v_cndmask_b32 v42, v46, v42, s[32:33]
    v_cndmask_b32 v43, v47, v43, s[32:33]
    v_pk_mul_f32 v[40:41], v[40:41], v[22:23] op_sel_hi:[1,0]
    v_pk_mul_f32 v[42:43], v[42:43], v[22:23] op_sel_hi:[1,0]
    v_cvt_pk_bf16_f32 v44, v40, v41
    v_cvt_pk_bf16_f32 v45, v42, v43
    ds_write_b64 v5, v[44:45]
    s_mov_b32 m0, s73
    s_add_u32 s28, s28, 0x80000
    buffer_load_dwordx4 v1, s[4:7], s28 offen lds
    buffer_load_dwordx4 v1, s[4:7], s28 offen offset:1024 lds
    v_and_b32 v9, 0x70, v1
    v_bfe_u32 v29, v1, 8, 1
    v_lshl_add_u32 v9, v29, 3, v9
    v_bfe_u32 v29, v1, 9, 1
    v_lshl_add_u32 v9, v29, 2, v9
    v_mov_b32 v29, 0x40000000
    s_waitcnt lgkmcnt(0)
    s_barrier
    ds_read_b128 v[12:15], v0 offset:0
    ds_read_b128 v[16:19], v0 offset:64
    ds_read_b128 v[20:23], v0 offset:128
    ds_read_b128 v[24:27], v0 offset:192
    v_cndmask_b32 v9, v29, v9, s[32:33]
    v_and_b32 v29, 16, v1
    v_lshlrev_b32 v29, v29, s38
    v_cndmask_b32 v88, 0, v29, s[44:45]
    v_cndmask_b32 v89, 0, v29, s[46:47]
    v_cndmask_b32 v90, 0, v29, s[48:49]
    v_cndmask_b32 v91, 0, v29, s[50:51]
    s_waitcnt lgkmcnt(3)
    v_smfmac_f32_16x16x64_bf16 v[72:75], v[12:15], a[160:167], v6
    s_waitcnt lgkmcnt(2)
    v_smfmac_f32_16x16x64_bf16 v[72:75], v[16:19], a[168:175], v6
    s_waitcnt lgkmcnt(1)
    v_smfmac_f32_16x16x64_bf16 v[72:75], v[20:23], a[176:183], v6
    s_waitcnt lgkmcnt(0)
    v_smfmac_f32_16x16x64_bf16 v[72:75], v[24:27], a[184:191], v6
    v_smfmac_f32_16x16x64_bf16 v[76:79], v[12:15], a[192:199], v6
    v_smfmac_f32_16x16x64_bf16 v[76:79], v[16:19], a[200:207], v6
    v_cvt_pk_bf16_f32 v72, v72, v73
    v_smfmac_f32_16x16x64_bf16 v[76:79], v[20:23], a[208:215], v6
    v_cvt_pk_bf16_f32 v73, v74, v75
    v_smfmac_f32_16x16x64_bf16 v[76:79], v[24:27], a[216:223], v6
    v_and_or_b32 v72, v72, -2, s16
    v_mfma_f32_16x16x32_bf16 v[80:83], v[12:15], a[224:227], 0
    buffer_store_dwordx2 v[72:73], v7, s[4:7], s23 offen
    v_mfma_f32_16x16x32_bf16 v[80:83], v[16:19], a[228:231], v[80:83]
    v_mfma_f32_16x16x32_bf16 v[80:83], v[20:23], a[232:235], v[80:83]
    v_cvt_pk_bf16_f32 v76, v76, v77
    v_cvt_pk_bf16_f32 v77, v78, v79
    v_mfma_f32_16x16x32_bf16 v[80:83], v[24:27], a[236:239], v[80:83]
    v_and_or_b32 v76, v76, -2, s16
    buffer_store_dwordx2 v[76:77], v7, s[4:7], s25 offen
    s_add_u32 s17, s17, 0x4000
    s_add_u32 s3, s3, 0x80000
    s_add_u32 s29, s29, 0x80000
    s_add_u32 s18, s18, 0x4000
    s_add_u32 s21, s21, 0x8000
    s_add_u32 s15, s15, 1
    s_nop 0
    v_cvt_pk_bf16_f32 v80, v80, v81
    v_cvt_pk_bf16_f32 v81, v82, v83
    v_and_or_b32 v80, v80, -2, s16
    s_mov_b64 exec, s[34:35]
    buffer_store_dwordx2 v[80:81], v7, s[4:7], s26 offen
    s_mov_b64 exec, -1
    s_cmp_lg_u32 s42, 0
    s_cbranch_scc1 OWN_84
    s_cmp_lt_u32 s14, 2
    s_cbranch_scc1 IDLE_83
    s_branch REC_POLL
OWN_84:
    s_nop 15
    s_nop 13
    buffer_load_dwordx4 v[12:15], v1, s[4:7], s24 offen offset:0 sc1
    buffer_load_dwordx4 v[16:19], v1, s[4:7], s24 offen offset:1024 sc1
    buffer_load_dwordx4 v[20:23], v1, s[4:7], s24 offen offset:2048 sc1
    buffer_load_dwordx4 v[24:27], v1, s[4:7], s24 offen offset:3072 sc1
    ds_read_b128 v[56:59], v2 offset:0
    ds_read_b128 v[60:63], v2 offset:1024
    ds_read_b128 v[64:67], v2 offset:2048
    ds_read_b128 v[68:71], v2 offset:3072
    v_mov_b64 v[32:33], 0
    v_mov_b64 v[34:35], 0
    v_mov_b64 v[36:37], 0
    v_mov_b64 v[38:39], 0
    v_mov_b64 v[40:41], 0
    v_mov_b64 v[42:43], 0
    v_mov_b64 v[44:45], 0
    v_mov_b64 v[46:47], 0
    buffer_load_dwordx4 v[72:75], v1, s[4:7], s24 offen offset:0 sc1
    buffer_load_dwordx4 v[76:79], v1, s[4:7], s24 offen offset:1024 sc1
    buffer_load_dwordx4 v[80:83], v1, s[4:7], s24 offen offset:2048 sc1
    buffer_load_dwordx4 v[84:87], v1, s[4:7], s24 offen offset:3072 sc1
    v_mov_b64 v[48:49], 0
    v_mov_b64 v[50:51], 0
    v_mov_b64 v[52:53], 0
    v_mov_b64 v[54:55], 0
OPOLL_86:
    s_waitcnt vmcnt(7)
    v_mfma_f32_16x16x32_bf16 v[92:95], v[12:15], v[88:91], 0
    v_bitop3_b32 v10, v12, v14, s16 bitop3:0x7e
    s_waitcnt vmcnt(6)
    v_mfma_f32_16x16x32_bf16 v[92:95], v[16:19], v[88:91], v[92:95]
    v_bitop3_b32 v11, v16, v18, s16 bitop3:0x7e
    s_waitcnt vmcnt(5)
    v_mfma_f32_16x16x32_bf16 v[92:95], v[20:23], v[88:91], v[92:95]
    v_bitop3_b32 v30, v20, v22, s16 bitop3:0x7e
    s_waitcnt vmcnt(4)
    v_mfma_f32_16x16x32_bf16 v[92:95], v[24:27], v[88:91], v[92:95]
    v_bitop3_b32 v31, v24, v26, s16 bitop3:0x7e
    v_or3_b32 v10, v10, v11, v30
    v_bitop3_b32 v10, v10, v31, 1 bitop3:0xa8
    v_cmp_ne_u32 vcc, 0, v10
    s_nop 3
    s_cbranch_vccz ODONE_85
    s_add_u32 s40, s40, 1
    buffer_load_dwordx4 v[12:15], v1, s[4:7], s24 offen offset:0 sc1
    buffer_load_dwordx4 v[16:19], v1, s[4:7], s24 offen offset:1024 sc1
    buffer_load_dwordx4 v[20:23], v1, s[4:7], s24 offen offset:2048 sc1
    buffer_load_dwordx4 v[24:27], v1, s[4:7], s24 offen offset:3072 sc1
    s_waitcnt vmcnt(7)
    v_mfma_f32_16x16x32_bf16 v[92:95], v[72:75], v[88:91], 0
    v_bitop3_b32 v10, v72, v74, s16 bitop3:0x7e
    s_waitcnt vmcnt(6)
    v_mfma_f32_16x16x32_bf16 v[92:95], v[76:79], v[88:91], v[92:95]
    v_bitop3_b32 v11, v76, v78, s16 bitop3:0x7e
    s_waitcnt vmcnt(5)
    v_mfma_f32_16x16x32_bf16 v[92:95], v[80:83], v[88:91], v[92:95]
    v_bitop3_b32 v30, v80, v82, s16 bitop3:0x7e
    s_waitcnt vmcnt(4)
    v_mfma_f32_16x16x32_bf16 v[92:95], v[84:87], v[88:91], v[92:95]
    v_bitop3_b32 v31, v84, v86, s16 bitop3:0x7e
    v_or3_b32 v10, v10, v11, v30
    v_bitop3_b32 v10, v10, v31, 1 bitop3:0xa8
    v_cmp_ne_u32 vcc, 0, v10
    s_add_u32 s68, s68, 1
    s_cmp_gt_u32 s68, 262144
    s_cbranch_scc1 ODONE_85
    s_nop 0
    s_cbranch_vccz ODONE_85
    s_add_u32 s40, s40, 1
    buffer_load_dwordx4 v[72:75], v1, s[4:7], s24 offen offset:0 sc1
    buffer_load_dwordx4 v[76:79], v1, s[4:7], s24 offen offset:1024 sc1
    buffer_load_dwordx4 v[80:83], v1, s[4:7], s24 offen offset:2048 sc1
    buffer_load_dwordx4 v[84:87], v1, s[4:7], s24 offen offset:3072 sc1
    s_branch OPOLL_86
ODONE_85:
    v_permlane32_swap_b32 v92, v94
    v_permlane32_swap_b32 v93, v95
    v_add_f32 v92, v92, v94
    v_add_f32 v93, v93, v95
    v_cvt_pk_bf16_f32 v8, v92, v93
    buffer_store_dword v8, v9, s[4:7], s18 offen
    s_cmp_eq_u32 s15, 63
    s_cselect_b32 s59, s55, 0
    s_barrier
    s_nop 15
    s_nop 15
    s_nop 12
    buffer_store_dword v8, v9, s[4:7], s21 offen sc1
    s_cmp_lt_u32 s15, 61
    s_cbranch_scc1 EFLG_87
    buffer_store_dword v6, off, s[4:7], s22 sc1
EFLG_87:
    s_xor_b32 s16, s16, 1
    s_waitcnt vmcnt(2) lgkmcnt(0)
    s_branch REC_LOOP
IDLE_83:
    s_barrier
    s_cmp_eq_u32 s15, 63
    s_cselect_b32 s59, s55, 0
    v_mov_b64 v[32:33], 0
    v_mov_b64 v[34:35], 0
    v_mov_b64 v[36:37], 0
    v_mov_b64 v[38:39], 0
    v_mov_b64 v[40:41], 0
    v_mov_b64 v[42:43], 0
    v_mov_b64 v[44:45], 0
    v_mov_b64 v[46:47], 0
    v_mov_b64 v[48:49], 0
    v_mov_b64 v[50:51], 0
    v_mov_b64 v[52:53], 0
    v_mov_b64 v[54:55], 0
    ds_read_b128 v[56:59], v2 offset:0
    ds_read_b128 v[60:63], v2 offset:1024
    ds_read_b128 v[64:67], v2 offset:2048
    ds_read_b128 v[68:71], v2 offset:3072
    s_xor_b32 s16, s16, 1
    s_waitcnt vmcnt(0)
    s_branch REC_LOOP
REC_TAIL:
RETRY_65:
SPIN_88:
    buffer_load_dwordx4 v[20:23], v1, s[4:7], s17 offen offset:2048 sc1
    buffer_load_dwordx4 v[24:27], v1, s[4:7], s17 offen offset:3072 sc1
    buffer_load_dwordx4 v[28:31], v1, s[4:7], s74 offen offset:0 sc1
    s_add_u32 s68, s68, 1
    s_add_u32 s40, s40, 1024
    s_cmp_gt_u32 s68, 262144
    s_waitcnt vmcnt(0)
    s_cbranch_scc1 BACK_66
    v_cmp_eq_u32 vcc, -1, v23
    s_cbranch_vccnz SPIN_88
    s_branch BACK_66
RETRY_67:
SPIN_89:
    buffer_load_dwordx4 v[24:27], v1, s[4:7], s17 offen offset:3072 sc1
    buffer_load_dwordx4 v[28:31], v1, s[4:7], s74 offen offset:0 sc1
    s_add_u32 s68, s68, 1
    s_add_u32 s40, s40, 1024
    s_cmp_gt_u32 s68, 262144
    s_waitcnt vmcnt(0)
    s_cbranch_scc1 BACK_68
    v_cmp_eq_u32 vcc, -1, v27
    s_cbranch_vccnz SPIN_89
    s_branch BACK_68
RETRY_69:
SPIN_90:
    buffer_load_dwordx4 v[28:31], v1, s[4:7], s74 offen offset:0 sc1
    s_add_u32 s68, s68, 1
    s_add_u32 s40, s40, 1024
    s_cmp_gt_u32 s68, 262144
    s_waitcnt vmcnt(0)
    s_cbranch_scc1 BACK_70
    v_cmp_eq_u32 vcc, -1, v31
    s_cbranch_vccnz SPIN_90
    s_branch BACK_70
RETRY_71:
SPIN_91:
    buffer_load_dwordx4 v[12:15], v1, s[4:7], s20 offen offset:0 sc1
    buffer_load_dwordx4 v[16:19], v1, s[4:7], s20 offen offset:1024 sc1
    buffer_load_dwordx4 v[20:23], v1, s[4:7], s20 offen offset:2048 sc1
    buffer_load_dwordx4 v[24:27], v1, s[4:7], s20 offen offset:3072 sc1
    s_add_u32 s68, s68, 1
    s_add_u32 s40, s40, 1048576
    s_cmp_gt_u32 s68, 262144
    s_waitcnt vmcnt(0)
    s_cbranch_scc1 BACK_72
    v_cmp_eq_u32 vcc, -1, v15
    s_cbranch_vccnz SPIN_91
    s_branch BACK_72
RETRY_73:
SPIN_92:
    buffer_load_dwordx4 v[16:19], v1, s[4:7], s20 offen offset:1024 sc1
    buffer_load_dwordx4 v[20:23], v1, s[4:7], s20 offen offset:2048 sc1
    buffer_load_dwordx4 v[24:27], v1, s[4:7], s20 offen offset:3072 sc1
    buffer_load_dwordx4 v[28:31], v1, s[4:7], s75 offen offset:0 sc1
    s_add_u32 s68, s68, 1
    s_add_u32 s40, s40, 1048576
    s_cmp_gt_u32 s68, 262144
    s_waitcnt vmcnt(0)
    s_cbranch_scc1 BACK_74
    v_cmp_eq_u32 vcc, -1, v19
    s_cbranch_vccnz SPIN_92
    s_branch BACK_74
RETRY_75:
SPIN_93:
    buffer_load_dwordx4 v[20:23], v1, s[4:7], s20 offen offset:2048 sc1
    buffer_load_dwordx4 v[24:27], v1, s[4:7], s20 offen offset:3072 sc1
    buffer_load_dwordx4 v[28:31], v1, s[4:7], s75 offen offset:0 sc1
    s_add_u32 s68, s68, 1
    s_add_u32 s40, s40, 1048576
    s_cmp_gt_u32 s68, 262144
    s_waitcnt vmcnt(0)
    s_cbranch_scc1 BACK_76
    v_cmp_eq_u32 vcc, -1, v23
    s_cbranch_vccnz SPIN_93
    s_branch BACK_76
RETRY_77:
SPIN_94:
    buffer_load_dwordx4 v[24:27], v1, s[4:7], s20 offen offset:3072 sc1
    buffer_load_dwordx4 v[28:31], v1, s[4:7], s75 offen offset:0 sc1
    s_add_u32 s68, s68, 1
    s_add_u32 s40, s40, 1048576
    s_cmp_gt_u32 s68, 262144
    s_waitcnt vmcnt(0)
    s_cbranch_scc1 BACK_78
    v_cmp_eq_u32 vcc, -1, v27
    s_cbranch_vccnz SPIN_94
    s_branch BACK_78
RETRY_79:
SPIN_95:
    buffer_load_dwordx4 v[28:31], v1, s[4:7], s75 offen offset:0 sc1
    s_add_u32 s68, s68, 1
    s_add_u32 s40, s40, 1048576
    s_cmp_gt_u32 s68, 262144
    s_waitcnt vmcnt(0)
    s_cbranch_scc1 BACK_80
    v_cmp_eq_u32 vcc, -1, v31
    s_cbranch_vccnz SPIN_95
    s_branch BACK_80
REC_FINAL:
    s_cmp_lg_u32 s12, 0
    s_cbranch_scc1 REC_END
    s_waitcnt lgkmcnt(0)
    v_smfmac_f32_16x16x64_bf16 v[48:51], v[20:23], a[112:119], v6
    v_smfmac_f32_16x16x64_bf16 v[52:55], v[20:23], a[120:127], v6
    v_smfmac_f32_16x16x64_bf16 v[48:51], v[24:27], a[128:135], v6
    v_smfmac_f32_16x16x64_bf16 v[52:55], v[24:27], a[136:143], v6
    v_smfmac_f32_16x16x64_bf16 v[48:51], v[28:31], a[144:151], v6
    v_smfmac_f32_16x16x64_bf16 v[52:55], v[28:31], a[152:159], v6
    ds_read_b64_tr_b16 v[192:193], v4 offset:2304
    ds_read_b64_tr_b16 v[194:195], v4 offset:2432
    ds_read_b64_tr_b16 v[196:197], v4 offset:2560
    ds_read_b64_tr_b16 v[198:199], v4 offset:2688
    ds_read_b64_tr_b16 v[200:201], v4 offset:2816
    ds_read_b64_tr_b16 v[202:203], v4 offset:2944
    ds_read_b64_tr_b16 v[204:205], v4 offset:3072
    ds_read_b64_tr_b16 v[206:207], v4 offset:3200
    ds_read_b128 v[160:163], v1 offset:0
    ds_read_b128 v[164:167], v1 offset:1024
    ds_read_b128 v[168:171], v1 offset:2048
    ds_read_b128 v[172:175], v1 offset:3072
    ds_read_b128 v[176:179], v1 offset:4096
    ds_read_b128 v[180:183], v1 offset:5120
    ds_read_b128 v[184:187], v1 offset:6144
    ds_read_b128 v[188:191], v1 offset:7168
    v_mbcnt_lo_u32_b32 v0, -1, 0
    v_mbcnt_hi_u32_b32 v0, -1, v0
    s_mov_b32 s34, 0x3e0293ee
    s_mov_b32 s35, 0x3e0293ee
    s_mov_b32 s36, -1
    s_mov_b32 s37, 0
    v_lshrrev_b32 v5, 4, v0
    v_lshlrev_b32 v5, 2, v5
    v_and_b32 v6, 15, v0
    v_add_u32 v7, 0, v5
    v_cmp_le_u32 s[38:39], v7, v6
    v_add_u32 v7, 1, v5
    v_cmp_le_u32 s[40:41], v7, v6
    v_add_u32 v7, 2, v5
    v_cmp_le_u32 s[42:43], v7, v6
    v_add_u32 v7, 3, v5
    v_cmp_le_u32 s[44:45], v7, v6
    v_mov_b32 v252, 0x3f803f80
    v_mov_b32 v253, 0x3f803f80
    v_mov_b32 v254, 0x3f803f80
    v_mov_b32 v255, 0x3f803f80
    v_permlane32_swap_b32 v48, v52
    v_permlane32_swap_b32 v49, v53
    v_permlane32_swap_b32 v50, v54
    v_permlane32_swap_b32 v51, v55
    v_pk_add_f32 v[48:49], v[48:49], v[52:53]
    v_pk_add_f32 v[50:51], v[50:51], v[54:55]
    v_cvt_pk_bf16_f32 v208, v48, v49
    v_cvt_pk_bf16_f32 v209, v50, v51
    v_mov_b32 v210, v208
    v_mov_b32 v211, v209
    s_nop 1
    v_permlane32_swap_b32 v208, v210
    v_permlane32_swap_b32 v209, v211
    s_mov_b32 s24, 63
    s_lshl_b32 s64, s24, 5
    s_add_u32 s64, s64, s13
    s_lshl_b32 s33, s64, 2
    s_add_u32 s33, s33, 0x296000
    s_lshl_b32 s32, s24, 18
    s_lshl_b32 s65, s13, 12
    s_add_u32 s32, s32, s65
    s_add_u32 s32, s32, 0x4400000
    s_lshl_b32 s64, s14, 10
    s_add_u32 s32, s32, s64
    s_waitcnt vmcnt(0) lgkmcnt(0)
    v_mfma_f32_16x16x32_bf16 v[228:231], v[160:163], v[96:99], 0
    v_mfma_f32_16x16x32_bf16 v[236:239], v[160:163], v[112:115], 0
    v_mfma_f32_16x16x32_bf16 v[240:243], v[176:179], v[112:115], 0
    v_mfma_f32_16x16x32_bf16 v[228:231], v[164:167], v[100:103], v[228:231]
    v_mfma_f32_16x16x32_bf16 v[236:239], v[164:167], v[116:119], v[236:239]
    v_mfma_f32_16x16x32_bf16 v[240:243], v[180:183], v[116:119], v[240:243]
    v_mfma_f32_16x16x32_bf16 v[228:231], v[168:171], v[104:107], v[228:231]
    v_mfma_f32_16x16x32_bf16 v[236:239], v[168:171], v[120:123], v[236:239]
    v_mfma_f32_16x16x32_bf16 v[240:243], v[184:187], v[120:123], v[240:243]
    v_mfma_f32_16x16x32_bf16 v[228:231], v[172:175], v[108:111], v[228:231]
    v_mfma_f32_16x16x32_bf16 v[236:239], v[172:175], v[124:127], v[236:239]
    v_mfma_f32_16x16x32_bf16 v[240:243], v[188:191], v[124:127], v[240:243]
    v_mfma_f32_16x16x32_bf16 v[224:227], v[192:195], v[96:99], 0
    v_mfma_f32_16x16x32_bf16 v[232:235], v[192:195], v[112:115], 0
    v_mfma_f32_16x16x32_bf16 v[224:227], v[196:199], v[100:103], v[224:227]
    v_mfma_f32_16x16x32_bf16 v[232:235], v[196:199], v[116:119], v[232:235]
    v_mfma_f32_16x16x32_bf16 v[224:227], v[200:203], v[104:107], v[224:227]
    v_mfma_f32_16x16x32_bf16 v[232:235], v[200:203], v[120:123], v[232:235]
    v_mfma_f32_16x16x32_bf16 v[224:227], v[204:207], v[108:111], v[224:227]
    v_mfma_f32_16x16x32_bf16 v[232:235], v[204:207], v[124:127], v[232:235]
    v_mov_b32 v11, 0xff800000
    s_nop 7
    v_cndmask_b32 v228, v11, v228, s[38:39]
    v_cndmask_b32 v240, v11, v240, s[38:39]
    v_cndmask_b32 v224, v11, v224, s[36:37]
    v_cndmask_b32 v232, v11, v232, s[36:37]
    v_cndmask_b32 v229, v11, v229, s[40:41]
    v_cndmask_b32 v241, v11, v241, s[40:41]
    v_cndmask_b32 v225, v11, v225, s[36:37]
    v_cndmask_b32 v233, v11, v233, s[36:37]
    v_cndmask_b32 v230, v11, v230, s[42:43]
    v_cndmask_b32 v242, v11, v242, s[42:43]
    v_cndmask_b32 v226, v11, v226, s[36:37]
    v_cndmask_b32 v234, v11, v234, s[36:37]
    v_cndmask_b32 v231, v11, v231, s[44:45]
    v_cndmask_b32 v243, v11, v243, s[44:45]
    v_cndmask_b32 v227, v11, v227, s[36:37]
    v_cndmask_b32 v235, v11, v235, s[36:37]
    v_max3_f32 v8, v224, v225, v226
    v_max3_f32 v8, v8, v227, v228
    v_max3_f32 v8, v8, v229, v230
    v_max_f32 v8, v8, v231
    v_mov_b32 v9, v8
    s_nop 1
    v_permlane16_swap_b32 v8, v9
    v_max_f32 v8, v8, v9
    v_mov_b32 v9, v8
    s_nop 1
    v_permlane32_swap_b32 v8, v9
    v_max_f32 v8, v8, v9
    v_mul_f32 v8, s34, v8
    v_fma_f32 v224, v224, s34, -v8
    v_fma_f32 v225, v225, s34, -v8
    v_fma_f32 v226, v226, s34, -v8
    v_fma_f32 v227, v227, s34, -v8
    v_fma_f32 v228, v228, s34, -v8
    v_fma_f32 v229, v229, s34, -v8
    v_fma_f32 v230, v230, s34, -v8
    v_fma_f32 v231, v231, s34, -v8
    v_exp_f32 v224, v224
    v_exp_f32 v225, v225
    v_exp_f32 v226, v226
    v_exp_f32 v227, v227
    v_exp_f32 v228, v228
    v_exp_f32 v229, v229
    v_exp_f32 v230, v230
    v_exp_f32 v231, v231
    s_nop 0
    v_cvt_pk_bf16_f32 v16, v228, v229
    v_cvt_pk_bf16_f32 v17, v230, v231
    v_mov_b32 v18, 0
    v_mov_b32 v19, 0
    v_cvt_pk_bf16_f32 v20, v224, v225
    v_cvt_pk_bf16_f32 v21, v226, v227
    v_max3_f32 v8, v232, v233, v234
    v_max3_f32 v8, v8, v235, v236
    v_max3_f32 v8, v8, v237, v238
    v_max3_f32 v8, v8, v239, v240
    v_max3_f32 v8, v8, v241, v242
    v_max_f32 v8, v8, v243
    v_mov_b32 v9, v8
    s_nop 1
    v_permlane16_swap_b32 v8, v9
    v_max_f32 v8, v8, v9
    v_mov_b32 v9, v8
    s_nop 1
    v_permlane32_swap_b32 v8, v9
    v_max_f32 v8, v8, v9
    v_mul_f32 v8, s34, v8
    v_fma_f32 v232, v232, s34, -v8
    v_fma_f32 v233, v233, s34, -v8
    v_fma_f32 v234, v234, s34, -v8
    v_fma_f32 v235, v235, s34, -v8
    v_fma_f32 v236, v236, s34, -v8
    v_fma_f32 v237, v237, s34, -v8
    v_fma_f32 v238, v238, s34, -v8
    v_fma_f32 v239, v239, s34, -v8
    v_fma_f32 v240, v240, s34, -v8
    v_fma_f32 v241, v241, s34, -v8
    v_fma_f32 v242, v242, s34, -v8
    v_fma_f32 v243, v243, s34, -v8
    v_exp_f32 v232, v232
    v_exp_f32 v233, v233
    v_exp_f32 v234, v234
    v_exp_f32 v235, v235
    v_exp_f32 v236, v236
    v_exp_f32 v237, v237
    v_exp_f32 v238, v238
    v_exp_f32 v239, v239
    v_exp_f32 v240, v240
    v_exp_f32 v241, v241
    v_exp_f32 v242, v242
    v_exp_f32 v243, v243
    s_nop 0
    v_cvt_pk_bf16_f32 v22, v236, v237
    v_cvt_pk_bf16_f32 v23, v238, v239
    v_cvt_pk_bf16_f32 v24, v240, v241
    v_cvt_pk_bf16_f32 v25, v242, v243
    v_cvt_pk_bf16_f32 v26, v232, v233
    v_cvt_pk_bf16_f32 v27, v234, v235
    v_mfma_f32_16x16x32_bf16 v[244:247], v[252:255], v[16:19], 0
    v_mfma_f32_16x16x32_bf16 v[248:251], v[252:255], v[22:25], 0
    v_mfma_f32_16x16x32_bf16 v[32:35], v[88:91], v[16:19], 0
    v_mfma_f32_16x16x32_bf16 v[36:39], v[88:91], v[22:25], 0
    v_mfma_f32_16x16x32_bf16 v[40:43], v[92:95], v[16:19], 0
    v_mfma_f32_16x16x32_bf16 v[44:47], v[92:95], v[22:25], 0
    v_mfma_f32_16x16x16_bf16 v[244:247], v[252:253], v[20:21], v[244:247]
    v_mfma_f32_16x16x16_bf16 v[248:251], v[252:253], v[26:27], v[248:251]
    v_mfma_f32_16x16x16_bf16 v[32:35], v[208:209], v[20:21], v[32:35]
    v_mfma_f32_16x16x16_bf16 v[36:39], v[208:209], v[26:27], v[36:39]
    v_mfma_f32_16x16x16_bf16 v[40:43], v[210:211], v[20:21], v[40:43]
    v_mfma_f32_16x16x16_bf16 v[44:47], v[210:211], v[26:27], v[44:47]
    v_rcp_f32 v8, v244
    v_rcp_f32 v9, v248
    s_nop 7
    v_mul_f32 v32, v32, v8
    v_mul_f32 v33, v33, v8
    v_mul_f32 v34, v34, v8
    v_mul_f32 v35, v35, v8
    v_cvt_pk_bf16_f32 v96, v32, v33
    v_cvt_pk_bf16_f32 v97, v34, v35
    v_mul_f32 v40, v40, v8
    v_mul_f32 v41, v41, v8
    v_mul_f32 v42, v42, v8
    v_mul_f32 v43, v43, v8
    v_cvt_pk_bf16_f32 v98, v40, v41
    v_cvt_pk_bf16_f32 v99, v42, v43
    s_add_u32 s64, s32, 0x0
    buffer_store_dwordx4 v[96:99], v1, s[4:7], s64 offen offset:0 sc1
    v_mul_f32 v36, v36, v9
    v_mul_f32 v37, v37, v9
    v_mul_f32 v38, v38, v9
    v_mul_f32 v39, v39, v9
    v_cvt_pk_bf16_f32 v100, v36, v37
    v_cvt_pk_bf16_f32 v101, v38, v39
    v_mul_f32 v44, v44, v9
    v_mul_f32 v45, v45, v9
    v_mul_f32 v46, v46, v9
    v_mul_f32 v47, v47, v9
    v_cvt_pk_bf16_f32 v102, v44, v45
    v_cvt_pk_bf16_f32 v103, v46, v47
    s_add_u32 s64, s32, 0x20000
    buffer_store_dwordx4 v[100:103], v1, s[4:7], s64 offen offset:0 sc1
    s_waitcnt vmcnt(0)
    s_barrier
    s_cmp_lg_u32 s14, 0
    s_cbranch_scc1 REC_END
    v_mov_b32 v7, 1
    v_mov_b32 v8, 0
    s_mov_b64 exec, 1
    buffer_store_dword v7, v8, s[4:7], s33 offen sc1
    s_mov_b64 exec, -1
    s_branch REC_END
REC_END:
    s_branch M_EXIT
M_HELP:
    v_mbcnt_lo_u32_b32 v0, -1, 0
    v_mbcnt_hi_u32_b32 v0, -1, v0
    s_and_b32 s12, s96, 1
    s_lshr_b32 s3, s96, 1
    s_and_b32 s13, s3, 31
    s_lshr_b32 s3, s3, 5
    s_load_dwordx4 s[48:51], s[0:1], 16
    s_load_dwordx2 s[52:53], s[0:1], 32
    s_waitcnt lgkmcnt(0)
    s_mov_b32 s46, 5242880
    s_mov_b32 s47, 0x00020000
    s_cmp_eq_u32 s3, 1
    s_cselect_b32 s44, s52, s50
    s_cselect_b32 s45, s53, s51
    s_cmp_eq_u32 s3, 2
    s_cselect_b32 s44, s48, s44
    s_cselect_b32 s45, s49, s45
    s_load_dwordx2 s[16:17], s[0:1], 0
    s_mov_b32 s18, 2621440
    s_mov_b32 s19, 0x00020000
    s_load_dwordx2 s[20:21], s[0:1], 64
    s_mov_b32 s22, 1280
    s_mov_b32 s23, 0x00020000
    s_load_dwordx2 s[24:25], s[0:1], 8
    s_mov_b32 s26, 10240
    s_mov_b32 s27, 0x00020000
    s_lshr_b32 s29, s96, 5
    s_sub_u32 s28, s96, s29
    s_lshl_b32 s28, s28, 2
    s_add_u32 s28, s28, s14
    s_mul_i32 s28, s28, 3
    v_lshlrev_b32 v3, 4, v0
    v_lshlrev_b32 v4, 2, v0
    s_waitcnt lgkmcnt(0)
    s_and_b32 s29, s96, 31
    s_cmp_eq_u32 s29, 31
    s_cbranch_scc1 INP2_96
    s_add_u32 s29, s28, 0
    s_mul_i32 s33, s29, 1280
    buffer_load_dwordx4 v[10:13], v3, s[16:19], s33 offen
    buffer_load_dword v14, v4, s[16:19], s33 offen offset:1024
    s_add_u32 s29, s28, 1
    s_mul_i32 s34, s29, 1280
    buffer_load_dwordx4 v[16:19], v3, s[16:19], s34 offen
    buffer_load_dword v20, v4, s[16:19], s34 offen offset:1024
    s_add_u32 s29, s28, 2
    s_mul_i32 s35, s29, 1280
    buffer_load_dwordx4 v[22:25], v3, s[16:19], s35 offen
    buffer_load_dword v26, v4, s[16:19], s35 offen offset:1024
    buffer_load_dwordx4 v[28:31], v3, s[20:23], 0 offen
    buffer_load_dword v32, v4, s[20:23], 0 offen offset:1024
    s_cmp_ge_u32 s96, 10
    s_cbranch_scc1 INM0_97
    v_and_b32 v5, 7, v0
    v_mul_u32_u24 v5, 1280, v5
    v_lshrrev_b32 v6, 4, v0
    v_lshl_add_u32 v5, v6, 5, v5
    v_bfe_u32 v6, v0, 3, 1
    v_lshl_add_u32 v5, v6, 4, v5
    s_lshl_b32 s29, s96, 7
    buffer_load_dwordx4 v[34:37], v5, s[24:27], s29 offen
INM0_97:
    s_waitcnt vmcnt(0)
    s_add_u32 s29, s28, 0
    s_cmp_ge_u32 s29, 2048
    s_cbranch_scc1 INR_98
    v_lshlrev_b32 v50, 16, v10
    v_and_b32 v60, 0xffff0000, v10
    v_lshlrev_b32 v51, 16, v11
    v_and_b32 v61, 0xffff0000, v11
    v_lshlrev_b32 v52, 16, v12
    v_and_b32 v62, 0xffff0000, v12
    v_lshlrev_b32 v53, 16, v13
    v_and_b32 v63, 0xffff0000, v13
    v_lshlrev_b32 v54, 16, v14
    v_and_b32 v64, 0xffff0000, v14
    v_add_f32 v70, v50, v60
    v_add_f32 v70, v70, v51
    v_add_f32 v70, v70, v61
    v_add_f32 v70, v70, v52
    v_add_f32 v70, v70, v62
    v_add_f32 v70, v70, v53
    v_add_f32 v70, v70, v63
    v_add_f32 v70, v70, v54
    v_add_f32 v70, v70, v64
    s_nop 1
    v_add_f32_dpp v70, v70, v70 quad_perm:[1,0,3,2] row_mask:0xf bank_mask:0xf
    s_nop 1
    v_add_f32_dpp v70, v70, v70 quad_perm:[2,3,0,1] row_mask:0xf bank_mask:0xf
    s_nop 1
    v_add_f32_dpp v70, v70, v70 row_half_mirror row_mask:0xf bank_mask:0xf
    s_nop 1
    v_add_f32_dpp v70, v70, v70 row_mirror row_mask:0xf bank_mask:0xf
    v_mov_b32 v71, v70
    s_nop 1
    v_permlane16_swap_b32 v70, v71
    v_add_f32 v70, v70, v71
    v_mov_b32 v71, v70
    s_nop 1
    v_permlane32_swap_b32 v70, v71
    v_add_f32 v70, v70, v71
    v_mul_f32 v72, 0x3acccccd, v70
    v_mov_b32 v73, 0
    v_sub_f32 v74, v50, v72
    v_fmac_f32 v73, v74, v74
    v_sub_f32 v74, v60, v72
    v_fmac_f32 v73, v74, v74
    v_sub_f32 v74, v51, v72
    v_fmac_f32 v73, v74, v74
    v_sub_f32 v74, v61, v72
    v_fmac_f32 v73, v74, v74
    v_sub_f32 v74, v52, v72
    v_fmac_f32 v73, v74, v74
    v_sub_f32 v74, v62, v72
    v_fmac_f32 v73, v74, v74
    v_sub_f32 v74, v53, v72
    v_fmac_f32 v73, v74, v74
    v_sub_f32 v74, v63, v72
    v_fmac_f32 v73, v74, v74
    v_sub_f32 v74, v54, v72
    v_fmac_f32 v73, v74, v74
    v_sub_f32 v74, v64, v72
    v_fmac_f32 v73, v74, v74
    s_nop 1
    v_add_f32_dpp v73, v73, v73 quad_perm:[1,0,3,2] row_mask:0xf bank_mask:0xf
    s_nop 1
    v_add_f32_dpp v73, v73, v73 quad_perm:[2,3,0,1] row_mask:0xf bank_mask:0xf
    s_nop 1
    v_add_f32_dpp v73, v73, v73 row_half_mirror row_mask:0xf bank_mask:0xf
    s_nop 1
    v_add_f32_dpp v73, v73, v73 row_mirror row_mask:0xf bank_mask:0xf
    v_mov_b32 v71, v73
    s_nop 1
    v_permlane16_swap_b32 v73, v71
    v_add_f32 v73, v73, v71
    v_mov_b32 v71, v73
    s_nop 1
    v_permlane32_swap_b32 v73, v71
    v_add_f32 v73, v73, v71
    v_mul_f32 v73, 0x3acccccd, v73
    v_cvt_pk_bf16_f32 v72, v72, v72
    v_lshlrev_b32 v72, 16, v72
    v_cvt_pk_bf16_f32 v73, v73, v73
    v_lshlrev_b32 v73, 16, v73
    v_add_f32 v73, 0x3727c5ac, v73
    v_cvt_pk_bf16_f32 v73, v73, v73
    v_lshlrev_b32 v73, 16, v73
    v_sqrt_f32 v73, v73
    s_nop 0
    v_cvt_pk_bf16_f32 v73, v73, v73
    v_lshlrev_b32 v73, 16, v73
    v_rcp_f32 v75, v73
    s_nop 0
    v_mov_b32 v76, 0
    v_sub_f32 v50, v50, v72
    v_cvt_pk_bf16_f32 v50, v50, v50
    v_lshlrev_b32 v50, 16, v50
    v_mul_f32 v74, v50, v75
    v_fma_f32 v77, -v74, v73, v50
    v_fma_f32 v50, v77, v75, v74
    v_sub_f32 v60, v60, v72
    v_cvt_pk_bf16_f32 v60, v60, v60
    v_lshlrev_b32 v60, 16, v60
    v_mul_f32 v74, v60, v75
    v_fma_f32 v77, -v74, v73, v60
    v_fma_f32 v60, v77, v75, v74
    v_cvt_pk_bf16_f32 v10, v50, v60
    v_lshlrev_b32 v74, 16, v10
    v_lshlrev_b32 v77, 16, v28
    v_fmac_f32 v76, v74, v77
    v_and_b32 v74, 0xffff0000, v10
    v_and_b32 v77, 0xffff0000, v28
    v_fmac_f32 v76, v74, v77
    v_sub_f32 v51, v51, v72
    v_cvt_pk_bf16_f32 v51, v51, v51
    v_lshlrev_b32 v51, 16, v51
    v_mul_f32 v74, v51, v75
    v_fma_f32 v77, -v74, v73, v51
    v_fma_f32 v51, v77, v75, v74
    v_sub_f32 v61, v61, v72
    v_cvt_pk_bf16_f32 v61, v61, v61
    v_lshlrev_b32 v61, 16, v61
    v_mul_f32 v74, v61, v75
    v_fma_f32 v77, -v74, v73, v61
    v_fma_f32 v61, v77, v75, v74
    v_cvt_pk_bf16_f32 v11, v51, v61
    v_lshlrev_b32 v74, 16, v11
    v_lshlrev_b32 v77, 16, v29
    v_fmac_f32 v76, v74, v77
    v_and_b32 v74, 0xffff0000, v11
    v_and_b32 v77, 0xffff0000, v29
    v_fmac_f32 v76, v74, v77
    v_sub_f32 v52, v52, v72
    v_cvt_pk_bf16_f32 v52, v52, v52
    v_lshlrev_b32 v52, 16, v52
    v_mul_f32 v74, v52, v75
    v_fma_f32 v77, -v74, v73, v52
    v_fma_f32 v52, v77, v75, v74
    v_sub_f32 v62, v62, v72
    v_cvt_pk_bf16_f32 v62, v62, v62
    v_lshlrev_b32 v62, 16, v62
    v_mul_f32 v74, v62, v75
    v_fma_f32 v77, -v74, v73, v62
    v_fma_f32 v62, v77, v75, v74
    v_cvt_pk_bf16_f32 v12, v52, v62
    v_lshlrev_b32 v74, 16, v12
    v_lshlrev_b32 v77, 16, v30
    v_fmac_f32 v76, v74, v77
    v_and_b32 v74, 0xffff0000, v12
    v_and_b32 v77, 0xffff0000, v30
    v_fmac_f32 v76, v74, v77
    v_sub_f32 v53, v53, v72
    v_cvt_pk_bf16_f32 v53, v53, v53
    v_lshlrev_b32 v53, 16, v53
    v_mul_f32 v74, v53, v75
    v_fma_f32 v77, -v74, v73, v53
    v_fma_f32 v53, v77, v75, v74
    v_sub_f32 v63, v63, v72
    v_cvt_pk_bf16_f32 v63, v63, v63
    v_lshlrev_b32 v63, 16, v63
    v_mul_f32 v74, v63, v75
    v_fma_f32 v77, -v74, v73, v63
    v_fma_f32 v63, v77, v75, v74
    v_cvt_pk_bf16_f32 v13, v53, v63
    v_lshlrev_b32 v74, 16, v13
    v_lshlrev_b32 v77, 16, v31
    v_fmac_f32 v76, v74, v77
    v_and_b32 v74, 0xffff0000, v13
    v_and_b32 v77, 0xffff0000, v31
    v_fmac_f32 v76, v74, v77
    v_sub_f32 v54, v54, v72
    v_cvt_pk_bf16_f32 v54, v54, v54
    v_lshlrev_b32 v54, 16, v54
    v_mul_f32 v74, v54, v75
    v_fma_f32 v77, -v74, v73, v54
    v_fma_f32 v54, v77, v75, v74
    v_sub_f32 v64, v64, v72
    v_cvt_pk_bf16_f32 v64, v64, v64
    v_lshlrev_b32 v64, 16, v64
    v_mul_f32 v74, v64, v75
    v_fma_f32 v77, -v74, v73, v64
    v_fma_f32 v64, v77, v75, v74
    v_cvt_pk_bf16_f32 v14, v54, v64
    v_lshlrev_b32 v74, 16, v14
    v_lshlrev_b32 v77, 16, v32
    v_fmac_f32 v76, v74, v77
    v_and_b32 v74, 0xffff0000, v14
    v_and_b32 v77, 0xffff0000, v32
    v_fmac_f32 v76, v74, v77
    s_add_u32 s30, s33, 0x0
    buffer_store_dwordx4 v[10:13], v3, s[4:7], s30 offen sc1
    buffer_store_dword v14, v4, s[4:7], s30 offen offset:1024 sc1
    s_nop 1
    v_add_f32_dpp v76, v76, v76 quad_perm:[1,0,3,2] row_mask:0xf bank_mask:0xf
    s_nop 1
    v_add_f32_dpp v76, v76, v76 quad_perm:[2,3,0,1] row_mask:0xf bank_mask:0xf
    s_nop 1
    v_add_f32_dpp v76, v76, v76 row_half_mirror row_mask:0xf bank_mask:0xf
    s_nop 1
    v_add_f32_dpp v76, v76, v76 row_mirror row_mask:0xf bank_mask:0xf
    v_mov_b32 v71, v76
    s_nop 1
    v_permlane16_swap_b32 v76, v71
    v_add_f32 v76, v76, v71
    v_mov_b32 v71, v76
    s_nop 1
    v_permlane32_swap_b32 v76, v71
    v_add_f32 v76, v76, v71
    v_cvt_pk_bf16_f32 v76, v76, v76
    v_lshlrev_b32 v76, 16, v76
    s_lshl_b32 s30, s29, 2
    s_add_u32 s30, s30, 0x280000
    s_mov_b64 exec, 1
    buffer_store_dword v76, off, s[4:7], s30 sc1
    s_mov_b64 exec, -1
INR_98:
    s_add_u32 s29, s28, 1
    s_cmp_ge_u32 s29, 2048
    s_cbranch_scc1 INR_99
    v_lshlrev_b32 v50, 16, v16
    v_and_b32 v60, 0xffff0000, v16
    v_lshlrev_b32 v51, 16, v17
    v_and_b32 v61, 0xffff0000, v17
    v_lshlrev_b32 v52, 16, v18
    v_and_b32 v62, 0xffff0000, v18
    v_lshlrev_b32 v53, 16, v19
    v_and_b32 v63, 0xffff0000, v19
    v_lshlrev_b32 v54, 16, v20
    v_and_b32 v64, 0xffff0000, v20
    v_add_f32 v70, v50, v60
    v_add_f32 v70, v70, v51
    v_add_f32 v70, v70, v61
    v_add_f32 v70, v70, v52
    v_add_f32 v70, v70, v62
    v_add_f32 v70, v70, v53
    v_add_f32 v70, v70, v63
    v_add_f32 v70, v70, v54
    v_add_f32 v70, v70, v64
    s_nop 1
    v_add_f32_dpp v70, v70, v70 quad_perm:[1,0,3,2] row_mask:0xf bank_mask:0xf
    s_nop 1
    v_add_f32_dpp v70, v70, v70 quad_perm:[2,3,0,1] row_mask:0xf bank_mask:0xf
    s_nop 1
    v_add_f32_dpp v70, v70, v70 row_half_mirror row_mask:0xf bank_mask:0xf
    s_nop 1
    v_add_f32_dpp v70, v70, v70 row_mirror row_mask:0xf bank_mask:0xf
    v_mov_b32 v71, v70
    s_nop 1
    v_permlane16_swap_b32 v70, v71
    v_add_f32 v70, v70, v71
    v_mov_b32 v71, v70
    s_nop 1
    v_permlane32_swap_b32 v70, v71
    v_add_f32 v70, v70, v71
    v_mul_f32 v72, 0x3acccccd, v70
    v_mov_b32 v73, 0
    v_sub_f32 v74, v50, v72
    v_fmac_f32 v73, v74, v74
    v_sub_f32 v74, v60, v72
    v_fmac_f32 v73, v74, v74
    v_sub_f32 v74, v51, v72
    v_fmac_f32 v73, v74, v74
    v_sub_f32 v74, v61, v72
    v_fmac_f32 v73, v74, v74
    v_sub_f32 v74, v52, v72
    v_fmac_f32 v73, v74, v74
    v_sub_f32 v74, v62, v72
    v_fmac_f32 v73, v74, v74
    v_sub_f32 v74, v53, v72
    v_fmac_f32 v73, v74, v74
    v_sub_f32 v74, v63, v72
    v_fmac_f32 v73, v74, v74
    v_sub_f32 v74, v54, v72
    v_fmac_f32 v73, v74, v74
    v_sub_f32 v74, v64, v72
    v_fmac_f32 v73, v74, v74
    s_nop 1
    v_add_f32_dpp v73, v73, v73 quad_perm:[1,0,3,2] row_mask:0xf bank_mask:0xf
    s_nop 1
    v_add_f32_dpp v73, v73, v73 quad_perm:[2,3,0,1] row_mask:0xf bank_mask:0xf
    s_nop 1
    v_add_f32_dpp v73, v73, v73 row_half_mirror row_mask:0xf bank_mask:0xf
    s_nop 1
    v_add_f32_dpp v73, v73, v73 row_mirror row_mask:0xf bank_mask:0xf
    v_mov_b32 v71, v73
    s_nop 1
    v_permlane16_swap_b32 v73, v71
    v_add_f32 v73, v73, v71
    v_mov_b32 v71, v73
    s_nop 1
    v_permlane32_swap_b32 v73, v71
    v_add_f32 v73, v73, v71
    v_mul_f32 v73, 0x3acccccd, v73
    v_cvt_pk_bf16_f32 v72, v72, v72
    v_lshlrev_b32 v72, 16, v72
    v_cvt_pk_bf16_f32 v73, v73, v73
    v_lshlrev_b32 v73, 16, v73
    v_add_f32 v73, 0x3727c5ac, v73
    v_cvt_pk_bf16_f32 v73, v73, v73
    v_lshlrev_b32 v73, 16, v73
    v_sqrt_f32 v73, v73
    s_nop 0
    v_cvt_pk_bf16_f32 v73, v73, v73
    v_lshlrev_b32 v73, 16, v73
    v_rcp_f32 v75, v73
    s_nop 0
    v_mov_b32 v76, 0
    v_sub_f32 v50, v50, v72
    v_cvt_pk_bf16_f32 v50, v50, v50
    v_lshlrev_b32 v50, 16, v50
    v_mul_f32 v74, v50, v75
    v_fma_f32 v77, -v74, v73, v50
    v_fma_f32 v50, v77, v75, v74
    v_sub_f32 v60, v60, v72
    v_cvt_pk_bf16_f32 v60, v60, v60
    v_lshlrev_b32 v60, 16, v60
    v_mul_f32 v74, v60, v75
    v_fma_f32 v77, -v74, v73, v60
    v_fma_f32 v60, v77, v75, v74
    v_cvt_pk_bf16_f32 v16, v50, v60
    v_lshlrev_b32 v74, 16, v16
    v_lshlrev_b32 v77, 16, v28
    v_fmac_f32 v76, v74, v77
    v_and_b32 v74, 0xffff0000, v16
    v_and_b32 v77, 0xffff0000, v28
    v_fmac_f32 v76, v74, v77
    v_sub_f32 v51, v51, v72
    v_cvt_pk_bf16_f32 v51, v51, v51
    v_lshlrev_b32 v51, 16, v51
    v_mul_f32 v74, v51, v75
    v_fma_f32 v77, -v74, v73, v51
    v_fma_f32 v51, v77, v75, v74
    v_sub_f32 v61, v61, v72
    v_cvt_pk_bf16_f32 v61, v61, v61
    v_lshlrev_b32 v61, 16, v61
    v_mul_f32 v74, v61, v75
    v_fma_f32 v77, -v74, v73, v61
    v_fma_f32 v61, v77, v75, v74
    v_cvt_pk_bf16_f32 v17, v51, v61
    v_lshlrev_b32 v74, 16, v17
    v_lshlrev_b32 v77, 16, v29
    v_fmac_f32 v76, v74, v77
    v_and_b32 v74, 0xffff0000, v17
    v_and_b32 v77, 0xffff0000, v29
    v_fmac_f32 v76, v74, v77
    v_sub_f32 v52, v52, v72
    v_cvt_pk_bf16_f32 v52, v52, v52
    v_lshlrev_b32 v52, 16, v52
    v_mul_f32 v74, v52, v75
    v_fma_f32 v77, -v74, v73, v52
    v_fma_f32 v52, v77, v75, v74
    v_sub_f32 v62, v62, v72
    v_cvt_pk_bf16_f32 v62, v62, v62
    v_lshlrev_b32 v62, 16, v62
    v_mul_f32 v74, v62, v75
    v_fma_f32 v77, -v74, v73, v62
    v_fma_f32 v62, v77, v75, v74
    v_cvt_pk_bf16_f32 v18, v52, v62
    v_lshlrev_b32 v74, 16, v18
    v_lshlrev_b32 v77, 16, v30
    v_fmac_f32 v76, v74, v77
    v_and_b32 v74, 0xffff0000, v18
    v_and_b32 v77, 0xffff0000, v30
    v_fmac_f32 v76, v74, v77
    v_sub_f32 v53, v53, v72
    v_cvt_pk_bf16_f32 v53, v53, v53
    v_lshlrev_b32 v53, 16, v53
    v_mul_f32 v74, v53, v75
    v_fma_f32 v77, -v74, v73, v53
    v_fma_f32 v53, v77, v75, v74
    v_sub_f32 v63, v63, v72
    v_cvt_pk_bf16_f32 v63, v63, v63
    v_lshlrev_b32 v63, 16, v63
    v_mul_f32 v74, v63, v75
    v_fma_f32 v77, -v74, v73, v63
    v_fma_f32 v63, v77, v75, v74
    v_cvt_pk_bf16_f32 v19, v53, v63
    v_lshlrev_b32 v74, 16, v19
    v_lshlrev_b32 v77, 16, v31
    v_fmac_f32 v76, v74, v77
    v_and_b32 v74, 0xffff0000, v19
    v_and_b32 v77, 0xffff0000, v31
    v_fmac_f32 v76, v74, v77
    v_sub_f32 v54, v54, v72
    v_cvt_pk_bf16_f32 v54, v54, v54
    v_lshlrev_b32 v54, 16, v54
    v_mul_f32 v74, v54, v75
    v_fma_f32 v77, -v74, v73, v54
    v_fma_f32 v54, v77, v75, v74
    v_sub_f32 v64, v64, v72
    v_cvt_pk_bf16_f32 v64, v64, v64
    v_lshlrev_b32 v64, 16, v64
    v_mul_f32 v74, v64, v75
    v_fma_f32 v77, -v74, v73, v64
    v_fma_f32 v64, v77, v75, v74
    v_cvt_pk_bf16_f32 v20, v54, v64
    v_lshlrev_b32 v74, 16, v20
    v_lshlrev_b32 v77, 16, v32
    v_fmac_f32 v76, v74, v77
    v_and_b32 v74, 0xffff0000, v20
    v_and_b32 v77, 0xffff0000, v32
    v_fmac_f32 v76, v74, v77
    s_add_u32 s30, s34, 0x0
    buffer_store_dwordx4 v[16:19], v3, s[4:7], s30 offen sc1
    buffer_store_dword v20, v4, s[4:7], s30 offen offset:1024 sc1
    s_nop 1
    v_add_f32_dpp v76, v76, v76 quad_perm:[1,0,3,2] row_mask:0xf bank_mask:0xf
    s_nop 1
    v_add_f32_dpp v76, v76, v76 quad_perm:[2,3,0,1] row_mask:0xf bank_mask:0xf
    s_nop 1
    v_add_f32_dpp v76, v76, v76 row_half_mirror row_mask:0xf bank_mask:0xf
    s_nop 1
    v_add_f32_dpp v76, v76, v76 row_mirror row_mask:0xf bank_mask:0xf
    v_mov_b32 v71, v76
    s_nop 1
    v_permlane16_swap_b32 v76, v71
    v_add_f32 v76, v76, v71
    v_mov_b32 v71, v76
    s_nop 1
    v_permlane32_swap_b32 v76, v71
    v_add_f32 v76, v76, v71
    v_cvt_pk_bf16_f32 v76, v76, v76
    v_lshlrev_b32 v76, 16, v76
    s_lshl_b32 s30, s29, 2
    s_add_u32 s30, s30, 0x280000
    s_mov_b64 exec, 1
    buffer_store_dword v76, off, s[4:7], s30 sc1
    s_mov_b64 exec, -1
INR_99:
    s_add_u32 s29, s28, 2
    s_cmp_ge_u32 s29, 2048
    s_cbranch_scc1 INR_100
    v_lshlrev_b32 v50, 16, v22
    v_and_b32 v60, 0xffff0000, v22
    v_lshlrev_b32 v51, 16, v23
    v_and_b32 v61, 0xffff0000, v23
    v_lshlrev_b32 v52, 16, v24
    v_and_b32 v62, 0xffff0000, v24
    v_lshlrev_b32 v53, 16, v25
    v_and_b32 v63, 0xffff0000, v25
    v_lshlrev_b32 v54, 16, v26
    v_and_b32 v64, 0xffff0000, v26
    v_add_f32 v70, v50, v60
    v_add_f32 v70, v70, v51
    v_add_f32 v70, v70, v61
    v_add_f32 v70, v70, v52
    v_add_f32 v70, v70, v62
    v_add_f32 v70, v70, v53
    v_add_f32 v70, v70, v63
    v_add_f32 v70, v70, v54
    v_add_f32 v70, v70, v64
    s_nop 1
    v_add_f32_dpp v70, v70, v70 quad_perm:[1,0,3,2] row_mask:0xf bank_mask:0xf
    s_nop 1
    v_add_f32_dpp v70, v70, v70 quad_perm:[2,3,0,1] row_mask:0xf bank_mask:0xf
    s_nop 1
    v_add_f32_dpp v70, v70, v70 row_half_mirror row_mask:0xf bank_mask:0xf
    s_nop 1
    v_add_f32_dpp v70, v70, v70 row_mirror row_mask:0xf bank_mask:0xf
    v_mov_b32 v71, v70
    s_nop 1
    v_permlane16_swap_b32 v70, v71
    v_add_f32 v70, v70, v71
    v_mov_b32 v71, v70
    s_nop 1
    v_permlane32_swap_b32 v70, v71
    v_add_f32 v70, v70, v71
    v_mul_f32 v72, 0x3acccccd, v70
    v_mov_b32 v73, 0
    v_sub_f32 v74, v50, v72
    v_fmac_f32 v73, v74, v74
    v_sub_f32 v74, v60, v72
    v_fmac_f32 v73, v74, v74
    v_sub_f32 v74, v51, v72
    v_fmac_f32 v73, v74, v74
    v_sub_f32 v74, v61, v72
    v_fmac_f32 v73, v74, v74
    v_sub_f32 v74, v52, v72
    v_fmac_f32 v73, v74, v74
    v_sub_f32 v74, v62, v72
    v_fmac_f32 v73, v74, v74
    v_sub_f32 v74, v53, v72
    v_fmac_f32 v73, v74, v74
    v_sub_f32 v74, v63, v72
    v_fmac_f32 v73, v74, v74
    v_sub_f32 v74, v54, v72
    v_fmac_f32 v73, v74, v74
    v_sub_f32 v74, v64, v72
    v_fmac_f32 v73, v74, v74
    s_nop 1
    v_add_f32_dpp v73, v73, v73 quad_perm:[1,0,3,2] row_mask:0xf bank_mask:0xf
    s_nop 1
    v_add_f32_dpp v73, v73, v73 quad_perm:[2,3,0,1] row_mask:0xf bank_mask:0xf
    s_nop 1
    v_add_f32_dpp v73, v73, v73 row_half_mirror row_mask:0xf bank_mask:0xf
    s_nop 1
    v_add_f32_dpp v73, v73, v73 row_mirror row_mask:0xf bank_mask:0xf
    v_mov_b32 v71, v73
    s_nop 1
    v_permlane16_swap_b32 v73, v71
    v_add_f32 v73, v73, v71
    v_mov_b32 v71, v73
    s_nop 1
    v_permlane32_swap_b32 v73, v71
    v_add_f32 v73, v73, v71
    v_mul_f32 v73, 0x3acccccd, v73
    v_cvt_pk_bf16_f32 v72, v72, v72
    v_lshlrev_b32 v72, 16, v72
    v_cvt_pk_bf16_f32 v73, v73, v73
    v_lshlrev_b32 v73, 16, v73
    v_add_f32 v73, 0x3727c5ac, v73
    v_cvt_pk_bf16_f32 v73, v73, v73
    v_lshlrev_b32 v73, 16, v73
    v_sqrt_f32 v73, v73
    s_nop 0
    v_cvt_pk_bf16_f32 v73, v73, v73
    v_lshlrev_b32 v73, 16, v73
    v_rcp_f32 v75, v73
    s_nop 0
    v_mov_b32 v76, 0
    v_sub_f32 v50, v50, v72
    v_cvt_pk_bf16_f32 v50, v50, v50
    v_lshlrev_b32 v50, 16, v50
    v_mul_f32 v74, v50, v75
    v_fma_f32 v77, -v74, v73, v50
    v_fma_f32 v50, v77, v75, v74
    v_sub_f32 v60, v60, v72
    v_cvt_pk_bf16_f32 v60, v60, v60
    v_lshlrev_b32 v60, 16, v60
    v_mul_f32 v74, v60, v75
    v_fma_f32 v77, -v74, v73, v60
    v_fma_f32 v60, v77, v75, v74
    v_cvt_pk_bf16_f32 v22, v50, v60
    v_lshlrev_b32 v74, 16, v22
    v_lshlrev_b32 v77, 16, v28
    v_fmac_f32 v76, v74, v77
    v_and_b32 v74, 0xffff0000, v22
    v_and_b32 v77, 0xffff0000, v28
    v_fmac_f32 v76, v74, v77
    v_sub_f32 v51, v51, v72
    v_cvt_pk_bf16_f32 v51, v51, v51
    v_lshlrev_b32 v51, 16, v51
    v_mul_f32 v74, v51, v75
    v_fma_f32 v77, -v74, v73, v51
    v_fma_f32 v51, v77, v75, v74
    v_sub_f32 v61, v61, v72
    v_cvt_pk_bf16_f32 v61, v61, v61
    v_lshlrev_b32 v61, 16, v61
    v_mul_f32 v74, v61, v75
    v_fma_f32 v77, -v74, v73, v61
    v_fma_f32 v61, v77, v75, v74
    v_cvt_pk_bf16_f32 v23, v51, v61
    v_lshlrev_b32 v74, 16, v23
    v_lshlrev_b32 v77, 16, v29
    v_fmac_f32 v76, v74, v77
    v_and_b32 v74, 0xffff0000, v23
    v_and_b32 v77, 0xffff0000, v29
    v_fmac_f32 v76, v74, v77
    v_sub_f32 v52, v52, v72
    v_cvt_pk_bf16_f32 v52, v52, v52
    v_lshlrev_b32 v52, 16, v52
    v_mul_f32 v74, v52, v75
    v_fma_f32 v77, -v74, v73, v52
    v_fma_f32 v52, v77, v75, v74
    v_sub_f32 v62, v62, v72
    v_cvt_pk_bf16_f32 v62, v62, v62
    v_lshlrev_b32 v62, 16, v62
    v_mul_f32 v74, v62, v75
    v_fma_f32 v77, -v74, v73, v62
    v_fma_f32 v62, v77, v75, v74
    v_cvt_pk_bf16_f32 v24, v52, v62
    v_lshlrev_b32 v74, 16, v24
    v_lshlrev_b32 v77, 16, v30
    v_fmac_f32 v76, v74, v77
    v_and_b32 v74, 0xffff0000, v24
    v_and_b32 v77, 0xffff0000, v30
    v_fmac_f32 v76, v74, v77
    v_sub_f32 v53, v53, v72
    v_cvt_pk_bf16_f32 v53, v53, v53
    v_lshlrev_b32 v53, 16, v53
    v_mul_f32 v74, v53, v75
    v_fma_f32 v77, -v74, v73, v53
    v_fma_f32 v53, v77, v75, v74
    v_sub_f32 v63, v63, v72
    v_cvt_pk_bf16_f32 v63, v63, v63
    v_lshlrev_b32 v63, 16, v63
    v_mul_f32 v74, v63, v75
    v_fma_f32 v77, -v74, v73, v63
    v_fma_f32 v63, v77, v75, v74
    v_cvt_pk_bf16_f32 v25, v53, v63
    v_lshlrev_b32 v74, 16, v25
    v_lshlrev_b32 v77, 16, v31
    v_fmac_f32 v76, v74, v77
    v_and_b32 v74, 0xffff0000, v25
    v_and_b32 v77, 0xffff0000, v31
    v_fmac_f32 v76, v74, v77
    v_sub_f32 v54, v54, v72
    v_cvt_pk_bf16_f32 v54, v54, v54
    v_lshlrev_b32 v54, 16, v54
    v_mul_f32 v74, v54, v75
    v_fma_f32 v77, -v74, v73, v54
    v_fma_f32 v54, v77, v75, v74
    v_sub_f32 v64, v64, v72
    v_cvt_pk_bf16_f32 v64, v64, v64
    v_lshlrev_b32 v64, 16, v64
    v_mul_f32 v74, v64, v75
    v_fma_f32 v77, -v74, v73, v64
    v_fma_f32 v64, v77, v75, v74
    v_cvt_pk_bf16_f32 v26, v54, v64
    v_lshlrev_b32 v74, 16, v26
    v_lshlrev_b32 v77, 16, v32
    v_fmac_f32 v76, v74, v77
    v_and_b32 v74, 0xffff0000, v26
    v_and_b32 v77, 0xffff0000, v32
    v_fmac_f32 v76, v74, v77
    s_add_u32 s30, s35, 0x0
    buffer_store_dwordx4 v[22:25], v3, s[4:7], s30 offen sc1
    buffer_store_dword v26, v4, s[4:7], s30 offen offset:1024 sc1
    s_nop 1
    v_add_f32_dpp v76, v76, v76 quad_perm:[1,0,3,2] row_mask:0xf bank_mask:0xf
    s_nop 1
    v_add_f32_dpp v76, v76, v76 quad_perm:[2,3,0,1] row_mask:0xf bank_mask:0xf
    s_nop 1
    v_add_f32_dpp v76, v76, v76 row_half_mirror row_mask:0xf bank_mask:0xf
    s_nop 1
    v_add_f32_dpp v76, v76, v76 row_mirror row_mask:0xf bank_mask:0xf
    v_mov_b32 v71, v76
    s_nop 1
    v_permlane16_swap_b32 v76, v71
    v_add_f32 v76, v76, v71
    v_mov_b32 v71, v76
    s_nop 1
    v_permlane32_swap_b32 v76, v71
    v_add_f32 v76, v76, v71
    v_cvt_pk_bf16_f32 v76, v76, v76
    v_lshlrev_b32 v76, 16, v76
    s_lshl_b32 s30, s29, 2
    s_add_u32 s30, s30, 0x280000
    s_mov_b64 exec, 1
    buffer_store_dword v76, off, s[4:7], s30 sc1
    s_mov_b64 exec, -1
INR_100:
    s_lshl_b32 s29, s96, 2
    s_add_u32 s29, s29, s14
    s_lshl_b32 s29, s29, 6
    v_add_u32 v5, s29, v0
    v_lshlrev_b32 v6, 4, v5
    v_mov_b32 v44, 0
    v_mov_b32 v45, 0
    v_mov_b32 v46, 0
    v_mov_b32 v47, 0
    v_cmp_gt_u32 vcc, 0x1000, v5
    s_nop 0
    s_and_saveexec_b64 s[38:39], vcc
    s_cbranch_execz INF_101
    s_mov_b32 s30, 0x290000
    buffer_store_dwordx4 v[44:47], v6, s[4:7], s30 offen sc1
INF_101:
    s_mov_b64 exec, s[38:39]
    s_waitcnt vmcnt(0)
    s_barrier
    s_cmp_lg_u32 s14, 0
    s_cbranch_scc1 INA_102
    v_mov_b32 v8, 1
    s_mov_b64 exec, 1
    buffer_atomic_add v8, off, s[60:63], s95 sc1
    s_mov_b64 exec, -1
INA_102:
INP2_96:
    s_lshl_b32 s29, s96, 2
    s_add_u32 s29, s29, s14
    s_lshl_b32 s29, s29, 6
    v_add_u32 v5, s29, v0
    v_lshlrev_b32 v6, 4, v5
    v_mov_b32 v40, -1
    v_mov_b32 v41, -1
    v_mov_b32 v42, -1
    v_mov_b32 v43, -1
    v_cmp_gt_u32 vcc, 0x5000, v5
    s_nop 0
    s_and_saveexec_b64 s[38:39], vcc
    s_cbranch_execz INF_103
    s_mov_b32 s30, 0x300000
    buffer_store_dwordx4 v[40:43], v6, s[4:7], s30 offen sc1
INF_103:
    s_mov_b64 exec, s[38:39]
    v_lshrrev_b32 v7, 6, v5
    v_mul_u32_u24 v7, 52429, v7
    v_lshrrev_b32 v7, 18, v7
    v_mul_u32_u24 v8, 320, v7
    v_sub_u32 v8, v5, v8
    v_lshlrev_b32 v48, 4, v8
    v_lshl_add_u32 v49, v7, 13, v48
    v_cmp_gt_u32 vcc, 0xa000, v5
    s_nop 0
    s_and_saveexec_b64 s[38:39], vcc
    s_cbranch_execz INF_104
    s_mov_b32 s30, 0x5904000
    buffer_store_dwordx4 v[40:43], v49, s[4:7], s30 offen sc1
INF_104:
    s_mov_b64 exec, s[38:39]
    s_cmp_ge_u32 s96, 10
    s_cbranch_scc1 INM1_105
    s_cmp_lg_u32 s14, 0
    s_cbranch_scc1 INM1_105
    s_cmp_ge_u32 s96, 5
    s_cselect_b32 s36, 1, 0
    s_mul_i32 s29, s36, 5
    s_sub_u32 s29, s96, s29
    s_lshl_b32 s29, s29, 10
    s_lshl_b32 s30, s36, 13
    s_add_u32 s30, s30, 0x5900000
    s_add_u32 s30, s30, s29
    buffer_store_dwordx4 v[34:37], v3, s[4:7], s30 offen sc1
INM1_105:
    s_lshl_b32 s40, s13, 8
    s_lshl_b32 s42, s14, 17
    s_add_u32 s40, s40, s42
    s_mul_i32 s41, s14, 40960
    v_lshrrev_b32 v81, 4, v0
    v_lshlrev_b32 v79, 13, v81
    v_lshlrev_b32 v81, 1, v81
    v_and_b32 v82, 15, v0
    v_xor_b32 v81, v81, v82
    v_xor_b32 v82, 8, v81
    v_lshl_add_u32 v80, v82, 4, v79
    v_lshl_add_u32 v79, v81, 4, v79
    s_add_u32 m0, s41, 0
    s_add_u32 s42, s40, 0x0
    buffer_load_dwordx4 v79, s[44:47], s42 offen lds
    s_add_u32 m0, s41, 1024
    s_add_u32 s42, s40, 0x8000
    buffer_load_dwordx4 v79, s[44:47], s42 offen lds
    s_add_u32 m0, s41, 2048
    s_add_u32 s42, s40, 0x10000
    buffer_load_dwordx4 v80, s[44:47], s42 offen lds
    s_add_u32 m0, s41, 3072
    s_add_u32 s42, s40, 0x18000
    buffer_load_dwordx4 v80, s[44:47], s42 offen lds
    s_add_u32 m0, s41, 4096
    s_add_u32 s42, s40, 0x80000
    buffer_load_dwordx4 v79, s[44:47], s42 offen lds
    s_add_u32 m0, s41, 5120
    s_add_u32 s42, s40, 0x88000
    buffer_load_dwordx4 v79, s[44:47], s42 offen lds
    s_add_u32 m0, s41, 6144
    s_add_u32 s42, s40, 0x90000
    buffer_load_dwordx4 v80, s[44:47], s42 offen lds
    s_add_u32 m0, s41, 7168
    s_add_u32 s42, s40, 0x98000
    buffer_load_dwordx4 v80, s[44:47], s42 offen lds
    s_add_u32 m0, s41, 8192
    s_add_u32 s42, s40, 0x100000
    buffer_load_dwordx4 v79, s[44:47], s42 offen lds
    s_add_u32 m0, s41, 9216
    s_add_u32 s42, s40, 0x108000
    buffer_load_dwordx4 v79, s[44:47], s42 offen lds
    s_add_u32 m0, s41, 10240
    s_add_u32 s42, s40, 0x110000
    buffer_load_dwordx4 v80, s[44:47], s42 offen lds
    s_add_u32 m0, s41, 11264
    s_add_u32 s42, s40, 0x118000
    buffer_load_dwordx4 v80, s[44:47], s42 offen lds
    s_add_u32 m0, s41, 12288
    s_add_u32 s42, s40, 0x180000
    buffer_load_dwordx4 v79, s[44:47], s42 offen lds
    s_add_u32 m0, s41, 13312
    s_add_u32 s42, s40, 0x188000
    buffer_load_dwordx4 v79, s[44:47], s42 offen lds
    s_add_u32 m0, s41, 14336
    s_add_u32 s42, s40, 0x190000
    buffer_load_dwordx4 v80, s[44:47], s42 offen lds
    s_add_u32 m0, s41, 15360
    s_add_u32 s42, s40, 0x198000
    buffer_load_dwordx4 v80, s[44:47], s42 offen lds
    s_add_u32 m0, s41, 16384
    s_add_u32 s42, s40, 0x200000
    buffer_load_dwordx4 v79, s[44:47], s42 offen lds
    s_add_u32 m0, s41, 17408
    s_add_u32 s42, s40, 0x208000
    buffer_load_dwordx4 v79, s[44:47], s42 offen lds
    s_add_u32 m0, s41, 18432
    s_add_u32 s42, s40, 0x210000
    buffer_load_dwordx4 v80, s[44:47], s42 offen lds
    s_add_u32 m0, s41, 19456
    s_add_u32 s42, s40, 0x218000
    buffer_load_dwordx4 v80, s[44:47], s42 offen lds
    s_add_u32 m0, s41, 20480
    s_add_u32 s42, s40, 0x280000
    buffer_load_dwordx4 v79, s[44:47], s42 offen lds
    s_add_u32 m0, s41, 21504
    s_add_u32 s42, s40, 0x288000
    buffer_load_dwordx4 v79, s[44:47], s42 offen lds
    s_add_u32 m0, s41, 22528
    s_add_u32 s42, s40, 0x290000
    buffer_load_dwordx4 v80, s[44:47], s42 offen lds
    s_add_u32 m0, s41, 23552
    s_add_u32 s42, s40, 0x298000
    buffer_load_dwordx4 v80, s[44:47], s42 offen lds
    s_add_u32 m0, s41, 24576
    s_add_u32 s42, s40, 0x300000
    buffer_load_dwordx4 v79, s[44:47], s42 offen lds
    s_add_u32 m0, s41, 25600
    s_add_u32 s42, s40, 0x308000
    buffer_load_dwordx4 v79, s[44:47], s42 offen lds
    s_add_u32 m0, s41, 26624
    s_add_u32 s42, s40, 0x310000
    buffer_load_dwordx4 v80, s[44:47], s42 offen lds
    s_add_u32 m0, s41, 27648
    s_add_u32 s42, s40, 0x318000
    buffer_load_dwordx4 v80, s[44:47], s42 offen lds
    s_add_u32 m0, s41, 28672
    s_add_u32 s42, s40, 0x380000
    buffer_load_dwordx4 v79, s[44:47], s42 offen lds
    s_add_u32 m0, s41, 29696
    s_add_u32 s42, s40, 0x388000
    buffer_load_dwordx4 v79, s[44:47], s42 offen lds
    s_add_u32 m0, s41, 30720
    s_add_u32 s42, s40, 0x390000
    buffer_load_dwordx4 v80, s[44:47], s42 offen lds
    s_add_u32 m0, s41, 31744
    s_add_u32 s42, s40, 0x398000
    buffer_load_dwordx4 v80, s[44:47], s42 offen lds
    s_add_u32 m0, s41, 32768
    s_add_u32 s42, s40, 0x400000
    buffer_load_dwordx4 v79, s[44:47], s42 offen lds
    s_add_u32 m0, s41, 33792
    s_add_u32 s42, s40, 0x408000
    buffer_load_dwordx4 v79, s[44:47], s42 offen lds
    s_add_u32 m0, s41, 34816
    s_add_u32 s42, s40, 0x410000
    buffer_load_dwordx4 v80, s[44:47], s42 offen lds
    s_add_u32 m0, s41, 35840
    s_add_u32 s42, s40, 0x418000
    buffer_load_dwordx4 v80, s[44:47], s42 offen lds
    s_add_u32 m0, s41, 36864
    s_add_u32 s42, s40, 0x480000
    buffer_load_dwordx4 v79, s[44:47], s42 offen lds
    s_add_u32 m0, s41, 37888
    s_add_u32 s42, s40, 0x488000
    buffer_load_dwordx4 v79, s[44:47], s42 offen lds
    s_add_u32 m0, s41, 38912
    s_add_u32 s42, s40, 0x490000
    buffer_load_dwordx4 v80, s[44:47], s42 offen lds
    s_add_u32 m0, s41, 39936
    s_add_u32 s42, s40, 0x498000
    buffer_load_dwordx4 v80, s[44:47], s42 offen lds
    v_mbcnt_lo_u32_b32 v0, -1, 0
    v_mbcnt_hi_u32_b32 v0, -1, v0
    s_cmp_eq_u32 s3, 0
    s_cbranch_scc1 H_E0
    s_cmp_eq_u32 s3, 1
    s_cbranch_scc1 H_E1
    s_cmp_eq_u32 s3, 2
    s_cbranch_scc1 H_E2
    s_branch M_EXIT
H_E0:
    s_lshl_b32 s16, s13, 14
    s_mov_b32 s17, 0x80000
    s_lshl_b32 s64, s14, 10
    s_add_u32 s16, s16, 0x1400000
    s_add_u32 s16, s16, s64
    s_mul_i32 s64, s12, s17
    s_lshl_b32 s64, s64, 2
    s_add_u32 s16, s16, s64
    s_lshl_b32 s18, s13, 4
    s_add_u32 s18, s18, 0x291000
    s_branch G_T
H_E1:
    s_lshl_b32 s16, s13, 14
    s_mov_b32 s17, 0x80000
    s_lshl_b32 s64, s14, 11
    s_add_u32 s16, s16, 0x1402000
    s_add_u32 s16, s16, s64
    s_mul_i32 s64, s12, s17
    s_lshl_b32 s64, s64, 2
    s_add_u32 s16, s16, s64
    s_lshl_b32 s18, s13, 4
    s_add_u32 s18, s18, 0x291004
    s_branch G_N
H_E2:
    s_lshl_b32 s16, s13, 13
    s_mov_b32 s17, 0x40000
    s_lshl_b32 s64, s14, 10
    s_add_u32 s16, s16, 0x3400000
    s_add_u32 s16, s16, s64
    s_mul_i32 s64, s12, s17
    s_lshl_b32 s64, s64, 2
    s_add_u32 s16, s16, s64
    s_lshl_b32 s18, s13, 4
    s_add_u32 s18, s18, 0x291008
    s_branch G_T
G_T:
    v_lshrrev_b32 v6, 5, v0
    v_mul_u32_u24 v7, 40960, v6
    v_bfe_u32 v6, v0, 4, 1
    v_lshl_add_u32 v7, v6, 11, v7
    v_lshlrev_b32 v8, 3, v6
    v_bfe_u32 v6, v0, 2, 2
    v_lshl_add_u32 v7, v6, 8, v7
    v_lshl_add_u32 v8, v6, 1, v8
    v_and_b32 v6, 1, v0
    v_lshl_add_u32 v7, v6, 3, v7
    v_bfe_u32 v6, v0, 1, 1
    s_lshl_b32 s64, s14, 2
    v_add_u32 v10, s64, v6
    v_add_u32 v6, 0, v10
    v_xor_b32 v6, v6, v8
    v_lshl_add_u32 v3, v6, 4, v7
    v_add_u32 v4, 81920, v3
    v_add_u32 v6, 2, v10
    v_xor_b32 v6, v6, v8
    v_lshl_add_u32 v5, v6, 4, v7
    v_add_u32 v9, 81920, v5
    s_waitcnt vmcnt(0)
    s_barrier
    ds_read_b64_tr_b16 v[96:97], v3 offset:0
    ds_read_b64_tr_b16 v[98:99], v3 offset:1024
    ds_read_b64_tr_b16 v[100:101], v5 offset:0
    ds_read_b64_tr_b16 v[102:103], v5 offset:1024
    ds_read_b64_tr_b16 v[104:105], v4 offset:0
    ds_read_b64_tr_b16 v[106:107], v4 offset:1024
    ds_read_b64_tr_b16 v[108:109], v9 offset:0
    ds_read_b64_tr_b16 v[110:111], v9 offset:1024
    ds_read_b64_tr_b16 v[112:113], v3 offset:4096
    ds_read_b64_tr_b16 v[114:115], v3 offset:5120
    ds_read_b64_tr_b16 v[116:117], v5 offset:4096
    ds_read_b64_tr_b16 v[118:119], v5 offset:5120
    ds_read_b64_tr_b16 v[120:121], v4 offset:4096
    ds_read_b64_tr_b16 v[122:123], v4 offset:5120
    ds_read_b64_tr_b16 v[124:125], v9 offset:4096
    ds_read_b64_tr_b16 v[126:127], v9 offset:5120
    s_waitcnt lgkmcnt(4)
    ds_read_b64_tr_b16 v[128:129], v3 offset:8192
    ds_read_b64_tr_b16 v[130:131], v3 offset:9216
    ds_read_b64_tr_b16 v[132:133], v5 offset:8192
    ds_read_b64_tr_b16 v[134:135], v5 offset:9216
    ds_read_b64_tr_b16 v[136:137], v4 offset:8192
    ds_read_b64_tr_b16 v[138:139], v4 offset:9216
    ds_read_b64_tr_b16 v[140:141], v9 offset:8192
    ds_read_b64_tr_b16 v[142:143], v9 offset:9216
    ds_read_b64_tr_b16 v[144:145], v3 offset:12288
    ds_read_b64_tr_b16 v[146:147], v3 offset:13312
    ds_read_b64_tr_b16 v[148:149], v5 offset:12288
    ds_read_b64_tr_b16 v[150:151], v5 offset:13312
    ds_read_b64_tr_b16 v[152:153], v4 offset:12288
    ds_read_b64_tr_b16 v[154:155], v4 offset:13312
    ds_read_b64_tr_b16 v[156:157], v9 offset:12288
    ds_read_b64_tr_b16 v[158:159], v9 offset:13312
    s_waitcnt lgkmcnt(4)
    ds_read_b64_tr_b16 v[160:161], v3 offset:16384
    ds_read_b64_tr_b16 v[162:163], v3 offset:17408
    ds_read_b64_tr_b16 v[164:165], v5 offset:16384
    ds_read_b64_tr_b16 v[166:167], v5 offset:17408
    ds_read_b64_tr_b16 v[168:169], v4 offset:16384
    ds_read_b64_tr_b16 v[170:171], v4 offset:17408
    ds_read_b64_tr_b16 v[172:173], v9 offset:16384
    ds_read_b64_tr_b16 v[174:175], v9 offset:17408
    ds_read_b64_tr_b16 v[176:177], v3 offset:20480
    ds_read_b64_tr_b16 v[178:179], v3 offset:21504
    ds_read_b64_tr_b16 v[180:181], v5 offset:20480
    ds_read_b64_tr_b16 v[182:183], v5 offset:21504
    ds_read_b64_tr_b16 v[184:185], v4 offset:20480
    ds_read_b64_tr_b16 v[186:187], v4 offset:21504
    ds_read_b64_tr_b16 v[188:189], v9 offset:20480
    ds_read_b64_tr_b16 v[190:191], v9 offset:21504
    s_waitcnt lgkmcnt(4)
    ds_read_b64_tr_b16 v[192:193], v3 offset:24576
    ds_read_b64_tr_b16 v[194:195], v3 offset:25600
    ds_read_b64_tr_b16 v[196:197], v5 offset:24576
    ds_read_b64_tr_b16 v[198:199], v5 offset:25600
    ds_read_b64_tr_b16 v[200:201], v4 offset:24576
    ds_read_b64_tr_b16 v[202:203], v4 offset:25600
    ds_read_b64_tr_b16 v[204:205], v9 offset:24576
    ds_read_b64_tr_b16 v[206:207], v9 offset:25600
    ds_read_b64_tr_b16 v[208:209], v3 offset:28672
    ds_read_b64_tr_b16 v[210:211], v3 offset:29696
    ds_read_b64_tr_b16 v[212:213], v5 offset:28672
    ds_read_b64_tr_b16 v[214:215], v5 offset:29696
    ds_read_b64_tr_b16 v[216:217], v4 offset:28672
    ds_read_b64_tr_b16 v[218:219], v4 offset:29696
    ds_read_b64_tr_b16 v[220:221], v9 offset:28672
    ds_read_b64_tr_b16 v[222:223], v9 offset:29696
    s_waitcnt lgkmcnt(4)
    ds_read_b64_tr_b16 v[224:225], v3 offset:32768
    ds_read_b64_tr_b16 v[226:227], v3 offset:33792
    ds_read_b64_tr_b16 v[228:229], v5 offset:32768
    ds_read_b64_tr_b16 v[230:231], v5 offset:33792
    ds_read_b64_tr_b16 v[232:233], v4 offset:32768
    ds_read_b64_tr_b16 v[234:235], v4 offset:33792
    ds_read_b64_tr_b16 v[236:237], v9 offset:32768
    ds_read_b64_tr_b16 v[238:239], v9 offset:33792
    ds_read_b64_tr_b16 v[240:241], v3 offset:36864
    ds_read_b64_tr_b16 v[242:243], v3 offset:37888
    ds_read_b64_tr_b16 v[244:245], v5 offset:36864
    ds_read_b64_tr_b16 v[246:247], v5 offset:37888
    ds_read_b64_tr_b16 v[248:249], v4 offset:36864
    ds_read_b64_tr_b16 v[250:251], v4 offset:37888
    ds_read_b64_tr_b16 v[252:253], v9 offset:36864
    ds_read_b64_tr_b16 v[254:255], v9 offset:37888
    s_waitcnt lgkmcnt(0)
    s_cmp_lg_u32 s97, 0
    s_cbranch_scc1 CM_106
    v_mbcnt_lo_u32_b32 v0, -1, 0
    v_mbcnt_hi_u32_b32 v0, -1, v0
    v_mul_u32_u24 v8, 32, v0
    s_mov_b32 s64, 0x0
    s_mov_b32 s65, 0
    s_mov_b64 exec, 0xff
TK_107:
    buffer_load_dword v9, v8, s[60:63], s64 offen sc1
    s_add_u32 s65, s65, 1
    s_waitcnt vmcnt(0)
    s_mov_b32 s66, 0
    v_readlane_b32 s67, v9, 0
    s_add_u32 s66, s66, s67
    v_readlane_b32 s67, v9, 1
    s_add_u32 s66, s66, s67
    v_readlane_b32 s67, v9, 2
    s_add_u32 s66, s66, s67
    v_readlane_b32 s67, v9, 3
    s_add_u32 s66, s66, s67
    v_readlane_b32 s67, v9, 4
    s_add_u32 s66, s66, s67
    v_readlane_b32 s67, v9, 5
    s_add_u32 s66, s66, s67
    v_readlane_b32 s67, v9, 6
    s_add_u32 s66, s66, s67
    v_readlane_b32 s67, v9, 7
    s_add_u32 s66, s66, s67
    s_cmp_ge_u32 s66, 256
    s_cbranch_scc1 TKD_108
    s_cmp_gt_u32 s65, 262144
    s_cbranch_scc0 TK_107
TKD_108:
    v_cmp_ne_u32 vcc, 32, v9
    s_mov_b64 exec, -1
    s_cbranch_vccnz M_SLOW
CM_106:
    s_mov_b32 s65, 0
GI_109:
    buffer_load_dword v8, off, s[60:63], s95 sc1
    s_add_u32 s65, s65, 1
    s_waitcnt vmcnt(0)
    v_readfirstlane_b32 s64, v8
    s_cmp_ge_u32 s64, 186
    s_cbranch_scc1 GID_110
    s_cmp_gt_u32 s65, 65536
    s_cbranch_scc1 GID_110
    s_sleep 4
    s_branch GI_109
GID_110:
    v_mbcnt_lo_u32_b32 v0, -1, 0
    v_mbcnt_hi_u32_b32 v0, -1, v0
    s_mov_b32 s65, 0
CW_111:
    buffer_load_dwordx2 v[8:9], off, s[60:63], 0 offset:132 sc1
    s_add_u32 s65, s65, 1
    s_waitcnt vmcnt(0)
    v_readfirstlane_b32 s30, v8
    v_readfirstlane_b32 s31, v9
    s_min_u32 s64, s30, s31
    s_cmp_lg_u32 s64, 0
    s_cbranch_scc1 CWD_112
    s_cmp_gt_u32 s65, 65536
    s_cbranch_scc1 CWD_112
    s_sleep 4
    s_branch CW_111
CWD_112:
    s_sub_u32 s30, s30, 1
    s_and_b32 s30, s30, 3
    s_sub_u32 s31, s31, 1
    s_and_b32 s31, s31, 3
    s_lshl_b32 s34, s96, 2
    s_add_u32 s34, s34, s14
    s_lshl_b32 s34, s34, 6
    v_add_u32 v5, s34, v0
    v_lshlrev_b32 v3, 4, v0
    v_mov_b32 v40, -1
    v_mov_b32 v41, -1
    v_mov_b32 v42, -1
    v_mov_b32 v43, -1
    v_lshrrev_b32 v7, 6, v5
    v_mul_u32_u24 v7, 52429, v7
    v_lshrrev_b32 v7, 18, v7
    v_mul_u32_u24 v8, 320, v7
    v_sub_u32 v8, v5, v8
    v_lshlrev_b32 v48, 4, v8
    s_lshl_b32 s30, s30, 13
    s_lshl_b32 s31, s31, 13
    s_add_u32 s31, s31, 0x200000
    v_and_b32 v8, 1, v7
    v_cmp_eq_u32 vcc, 1, v8
    v_mov_b32 v8, s30
    v_mov_b32 v9, s31
    v_cndmask_b32 v8, v8, v9, vcc
    v_lshrrev_b32 v9, 1, v7
    v_lshl_add_u32 v8, v9, 15, v8
    v_add_u32 v49, v8, v48
    v_cmp_le_u32 vcc, 640, v5
    v_mov_b32 v9, 0x40000000
    s_nop 0
    v_cndmask_b32 v49, v9, v49, vcc
    v_cmp_gt_u32 vcc, 0xa000, v5
    s_nop 0
    s_and_saveexec_b64 s[38:39], vcc
    s_cbranch_execz INF_113
    s_mov_b32 s35, 0x6000000
    buffer_store_dwordx4 v[40:43], v49, s[4:7], s35 offen sc1
INF_113:
    s_mov_b64 exec, s[38:39]
    s_cmp_ge_u32 s96, 10
    s_cbranch_scc1 INM2_114
    s_cmp_lg_u32 s14, 1
    s_cbranch_scc1 INM2_114
    s_cmp_ge_u32 s96, 5
    s_cselect_b32 s36, 1, 0
    s_mul_i32 s34, s36, 5
    s_sub_u32 s34, s96, s34
    s_lshl_b32 s34, s34, 10
    s_cmp_eq_u32 s36, 0
    s_cselect_b32 s37, s30, s31
    s_add_u32 s37, s37, 0x6000000
    s_add_u32 s37, s37, s34
    buffer_store_dwordx4 v[34:37], v3, s[4:7], s37 offen sc1
INM2_114:
    s_cmp_lg_u32 s3, 2
    s_cbranch_scc1 NOSEL_115
    s_or_b32 s64, s13, s12
    s_or_b32 s64, s64, s14
    s_cmp_lg_u32 s64, 0
    s_cbranch_scc1 NOSEL_115
    s_mov_b32 s29, 0
    v_lshlrev_b32 v1, 4, v0
    s_mov_b32 s64, 0x280000
    buffer_load_dwordx4 v[16:19], v1, s[4:7], s64 offen offset:0 sc1
    buffer_load_dwordx4 v[20:23], v1, s[4:7], s64 offen offset:1024 sc1
    buffer_load_dwordx4 v[24:27], v1, s[4:7], s64 offen offset:2048 sc1
    buffer_load_dwordx4 v[28:31], v1, s[4:7], s64 offen offset:3072 sc1
    s_add_u32 s64, s64, 4096
    buffer_load_dwordx4 v[32:35], v1, s[4:7], s64 offen offset:0 sc1
    buffer_load_dwordx4 v[36:39], v1, s[4:7], s64 offen offset:1024 sc1
    buffer_load_dwordx4 v[40:43], v1, s[4:7], s64 offen offset:2048 sc1
    buffer_load_dwordx4 v[44:47], v1, s[4:7], s64 offen offset:3072 sc1
    s_waitcnt vmcnt(0)
    v_lshlrev_b32 v2, 2, v0
    v_ashrrev_i32 v3, 31, v16
    v_or_b32 v3, 0x80000000, v3
    v_xor_b32 v16, v16, v3
    v_and_b32 v16, 0xffff0000, v16
    v_sub_u32 v3, 65535, v2
    v_or_b32 v16, v16, v3
    v_ashrrev_i32 v3, 31, v17
    v_or_b32 v3, 0x80000000, v3
    v_xor_b32 v17, v17, v3
    v_and_b32 v17, 0xffff0000, v17
    v_sub_u32 v3, 65534, v2
    v_or_b32 v17, v17, v3
    v_ashrrev_i32 v3, 31, v18
    v_or_b32 v3, 0x80000000, v3
    v_xor_b32 v18, v18, v3
    v_and_b32 v18, 0xffff0000, v18
    v_sub_u32 v3, 65533, v2
    v_or_b32 v18, v18, v3
    v_ashrrev_i32 v3, 31, v19
    v_or_b32 v3, 0x80000000, v3
    v_xor_b32 v19, v19, v3
    v_and_b32 v19, 0xffff0000, v19
    v_sub_u32 v3, 65532, v2
    v_or_b32 v19, v19, v3
    v_ashrrev_i32 v3, 31, v20
    v_or_b32 v3, 0x80000000, v3
    v_xor_b32 v20, v20, v3
    v_and_b32 v20, 0xffff0000, v20
    v_sub_u32 v3, 65279, v2
    v_or_b32 v20, v20, v3
    v_ashrrev_i32 v3, 31, v21
    v_or_b32 v3, 0x80000000, v3
    v_xor_b32 v21, v21, v3
    v_and_b32 v21, 0xffff0000, v21
    v_sub_u32 v3, 65278, v2
    v_or_b32 v21, v21, v3
    v_ashrrev_i32 v3, 31, v22
    v_or_b32 v3, 0x80000000, v3
    v_xor_b32 v22, v22, v3
    v_and_b32 v22, 0xffff0000, v22
    v_sub_u32 v3, 65277, v2
    v_or_b32 v22, v22, v3
    v_ashrrev_i32 v3, 31, v23
    v_or_b32 v3, 0x80000000, v3
    v_xor_b32 v23, v23, v3
    v_and_b32 v23, 0xffff0000, v23
    v_sub_u32 v3, 65276, v2
    v_or_b32 v23, v23, v3
    v_ashrrev_i32 v3, 31, v24
    v_or_b32 v3, 0x80000000, v3
    v_xor_b32 v24, v24, v3
    v_and_b32 v24, 0xffff0000, v24
    v_sub_u32 v3, 65023, v2
    v_or_b32 v24, v24, v3
    v_ashrrev_i32 v3, 31, v25
    v_or_b32 v3, 0x80000000, v3
    v_xor_b32 v25, v25, v3
    v_and_b32 v25, 0xffff0000, v25
    v_sub_u32 v3, 65022, v2
    v_or_b32 v25, v25, v3
    v_ashrrev_i32 v3, 31, v26
    v_or_b32 v3, 0x80000000, v3
    v_xor_b32 v26, v26, v3
    v_and_b32 v26, 0xffff0000, v26
    v_sub_u32 v3, 65021, v2
    v_or_b32 v26, v26, v3
    v_ashrrev_i32 v3, 31, v27
    v_or_b32 v3, 0x80000000, v3
    v_xor_b32 v27, v27, v3
    v_and_b32 v27, 0xffff0000, v27
    v_sub_u32 v3, 65020, v2
    v_or_b32 v27, v27, v3
    v_ashrrev_i32 v3, 31, v28
    v_or_b32 v3, 0x80000000, v3
    v_xor_b32 v28, v28, v3
    v_and_b32 v28, 0xffff0000, v28
    v_sub_u32 v3, 64767, v2
    v_or_b32 v28, v28, v3
    v_ashrrev_i32 v3, 31, v29
    v_or_b32 v3, 0x80000000, v3
    v_xor_b32 v29, v29, v3
    v_and_b32 v29, 0xffff0000, v29
    v_sub_u32 v3, 64766, v2
    v_or_b32 v29, v29, v3
    v_ashrrev_i32 v3, 31, v30
    v_or_b32 v3, 0x80000000, v3
    v_xor_b32 v30, v30, v3
    v_and_b32 v30, 0xffff0000, v30
    v_sub_u32 v3, 64765, v2
    v_or_b32 v30, v30, v3
    v_ashrrev_i32 v3, 31, v31
    v_or_b32 v3, 0x80000000, v3
    v_xor_b32 v31, v31, v3
    v_and_b32 v31, 0xffff0000, v31
    v_sub_u32 v3, 64764, v2
    v_or_b32 v31, v31, v3
    v_ashrrev_i32 v3, 31, v32
    v_or_b32 v3, 0x80000000, v3
    v_xor_b32 v32, v32, v3
    v_and_b32 v32, 0xffff0000, v32
    v_sub_u32 v3, 64511, v2
    v_or_b32 v32, v32, v3
    v_ashrrev_i32 v3, 31, v33
    v_or_b32 v3, 0x80000000, v3
    v_xor_b32 v33, v33, v3
    v_and_b32 v33, 0xffff0000, v33
    v_sub_u32 v3, 64510, v2
    v_or_b32 v33, v33, v3
    v_ashrrev_i32 v3, 31, v34
    v_or_b32 v3, 0x80000000, v3
    v_xor_b32 v34, v34, v3
    v_and_b32 v34, 0xffff0000, v34
    v_sub_u32 v3, 64509, v2
    v_or_b32 v34, v34, v3
    v_ashrrev_i32 v3, 31, v35
    v_or_b32 v3, 0x80000000, v3
    v_xor_b32 v35, v35, v3
    v_and_b32 v35, 0xffff0000, v35
    v_sub_u32 v3, 64508, v2
    v_or_b32 v35, v35, v3
    v_ashrrev_i32 v3, 31, v36
    v_or_b32 v3, 0x80000000, v3
    v_xor_b32 v36, v36, v3
    v_and_b32 v36, 0xffff0000, v36
    v_sub_u32 v3, 64255, v2
    v_or_b32 v36, v36, v3
    v_ashrrev_i32 v3, 31, v37
    v_or_b32 v3, 0x80000000, v3
    v_xor_b32 v37, v37, v3
    v_and_b32 v37, 0xffff0000, v37
    v_sub_u32 v3, 64254, v2
    v_or_b32 v37, v37, v3
    v_ashrrev_i32 v3, 31, v38
    v_or_b32 v3, 0x80000000, v3
    v_xor_b32 v38, v38, v3
    v_and_b32 v38, 0xffff0000, v38
    v_sub_u32 v3, 64253, v2
    v_or_b32 v38, v38, v3
    v_ashrrev_i32 v3, 31, v39
    v_or_b32 v3, 0x80000000, v3
    v_xor_b32 v39, v39, v3
    v_and_b32 v39, 0xffff0000, v39
    v_sub_u32 v3, 64252, v2
    v_or_b32 v39, v39, v3
    v_ashrrev_i32 v3, 31, v40
    v_or_b32 v3, 0x80000000, v3
    v_xor_b32 v40, v40, v3
    v_and_b32 v40, 0xffff0000, v40
    v_sub_u32 v3, 63999, v2
    v_or_b32 v40, v40, v3
    v_ashrrev_i32 v3, 31, v41
    v_or_b32 v3, 0x80000000, v3
    v_xor_b32 v41, v41, v3
    v_and_b32 v41, 0xffff0000, v41
    v_sub_u32 v3, 63998, v2
    v_or_b32 v41, v41, v3
    v_ashrrev_i32 v3, 31, v42
    v_or_b32 v3, 0x80000000, v3
    v_xor_b32 v42, v42, v3
    v_and_b32 v42, 0xffff0000, v42
    v_sub_u32 v3, 63997, v2
    v_or_b32 v42, v42, v3
    v_ashrrev_i32 v3, 31, v43
    v_or_b32 v3, 0x80000000, v3
    v_xor_b32 v43, v43, v3
    v_and_b32 v43, 0xffff0000, v43
    v_sub_u32 v3, 63996, v2
    v_or_b32 v43, v43, v3
    v_ashrrev_i32 v3, 31, v44
    v_or_b32 v3, 0x80000000, v3
    v_xor_b32 v44, v44, v3
    v_and_b32 v44, 0xffff0000, v44
    v_sub_u32 v3, 63743, v2
    v_or_b32 v44, v44, v3
    v_ashrrev_i32 v3, 31, v45
    v_or_b32 v3, 0x80000000, v3
    v_xor_b32 v45, v45, v3
    v_and_b32 v45, 0xffff0000, v45
    v_sub_u32 v3, 63742, v2
    v_or_b32 v45, v45, v3
    v_ashrrev_i32 v3, 31, v46
    v_or_b32 v3, 0x80000000, v3
    v_xor_b32 v46, v46, v3
    v_and_b32 v46, 0xffff0000, v46
    v_sub_u32 v3, 63741, v2
    v_or_b32 v46, v46, v3
    v_ashrrev_i32 v3, 31, v47
    v_or_b32 v3, 0x80000000, v3
    v_xor_b32 v47, v47, v3
    v_and_b32 v47, 0xffff0000, v47
    v_sub_u32 v3, 63740, v2
    v_or_b32 v47, v47, v3
    v_max3_u32 v4, v16, v17, v18
    v_max3_u32 v4, v4, v19, v20
    v_max3_u32 v4, v4, v21, v22
    v_max3_u32 v4, v4, v23, v24
    v_max3_u32 v4, v4, v25, v26
    v_max3_u32 v4, v4, v27, v28
    v_max3_u32 v4, v4, v29, v30
    v_max3_u32 v4, v4, v31, v32
    v_max3_u32 v4, v4, v33, v34
    v_max3_u32 v4, v4, v35, v36
    v_max3_u32 v4, v4, v37, v38
    v_max3_u32 v4, v4, v39, v40
    v_max3_u32 v4, v4, v41, v42
    v_max3_u32 v4, v4, v43, v44
    v_max3_u32 v4, v4, v45, v46
    v_max_u32 v4, v4, v47
    s_nop 1
    v_max_u32_dpp v4, v4, v4 quad_perm:[1,0,3,2] row_mask:0xf bank_mask:0xf
    s_nop 1
    v_max_u32_dpp v4, v4, v4 quad_perm:[2,3,0,1] row_mask:0xf bank_mask:0xf
    s_nop 1
    v_max_u32_dpp v4, v4, v4 row_half_mirror row_mask:0xf bank_mask:0xf
    s_nop 1
    v_max_u32_dpp v4, v4, v4 row_mirror row_mask:0xf bank_mask:0xf
    v_mov_b32 v5, v4
    s_nop 1
    v_permlane16_swap_b32 v4, v5
    v_max_u32 v4, v4, v5
    v_mov_b32 v5, v4
    s_nop 1
    v_permlane32_swap_b32 v4, v5
    v_max_u32 v4, v4, v5
    v_mov_b32 v56, v4
    v_cmp_eq_u32 vcc, v4, v16
    s_nop 1
    v_cndmask_b32 v16, v16, 0, vcc
    v_cmp_eq_u32 vcc, v4, v17
    s_nop 1
    v_cndmask_b32 v17, v17, 0, vcc
    v_cmp_eq_u32 vcc, v4, v18
    s_nop 1
    v_cndmask_b32 v18, v18, 0, vcc
    v_cmp_eq_u32 vcc, v4, v19
    s_nop 1
    v_cndmask_b32 v19, v19, 0, vcc
    v_cmp_eq_u32 vcc, v4, v20
    s_nop 1
    v_cndmask_b32 v20, v20, 0, vcc
    v_cmp_eq_u32 vcc, v4, v21
    s_nop 1
    v_cndmask_b32 v21, v21, 0, vcc
    v_cmp_eq_u32 vcc, v4, v22
    s_nop 1
    v_cndmask_b32 v22, v22, 0, vcc
    v_cmp_eq_u32 vcc, v4, v23
    s_nop 1
    v_cndmask_b32 v23, v23, 0, vcc
    v_cmp_eq_u32 vcc, v4, v24
    s_nop 1
    v_cndmask_b32 v24, v24, 0, vcc
    v_cmp_eq_u32 vcc, v4, v25
    s_nop 1
    v_cndmask_b32 v25, v25, 0, vcc
    v_cmp_eq_u32 vcc, v4, v26
    s_nop 1
    v_cndmask_b32 v26, v26, 0, vcc
    v_cmp_eq_u32 vcc, v4, v27
    s_nop 1
    v_cndmask_b32 v27, v27, 0, vcc
    v_cmp_eq_u32 vcc, v4, v28
    s_nop 1
    v_cndmask_b32 v28, v28, 0, vcc
    v_cmp_eq_u32 vcc, v4, v29
    s_nop 1
    v_cndmask_b32 v29, v29, 0, vcc
    v_cmp_eq_u32 vcc, v4, v30
    s_nop 1
    v_cndmask_b32 v30, v30, 0, vcc
    v_cmp_eq_u32 vcc, v4, v31
    s_nop 1
    v_cndmask_b32 v31, v31, 0, vcc
    v_cmp_eq_u32 vcc, v4, v32
    s_nop 1
    v_cndmask_b32 v32, v32, 0, vcc
    v_cmp_eq_u32 vcc, v4, v33
    s_nop 1
    v_cndmask_b32 v33, v33, 0, vcc
    v_cmp_eq_u32 vcc, v4, v34
    s_nop 1
    v_cndmask_b32 v34, v34, 0, vcc
    v_cmp_eq_u32 vcc, v4, v35
    s_nop 1
    v_cndmask_b32 v35, v35, 0, vcc
    v_cmp_eq_u32 vcc, v4, v36
    s_nop 1
    v_cndmask_b32 v36, v36, 0, vcc
    v_cmp_eq_u32 vcc, v4, v37
    s_nop 1
    v_cndmask_b32 v37, v37, 0, vcc
    v_cmp_eq_u32 vcc, v4, v38
    s_nop 1
    v_cndmask_b32 v38, v38, 0, vcc
    v_cmp_eq_u32 vcc, v4, v39
    s_nop 1
    v_cndmask_b32 v39, v39, 0, vcc
    v_cmp_eq_u32 vcc, v4, v40
    s_nop 1
    v_cndmask_b32 v40, v40, 0, vcc
    v_cmp_eq_u32 vcc, v4, v41
    s_nop 1
    v_cndmask_b32 v41, v41, 0, vcc
    v_cmp_eq_u32 vcc, v4, v42
    s_nop 1
    v_cndmask_b32 v42, v42, 0, vcc
    v_cmp_eq_u32 vcc, v4, v43
    s_nop 1
    v_cndmask_b32 v43, v43, 0, vcc
    v_cmp_eq_u32 vcc, v4, v44
    s_nop 1
    v_cndmask_b32 v44, v44, 0, vcc
    v_cmp_eq_u32 vcc, v4, v45
    s_nop 1
    v_cndmask_b32 v45, v45, 0, vcc
    v_cmp_eq_u32 vcc, v4, v46
    s_nop 1
    v_cndmask_b32 v46, v46, 0, vcc
    v_cmp_eq_u32 vcc, v4, v47
    s_nop 1
    v_cndmask_b32 v47, v47, 0, vcc
    v_max3_u32 v4, v16, v17, v18
    v_max3_u32 v4, v4, v19, v20
    v_max3_u32 v4, v4, v21, v22
    v_max3_u32 v4, v4, v23, v24
    v_max3_u32 v4, v4, v25, v26
    v_max3_u32 v4, v4, v27, v28
    v_max3_u32 v4, v4, v29, v30
    v_max3_u32 v4, v4, v31, v32
    v_max3_u32 v4, v4, v33, v34
    v_max3_u32 v4, v4, v35, v36
    v_max3_u32 v4, v4, v37, v38
    v_max3_u32 v4, v4, v39, v40
    v_max3_u32 v4, v4, v41, v42
    v_max3_u32 v4, v4, v43, v44
    v_max3_u32 v4, v4, v45, v46
    v_max_u32 v4, v4, v47
    s_nop 1
    v_max_u32_dpp v4, v4, v4 quad_perm:[1,0,3,2] row_mask:0xf bank_mask:0xf
    s_nop 1
    v_max_u32_dpp v4, v4, v4 quad_perm:[2,3,0,1] row_mask:0xf bank_mask:0xf
    s_nop 1
    v_max_u32_dpp v4, v4, v4 row_half_mirror row_mask:0xf bank_mask:0xf
    s_nop 1
    v_max_u32_dpp v4, v4, v4 row_mirror row_mask:0xf bank_mask:0xf
    v_mov_b32 v5, v4
    s_nop 1
    v_permlane16_swap_b32 v4, v5
    v_max_u32 v4, v4, v5
    v_mov_b32 v5, v4
    s_nop 1
    v_permlane32_swap_b32 v4, v5
    v_max_u32 v4, v4, v5
    v_mov_b32 v57, v4
    v_cmp_eq_u32 vcc, v4, v16
    s_nop 1
    v_cndmask_b32 v16, v16, 0, vcc
    v_cmp_eq_u32 vcc, v4, v17
    s_nop 1
    v_cndmask_b32 v17, v17, 0, vcc
    v_cmp_eq_u32 vcc, v4, v18
    s_nop 1
    v_cndmask_b32 v18, v18, 0, vcc
    v_cmp_eq_u32 vcc, v4, v19
    s_nop 1
    v_cndmask_b32 v19, v19, 0, vcc
    v_cmp_eq_u32 vcc, v4, v20
    s_nop 1
    v_cndmask_b32 v20, v20, 0, vcc
    v_cmp_eq_u32 vcc, v4, v21
    s_nop 1
    v_cndmask_b32 v21, v21, 0, vcc
    v_cmp_eq_u32 vcc, v4, v22
    s_nop 1
    v_cndmask_b32 v22, v22, 0, vcc
    v_cmp_eq_u32 vcc, v4, v23
    s_nop 1
    v_cndmask_b32 v23, v23, 0, vcc
    v_cmp_eq_u32 vcc, v4, v24
    s_nop 1
    v_cndmask_b32 v24, v24, 0, vcc
    v_cmp_eq_u32 vcc, v4, v25
    s_nop 1
    v_cndmask_b32 v25, v25, 0, vcc
    v_cmp_eq_u32 vcc, v4, v26
    s_nop 1
    v_cndmask_b32 v26, v26, 0, vcc
    v_cmp_eq_u32 vcc, v4, v27
    s_nop 1
    v_cndmask_b32 v27, v27, 0, vcc
    v_cmp_eq_u32 vcc, v4, v28
    s_nop 1
    v_cndmask_b32 v28, v28, 0, vcc
    v_cmp_eq_u32 vcc, v4, v29
    s_nop 1
    v_cndmask_b32 v29, v29, 0, vcc
    v_cmp_eq_u32 vcc, v4, v30
    s_nop 1
    v_cndmask_b32 v30, v30, 0, vcc
    v_cmp_eq_u32 vcc, v4, v31
    s_nop 1
    v_cndmask_b32 v31, v31, 0, vcc
    v_cmp_eq_u32 vcc, v4, v32
    s_nop 1
    v_cndmask_b32 v32, v32, 0, vcc
    v_cmp_eq_u32 vcc, v4, v33
    s_nop 1
    v_cndmask_b32 v33, v33, 0, vcc
    v_cmp_eq_u32 vcc, v4, v34
    s_nop 1
    v_cndmask_b32 v34, v34, 0, vcc
    v_cmp_eq_u32 vcc, v4, v35
    s_nop 1
    v_cndmask_b32 v35, v35, 0, vcc
    v_cmp_eq_u32 vcc, v4, v36
    s_nop 1
    v_cndmask_b32 v36, v36, 0, vcc
    v_cmp_eq_u32 vcc, v4, v37
    s_nop 1
    v_cndmask_b32 v37, v37, 0, vcc
    v_cmp_eq_u32 vcc, v4, v38
    s_nop 1
    v_cndmask_b32 v38, v38, 0, vcc
    v_cmp_eq_u32 vcc, v4, v39
    s_nop 1
    v_cndmask_b32 v39, v39, 0, vcc
    v_cmp_eq_u32 vcc, v4, v40
    s_nop 1
    v_cndmask_b32 v40, v40, 0, vcc
    v_cmp_eq_u32 vcc, v4, v41
    s_nop 1
    v_cndmask_b32 v41, v41, 0, vcc
    v_cmp_eq_u32 vcc, v4, v42
    s_nop 1
    v_cndmask_b32 v42, v42, 0, vcc
    v_cmp_eq_u32 vcc, v4, v43
    s_nop 1
    v_cndmask_b32 v43, v43, 0, vcc
    v_cmp_eq_u32 vcc, v4, v44
    s_nop 1
    v_cndmask_b32 v44, v44, 0, vcc
    v_cmp_eq_u32 vcc, v4, v45
    s_nop 1
    v_cndmask_b32 v45, v45, 0, vcc
    v_cmp_eq_u32 vcc, v4, v46
    s_nop 1
    v_cndmask_b32 v46, v46, 0, vcc
    v_cmp_eq_u32 vcc, v4, v47
    s_nop 1
    v_cndmask_b32 v47, v47, 0, vcc
    v_max3_u32 v4, v16, v17, v18
    v_max3_u32 v4, v4, v19, v20
    v_max3_u32 v4, v4, v21, v22
    v_max3_u32 v4, v4, v23, v24
    v_max3_u32 v4, v4, v25, v26
    v_max3_u32 v4, v4, v27, v28
    v_max3_u32 v4, v4, v29, v30
    v_max3_u32 v4, v4, v31, v32
    v_max3_u32 v4, v4, v33, v34
    v_max3_u32 v4, v4, v35, v36
    v_max3_u32 v4, v4, v37, v38
    v_max3_u32 v4, v4, v39, v40
    v_max3_u32 v4, v4, v41, v42
    v_max3_u32 v4, v4, v43, v44
    v_max3_u32 v4, v4, v45, v46
    v_max_u32 v4, v4, v47
    s_nop 1
    v_max_u32_dpp v4, v4, v4 quad_perm:[1,0,3,2] row_mask:0xf bank_mask:0xf
    s_nop 1
    v_max_u32_dpp v4, v4, v4 quad_perm:[2,3,0,1] row_mask:0xf bank_mask:0xf
    s_nop 1
    v_max_u32_dpp v4, v4, v4 row_half_mirror row_mask:0xf bank_mask:0xf
    s_nop 1
    v_max_u32_dpp v4, v4, v4 row_mirror row_mask:0xf bank_mask:0xf
    v_mov_b32 v5, v4
    s_nop 1
    v_permlane16_swap_b32 v4, v5
    v_max_u32 v4, v4, v5
    v_mov_b32 v5, v4
    s_nop 1
    v_permlane32_swap_b32 v4, v5
    v_max_u32 v4, v4, v5
    v_mov_b32 v58, v4
    v_cmp_eq_u32 vcc, v4, v16
    s_nop 1
    v_cndmask_b32 v16, v16, 0, vcc
    v_cmp_eq_u32 vcc, v4, v17
    s_nop 1
    v_cndmask_b32 v17, v17, 0, vcc
    v_cmp_eq_u32 vcc, v4, v18
    s_nop 1
    v_cndmask_b32 v18, v18, 0, vcc
    v_cmp_eq_u32 vcc, v4, v19
    s_nop 1
    v_cndmask_b32 v19, v19, 0, vcc
    v_cmp_eq_u32 vcc, v4, v20
    s_nop 1
    v_cndmask_b32 v20, v20, 0, vcc
    v_cmp_eq_u32 vcc, v4, v21
    s_nop 1
    v_cndmask_b32 v21, v21, 0, vcc
    v_cmp_eq_u32 vcc, v4, v22
    s_nop 1
    v_cndmask_b32 v22, v22, 0, vcc
    v_cmp_eq_u32 vcc, v4, v23
    s_nop 1
    v_cndmask_b32 v23, v23, 0, vcc
    v_cmp_eq_u32 vcc, v4, v24
    s_nop 1
    v_cndmask_b32 v24, v24, 0, vcc
    v_cmp_eq_u32 vcc, v4, v25
    s_nop 1
    v_cndmask_b32 v25, v25, 0, vcc
    v_cmp_eq_u32 vcc, v4, v26
    s_nop 1
    v_cndmask_b32 v26, v26, 0, vcc
    v_cmp_eq_u32 vcc, v4, v27
    s_nop 1
    v_cndmask_b32 v27, v27, 0, vcc
    v_cmp_eq_u32 vcc, v4, v28
    s_nop 1
    v_cndmask_b32 v28, v28, 0, vcc
    v_cmp_eq_u32 vcc, v4, v29
    s_nop 1
    v_cndmask_b32 v29, v29, 0, vcc
    v_cmp_eq_u32 vcc, v4, v30
    s_nop 1
    v_cndmask_b32 v30, v30, 0, vcc
    v_cmp_eq_u32 vcc, v4, v31
    s_nop 1
    v_cndmask_b32 v31, v31, 0, vcc
    v_cmp_eq_u32 vcc, v4, v32
    s_nop 1
    v_cndmask_b32 v32, v32, 0, vcc
    v_cmp_eq_u32 vcc, v4, v33
    s_nop 1
    v_cndmask_b32 v33, v33, 0, vcc
    v_cmp_eq_u32 vcc, v4, v34
    s_nop 1
    v_cndmask_b32 v34, v34, 0, vcc
    v_cmp_eq_u32 vcc, v4, v35
    s_nop 1
    v_cndmask_b32 v35, v35, 0, vcc
    v_cmp_eq_u32 vcc, v4, v36
    s_nop 1
    v_cndmask_b32 v36, v36, 0, vcc
    v_cmp_eq_u32 vcc, v4, v37
    s_nop 1
    v_cndmask_b32 v37, v37, 0, vcc
    v_cmp_eq_u32 vcc, v4, v38
    s_nop 1
    v_cndmask_b32 v38, v38, 0, vcc
    v_cmp_eq_u32 vcc, v4, v39
    s_nop 1
    v_cndmask_b32 v39, v39, 0, vcc
    v_cmp_eq_u32 vcc, v4, v40
    s_nop 1
    v_cndmask_b32 v40, v40, 0, vcc
    v_cmp_eq_u32 vcc, v4, v41
    s_nop 1
    v_cndmask_b32 v41, v41, 0, vcc
    v_cmp_eq_u32 vcc, v4, v42
    s_nop 1
    v_cndmask_b32 v42, v42, 0, vcc
    v_cmp_eq_u32 vcc, v4, v43
    s_nop 1
    v_cndmask_b32 v43, v43, 0, vcc
    v_cmp_eq_u32 vcc, v4, v44
    s_nop 1
    v_cndmask_b32 v44, v44, 0, vcc
    v_cmp_eq_u32 vcc, v4, v45
    s_nop 1
    v_cndmask_b32 v45, v45, 0, vcc
    v_cmp_eq_u32 vcc, v4, v46
    s_nop 1
    v_cndmask_b32 v46, v46, 0, vcc
    v_cmp_eq_u32 vcc, v4, v47
    s_nop 1
    v_cndmask_b32 v47, v47, 0, vcc
    v_max3_u32 v4, v16, v17, v18
    v_max3_u32 v4, v4, v19, v20
    v_max3_u32 v4, v4, v21, v22
    v_max3_u32 v4, v4, v23, v24
    v_max3_u32 v4, v4, v25, v26
    v_max3_u32 v4, v4, v27, v28
    v_max3_u32 v4, v4, v29, v30
    v_max3_u32 v4, v4, v31, v32
    v_max3_u32 v4, v4, v33, v34
    v_max3_u32 v4, v4, v35, v36
    v_max3_u32 v4, v4, v37, v38
    v_max3_u32 v4, v4, v39, v40
    v_max3_u32 v4, v4, v41, v42
    v_max3_u32 v4, v4, v43, v44
    v_max3_u32 v4, v4, v45, v46
    v_max_u32 v4, v4, v47
    s_nop 1
    v_max_u32_dpp v4, v4, v4 quad_perm:[1,0,3,2] row_mask:0xf bank_mask:0xf
    s_nop 1
    v_max_u32_dpp v4, v4, v4 quad_perm:[2,3,0,1] row_mask:0xf bank_mask:0xf
    s_nop 1
    v_max_u32_dpp v4, v4, v4 row_half_mirror row_mask:0xf bank_mask:0xf
    s_nop 1
    v_max_u32_dpp v4, v4, v4 row_mirror row_mask:0xf bank_mask:0xf
    v_mov_b32 v5, v4
    s_nop 1
    v_permlane16_swap_b32 v4, v5
    v_max_u32 v4, v4, v5
    v_mov_b32 v5, v4
    s_nop 1
    v_permlane32_swap_b32 v4, v5
    v_max_u32 v4, v4, v5
    v_mov_b32 v59, v4
    v_cmp_eq_u32 vcc, v4, v16
    s_nop 1
    v_cndmask_b32 v16, v16, 0, vcc
    v_cmp_eq_u32 vcc, v4, v17
    s_nop 1
    v_cndmask_b32 v17, v17, 0, vcc
    v_cmp_eq_u32 vcc, v4, v18
    s_nop 1
    v_cndmask_b32 v18, v18, 0, vcc
    v_cmp_eq_u32 vcc, v4, v19
    s_nop 1
    v_cndmask_b32 v19, v19, 0, vcc
    v_cmp_eq_u32 vcc, v4, v20
    s_nop 1
    v_cndmask_b32 v20, v20, 0, vcc
    v_cmp_eq_u32 vcc, v4, v21
    s_nop 1
    v_cndmask_b32 v21, v21, 0, vcc
    v_cmp_eq_u32 vcc, v4, v22
    s_nop 1
    v_cndmask_b32 v22, v22, 0, vcc
    v_cmp_eq_u32 vcc, v4, v23
    s_nop 1
    v_cndmask_b32 v23, v23, 0, vcc
    v_cmp_eq_u32 vcc, v4, v24
    s_nop 1
    v_cndmask_b32 v24, v24, 0, vcc
    v_cmp_eq_u32 vcc, v4, v25
    s_nop 1
    v_cndmask_b32 v25, v25, 0, vcc
    v_cmp_eq_u32 vcc, v4, v26
    s_nop 1
    v_cndmask_b32 v26, v26, 0, vcc
    v_cmp_eq_u32 vcc, v4, v27
    s_nop 1
    v_cndmask_b32 v27, v27, 0, vcc
    v_cmp_eq_u32 vcc, v4, v28
    s_nop 1
    v_cndmask_b32 v28, v28, 0, vcc
    v_cmp_eq_u32 vcc, v4, v29
    s_nop 1
    v_cndmask_b32 v29, v29, 0, vcc
    v_cmp_eq_u32 vcc, v4, v30
    s_nop 1
    v_cndmask_b32 v30, v30, 0, vcc
    v_cmp_eq_u32 vcc, v4, v31
    s_nop 1
    v_cndmask_b32 v31, v31, 0, vcc
    v_cmp_eq_u32 vcc, v4, v32
    s_nop 1
    v_cndmask_b32 v32, v32, 0, vcc
    v_cmp_eq_u32 vcc, v4, v33
    s_nop 1
    v_cndmask_b32 v33, v33, 0, vcc
    v_cmp_eq_u32 vcc, v4, v34
    s_nop 1
    v_cndmask_b32 v34, v34, 0, vcc
    v_cmp_eq_u32 vcc, v4, v35
    s_nop 1
    v_cndmask_b32 v35, v35, 0, vcc
    v_cmp_eq_u32 vcc, v4, v36
    s_nop 1
    v_cndmask_b32 v36, v36, 0, vcc
    v_cmp_eq_u32 vcc, v4, v37
    s_nop 1
    v_cndmask_b32 v37, v37, 0, vcc
    v_cmp_eq_u32 vcc, v4, v38
    s_nop 1
    v_cndmask_b32 v38, v38, 0, vcc
    v_cmp_eq_u32 vcc, v4, v39
    s_nop 1
    v_cndmask_b32 v39, v39, 0, vcc
    v_cmp_eq_u32 vcc, v4, v40
    s_nop 1
    v_cndmask_b32 v40, v40, 0, vcc
    v_cmp_eq_u32 vcc, v4, v41
    s_nop 1
    v_cndmask_b32 v41, v41, 0, vcc
    v_cmp_eq_u32 vcc, v4, v42
    s_nop 1
    v_cndmask_b32 v42, v42, 0, vcc
    v_cmp_eq_u32 vcc, v4, v43
    s_nop 1
    v_cndmask_b32 v43, v43, 0, vcc
    v_cmp_eq_u32 vcc, v4, v44
    s_nop 1
    v_cndmask_b32 v44, v44, 0, vcc
    v_cmp_eq_u32 vcc, v4, v45
    s_nop 1
    v_cndmask_b32 v45, v45, 0, vcc
    v_cmp_eq_u32 vcc, v4, v46
    s_nop 1
    v_cndmask_b32 v46, v46, 0, vcc
    v_cmp_eq_u32 vcc, v4, v47
    s_nop 1
    v_cndmask_b32 v47, v47, 0, vcc
    v_max3_u32 v4, v16, v17, v18
    v_max3_u32 v4, v4, v19, v20
    v_max3_u32 v4, v4, v21, v22
    v_max3_u32 v4, v4, v23, v24
    v_max3_u32 v4, v4, v25, v26
    v_max3_u32 v4, v4, v27, v28
    v_max3_u32 v4, v4, v29, v30
    v_max3_u32 v4, v4, v31, v32
    v_max3_u32 v4, v4, v33, v34
    v_max3_u32 v4, v4, v35, v36
    v_max3_u32 v4, v4, v37, v38
    v_max3_u32 v4, v4, v39, v40
    v_max3_u32 v4, v4, v41, v42
    v_max3_u32 v4, v4, v43, v44
    v_max3_u32 v4, v4, v45, v46
    v_max_u32 v4, v4, v47
    s_nop 1
    v_max_u32_dpp v4, v4, v4 quad_perm:[1,0,3,2] row_mask:0xf bank_mask:0xf
    s_nop 1
    v_max_u32_dpp v4, v4, v4 quad_perm:[2,3,0,1] row_mask:0xf bank_mask:0xf
    s_nop 1
    v_max_u32_dpp v4, v4, v4 row_half_mirror row_mask:0xf bank_mask:0xf
    s_nop 1
    v_max_u32_dpp v4, v4, v4 row_mirror row_mask:0xf bank_mask:0xf
    v_mov_b32 v5, v4
    s_nop 1
    v_permlane16_swap_b32 v4, v5
    v_max_u32 v4, v4, v5
    v_mov_b32 v5, v4
    s_nop 1
    v_permlane32_swap_b32 v4, v5
    v_max_u32 v4, v4, v5
    v_mov_b32 v60, v4
    v_cmp_eq_u32 vcc, v4, v16
    s_nop 1
    v_cndmask_b32 v16, v16, 0, vcc
    v_cmp_eq_u32 vcc, v4, v17
    s_nop 1
    v_cndmask_b32 v17, v17, 0, vcc
    v_cmp_eq_u32 vcc, v4, v18
    s_nop 1
    v_cndmask_b32 v18, v18, 0, vcc
    v_cmp_eq_u32 vcc, v4, v19
    s_nop 1
    v_cndmask_b32 v19, v19, 0, vcc
    v_cmp_eq_u32 vcc, v4, v20
    s_nop 1
    v_cndmask_b32 v20, v20, 0, vcc
    v_cmp_eq_u32 vcc, v4, v21
    s_nop 1
    v_cndmask_b32 v21, v21, 0, vcc
    v_cmp_eq_u32 vcc, v4, v22
    s_nop 1
    v_cndmask_b32 v22, v22, 0, vcc
    v_cmp_eq_u32 vcc, v4, v23
    s_nop 1
    v_cndmask_b32 v23, v23, 0, vcc
    v_cmp_eq_u32 vcc, v4, v24
    s_nop 1
    v_cndmask_b32 v24, v24, 0, vcc
    v_cmp_eq_u32 vcc, v4, v25
    s_nop 1
    v_cndmask_b32 v25, v25, 0, vcc
    v_cmp_eq_u32 vcc, v4, v26
    s_nop 1
    v_cndmask_b32 v26, v26, 0, vcc
    v_cmp_eq_u32 vcc, v4, v27
    s_nop 1
    v_cndmask_b32 v27, v27, 0, vcc
    v_cmp_eq_u32 vcc, v4, v28
    s_nop 1
    v_cndmask_b32 v28, v28, 0, vcc
    v_cmp_eq_u32 vcc, v4, v29
    s_nop 1
    v_cndmask_b32 v29, v29, 0, vcc
    v_cmp_eq_u32 vcc, v4, v30
    s_nop 1
    v_cndmask_b32 v30, v30, 0, vcc
    v_cmp_eq_u32 vcc, v4, v31
    s_nop 1
    v_cndmask_b32 v31, v31, 0, vcc
    v_cmp_eq_u32 vcc, v4, v32
    s_nop 1
    v_cndmask_b32 v32, v32, 0, vcc
    v_cmp_eq_u32 vcc, v4, v33
    s_nop 1
    v_cndmask_b32 v33, v33, 0, vcc
    v_cmp_eq_u32 vcc, v4, v34
    s_nop 1
    v_cndmask_b32 v34, v34, 0, vcc
    v_cmp_eq_u32 vcc, v4, v35
    s_nop 1
    v_cndmask_b32 v35, v35, 0, vcc
    v_cmp_eq_u32 vcc, v4, v36
    s_nop 1
    v_cndmask_b32 v36, v36, 0, vcc
    v_cmp_eq_u32 vcc, v4, v37
    s_nop 1
    v_cndmask_b32 v37, v37, 0, vcc
    v_cmp_eq_u32 vcc, v4, v38
    s_nop 1
    v_cndmask_b32 v38, v38, 0, vcc
    v_cmp_eq_u32 vcc, v4, v39
    s_nop 1
    v_cndmask_b32 v39, v39, 0, vcc
    v_cmp_eq_u32 vcc, v4, v40
    s_nop 1
    v_cndmask_b32 v40, v40, 0, vcc
    v_cmp_eq_u32 vcc, v4, v41
    s_nop 1
    v_cndmask_b32 v41, v41, 0, vcc
    v_cmp_eq_u32 vcc, v4, v42
    s_nop 1
    v_cndmask_b32 v42, v42, 0, vcc
    v_cmp_eq_u32 vcc, v4, v43
    s_nop 1
    v_cndmask_b32 v43, v43, 0, vcc
    v_cmp_eq_u32 vcc, v4, v44
    s_nop 1
    v_cndmask_b32 v44, v44, 0, vcc
    v_cmp_eq_u32 vcc, v4, v45
    s_nop 1
    v_cndmask_b32 v45, v45, 0, vcc
    v_cmp_eq_u32 vcc, v4, v46
    s_nop 1
    v_cndmask_b32 v46, v46, 0, vcc
    v_cmp_eq_u32 vcc, v4, v47
    s_nop 1
    v_cndmask_b32 v47, v47, 0, vcc
    v_max3_u32 v4, v16, v17, v18
    v_max3_u32 v4, v4, v19, v20
    v_max3_u32 v4, v4, v21, v22
    v_max3_u32 v4, v4, v23, v24
    v_max3_u32 v4, v4, v25, v26
    v_max3_u32 v4, v4, v27, v28
    v_max3_u32 v4, v4, v29, v30
    v_max3_u32 v4, v4, v31, v32
    v_max3_u32 v4, v4, v33, v34
    v_max3_u32 v4, v4, v35, v36
    v_max3_u32 v4, v4, v37, v38
    v_max3_u32 v4, v4, v39, v40
    v_max3_u32 v4, v4, v41, v42
    v_max3_u32 v4, v4, v43, v44
    v_max3_u32 v4, v4, v45, v46
    v_max_u32 v4, v4, v47
    s_nop 1
    v_max_u32_dpp v4, v4, v4 quad_perm:[1,0,3,2] row_mask:0xf bank_mask:0xf
    s_nop 1
    v_max_u32_dpp v4, v4, v4 quad_perm:[2,3,0,1] row_mask:0xf bank_mask:0xf
    s_nop 1
    v_max_u32_dpp v4, v4, v4 row_half_mirror row_mask:0xf bank_mask:0xf
    s_nop 1
    v_max_u32_dpp v4, v4, v4 row_mirror row_mask:0xf bank_mask:0xf
    v_mov_b32 v5, v4
    s_nop 1
    v_permlane16_swap_b32 v4, v5
    v_max_u32 v4, v4, v5
    v_mov_b32 v5, v4
    s_nop 1
    v_permlane32_swap_b32 v4, v5
    v_max_u32 v4, v4, v5
    v_mov_b32 v61, v4
    v_cmp_eq_u32 vcc, v4, v16
    s_nop 1
    v_cndmask_b32 v16, v16, 0, vcc
    v_cmp_eq_u32 vcc, v4, v17
    s_nop 1
    v_cndmask_b32 v17, v17, 0, vcc
    v_cmp_eq_u32 vcc, v4, v18
    s_nop 1
    v_cndmask_b32 v18, v18, 0, vcc
    v_cmp_eq_u32 vcc, v4, v19
    s_nop 1
    v_cndmask_b32 v19, v19, 0, vcc
    v_cmp_eq_u32 vcc, v4, v20
    s_nop 1
    v_cndmask_b32 v20, v20, 0, vcc
    v_cmp_eq_u32 vcc, v4, v21
    s_nop 1
    v_cndmask_b32 v21, v21, 0, vcc
    v_cmp_eq_u32 vcc, v4, v22
    s_nop 1
    v_cndmask_b32 v22, v22, 0, vcc
    v_cmp_eq_u32 vcc, v4, v23
    s_nop 1
    v_cndmask_b32 v23, v23, 0, vcc
    v_cmp_eq_u32 vcc, v4, v24
    s_nop 1
    v_cndmask_b32 v24, v24, 0, vcc
    v_cmp_eq_u32 vcc, v4, v25
    s_nop 1
    v_cndmask_b32 v25, v25, 0, vcc
    v_cmp_eq_u32 vcc, v4, v26
    s_nop 1
    v_cndmask_b32 v26, v26, 0, vcc
    v_cmp_eq_u32 vcc, v4, v27
    s_nop 1
    v_cndmask_b32 v27, v27, 0, vcc
    v_cmp_eq_u32 vcc, v4, v28
    s_nop 1
    v_cndmask_b32 v28, v28, 0, vcc
    v_cmp_eq_u32 vcc, v4, v29
    s_nop 1
    v_cndmask_b32 v29, v29, 0, vcc
    v_cmp_eq_u32 vcc, v4, v30
    s_nop 1
    v_cndmask_b32 v30, v30, 0, vcc
    v_cmp_eq_u32 vcc, v4, v31
    s_nop 1
    v_cndmask_b32 v31, v31, 0, vcc
    v_cmp_eq_u32 vcc, v4, v32
    s_nop 1
    v_cndmask_b32 v32, v32, 0, vcc
    v_cmp_eq_u32 vcc, v4, v33
    s_nop 1
    v_cndmask_b32 v33, v33, 0, vcc
    v_cmp_eq_u32 vcc, v4, v34
    s_nop 1
    v_cndmask_b32 v34, v34, 0, vcc
    v_cmp_eq_u32 vcc, v4, v35
    s_nop 1
    v_cndmask_b32 v35, v35, 0, vcc
    v_cmp_eq_u32 vcc, v4, v36
    s_nop 1
    v_cndmask_b32 v36, v36, 0, vcc
    v_cmp_eq_u32 vcc, v4, v37
    s_nop 1
    v_cndmask_b32 v37, v37, 0, vcc
    v_cmp_eq_u32 vcc, v4, v38
    s_nop 1
    v_cndmask_b32 v38, v38, 0, vcc
    v_cmp_eq_u32 vcc, v4, v39
    s_nop 1
    v_cndmask_b32 v39, v39, 0, vcc
    v_cmp_eq_u32 vcc, v4, v40
    s_nop 1
    v_cndmask_b32 v40, v40, 0, vcc
    v_cmp_eq_u32 vcc, v4, v41
    s_nop 1
    v_cndmask_b32 v41, v41, 0, vcc
    v_cmp_eq_u32 vcc, v4, v42
    s_nop 1
    v_cndmask_b32 v42, v42, 0, vcc
    v_cmp_eq_u32 vcc, v4, v43
    s_nop 1
    v_cndmask_b32 v43, v43, 0, vcc
    v_cmp_eq_u32 vcc, v4, v44
    s_nop 1
    v_cndmask_b32 v44, v44, 0, vcc
    v_cmp_eq_u32 vcc, v4, v45
    s_nop 1
    v_cndmask_b32 v45, v45, 0, vcc
    v_cmp_eq_u32 vcc, v4, v46
    s_nop 1
    v_cndmask_b32 v46, v46, 0, vcc
    v_cmp_eq_u32 vcc, v4, v47
    s_nop 1
    v_cndmask_b32 v47, v47, 0, vcc
    v_max3_u32 v4, v16, v17, v18
    v_max3_u32 v4, v4, v19, v20
    v_max3_u32 v4, v4, v21, v22
    v_max3_u32 v4, v4, v23, v24
    v_max3_u32 v4, v4, v25, v26
    v_max3_u32 v4, v4, v27, v28
    v_max3_u32 v4, v4, v29, v30
    v_max3_u32 v4, v4, v31, v32
    v_max3_u32 v4, v4, v33, v34
    v_max3_u32 v4, v4, v35, v36
    v_max3_u32 v4, v4, v37, v38
    v_max3_u32 v4, v4, v39, v40
    v_max3_u32 v4, v4, v41, v42
    v_max3_u32 v4, v4, v43, v44
    v_max3_u32 v4, v4, v45, v46
    v_max_u32 v4, v4, v47
    s_nop 1
    v_max_u32_dpp v4, v4, v4 quad_perm:[1,0,3,2] row_mask:0xf bank_mask:0xf
    s_nop 1
    v_max_u32_dpp v4, v4, v4 quad_perm:[2,3,0,1] row_mask:0xf bank_mask:0xf
    s_nop 1
    v_max_u32_dpp v4, v4, v4 row_half_mirror row_mask:0xf bank_mask:0xf
    s_nop 1
    v_max_u32_dpp v4, v4, v4 row_mirror row_mask:0xf bank_mask:0xf
    v_mov_b32 v5, v4
    s_nop 1
    v_permlane16_swap_b32 v4, v5
    v_max_u32 v4, v4, v5
    v_mov_b32 v5, v4
    s_nop 1
    v_permlane32_swap_b32 v4, v5
    v_max_u32 v4, v4, v5
    v_mov_b32 v62, v4
    v_cmp_eq_u32 vcc, v4, v16
    s_nop 1
    v_cndmask_b32 v16, v16, 0, vcc
    v_cmp_eq_u32 vcc, v4, v17
    s_nop 1
    v_cndmask_b32 v17, v17, 0, vcc
    v_cmp_eq_u32 vcc, v4, v18
    s_nop 1
    v_cndmask_b32 v18, v18, 0, vcc
    v_cmp_eq_u32 vcc, v4, v19
    s_nop 1
    v_cndmask_b32 v19, v19, 0, vcc
    v_cmp_eq_u32 vcc, v4, v20
    s_nop 1
    v_cndmask_b32 v20, v20, 0, vcc
    v_cmp_eq_u32 vcc, v4, v21
    s_nop 1
    v_cndmask_b32 v21, v21, 0, vcc
    v_cmp_eq_u32 vcc, v4, v22
    s_nop 1
    v_cndmask_b32 v22, v22, 0, vcc
    v_cmp_eq_u32 vcc, v4, v23
    s_nop 1
    v_cndmask_b32 v23, v23, 0, vcc
    v_cmp_eq_u32 vcc, v4, v24
    s_nop 1
    v_cndmask_b32 v24, v24, 0, vcc
    v_cmp_eq_u32 vcc, v4, v25
    s_nop 1
    v_cndmask_b32 v25, v25, 0, vcc
    v_cmp_eq_u32 vcc, v4, v26
    s_nop 1
    v_cndmask_b32 v26, v26, 0, vcc
    v_cmp_eq_u32 vcc, v4, v27
    s_nop 1
    v_cndmask_b32 v27, v27, 0, vcc
    v_cmp_eq_u32 vcc, v4, v28
    s_nop 1
    v_cndmask_b32 v28, v28, 0, vcc
    v_cmp_eq_u32 vcc, v4, v29
    s_nop 1
    v_cndmask_b32 v29, v29, 0, vcc
    v_cmp_eq_u32 vcc, v4, v30
    s_nop 1
    v_cndmask_b32 v30, v30, 0, vcc
    v_cmp_eq_u32 vcc, v4, v31
    s_nop 1
    v_cndmask_b32 v31, v31, 0, vcc
    v_cmp_eq_u32 vcc, v4, v32
    s_nop 1
    v_cndmask_b32 v32, v32, 0, vcc
    v_cmp_eq_u32 vcc, v4, v33
    s_nop 1
    v_cndmask_b32 v33, v33, 0, vcc
    v_cmp_eq_u32 vcc, v4, v34
    s_nop 1
    v_cndmask_b32 v34, v34, 0, vcc
    v_cmp_eq_u32 vcc, v4, v35
    s_nop 1
    v_cndmask_b32 v35, v35, 0, vcc
    v_cmp_eq_u32 vcc, v4, v36
    s_nop 1
    v_cndmask_b32 v36, v36, 0, vcc
    v_cmp_eq_u32 vcc, v4, v37
    s_nop 1
    v_cndmask_b32 v37, v37, 0, vcc
    v_cmp_eq_u32 vcc, v4, v38
    s_nop 1
    v_cndmask_b32 v38, v38, 0, vcc
    v_cmp_eq_u32 vcc, v4, v39
    s_nop 1
    v_cndmask_b32 v39, v39, 0, vcc
    v_cmp_eq_u32 vcc, v4, v40
    s_nop 1
    v_cndmask_b32 v40, v40, 0, vcc
    v_cmp_eq_u32 vcc, v4, v41
    s_nop 1
    v_cndmask_b32 v41, v41, 0, vcc
    v_cmp_eq_u32 vcc, v4, v42
    s_nop 1
    v_cndmask_b32 v42, v42, 0, vcc
    v_cmp_eq_u32 vcc, v4, v43
    s_nop 1
    v_cndmask_b32 v43, v43, 0, vcc
    v_cmp_eq_u32 vcc, v4, v44
    s_nop 1
    v_cndmask_b32 v44, v44, 0, vcc
    v_cmp_eq_u32 vcc, v4, v45
    s_nop 1
    v_cndmask_b32 v45, v45, 0, vcc
    v_cmp_eq_u32 vcc, v4, v46
    s_nop 1
    v_cndmask_b32 v46, v46, 0, vcc
    v_cmp_eq_u32 vcc, v4, v47
    s_nop 1
    v_cndmask_b32 v47, v47, 0, vcc
    v_max3_u32 v4, v16, v17, v18
    v_max3_u32 v4, v4, v19, v20
    v_max3_u32 v4, v4, v21, v22
    v_max3_u32 v4, v4, v23, v24
    v_max3_u32 v4, v4, v25, v26
    v_max3_u32 v4, v4, v27, v28
    v_max3_u32 v4, v4, v29, v30
    v_max3_u32 v4, v4, v31, v32
    v_max3_u32 v4, v4, v33, v34
    v_max3_u32 v4, v4, v35, v36
    v_max3_u32 v4, v4, v37, v38
    v_max3_u32 v4, v4, v39, v40
    v_max3_u32 v4, v4, v41, v42
    v_max3_u32 v4, v4, v43, v44
    v_max3_u32 v4, v4, v45, v46
    v_max_u32 v4, v4, v47
    s_nop 1
    v_max_u32_dpp v4, v4, v4 quad_perm:[1,0,3,2] row_mask:0xf bank_mask:0xf
    s_nop 1
    v_max_u32_dpp v4, v4, v4 quad_perm:[2,3,0,1] row_mask:0xf bank_mask:0xf
    s_nop 1
    v_max_u32_dpp v4, v4, v4 row_half_mirror row_mask:0xf bank_mask:0xf
    s_nop 1
    v_max_u32_dpp v4, v4, v4 row_mirror row_mask:0xf bank_mask:0xf
    v_mov_b32 v5, v4
    s_nop 1
    v_permlane16_swap_b32 v4, v5
    v_max_u32 v4, v4, v5
    v_mov_b32 v5, v4
    s_nop 1
    v_permlane32_swap_b32 v4, v5
    v_max_u32 v4, v4, v5
    v_mov_b32 v63, v4
    v_mov_b32 v4, v56
    v_cmp_eq_u32 vcc, 1, v0
    s_nop 1
    v_cndmask_b32 v4, v4, v57, vcc
    v_cmp_eq_u32 vcc, 2, v0
    s_nop 1
    v_cndmask_b32 v4, v4, v58, vcc
    v_cmp_eq_u32 vcc, 3, v0
    s_nop 1
    v_cndmask_b32 v4, v4, v59, vcc
    v_cmp_eq_u32 vcc, 4, v0
    s_nop 1
    v_cndmask_b32 v4, v4, v60, vcc
    v_cmp_eq_u32 vcc, 5, v0
    s_nop 1
    v_cndmask_b32 v4, v4, v61, vcc
    v_cmp_eq_u32 vcc, 6, v0
    s_nop 1
    v_cndmask_b32 v4, v4, v62, vcc
    v_cmp_eq_u32 vcc, 7, v0
    s_nop 1
    v_cndmask_b32 v4, v4, v63, vcc
    v_and_b32 v5, 0xffff, v4
    v_sub_u32 v5, 0xffff, v5
    v_and_b32 v4, 0xffff0000, v4
    v_ashrrev_i32 v3, 31, v4
    v_not_b32 v3, v3
    v_or_b32 v3, 0x80000000, v3
    v_xor_b32 v4, v4, v3
    v_and_b32 v4, 0xffff0000, v4
    v_mul_f32 v4, 0xbfb8aa3b, v4
    v_exp_f32 v4, v4
    s_nop 0
    v_add_f32 v4, 1.0, v4
    v_rcp_f32 v4, v4
    s_nop 0
    v_cvt_pk_bf16_f32 v4, v4, v4
    v_lshlrev_b32 v4, 16, v4
    v_lshlrev_b32 v6, 2, v0
    s_mov_b32 s64, 0x5400000
    s_mov_b64 exec, 0xff
    buffer_store_dword v5, v6, s[4:7], s64 offen sc1
    buffer_store_dword v4, v6, s[4:7], s64 offen offset:32 sc1
    s_mov_b64 exec, -1
    s_waitcnt vmcnt(0)
    v_mov_b32 v7, 1
    v_mov_b32 v8, 0
    s_mov_b32 s64, 0x298000
    s_mov_b64 exec, 1
    buffer_atomic_add v7, v8, s[4:7], s64 offen sc1
    s_mov_b64 exec, -1
    v_mbcnt_lo_u32_b32 v0, -1, 0
    v_mbcnt_hi_u32_b32 v0, -1, v0
NOSEL_115:
    v_lshlrev_b32 v1, 4, v0
    v_lshrrev_b32 v6, 3, v0
    v_mul_u32_u24 v2, 1280, v6
    v_and_b32 v7, 7, v0
    v_xor_b32 v7, v7, v6
    v_lshl_add_u32 v2, v7, 4, v2
    v_bfe_u32 v6, v0, 3, 1
    v_lshlrev_b32 v9, 10, v6
    v_and_b32 v6, 7, v0
    v_lshl_add_u32 v9, v6, 7, v9
    v_lshrrev_b32 v7, 4, v0
    v_xor_b32 v7, v7, v6
    v_lshl_add_u32 v3, v7, 4, v9
    v_xor_b32 v7, 4, v7
    v_lshl_add_u32 v4, v7, 4, v9
    v_add_u32 v6, 0x10000, v3
    v_add_u32 v9, 0x10000, v4
    s_barrier
    s_mul_i32 s20, s12, 163840
    s_mul_i32 s64, s14, 40960
    s_add_u32 s20, s20, s64
    s_add_u32 s20, s20, 0x0
    s_lshl_b32 s21, s14, 12
    s_add_u32 m0, s21, 0
    s_add_u32 s64, s20, 0x0
    buffer_load_dwordx4 v2, s[4:7], s64 offen lds
    s_add_u32 m0, s21, 1024
    s_add_u32 s64, s20, 0x2800
    buffer_load_dwordx4 v2, s[4:7], s64 offen lds
    s_add_u32 m0, s21, 2048
    s_add_u32 s64, s20, 0x5000
    buffer_load_dwordx4 v2, s[4:7], s64 offen lds
    s_add_u32 m0, s21, 3072
    s_add_u32 s64, s20, 0x7800
    buffer_load_dwordx4 v2, s[4:7], s64 offen lds
    s_add_u32 m0, s21, 16384
    s_add_u32 s64, s20, 0x80
    buffer_load_dwordx4 v2, s[4:7], s64 offen lds
    s_add_u32 m0, s21, 17408
    s_add_u32 s64, s20, 0x2880
    buffer_load_dwordx4 v2, s[4:7], s64 offen lds
    s_add_u32 m0, s21, 18432
    s_add_u32 s64, s20, 0x5080
    buffer_load_dwordx4 v2, s[4:7], s64 offen lds
    s_add_u32 m0, s21, 19456
    s_add_u32 s64, s20, 0x7880
    buffer_load_dwordx4 v2, s[4:7], s64 offen lds
    s_add_u32 m0, s21, 32768
    s_add_u32 s64, s20, 0x100
    buffer_load_dwordx4 v2, s[4:7], s64 offen lds
    s_add_u32 m0, s21, 33792
    s_add_u32 s64, s20, 0x2900
    buffer_load_dwordx4 v2, s[4:7], s64 offen lds
    s_add_u32 m0, s21, 34816
    s_add_u32 s64, s20, 0x5100
    buffer_load_dwordx4 v2, s[4:7], s64 offen lds
    s_add_u32 m0, s21, 35840
    s_add_u32 s64, s20, 0x7900
    buffer_load_dwordx4 v2, s[4:7], s64 offen lds
    s_add_u32 m0, s21, 49152
    s_add_u32 s64, s20, 0x180
    buffer_load_dwordx4 v2, s[4:7], s64 offen lds
    s_add_u32 m0, s21, 50176
    s_add_u32 s64, s20, 0x2980
    buffer_load_dwordx4 v2, s[4:7], s64 offen lds
    s_add_u32 m0, s21, 51200
    s_add_u32 s64, s20, 0x5180
    buffer_load_dwordx4 v2, s[4:7], s64 offen lds
    s_add_u32 m0, s21, 52224
    s_add_u32 s64, s20, 0x7980
    buffer_load_dwordx4 v2, s[4:7], s64 offen lds
    s_mov_b32 s64, 0x40000000
    buffer_store_dword v7, v1, s[4:7], s64 offen
    buffer_store_dword v7, v1, s[4:7], s64 offen
    buffer_store_dword v7, v1, s[4:7], s64 offen
    buffer_store_dword v7, v1, s[4:7], s64 offen
    buffer_store_dword v7, v1, s[4:7], s64 offen
    buffer_store_dword v7, v1, s[4:7], s64 offen
    buffer_store_dword v7, v1, s[4:7], s64 offen
    buffer_store_dword v7, v1, s[4:7], s64 offen
    s_waitcnt vmcnt(20)
    s_barrier
    ds_read_b128 a[0:3], v3 offset:0
    ds_read_b128 a[4:7], v3 offset:2048
    ds_read_b128 a[8:11], v3 offset:4096
    ds_read_b128 a[12:15], v3 offset:6144
    ds_read_b128 a[16:19], v3 offset:8192
    ds_read_b128 a[20:23], v3 offset:10240
    ds_read_b128 a[24:27], v3 offset:12288
    ds_read_b128 a[28:31], v3 offset:14336
    s_mov_b32 s19, 0
    s_mov_b32 s22, s16
    s_mov_b32 s23, 0x40000000
G_T_LOOP:
    s_waitcnt lgkmcnt(4)
    v_mfma_f32_16x16x32_bf16 v[16:19], v[96:99], a[0:3], 0
    v_mfma_f32_16x16x32_bf16 v[20:23], v[100:103], a[0:3], 0
    ds_read_b128 a[32:35], v4 offset:0
    v_mfma_f32_16x16x32_bf16 v[24:27], v[96:99], a[4:7], 0
    v_mfma_f32_16x16x32_bf16 v[28:31], v[100:103], a[4:7], 0
    ds_read_b128 a[36:39], v4 offset:2048
    v_mfma_f32_16x16x32_bf16 v[32:35], v[96:99], a[8:11], 0
    v_mfma_f32_16x16x32_bf16 v[36:39], v[100:103], a[8:11], 0
    ds_read_b128 a[40:43], v4 offset:4096
    v_mfma_f32_16x16x32_bf16 v[40:43], v[96:99], a[12:15], 0
    v_mfma_f32_16x16x32_bf16 v[44:47], v[100:103], a[12:15], 0
    ds_read_b128 a[44:47], v4 offset:6144
    s_waitcnt lgkmcnt(4)
    v_mfma_f32_16x16x32_bf16 v[48:51], v[96:99], a[16:19], 0
    v_mfma_f32_16x16x32_bf16 v[52:55], v[100:103], a[16:19], 0
    ds_read_b128 a[48:51], v4 offset:8192
    v_mfma_f32_16x16x32_bf16 v[56:59], v[96:99], a[20:23], 0
    v_mfma_f32_16x16x32_bf16 v[60:63], v[100:103], a[20:23], 0
    ds_read_b128 a[52:55], v4 offset:10240
    v_mfma_f32_16x16x32_bf16 v[64:67], v[96:99], a[24:27], 0
    v_mfma_f32_16x16x32_bf16 v[68:71], v[100:103], a[24:27], 0
    ds_read_b128 a[56:59], v4 offset:12288
    v_mfma_f32_16x16x32_bf16 v[72:75], v[96:99], a[28:31], 0
    v_mfma_f32_16x16x32_bf16 v[76:79], v[100:103], a[28:31], 0
    ds_read_b128 a[60:63], v4 offset:14336
    s_waitcnt vmcnt(16)
    s_barrier
    s_waitcnt lgkmcnt(4)
    v_mfma_f32_16x16x32_bf16 v[16:19], v[104:107], a[32:35], v[16:19]
    v_mfma_f32_16x16x32_bf16 v[20:23], v[108:111], a[32:35], v[20:23]
    ds_read_b128 a[0:3], v3 offset:16384
    s_add_u32 m0, s21, 65536
    v_mfma_f32_16x16x32_bf16 v[24:27], v[104:107], a[36:39], v[24:27]
    v_mfma_f32_16x16x32_bf16 v[28:31], v[108:111], a[36:39], v[28:31]
    ds_read_b128 a[4:7], v3 offset:18432
    s_add_u32 s64, s20, 0x200
    buffer_load_dwordx4 v2, s[4:7], s64 offen lds
    v_mfma_f32_16x16x32_bf16 v[32:35], v[104:107], a[40:43], v[32:35]
    v_mfma_f32_16x16x32_bf16 v[36:39], v[108:111], a[40:43], v[36:39]
    ds_read_b128 a[8:11], v3 offset:20480
    s_add_u32 m0, s21, 66560
    v_mfma_f32_16x16x32_bf16 v[40:43], v[104:107], a[44:47], v[40:43]
    v_mfma_f32_16x16x32_bf16 v[44:47], v[108:111], a[44:47], v[44:47]
    ds_read_b128 a[12:15], v3 offset:22528
    s_add_u32 s64, s20, 0x2a00
    buffer_load_dwordx4 v2, s[4:7], s64 offen lds
    s_waitcnt lgkmcnt(4)
    v_mfma_f32_16x16x32_bf16 v[48:51], v[104:107], a[48:51], v[48:51]
    v_mfma_f32_16x16x32_bf16 v[52:55], v[108:111], a[48:51], v[52:55]
    ds_read_b128 a[16:19], v3 offset:24576
    s_add_u32 m0, s21, 67584
    v_mfma_f32_16x16x32_bf16 v[56:59], v[104:107], a[52:55], v[56:59]
    v_mfma_f32_16x16x32_bf16 v[60:63], v[108:111], a[52:55], v[60:63]
    ds_read_b128 a[20:23], v3 offset:26624
    s_add_u32 s64, s20, 0x5200
    buffer_load_dwordx4 v2, s[4:7], s64 offen lds
    v_mfma_f32_16x16x32_bf16 v[64:67], v[104:107], a[56:59], v[64:67]
    v_mfma_f32_16x16x32_bf16 v[68:71], v[108:111], a[56:59], v[68:71]
    ds_read_b128 a[24:27], v3 offset:28672
    s_add_u32 m0, s21, 68608
    v_mfma_f32_16x16x32_bf16 v[72:75], v[104:107], a[60:63], v[72:75]
    v_mfma_f32_16x16x32_bf16 v[76:79], v[108:111], a[60:63], v[76:79]
    ds_read_b128 a[28:31], v3 offset:30720
    s_add_u32 s64, s20, 0x7a00
    buffer_load_dwordx4 v2, s[4:7], s64 offen lds
    s_waitcnt lgkmcnt(4)
    v_mfma_f32_16x16x32_bf16 v[16:19], v[112:115], a[0:3], v[16:19]
    v_mfma_f32_16x16x32_bf16 v[20:23], v[116:119], a[0:3], v[20:23]
    ds_read_b128 a[32:35], v4 offset:16384
    v_mfma_f32_16x16x32_bf16 v[24:27], v[112:115], a[4:7], v[24:27]
    v_mfma_f32_16x16x32_bf16 v[28:31], v[116:119], a[4:7], v[28:31]
    ds_read_b128 a[36:39], v4 offset:18432
    v_mfma_f32_16x16x32_bf16 v[32:35], v[112:115], a[8:11], v[32:35]
    v_mfma_f32_16x16x32_bf16 v[36:39], v[116:119], a[8:11], v[36:39]
    ds_read_b128 a[40:43], v4 offset:20480
    v_mfma_f32_16x16x32_bf16 v[40:43], v[112:115], a[12:15], v[40:43]
    v_mfma_f32_16x16x32_bf16 v[44:47], v[116:119], a[12:15], v[44:47]
    ds_read_b128 a[44:47], v4 offset:22528
    s_waitcnt lgkmcnt(4)
    v_mfma_f32_16x16x32_bf16 v[48:51], v[112:115], a[16:19], v[48:51]
    v_mfma_f32_16x16x32_bf16 v[52:55], v[116:119], a[16:19], v[52:55]
    ds_read_b128 a[48:51], v4 offset:24576
    v_mfma_f32_16x16x32_bf16 v[56:59], v[112:115], a[20:23], v[56:59]
    v_mfma_f32_16x16x32_bf16 v[60:63], v[116:119], a[20:23], v[60:63]
    ds_read_b128 a[52:55], v4 offset:26624
    v_mfma_f32_16x16x32_bf16 v[64:67], v[112:115], a[24:27], v[64:67]
    v_mfma_f32_16x16x32_bf16 v[68:71], v[116:119], a[24:27], v[68:71]
    ds_read_b128 a[56:59], v4 offset:28672
    v_mfma_f32_16x16x32_bf16 v[72:75], v[112:115], a[28:31], v[72:75]
    v_mfma_f32_16x16x32_bf16 v[76:79], v[116:119], a[28:31], v[76:79]
    ds_read_b128 a[60:63], v4 offset:30720
    s_waitcnt vmcnt(16)
    s_barrier
    s_cmp_lg_u32 s19, 0
    s_cbranch_scc1 GFD_116
    s_cmp_lg_u32 s14, 0
    s_cbranch_scc1 INE_117
    s_cmp_lg_u32 s96, 10
    s_cbranch_scc1 ING_118
    v_mov_b32 v7, 1
    v_lshlrev_b32 v8, 7, v0
    s_mov_b32 s65, 0x29a000
    s_mov_b64 exec, 3
    buffer_store_dword v7, v8, s[4:7], s65 offen sc1
    s_mov_b64 exec, -1
    s_waitcnt vmcnt(0)
ING_118:
    v_mov_b32 v8, 1
    s_mov_b32 s65, 0x290800
    s_mov_b64 exec, 1
    buffer_atomic_add v8, off, s[4:7], s65 sc1
    s_mov_b64 exec, -1
INE_117:
GFD_116:
    s_waitcnt lgkmcnt(4)
    v_mfma_f32_16x16x32_bf16 v[16:19], v[120:123], a[32:35], v[16:19]
    v_mfma_f32_16x16x32_bf16 v[20:23], v[124:127], a[32:35], v[20:23]
    ds_read_b128 a[0:3], v3 offset:32768
    s_add_u32 m0, s21, 0
    v_mfma_f32_16x16x32_bf16 v[24:27], v[120:123], a[36:39], v[24:27]
    v_mfma_f32_16x16x32_bf16 v[28:31], v[124:127], a[36:39], v[28:31]
    ds_read_b128 a[4:7], v3 offset:34816
    s_add_u32 s64, s20, 0x280
    buffer_load_dwordx4 v2, s[4:7], s64 offen lds
    v_mfma_f32_16x16x32_bf16 v[32:35], v[120:123], a[40:43], v[32:35]
    v_mfma_f32_16x16x32_bf16 v[36:39], v[124:127], a[40:43], v[36:39]
    ds_read_b128 a[8:11], v3 offset:36864
    s_add_u32 m0, s21, 1024
    v_mfma_f32_16x16x32_bf16 v[40:43], v[120:123], a[44:47], v[40:43]
    v_mfma_f32_16x16x32_bf16 v[44:47], v[124:127], a[44:47], v[44:47]
    ds_read_b128 a[12:15], v3 offset:38912
    s_add_u32 s64, s20, 0x2a80
    buffer_load_dwordx4 v2, s[4:7], s64 offen lds
    s_waitcnt lgkmcnt(4)
    v_mfma_f32_16x16x32_bf16 v[48:51], v[120:123], a[48:51], v[48:51]
    v_mfma_f32_16x16x32_bf16 v[52:55], v[124:127], a[48:51], v[52:55]
    ds_read_b128 a[16:19], v3 offset:40960
    s_add_u32 m0, s21, 2048
    v_mfma_f32_16x16x32_bf16 v[56:59], v[120:123], a[52:55], v[56:59]
    v_mfma_f32_16x16x32_bf16 v[60:63], v[124:127], a[52:55], v[60:63]
    ds_read_b128 a[20:23], v3 offset:43008
    s_add_u32 s64, s20, 0x5280
    buffer_load_dwordx4 v2, s[4:7], s64 offen lds
    v_mfma_f32_16x16x32_bf16 v[64:67], v[120:123], a[56:59], v[64:67]
    v_mfma_f32_16x16x32_bf16 v[68:71], v[124:127], a[56:59], v[68:71]
    ds_read_b128 a[24:27], v3 offset:45056
    s_add_u32 m0, s21, 3072
    v_mfma_f32_16x16x32_bf16 v[72:75], v[120:123], a[60:63], v[72:75]
    v_mfma_f32_16x16x32_bf16 v[76:79], v[124:127], a[60:63], v[76:79]
    ds_read_b128 a[28:31], v3 offset:47104
    s_add_u32 s64, s20, 0x7a80
    buffer_load_dwordx4 v2, s[4:7], s64 offen lds
    s_waitcnt lgkmcnt(4)
    v_mfma_f32_16x16x32_bf16 v[16:19], v[128:131], a[0:3], v[16:19]
    v_mfma_f32_16x16x32_bf16 v[20:23], v[132:135], a[0:3], v[20:23]
    ds_read_b128 a[32:35], v4 offset:32768
    v_mfma_f32_16x16x32_bf16 v[24:27], v[128:131], a[4:7], v[24:27]
    v_mfma_f32_16x16x32_bf16 v[28:31], v[132:135], a[4:7], v[28:31]
    ds_read_b128 a[36:39], v4 offset:34816
    v_mfma_f32_16x16x32_bf16 v[32:35], v[128:131], a[8:11], v[32:35]
    v_mfma_f32_16x16x32_bf16 v[36:39], v[132:135], a[8:11], v[36:39]
    ds_read_b128 a[40:43], v4 offset:36864
    v_mfma_f32_16x16x32_bf16 v[40:43], v[128:131], a[12:15], v[40:43]
    v_mfma_f32_16x16x32_bf16 v[44:47], v[132:135], a[12:15], v[44:47]
    ds_read_b128 a[44:47], v4 offset:38912
    s_waitcnt lgkmcnt(4)
    v_mfma_f32_16x16x32_bf16 v[48:51], v[128:131], a[16:19], v[48:51]
    v_mfma_f32_16x16x32_bf16 v[52:55], v[132:135], a[16:19], v[52:55]
    ds_read_b128 a[48:51], v4 offset:40960
    v_mfma_f32_16x16x32_bf16 v[56:59], v[128:131], a[20:23], v[56:59]
    v_mfma_f32_16x16x32_bf16 v[60:63], v[132:135], a[20:23], v[60:63]
    ds_read_b128 a[52:55], v4 offset:43008
    v_mfma_f32_16x16x32_bf16 v[64:67], v[128:131], a[24:27], v[64:67]
    v_mfma_f32_16x16x32_bf16 v[68:71], v[132:135], a[24:27], v[68:71]
    ds_read_b128 a[56:59], v4 offset:45056
    v_mfma_f32_16x16x32_bf16 v[72:75], v[128:131], a[28:31], v[72:75]
    v_mfma_f32_16x16x32_bf16 v[76:79], v[132:135], a[28:31], v[76:79]
    ds_read_b128 a[60:63], v4 offset:47104
    s_waitcnt vmcnt(16)
    s_barrier
    s_waitcnt lgkmcnt(4)
    v_mfma_f32_16x16x32_bf16 v[16:19], v[136:139], a[32:35], v[16:19]
    v_mfma_f32_16x16x32_bf16 v[20:23], v[140:143], a[32:35], v[20:23]
    ds_read_b128 a[0:3], v3 offset:49152
    s_add_u32 m0, s21, 16384
    v_mfma_f32_16x16x32_bf16 v[24:27], v[136:139], a[36:39], v[24:27]
    v_mfma_f32_16x16x32_bf16 v[28:31], v[140:143], a[36:39], v[28:31]
    ds_read_b128 a[4:7], v3 offset:51200
    s_add_u32 s64, s20, 0x300
    buffer_load_dwordx4 v2, s[4:7], s64 offen lds
    v_mfma_f32_16x16x32_bf16 v[32:35], v[136:139], a[40:43], v[32:35]
    v_mfma_f32_16x16x32_bf16 v[36:39], v[140:143], a[40:43], v[36:39]
    ds_read_b128 a[8:11], v3 offset:53248
    s_add_u32 m0, s21, 17408
    v_mfma_f32_16x16x32_bf16 v[40:43], v[136:139], a[44:47], v[40:43]
    v_mfma_f32_16x16x32_bf16 v[44:47], v[140:143], a[44:47], v[44:47]
    ds_read_b128 a[12:15], v3 offset:55296
    s_add_u32 s64, s20, 0x2b00
    buffer_load_dwordx4 v2, s[4:7], s64 offen lds
    s_waitcnt lgkmcnt(4)
    v_mfma_f32_16x16x32_bf16 v[48:51], v[136:139], a[48:51], v[48:51]
    v_mfma_f32_16x16x32_bf16 v[52:55], v[140:143], a[48:51], v[52:55]
    ds_read_b128 a[16:19], v3 offset:57344
    s_add_u32 m0, s21, 18432
    v_mfma_f32_16x16x32_bf16 v[56:59], v[136:139], a[52:55], v[56:59]
    v_mfma_f32_16x16x32_bf16 v[60:63], v[140:143], a[52:55], v[60:63]
    ds_read_b128 a[20:23], v3 offset:59392
    s_add_u32 s64, s20, 0x5300
    buffer_load_dwordx4 v2, s[4:7], s64 offen lds
    v_mfma_f32_16x16x32_bf16 v[64:67], v[136:139], a[56:59], v[64:67]
    v_mfma_f32_16x16x32_bf16 v[68:71], v[140:143], a[56:59], v[68:71]
    ds_read_b128 a[24:27], v3 offset:61440
    s_add_u32 m0, s21, 19456
    v_mfma_f32_16x16x32_bf16 v[72:75], v[136:139], a[60:63], v[72:75]
    v_mfma_f32_16x16x32_bf16 v[76:79], v[140:143], a[60:63], v[76:79]
    ds_read_b128 a[28:31], v3 offset:63488
    s_add_u32 s64, s20, 0x7b00
    buffer_load_dwordx4 v2, s[4:7], s64 offen lds
    s_waitcnt lgkmcnt(4)
    v_mfma_f32_16x16x32_bf16 v[16:19], v[144:147], a[0:3], v[16:19]
    v_mfma_f32_16x16x32_bf16 v[20:23], v[148:151], a[0:3], v[20:23]
    ds_read_b128 a[32:35], v4 offset:49152
    v_mfma_f32_16x16x32_bf16 v[24:27], v[144:147], a[4:7], v[24:27]
    v_mfma_f32_16x16x32_bf16 v[28:31], v[148:151], a[4:7], v[28:31]
    ds_read_b128 a[36:39], v4 offset:51200
    v_mfma_f32_16x16x32_bf16 v[32:35], v[144:147], a[8:11], v[32:35]
    v_mfma_f32_16x16x32_bf16 v[36:39], v[148:151], a[8:11], v[36:39]
    ds_read_b128 a[40:43], v4 offset:53248
    v_mfma_f32_16x16x32_bf16 v[40:43], v[144:147], a[12:15], v[40:43]
    v_mfma_f32_16x16x32_bf16 v[44:47], v[148:151], a[12:15], v[44:47]
    ds_read_b128 a[44:47], v4 offset:55296
    s_waitcnt lgkmcnt(4)
    v_mfma_f32_16x16x32_bf16 v[48:51], v[144:147], a[16:19], v[48:51]
    v_mfma_f32_16x16x32_bf16 v[52:55], v[148:151], a[16:19], v[52:55]
    ds_read_b128 a[48:51], v4 offset:57344
    v_mfma_f32_16x16x32_bf16 v[56:59], v[144:147], a[20:23], v[56:59]
    v_mfma_f32_16x16x32_bf16 v[60:63], v[148:151], a[20:23], v[60:63]
    ds_read_b128 a[52:55], v4 offset:59392
    v_mfma_f32_16x16x32_bf16 v[64:67], v[144:147], a[24:27], v[64:67]
    v_mfma_f32_16x16x32_bf16 v[68:71], v[148:151], a[24:27], v[68:71]
    ds_read_b128 a[56:59], v4 offset:61440
    v_mfma_f32_16x16x32_bf16 v[72:75], v[144:147], a[28:31], v[72:75]
    v_mfma_f32_16x16x32_bf16 v[76:79], v[148:151], a[28:31], v[76:79]
    ds_read_b128 a[60:63], v4 offset:63488
    s_waitcnt vmcnt(8)
    s_barrier
    s_cmp_lg_u32 s14, 0
    s_cbranch_scc1 GF_119
    v_mov_b32 v7, 1
    v_mov_b32 v8, 0
    s_mov_b64 exec, 1
    buffer_store_dword v7, v8, s[4:7], s23 offen sc1
    s_mov_b64 exec, -1
GF_119:
    s_waitcnt lgkmcnt(4)
    v_mfma_f32_16x16x32_bf16 v[16:19], v[152:155], a[32:35], v[16:19]
    v_mfma_f32_16x16x32_bf16 v[20:23], v[156:159], a[32:35], v[20:23]
    ds_read_b128 a[0:3], v6 offset:0
    s_add_u32 m0, s21, 32768
    v_mfma_f32_16x16x32_bf16 v[24:27], v[152:155], a[36:39], v[24:27]
    v_mfma_f32_16x16x32_bf16 v[28:31], v[156:159], a[36:39], v[28:31]
    ds_read_b128 a[4:7], v6 offset:2048
    s_add_u32 s64, s20, 0x380
    buffer_load_dwordx4 v2, s[4:7], s64 offen lds
    v_mfma_f32_16x16x32_bf16 v[32:35], v[152:155], a[40:43], v[32:35]
    v_mfma_f32_16x16x32_bf16 v[36:39], v[156:159], a[40:43], v[36:39]
    ds_read_b128 a[8:11], v6 offset:4096
    s_add_u32 m0, s21, 33792
    v_mfma_f32_16x16x32_bf16 v[40:43], v[152:155], a[44:47], v[40:43]
    v_mfma_f32_16x16x32_bf16 v[44:47], v[156:159], a[44:47], v[44:47]
    ds_read_b128 a[12:15], v6 offset:6144
    s_add_u32 s64, s20, 0x2b80
    buffer_load_dwordx4 v2, s[4:7], s64 offen lds
    s_waitcnt lgkmcnt(4)
    v_mfma_f32_16x16x32_bf16 v[48:51], v[152:155], a[48:51], v[48:51]
    v_mfma_f32_16x16x32_bf16 v[52:55], v[156:159], a[48:51], v[52:55]
    ds_read_b128 a[16:19], v6 offset:8192
    s_add_u32 m0, s21, 34816
    v_mfma_f32_16x16x32_bf16 v[56:59], v[152:155], a[52:55], v[56:59]
    v_mfma_f32_16x16x32_bf16 v[60:63], v[156:159], a[52:55], v[60:63]
    ds_read_b128 a[20:23], v6 offset:10240
    s_add_u32 s64, s20, 0x5380
    buffer_load_dwordx4 v2, s[4:7], s64 offen lds
    v_mfma_f32_16x16x32_bf16 v[64:67], v[152:155], a[56:59], v[64:67]
    v_mfma_f32_16x16x32_bf16 v[68:71], v[156:159], a[56:59], v[68:71]
    ds_read_b128 a[24:27], v6 offset:12288
    s_add_u32 m0, s21, 35840
    v_mfma_f32_16x16x32_bf16 v[72:75], v[152:155], a[60:63], v[72:75]
    v_mfma_f32_16x16x32_bf16 v[76:79], v[156:159], a[60:63], v[76:79]
    ds_read_b128 a[28:31], v6 offset:14336
    s_add_u32 s64, s20, 0x7b80
    buffer_load_dwordx4 v2, s[4:7], s64 offen lds
    s_waitcnt lgkmcnt(4)
    v_mfma_f32_16x16x32_bf16 v[16:19], v[160:163], a[0:3], v[16:19]
    v_mfma_f32_16x16x32_bf16 v[20:23], v[164:167], a[0:3], v[20:23]
    ds_read_b128 a[32:35], v9 offset:0
    v_mfma_f32_16x16x32_bf16 v[24:27], v[160:163], a[4:7], v[24:27]
    v_mfma_f32_16x16x32_bf16 v[28:31], v[164:167], a[4:7], v[28:31]
    ds_read_b128 a[36:39], v9 offset:2048
    v_mfma_f32_16x16x32_bf16 v[32:35], v[160:163], a[8:11], v[32:35]
    v_mfma_f32_16x16x32_bf16 v[36:39], v[164:167], a[8:11], v[36:39]
    ds_read_b128 a[40:43], v9 offset:4096
    v_mfma_f32_16x16x32_bf16 v[40:43], v[160:163], a[12:15], v[40:43]
    v_mfma_f32_16x16x32_bf16 v[44:47], v[164:167], a[12:15], v[44:47]
    ds_read_b128 a[44:47], v9 offset:6144
    s_waitcnt lgkmcnt(4)
    v_mfma_f32_16x16x32_bf16 v[48:51], v[160:163], a[16:19], v[48:51]
    v_mfma_f32_16x16x32_bf16 v[52:55], v[164:167], a[16:19], v[52:55]
    ds_read_b128 a[48:51], v9 offset:8192
    v_mfma_f32_16x16x32_bf16 v[56:59], v[160:163], a[20:23], v[56:59]
    v_mfma_f32_16x16x32_bf16 v[60:63], v[164:167], a[20:23], v[60:63]
    ds_read_b128 a[52:55], v9 offset:10240
    v_mfma_f32_16x16x32_bf16 v[64:67], v[160:163], a[24:27], v[64:67]
    v_mfma_f32_16x16x32_bf16 v[68:71], v[164:167], a[24:27], v[68:71]
    ds_read_b128 a[56:59], v9 offset:12288
    v_mfma_f32_16x16x32_bf16 v[72:75], v[160:163], a[28:31], v[72:75]
    v_mfma_f32_16x16x32_bf16 v[76:79], v[164:167], a[28:31], v[76:79]
    ds_read_b128 a[60:63], v9 offset:14336
    s_waitcnt vmcnt(8)
    s_barrier
    s_waitcnt lgkmcnt(4)
    v_mfma_f32_16x16x32_bf16 v[16:19], v[168:171], a[32:35], v[16:19]
    v_mfma_f32_16x16x32_bf16 v[20:23], v[172:175], a[32:35], v[20:23]
    ds_read_b128 a[0:3], v3 offset:0
    s_add_u32 m0, s21, 49152
    v_mfma_f32_16x16x32_bf16 v[24:27], v[168:171], a[36:39], v[24:27]
    v_mfma_f32_16x16x32_bf16 v[28:31], v[172:175], a[36:39], v[28:31]
    ds_read_b128 a[4:7], v3 offset:2048
    s_add_u32 s64, s20, 0x400
    buffer_load_dwordx4 v2, s[4:7], s64 offen lds
    v_mfma_f32_16x16x32_bf16 v[32:35], v[168:171], a[40:43], v[32:35]
    v_mfma_f32_16x16x32_bf16 v[36:39], v[172:175], a[40:43], v[36:39]
    ds_read_b128 a[8:11], v3 offset:4096
    s_add_u32 m0, s21, 50176
    v_mfma_f32_16x16x32_bf16 v[40:43], v[168:171], a[44:47], v[40:43]
    v_mfma_f32_16x16x32_bf16 v[44:47], v[172:175], a[44:47], v[44:47]
    ds_read_b128 a[12:15], v3 offset:6144
    s_add_u32 s64, s20, 0x2c00
    buffer_load_dwordx4 v2, s[4:7], s64 offen lds
    s_waitcnt lgkmcnt(4)
    v_mfma_f32_16x16x32_bf16 v[48:51], v[168:171], a[48:51], v[48:51]
    v_mfma_f32_16x16x32_bf16 v[52:55], v[172:175], a[48:51], v[52:55]
    ds_read_b128 a[16:19], v3 offset:8192
    s_add_u32 m0, s21, 51200
    v_mfma_f32_16x16x32_bf16 v[56:59], v[168:171], a[52:55], v[56:59]
    v_mfma_f32_16x16x32_bf16 v[60:63], v[172:175], a[52:55], v[60:63]
    ds_read_b128 a[20:23], v3 offset:10240
    s_add_u32 s64, s20, 0x5400
    buffer_load_dwordx4 v2, s[4:7], s64 offen lds
    v_mfma_f32_16x16x32_bf16 v[64:67], v[168:171], a[56:59], v[64:67]
    v_mfma_f32_16x16x32_bf16 v[68:71], v[172:175], a[56:59], v[68:71]
    ds_read_b128 a[24:27], v3 offset:12288
    s_add_u32 m0, s21, 52224
    v_mfma_f32_16x16x32_bf16 v[72:75], v[168:171], a[60:63], v[72:75]
    v_mfma_f32_16x16x32_bf16 v[76:79], v[172:175], a[60:63], v[76:79]
    ds_read_b128 a[28:31], v3 offset:14336
    s_add_u32 s64, s20, 0x7c00
    buffer_load_dwordx4 v2, s[4:7], s64 offen lds
    s_waitcnt lgkmcnt(4)
    v_mfma_f32_16x16x32_bf16 v[16:19], v[176:179], a[0:3], v[16:19]
    v_mfma_f32_16x16x32_bf16 v[20:23], v[180:183], a[0:3], v[20:23]
    ds_read_b128 a[32:35], v4 offset:0
    v_mfma_f32_16x16x32_bf16 v[24:27], v[176:179], a[4:7], v[24:27]
    v_mfma_f32_16x16x32_bf16 v[28:31], v[180:183], a[4:7], v[28:31]
    ds_read_b128 a[36:39], v4 offset:2048
    v_mfma_f32_16x16x32_bf16 v[32:35], v[176:179], a[8:11], v[32:35]
    v_mfma_f32_16x16x32_bf16 v[36:39], v[180:183], a[8:11], v[36:39]
    ds_read_b128 a[40:43], v4 offset:4096
    v_mfma_f32_16x16x32_bf16 v[40:43], v[176:179], a[12:15], v[40:43]
    v_mfma_f32_16x16x32_bf16 v[44:47], v[180:183], a[12:15], v[44:47]
    ds_read_b128 a[44:47], v4 offset:6144
    s_waitcnt lgkmcnt(4)
    v_mfma_f32_16x16x32_bf16 v[48:51], v[176:179], a[16:19], v[48:51]
    v_mfma_f32_16x16x32_bf16 v[52:55], v[180:183], a[16:19], v[52:55]
    ds_read_b128 a[48:51], v4 offset:8192
    v_mfma_f32_16x16x32_bf16 v[56:59], v[176:179], a[20:23], v[56:59]
    v_mfma_f32_16x16x32_bf16 v[60:63], v[180:183], a[20:23], v[60:63]
    ds_read_b128 a[52:55], v4 offset:10240
    v_mfma_f32_16x16x32_bf16 v[64:67], v[176:179], a[24:27], v[64:67]
    v_mfma_f32_16x16x32_bf16 v[68:71], v[180:183], a[24:27], v[68:71]
    ds_read_b128 a[56:59], v4 offset:12288
    v_mfma_f32_16x16x32_bf16 v[72:75], v[176:179], a[28:31], v[72:75]
    v_mfma_f32_16x16x32_bf16 v[76:79], v[180:183], a[28:31], v[76:79]
    ds_read_b128 a[60:63], v4 offset:14336
    s_waitcnt vmcnt(8)
    s_barrier
    s_waitcnt lgkmcnt(4)
    v_mfma_f32_16x16x32_bf16 v[16:19], v[184:187], a[32:35], v[16:19]
    v_mfma_f32_16x16x32_bf16 v[20:23], v[188:191], a[32:35], v[20:23]
    ds_read_b128 a[0:3], v3 offset:16384
    s_add_u32 m0, s21, 65536
    v_mfma_f32_16x16x32_bf16 v[24:27], v[184:187], a[36:39], v[24:27]
    v_mfma_f32_16x16x32_bf16 v[28:31], v[188:191], a[36:39], v[28:31]
    ds_read_b128 a[4:7], v3 offset:18432
    s_add_u32 s64, s20, 0x480
    buffer_load_dwordx4 v2, s[4:7], s64 offen lds
    v_mfma_f32_16x16x32_bf16 v[32:35], v[184:187], a[40:43], v[32:35]
    v_mfma_f32_16x16x32_bf16 v[36:39], v[188:191], a[40:43], v[36:39]
    ds_read_b128 a[8:11], v3 offset:20480
    s_add_u32 m0, s21, 66560
    v_mfma_f32_16x16x32_bf16 v[40:43], v[184:187], a[44:47], v[40:43]
    v_mfma_f32_16x16x32_bf16 v[44:47], v[188:191], a[44:47], v[44:47]
    ds_read_b128 a[12:15], v3 offset:22528
    s_add_u32 s64, s20, 0x2c80
    buffer_load_dwordx4 v2, s[4:7], s64 offen lds
    s_waitcnt lgkmcnt(4)
    v_mfma_f32_16x16x32_bf16 v[48:51], v[184:187], a[48:51], v[48:51]
    v_mfma_f32_16x16x32_bf16 v[52:55], v[188:191], a[48:51], v[52:55]
    ds_read_b128 a[16:19], v3 offset:24576
    s_add_u32 m0, s21, 67584
    v_mfma_f32_16x16x32_bf16 v[56:59], v[184:187], a[52:55], v[56:59]
    v_mfma_f32_16x16x32_bf16 v[60:63], v[188:191], a[52:55], v[60:63]
    ds_read_b128 a[20:23], v3 offset:26624
    s_add_u32 s64, s20, 0x5480
    buffer_load_dwordx4 v2, s[4:7], s64 offen lds
    v_mfma_f32_16x16x32_bf16 v[64:67], v[184:187], a[56:59], v[64:67]
    v_mfma_f32_16x16x32_bf16 v[68:71], v[188:191], a[56:59], v[68:71]
    ds_read_b128 a[24:27], v3 offset:28672
    s_add_u32 m0, s21, 68608
    v_mfma_f32_16x16x32_bf16 v[72:75], v[184:187], a[60:63], v[72:75]
    v_mfma_f32_16x16x32_bf16 v[76:79], v[188:191], a[60:63], v[76:79]
    ds_read_b128 a[28:31], v3 offset:30720
    s_add_u32 s64, s20, 0x7c80
    buffer_load_dwordx4 v2, s[4:7], s64 offen lds
    s_waitcnt lgkmcnt(4)
    v_mfma_f32_16x16x32_bf16 v[16:19], v[192:195], a[0:3], v[16:19]
    v_mfma_f32_16x16x32_bf16 v[20:23], v[196:199], a[0:3], v[20:23]
    ds_read_b128 a[32:35], v4 offset:16384
    v_mfma_f32_16x16x32_bf16 v[24:27], v[192:195], a[4:7], v[24:27]
    v_mfma_f32_16x16x32_bf16 v[28:31], v[196:199], a[4:7], v[28:31]
    ds_read_b128 a[36:39], v4 offset:18432
    v_mfma_f32_16x16x32_bf16 v[32:35], v[192:195], a[8:11], v[32:35]
    v_mfma_f32_16x16x32_bf16 v[36:39], v[196:199], a[8:11], v[36:39]
    ds_read_b128 a[40:43], v4 offset:20480
    v_mfma_f32_16x16x32_bf16 v[40:43], v[192:195], a[12:15], v[40:43]
    v_mfma_f32_16x16x32_bf16 v[44:47], v[196:199], a[12:15], v[44:47]
    ds_read_b128 a[44:47], v4 offset:22528
    s_waitcnt lgkmcnt(4)
    v_mfma_f32_16x16x32_bf16 v[48:51], v[192:195], a[16:19], v[48:51]
    v_mfma_f32_16x16x32_bf16 v[52:55], v[196:199], a[16:19], v[52:55]
    ds_read_b128 a[48:51], v4 offset:24576
    v_mfma_f32_16x16x32_bf16 v[56:59], v[192:195], a[20:23], v[56:59]
    v_mfma_f32_16x16x32_bf16 v[60:63], v[196:199], a[20:23], v[60:63]
    ds_read_b128 a[52:55], v4 offset:26624
    v_mfma_f32_16x16x32_bf16 v[64:67], v[192:195], a[24:27], v[64:67]
    v_mfma_f32_16x16x32_bf16 v[68:71], v[196:199], a[24:27], v[68:71]
    ds_read_b128 a[56:59], v4 offset:28672
    v_mfma_f32_16x16x32_bf16 v[72:75], v[192:195], a[28:31], v[72:75]
    v_mfma_f32_16x16x32_bf16 v[76:79], v[196:199], a[28:31], v[76:79]
    ds_read_b128 a[60:63], v4 offset:30720
    s_waitcnt vmcnt(8)
    s_barrier
    s_waitcnt lgkmcnt(4)
    v_mfma_f32_16x16x32_bf16 v[16:19], v[200:203], a[32:35], v[16:19]
    v_mfma_f32_16x16x32_bf16 v[20:23], v[204:207], a[32:35], v[20:23]
    ds_read_b128 a[0:3], v3 offset:32768
    s_add_u32 m0, s21, 0
    v_mfma_f32_16x16x32_bf16 v[24:27], v[200:203], a[36:39], v[24:27]
    v_mfma_f32_16x16x32_bf16 v[28:31], v[204:207], a[36:39], v[28:31]
    ds_read_b128 a[4:7], v3 offset:34816
    s_add_u32 s64, s20, 0x50000
    buffer_load_dwordx4 v2, s[4:7], s64 offen lds
    v_mfma_f32_16x16x32_bf16 v[32:35], v[200:203], a[40:43], v[32:35]
    v_mfma_f32_16x16x32_bf16 v[36:39], v[204:207], a[40:43], v[36:39]
    ds_read_b128 a[8:11], v3 offset:36864
    s_add_u32 m0, s21, 1024
    v_mfma_f32_16x16x32_bf16 v[40:43], v[200:203], a[44:47], v[40:43]
    v_mfma_f32_16x16x32_bf16 v[44:47], v[204:207], a[44:47], v[44:47]
    ds_read_b128 a[12:15], v3 offset:38912
    s_add_u32 s64, s20, 0x52800
    buffer_load_dwordx4 v2, s[4:7], s64 offen lds
    s_waitcnt lgkmcnt(4)
    v_mfma_f32_16x16x32_bf16 v[48:51], v[200:203], a[48:51], v[48:51]
    v_mfma_f32_16x16x32_bf16 v[52:55], v[204:207], a[48:51], v[52:55]
    ds_read_b128 a[16:19], v3 offset:40960
    s_add_u32 m0, s21, 2048
    v_mfma_f32_16x16x32_bf16 v[56:59], v[200:203], a[52:55], v[56:59]
    v_mfma_f32_16x16x32_bf16 v[60:63], v[204:207], a[52:55], v[60:63]
    ds_read_b128 a[20:23], v3 offset:43008
    s_add_u32 s64, s20, 0x55000
    buffer_load_dwordx4 v2, s[4:7], s64 offen lds
    v_mfma_f32_16x16x32_bf16 v[64:67], v[200:203], a[56:59], v[64:67]
    v_mfma_f32_16x16x32_bf16 v[68:71], v[204:207], a[56:59], v[68:71]
    ds_read_b128 a[24:27], v3 offset:45056
    s_add_u32 m0, s21, 3072
    v_mfma_f32_16x16x32_bf16 v[72:75], v[200:203], a[60:63], v[72:75]
    v_mfma_f32_16x16x32_bf16 v[76:79], v[204:207], a[60:63], v[76:79]
    ds_read_b128 a[28:31], v3 offset:47104
    s_add_u32 s64, s20, 0x57800
    buffer_load_dwordx4 v2, s[4:7], s64 offen lds
    s_waitcnt lgkmcnt(4)
    v_mfma_f32_16x16x32_bf16 v[16:19], v[208:211], a[0:3], v[16:19]
    v_mfma_f32_16x16x32_bf16 v[20:23], v[212:215], a[0:3], v[20:23]
    ds_read_b128 a[32:35], v4 offset:32768
    v_mfma_f32_16x16x32_bf16 v[24:27], v[208:211], a[4:7], v[24:27]
    v_mfma_f32_16x16x32_bf16 v[28:31], v[212:215], a[4:7], v[28:31]
    ds_read_b128 a[36:39], v4 offset:34816
    v_mfma_f32_16x16x32_bf16 v[32:35], v[208:211], a[8:11], v[32:35]
    v_mfma_f32_16x16x32_bf16 v[36:39], v[212:215], a[8:11], v[36:39]
    ds_read_b128 a[40:43], v4 offset:36864
    v_mfma_f32_16x16x32_bf16 v[40:43], v[208:211], a[12:15], v[40:43]
    v_mfma_f32_16x16x32_bf16 v[44:47], v[212:215], a[12:15], v[44:47]
    ds_read_b128 a[44:47], v4 offset:38912
    s_waitcnt lgkmcnt(4)
    v_mfma_f32_16x16x32_bf16 v[48:51], v[208:211], a[16:19], v[48:51]
    v_mfma_f32_16x16x32_bf16 v[52:55], v[212:215], a[16:19], v[52:55]
    ds_read_b128 a[48:51], v4 offset:40960
    v_mfma_f32_16x16x32_bf16 v[56:59], v[208:211], a[20:23], v[56:59]
    v_mfma_f32_16x16x32_bf16 v[60:63], v[212:215], a[20:23], v[60:63]
    ds_read_b128 a[52:55], v4 offset:43008
    v_mfma_f32_16x16x32_bf16 v[64:67], v[208:211], a[24:27], v[64:67]
    v_mfma_f32_16x16x32_bf16 v[68:71], v[212:215], a[24:27], v[68:71]
    ds_read_b128 a[56:59], v4 offset:45056
    v_mfma_f32_16x16x32_bf16 v[72:75], v[208:211], a[28:31], v[72:75]
    v_mfma_f32_16x16x32_bf16 v[76:79], v[212:215], a[28:31], v[76:79]
    ds_read_b128 a[60:63], v4 offset:47104
    s_waitcnt vmcnt(8)
    s_barrier
    s_waitcnt lgkmcnt(4)
    v_mfma_f32_16x16x32_bf16 v[16:19], v[216:219], a[32:35], v[16:19]
    v_mfma_f32_16x16x32_bf16 v[20:23], v[220:223], a[32:35], v[20:23]
    ds_read_b128 a[0:3], v3 offset:49152
    s_add_u32 m0, s21, 16384
    v_mfma_f32_16x16x32_bf16 v[24:27], v[216:219], a[36:39], v[24:27]
    v_mfma_f32_16x16x32_bf16 v[28:31], v[220:223], a[36:39], v[28:31]
    ds_read_b128 a[4:7], v3 offset:51200
    s_add_u32 s64, s20, 0x50080
    buffer_load_dwordx4 v2, s[4:7], s64 offen lds
    v_mfma_f32_16x16x32_bf16 v[32:35], v[216:219], a[40:43], v[32:35]
    v_mfma_f32_16x16x32_bf16 v[36:39], v[220:223], a[40:43], v[36:39]
    ds_read_b128 a[8:11], v3 offset:53248
    s_add_u32 m0, s21, 17408
    v_mfma_f32_16x16x32_bf16 v[40:43], v[216:219], a[44:47], v[40:43]
    v_mfma_f32_16x16x32_bf16 v[44:47], v[220:223], a[44:47], v[44:47]
    ds_read_b128 a[12:15], v3 offset:55296
    s_add_u32 s64, s20, 0x52880
    buffer_load_dwordx4 v2, s[4:7], s64 offen lds
    s_waitcnt lgkmcnt(4)
    v_mfma_f32_16x16x32_bf16 v[48:51], v[216:219], a[48:51], v[48:51]
    v_mfma_f32_16x16x32_bf16 v[52:55], v[220:223], a[48:51], v[52:55]
    ds_read_b128 a[16:19], v3 offset:57344
    s_add_u32 m0, s21, 18432
    v_mfma_f32_16x16x32_bf16 v[56:59], v[216:219], a[52:55], v[56:59]
    v_mfma_f32_16x16x32_bf16 v[60:63], v[220:223], a[52:55], v[60:63]
    ds_read_b128 a[20:23], v3 offset:59392
    s_add_u32 s64, s20, 0x55080
    buffer_load_dwordx4 v2, s[4:7], s64 offen lds
    v_mfma_f32_16x16x32_bf16 v[64:67], v[216:219], a[56:59], v[64:67]
    v_mfma_f32_16x16x32_bf16 v[68:71], v[220:223], a[56:59], v[68:71]
    ds_read_b128 a[24:27], v3 offset:61440
    s_add_u32 m0, s21, 19456
    v_mfma_f32_16x16x32_bf16 v[72:75], v[216:219], a[60:63], v[72:75]
    v_mfma_f32_16x16x32_bf16 v[76:79], v[220:223], a[60:63], v[76:79]
    ds_read_b128 a[28:31], v3 offset:63488
    s_add_u32 s64, s20, 0x57880
    buffer_load_dwordx4 v2, s[4:7], s64 offen lds
    s_waitcnt lgkmcnt(4)
    v_mfma_f32_16x16x32_bf16 v[16:19], v[224:227], a[0:3], v[16:19]
    v_mfma_f32_16x16x32_bf16 v[20:23], v[228:231], a[0:3], v[20:23]
    ds_read_b128 a[32:35], v4 offset:49152
    v_mfma_f32_16x16x32_bf16 v[24:27], v[224:227], a[4:7], v[24:27]
    v_mfma_f32_16x16x32_bf16 v[28:31], v[228:231], a[4:7], v[28:31]
    ds_read_b128 a[36:39], v4 offset:51200
    v_mfma_f32_16x16x32_bf16 v[32:35], v[224:227], a[8:11], v[32:35]
    v_mfma_f32_16x16x32_bf16 v[36:39], v[228:231], a[8:11], v[36:39]
    ds_read_b128 a[40:43], v4 offset:53248
    v_mfma_f32_16x16x32_bf16 v[40:43], v[224:227], a[12:15], v[40:43]
    v_mfma_f32_16x16x32_bf16 v[44:47], v[228:231], a[12:15], v[44:47]
    ds_read_b128 a[44:47], v4 offset:55296
    s_waitcnt lgkmcnt(4)
    v_mfma_f32_16x16x32_bf16 v[48:51], v[224:227], a[16:19], v[48:51]
    v_mfma_f32_16x16x32_bf16 v[52:55], v[228:231], a[16:19], v[52:55]
    ds_read_b128 a[48:51], v4 offset:57344
    v_mfma_f32_16x16x32_bf16 v[56:59], v[224:227], a[20:23], v[56:59]
    v_mfma_f32_16x16x32_bf16 v[60:63], v[228:231], a[20:23], v[60:63]
    ds_read_b128 a[52:55], v4 offset:59392
    v_mfma_f32_16x16x32_bf16 v[64:67], v[224:227], a[24:27], v[64:67]
    v_mfma_f32_16x16x32_bf16 v[68:71], v[228:231], a[24:27], v[68:71]
    ds_read_b128 a[56:59], v4 offset:61440
    v_mfma_f32_16x16x32_bf16 v[72:75], v[224:227], a[28:31], v[72:75]
    v_mfma_f32_16x16x32_bf16 v[76:79], v[228:231], a[28:31], v[76:79]
    ds_read_b128 a[60:63], v4 offset:63488
    s_waitcnt vmcnt(8)
    s_barrier
    s_waitcnt lgkmcnt(4)
    v_mfma_f32_16x16x32_bf16 v[16:19], v[232:235], a[32:35], v[16:19]
    v_mfma_f32_16x16x32_bf16 v[20:23], v[236:239], a[32:35], v[20:23]
    ds_read_b128 a[0:3], v6 offset:0
    s_add_u32 m0, s21, 32768
    v_mfma_f32_16x16x32_bf16 v[24:27], v[232:235], a[36:39], v[24:27]
    v_mfma_f32_16x16x32_bf16 v[28:31], v[236:239], a[36:39], v[28:31]
    ds_read_b128 a[4:7], v6 offset:2048
    s_add_u32 s64, s20, 0x50100
    buffer_load_dwordx4 v2, s[4:7], s64 offen lds
    v_mfma_f32_16x16x32_bf16 v[32:35], v[232:235], a[40:43], v[32:35]
    v_mfma_f32_16x16x32_bf16 v[36:39], v[236:239], a[40:43], v[36:39]
    ds_read_b128 a[8:11], v6 offset:4096
    s_add_u32 m0, s21, 33792
    v_mfma_f32_16x16x32_bf16 v[40:43], v[232:235], a[44:47], v[40:43]
    v_mfma_f32_16x16x32_bf16 v[44:47], v[236:239], a[44:47], v[44:47]
    ds_read_b128 a[12:15], v6 offset:6144
    s_add_u32 s64, s20, 0x52900
    buffer_load_dwordx4 v2, s[4:7], s64 offen lds
    s_waitcnt lgkmcnt(4)
    v_mfma_f32_16x16x32_bf16 v[48:51], v[232:235], a[48:51], v[48:51]
    v_mfma_f32_16x16x32_bf16 v[52:55], v[236:239], a[48:51], v[52:55]
    ds_read_b128 a[16:19], v6 offset:8192
    s_add_u32 m0, s21, 34816
    v_mfma_f32_16x16x32_bf16 v[56:59], v[232:235], a[52:55], v[56:59]
    v_mfma_f32_16x16x32_bf16 v[60:63], v[236:239], a[52:55], v[60:63]
    ds_read_b128 a[20:23], v6 offset:10240
    s_add_u32 s64, s20, 0x55100
    buffer_load_dwordx4 v2, s[4:7], s64 offen lds
    v_mfma_f32_16x16x32_bf16 v[64:67], v[232:235], a[56:59], v[64:67]
    v_mfma_f32_16x16x32_bf16 v[68:71], v[236:239], a[56:59], v[68:71]
    ds_read_b128 a[24:27], v6 offset:12288
    s_add_u32 m0, s21, 35840
    v_mfma_f32_16x16x32_bf16 v[72:75], v[232:235], a[60:63], v[72:75]
    v_mfma_f32_16x16x32_bf16 v[76:79], v[236:239], a[60:63], v[76:79]
    ds_read_b128 a[28:31], v6 offset:14336
    s_add_u32 s64, s20, 0x57900
    buffer_load_dwordx4 v2, s[4:7], s64 offen lds
    s_waitcnt lgkmcnt(4)
    v_mfma_f32_16x16x32_bf16 v[16:19], v[240:243], a[0:3], v[16:19]
    v_mfma_f32_16x16x32_bf16 v[20:23], v[244:247], a[0:3], v[20:23]
    ds_read_b128 a[32:35], v9 offset:0
    v_mfma_f32_16x16x32_bf16 v[24:27], v[240:243], a[4:7], v[24:27]
    v_mfma_f32_16x16x32_bf16 v[28:31], v[244:247], a[4:7], v[28:31]
    ds_read_b128 a[36:39], v9 offset:2048
    v_mfma_f32_16x16x32_bf16 v[32:35], v[240:243], a[8:11], v[32:35]
    v_mfma_f32_16x16x32_bf16 v[36:39], v[244:247], a[8:11], v[36:39]
    ds_read_b128 a[40:43], v9 offset:4096
    v_mfma_f32_16x16x32_bf16 v[40:43], v[240:243], a[12:15], v[40:43]
    v_mfma_f32_16x16x32_bf16 v[44:47], v[244:247], a[12:15], v[44:47]
    ds_read_b128 a[44:47], v9 offset:6144
    s_waitcnt lgkmcnt(4)
    v_mfma_f32_16x16x32_bf16 v[48:51], v[240:243], a[16:19], v[48:51]
    v_mfma_f32_16x16x32_bf16 v[52:55], v[244:247], a[16:19], v[52:55]
    ds_read_b128 a[48:51], v9 offset:8192
    v_mfma_f32_16x16x32_bf16 v[56:59], v[240:243], a[20:23], v[56:59]
    v_mfma_f32_16x16x32_bf16 v[60:63], v[244:247], a[20:23], v[60:63]
    ds_read_b128 a[52:55], v9 offset:10240
    v_mfma_f32_16x16x32_bf16 v[64:67], v[240:243], a[24:27], v[64:67]
    v_mfma_f32_16x16x32_bf16 v[68:71], v[244:247], a[24:27], v[68:71]
    ds_read_b128 a[56:59], v9 offset:12288
    v_mfma_f32_16x16x32_bf16 v[72:75], v[240:243], a[28:31], v[72:75]
    v_mfma_f32_16x16x32_bf16 v[76:79], v[244:247], a[28:31], v[76:79]
    ds_read_b128 a[60:63], v9 offset:14336
    s_waitcnt vmcnt(8)
    s_barrier
    s_waitcnt lgkmcnt(4)
    v_mfma_f32_16x16x32_bf16 v[16:19], v[248:251], a[32:35], v[16:19]
    v_mfma_f32_16x16x32_bf16 v[20:23], v[252:255], a[32:35], v[20:23]
    ds_read_b128 a[0:3], v3 offset:0
    s_add_u32 m0, s21, 49152
    v_mfma_f32_16x16x32_bf16 v[24:27], v[248:251], a[36:39], v[24:27]
    v_mfma_f32_16x16x32_bf16 v[28:31], v[252:255], a[36:39], v[28:31]
    ds_read_b128 a[4:7], v3 offset:2048
    s_add_u32 s64, s20, 0x50180
    buffer_load_dwordx4 v2, s[4:7], s64 offen lds
    v_mfma_f32_16x16x32_bf16 v[32:35], v[248:251], a[40:43], v[32:35]
    v_mfma_f32_16x16x32_bf16 v[36:39], v[252:255], a[40:43], v[36:39]
    ds_read_b128 a[8:11], v3 offset:4096
    s_add_u32 m0, s21, 50176
    v_mfma_f32_16x16x32_bf16 v[40:43], v[248:251], a[44:47], v[40:43]
    v_mfma_f32_16x16x32_bf16 v[44:47], v[252:255], a[44:47], v[44:47]
    ds_read_b128 a[12:15], v3 offset:6144
    s_add_u32 s64, s20, 0x52980
    buffer_load_dwordx4 v2, s[4:7], s64 offen lds
    s_waitcnt lgkmcnt(4)
    v_mfma_f32_16x16x32_bf16 v[48:51], v[248:251], a[48:51], v[48:51]
    v_mfma_f32_16x16x32_bf16 v[52:55], v[252:255], a[48:51], v[52:55]
    ds_read_b128 a[16:19], v3 offset:8192
    s_add_u32 m0, s21, 51200
    v_mfma_f32_16x16x32_bf16 v[56:59], v[248:251], a[52:55], v[56:59]
    v_mfma_f32_16x16x32_bf16 v[60:63], v[252:255], a[52:55], v[60:63]
    ds_read_b128 a[20:23], v3 offset:10240
    s_add_u32 s64, s20, 0x55180
    buffer_load_dwordx4 v2, s[4:7], s64 offen lds
    v_mfma_f32_16x16x32_bf16 v[64:67], v[248:251], a[56:59], v[64:67]
    v_mfma_f32_16x16x32_bf16 v[68:71], v[252:255], a[56:59], v[68:71]
    ds_read_b128 a[24:27], v3 offset:12288
    s_add_u32 m0, s21, 52224
    v_mfma_f32_16x16x32_bf16 v[72:75], v[248:251], a[60:63], v[72:75]
    v_mfma_f32_16x16x32_bf16 v[76:79], v[252:255], a[60:63], v[76:79]
    ds_read_b128 a[28:31], v3 offset:14336
    s_add_u32 s64, s20, 0x57980
    buffer_load_dwordx4 v2, s[4:7], s64 offen lds
    s_nop 5
    s_mul_i32 s65, s17, 0
    s_add_u32 s65, s65, s22
    s_add_u32 s64, s65, 0
    v_cvt_pk_bf16_f32 v80, v16, v17
    v_cvt_pk_bf16_f32 v81, v18, v19
    v_cvt_pk_bf16_f32 v82, v20, v21
    v_cvt_pk_bf16_f32 v83, v22, v23
    buffer_store_dwordx4 v[80:83], v1, s[4:7], s64 offen sc1
    s_add_u32 s64, s65, 4096
    v_cvt_pk_bf16_f32 v84, v24, v25
    v_cvt_pk_bf16_f32 v85, v26, v27
    v_cvt_pk_bf16_f32 v86, v28, v29
    v_cvt_pk_bf16_f32 v87, v30, v31
    buffer_store_dwordx4 v[84:87], v1, s[4:7], s64 offen sc1
    s_mul_i32 s65, s17, 1
    s_add_u32 s65, s65, s22
    s_add_u32 s64, s65, 0
    v_cvt_pk_bf16_f32 v88, v32, v33
    v_cvt_pk_bf16_f32 v89, v34, v35
    v_cvt_pk_bf16_f32 v90, v36, v37
    v_cvt_pk_bf16_f32 v91, v38, v39
    buffer_store_dwordx4 v[88:91], v1, s[4:7], s64 offen sc1
    s_add_u32 s64, s65, 4096
    v_cvt_pk_bf16_f32 v92, v40, v41
    v_cvt_pk_bf16_f32 v93, v42, v43
    v_cvt_pk_bf16_f32 v94, v44, v45
    v_cvt_pk_bf16_f32 v95, v46, v47
    buffer_store_dwordx4 v[92:95], v1, s[4:7], s64 offen sc1
    s_mul_i32 s65, s17, 2
    s_add_u32 s65, s65, s22
    s_add_u32 s64, s65, 0
    v_cvt_pk_bf16_f32 v80, v48, v49
    v_cvt_pk_bf16_f32 v81, v50, v51
    v_cvt_pk_bf16_f32 v82, v52, v53
    v_cvt_pk_bf16_f32 v83, v54, v55
    buffer_store_dwordx4 v[80:83], v1, s[4:7], s64 offen sc1
    s_add_u32 s64, s65, 4096
    v_cvt_pk_bf16_f32 v84, v56, v57
    v_cvt_pk_bf16_f32 v85, v58, v59
    v_cvt_pk_bf16_f32 v86, v60, v61
    v_cvt_pk_bf16_f32 v87, v62, v63
    buffer_store_dwordx4 v[84:87], v1, s[4:7], s64 offen sc1
    s_mul_i32 s65, s17, 3
    s_add_u32 s65, s65, s22
    s_add_u32 s64, s65, 0
    v_cvt_pk_bf16_f32 v88, v64, v65
    v_cvt_pk_bf16_f32 v89, v66, v67
    v_cvt_pk_bf16_f32 v90, v68, v69
    v_cvt_pk_bf16_f32 v91, v70, v71
    buffer_store_dwordx4 v[88:91], v1, s[4:7], s64 offen sc1
    s_add_u32 s64, s65, 4096
    v_cvt_pk_bf16_f32 v92, v72, v73
    v_cvt_pk_bf16_f32 v93, v74, v75
    v_cvt_pk_bf16_f32 v94, v76, v77
    v_cvt_pk_bf16_f32 v95, v78, v79
    buffer_store_dwordx4 v[92:95], v1, s[4:7], s64 offen sc1
    s_lshl_b32 s64, s19, 1
    s_add_u32 s64, s64, s12
    s_lshl_b32 s64, s64, 9
    s_add_u32 s23, s18, s64
    s_lshl_b32 s64, s17, 3
    s_add_u32 s22, s22, s64
    s_add_u32 s19, s19, 1
    s_add_u32 s20, s20, 0x50000
    s_cmp_lg_u32 s19, 1
    s_cbranch_scc1 GE0_120
    s_waitcnt vmcnt(0)
    s_barrier
    s_cmp_lg_u32 s14, 0
    s_cbranch_scc1 GF_121
    v_mov_b32 v7, 1
    v_mov_b32 v8, 0
    s_mov_b64 exec, 1
    buffer_store_dword v7, v8, s[4:7], s23 offen sc1
    s_mov_b64 exec, -1
GF_121:
GE0_120:
    s_cmp_lt_u32 s19, 8
    s_cbranch_scc1 G_T_LOOP
    s_waitcnt vmcnt(0) lgkmcnt(0)
    s_barrier
    s_cmp_lg_u32 s14, 0
    s_cbranch_scc1 GF_122
    v_mov_b32 v7, 1
    v_mov_b32 v8, 0
    s_mov_b64 exec, 1
    buffer_store_dword v7, v8, s[4:7], s23 offen sc1
    s_mov_b64 exec, -1
GF_122:
    s_cmp_eq_u32 s3, 2
    s_cbranch_scc1 H_Q
    s_cmp_eq_u32 s12, 1
    s_cbranch_scc1 H_OUT
    s_lshl_b32 s88, s3, 5
    s_add_u32 s88, s88, s13
    s_mov_b32 s29, 0
    v_lshlrev_b32 v1, 4, v0
    s_mov_b32 s65, 0
CW_123:
    buffer_load_dwordx2 v[8:9], off, s[60:63], 0 offset:132 sc1
    s_add_u32 s65, s65, 1
    s_waitcnt vmcnt(0)
    v_readfirstlane_b32 s66, v8
    v_readfirstlane_b32 s67, v9
    s_min_u32 s64, s66, s67
    s_cmp_lg_u32 s64, 0
    s_cbranch_scc1 CWD_124
    s_cmp_gt_u32 s65, 65536
    s_cbranch_scc1 CWD_124
    s_sleep 4
    s_branch CW_123
CWD_124:
    s_sub_u32 s66, s66, 1
    s_and_b32 s66, s66, 3
    s_sub_u32 s67, s67, 1
    s_and_b32 s67, s67, 3
    s_mov_b32 s64, s66
    s_mov_b32 s65, s67
    s_and_b32 s64, s64, 3
    s_lshl_b32 s64, s64, 13
    s_and_b32 s65, s65, 3
    s_lshl_b32 s65, s65, 13
    s_add_u32 s25, s64, 0x6000000
    s_add_u32 s30, s65, 0x6200000
    v_bfe_u32 v4, v0, 3, 1
    v_mul_u32_u24 v2, 0x8000, v4
    v_lshrrev_b32 v4, 5, v0
    v_lshl_add_u32 v2, v4, 8, v2
    v_bfe_u32 v4, v0, 4, 1
    v_lshl_add_u32 v2, v4, 7, v2
    v_and_b32 v4, 7, v0
    v_lshl_add_u32 v2, v4, 4, v2
    v_bfe_u32 v4, v0, 3, 1
    v_lshlrev_b32 v3, 16, v4
    v_lshrrev_b32 v4, 4, v0
    v_lshl_add_u32 v3, v4, 7, v3
    v_and_b32 v4, 7, v0
    v_lshl_add_u32 v3, v4, 4, v3
    s_lshl_b32 s26, s13, 11
    s_lshl_b32 s64, s14, 9
    s_add_u32 s26, s26, s64
    s_add_u32 s26, s26, 0x640000
    s_lshl_b32 s27, s13, 3
    s_add_u32 s27, s27, 0x294000
    s_mov_b32 s28, 0x29a000
    s_mov_b32 s24, 0
    v_lshlrev_b32 v6, 7, v0
MKT_LOOP:
    s_cmp_lg_u32 s24, 10
    s_cbranch_scc1 MKH_125
    v_mov_b32 v10, v2
    v_mov_b32 v11, v3
    s_cmp_ge_u32 s88, 60
    s_cbranch_scc1 NOWO_126
    s_mov_b32 s89, s13
    s_mul_hi_u32 s65, s88, 0xccccccd
    s_mul_i32 s65, s65, 20
    s_sub_u32 s13, s88, s65
    s_load_dwordx2 s[44:45], s[0:1], 40
    s_mov_b32 s46, 0x500000
    s_mov_b32 s47, 0x00020000
    s_waitcnt lgkmcnt(0)
    s_mul_i32 s21, s14, 36864
    v_lshrrev_b32 v7, 2, v0
    v_mul_u32_u24 v4, 1280, v7
    v_bfe_u32 v7, v0, 4, 1
    v_lshlrev_b32 v7, 1, v7
    v_and_b32 v8, 3, v0
    v_xor_b32 v7, v7, v8
    v_lshl_add_u32 v4, v7, 4, v4
    v_lshrrev_b32 v7, 4, v0
    v_lshlrev_b32 v2, 8, v7
    v_bfe_u32 v7, v0, 2, 2
    v_lshl_add_u32 v2, v7, 6, v2
    v_and_b32 v7, 3, v0
    v_lshl_add_u32 v2, v7, 3, v2
    v_add_u32 v2, s21, v2
    v_bfe_u32 v7, v0, 4, 1
    v_lshlrev_b32 v7, 5, v7
    v_sub_u32 v3, 32, v7
    v_add_u32 v3, v3, v2
    v_add_u32 v2, v2, v7
    s_mul_i32 s65, s14, 1310720
    s_lshl_b32 s66, s13, 6
    s_add_u32 s65, s65, s66
    s_add_u32 m0, s21, 0
    s_add_u32 s64, s65, 0x0
    buffer_load_dwordx4 v4, s[44:47], s64 offen lds
    s_add_u32 m0, s21, 1024
    s_add_u32 s64, s65, 0x5000
    buffer_load_dwordx4 v4, s[44:47], s64 offen lds
    s_add_u32 m0, s21, 2048
    s_add_u32 s64, s65, 0xa000
    buffer_load_dwordx4 v4, s[44:47], s64 offen lds
    s_add_u32 m0, s21, 3072
    s_add_u32 s64, s65, 0xf000
    buffer_load_dwordx4 v4, s[44:47], s64 offen lds
    s_add_u32 m0, s21, 4096
    s_add_u32 s64, s65, 0x14000
    buffer_load_dwordx4 v4, s[44:47], s64 offen lds
    s_add_u32 m0, s21, 5120
    s_add_u32 s64, s65, 0x19000
    buffer_load_dwordx4 v4, s[44:47], s64 offen lds
    s_add_u32 m0, s21, 6144
    s_add_u32 s64, s65, 0x1e000
    buffer_load_dwordx4 v4, s[44:47], s64 offen lds
    s_add_u32 m0, s21, 7168
    s_add_u32 s64, s65, 0x23000
    buffer_load_dwordx4 v4, s[44:47], s64 offen lds
    s_add_u32 m0, s21, 8192
    s_add_u32 s64, s65, 0x28000
    buffer_load_dwordx4 v4, s[44:47], s64 offen lds
    s_add_u32 m0, s21, 9216
    s_add_u32 s64, s65, 0x2d000
    buffer_load_dwordx4 v4, s[44:47], s64 offen lds
    s_add_u32 m0, s21, 10240
    s_add_u32 s64, s65, 0x32000
    buffer_load_dwordx4 v4, s[44:47], s64 offen lds
    s_add_u32 m0, s21, 11264
    s_add_u32 s64, s65, 0x37000
    buffer_load_dwordx4 v4, s[44:47], s64 offen lds
    s_add_u32 m0, s21, 12288
    s_add_u32 s64, s65, 0x3c000
    buffer_load_dwordx4 v4, s[44:47], s64 offen lds
    s_add_u32 m0, s21, 13312
    s_add_u32 s64, s65, 0x41000
    buffer_load_dwordx4 v4, s[44:47], s64 offen lds
    s_add_u32 m0, s21, 14336
    s_add_u32 s64, s65, 0x46000
    buffer_load_dwordx4 v4, s[44:47], s64 offen lds
    s_add_u32 m0, s21, 15360
    s_add_u32 s64, s65, 0x4b000
    buffer_load_dwordx4 v4, s[44:47], s64 offen lds
    s_add_u32 m0, s21, 16384
    s_add_u32 s64, s65, 0x50000
    buffer_load_dwordx4 v4, s[44:47], s64 offen lds
    s_add_u32 m0, s21, 17408
    s_add_u32 s64, s65, 0x55000
    buffer_load_dwordx4 v4, s[44:47], s64 offen lds
    s_add_u32 m0, s21, 18432
    s_add_u32 s64, s65, 0x5a000
    buffer_load_dwordx4 v4, s[44:47], s64 offen lds
    s_add_u32 m0, s21, 19456
    s_add_u32 s64, s65, 0x5f000
    buffer_load_dwordx4 v4, s[44:47], s64 offen lds
    s_add_u32 m0, s21, 20480
    s_add_u32 s64, s65, 0x64000
    buffer_load_dwordx4 v4, s[44:47], s64 offen lds
    s_add_u32 m0, s21, 21504
    s_add_u32 s64, s65, 0x69000
    buffer_load_dwordx4 v4, s[44:47], s64 offen lds
    s_add_u32 m0, s21, 22528
    s_add_u32 s64, s65, 0x6e000
    buffer_load_dwordx4 v4, s[44:47], s64 offen lds
    s_add_u32 m0, s21, 23552
    s_add_u32 s64, s65, 0x73000
    buffer_load_dwordx4 v4, s[44:47], s64 offen lds
    s_add_u32 m0, s21, 24576
    s_add_u32 s64, s65, 0x78000
    buffer_load_dwordx4 v4, s[44:47], s64 offen lds
    s_add_u32 m0, s21, 25600
    s_add_u32 s64, s65, 0x7d000
    buffer_load_dwordx4 v4, s[44:47], s64 offen lds
    s_add_u32 m0, s21, 26624
    s_add_u32 s64, s65, 0x82000
    buffer_load_dwordx4 v4, s[44:47], s64 offen lds
    s_add_u32 m0, s21, 27648
    s_add_u32 s64, s65, 0x87000
    buffer_load_dwordx4 v4, s[44:47], s64 offen lds
    s_add_u32 m0, s21, 28672
    s_add_u32 s64, s65, 0x8c000
    buffer_load_dwordx4 v4, s[44:47], s64 offen lds
    s_add_u32 m0, s21, 29696
    s_add_u32 s64, s65, 0x91000
    buffer_load_dwordx4 v4, s[44:47], s64 offen lds
    s_add_u32 m0, s21, 30720
    s_add_u32 s64, s65, 0x96000
    buffer_load_dwordx4 v4, s[44:47], s64 offen lds
    s_add_u32 m0, s21, 31744
    s_add_u32 s64, s65, 0x9b000
    buffer_load_dwordx4 v4, s[44:47], s64 offen lds
    s_add_u32 m0, s21, 32768
    s_add_u32 s64, s65, 0xa0000
    buffer_load_dwordx4 v4, s[44:47], s64 offen lds
    s_add_u32 m0, s21, 33792
    s_add_u32 s64, s65, 0xa5000
    buffer_load_dwordx4 v4, s[44:47], s64 offen lds
    s_add_u32 m0, s21, 34816
    s_add_u32 s64, s65, 0xaa000
    buffer_load_dwordx4 v4, s[44:47], s64 offen lds
    s_add_u32 m0, s21, 35840
    s_add_u32 s64, s65, 0xaf000
    buffer_load_dwordx4 v4, s[44:47], s64 offen lds
    s_waitcnt vmcnt(32)
    ds_read_b64_tr_b16 a[0:1], v2 offset:0
    ds_read_b64_tr_b16 a[2:3], v2 offset:1024
    ds_read_b64_tr_b16 a[4:5], v3 offset:0
    ds_read_b64_tr_b16 a[6:7], v3 offset:1024
    ds_read_b64_tr_b16 a[8:9], v2 offset:2048
    ds_read_b64_tr_b16 a[10:11], v2 offset:3072
    ds_read_b64_tr_b16 a[12:13], v3 offset:2048
    ds_read_b64_tr_b16 a[14:15], v3 offset:3072
    s_waitcnt lgkmcnt(0)
    s_add_u32 m0, s21, 0
    s_add_u32 s64, s65, 0xb4000
    buffer_load_dwordx4 v4, s[44:47], s64 offen lds
    s_add_u32 m0, s21, 1024
    s_add_u32 s64, s65, 0xb9000
    buffer_load_dwordx4 v4, s[44:47], s64 offen lds
    s_add_u32 m0, s21, 2048
    s_add_u32 s64, s65, 0xbe000
    buffer_load_dwordx4 v4, s[44:47], s64 offen lds
    s_add_u32 m0, s21, 3072
    s_add_u32 s64, s65, 0xc3000
    buffer_load_dwordx4 v4, s[44:47], s64 offen lds
    s_waitcnt vmcnt(32)
    ds_read_b64_tr_b16 a[16:17], v2 offset:4096
    ds_read_b64_tr_b16 a[18:19], v2 offset:5120
    ds_read_b64_tr_b16 a[20:21], v3 offset:4096
    ds_read_b64_tr_b16 a[22:23], v3 offset:5120
    ds_read_b64_tr_b16 a[24:25], v2 offset:6144
    ds_read_b64_tr_b16 a[26:27], v2 offset:7168
    ds_read_b64_tr_b16 a[28:29], v3 offset:6144
    ds_read_b64_tr_b16 a[30:31], v3 offset:7168
    s_waitcnt lgkmcnt(0)
    s_add_u32 m0, s21, 4096
    s_add_u32 s64, s65, 0xc8000
    buffer_load_dwordx4 v4, s[44:47], s64 offen lds
    s_add_u32 m0, s21, 5120
    s_add_u32 s64, s65, 0xcd000
    buffer_load_dwordx4 v4, s[44:47], s64 offen lds
    s_add_u32 m0, s21, 6144
    s_add_u32 s64, s65, 0xd2000
    buffer_load_dwordx4 v4, s[44:47], s64 offen lds
    s_add_u32 m0, s21, 7168
    s_add_u32 s64, s65, 0xd7000
    buffer_load_dwordx4 v4, s[44:47], s64 offen lds
    s_waitcnt vmcnt(32)
    ds_read_b64_tr_b16 a[32:33], v2 offset:8192
    ds_read_b64_tr_b16 a[34:35], v2 offset:9216
    ds_read_b64_tr_b16 a[36:37], v3 offset:8192
    ds_read_b64_tr_b16 a[38:39], v3 offset:9216
    ds_read_b64_tr_b16 a[40:41], v2 offset:10240
    ds_read_b64_tr_b16 a[42:43], v2 offset:11264
    ds_read_b64_tr_b16 a[44:45], v3 offset:10240
    ds_read_b64_tr_b16 a[46:47], v3 offset:11264
    s_waitcnt lgkmcnt(0)
    s_add_u32 m0, s21, 8192
    s_add_u32 s64, s65, 0xdc000
    buffer_load_dwordx4 v4, s[44:47], s64 offen lds
    s_add_u32 m0, s21, 9216
    s_add_u32 s64, s65, 0xe1000
    buffer_load_dwordx4 v4, s[44:47], s64 offen lds
    s_add_u32 m0, s21, 10240
    s_add_u32 s64, s65, 0xe6000
    buffer_load_dwordx4 v4, s[44:47], s64 offen lds
    s_add_u32 m0, s21, 11264
    s_add_u32 s64, s65, 0xeb000
    buffer_load_dwordx4 v4, s[44:47], s64 offen lds
    s_waitcnt vmcnt(32)
    ds_read_b64_tr_b16 a[48:49], v2 offset:12288
    ds_read_b64_tr_b16 a[50:51], v2 offset:13312
    ds_read_b64_tr_b16 a[52:53], v3 offset:12288
    ds_read_b64_tr_b16 a[54:55], v3 offset:13312
    ds_read_b64_tr_b16 a[56:57], v2 offset:14336
    ds_read_b64_tr_b16 a[58:59], v2 offset:15360
    ds_read_b64_tr_b16 a[60:61], v3 offset:14336
    ds_read_b64_tr_b16 a[62:63], v3 offset:15360
    s_waitcnt lgkmcnt(0)
    s_add_u32 m0, s21, 12288
    s_add_u32 s64, s65, 0xf0000
    buffer_load_dwordx4 v4, s[44:47], s64 offen lds
    s_add_u32 m0, s21, 13312
    s_add_u32 s64, s65, 0xf5000
    buffer_load_dwordx4 v4, s[44:47], s64 offen lds
    s_add_u32 m0, s21, 14336
    s_add_u32 s64, s65, 0xfa000
    buffer_load_dwordx4 v4, s[44:47], s64 offen lds
    s_add_u32 m0, s21, 15360
    s_add_u32 s64, s65, 0xff000
    buffer_load_dwordx4 v4, s[44:47], s64 offen lds
    s_waitcnt vmcnt(32)
    ds_read_b64_tr_b16 a[64:65], v2 offset:16384
    ds_read_b64_tr_b16 a[66:67], v2 offset:17408
    ds_read_b64_tr_b16 a[68:69], v3 offset:16384
    ds_read_b64_tr_b16 a[70:71], v3 offset:17408
    ds_read_b64_tr_b16 a[72:73], v2 offset:18432
    ds_read_b64_tr_b16 a[74:75], v2 offset:19456
    ds_read_b64_tr_b16 a[76:77], v3 offset:18432
    ds_read_b64_tr_b16 a[78:79], v3 offset:19456
    s_waitcnt lgkmcnt(0)
    s_add_u32 m0, s21, 16384
    s_add_u32 s64, s65, 0x104000
    buffer_load_dwordx4 v4, s[44:47], s64 offen lds
    s_add_u32 m0, s21, 17408
    s_add_u32 s64, s65, 0x109000
    buffer_load_dwordx4 v4, s[44:47], s64 offen lds
    s_add_u32 m0, s21, 18432
    s_add_u32 s64, s65, 0x10e000
    buffer_load_dwordx4 v4, s[44:47], s64 offen lds
    s_add_u32 m0, s21, 19456
    s_add_u32 s64, s65, 0x113000
    buffer_load_dwordx4 v4, s[44:47], s64 offen lds
    s_waitcnt vmcnt(32)
    ds_read_b64_tr_b16 a[80:81], v2 offset:20480
    ds_read_b64_tr_b16 a[82:83], v2 offset:21504
    ds_read_b64_tr_b16 a[84:85], v3 offset:20480
    ds_read_b64_tr_b16 a[86:87], v3 offset:21504
    ds_read_b64_tr_b16 a[88:89], v2 offset:22528
    ds_read_b64_tr_b16 a[90:91], v2 offset:23552
    ds_read_b64_tr_b16 a[92:93], v3 offset:22528
    ds_read_b64_tr_b16 a[94:95], v3 offset:23552
    s_waitcnt lgkmcnt(0)
    s_add_u32 m0, s21, 20480
    s_add_u32 s64, s65, 0x118000
    buffer_load_dwordx4 v4, s[44:47], s64 offen lds
    s_add_u32 m0, s21, 21504
    s_add_u32 s64, s65, 0x11d000
    buffer_load_dwordx4 v4, s[44:47], s64 offen lds
    s_add_u32 m0, s21, 22528
    s_add_u32 s64, s65, 0x122000
    buffer_load_dwordx4 v4, s[44:47], s64 offen lds
    s_add_u32 m0, s21, 23552
    s_add_u32 s64, s65, 0x127000
    buffer_load_dwordx4 v4, s[44:47], s64 offen lds
    s_waitcnt vmcnt(32)
    ds_read_b64_tr_b16 a[96:97], v2 offset:24576
    ds_read_b64_tr_b16 a[98:99], v2 offset:25600
    ds_read_b64_tr_b16 a[100:101], v3 offset:24576
    ds_read_b64_tr_b16 a[102:103], v3 offset:25600
    ds_read_b64_tr_b16 a[104:105], v2 offset:26624
    ds_read_b64_tr_b16 a[106:107], v2 offset:27648
    ds_read_b64_tr_b16 a[108:109], v3 offset:26624
    ds_read_b64_tr_b16 a[110:111], v3 offset:27648
    s_waitcnt lgkmcnt(0)
    s_add_u32 m0, s21, 24576
    s_add_u32 s64, s65, 0x12c000
    buffer_load_dwordx4 v4, s[44:47], s64 offen lds
    s_add_u32 m0, s21, 25600
    s_add_u32 s64, s65, 0x131000
    buffer_load_dwordx4 v4, s[44:47], s64 offen lds
    s_add_u32 m0, s21, 26624
    s_add_u32 s64, s65, 0x136000
    buffer_load_dwordx4 v4, s[44:47], s64 offen lds
    s_add_u32 m0, s21, 27648
    s_add_u32 s64, s65, 0x13b000
    buffer_load_dwordx4 v4, s[44:47], s64 offen lds
    s_waitcnt vmcnt(32)
    ds_read_b64_tr_b16 a[112:113], v2 offset:28672
    ds_read_b64_tr_b16 a[114:115], v2 offset:29696
    ds_read_b64_tr_b16 a[116:117], v3 offset:28672
    ds_read_b64_tr_b16 a[118:119], v3 offset:29696
    ds_read_b64_tr_b16 a[120:121], v2 offset:30720
    ds_read_b64_tr_b16 a[122:123], v2 offset:31744
    ds_read_b64_tr_b16 a[124:125], v3 offset:30720
    ds_read_b64_tr_b16 a[126:127], v3 offset:31744
    s_waitcnt lgkmcnt(0)
    s_waitcnt vmcnt(28)
    ds_read_b64_tr_b16 a[128:129], v2 offset:32768
    ds_read_b64_tr_b16 a[130:131], v2 offset:33792
    ds_read_b64_tr_b16 a[132:133], v3 offset:32768
    ds_read_b64_tr_b16 a[134:135], v3 offset:33792
    ds_read_b64_tr_b16 a[136:137], v2 offset:34816
    ds_read_b64_tr_b16 a[138:139], v2 offset:35840
    ds_read_b64_tr_b16 a[140:141], v3 offset:34816
    ds_read_b64_tr_b16 a[142:143], v3 offset:35840
    s_waitcnt lgkmcnt(0)
    s_waitcnt vmcnt(24)
    ds_read_b64_tr_b16 a[144:145], v2 offset:0
    ds_read_b64_tr_b16 a[146:147], v2 offset:1024
    ds_read_b64_tr_b16 a[148:149], v3 offset:0
    ds_read_b64_tr_b16 a[150:151], v3 offset:1024
    ds_read_b64_tr_b16 a[152:153], v2 offset:2048
    ds_read_b64_tr_b16 a[154:155], v2 offset:3072
    ds_read_b64_tr_b16 a[156:157], v3 offset:2048
    ds_read_b64_tr_b16 a[158:159], v3 offset:3072
    s_waitcnt lgkmcnt(0)
    s_waitcnt vmcnt(20)
    ds_read_b64_tr_b16 a[160:161], v2 offset:4096
    ds_read_b64_tr_b16 a[162:163], v2 offset:5120
    ds_read_b64_tr_b16 a[164:165], v3 offset:4096
    ds_read_b64_tr_b16 a[166:167], v3 offset:5120
    ds_read_b64_tr_b16 a[168:169], v2 offset:6144
    ds_read_b64_tr_b16 a[170:171], v2 offset:7168
    ds_read_b64_tr_b16 a[172:173], v3 offset:6144
    ds_read_b64_tr_b16 a[174:175], v3 offset:7168
    s_waitcnt lgkmcnt(0)
    s_waitcnt vmcnt(16)
    ds_read_b64_tr_b16 a[176:177], v2 offset:8192
    ds_read_b64_tr_b16 a[178:179], v2 offset:9216
    ds_read_b64_tr_b16 a[180:181], v3 offset:8192
    ds_read_b64_tr_b16 a[182:183], v3 offset:9216
    ds_read_b64_tr_b16 a[184:185], v2 offset:10240
    ds_read_b64_tr_b16 a[186:187], v2 offset:11264
    ds_read_b64_tr_b16 a[188:189], v3 offset:10240
    ds_read_b64_tr_b16 a[190:191], v3 offset:11264
    s_waitcnt lgkmcnt(0)
    s_waitcnt vmcnt(12)
    ds_read_b64_tr_b16 a[192:193], v2 offset:12288
    ds_read_b64_tr_b16 a[194:195], v2 offset:13312
    ds_read_b64_tr_b16 a[196:197], v3 offset:12288
    ds_read_b64_tr_b16 a[198:199], v3 offset:13312
    ds_read_b64_tr_b16 a[200:201], v2 offset:14336
    ds_read_b64_tr_b16 a[202:203], v2 offset:15360
    ds_read_b64_tr_b16 a[204:205], v3 offset:14336
    ds_read_b64_tr_b16 a[206:207], v3 offset:15360
    s_waitcnt lgkmcnt(0)
    s_waitcnt vmcnt(8)
    ds_read_b64_tr_b16 a[208:209], v2 offset:16384
    ds_read_b64_tr_b16 a[210:211], v2 offset:17408
    ds_read_b64_tr_b16 a[212:213], v3 offset:16384
    ds_read_b64_tr_b16 a[214:215], v3 offset:17408
    ds_read_b64_tr_b16 a[216:217], v2 offset:18432
    ds_read_b64_tr_b16 a[218:219], v2 offset:19456
    ds_read_b64_tr_b16 a[220:221], v3 offset:18432
    ds_read_b64_tr_b16 a[222:223], v3 offset:19456
    s_waitcnt lgkmcnt(0)
    s_waitcnt vmcnt(4)
    ds_read_b64_tr_b16 a[224:225], v2 offset:20480
    ds_read_b64_tr_b16 a[226:227], v2 offset:21504
    ds_read_b64_tr_b16 a[228:229], v3 offset:20480
    ds_read_b64_tr_b16 a[230:231], v3 offset:21504
    ds_read_b64_tr_b16 a[232:233], v2 offset:22528
    ds_read_b64_tr_b16 a[234:235], v2 offset:23552
    ds_read_b64_tr_b16 a[236:237], v3 offset:22528
    ds_read_b64_tr_b16 a[238:239], v3 offset:23552
    s_waitcnt lgkmcnt(0)
    s_waitcnt vmcnt(0)
    ds_read_b64_tr_b16 a[240:241], v2 offset:24576
    ds_read_b64_tr_b16 a[242:243], v2 offset:25600
    ds_read_b64_tr_b16 a[244:245], v3 offset:24576
    ds_read_b64_tr_b16 a[246:247], v3 offset:25600
    ds_read_b64_tr_b16 a[248:249], v2 offset:26624
    ds_read_b64_tr_b16 a[250:251], v2 offset:27648
    ds_read_b64_tr_b16 a[252:253], v3 offset:26624
    ds_read_b64_tr_b16 a[254:255], v3 offset:27648
    s_waitcnt lgkmcnt(0)
    s_mov_b32 s13, s89
NOWO_126:
    v_mov_b32 v2, v10
    v_mov_b32 v3, v11
MKH_125:
    s_cmp_lg_u32 s24, 31
    s_mov_b64 exec, 0xf
    s_cbranch_scc1 MKL_127
    s_mov_b64 exec, -1
    v_bfe_u32 v4, v0, 3, 1
    v_mul_u32_u24 v4, 0x8000, v4
    v_sub_u32 v2, v2, v4
    s_mov_b64 exec, 3
MKL_127:
MKT_M_128:
    buffer_load_dword v5, v6, s[4:7], s28 offen sc1
    s_add_u32 s29, s29, 1
    s_waitcnt vmcnt(0)
    v_cmp_eq_u32 vcc, 0, v5
    s_cbranch_vccz MKT_MD_129
    s_cmp_gt_u32 s29, 262144
    s_cbranch_scc1 MKT_MD_129
    s_sleep 1
    s_branch MKT_M_128
MKT_MD_129:
    s_mov_b64 exec, -1
MKR_130:
    s_add_u32 s64, s25, 0x0
    buffer_load_dwordx4 v[16:19], v2, s[4:7], s64 offen sc1
    s_add_u32 s64, s25, 0x200
    buffer_load_dwordx4 v[20:23], v2, s[4:7], s64 offen sc1
    s_add_u32 s64, s25, 0x400
    buffer_load_dwordx4 v[24:27], v2, s[4:7], s64 offen sc1
    s_add_u32 s64, s25, 0x600
    buffer_load_dwordx4 v[28:31], v2, s[4:7], s64 offen sc1
    s_add_u32 s64, s25, 0x800
    buffer_load_dwordx4 v[32:35], v2, s[4:7], s64 offen sc1
    s_add_u32 s64, s25, 0xa00
    buffer_load_dwordx4 v[36:39], v2, s[4:7], s64 offen sc1
    s_add_u32 s64, s25, 0xc00
    buffer_load_dwordx4 v[40:43], v2, s[4:7], s64 offen sc1
    s_add_u32 s64, s25, 0xe00
    buffer_load_dwordx4 v[44:47], v2, s[4:7], s64 offen sc1
    s_add_u32 s64, s25, 0x1000
    buffer_load_dwordx4 v[48:51], v2, s[4:7], s64 offen sc1
    s_add_u32 s64, s25, 0x1200
    buffer_load_dwordx4 v[52:55], v2, s[4:7], s64 offen sc1
    s_add_u32 s64, s30, 0x0
    buffer_load_dwordx4 v[56:59], v2, s[4:7], s64 offen sc1
    s_add_u32 s64, s30, 0x200
    buffer_load_dwordx4 v[60:63], v2, s[4:7], s64 offen sc1
    s_add_u32 s64, s30, 0x400
    buffer_load_dwordx4 v[64:67], v2, s[4:7], s64 offen sc1
    s_add_u32 s64, s30, 0x600
    buffer_load_dwordx4 v[68:71], v2, s[4:7], s64 offen sc1
    s_add_u32 s64, s30, 0x800
    buffer_load_dwordx4 v[72:75], v2, s[4:7], s64 offen sc1
    s_add_u32 s64, s30, 0xa00
    buffer_load_dwordx4 v[76:79], v2, s[4:7], s64 offen sc1
    s_add_u32 s64, s30, 0xc00
    buffer_load_dwordx4 v[80:83], v2, s[4:7], s64 offen sc1
    s_add_u32 s64, s30, 0xe00
    buffer_load_dwordx4 v[84:87], v2, s[4:7], s64 offen sc1
    s_add_u32 s64, s30, 0x1000
    buffer_load_dwordx4 v[88:91], v2, s[4:7], s64 offen sc1
    s_add_u32 s64, s30, 0x1200
    buffer_load_dwordx4 v[92:95], v2, s[4:7], s64 offen sc1
    s_add_u32 s29, s29, 1
    s_waitcnt vmcnt(0)
    v_max3_u32 v4, v19, v23, v27
    v_max3_u32 v4, v4, v31, v35
    v_max3_u32 v4, v4, v39, v43
    v_max3_u32 v4, v4, v47, v51
    v_max3_u32 v4, v4, v55, v59
    v_max3_u32 v4, v4, v63, v67
    v_max3_u32 v4, v4, v71, v75
    v_max3_u32 v4, v4, v79, v83
    v_max3_u32 v4, v4, v87, v91
    v_max_u32 v4, v4, v95
    v_cmp_eq_u32 vcc, -1, v4
    s_cbranch_vccz MKO_131
    s_cmp_gt_u32 s29, 262144
    s_cbranch_scc0 MKR_130
MKO_131:
    v_mfma_f32_16x16x32_bf16 v[8:11], v[96:99], v[16:19], 0
    v_mfma_f32_16x16x32_bf16 v[12:15], v[100:103], v[16:19], 0
    v_mfma_f32_16x16x32_bf16 v[8:11], v[104:107], v[20:23], v[8:11]
    v_mfma_f32_16x16x32_bf16 v[12:15], v[108:111], v[20:23], v[12:15]
    v_mfma_f32_16x16x32_bf16 v[8:11], v[112:115], v[24:27], v[8:11]
    v_mfma_f32_16x16x32_bf16 v[12:15], v[116:119], v[24:27], v[12:15]
    v_mfma_f32_16x16x32_bf16 v[8:11], v[120:123], v[28:31], v[8:11]
    v_mfma_f32_16x16x32_bf16 v[12:15], v[124:127], v[28:31], v[12:15]
    v_mfma_f32_16x16x32_bf16 v[8:11], v[128:131], v[32:35], v[8:11]
    v_mfma_f32_16x16x32_bf16 v[12:15], v[132:135], v[32:35], v[12:15]
    v_mfma_f32_16x16x32_bf16 v[8:11], v[136:139], v[36:39], v[8:11]
    v_mfma_f32_16x16x32_bf16 v[12:15], v[140:143], v[36:39], v[12:15]
    v_mfma_f32_16x16x32_bf16 v[8:11], v[144:147], v[40:43], v[8:11]
    v_mfma_f32_16x16x32_bf16 v[12:15], v[148:151], v[40:43], v[12:15]
    v_mfma_f32_16x16x32_bf16 v[8:11], v[152:155], v[44:47], v[8:11]
    v_mfma_f32_16x16x32_bf16 v[12:15], v[156:159], v[44:47], v[12:15]
    v_mfma_f32_16x16x32_bf16 v[8:11], v[160:163], v[48:51], v[8:11]
    v_mfma_f32_16x16x32_bf16 v[12:15], v[164:167], v[48:51], v[12:15]
    v_mfma_f32_16x16x32_bf16 v[8:11], v[168:171], v[52:55], v[8:11]
    v_mfma_f32_16x16x32_bf16 v[12:15], v[172:175], v[52:55], v[12:15]
    v_mfma_f32_16x16x32_bf16 v[8:11], v[176:179], v[56:59], v[8:11]
    v_mfma_f32_16x16x32_bf16 v[12:15], v[180:183], v[56:59], v[12:15]
    v_mfma_f32_16x16x32_bf16 v[8:11], v[184:187], v[60:63], v[8:11]
    v_mfma_f32_16x16x32_bf16 v[12:15], v[188:191], v[60:63], v[12:15]
    v_mfma_f32_16x16x32_bf16 v[8:11], v[192:195], v[64:67], v[8:11]
    v_mfma_f32_16x16x32_bf16 v[12:15], v[196:199], v[64:67], v[12:15]
    v_mfma_f32_16x16x32_bf16 v[8:11], v[200:203], v[68:71], v[8:11]
    v_mfma_f32_16x16x32_bf16 v[12:15], v[204:207], v[68:71], v[12:15]
    v_mfma_f32_16x16x32_bf16 v[8:11], v[208:211], v[72:75], v[8:11]
    v_mfma_f32_16x16x32_bf16 v[12:15], v[212:215], v[72:75], v[12:15]
    v_mfma_f32_16x16x32_bf16 v[8:11], v[216:219], v[76:79], v[8:11]
    v_mfma_f32_16x16x32_bf16 v[12:15], v[220:223], v[76:79], v[12:15]
    v_mfma_f32_16x16x32_bf16 v[8:11], v[224:227], v[80:83], v[8:11]
    v_mfma_f32_16x16x32_bf16 v[12:15], v[228:231], v[80:83], v[12:15]
    v_mfma_f32_16x16x32_bf16 v[8:11], v[232:235], v[84:87], v[8:11]
    v_mfma_f32_16x16x32_bf16 v[12:15], v[236:239], v[84:87], v[12:15]
    v_mfma_f32_16x16x32_bf16 v[8:11], v[240:243], v[88:91], v[8:11]
    v_mfma_f32_16x16x32_bf16 v[12:15], v[244:247], v[88:91], v[12:15]
    v_mfma_f32_16x16x32_bf16 v[8:11], v[248:251], v[92:95], v[8:11]
    v_mfma_f32_16x16x32_bf16 v[12:15], v[252:255], v[92:95], v[12:15]
    s_nop 7
    v_cvt_pk_bf16_f32 v16, v8, v9
    v_cvt_pk_bf16_f32 v17, v10, v11
    v_cvt_pk_bf16_f32 v18, v12, v13
    v_cvt_pk_bf16_f32 v19, v14, v15
    buffer_store_dwordx4 v[16:19], v3, s[4:7], s26 offen sc1
    s_waitcnt vmcnt(0)
    s_barrier
    s_cmp_lg_u32 s14, 0
    s_cbranch_scc1 GF_132
    v_mov_b32 v7, 1
    v_mov_b32 v8, 0
    s_mov_b64 exec, 1
    buffer_store_dword v7, v8, s[4:7], s27 offen sc1
    s_mov_b64 exec, -1
GF_132:
    s_add_u32 s25, s25, 0x10000
    s_add_u32 s30, s30, 0x10000
    s_add_u32 s26, s26, 0x20000
    s_add_u32 s27, s27, 256
    s_add_u32 s28, s28, 512
    s_add_u32 s24, s24, 1
    s_cmp_lt_u32 s24, 32
    s_cbranch_scc1 MKT_LOOP
    s_cmp_ge_u32 s88, 60
    s_cbranch_scc1 M_EXIT
    s_branch H_EXTRA
G_N:
    v_lshrrev_b32 v6, 5, v0
    v_mul_u32_u24 v7, 40960, v6
    v_bfe_u32 v6, v0, 4, 1
    v_lshl_add_u32 v7, v6, 11, v7
    v_lshlrev_b32 v8, 3, v6
    v_bfe_u32 v6, v0, 2, 2
    v_lshl_add_u32 v7, v6, 8, v7
    v_lshl_add_u32 v8, v6, 1, v8
    v_and_b32 v6, 1, v0
    v_lshl_add_u32 v7, v6, 3, v7
    v_bfe_u32 v6, v0, 1, 1
    s_lshl_b32 s64, s14, 2
    v_add_u32 v10, s64, v6
    v_add_u32 v6, 0, v10
    v_xor_b32 v6, v6, v8
    v_lshl_add_u32 v3, v6, 4, v7
    v_add_u32 v4, 81920, v3
    v_add_u32 v6, 2, v10
    v_xor_b32 v6, v6, v8
    v_lshl_add_u32 v5, v6, 4, v7
    v_add_u32 v9, 81920, v5
    s_waitcnt vmcnt(0)
    s_barrier
    ds_read_b64_tr_b16 v[96:97], v3 offset:0
    ds_read_b64_tr_b16 v[98:99], v3 offset:1024
    ds_read_b64_tr_b16 v[100:101], v5 offset:0
    ds_read_b64_tr_b16 v[102:103], v5 offset:1024
    ds_read_b64_tr_b16 v[104:105], v4 offset:0
    ds_read_b64_tr_b16 v[106:107], v4 offset:1024
    ds_read_b64_tr_b16 v[108:109], v9 offset:0
    ds_read_b64_tr_b16 v[110:111], v9 offset:1024
    ds_read_b64_tr_b16 v[112:113], v3 offset:4096
    ds_read_b64_tr_b16 v[114:115], v3 offset:5120
    ds_read_b64_tr_b16 v[116:117], v5 offset:4096
    ds_read_b64_tr_b16 v[118:119], v5 offset:5120
    ds_read_b64_tr_b16 v[120:121], v4 offset:4096
    ds_read_b64_tr_b16 v[122:123], v4 offset:5120
    ds_read_b64_tr_b16 v[124:125], v9 offset:4096
    ds_read_b64_tr_b16 v[126:127], v9 offset:5120
    s_waitcnt lgkmcnt(4)
    ds_read_b64_tr_b16 v[128:129], v3 offset:8192
    ds_read_b64_tr_b16 v[130:131], v3 offset:9216
    ds_read_b64_tr_b16 v[132:133], v5 offset:8192
    ds_read_b64_tr_b16 v[134:135], v5 offset:9216
    ds_read_b64_tr_b16 v[136:137], v4 offset:8192
    ds_read_b64_tr_b16 v[138:139], v4 offset:9216
    ds_read_b64_tr_b16 v[140:141], v9 offset:8192
    ds_read_b64_tr_b16 v[142:143], v9 offset:9216
    ds_read_b64_tr_b16 v[144:145], v3 offset:12288
    ds_read_b64_tr_b16 v[146:147], v3 offset:13312
    ds_read_b64_tr_b16 v[148:149], v5 offset:12288
    ds_read_b64_tr_b16 v[150:151], v5 offset:13312
    ds_read_b64_tr_b16 v[152:153], v4 offset:12288
    ds_read_b64_tr_b16 v[154:155], v4 offset:13312
    ds_read_b64_tr_b16 v[156:157], v9 offset:12288
    ds_read_b64_tr_b16 v[158:159], v9 offset:13312
    s_waitcnt lgkmcnt(4)
    ds_read_b64_tr_b16 v[160:161], v3 offset:16384
    ds_read_b64_tr_b16 v[162:163], v3 offset:17408
    ds_read_b64_tr_b16 v[164:165], v5 offset:16384
    ds_read_b64_tr_b16 v[166:167], v5 offset:17408
    ds_read_b64_tr_b16 v[168:169], v4 offset:16384
    ds_read_b64_tr_b16 v[170:171], v4 offset:17408
    ds_read_b64_tr_b16 v[172:173], v9 offset:16384
    ds_read_b64_tr_b16 v[174:175], v9 offset:17408
    ds_read_b64_tr_b16 v[176:177], v3 offset:20480
    ds_read_b64_tr_b16 v[178:179], v3 offset:21504
    ds_read_b64_tr_b16 v[180:181], v5 offset:20480
    ds_read_b64_tr_b16 v[182:183], v5 offset:21504
    ds_read_b64_tr_b16 v[184:185], v4 offset:20480
    ds_read_b64_tr_b16 v[186:187], v4 offset:21504
    ds_read_b64_tr_b16 v[188:189], v9 offset:20480
    ds_read_b64_tr_b16 v[190:191], v9 offset:21504
    s_waitcnt lgkmcnt(4)
    ds_read_b64_tr_b16 v[192:193], v3 offset:24576
    ds_read_b64_tr_b16 v[194:195], v3 offset:25600
    ds_read_b64_tr_b16 v[196:197], v5 offset:24576
    ds_read_b64_tr_b16 v[198:199], v5 offset:25600
    ds_read_b64_tr_b16 v[200:201], v4 offset:24576
    ds_read_b64_tr_b16 v[202:203], v4 offset:25600
    ds_read_b64_tr_b16 v[204:205], v9 offset:24576
    ds_read_b64_tr_b16 v[206:207], v9 offset:25600
    ds_read_b64_tr_b16 v[208:209], v3 offset:28672
    ds_read_b64_tr_b16 v[210:211], v3 offset:29696
    ds_read_b64_tr_b16 v[212:213], v5 offset:28672
    ds_read_b64_tr_b16 v[214:215], v5 offset:29696
    ds_read_b64_tr_b16 v[216:217], v4 offset:28672
    ds_read_b64_tr_b16 v[218:219], v4 offset:29696
    ds_read_b64_tr_b16 v[220:221], v9 offset:28672
    ds_read_b64_tr_b16 v[222:223], v9 offset:29696
    s_waitcnt lgkmcnt(4)
    ds_read_b64_tr_b16 v[224:225], v3 offset:32768
    ds_read_b64_tr_b16 v[226:227], v3 offset:33792
    ds_read_b64_tr_b16 v[228:229], v5 offset:32768
    ds_read_b64_tr_b16 v[230:231], v5 offset:33792
    ds_read_b64_tr_b16 v[232:233], v4 offset:32768
    ds_read_b64_tr_b16 v[234:235], v4 offset:33792
    ds_read_b64_tr_b16 v[236:237], v9 offset:32768
    ds_read_b64_tr_b16 v[238:239], v9 offset:33792
    ds_read_b64_tr_b16 v[240:241], v3 offset:36864
    ds_read_b64_tr_b16 v[242:243], v3 offset:37888
    ds_read_b64_tr_b16 v[244:245], v5 offset:36864
    ds_read_b64_tr_b16 v[246:247], v5 offset:37888
    ds_read_b64_tr_b16 v[248:249], v4 offset:36864
    ds_read_b64_tr_b16 v[250:251], v4 offset:37888
    ds_read_b64_tr_b16 v[252:253], v9 offset:36864
    ds_read_b64_tr_b16 v[254:255], v9 offset:37888
    s_waitcnt lgkmcnt(0)
    s_cmp_lg_u32 s97, 0
    s_cbranch_scc1 CM_133
    v_mbcnt_lo_u32_b32 v0, -1, 0
    v_mbcnt_hi_u32_b32 v0, -1, v0
    v_mul_u32_u24 v8, 32, v0
    s_mov_b32 s64, 0x0
    s_mov_b32 s65, 0
    s_mov_b64 exec, 0xff
TK_134:
    buffer_load_dword v9, v8, s[60:63], s64 offen sc1
    s_add_u32 s65, s65, 1
    s_waitcnt vmcnt(0)
    s_mov_b32 s66, 0
    v_readlane_b32 s67, v9, 0
    s_add_u32 s66, s66, s67
    v_readlane_b32 s67, v9, 1
    s_add_u32 s66, s66, s67
    v_readlane_b32 s67, v9, 2
    s_add_u32 s66, s66, s67
    v_readlane_b32 s67, v9, 3
    s_add_u32 s66, s66, s67
    v_readlane_b32 s67, v9, 4
    s_add_u32 s66, s66, s67
    v_readlane_b32 s67, v9, 5
    s_add_u32 s66, s66, s67
    v_readlane_b32 s67, v9, 6
    s_add_u32 s66, s66, s67
    v_readlane_b32 s67, v9, 7
    s_add_u32 s66, s66, s67
    s_cmp_ge_u32 s66, 256
    s_cbranch_scc1 TKD_135
    s_cmp_gt_u32 s65, 262144
    s_cbranch_scc0 TK_134
TKD_135:
    v_cmp_ne_u32 vcc, 32, v9
    s_mov_b64 exec, -1
    s_cbranch_vccnz M_SLOW
CM_133:
    s_mov_b32 s65, 0
GI_136:
    buffer_load_dword v8, off, s[60:63], s95 sc1
    s_add_u32 s65, s65, 1
    s_waitcnt vmcnt(0)
    v_readfirstlane_b32 s64, v8
    s_cmp_ge_u32 s64, 186
    s_cbranch_scc1 GID_137
    s_cmp_gt_u32 s65, 65536
    s_cbranch_scc1 GID_137
    s_sleep 4
    s_branch GI_136
GID_137:
    v_mbcnt_lo_u32_b32 v0, -1, 0
    v_mbcnt_hi_u32_b32 v0, -1, v0
    s_mov_b32 s65, 0
CW_138:
    buffer_load_dwordx2 v[8:9], off, s[60:63], 0 offset:132 sc1
    s_add_u32 s65, s65, 1
    s_waitcnt vmcnt(0)
    v_readfirstlane_b32 s30, v8
    v_readfirstlane_b32 s31, v9
    s_min_u32 s64, s30, s31
    s_cmp_lg_u32 s64, 0
    s_cbranch_scc1 CWD_139
    s_cmp_gt_u32 s65, 65536
    s_cbranch_scc1 CWD_139
    s_sleep 4
    s_branch CW_138
CWD_139:
    s_sub_u32 s30, s30, 1
    s_and_b32 s30, s30, 3
    s_sub_u32 s31, s31, 1
    s_and_b32 s31, s31, 3
    s_lshl_b32 s34, s96, 2
    s_add_u32 s34, s34, s14
    s_lshl_b32 s34, s34, 6
    v_add_u32 v5, s34, v0
    v_lshlrev_b32 v3, 4, v0
    v_mov_b32 v40, -1
    v_mov_b32 v41, -1
    v_mov_b32 v42, -1
    v_mov_b32 v43, -1
    v_lshrrev_b32 v7, 6, v5
    v_mul_u32_u24 v7, 52429, v7
    v_lshrrev_b32 v7, 18, v7
    v_mul_u32_u24 v8, 320, v7
    v_sub_u32 v8, v5, v8
    v_lshlrev_b32 v48, 4, v8
    s_lshl_b32 s30, s30, 13
    s_lshl_b32 s31, s31, 13
    s_add_u32 s31, s31, 0x200000
    v_and_b32 v8, 1, v7
    v_cmp_eq_u32 vcc, 1, v8
    v_mov_b32 v8, s30
    v_mov_b32 v9, s31
    v_cndmask_b32 v8, v8, v9, vcc
    v_lshrrev_b32 v9, 1, v7
    v_lshl_add_u32 v8, v9, 15, v8
    v_add_u32 v49, v8, v48
    v_cmp_le_u32 vcc, 640, v5
    v_mov_b32 v9, 0x40000000
    s_nop 0
    v_cndmask_b32 v49, v9, v49, vcc
    v_cmp_gt_u32 vcc, 0xa000, v5
    s_nop 0
    s_and_saveexec_b64 s[38:39], vcc
    s_cbranch_execz INF_140
    s_mov_b32 s35, 0x6000000
    buffer_store_dwordx4 v[40:43], v49, s[4:7], s35 offen sc1
INF_140:
    s_mov_b64 exec, s[38:39]
    s_cmp_ge_u32 s96, 10
    s_cbranch_scc1 INM2_141
    s_cmp_lg_u32 s14, 1
    s_cbranch_scc1 INM2_141
    s_cmp_ge_u32 s96, 5
    s_cselect_b32 s36, 1, 0
    s_mul_i32 s34, s36, 5
    s_sub_u32 s34, s96, s34
    s_lshl_b32 s34, s34, 10
    s_cmp_eq_u32 s36, 0
    s_cselect_b32 s37, s30, s31
    s_add_u32 s37, s37, 0x6000000
    s_add_u32 s37, s37, s34
    buffer_store_dwordx4 v[34:37], v3, s[4:7], s37 offen sc1
INM2_141:
    v_lshlrev_b32 v1, 4, v0
    v_lshrrev_b32 v6, 3, v0
    v_mul_u32_u24 v2, 1280, v6
    v_and_b32 v7, 7, v0
    v_xor_b32 v7, v7, v6
    v_lshl_add_u32 v2, v7, 4, v2
    v_bfe_u32 v6, v0, 3, 1
    v_lshlrev_b32 v9, 10, v6
    v_and_b32 v6, 7, v0
    v_lshl_add_u32 v9, v6, 7, v9
    v_lshrrev_b32 v7, 4, v0
    v_xor_b32 v7, v7, v6
    v_lshl_add_u32 v3, v7, 4, v9
    v_xor_b32 v7, 4, v7
    v_lshl_add_u32 v4, v7, 4, v9
    v_add_u32 v6, 0x10000, v3
    v_add_u32 v9, 0x10000, v4
    s_barrier
    s_mul_i32 s20, s12, 163840
    s_mul_i32 s64, s14, 40960
    s_add_u32 s20, s20, s64
    s_add_u32 s20, s20, 0x0
    s_lshl_b32 s21, s14, 12
    s_add_u32 m0, s21, 0
    s_add_u32 s64, s20, 0x0
    buffer_load_dwordx4 v2, s[4:7], s64 offen lds
    s_add_u32 m0, s21, 1024
    s_add_u32 s64, s20, 0x2800
    buffer_load_dwordx4 v2, s[4:7], s64 offen lds
    s_add_u32 m0, s21, 2048
    s_add_u32 s64, s20, 0x5000
    buffer_load_dwordx4 v2, s[4:7], s64 offen lds
    s_add_u32 m0, s21, 3072
    s_add_u32 s64, s20, 0x7800
    buffer_load_dwordx4 v2, s[4:7], s64 offen lds
    s_add_u32 m0, s21, 16384
    s_add_u32 s64, s20, 0x80
    buffer_load_dwordx4 v2, s[4:7], s64 offen lds
    s_add_u32 m0, s21, 17408
    s_add_u32 s64, s20, 0x2880
    buffer_load_dwordx4 v2, s[4:7], s64 offen lds
    s_add_u32 m0, s21, 18432
    s_add_u32 s64, s20, 0x5080
    buffer_load_dwordx4 v2, s[4:7], s64 offen lds
    s_add_u32 m0, s21, 19456
    s_add_u32 s64, s20, 0x7880
    buffer_load_dwordx4 v2, s[4:7], s64 offen lds
    s_add_u32 m0, s21, 32768
    s_add_u32 s64, s20, 0x100
    buffer_load_dwordx4 v2, s[4:7], s64 offen lds
    s_add_u32 m0, s21, 33792
    s_add_u32 s64, s20, 0x2900
    buffer_load_dwordx4 v2, s[4:7], s64 offen lds
    s_add_u32 m0, s21, 34816
    s_add_u32 s64, s20, 0x5100
    buffer_load_dwordx4 v2, s[4:7], s64 offen lds
    s_add_u32 m0, s21, 35840
    s_add_u32 s64, s20, 0x7900
    buffer_load_dwordx4 v2, s[4:7], s64 offen lds
    s_add_u32 m0, s21, 49152
    s_add_u32 s64, s20, 0x180
    buffer_load_dwordx4 v2, s[4:7], s64 offen lds
    s_add_u32 m0, s21, 50176
    s_add_u32 s64, s20, 0x2980
    buffer_load_dwordx4 v2, s[4:7], s64 offen lds
    s_add_u32 m0, s21, 51200
    s_add_u32 s64, s20, 0x5180
    buffer_load_dwordx4 v2, s[4:7], s64 offen lds
    s_add_u32 m0, s21, 52224
    s_add_u32 s64, s20, 0x7980
    buffer_load_dwordx4 v2, s[4:7], s64 offen lds
    s_mov_b32 s64, 0x40000000
    buffer_store_dword v7, v1, s[4:7], s64 offen
    buffer_store_dword v7, v1, s[4:7], s64 offen
    buffer_store_dword v7, v1, s[4:7], s64 offen
    buffer_store_dword v7, v1, s[4:7], s64 offen
    buffer_store_dword v7, v1, s[4:7], s64 offen
    buffer_store_dword v7, v1, s[4:7], s64 offen
    buffer_store_dword v7, v1, s[4:7], s64 offen
    buffer_store_dword v7, v1, s[4:7], s64 offen
    s_waitcnt vmcnt(20)
    s_barrier
    ds_read_b128 a[0:3], v3 offset:0
    ds_read_b128 a[4:7], v3 offset:2048
    ds_read_b128 a[8:11], v3 offset:4096
    ds_read_b128 a[12:15], v3 offset:6144
    ds_read_b128 a[16:19], v3 offset:8192
    ds_read_b128 a[20:23], v3 offset:10240
    ds_read_b128 a[24:27], v3 offset:12288
    ds_read_b128 a[28:31], v3 offset:14336
    s_mov_b32 s19, 0
    s_mov_b32 s22, s16
    s_mov_b32 s23, 0x40000000
G_N_LOOP:
    s_waitcnt lgkmcnt(4)
    v_mfma_f32_16x16x32_bf16 v[16:19], a[0:3], v[96:99], 0
    v_mfma_f32_16x16x32_bf16 v[20:23], a[0:3], v[100:103], 0
    ds_read_b128 a[32:35], v4 offset:0
    v_mfma_f32_16x16x32_bf16 v[24:27], a[4:7], v[96:99], 0
    v_mfma_f32_16x16x32_bf16 v[28:31], a[4:7], v[100:103], 0
    ds_read_b128 a[36:39], v4 offset:2048
    v_mfma_f32_16x16x32_bf16 v[32:35], a[8:11], v[96:99], 0
    v_mfma_f32_16x16x32_bf16 v[36:39], a[8:11], v[100:103], 0
    ds_read_b128 a[40:43], v4 offset:4096
    v_mfma_f32_16x16x32_bf16 v[40:43], a[12:15], v[96:99], 0
    v_mfma_f32_16x16x32_bf16 v[44:47], a[12:15], v[100:103], 0
    ds_read_b128 a[44:47], v4 offset:6144
    s_waitcnt lgkmcnt(4)
    v_mfma_f32_16x16x32_bf16 v[48:51], a[16:19], v[96:99], 0
    v_mfma_f32_16x16x32_bf16 v[52:55], a[16:19], v[100:103], 0
    ds_read_b128 a[48:51], v4 offset:8192
    v_mfma_f32_16x16x32_bf16 v[56:59], a[20:23], v[96:99], 0
    v_mfma_f32_16x16x32_bf16 v[60:63], a[20:23], v[100:103], 0
    ds_read_b128 a[52:55], v4 offset:10240
    v_mfma_f32_16x16x32_bf16 v[64:67], a[24:27], v[96:99], 0
    v_mfma_f32_16x16x32_bf16 v[68:71], a[24:27], v[100:103], 0
    ds_read_b128 a[56:59], v4 offset:12288
    v_mfma_f32_16x16x32_bf16 v[72:75], a[28:31], v[96:99], 0
    v_mfma_f32_16x16x32_bf16 v[76:79], a[28:31], v[100:103], 0
    ds_read_b128 a[60:63], v4 offset:14336
    s_waitcnt vmcnt(16)
    s_barrier
    s_waitcnt lgkmcnt(4)
    v_mfma_f32_16x16x32_bf16 v[16:19], a[32:35], v[104:107], v[16:19]
    v_mfma_f32_16x16x32_bf16 v[20:23], a[32:35], v[108:111], v[20:23]
    ds_read_b128 a[0:3], v3 offset:16384
    s_add_u32 m0, s21, 65536
    v_mfma_f32_16x16x32_bf16 v[24:27], a[36:39], v[104:107], v[24:27]
    v_mfma_f32_16x16x32_bf16 v[28:31], a[36:39], v[108:111], v[28:31]
    ds_read_b128 a[4:7], v3 offset:18432
    s_add_u32 s64, s20, 0x200
    buffer_load_dwordx4 v2, s[4:7], s64 offen lds
    v_mfma_f32_16x16x32_bf16 v[32:35], a[40:43], v[104:107], v[32:35]
    v_mfma_f32_16x16x32_bf16 v[36:39], a[40:43], v[108:111], v[36:39]
    ds_read_b128 a[8:11], v3 offset:20480
    s_add_u32 m0, s21, 66560
    v_mfma_f32_16x16x32_bf16 v[40:43], a[44:47], v[104:107], v[40:43]
    v_mfma_f32_16x16x32_bf16 v[44:47], a[44:47], v[108:111], v[44:47]
    ds_read_b128 a[12:15], v3 offset:22528
    s_add_u32 s64, s20, 0x2a00
    buffer_load_dwordx4 v2, s[4:7], s64 offen lds
    s_waitcnt lgkmcnt(4)
    v_mfma_f32_16x16x32_bf16 v[48:51], a[48:51], v[104:107], v[48:51]
    v_mfma_f32_16x16x32_bf16 v[52:55], a[48:51], v[108:111], v[52:55]
    ds_read_b128 a[16:19], v3 offset:24576
    s_add_u32 m0, s21, 67584
    v_mfma_f32_16x16x32_bf16 v[56:59], a[52:55], v[104:107], v[56:59]
    v_mfma_f32_16x16x32_bf16 v[60:63], a[52:55], v[108:111], v[60:63]
    ds_read_b128 a[20:23], v3 offset:26624
    s_add_u32 s64, s20, 0x5200
    buffer_load_dwordx4 v2, s[4:7], s64 offen lds
    v_mfma_f32_16x16x32_bf16 v[64:67], a[56:59], v[104:107], v[64:67]
    v_mfma_f32_16x16x32_bf16 v[68:71], a[56:59], v[108:111], v[68:71]
    ds_read_b128 a[24:27], v3 offset:28672
    s_add_u32 m0, s21, 68608
    v_mfma_f32_16x16x32_bf16 v[72:75], a[60:63], v[104:107], v[72:75]
    v_mfma_f32_16x16x32_bf16 v[76:79], a[60:63], v[108:111], v[76:79]
    ds_read_b128 a[28:31], v3 offset:30720
    s_add_u32 s64, s20, 0x7a00
    buffer_load_dwordx4 v2, s[4:7], s64 offen lds
    s_waitcnt lgkmcnt(4)
    v_mfma_f32_16x16x32_bf16 v[16:19], a[0:3], v[112:115], v[16:19]
    v_mfma_f32_16x16x32_bf16 v[20:23], a[0:3], v[116:119], v[20:23]
    ds_read_b128 a[32:35], v4 offset:16384
    v_mfma_f32_16x16x32_bf16 v[24:27], a[4:7], v[112:115], v[24:27]
    v_mfma_f32_16x16x32_bf16 v[28:31], a[4:7], v[116:119], v[28:31]
    ds_read_b128 a[36:39], v4 offset:18432
    v_mfma_f32_16x16x32_bf16 v[32:35], a[8:11], v[112:115], v[32:35]
    v_mfma_f32_16x16x32_bf16 v[36:39], a[8:11], v[116:119], v[36:39]
    ds_read_b128 a[40:43], v4 offset:20480
    v_mfma_f32_16x16x32_bf16 v[40:43], a[12:15], v[112:115], v[40:43]
    v_mfma_f32_16x16x32_bf16 v[44:47], a[12:15], v[116:119], v[44:47]
    ds_read_b128 a[44:47], v4 offset:22528
    s_waitcnt lgkmcnt(4)
    v_mfma_f32_16x16x32_bf16 v[48:51], a[16:19], v[112:115], v[48:51]
    v_mfma_f32_16x16x32_bf16 v[52:55], a[16:19], v[116:119], v[52:55]
    ds_read_b128 a[48:51], v4 offset:24576
    v_mfma_f32_16x16x32_bf16 v[56:59], a[20:23], v[112:115], v[56:59]
    v_mfma_f32_16x16x32_bf16 v[60:63], a[20:23], v[116:119], v[60:63]
    ds_read_b128 a[52:55], v4 offset:26624
    v_mfma_f32_16x16x32_bf16 v[64:67], a[24:27], v[112:115], v[64:67]
    v_mfma_f32_16x16x32_bf16 v[68:71], a[24:27], v[116:119], v[68:71]
    ds_read_b128 a[56:59], v4 offset:28672
    v_mfma_f32_16x16x32_bf16 v[72:75], a[28:31], v[112:115], v[72:75]
    v_mfma_f32_16x16x32_bf16 v[76:79], a[28:31], v[116:119], v[76:79]
    ds_read_b128 a[60:63], v4 offset:30720
    s_waitcnt vmcnt(16)
    s_barrier
    s_cmp_lg_u32 s19, 0
    s_cbranch_scc1 GFD_142
    s_cmp_lg_u32 s14, 0
    s_cbranch_scc1 INE_143
    s_cmp_lg_u32 s96, 10
    s_cbranch_scc1 ING_144
    v_mov_b32 v7, 1
    v_lshlrev_b32 v8, 7, v0
    s_mov_b32 s65, 0x29a000
    s_mov_b64 exec, 3
    buffer_store_dword v7, v8, s[4:7], s65 offen sc1
    s_mov_b64 exec, -1
    s_waitcnt vmcnt(0)
ING_144:
    v_mov_b32 v8, 1
    s_mov_b32 s65, 0x290800
    s_mov_b64 exec, 1
    buffer_atomic_add v8, off, s[4:7], s65 sc1
    s_mov_b64 exec, -1
INE_143:
GFD_142:
    s_waitcnt lgkmcnt(4)
    v_mfma_f32_16x16x32_bf16 v[16:19], a[32:35], v[120:123], v[16:19]
    v_mfma_f32_16x16x32_bf16 v[20:23], a[32:35], v[124:127], v[20:23]
    ds_read_b128 a[0:3], v3 offset:32768
    s_add_u32 m0, s21, 0
    v_mfma_f32_16x16x32_bf16 v[24:27], a[36:39], v[120:123], v[24:27]
    v_mfma_f32_16x16x32_bf16 v[28:31], a[36:39], v[124:127], v[28:31]
    ds_read_b128 a[4:7], v3 offset:34816
    s_add_u32 s64, s20, 0x280
    buffer_load_dwordx4 v2, s[4:7], s64 offen lds
    v_mfma_f32_16x16x32_bf16 v[32:35], a[40:43], v[120:123], v[32:35]
    v_mfma_f32_16x16x32_bf16 v[36:39], a[40:43], v[124:127], v[36:39]
    ds_read_b128 a[8:11], v3 offset:36864
    s_add_u32 m0, s21, 1024
    v_mfma_f32_16x16x32_bf16 v[40:43], a[44:47], v[120:123], v[40:43]
    v_mfma_f32_16x16x32_bf16 v[44:47], a[44:47], v[124:127], v[44:47]
    ds_read_b128 a[12:15], v3 offset:38912
    s_add_u32 s64, s20, 0x2a80
    buffer_load_dwordx4 v2, s[4:7], s64 offen lds
    s_waitcnt lgkmcnt(4)
    v_mfma_f32_16x16x32_bf16 v[48:51], a[48:51], v[120:123], v[48:51]
    v_mfma_f32_16x16x32_bf16 v[52:55], a[48:51], v[124:127], v[52:55]
    ds_read_b128 a[16:19], v3 offset:40960
    s_add_u32 m0, s21, 2048
    v_mfma_f32_16x16x32_bf16 v[56:59], a[52:55], v[120:123], v[56:59]
    v_mfma_f32_16x16x32_bf16 v[60:63], a[52:55], v[124:127], v[60:63]
    ds_read_b128 a[20:23], v3 offset:43008
    s_add_u32 s64, s20, 0x5280
    buffer_load_dwordx4 v2, s[4:7], s64 offen lds
    v_mfma_f32_16x16x32_bf16 v[64:67], a[56:59], v[120:123], v[64:67]
    v_mfma_f32_16x16x32_bf16 v[68:71], a[56:59], v[124:127], v[68:71]
    ds_read_b128 a[24:27], v3 offset:45056
    s_add_u32 m0, s21, 3072
    v_mfma_f32_16x16x32_bf16 v[72:75], a[60:63], v[120:123], v[72:75]
    v_mfma_f32_16x16x32_bf16 v[76:79], a[60:63], v[124:127], v[76:79]
    ds_read_b128 a[28:31], v3 offset:47104
    s_add_u32 s64, s20, 0x7a80
    buffer_load_dwordx4 v2, s[4:7], s64 offen lds
    s_waitcnt lgkmcnt(4)
    v_mfma_f32_16x16x32_bf16 v[16:19], a[0:3], v[128:131], v[16:19]
    v_mfma_f32_16x16x32_bf16 v[20:23], a[0:3], v[132:135], v[20:23]
    ds_read_b128 a[32:35], v4 offset:32768
    v_mfma_f32_16x16x32_bf16 v[24:27], a[4:7], v[128:131], v[24:27]
    v_mfma_f32_16x16x32_bf16 v[28:31], a[4:7], v[132:135], v[28:31]
    ds_read_b128 a[36:39], v4 offset:34816
    v_mfma_f32_16x16x32_bf16 v[32:35], a[8:11], v[128:131], v[32:35]
    v_mfma_f32_16x16x32_bf16 v[36:39], a[8:11], v[132:135], v[36:39]
    ds_read_b128 a[40:43], v4 offset:36864
    v_mfma_f32_16x16x32_bf16 v[40:43], a[12:15], v[128:131], v[40:43]
    v_mfma_f32_16x16x32_bf16 v[44:47], a[12:15], v[132:135], v[44:47]
    ds_read_b128 a[44:47], v4 offset:38912
    s_waitcnt lgkmcnt(4)
    v_mfma_f32_16x16x32_bf16 v[48:51], a[16:19], v[128:131], v[48:51]
    v_mfma_f32_16x16x32_bf16 v[52:55], a[16:19], v[132:135], v[52:55]
    ds_read_b128 a[48:51], v4 offset:40960
    v_mfma_f32_16x16x32_bf16 v[56:59], a[20:23], v[128:131], v[56:59]
    v_mfma_f32_16x16x32_bf16 v[60:63], a[20:23], v[132:135], v[60:63]
    ds_read_b128 a[52:55], v4 offset:43008
    v_mfma_f32_16x16x32_bf16 v[64:67], a[24:27], v[128:131], v[64:67]
    v_mfma_f32_16x16x32_bf16 v[68:71], a[24:27], v[132:135], v[68:71]
    ds_read_b128 a[56:59], v4 offset:45056
    v_mfma_f32_16x16x32_bf16 v[72:75], a[28:31], v[128:131], v[72:75]
    v_mfma_f32_16x16x32_bf16 v[76:79], a[28:31], v[132:135], v[76:79]
    ds_read_b128 a[60:63], v4 offset:47104
    s_waitcnt vmcnt(16)
    s_barrier
    s_waitcnt lgkmcnt(4)
    v_mfma_f32_16x16x32_bf16 v[16:19], a[32:35], v[136:139], v[16:19]
    v_mfma_f32_16x16x32_bf16 v[20:23], a[32:35], v[140:143], v[20:23]
    ds_read_b128 a[0:3], v3 offset:49152
    s_add_u32 m0, s21, 16384
    v_mfma_f32_16x16x32_bf16 v[24:27], a[36:39], v[136:139], v[24:27]
    v_mfma_f32_16x16x32_bf16 v[28:31], a[36:39], v[140:143], v[28:31]
    ds_read_b128 a[4:7], v3 offset:51200
    s_add_u32 s64, s20, 0x300
    buffer_load_dwordx4 v2, s[4:7], s64 offen lds
    v_mfma_f32_16x16x32_bf16 v[32:35], a[40:43], v[136:139], v[32:35]
    v_mfma_f32_16x16x32_bf16 v[36:39], a[40:43], v[140:143], v[36:39]
    ds_read_b128 a[8:11], v3 offset:53248
    s_add_u32 m0, s21, 17408
    v_mfma_f32_16x16x32_bf16 v[40:43], a[44:47], v[136:139], v[40:43]
    v_mfma_f32_16x16x32_bf16 v[44:47], a[44:47], v[140:143], v[44:47]
    ds_read_b128 a[12:15], v3 offset:55296
    s_add_u32 s64, s20, 0x2b00
    buffer_load_dwordx4 v2, s[4:7], s64 offen lds
    s_waitcnt lgkmcnt(4)
    v_mfma_f32_16x16x32_bf16 v[48:51], a[48:51], v[136:139], v[48:51]
    v_mfma_f32_16x16x32_bf16 v[52:55], a[48:51], v[140:143], v[52:55]
    ds_read_b128 a[16:19], v3 offset:57344
    s_add_u32 m0, s21, 18432
    v_mfma_f32_16x16x32_bf16 v[56:59], a[52:55], v[136:139], v[56:59]
    v_mfma_f32_16x16x32_bf16 v[60:63], a[52:55], v[140:143], v[60:63]
    ds_read_b128 a[20:23], v3 offset:59392
    s_add_u32 s64, s20, 0x5300
    buffer_load_dwordx4 v2, s[4:7], s64 offen lds
    v_mfma_f32_16x16x32_bf16 v[64:67], a[56:59], v[136:139], v[64:67]
    v_mfma_f32_16x16x32_bf16 v[68:71], a[56:59], v[140:143], v[68:71]
    ds_read_b128 a[24:27], v3 offset:61440
    s_add_u32 m0, s21, 19456
    v_mfma_f32_16x16x32_bf16 v[72:75], a[60:63], v[136:139], v[72:75]
    v_mfma_f32_16x16x32_bf16 v[76:79], a[60:63], v[140:143], v[76:79]
    ds_read_b128 a[28:31], v3 offset:63488
    s_add_u32 s64, s20, 0x7b00
    buffer_load_dwordx4 v2, s[4:7], s64 offen lds
    s_waitcnt lgkmcnt(4)
    v_mfma_f32_16x16x32_bf16 v[16:19], a[0:3], v[144:147], v[16:19]
    v_mfma_f32_16x16x32_bf16 v[20:23], a[0:3], v[148:151], v[20:23]
    ds_read_b128 a[32:35], v4 offset:49152
    v_mfma_f32_16x16x32_bf16 v[24:27], a[4:7], v[144:147], v[24:27]
    v_mfma_f32_16x16x32_bf16 v[28:31], a[4:7], v[148:151], v[28:31]
    ds_read_b128 a[36:39], v4 offset:51200
    v_mfma_f32_16x16x32_bf16 v[32:35], a[8:11], v[144:147], v[32:35]
    v_mfma_f32_16x16x32_bf16 v[36:39], a[8:11], v[148:151], v[36:39]
    ds_read_b128 a[40:43], v4 offset:53248
    v_mfma_f32_16x16x32_bf16 v[40:43], a[12:15], v[144:147], v[40:43]
    v_mfma_f32_16x16x32_bf16 v[44:47], a[12:15], v[148:151], v[44:47]
    ds_read_b128 a[44:47], v4 offset:55296
    s_waitcnt lgkmcnt(4)
    v_mfma_f32_16x16x32_bf16 v[48:51], a[16:19], v[144:147], v[48:51]
    v_mfma_f32_16x16x32_bf16 v[52:55], a[16:19], v[148:151], v[52:55]
    ds_read_b128 a[48:51], v4 offset:57344
    v_mfma_f32_16x16x32_bf16 v[56:59], a[20:23], v[144:147], v[56:59]
    v_mfma_f32_16x16x32_bf16 v[60:63], a[20:23], v[148:151], v[60:63]
    ds_read_b128 a[52:55], v4 offset:59392
    v_mfma_f32_16x16x32_bf16 v[64:67], a[24:27], v[144:147], v[64:67]
    v_mfma_f32_16x16x32_bf16 v[68:71], a[24:27], v[148:151], v[68:71]
    ds_read_b128 a[56:59], v4 offset:61440
    v_mfma_f32_16x16x32_bf16 v[72:75], a[28:31], v[144:147], v[72:75]
    v_mfma_f32_16x16x32_bf16 v[76:79], a[28:31], v[148:151], v[76:79]
    ds_read_b128 a[60:63], v4 offset:63488
    s_waitcnt vmcnt(8)
    s_barrier
    s_cmp_lg_u32 s14, 0
    s_cbranch_scc1 GF_145
    v_mov_b32 v7, 1
    v_mov_b32 v8, 0
    s_mov_b64 exec, 1
    buffer_store_dword v7, v8, s[4:7], s23 offen sc1
    s_mov_b64 exec, -1
GF_145:
    s_waitcnt lgkmcnt(4)
    v_mfma_f32_16x16x32_bf16 v[16:19], a[32:35], v[152:155], v[16:19]
    v_mfma_f32_16x16x32_bf16 v[20:23], a[32:35], v[156:159], v[20:23]
    ds_read_b128 a[0:3], v6 offset:0
    s_add_u32 m0, s21, 32768
    v_mfma_f32_16x16x32_bf16 v[24:27], a[36:39], v[152:155], v[24:27]
    v_mfma_f32_16x16x32_bf16 v[28:31], a[36:39], v[156:159], v[28:31]
    ds_read_b128 a[4:7], v6 offset:2048
    s_add_u32 s64, s20, 0x380
    buffer_load_dwordx4 v2, s[4:7], s64 offen lds
    v_mfma_f32_16x16x32_bf16 v[32:35], a[40:43], v[152:155], v[32:35]
    v_mfma_f32_16x16x32_bf16 v[36:39], a[40:43], v[156:159], v[36:39]
    ds_read_b128 a[8:11], v6 offset:4096
    s_add_u32 m0, s21, 33792
    v_mfma_f32_16x16x32_bf16 v[40:43], a[44:47], v[152:155], v[40:43]
    v_mfma_f32_16x16x32_bf16 v[44:47], a[44:47], v[156:159], v[44:47]
    ds_read_b128 a[12:15], v6 offset:6144
    s_add_u32 s64, s20, 0x2b80
    buffer_load_dwordx4 v2, s[4:7], s64 offen lds
    s_waitcnt lgkmcnt(4)
    v_mfma_f32_16x16x32_bf16 v[48:51], a[48:51], v[152:155], v[48:51]
    v_mfma_f32_16x16x32_bf16 v[52:55], a[48:51], v[156:159], v[52:55]
    ds_read_b128 a[16:19], v6 offset:8192
    s_add_u32 m0, s21, 34816
    v_mfma_f32_16x16x32_bf16 v[56:59], a[52:55], v[152:155], v[56:59]
    v_mfma_f32_16x16x32_bf16 v[60:63], a[52:55], v[156:159], v[60:63]
    ds_read_b128 a[20:23], v6 offset:10240
    s_add_u32 s64, s20, 0x5380
    buffer_load_dwordx4 v2, s[4:7], s64 offen lds
    v_mfma_f32_16x16x32_bf16 v[64:67], a[56:59], v[152:155], v[64:67]
    v_mfma_f32_16x16x32_bf16 v[68:71], a[56:59], v[156:159], v[68:71]
    ds_read_b128 a[24:27], v6 offset:12288
    s_add_u32 m0, s21, 35840
    v_mfma_f32_16x16x32_bf16 v[72:75], a[60:63], v[152:155], v[72:75]
    v_mfma_f32_16x16x32_bf16 v[76:79], a[60:63], v[156:159], v[76:79]
    ds_read_b128 a[28:31], v6 offset:14336
    s_add_u32 s64, s20, 0x7b80
    buffer_load_dwordx4 v2, s[4:7], s64 offen lds
    s_waitcnt lgkmcnt(4)
    v_mfma_f32_16x16x32_bf16 v[16:19], a[0:3], v[160:163], v[16:19]
    v_mfma_f32_16x16x32_bf16 v[20:23], a[0:3], v[164:167], v[20:23]
    ds_read_b128 a[32:35], v9 offset:0
    v_mfma_f32_16x16x32_bf16 v[24:27], a[4:7], v[160:163], v[24:27]
    v_mfma_f32_16x16x32_bf16 v[28:31], a[4:7], v[164:167], v[28:31]
    ds_read_b128 a[36:39], v9 offset:2048
    v_mfma_f32_16x16x32_bf16 v[32:35], a[8:11], v[160:163], v[32:35]
    v_mfma_f32_16x16x32_bf16 v[36:39], a[8:11], v[164:167], v[36:39]
    ds_read_b128 a[40:43], v9 offset:4096
    v_mfma_f32_16x16x32_bf16 v[40:43], a[12:15], v[160:163], v[40:43]
    v_mfma_f32_16x16x32_bf16 v[44:47], a[12:15], v[164:167], v[44:47]
    ds_read_b128 a[44:47], v9 offset:6144
    s_waitcnt lgkmcnt(4)
    v_mfma_f32_16x16x32_bf16 v[48:51], a[16:19], v[160:163], v[48:51]
    v_mfma_f32_16x16x32_bf16 v[52:55], a[16:19], v[164:167], v[52:55]
    ds_read_b128 a[48:51], v9 offset:8192
    v_mfma_f32_16x16x32_bf16 v[56:59], a[20:23], v[160:163], v[56:59]
    v_mfma_f32_16x16x32_bf16 v[60:63], a[20:23], v[164:167], v[60:63]
    ds_read_b128 a[52:55], v9 offset:10240
    v_mfma_f32_16x16x32_bf16 v[64:67], a[24:27], v[160:163], v[64:67]
    v_mfma_f32_16x16x32_bf16 v[68:71], a[24:27], v[164:167], v[68:71]
    ds_read_b128 a[56:59], v9 offset:12288
    v_mfma_f32_16x16x32_bf16 v[72:75], a[28:31], v[160:163], v[72:75]
    v_mfma_f32_16x16x32_bf16 v[76:79], a[28:31], v[164:167], v[76:79]
    ds_read_b128 a[60:63], v9 offset:14336
    s_waitcnt vmcnt(8)
    s_barrier
    s_waitcnt lgkmcnt(4)
    v_mfma_f32_16x16x32_bf16 v[16:19], a[32:35], v[168:171], v[16:19]
    v_mfma_f32_16x16x32_bf16 v[20:23], a[32:35], v[172:175], v[20:23]
    ds_read_b128 a[0:3], v3 offset:0
    s_add_u32 m0, s21, 49152
    v_mfma_f32_16x16x32_bf16 v[24:27], a[36:39], v[168:171], v[24:27]
    v_mfma_f32_16x16x32_bf16 v[28:31], a[36:39], v[172:175], v[28:31]
    ds_read_b128 a[4:7], v3 offset:2048
    s_add_u32 s64, s20, 0x400
    buffer_load_dwordx4 v2, s[4:7], s64 offen lds
    v_mfma_f32_16x16x32_bf16 v[32:35], a[40:43], v[168:171], v[32:35]
    v_mfma_f32_16x16x32_bf16 v[36:39], a[40:43], v[172:175], v[36:39]
    ds_read_b128 a[8:11], v3 offset:4096
    s_add_u32 m0, s21, 50176
    v_mfma_f32_16x16x32_bf16 v[40:43], a[44:47], v[168:171], v[40:43]
    v_mfma_f32_16x16x32_bf16 v[44:47], a[44:47], v[172:175], v[44:47]
    ds_read_b128 a[12:15], v3 offset:6144
    s_add_u32 s64, s20, 0x2c00
    buffer_load_dwordx4 v2, s[4:7], s64 offen lds
    s_waitcnt lgkmcnt(4)
    v_mfma_f32_16x16x32_bf16 v[48:51], a[48:51], v[168:171], v[48:51]
    v_mfma_f32_16x16x32_bf16 v[52:55], a[48:51], v[172:175], v[52:55]
    ds_read_b128 a[16:19], v3 offset:8192
    s_add_u32 m0, s21, 51200
    v_mfma_f32_16x16x32_bf16 v[56:59], a[52:55], v[168:171], v[56:59]
    v_mfma_f32_16x16x32_bf16 v[60:63], a[52:55], v[172:175], v[60:63]
    ds_read_b128 a[20:23], v3 offset:10240
    s_add_u32 s64, s20, 0x5400
    buffer_load_dwordx4 v2, s[4:7], s64 offen lds
    v_mfma_f32_16x16x32_bf16 v[64:67], a[56:59], v[168:171], v[64:67]
    v_mfma_f32_16x16x32_bf16 v[68:71], a[56:59], v[172:175], v[68:71]
    ds_read_b128 a[24:27], v3 offset:12288
    s_add_u32 m0, s21, 52224
    v_mfma_f32_16x16x32_bf16 v[72:75], a[60:63], v[168:171], v[72:75]
    v_mfma_f32_16x16x32_bf16 v[76:79], a[60:63], v[172:175], v[76:79]
    ds_read_b128 a[28:31], v3 offset:14336
    s_add_u32 s64, s20, 0x7c00
    buffer_load_dwordx4 v2, s[4:7], s64 offen lds
    s_waitcnt lgkmcnt(4)
    v_mfma_f32_16x16x32_bf16 v[16:19], a[0:3], v[176:179], v[16:19]
    v_mfma_f32_16x16x32_bf16 v[20:23], a[0:3], v[180:183], v[20:23]
    ds_read_b128 a[32:35], v4 offset:0
    v_mfma_f32_16x16x32_bf16 v[24:27], a[4:7], v[176:179], v[24:27]
    v_mfma_f32_16x16x32_bf16 v[28:31], a[4:7], v[180:183], v[28:31]
    ds_read_b128 a[36:39], v4 offset:2048
    v_mfma_f32_16x16x32_bf16 v[32:35], a[8:11], v[176:179], v[32:35]
    v_mfma_f32_16x16x32_bf16 v[36:39], a[8:11], v[180:183], v[36:39]
    ds_read_b128 a[40:43], v4 offset:4096
    v_mfma_f32_16x16x32_bf16 v[40:43], a[12:15], v[176:179], v[40:43]
    v_mfma_f32_16x16x32_bf16 v[44:47], a[12:15], v[180:183], v[44:47]
    ds_read_b128 a[44:47], v4 offset:6144
    s_waitcnt lgkmcnt(4)
    v_mfma_f32_16x16x32_bf16 v[48:51], a[16:19], v[176:179], v[48:51]
    v_mfma_f32_16x16x32_bf16 v[52:55], a[16:19], v[180:183], v[52:55]
    ds_read_b128 a[48:51], v4 offset:8192
    v_mfma_f32_16x16x32_bf16 v[56:59], a[20:23], v[176:179], v[56:59]
    v_mfma_f32_16x16x32_bf16 v[60:63], a[20:23], v[180:183], v[60:63]
    ds_read_b128 a[52:55], v4 offset:10240
    v_mfma_f32_16x16x32_bf16 v[64:67], a[24:27], v[176:179], v[64:67]
    v_mfma_f32_16x16x32_bf16 v[68:71], a[24:27], v[180:183], v[68:71]
    ds_read_b128 a[56:59], v4 offset:12288
    v_mfma_f32_16x16x32_bf16 v[72:75], a[28:31], v[176:179], v[72:75]
    v_mfma_f32_16x16x32_bf16 v[76:79], a[28:31], v[180:183], v[76:79]
    ds_read_b128 a[60:63], v4 offset:14336
    s_waitcnt vmcnt(8)
    s_barrier
    s_waitcnt lgkmcnt(4)
    v_mfma_f32_16x16x32_bf16 v[16:19], a[32:35], v[184:187], v[16:19]
    v_mfma_f32_16x16x32_bf16 v[20:23], a[32:35], v[188:191], v[20:23]
    ds_read_b128 a[0:3], v3 offset:16384
    s_add_u32 m0, s21, 65536
    v_mfma_f32_16x16x32_bf16 v[24:27], a[36:39], v[184:187], v[24:27]
    v_mfma_f32_16x16x32_bf16 v[28:31], a[36:39], v[188:191], v[28:31]
    ds_read_b128 a[4:7], v3 offset:18432
    s_add_u32 s64, s20, 0x480
    buffer_load_dwordx4 v2, s[4:7], s64 offen lds
    v_mfma_f32_16x16x32_bf16 v[32:35], a[40:43], v[184:187], v[32:35]
    v_mfma_f32_16x16x32_bf16 v[36:39], a[40:43], v[188:191], v[36:39]
    ds_read_b128 a[8:11], v3 offset:20480
    s_add_u32 m0, s21, 66560
    v_mfma_f32_16x16x32_bf16 v[40:43], a[44:47], v[184:187], v[40:43]
    v_mfma_f32_16x16x32_bf16 v[44:47], a[44:47], v[188:191], v[44:47]
    ds_read_b128 a[12:15], v3 offset:22528
    s_add_u32 s64, s20, 0x2c80
    buffer_load_dwordx4 v2, s[4:7], s64 offen lds
    s_waitcnt lgkmcnt(4)
    v_mfma_f32_16x16x32_bf16 v[48:51], a[48:51], v[184:187], v[48:51]
    v_mfma_f32_16x16x32_bf16 v[52:55], a[48:51], v[188:191], v[52:55]
    ds_read_b128 a[16:19], v3 offset:24576
    s_add_u32 m0, s21, 67584
    v_mfma_f32_16x16x32_bf16 v[56:59], a[52:55], v[184:187], v[56:59]
    v_mfma_f32_16x16x32_bf16 v[60:63], a[52:55], v[188:191], v[60:63]
    ds_read_b128 a[20:23], v3 offset:26624
    s_add_u32 s64, s20, 0x5480
    buffer_load_dwordx4 v2, s[4:7], s64 offen lds
    v_mfma_f32_16x16x32_bf16 v[64:67], a[56:59], v[184:187], v[64:67]
    v_mfma_f32_16x16x32_bf16 v[68:71], a[56:59], v[188:191], v[68:71]
    ds_read_b128 a[24:27], v3 offset:28672
    s_add_u32 m0, s21, 68608
    v_mfma_f32_16x16x32_bf16 v[72:75], a[60:63], v[184:187], v[72:75]
    v_mfma_f32_16x16x32_bf16 v[76:79], a[60:63], v[188:191], v[76:79]
    ds_read_b128 a[28:31], v3 offset:30720
    s_add_u32 s64, s20, 0x7c80
    buffer_load_dwordx4 v2, s[4:7], s64 offen lds
    s_waitcnt lgkmcnt(4)
    v_mfma_f32_16x16x32_bf16 v[16:19], a[0:3], v[192:195], v[16:19]
    v_mfma_f32_16x16x32_bf16 v[20:23], a[0:3], v[196:199], v[20:23]
    ds_read_b128 a[32:35], v4 offset:16384
    v_mfma_f32_16x16x32_bf16 v[24:27], a[4:7], v[192:195], v[24:27]
    v_mfma_f32_16x16x32_bf16 v[28:31], a[4:7], v[196:199], v[28:31]
    ds_read_b128 a[36:39], v4 offset:18432
    v_mfma_f32_16x16x32_bf16 v[32:35], a[8:11], v[192:195], v[32:35]
    v_mfma_f32_16x16x32_bf16 v[36:39], a[8:11], v[196:199], v[36:39]
    ds_read_b128 a[40:43], v4 offset:20480
    v_mfma_f32_16x16x32_bf16 v[40:43], a[12:15], v[192:195], v[40:43]
    v_mfma_f32_16x16x32_bf16 v[44:47], a[12:15], v[196:199], v[44:47]
    ds_read_b128 a[44:47], v4 offset:22528
    s_waitcnt lgkmcnt(4)
    v_mfma_f32_16x16x32_bf16 v[48:51], a[16:19], v[192:195], v[48:51]
    v_mfma_f32_16x16x32_bf16 v[52:55], a[16:19], v[196:199], v[52:55]
    ds_read_b128 a[48:51], v4 offset:24576
    v_mfma_f32_16x16x32_bf16 v[56:59], a[20:23], v[192:195], v[56:59]
    v_mfma_f32_16x16x32_bf16 v[60:63], a[20:23], v[196:199], v[60:63]
    ds_read_b128 a[52:55], v4 offset:26624
    v_mfma_f32_16x16x32_bf16 v[64:67], a[24:27], v[192:195], v[64:67]
    v_mfma_f32_16x16x32_bf16 v[68:71], a[24:27], v[196:199], v[68:71]
    ds_read_b128 a[56:59], v4 offset:28672
    v_mfma_f32_16x16x32_bf16 v[72:75], a[28:31], v[192:195], v[72:75]
    v_mfma_f32_16x16x32_bf16 v[76:79], a[28:31], v[196:199], v[76:79]
    ds_read_b128 a[60:63], v4 offset:30720
    s_waitcnt vmcnt(8)
    s_barrier
    s_waitcnt lgkmcnt(4)
    v_mfma_f32_16x16x32_bf16 v[16:19], a[32:35], v[200:203], v[16:19]
    v_mfma_f32_16x16x32_bf16 v[20:23], a[32:35], v[204:207], v[20:23]
    ds_read_b128 a[0:3], v3 offset:32768
    s_add_u32 m0, s21, 0
    v_mfma_f32_16x16x32_bf16 v[24:27], a[36:39], v[200:203], v[24:27]
    v_mfma_f32_16x16x32_bf16 v[28:31], a[36:39], v[204:207], v[28:31]
    ds_read_b128 a[4:7], v3 offset:34816
    s_add_u32 s64, s20, 0x50000
    buffer_load_dwordx4 v2, s[4:7], s64 offen lds
    v_mfma_f32_16x16x32_bf16 v[32:35], a[40:43], v[200:203], v[32:35]
    v_mfma_f32_16x16x32_bf16 v[36:39], a[40:43], v[204:207], v[36:39]
    ds_read_b128 a[8:11], v3 offset:36864
    s_add_u32 m0, s21, 1024
    v_mfma_f32_16x16x32_bf16 v[40:43], a[44:47], v[200:203], v[40:43]
    v_mfma_f32_16x16x32_bf16 v[44:47], a[44:47], v[204:207], v[44:47]
    ds_read_b128 a[12:15], v3 offset:38912
    s_add_u32 s64, s20, 0x52800
    buffer_load_dwordx4 v2, s[4:7], s64 offen lds
    s_waitcnt lgkmcnt(4)
    v_mfma_f32_16x16x32_bf16 v[48:51], a[48:51], v[200:203], v[48:51]
    v_mfma_f32_16x16x32_bf16 v[52:55], a[48:51], v[204:207], v[52:55]
    ds_read_b128 a[16:19], v3 offset:40960
    s_add_u32 m0, s21, 2048
    v_mfma_f32_16x16x32_bf16 v[56:59], a[52:55], v[200:203], v[56:59]
    v_mfma_f32_16x16x32_bf16 v[60:63], a[52:55], v[204:207], v[60:63]
    ds_read_b128 a[20:23], v3 offset:43008
    s_add_u32 s64, s20, 0x55000
    buffer_load_dwordx4 v2, s[4:7], s64 offen lds
    v_mfma_f32_16x16x32_bf16 v[64:67], a[56:59], v[200:203], v[64:67]
    v_mfma_f32_16x16x32_bf16 v[68:71], a[56:59], v[204:207], v[68:71]
    ds_read_b128 a[24:27], v3 offset:45056
    s_add_u32 m0, s21, 3072
    v_mfma_f32_16x16x32_bf16 v[72:75], a[60:63], v[200:203], v[72:75]
    v_mfma_f32_16x16x32_bf16 v[76:79], a[60:63], v[204:207], v[76:79]
    ds_read_b128 a[28:31], v3 offset:47104
    s_add_u32 s64, s20, 0x57800
    buffer_load_dwordx4 v2, s[4:7], s64 offen lds
    s_waitcnt lgkmcnt(4)
    v_mfma_f32_16x16x32_bf16 v[16:19], a[0:3], v[208:211], v[16:19]
    v_mfma_f32_16x16x32_bf16 v[20:23], a[0:3], v[212:215], v[20:23]
    ds_read_b128 a[32:35], v4 offset:32768
    v_mfma_f32_16x16x32_bf16 v[24:27], a[4:7], v[208:211], v[24:27]
    v_mfma_f32_16x16x32_bf16 v[28:31], a[4:7], v[212:215], v[28:31]
    ds_read_b128 a[36:39], v4 offset:34816
    v_mfma_f32_16x16x32_bf16 v[32:35], a[8:11], v[208:211], v[32:35]
    v_mfma_f32_16x16x32_bf16 v[36:39], a[8:11], v[212:215], v[36:39]
    ds_read_b128 a[40:43], v4 offset:36864
    v_mfma_f32_16x16x32_bf16 v[40:43], a[12:15], v[208:211], v[40:43]
    v_mfma_f32_16x16x32_bf16 v[44:47], a[12:15], v[212:215], v[44:47]
    ds_read_b128 a[44:47], v4 offset:38912
    s_waitcnt lgkmcnt(4)
    v_mfma_f32_16x16x32_bf16 v[48:51], a[16:19], v[208:211], v[48:51]
    v_mfma_f32_16x16x32_bf16 v[52:55], a[16:19], v[212:215], v[52:55]
    ds_read_b128 a[48:51], v4 offset:40960
    v_mfma_f32_16x16x32_bf16 v[56:59], a[20:23], v[208:211], v[56:59]
    v_mfma_f32_16x16x32_bf16 v[60:63], a[20:23], v[212:215], v[60:63]
    ds_read_b128 a[52:55], v4 offset:43008
    v_mfma_f32_16x16x32_bf16 v[64:67], a[24:27], v[208:211], v[64:67]
    v_mfma_f32_16x16x32_bf16 v[68:71], a[24:27], v[212:215], v[68:71]
    ds_read_b128 a[56:59], v4 offset:45056
    v_mfma_f32_16x16x32_bf16 v[72:75], a[28:31], v[208:211], v[72:75]
    v_mfma_f32_16x16x32_bf16 v[76:79], a[28:31], v[212:215], v[76:79]
    ds_read_b128 a[60:63], v4 offset:47104
    s_waitcnt vmcnt(8)
    s_barrier
    s_waitcnt lgkmcnt(4)
    v_mfma_f32_16x16x32_bf16 v[16:19], a[32:35], v[216:219], v[16:19]
    v_mfma_f32_16x16x32_bf16 v[20:23], a[32:35], v[220:223], v[20:23]
    ds_read_b128 a[0:3], v3 offset:49152
    s_add_u32 m0, s21, 16384
    v_mfma_f32_16x16x32_bf16 v[24:27], a[36:39], v[216:219], v[24:27]
    v_mfma_f32_16x16x32_bf16 v[28:31], a[36:39], v[220:223], v[28:31]
    ds_read_b128 a[4:7], v3 offset:51200
    s_add_u32 s64, s20, 0x50080
    buffer_load_dwordx4 v2, s[4:7], s64 offen lds
    v_mfma_f32_16x16x32_bf16 v[32:35], a[40:43], v[216:219], v[32:35]
    v_mfma_f32_16x16x32_bf16 v[36:39], a[40:43], v[220:223], v[36:39]
    ds_read_b128 a[8:11], v3 offset:53248
    s_add_u32 m0, s21, 17408
    v_mfma_f32_16x16x32_bf16 v[40:43], a[44:47], v[216:219], v[40:43]
    v_mfma_f32_16x16x32_bf16 v[44:47], a[44:47], v[220:223], v[44:47]
    ds_read_b128 a[12:15], v3 offset:55296
    s_add_u32 s64, s20, 0x52880
    buffer_load_dwordx4 v2, s[4:7], s64 offen lds
    s_waitcnt lgkmcnt(4)
    v_mfma_f32_16x16x32_bf16 v[48:51], a[48:51], v[216:219], v[48:51]
    v_mfma_f32_16x16x32_bf16 v[52:55], a[48:51], v[220:223], v[52:55]
    ds_read_b128 a[16:19], v3 offset:57344
    s_add_u32 m0, s21, 18432
    v_mfma_f32_16x16x32_bf16 v[56:59], a[52:55], v[216:219], v[56:59]
    v_mfma_f32_16x16x32_bf16 v[60:63], a[52:55], v[220:223], v[60:63]
    ds_read_b128 a[20:23], v3 offset:59392
    s_add_u32 s64, s20, 0x55080
    buffer_load_dwordx4 v2, s[4:7], s64 offen lds
    v_mfma_f32_16x16x32_bf16 v[64:67], a[56:59], v[216:219], v[64:67]
    v_mfma_f32_16x16x32_bf16 v[68:71], a[56:59], v[220:223], v[68:71]
    ds_read_b128 a[24:27], v3 offset:61440
    s_add_u32 m0, s21, 19456
    v_mfma_f32_16x16x32_bf16 v[72:75], a[60:63], v[216:219], v[72:75]
    v_mfma_f32_16x16x32_bf16 v[76:79], a[60:63], v[220:223], v[76:79]
    ds_read_b128 a[28:31], v3 offset:63488
    s_add_u32 s64, s20, 0x57880
    buffer_load_dwordx4 v2, s[4:7], s64 offen lds
    s_waitcnt lgkmcnt(4)
    v_mfma_f32_16x16x32_bf16 v[16:19], a[0:3], v[224:227], v[16:19]
    v_mfma_f32_16x16x32_bf16 v[20:23], a[0:3], v[228:231], v[20:23]
    ds_read_b128 a[32:35], v4 offset:49152
    v_mfma_f32_16x16x32_bf16 v[24:27], a[4:7], v[224:227], v[24:27]
    v_mfma_f32_16x16x32_bf16 v[28:31], a[4:7], v[228:231], v[28:31]
    ds_read_b128 a[36:39], v4 offset:51200
    v_mfma_f32_16x16x32_bf16 v[32:35], a[8:11], v[224:227], v[32:35]
    v_mfma_f32_16x16x32_bf16 v[36:39], a[8:11], v[228:231], v[36:39]
    ds_read_b128 a[40:43], v4 offset:53248
    v_mfma_f32_16x16x32_bf16 v[40:43], a[12:15], v[224:227], v[40:43]
    v_mfma_f32_16x16x32_bf16 v[44:47], a[12:15], v[228:231], v[44:47]
    ds_read_b128 a[44:47], v4 offset:55296
    s_waitcnt lgkmcnt(4)
    v_mfma_f32_16x16x32_bf16 v[48:51], a[16:19], v[224:227], v[48:51]
    v_mfma_f32_16x16x32_bf16 v[52:55], a[16:19], v[228:231], v[52:55]
    ds_read_b128 a[48:51], v4 offset:57344
    v_mfma_f32_16x16x32_bf16 v[56:59], a[20:23], v[224:227], v[56:59]
    v_mfma_f32_16x16x32_bf16 v[60:63], a[20:23], v[228:231], v[60:63]
    ds_read_b128 a[52:55], v4 offset:59392
    v_mfma_f32_16x16x32_bf16 v[64:67], a[24:27], v[224:227], v[64:67]
    v_mfma_f32_16x16x32_bf16 v[68:71], a[24:27], v[228:231], v[68:71]
    ds_read_b128 a[56:59], v4 offset:61440
    v_mfma_f32_16x16x32_bf16 v[72:75], a[28:31], v[224:227], v[72:75]
    v_mfma_f32_16x16x32_bf16 v[76:79], a[28:31], v[228:231], v[76:79]
    ds_read_b128 a[60:63], v4 offset:63488
    s_waitcnt vmcnt(8)
    s_barrier
    s_waitcnt lgkmcnt(4)
    v_mfma_f32_16x16x32_bf16 v[16:19], a[32:35], v[232:235], v[16:19]
    v_mfma_f32_16x16x32_bf16 v[20:23], a[32:35], v[236:239], v[20:23]
    ds_read_b128 a[0:3], v6 offset:0
    s_add_u32 m0, s21, 32768
    v_mfma_f32_16x16x32_bf16 v[24:27], a[36:39], v[232:235], v[24:27]
    v_mfma_f32_16x16x32_bf16 v[28:31], a[36:39], v[236:239], v[28:31]
    ds_read_b128 a[4:7], v6 offset:2048
    s_add_u32 s64, s20, 0x50100
    buffer_load_dwordx4 v2, s[4:7], s64 offen lds
    v_mfma_f32_16x16x32_bf16 v[32:35], a[40:43], v[232:235], v[32:35]
    v_mfma_f32_16x16x32_bf16 v[36:39], a[40:43], v[236:239], v[36:39]
    ds_read_b128 a[8:11], v6 offset:4096
    s_add_u32 m0, s21, 33792
    v_mfma_f32_16x16x32_bf16 v[40:43], a[44:47], v[232:235], v[40:43]
    v_mfma_f32_16x16x32_bf16 v[44:47], a[44:47], v[236:239], v[44:47]
    ds_read_b128 a[12:15], v6 offset:6144
    s_add_u32 s64, s20, 0x52900
    buffer_load_dwordx4 v2, s[4:7], s64 offen lds
    s_waitcnt lgkmcnt(4)
    v_mfma_f32_16x16x32_bf16 v[48:51], a[48:51], v[232:235], v[48:51]
    v_mfma_f32_16x16x32_bf16 v[52:55], a[48:51], v[236:239], v[52:55]
    ds_read_b128 a[16:19], v6 offset:8192
    s_add_u32 m0, s21, 34816
    v_mfma_f32_16x16x32_bf16 v[56:59], a[52:55], v[232:235], v[56:59]
    v_mfma_f32_16x16x32_bf16 v[60:63], a[52:55], v[236:239], v[60:63]
    ds_read_b128 a[20:23], v6 offset:10240
    s_add_u32 s64, s20, 0x55100
    buffer_load_dwordx4 v2, s[4:7], s64 offen lds
    v_mfma_f32_16x16x32_bf16 v[64:67], a[56:59], v[232:235], v[64:67]
    v_mfma_f32_16x16x32_bf16 v[68:71], a[56:59], v[236:239], v[68:71]
    ds_read_b128 a[24:27], v6 offset:12288
    s_add_u32 m0, s21, 35840
    v_mfma_f32_16x16x32_bf16 v[72:75], a[60:63], v[232:235], v[72:75]
    v_mfma_f32_16x16x32_bf16 v[76:79], a[60:63], v[236:239], v[76:79]
    ds_read_b128 a[28:31], v6 offset:14336
    s_add_u32 s64, s20, 0x57900
    buffer_load_dwordx4 v2, s[4:7], s64 offen lds
    s_waitcnt lgkmcnt(4)
    v_mfma_f32_16x16x32_bf16 v[16:19], a[0:3], v[240:243], v[16:19]
    v_mfma_f32_16x16x32_bf16 v[20:23], a[0:3], v[244:247], v[20:23]
    ds_read_b128 a[32:35], v9 offset:0
    v_mfma_f32_16x16x32_bf16 v[24:27], a[4:7], v[240:243], v[24:27]
    v_mfma_f32_16x16x32_bf16 v[28:31], a[4:7], v[244:247], v[28:31]
    ds_read_b128 a[36:39], v9 offset:2048
    v_mfma_f32_16x16x32_bf16 v[32:35], a[8:11], v[240:243], v[32:35]
    v_mfma_f32_16x16x32_bf16 v[36:39], a[8:11], v[244:247], v[36:39]
    ds_read_b128 a[40:43], v9 offset:4096
    v_mfma_f32_16x16x32_bf16 v[40:43], a[12:15], v[240:243], v[40:43]
    v_mfma_f32_16x16x32_bf16 v[44:47], a[12:15], v[244:247], v[44:47]
    ds_read_b128 a[44:47], v9 offset:6144
    s_waitcnt lgkmcnt(4)
    v_mfma_f32_16x16x32_bf16 v[48:51], a[16:19], v[240:243], v[48:51]
    v_mfma_f32_16x16x32_bf16 v[52:55], a[16:19], v[244:247], v[52:55]
    ds_read_b128 a[48:51], v9 offset:8192
    v_mfma_f32_16x16x32_bf16 v[56:59], a[20:23], v[240:243], v[56:59]
    v_mfma_f32_16x16x32_bf16 v[60:63], a[20:23], v[244:247], v[60:63]
    ds_read_b128 a[52:55], v9 offset:10240
    v_mfma_f32_16x16x32_bf16 v[64:67], a[24:27], v[240:243], v[64:67]
    v_mfma_f32_16x16x32_bf16 v[68:71], a[24:27], v[244:247], v[68:71]
    ds_read_b128 a[56:59], v9 offset:12288
    v_mfma_f32_16x16x32_bf16 v[72:75], a[28:31], v[240:243], v[72:75]
    v_mfma_f32_16x16x32_bf16 v[76:79], a[28:31], v[244:247], v[76:79]
    ds_read_b128 a[60:63], v9 offset:14336
    s_waitcnt vmcnt(8)
    s_barrier
    s_waitcnt lgkmcnt(4)
    v_mfma_f32_16x16x32_bf16 v[16:19], a[32:35], v[248:251], v[16:19]
    v_mfma_f32_16x16x32_bf16 v[20:23], a[32:35], v[252:255], v[20:23]
    ds_read_b128 a[0:3], v3 offset:0
    s_add_u32 m0, s21, 49152
    v_mfma_f32_16x16x32_bf16 v[24:27], a[36:39], v[248:251], v[24:27]
    v_mfma_f32_16x16x32_bf16 v[28:31], a[36:39], v[252:255], v[28:31]
    ds_read_b128 a[4:7], v3 offset:2048
    s_add_u32 s64, s20, 0x50180
    buffer_load_dwordx4 v2, s[4:7], s64 offen lds
    v_mfma_f32_16x16x32_bf16 v[32:35], a[40:43], v[248:251], v[32:35]
    v_mfma_f32_16x16x32_bf16 v[36:39], a[40:43], v[252:255], v[36:39]
    ds_read_b128 a[8:11], v3 offset:4096
    s_add_u32 m0, s21, 50176
    v_mfma_f32_16x16x32_bf16 v[40:43], a[44:47], v[248:251], v[40:43]
    v_mfma_f32_16x16x32_bf16 v[44:47], a[44:47], v[252:255], v[44:47]
    ds_read_b128 a[12:15], v3 offset:6144
    s_add_u32 s64, s20, 0x52980
    buffer_load_dwordx4 v2, s[4:7], s64 offen lds
    s_waitcnt lgkmcnt(4)
    v_mfma_f32_16x16x32_bf16 v[48:51], a[48:51], v[248:251], v[48:51]
    v_mfma_f32_16x16x32_bf16 v[52:55], a[48:51], v[252:255], v[52:55]
    ds_read_b128 a[16:19], v3 offset:8192
    s_add_u32 m0, s21, 51200
    v_mfma_f32_16x16x32_bf16 v[56:59], a[52:55], v[248:251], v[56:59]
    v_mfma_f32_16x16x32_bf16 v[60:63], a[52:55], v[252:255], v[60:63]
    ds_read_b128 a[20:23], v3 offset:10240
    s_add_u32 s64, s20, 0x55180
    buffer_load_dwordx4 v2, s[4:7], s64 offen lds
    v_mfma_f32_16x16x32_bf16 v[64:67], a[56:59], v[248:251], v[64:67]
    v_mfma_f32_16x16x32_bf16 v[68:71], a[56:59], v[252:255], v[68:71]
    ds_read_b128 a[24:27], v3 offset:12288
    s_add_u32 m0, s21, 52224
    v_mfma_f32_16x16x32_bf16 v[72:75], a[60:63], v[248:251], v[72:75]
    v_mfma_f32_16x16x32_bf16 v[76:79], a[60:63], v[252:255], v[76:79]
    ds_read_b128 a[28:31], v3 offset:14336
    s_add_u32 s64, s20, 0x57980
    buffer_load_dwordx4 v2, s[4:7], s64 offen lds
    s_nop 5
    s_mul_i32 s65, s17, 0
    s_add_u32 s65, s65, s22
    s_add_u32 s64, s65, 0
    v_cvt_pk_bf16_f32 v80, v16, v17
    v_cvt_pk_bf16_f32 v81, v18, v19
    v_cvt_pk_bf16_f32 v82, v24, v25
    v_cvt_pk_bf16_f32 v83, v26, v27
    buffer_store_dwordx4 v[80:83], v1, s[4:7], s64 offen sc1
    s_add_u32 s64, s65, 1024
    v_cvt_pk_bf16_f32 v84, v20, v21
    v_cvt_pk_bf16_f32 v85, v22, v23
    v_cvt_pk_bf16_f32 v86, v28, v29
    v_cvt_pk_bf16_f32 v87, v30, v31
    buffer_store_dwordx4 v[84:87], v1, s[4:7], s64 offen sc1
    s_mul_i32 s65, s17, 1
    s_add_u32 s65, s65, s22
    s_add_u32 s64, s65, 0
    v_cvt_pk_bf16_f32 v88, v32, v33
    v_cvt_pk_bf16_f32 v89, v34, v35
    v_cvt_pk_bf16_f32 v90, v40, v41
    v_cvt_pk_bf16_f32 v91, v42, v43
    buffer_store_dwordx4 v[88:91], v1, s[4:7], s64 offen sc1
    s_add_u32 s64, s65, 1024
    v_cvt_pk_bf16_f32 v92, v36, v37
    v_cvt_pk_bf16_f32 v93, v38, v39
    v_cvt_pk_bf16_f32 v94, v44, v45
    v_cvt_pk_bf16_f32 v95, v46, v47
    buffer_store_dwordx4 v[92:95], v1, s[4:7], s64 offen sc1
    s_mul_i32 s65, s17, 2
    s_add_u32 s65, s65, s22
    s_add_u32 s64, s65, 0
    v_cvt_pk_bf16_f32 v80, v48, v49
    v_cvt_pk_bf16_f32 v81, v50, v51
    v_cvt_pk_bf16_f32 v82, v56, v57
    v_cvt_pk_bf16_f32 v83, v58, v59
    buffer_store_dwordx4 v[80:83], v1, s[4:7], s64 offen sc1
    s_add_u32 s64, s65, 1024
    v_cvt_pk_bf16_f32 v84, v52, v53
    v_cvt_pk_bf16_f32 v85, v54, v55
    v_cvt_pk_bf16_f32 v86, v60, v61
    v_cvt_pk_bf16_f32 v87, v62, v63
    buffer_store_dwordx4 v[84:87], v1, s[4:7], s64 offen sc1
    s_mul_i32 s65, s17, 3
    s_add_u32 s65, s65, s22
    s_add_u32 s64, s65, 0
    v_cvt_pk_bf16_f32 v88, v64, v65
    v_cvt_pk_bf16_f32 v89, v66, v67
    v_cvt_pk_bf16_f32 v90, v72, v73
    v_cvt_pk_bf16_f32 v91, v74, v75
    buffer_store_dwordx4 v[88:91], v1, s[4:7], s64 offen sc1
    s_add_u32 s64, s65, 1024
    v_cvt_pk_bf16_f32 v92, v68, v69
    v_cvt_pk_bf16_f32 v93, v70, v71
    v_cvt_pk_bf16_f32 v94, v76, v77
    v_cvt_pk_bf16_f32 v95, v78, v79
    buffer_store_dwordx4 v[92:95], v1, s[4:7], s64 offen sc1
    s_lshl_b32 s64, s19, 1
    s_add_u32 s64, s64, s12
    s_lshl_b32 s64, s64, 9
    s_add_u32 s23, s18, s64
    s_lshl_b32 s64, s17, 3
    s_add_u32 s22, s22, s64
    s_add_u32 s19, s19, 1
    s_add_u32 s20, s20, 0x50000
    s_cmp_lg_u32 s19, 1
    s_cbranch_scc1 GE0_146
    s_waitcnt vmcnt(0)
    s_barrier
    s_cmp_lg_u32 s14, 0
    s_cbranch_scc1 GF_147
    v_mov_b32 v7, 1
    v_mov_b32 v8, 0
    s_mov_b64 exec, 1
    buffer_store_dword v7, v8, s[4:7], s23 offen sc1
    s_mov_b64 exec, -1
GF_147:
GE0_146:
    s_cmp_lt_u32 s19, 8
    s_cbranch_scc1 G_N_LOOP
    s_waitcnt vmcnt(0) lgkmcnt(0)
    s_barrier
    s_cmp_lg_u32 s14, 0
    s_cbranch_scc1 GF_148
    v_mov_b32 v7, 1
    v_mov_b32 v8, 0
    s_mov_b64 exec, 1
    buffer_store_dword v7, v8, s[4:7], s23 offen sc1
    s_mov_b64 exec, -1
GF_148:
    s_cmp_eq_u32 s12, 1
    s_cbranch_scc1 H_OUT
    s_lshl_b32 s88, s3, 5
    s_add_u32 s88, s88, s13
    s_mov_b32 s29, 0
    v_lshlrev_b32 v1, 4, v0
    s_mov_b32 s65, 0
CW_149:
    buffer_load_dwordx2 v[8:9], off, s[60:63], 0 offset:132 sc1
    s_add_u32 s65, s65, 1
    s_waitcnt vmcnt(0)
    v_readfirstlane_b32 s66, v8
    v_readfirstlane_b32 s67, v9
    s_min_u32 s64, s66, s67
    s_cmp_lg_u32 s64, 0
    s_cbranch_scc1 CWD_150
    s_cmp_gt_u32 s65, 65536
    s_cbranch_scc1 CWD_150
    s_sleep 4
    s_branch CW_149
CWD_150:
    s_sub_u32 s66, s66, 1
    s_and_b32 s66, s66, 3
    s_sub_u32 s67, s67, 1
    s_and_b32 s67, s67, 3
    s_mov_b32 s64, s66
    s_mov_b32 s65, s67
    s_and_b32 s64, s64, 3
    s_lshl_b32 s64, s64, 13
    s_and_b32 s65, s65, 3
    s_lshl_b32 s65, s65, 13
    s_add_u32 s25, s64, 0x6000000
    s_add_u32 s30, s65, 0x6200000
    v_bfe_u32 v4, v0, 3, 1
    v_mul_u32_u24 v2, 0x8000, v4
    v_lshrrev_b32 v4, 5, v0
    v_lshl_add_u32 v2, v4, 8, v2
    v_bfe_u32 v4, v0, 4, 1
    v_lshl_add_u32 v2, v4, 7, v2
    v_and_b32 v4, 7, v0
    v_lshl_add_u32 v2, v4, 4, v2
    v_lshrrev_b32 v4, 5, v0
    v_lshlrev_b32 v3, 16, v4
    v_bfe_u32 v4, v0, 4, 1
    v_lshl_add_u32 v3, v4, 7, v3
    v_and_b32 v4, 15, v0
    v_lshl_add_u32 v3, v4, 3, v3
    s_lshl_b32 s26, s13, 11
    s_lshl_b32 s64, s14, 9
    s_add_u32 s26, s26, s64
    s_add_u32 s26, s26, 0xa40000
    s_lshl_b32 s27, s13, 3
    s_add_u32 s27, s27, 0x294004
    s_mov_b32 s28, 0x29a000
    s_mov_b32 s24, 0
    v_lshlrev_b32 v6, 7, v0
MKN_LOOP:
    s_cmp_lg_u32 s24, 10
    s_cbranch_scc1 MKH_151
    v_mov_b32 v10, v2
    v_mov_b32 v11, v3
    s_cmp_ge_u32 s88, 60
    s_cbranch_scc1 NOWO_152
    s_mov_b32 s89, s13
    s_mul_hi_u32 s65, s88, 0xccccccd
    s_mul_i32 s65, s65, 20
    s_sub_u32 s13, s88, s65
    s_load_dwordx2 s[44:45], s[0:1], 40
    s_mov_b32 s46, 0x500000
    s_mov_b32 s47, 0x00020000
    s_waitcnt lgkmcnt(0)
    s_mul_i32 s21, s14, 36864
    v_lshrrev_b32 v7, 2, v0
    v_mul_u32_u24 v4, 1280, v7
    v_bfe_u32 v7, v0, 4, 1
    v_lshlrev_b32 v7, 1, v7
    v_and_b32 v8, 3, v0
    v_xor_b32 v7, v7, v8
    v_lshl_add_u32 v4, v7, 4, v4
    v_lshrrev_b32 v7, 4, v0
    v_lshlrev_b32 v2, 8, v7
    v_bfe_u32 v7, v0, 2, 2
    v_lshl_add_u32 v2, v7, 6, v2
    v_and_b32 v7, 3, v0
    v_lshl_add_u32 v2, v7, 3, v2
    v_add_u32 v2, s21, v2
    v_bfe_u32 v7, v0, 4, 1
    v_lshlrev_b32 v7, 5, v7
    v_sub_u32 v3, 32, v7
    v_add_u32 v3, v3, v2
    v_add_u32 v2, v2, v7
    s_mul_i32 s65, s14, 1310720
    s_lshl_b32 s66, s13, 6
    s_add_u32 s65, s65, s66
    s_add_u32 m0, s21, 0
    s_add_u32 s64, s65, 0x0
    buffer_load_dwordx4 v4, s[44:47], s64 offen lds
    s_add_u32 m0, s21, 1024
    s_add_u32 s64, s65, 0x5000
    buffer_load_dwordx4 v4, s[44:47], s64 offen lds
    s_add_u32 m0, s21, 2048
    s_add_u32 s64, s65, 0xa000
    buffer_load_dwordx4 v4, s[44:47], s64 offen lds
    s_add_u32 m0, s21, 3072
    s_add_u32 s64, s65, 0xf000
    buffer_load_dwordx4 v4, s[44:47], s64 offen lds
    s_add_u32 m0, s21, 4096
    s_add_u32 s64, s65, 0x14000
    buffer_load_dwordx4 v4, s[44:47], s64 offen lds
    s_add_u32 m0, s21, 5120
    s_add_u32 s64, s65, 0x19000
    buffer_load_dwordx4 v4, s[44:47], s64 offen lds
    s_add_u32 m0, s21, 6144
    s_add_u32 s64, s65, 0x1e000
    buffer_load_dwordx4 v4, s[44:47], s64 offen lds
    s_add_u32 m0, s21, 7168
    s_add_u32 s64, s65, 0x23000
    buffer_load_dwordx4 v4, s[44:47], s64 offen lds
    s_add_u32 m0, s21, 8192
    s_add_u32 s64, s65, 0x28000
    buffer_load_dwordx4 v4, s[44:47], s64 offen lds
    s_add_u32 m0, s21, 9216
    s_add_u32 s64, s65, 0x2d000
    buffer_load_dwordx4 v4, s[44:47], s64 offen lds
    s_add_u32 m0, s21, 10240
    s_add_u32 s64, s65, 0x32000
    buffer_load_dwordx4 v4, s[44:47], s64 offen lds
    s_add_u32 m0, s21, 11264
    s_add_u32 s64, s65, 0x37000
    buffer_load_dwordx4 v4, s[44:47], s64 offen lds
    s_add_u32 m0, s21, 12288
    s_add_u32 s64, s65, 0x3c000
    buffer_load_dwordx4 v4, s[44:47], s64 offen lds
    s_add_u32 m0, s21, 13312
    s_add_u32 s64, s65, 0x41000
    buffer_load_dwordx4 v4, s[44:47], s64 offen lds
    s_add_u32 m0, s21, 14336
    s_add_u32 s64, s65, 0x46000
    buffer_load_dwordx4 v4, s[44:47], s64 offen lds
    s_add_u32 m0, s21, 15360
    s_add_u32 s64, s65, 0x4b000
    buffer_load_dwordx4 v4, s[44:47], s64 offen lds
    s_add_u32 m0, s21, 16384
    s_add_u32 s64, s65, 0x50000
    buffer_load_dwordx4 v4, s[44:47], s64 offen lds
    s_add_u32 m0, s21, 17408
    s_add_u32 s64, s65, 0x55000
    buffer_load_dwordx4 v4, s[44:47], s64 offen lds
    s_add_u32 m0, s21, 18432
    s_add_u32 s64, s65, 0x5a000
    buffer_load_dwordx4 v4, s[44:47], s64 offen lds
    s_add_u32 m0, s21, 19456
    s_add_u32 s64, s65, 0x5f000
    buffer_load_dwordx4 v4, s[44:47], s64 offen lds
    s_add_u32 m0, s21, 20480
    s_add_u32 s64, s65, 0x64000
    buffer_load_dwordx4 v4, s[44:47], s64 offen lds
    s_add_u32 m0, s21, 21504
    s_add_u32 s64, s65, 0x69000
    buffer_load_dwordx4 v4, s[44:47], s64 offen lds
    s_add_u32 m0, s21, 22528
    s_add_u32 s64, s65, 0x6e000
    buffer_load_dwordx4 v4, s[44:47], s64 offen lds
    s_add_u32 m0, s21, 23552
    s_add_u32 s64, s65, 0x73000
    buffer_load_dwordx4 v4, s[44:47], s64 offen lds
    s_add_u32 m0, s21, 24576
    s_add_u32 s64, s65, 0x78000
    buffer_load_dwordx4 v4, s[44:47], s64 offen lds
    s_add_u32 m0, s21, 25600
    s_add_u32 s64, s65, 0x7d000
    buffer_load_dwordx4 v4, s[44:47], s64 offen lds
    s_add_u32 m0, s21, 26624
    s_add_u32 s64, s65, 0x82000
    buffer_load_dwordx4 v4, s[44:47], s64 offen lds
    s_add_u32 m0, s21, 27648
    s_add_u32 s64, s65, 0x87000
    buffer_load_dwordx4 v4, s[44:47], s64 offen lds
    s_add_u32 m0, s21, 28672
    s_add_u32 s64, s65, 0x8c000
    buffer_load_dwordx4 v4, s[44:47], s64 offen lds
    s_add_u32 m0, s21, 29696
    s_add_u32 s64, s65, 0x91000
    buffer_load_dwordx4 v4, s[44:47], s64 offen lds
    s_add_u32 m0, s21, 30720
    s_add_u32 s64, s65, 0x96000
    buffer_load_dwordx4 v4, s[44:47], s64 offen lds
    s_add_u32 m0, s21, 31744
    s_add_u32 s64, s65, 0x9b000
    buffer_load_dwordx4 v4, s[44:47], s64 offen lds
    s_add_u32 m0, s21, 32768
    s_add_u32 s64, s65, 0xa0000
    buffer_load_dwordx4 v4, s[44:47], s64 offen lds
    s_add_u32 m0, s21, 33792
    s_add_u32 s64, s65, 0xa5000
    buffer_load_dwordx4 v4, s[44:47], s64 offen lds
    s_add_u32 m0, s21, 34816
    s_add_u32 s64, s65, 0xaa000
    buffer_load_dwordx4 v4, s[44:47], s64 offen lds
    s_add_u32 m0, s21, 35840
    s_add_u32 s64, s65, 0xaf000
    buffer_load_dwordx4 v4, s[44:47], s64 offen lds
    s_waitcnt vmcnt(32)
    ds_read_b64_tr_b16 a[0:1], v2 offset:0
    ds_read_b64_tr_b16 a[2:3], v2 offset:1024
    ds_read_b64_tr_b16 a[4:5], v3 offset:0
    ds_read_b64_tr_b16 a[6:7], v3 offset:1024
    ds_read_b64_tr_b16 a[8:9], v2 offset:2048
    ds_read_b64_tr_b16 a[10:11], v2 offset:3072
    ds_read_b64_tr_b16 a[12:13], v3 offset:2048
    ds_read_b64_tr_b16 a[14:15], v3 offset:3072
    s_waitcnt lgkmcnt(0)
    s_add_u32 m0, s21, 0
    s_add_u32 s64, s65, 0xb4000
    buffer_load_dwordx4 v4, s[44:47], s64 offen lds
    s_add_u32 m0, s21, 1024
    s_add_u32 s64, s65, 0xb9000
    buffer_load_dwordx4 v4, s[44:47], s64 offen lds
    s_add_u32 m0, s21, 2048
    s_add_u32 s64, s65, 0xbe000
    buffer_load_dwordx4 v4, s[44:47], s64 offen lds
    s_add_u32 m0, s21, 3072
    s_add_u32 s64, s65, 0xc3000
    buffer_load_dwordx4 v4, s[44:47], s64 offen lds
    s_waitcnt vmcnt(32)
    ds_read_b64_tr_b16 a[16:17], v2 offset:4096
    ds_read_b64_tr_b16 a[18:19], v2 offset:5120
    ds_read_b64_tr_b16 a[20:21], v3 offset:4096
    ds_read_b64_tr_b16 a[22:23], v3 offset:5120
    ds_read_b64_tr_b16 a[24:25], v2 offset:6144
    ds_read_b64_tr_b16 a[26:27], v2 offset:7168
    ds_read_b64_tr_b16 a[28:29], v3 offset:6144
    ds_read_b64_tr_b16 a[30:31], v3 offset:7168
    s_waitcnt lgkmcnt(0)
    s_add_u32 m0, s21, 4096
    s_add_u32 s64, s65, 0xc8000
    buffer_load_dwordx4 v4, s[44:47], s64 offen lds
    s_add_u32 m0, s21, 5120
    s_add_u32 s64, s65, 0xcd000
    buffer_load_dwordx4 v4, s[44:47], s64 offen lds
    s_add_u32 m0, s21, 6144
    s_add_u32 s64, s65, 0xd2000
    buffer_load_dwordx4 v4, s[44:47], s64 offen lds
    s_add_u32 m0, s21, 7168
    s_add_u32 s64, s65, 0xd7000
    buffer_load_dwordx4 v4, s[44:47], s64 offen lds
    s_waitcnt vmcnt(32)
    ds_read_b64_tr_b16 a[32:33], v2 offset:8192
    ds_read_b64_tr_b16 a[34:35], v2 offset:9216
    ds_read_b64_tr_b16 a[36:37], v3 offset:8192
    ds_read_b64_tr_b16 a[38:39], v3 offset:9216
    ds_read_b64_tr_b16 a[40:41], v2 offset:10240
    ds_read_b64_tr_b16 a[42:43], v2 offset:11264
    ds_read_b64_tr_b16 a[44:45], v3 offset:10240
    ds_read_b64_tr_b16 a[46:47], v3 offset:11264
    s_waitcnt lgkmcnt(0)
    s_add_u32 m0, s21, 8192
    s_add_u32 s64, s65, 0xdc000
    buffer_load_dwordx4 v4, s[44:47], s64 offen lds
    s_add_u32 m0, s21, 9216
    s_add_u32 s64, s65, 0xe1000
    buffer_load_dwordx4 v4, s[44:47], s64 offen lds
    s_add_u32 m0, s21, 10240
    s_add_u32 s64, s65, 0xe6000
    buffer_load_dwordx4 v4, s[44:47], s64 offen lds
    s_add_u32 m0, s21, 11264
    s_add_u32 s64, s65, 0xeb000
    buffer_load_dwordx4 v4, s[44:47], s64 offen lds
    s_waitcnt vmcnt(32)
    ds_read_b64_tr_b16 a[48:49], v2 offset:12288
    ds_read_b64_tr_b16 a[50:51], v2 offset:13312
    ds_read_b64_tr_b16 a[52:53], v3 offset:12288
    ds_read_b64_tr_b16 a[54:55], v3 offset:13312
    ds_read_b64_tr_b16 a[56:57], v2 offset:14336
    ds_read_b64_tr_b16 a[58:59], v2 offset:15360
    ds_read_b64_tr_b16 a[60:61], v3 offset:14336
    ds_read_b64_tr_b16 a[62:63], v3 offset:15360
    s_waitcnt lgkmcnt(0)
    s_add_u32 m0, s21, 12288
    s_add_u32 s64, s65, 0xf0000
    buffer_load_dwordx4 v4, s[44:47], s64 offen lds
    s_add_u32 m0, s21, 13312
    s_add_u32 s64, s65, 0xf5000
    buffer_load_dwordx4 v4, s[44:47], s64 offen lds
    s_add_u32 m0, s21, 14336
    s_add_u32 s64, s65, 0xfa000
    buffer_load_dwordx4 v4, s[44:47], s64 offen lds
    s_add_u32 m0, s21, 15360
    s_add_u32 s64, s65, 0xff000
    buffer_load_dwordx4 v4, s[44:47], s64 offen lds
    s_waitcnt vmcnt(32)
    ds_read_b64_tr_b16 a[64:65], v2 offset:16384
    ds_read_b64_tr_b16 a[66:67], v2 offset:17408
    ds_read_b64_tr_b16 a[68:69], v3 offset:16384
    ds_read_b64_tr_b16 a[70:71], v3 offset:17408
    ds_read_b64_tr_b16 a[72:73], v2 offset:18432
    ds_read_b64_tr_b16 a[74:75], v2 offset:19456
    ds_read_b64_tr_b16 a[76:77], v3 offset:18432
    ds_read_b64_tr_b16 a[78:79], v3 offset:19456
    s_waitcnt lgkmcnt(0)
    s_add_u32 m0, s21, 16384
    s_add_u32 s64, s65, 0x104000
    buffer_load_dwordx4 v4, s[44:47], s64 offen lds
    s_add_u32 m0, s21, 17408
    s_add_u32 s64, s65, 0x109000
    buffer_load_dwordx4 v4, s[44:47], s64 offen lds
    s_add_u32 m0, s21, 18432
    s_add_u32 s64, s65, 0x10e000
    buffer_load_dwordx4 v4, s[44:47], s64 offen lds
    s_add_u32 m0, s21, 19456
    s_add_u32 s64, s65, 0x113000
    buffer_load_dwordx4 v4, s[44:47], s64 offen lds
    s_waitcnt vmcnt(32)
    ds_read_b64_tr_b16 a[80:81], v2 offset:20480
    ds_read_b64_tr_b16 a[82:83], v2 offset:21504
    ds_read_b64_tr_b16 a[84:85], v3 offset:20480
    ds_read_b64_tr_b16 a[86:87], v3 offset:21504
    ds_read_b64_tr_b16 a[88:89], v2 offset:22528
    ds_read_b64_tr_b16 a[90:91], v2 offset:23552
    ds_read_b64_tr_b16 a[92:93], v3 offset:22528
    ds_read_b64_tr_b16 a[94:95], v3 offset:23552
    s_waitcnt lgkmcnt(0)
    s_add_u32 m0, s21, 20480
    s_add_u32 s64, s65, 0x118000
    buffer_load_dwordx4 v4, s[44:47], s64 offen lds
    s_add_u32 m0, s21, 21504
    s_add_u32 s64, s65, 0x11d000
    buffer_load_dwordx4 v4, s[44:47], s64 offen lds
    s_add_u32 m0, s21, 22528
    s_add_u32 s64, s65, 0x122000
    buffer_load_dwordx4 v4, s[44:47], s64 offen lds
    s_add_u32 m0, s21, 23552
    s_add_u32 s64, s65, 0x127000
    buffer_load_dwordx4 v4, s[44:47], s64 offen lds
    s_waitcnt vmcnt(32)
    ds_read_b64_tr_b16 a[96:97], v2 offset:24576
    ds_read_b64_tr_b16 a[98:99], v2 offset:25600
    ds_read_b64_tr_b16 a[100:101], v3 offset:24576
    ds_read_b64_tr_b16 a[102:103], v3 offset:25600
    ds_read_b64_tr_b16 a[104:105], v2 offset:26624
    ds_read_b64_tr_b16 a[106:107], v2 offset:27648
    ds_read_b64_tr_b16 a[108:109], v3 offset:26624
    ds_read_b64_tr_b16 a[110:111], v3 offset:27648
    s_waitcnt lgkmcnt(0)
    s_add_u32 m0, s21, 24576
    s_add_u32 s64, s65, 0x12c000
    buffer_load_dwordx4 v4, s[44:47], s64 offen lds
    s_add_u32 m0, s21, 25600
    s_add_u32 s64, s65, 0x131000
    buffer_load_dwordx4 v4, s[44:47], s64 offen lds
    s_add_u32 m0, s21, 26624
    s_add_u32 s64, s65, 0x136000
    buffer_load_dwordx4 v4, s[44:47], s64 offen lds
    s_add_u32 m0, s21, 27648
    s_add_u32 s64, s65, 0x13b000
    buffer_load_dwordx4 v4, s[44:47], s64 offen lds
    s_waitcnt vmcnt(32)
    ds_read_b64_tr_b16 a[112:113], v2 offset:28672
    ds_read_b64_tr_b16 a[114:115], v2 offset:29696
    ds_read_b64_tr_b16 a[116:117], v3 offset:28672
    ds_read_b64_tr_b16 a[118:119], v3 offset:29696
    ds_read_b64_tr_b16 a[120:121], v2 offset:30720
    ds_read_b64_tr_b16 a[122:123], v2 offset:31744
    ds_read_b64_tr_b16 a[124:125], v3 offset:30720
    ds_read_b64_tr_b16 a[126:127], v3 offset:31744
    s_waitcnt lgkmcnt(0)
    s_waitcnt vmcnt(28)
    ds_read_b64_tr_b16 a[128:129], v2 offset:32768
    ds_read_b64_tr_b16 a[130:131], v2 offset:33792
    ds_read_b64_tr_b16 a[132:133], v3 offset:32768
    ds_read_b64_tr_b16 a[134:135], v3 offset:33792
    ds_read_b64_tr_b16 a[136:137], v2 offset:34816
    ds_read_b64_tr_b16 a[138:139], v2 offset:35840
    ds_read_b64_tr_b16 a[140:141], v3 offset:34816
    ds_read_b64_tr_b16 a[142:143], v3 offset:35840
    s_waitcnt lgkmcnt(0)
    s_waitcnt vmcnt(24)
    ds_read_b64_tr_b16 a[144:145], v2 offset:0
    ds_read_b64_tr_b16 a[146:147], v2 offset:1024
    ds_read_b64_tr_b16 a[148:149], v3 offset:0
    ds_read_b64_tr_b16 a[150:151], v3 offset:1024
    ds_read_b64_tr_b16 a[152:153], v2 offset:2048
    ds_read_b64_tr_b16 a[154:155], v2 offset:3072
    ds_read_b64_tr_b16 a[156:157], v3 offset:2048
    ds_read_b64_tr_b16 a[158:159], v3 offset:3072
    s_waitcnt lgkmcnt(0)
    s_waitcnt vmcnt(20)
    ds_read_b64_tr_b16 a[160:161], v2 offset:4096
    ds_read_b64_tr_b16 a[162:163], v2 offset:5120
    ds_read_b64_tr_b16 a[164:165], v3 offset:4096
    ds_read_b64_tr_b16 a[166:167], v3 offset:5120
    ds_read_b64_tr_b16 a[168:169], v2 offset:6144
    ds_read_b64_tr_b16 a[170:171], v2 offset:7168
    ds_read_b64_tr_b16 a[172:173], v3 offset:6144
    ds_read_b64_tr_b16 a[174:175], v3 offset:7168
    s_waitcnt lgkmcnt(0)
    s_waitcnt vmcnt(16)
    ds_read_b64_tr_b16 a[176:177], v2 offset:8192
    ds_read_b64_tr_b16 a[178:179], v2 offset:9216
    ds_read_b64_tr_b16 a[180:181], v3 offset:8192
    ds_read_b64_tr_b16 a[182:183], v3 offset:9216
    ds_read_b64_tr_b16 a[184:185], v2 offset:10240
    ds_read_b64_tr_b16 a[186:187], v2 offset:11264
    ds_read_b64_tr_b16 a[188:189], v3 offset:10240
    ds_read_b64_tr_b16 a[190:191], v3 offset:11264
    s_waitcnt lgkmcnt(0)
    s_waitcnt vmcnt(12)
    ds_read_b64_tr_b16 a[192:193], v2 offset:12288
    ds_read_b64_tr_b16 a[194:195], v2 offset:13312
    ds_read_b64_tr_b16 a[196:197], v3 offset:12288
    ds_read_b64_tr_b16 a[198:199], v3 offset:13312
    ds_read_b64_tr_b16 a[200:201], v2 offset:14336
    ds_read_b64_tr_b16 a[202:203], v2 offset:15360
    ds_read_b64_tr_b16 a[204:205], v3 offset:14336
    ds_read_b64_tr_b16 a[206:207], v3 offset:15360
    s_waitcnt lgkmcnt(0)
    s_waitcnt vmcnt(8)
    ds_read_b64_tr_b16 a[208:209], v2 offset:16384
    ds_read_b64_tr_b16 a[210:211], v2 offset:17408
    ds_read_b64_tr_b16 a[212:213], v3 offset:16384
    ds_read_b64_tr_b16 a[214:215], v3 offset:17408
    ds_read_b64_tr_b16 a[216:217], v2 offset:18432
    ds_read_b64_tr_b16 a[218:219], v2 offset:19456
    ds_read_b64_tr_b16 a[220:221], v3 offset:18432
    ds_read_b64_tr_b16 a[222:223], v3 offset:19456
    s_waitcnt lgkmcnt(0)
    s_waitcnt vmcnt(4)
    ds_read_b64_tr_b16 a[224:225], v2 offset:20480
    ds_read_b64_tr_b16 a[226:227], v2 offset:21504
    ds_read_b64_tr_b16 a[228:229], v3 offset:20480
    ds_read_b64_tr_b16 a[230:231], v3 offset:21504
    ds_read_b64_tr_b16 a[232:233], v2 offset:22528
    ds_read_b64_tr_b16 a[234:235], v2 offset:23552
    ds_read_b64_tr_b16 a[236:237], v3 offset:22528
    ds_read_b64_tr_b16 a[238:239], v3 offset:23552
    s_waitcnt lgkmcnt(0)
    s_waitcnt vmcnt(0)
    ds_read_b64_tr_b16 a[240:241], v2 offset:24576
    ds_read_b64_tr_b16 a[242:243], v2 offset:25600
    ds_read_b64_tr_b16 a[244:245], v3 offset:24576
    ds_read_b64_tr_b16 a[246:247], v3 offset:25600
    ds_read_b64_tr_b16 a[248:249], v2 offset:26624
    ds_read_b64_tr_b16 a[250:251], v2 offset:27648
    ds_read_b64_tr_b16 a[252:253], v3 offset:26624
    ds_read_b64_tr_b16 a[254:255], v3 offset:27648
    s_waitcnt lgkmcnt(0)
    s_mov_b32 s13, s89
NOWO_152:
    v_mov_b32 v2, v10
    v_mov_b32 v3, v11
MKH_151:
    s_cmp_lg_u32 s24, 31
    s_mov_b64 exec, 0xf
    s_cbranch_scc1 MKL_153
    s_mov_b64 exec, -1
    v_bfe_u32 v4, v0, 3, 1
    v_mul_u32_u24 v4, 0x8000, v4
    v_sub_u32 v2, v2, v4
    s_mov_b64 exec, 3
MKL_153:
MKN_M_154:
    buffer_load_dword v5, v6, s[4:7], s28 offen sc1
    s_add_u32 s29, s29, 1
    s_waitcnt vmcnt(0)
    v_cmp_eq_u32 vcc, 0, v5
    s_cbranch_vccz MKN_MD_155
    s_cmp_gt_u32 s29, 262144
    s_cbranch_scc1 MKN_MD_155
    s_sleep 1
    s_branch MKN_M_154
MKN_MD_155:
    s_mov_b64 exec, -1
MKR_156:
    s_add_u32 s64, s25, 0x0
    buffer_load_dwordx4 v[16:19], v2, s[4:7], s64 offen sc1
    s_add_u32 s64, s25, 0x200
    buffer_load_dwordx4 v[20:23], v2, s[4:7], s64 offen sc1
    s_add_u32 s64, s25, 0x400
    buffer_load_dwordx4 v[24:27], v2, s[4:7], s64 offen sc1
    s_add_u32 s64, s25, 0x600
    buffer_load_dwordx4 v[28:31], v2, s[4:7], s64 offen sc1
    s_add_u32 s64, s25, 0x800
    buffer_load_dwordx4 v[32:35], v2, s[4:7], s64 offen sc1
    s_add_u32 s64, s25, 0xa00
    buffer_load_dwordx4 v[36:39], v2, s[4:7], s64 offen sc1
    s_add_u32 s64, s25, 0xc00
    buffer_load_dwordx4 v[40:43], v2, s[4:7], s64 offen sc1
    s_add_u32 s64, s25, 0xe00
    buffer_load_dwordx4 v[44:47], v2, s[4:7], s64 offen sc1
    s_add_u32 s64, s25, 0x1000
    buffer_load_dwordx4 v[48:51], v2, s[4:7], s64 offen sc1
    s_add_u32 s64, s25, 0x1200
    buffer_load_dwordx4 v[52:55], v2, s[4:7], s64 offen sc1
    s_add_u32 s64, s30, 0x0
    buffer_load_dwordx4 v[56:59], v2, s[4:7], s64 offen sc1
    s_add_u32 s64, s30, 0x200
    buffer_load_dwordx4 v[60:63], v2, s[4:7], s64 offen sc1
    s_add_u32 s64, s30, 0x400
    buffer_load_dwordx4 v[64:67], v2, s[4:7], s64 offen sc1
    s_add_u32 s64, s30, 0x600
    buffer_load_dwordx4 v[68:71], v2, s[4:7], s64 offen sc1
    s_add_u32 s64, s30, 0x800
    buffer_load_dwordx4 v[72:75], v2, s[4:7], s64 offen sc1
    s_add_u32 s64, s30, 0xa00
    buffer_load_dwordx4 v[76:79], v2, s[4:7], s64 offen sc1
    s_add_u32 s64, s30, 0xc00
    buffer_load_dwordx4 v[80:83], v2, s[4:7], s64 offen sc1
    s_add_u32 s64, s30, 0xe00
    buffer_load_dwordx4 v[84:87], v2, s[4:7], s64 offen sc1
    s_add_u32 s64, s30, 0x1000
    buffer_load_dwordx4 v[88:91], v2, s[4:7], s64 offen sc1
    s_add_u32 s64, s30, 0x1200
    buffer_load_dwordx4 v[92:95], v2, s[4:7], s64 offen sc1
    s_add_u32 s29, s29, 1
    s_waitcnt vmcnt(0)
    v_max3_u32 v4, v19, v23, v27
    v_max3_u32 v4, v4, v31, v35
    v_max3_u32 v4, v4, v39, v43
    v_max3_u32 v4, v4, v47, v51
    v_max3_u32 v4, v4, v55, v59
    v_max3_u32 v4, v4, v63, v67
    v_max3_u32 v4, v4, v71, v75
    v_max3_u32 v4, v4, v79, v83
    v_max3_u32 v4, v4, v87, v91
    v_max_u32 v4, v4, v95
    v_cmp_eq_u32 vcc, -1, v4
    s_cbranch_vccz MKO_157
    s_cmp_gt_u32 s29, 262144
    s_cbranch_scc0 MKR_156
MKO_157:
    v_mfma_f32_16x16x32_bf16 v[8:11], v[16:19], v[96:99], 0
    v_mfma_f32_16x16x32_bf16 v[12:15], v[16:19], v[100:103], 0
    v_mfma_f32_16x16x32_bf16 v[8:11], v[20:23], v[104:107], v[8:11]
    v_mfma_f32_16x16x32_bf16 v[12:15], v[20:23], v[108:111], v[12:15]
    v_mfma_f32_16x16x32_bf16 v[8:11], v[24:27], v[112:115], v[8:11]
    v_mfma_f32_16x16x32_bf16 v[12:15], v[24:27], v[116:119], v[12:15]
    v_mfma_f32_16x16x32_bf16 v[8:11], v[28:31], v[120:123], v[8:11]
    v_mfma_f32_16x16x32_bf16 v[12:15], v[28:31], v[124:127], v[12:15]
    v_mfma_f32_16x16x32_bf16 v[8:11], v[32:35], v[128:131], v[8:11]
    v_mfma_f32_16x16x32_bf16 v[12:15], v[32:35], v[132:135], v[12:15]
    v_mfma_f32_16x16x32_bf16 v[8:11], v[36:39], v[136:139], v[8:11]
    v_mfma_f32_16x16x32_bf16 v[12:15], v[36:39], v[140:143], v[12:15]
    v_mfma_f32_16x16x32_bf16 v[8:11], v[40:43], v[144:147], v[8:11]
    v_mfma_f32_16x16x32_bf16 v[12:15], v[40:43], v[148:151], v[12:15]
    v_mfma_f32_16x16x32_bf16 v[8:11], v[44:47], v[152:155], v[8:11]
    v_mfma_f32_16x16x32_bf16 v[12:15], v[44:47], v[156:159], v[12:15]
    v_mfma_f32_16x16x32_bf16 v[8:11], v[48:51], v[160:163], v[8:11]
    v_mfma_f32_16x16x32_bf16 v[12:15], v[48:51], v[164:167], v[12:15]
    v_mfma_f32_16x16x32_bf16 v[8:11], v[52:55], v[168:171], v[8:11]
    v_mfma_f32_16x16x32_bf16 v[12:15], v[52:55], v[172:175], v[12:15]
    v_mfma_f32_16x16x32_bf16 v[8:11], v[56:59], v[176:179], v[8:11]
    v_mfma_f32_16x16x32_bf16 v[12:15], v[56:59], v[180:183], v[12:15]
    v_mfma_f32_16x16x32_bf16 v[8:11], v[60:63], v[184:187], v[8:11]
    v_mfma_f32_16x16x32_bf16 v[12:15], v[60:63], v[188:191], v[12:15]
    v_mfma_f32_16x16x32_bf16 v[8:11], v[64:67], v[192:195], v[8:11]
    v_mfma_f32_16x16x32_bf16 v[12:15], v[64:67], v[196:199], v[12:15]
    v_mfma_f32_16x16x32_bf16 v[8:11], v[68:71], v[200:203], v[8:11]
    v_mfma_f32_16x16x32_bf16 v[12:15], v[68:71], v[204:207], v[12:15]
    v_mfma_f32_16x16x32_bf16 v[8:11], v[72:75], v[208:211], v[8:11]
    v_mfma_f32_16x16x32_bf16 v[12:15], v[72:75], v[212:215], v[12:15]
    v_mfma_f32_16x16x32_bf16 v[8:11], v[76:79], v[216:219], v[8:11]
    v_mfma_f32_16x16x32_bf16 v[12:15], v[76:79], v[220:223], v[12:15]
    v_mfma_f32_16x16x32_bf16 v[8:11], v[80:83], v[224:227], v[8:11]
    v_mfma_f32_16x16x32_bf16 v[12:15], v[80:83], v[228:231], v[12:15]
    v_mfma_f32_16x16x32_bf16 v[8:11], v[84:87], v[232:235], v[8:11]
    v_mfma_f32_16x16x32_bf16 v[12:15], v[84:87], v[236:239], v[12:15]
    v_mfma_f32_16x16x32_bf16 v[8:11], v[88:91], v[240:243], v[8:11]
    v_mfma_f32_16x16x32_bf16 v[12:15], v[88:91], v[244:247], v[12:15]
    v_mfma_f32_16x16x32_bf16 v[8:11], v[92:95], v[248:251], v[8:11]
    v_mfma_f32_16x16x32_bf16 v[12:15], v[92:95], v[252:255], v[12:15]
    s_nop 7
    v_cvt_pk_bf16_f32 v16, v8, v9
    v_cvt_pk_bf16_f32 v17, v10, v11
    v_cvt_pk_bf16_f32 v18, v12, v13
    v_cvt_pk_bf16_f32 v19, v14, v15
    buffer_store_dwordx2 v[16:17], v3, s[4:7], s26 offen sc1
    buffer_store_dwordx2 v[18:19], v3, s[4:7], s26 offen offset:256 sc1
    s_waitcnt vmcnt(0)
    s_barrier
    s_cmp_lg_u32 s14, 0
    s_cbranch_scc1 GF_158
    v_mov_b32 v7, 1
    v_mov_b32 v8, 0
    s_mov_b64 exec, 1
    buffer_store_dword v7, v8, s[4:7], s27 offen sc1
    s_mov_b64 exec, -1
GF_158:
    s_add_u32 s25, s25, 0x10000
    s_add_u32 s30, s30, 0x10000
    s_add_u32 s26, s26, 0x20000
    s_add_u32 s27, s27, 256
    s_add_u32 s28, s28, 512
    s_add_u32 s24, s24, 1
    s_cmp_lt_u32 s24, 32
    s_cbranch_scc1 MKN_LOOP
    s_cmp_ge_u32 s88, 60
    s_cbranch_scc1 M_EXIT
    s_branch H_EXTRA
H_OUT:
    s_lshl_b32 s64, s3, 5
    s_add_u32 s64, s64, s13
    s_cmp_ge_u32 s64, 60
    s_cbranch_scc1 M_EXIT
    s_mul_hi_u32 s12, s64, 0xccccccd
    s_mul_i32 s65, s12, 20
    s_sub_u32 s13, s64, s65
    s_load_dwordx2 s[44:45], s[0:1], 40
    s_mov_b32 s46, 0x500000
    s_mov_b32 s47, 0x00020000
    s_load_dwordx2 s[48:49], s[0:1], 0
    s_mov_b32 s50, 0x280000
    s_mov_b32 s51, 0x00020000
    s_load_dwordx2 s[52:53], s[0:1], 96
    s_mov_b32 s54, 0x280000
    s_mov_b32 s55, 0x00020000
    s_mov_b32 s36, -1
    s_mov_b32 s37, 0
    s_waitcnt lgkmcnt(0)
    s_mul_i32 s21, s14, 36864
    v_lshrrev_b32 v7, 2, v0
    v_mul_u32_u24 v4, 1280, v7
    v_bfe_u32 v7, v0, 4, 1
    v_lshlrev_b32 v7, 1, v7
    v_and_b32 v8, 3, v0
    v_xor_b32 v7, v7, v8
    v_lshl_add_u32 v4, v7, 4, v4
    v_lshrrev_b32 v7, 4, v0
    v_lshlrev_b32 v2, 8, v7
    v_bfe_u32 v7, v0, 2, 2
    v_lshl_add_u32 v2, v7, 6, v2
    v_and_b32 v7, 3, v0
    v_lshl_add_u32 v2, v7, 3, v2
    v_add_u32 v2, s21, v2
    v_bfe_u32 v7, v0, 4, 1
    v_lshlrev_b32 v7, 5, v7
    v_sub_u32 v3, 32, v7
    v_add_u32 v3, v3, v2
    v_add_u32 v2, v2, v7
    s_mul_i32 s65, s14, 1310720
    s_lshl_b32 s66, s13, 6
    s_add_u32 s65, s65, s66
    s_add_u32 m0, s21, 0
    s_add_u32 s64, s65, 0x0
    buffer_load_dwordx4 v4, s[44:47], s64 offen lds
    s_add_u32 m0, s21, 1024
    s_add_u32 s64, s65, 0x5000
    buffer_load_dwordx4 v4, s[44:47], s64 offen lds
    s_add_u32 m0, s21, 2048
    s_add_u32 s64, s65, 0xa000
    buffer_load_dwordx4 v4, s[44:47], s64 offen lds
    s_add_u32 m0, s21, 3072
    s_add_u32 s64, s65, 0xf000
    buffer_load_dwordx4 v4, s[44:47], s64 offen lds
    s_add_u32 m0, s21, 4096
    s_add_u32 s64, s65, 0x14000
    buffer_load_dwordx4 v4, s[44:47], s64 offen lds
    s_add_u32 m0, s21, 5120
    s_add_u32 s64, s65, 0x19000
    buffer_load_dwordx4 v4, s[44:47], s64 offen lds
    s_add_u32 m0, s21, 6144
    s_add_u32 s64, s65, 0x1e000
    buffer_load_dwordx4 v4, s[44:47], s64 offen lds
    s_add_u32 m0, s21, 7168
    s_add_u32 s64, s65, 0x23000
    buffer_load_dwordx4 v4, s[44:47], s64 offen lds
    s_add_u32 m0, s21, 8192
    s_add_u32 s64, s65, 0x28000
    buffer_load_dwordx4 v4, s[44:47], s64 offen lds
    s_add_u32 m0, s21, 9216
    s_add_u32 s64, s65, 0x2d000
    buffer_load_dwordx4 v4, s[44:47], s64 offen lds
    s_add_u32 m0, s21, 10240
    s_add_u32 s64, s65, 0x32000
    buffer_load_dwordx4 v4, s[44:47], s64 offen lds
    s_add_u32 m0, s21, 11264
    s_add_u32 s64, s65, 0x37000
    buffer_load_dwordx4 v4, s[44:47], s64 offen lds
    s_add_u32 m0, s21, 12288
    s_add_u32 s64, s65, 0x3c000
    buffer_load_dwordx4 v4, s[44:47], s64 offen lds
    s_add_u32 m0, s21, 13312
    s_add_u32 s64, s65, 0x41000
    buffer_load_dwordx4 v4, s[44:47], s64 offen lds
    s_add_u32 m0, s21, 14336
    s_add_u32 s64, s65, 0x46000
    buffer_load_dwordx4 v4, s[44:47], s64 offen lds
    s_add_u32 m0, s21, 15360
    s_add_u32 s64, s65, 0x4b000
    buffer_load_dwordx4 v4, s[44:47], s64 offen lds
    s_add_u32 m0, s21, 16384
    s_add_u32 s64, s65, 0x50000
    buffer_load_dwordx4 v4, s[44:47], s64 offen lds
    s_add_u32 m0, s21, 17408
    s_add_u32 s64, s65, 0x55000
    buffer_load_dwordx4 v4, s[44:47], s64 offen lds
    s_add_u32 m0, s21, 18432
    s_add_u32 s64, s65, 0x5a000
    buffer_load_dwordx4 v4, s[44:47], s64 offen lds
    s_add_u32 m0, s21, 19456
    s_add_u32 s64, s65, 0x5f000
    buffer_load_dwordx4 v4, s[44:47], s64 offen lds
    s_add_u32 m0, s21, 20480
    s_add_u32 s64, s65, 0x64000
    buffer_load_dwordx4 v4, s[44:47], s64 offen lds
    s_add_u32 m0, s21, 21504
    s_add_u32 s64, s65, 0x69000
    buffer_load_dwordx4 v4, s[44:47], s64 offen lds
    s_add_u32 m0, s21, 22528
    s_add_u32 s64, s65, 0x6e000
    buffer_load_dwordx4 v4, s[44:47], s64 offen lds
    s_add_u32 m0, s21, 23552
    s_add_u32 s64, s65, 0x73000
    buffer_load_dwordx4 v4, s[44:47], s64 offen lds
    s_add_u32 m0, s21, 24576
    s_add_u32 s64, s65, 0x78000
    buffer_load_dwordx4 v4, s[44:47], s64 offen lds
    s_add_u32 m0, s21, 25600
    s_add_u32 s64, s65, 0x7d000
    buffer_load_dwordx4 v4, s[44:47], s64 offen lds
    s_add_u32 m0, s21, 26624
    s_add_u32 s64, s65, 0x82000
    buffer_load_dwordx4 v4, s[44:47], s64 offen lds
    s_add_u32 m0, s21, 27648
    s_add_u32 s64, s65, 0x87000
    buffer_load_dwordx4 v4, s[44:47], s64 offen lds
    s_add_u32 m0, s21, 28672
    s_add_u32 s64, s65, 0x8c000
    buffer_load_dwordx4 v4, s[44:47], s64 offen lds
    s_add_u32 m0, s21, 29696
    s_add_u32 s64, s65, 0x91000
    buffer_load_dwordx4 v4, s[44:47], s64 offen lds
    s_add_u32 m0, s21, 30720
    s_add_u32 s64, s65, 0x96000
    buffer_load_dwordx4 v4, s[44:47], s64 offen lds
    s_add_u32 m0, s21, 31744
    s_add_u32 s64, s65, 0x9b000
    buffer_load_dwordx4 v4, s[44:47], s64 offen lds
    s_add_u32 m0, s21, 32768
    s_add_u32 s64, s65, 0xa0000
    buffer_load_dwordx4 v4, s[44:47], s64 offen lds
    s_add_u32 m0, s21, 33792
    s_add_u32 s64, s65, 0xa5000
    buffer_load_dwordx4 v4, s[44:47], s64 offen lds
    s_add_u32 m0, s21, 34816
    s_add_u32 s64, s65, 0xaa000
    buffer_load_dwordx4 v4, s[44:47], s64 offen lds
    s_add_u32 m0, s21, 35840
    s_add_u32 s64, s65, 0xaf000
    buffer_load_dwordx4 v4, s[44:47], s64 offen lds
    s_waitcnt vmcnt(32)
    ds_read_b64_tr_b16 a[0:1], v2 offset:0
    ds_read_b64_tr_b16 a[2:3], v2 offset:1024
    ds_read_b64_tr_b16 a[4:5], v3 offset:0
    ds_read_b64_tr_b16 a[6:7], v3 offset:1024
    ds_read_b64_tr_b16 a[8:9], v2 offset:2048
    ds_read_b64_tr_b16 a[10:11], v2 offset:3072
    ds_read_b64_tr_b16 a[12:13], v3 offset:2048
    ds_read_b64_tr_b16 a[14:15], v3 offset:3072
    s_waitcnt lgkmcnt(0)
    s_add_u32 m0, s21, 0
    s_add_u32 s64, s65, 0xb4000
    buffer_load_dwordx4 v4, s[44:47], s64 offen lds
    s_add_u32 m0, s21, 1024
    s_add_u32 s64, s65, 0xb9000
    buffer_load_dwordx4 v4, s[44:47], s64 offen lds
    s_add_u32 m0, s21, 2048
    s_add_u32 s64, s65, 0xbe000
    buffer_load_dwordx4 v4, s[44:47], s64 offen lds
    s_add_u32 m0, s21, 3072
    s_add_u32 s64, s65, 0xc3000
    buffer_load_dwordx4 v4, s[44:47], s64 offen lds
    s_waitcnt vmcnt(32)
    ds_read_b64_tr_b16 a[16:17], v2 offset:4096
    ds_read_b64_tr_b16 a[18:19], v2 offset:5120
    ds_read_b64_tr_b16 a[20:21], v3 offset:4096
    ds_read_b64_tr_b16 a[22:23], v3 offset:5120
    ds_read_b64_tr_b16 a[24:25], v2 offset:6144
    ds_read_b64_tr_b16 a[26:27], v2 offset:7168
    ds_read_b64_tr_b16 a[28:29], v3 offset:6144
    ds_read_b64_tr_b16 a[30:31], v3 offset:7168
    s_waitcnt lgkmcnt(0)
    s_add_u32 m0, s21, 4096
    s_add_u32 s64, s65, 0xc8000
    buffer_load_dwordx4 v4, s[44:47], s64 offen lds
    s_add_u32 m0, s21, 5120
    s_add_u32 s64, s65, 0xcd000
    buffer_load_dwordx4 v4, s[44:47], s64 offen lds
    s_add_u32 m0, s21, 6144
    s_add_u32 s64, s65, 0xd2000
    buffer_load_dwordx4 v4, s[44:47], s64 offen lds
    s_add_u32 m0, s21, 7168
    s_add_u32 s64, s65, 0xd7000
    buffer_load_dwordx4 v4, s[44:47], s64 offen lds
    s_waitcnt vmcnt(32)
    ds_read_b64_tr_b16 a[32:33], v2 offset:8192
    ds_read_b64_tr_b16 a[34:35], v2 offset:9216
    ds_read_b64_tr_b16 a[36:37], v3 offset:8192
    ds_read_b64_tr_b16 a[38:39], v3 offset:9216
    ds_read_b64_tr_b16 a[40:41], v2 offset:10240
    ds_read_b64_tr_b16 a[42:43], v2 offset:11264
    ds_read_b64_tr_b16 a[44:45], v3 offset:10240
    ds_read_b64_tr_b16 a[46:47], v3 offset:11264
    s_waitcnt lgkmcnt(0)
    s_add_u32 m0, s21, 8192
    s_add_u32 s64, s65, 0xdc000
    buffer_load_dwordx4 v4, s[44:47], s64 offen lds
    s_add_u32 m0, s21, 9216
    s_add_u32 s64, s65, 0xe1000
    buffer_load_dwordx4 v4, s[44:47], s64 offen lds
    s_add_u32 m0, s21, 10240
    s_add_u32 s64, s65, 0xe6000
    buffer_load_dwordx4 v4, s[44:47], s64 offen lds
    s_add_u32 m0, s21, 11264
    s_add_u32 s64, s65, 0xeb000
    buffer_load_dwordx4 v4, s[44:47], s64 offen lds
    s_waitcnt vmcnt(32)
    ds_read_b64_tr_b16 a[48:49], v2 offset:12288
    ds_read_b64_tr_b16 a[50:51], v2 offset:13312
    ds_read_b64_tr_b16 a[52:53], v3 offset:12288
    ds_read_b64_tr_b16 a[54:55], v3 offset:13312
    ds_read_b64_tr_b16 a[56:57], v2 offset:14336
    ds_read_b64_tr_b16 a[58:59], v2 offset:15360
    ds_read_b64_tr_b16 a[60:61], v3 offset:14336
    ds_read_b64_tr_b16 a[62:63], v3 offset:15360
    s_waitcnt lgkmcnt(0)
    s_add_u32 m0, s21, 12288
    s_add_u32 s64, s65, 0xf0000
    buffer_load_dwordx4 v4, s[44:47], s64 offen lds
    s_add_u32 m0, s21, 13312
    s_add_u32 s64, s65, 0xf5000
    buffer_load_dwordx4 v4, s[44:47], s64 offen lds
    s_add_u32 m0, s21, 14336
    s_add_u32 s64, s65, 0xfa000
    buffer_load_dwordx4 v4, s[44:47], s64 offen lds
    s_add_u32 m0, s21, 15360
    s_add_u32 s64, s65, 0xff000
    buffer_load_dwordx4 v4, s[44:47], s64 offen lds
    s_waitcnt vmcnt(32)
    ds_read_b64_tr_b16 a[64:65], v2 offset:16384
    ds_read_b64_tr_b16 a[66:67], v2 offset:17408
    ds_read_b64_tr_b16 a[68:69], v3 offset:16384
    ds_read_b64_tr_b16 a[70:71], v3 offset:17408
    ds_read_b64_tr_b16 a[72:73], v2 offset:18432
    ds_read_b64_tr_b16 a[74:75], v2 offset:19456
    ds_read_b64_tr_b16 a[76:77], v3 offset:18432
    ds_read_b64_tr_b16 a[78:79], v3 offset:19456
    s_waitcnt lgkmcnt(0)
    s_add_u32 m0, s21, 16384
    s_add_u32 s64, s65, 0x104000
    buffer_load_dwordx4 v4, s[44:47], s64 offen lds
    s_add_u32 m0, s21, 17408
    s_add_u32 s64, s65, 0x109000
    buffer_load_dwordx4 v4, s[44:47], s64 offen lds
    s_add_u32 m0, s21, 18432
    s_add_u32 s64, s65, 0x10e000
    buffer_load_dwordx4 v4, s[44:47], s64 offen lds
    s_add_u32 m0, s21, 19456
    s_add_u32 s64, s65, 0x113000
    buffer_load_dwordx4 v4, s[44:47], s64 offen lds
    s_waitcnt vmcnt(32)
    ds_read_b64_tr_b16 a[80:81], v2 offset:20480
    ds_read_b64_tr_b16 a[82:83], v2 offset:21504
    ds_read_b64_tr_b16 a[84:85], v3 offset:20480
    ds_read_b64_tr_b16 a[86:87], v3 offset:21504
    ds_read_b64_tr_b16 a[88:89], v2 offset:22528
    ds_read_b64_tr_b16 a[90:91], v2 offset:23552
    ds_read_b64_tr_b16 a[92:93], v3 offset:22528
    ds_read_b64_tr_b16 a[94:95], v3 offset:23552
    s_waitcnt lgkmcnt(0)
    s_add_u32 m0, s21, 20480
    s_add_u32 s64, s65, 0x118000
    buffer_load_dwordx4 v4, s[44:47], s64 offen lds
    s_add_u32 m0, s21, 21504
    s_add_u32 s64, s65, 0x11d000
    buffer_load_dwordx4 v4, s[44:47], s64 offen lds
    s_add_u32 m0, s21, 22528
    s_add_u32 s64, s65, 0x122000
    buffer_load_dwordx4 v4, s[44:47], s64 offen lds
    s_add_u32 m0, s21, 23552
    s_add_u32 s64, s65, 0x127000
    buffer_load_dwordx4 v4, s[44:47], s64 offen lds
    s_waitcnt vmcnt(32)
    ds_read_b64_tr_b16 a[96:97], v2 offset:24576
    ds_read_b64_tr_b16 a[98:99], v2 offset:25600
    ds_read_b64_tr_b16 a[100:101], v3 offset:24576
    ds_read_b64_tr_b16 a[102:103], v3 offset:25600
    ds_read_b64_tr_b16 a[104:105], v2 offset:26624
    ds_read_b64_tr_b16 a[106:107], v2 offset:27648
    ds_read_b64_tr_b16 a[108:109], v3 offset:26624
    ds_read_b64_tr_b16 a[110:111], v3 offset:27648
    s_waitcnt lgkmcnt(0)
    s_add_u32 m0, s21, 24576
    s_add_u32 s64, s65, 0x12c000
    buffer_load_dwordx4 v4, s[44:47], s64 offen lds
    s_add_u32 m0, s21, 25600
    s_add_u32 s64, s65, 0x131000
    buffer_load_dwordx4 v4, s[44:47], s64 offen lds
    s_add_u32 m0, s21, 26624
    s_add_u32 s64, s65, 0x136000
    buffer_load_dwordx4 v4, s[44:47], s64 offen lds
    s_add_u32 m0, s21, 27648
    s_add_u32 s64, s65, 0x13b000
    buffer_load_dwordx4 v4, s[44:47], s64 offen lds
    s_waitcnt vmcnt(32)
    ds_read_b64_tr_b16 a[112:113], v2 offset:28672
    ds_read_b64_tr_b16 a[114:115], v2 offset:29696
    ds_read_b64_tr_b16 a[116:117], v3 offset:28672
    ds_read_b64_tr_b16 a[118:119], v3 offset:29696
    ds_read_b64_tr_b16 a[120:121], v2 offset:30720
    ds_read_b64_tr_b16 a[122:123], v2 offset:31744
    ds_read_b64_tr_b16 a[124:125], v3 offset:30720
    ds_read_b64_tr_b16 a[126:127], v3 offset:31744
    s_waitcnt lgkmcnt(0)
    s_waitcnt vmcnt(28)
    ds_read_b64_tr_b16 a[128:129], v2 offset:32768
    ds_read_b64_tr_b16 a[130:131], v2 offset:33792
    ds_read_b64_tr_b16 a[132:133], v3 offset:32768
    ds_read_b64_tr_b16 a[134:135], v3 offset:33792
    ds_read_b64_tr_b16 a[136:137], v2 offset:34816
    ds_read_b64_tr_b16 a[138:139], v2 offset:35840
    ds_read_b64_tr_b16 a[140:141], v3 offset:34816
    ds_read_b64_tr_b16 a[142:143], v3 offset:35840
    s_waitcnt lgkmcnt(0)
    s_waitcnt vmcnt(24)
    ds_read_b64_tr_b16 a[144:145], v2 offset:0
    ds_read_b64_tr_b16 a[146:147], v2 offset:1024
    ds_read_b64_tr_b16 a[148:149], v3 offset:0
    ds_read_b64_tr_b16 a[150:151], v3 offset:1024
    ds_read_b64_tr_b16 a[152:153], v2 offset:2048
    ds_read_b64_tr_b16 a[154:155], v2 offset:3072
    ds_read_b64_tr_b16 a[156:157], v3 offset:2048
    ds_read_b64_tr_b16 a[158:159], v3 offset:3072
    s_waitcnt lgkmcnt(0)
    s_waitcnt vmcnt(20)
    ds_read_b64_tr_b16 a[160:161], v2 offset:4096
    ds_read_b64_tr_b16 a[162:163], v2 offset:5120
    ds_read_b64_tr_b16 a[164:165], v3 offset:4096
    ds_read_b64_tr_b16 a[166:167], v3 offset:5120
    ds_read_b64_tr_b16 a[168:169], v2 offset:6144
    ds_read_b64_tr_b16 a[170:171], v2 offset:7168
    ds_read_b64_tr_b16 a[172:173], v3 offset:6144
    ds_read_b64_tr_b16 a[174:175], v3 offset:7168
    s_waitcnt lgkmcnt(0)
    s_waitcnt vmcnt(16)
    ds_read_b64_tr_b16 a[176:177], v2 offset:8192
    ds_read_b64_tr_b16 a[178:179], v2 offset:9216
    ds_read_b64_tr_b16 a[180:181], v3 offset:8192
    ds_read_b64_tr_b16 a[182:183], v3 offset:9216
    ds_read_b64_tr_b16 a[184:185], v2 offset:10240
    ds_read_b64_tr_b16 a[186:187], v2 offset:11264
    ds_read_b64_tr_b16 a[188:189], v3 offset:10240
    ds_read_b64_tr_b16 a[190:191], v3 offset:11264
    s_waitcnt lgkmcnt(0)
    s_waitcnt vmcnt(12)
    ds_read_b64_tr_b16 a[192:193], v2 offset:12288
    ds_read_b64_tr_b16 a[194:195], v2 offset:13312
    ds_read_b64_tr_b16 a[196:197], v3 offset:12288
    ds_read_b64_tr_b16 a[198:199], v3 offset:13312
    ds_read_b64_tr_b16 a[200:201], v2 offset:14336
    ds_read_b64_tr_b16 a[202:203], v2 offset:15360
    ds_read_b64_tr_b16 a[204:205], v3 offset:14336
    ds_read_b64_tr_b16 a[206:207], v3 offset:15360
    s_waitcnt lgkmcnt(0)
    s_waitcnt vmcnt(8)
    ds_read_b64_tr_b16 a[208:209], v2 offset:16384
    ds_read_b64_tr_b16 a[210:211], v2 offset:17408
    ds_read_b64_tr_b16 a[212:213], v3 offset:16384
    ds_read_b64_tr_b16 a[214:215], v3 offset:17408
    ds_read_b64_tr_b16 a[216:217], v2 offset:18432
    ds_read_b64_tr_b16 a[218:219], v2 offset:19456
    ds_read_b64_tr_b16 a[220:221], v3 offset:18432
    ds_read_b64_tr_b16 a[222:223], v3 offset:19456
    s_waitcnt lgkmcnt(0)
    s_waitcnt vmcnt(4)
    ds_read_b64_tr_b16 a[224:225], v2 offset:20480
    ds_read_b64_tr_b16 a[226:227], v2 offset:21504
    ds_read_b64_tr_b16 a[228:229], v3 offset:20480
    ds_read_b64_tr_b16 a[230:231], v3 offset:21504
    ds_read_b64_tr_b16 a[232:233], v2 offset:22528
    ds_read_b64_tr_b16 a[234:235], v2 offset:23552
    ds_read_b64_tr_b16 a[236:237], v3 offset:22528
    ds_read_b64_tr_b16 a[238:239], v3 offset:23552
    s_waitcnt lgkmcnt(0)
    s_waitcnt vmcnt(0)
    ds_read_b64_tr_b16 a[240:241], v2 offset:24576
    ds_read_b64_tr_b16 a[242:243], v2 offset:25600
    ds_read_b64_tr_b16 a[244:245], v3 offset:24576
    ds_read_b64_tr_b16 a[246:247], v3 offset:25600
    ds_read_b64_tr_b16 a[248:249], v2 offset:26624
    ds_read_b64_tr_b16 a[250:251], v2 offset:27648
    ds_read_b64_tr_b16 a[252:253], v3 offset:26624
    ds_read_b64_tr_b16 a[254:255], v3 offset:27648
    s_waitcnt lgkmcnt(0)
    s_barrier
    s_mov_b32 s29, 0
    v_lshlrev_b32 v1, 4, v0
    v_mov_b32 v8, 0
    s_mov_b32 s64, 0x298000
OUS_159:
    buffer_load_dword v7, v8, s[4:7], s64 offen sc1
    s_add_u32 s29, s29, 1
    s_waitcnt vmcnt(0)
    v_cmp_gt_u32 vcc, 1, v7
    s_cbranch_vccz OUSD_160
    s_cmp_gt_u32 s29, 262144
    s_cbranch_scc1 OUSD_160
    s_sleep 8
    s_branch OUS_159
OUSD_160:
    v_lshlrev_b32 v6, 2, v0
    s_mov_b32 s64, 0x5400000
    buffer_load_dword v7, v6, s[4:7], s64 offen sc1
    s_waitcnt vmcnt(0)
    v_readlane_b32 s72, v7, 0
    v_readlane_b32 s73, v7, 1
    v_readlane_b32 s74, v7, 2
    v_readlane_b32 s75, v7, 3
    v_readlane_b32 s76, v7, 4
    v_readlane_b32 s77, v7, 5
    v_readlane_b32 s78, v7, 6
    v_readlane_b32 s79, v7, 7
    s_and_b32 s64, s14, 1
    s_lshl_b32 s64, s64, 4
    v_and_b32 v6, 15, v0
    v_add_u32 v6, s64, v6
    v_mov_b32 v9, v6
    v_mul_u32_u24 v5, 1280, v6
    v_lshrrev_b32 v6, 4, v0
    v_lshl_add_u32 v5, v6, 3, v5
    s_lshr_b32 s64, s14, 1
    s_lshl_b32 s64, s64, 5
    s_lshl_b32 s65, s13, 6
    s_add_u32 s64, s64, s65
    v_add_u32 v5, s64, v5
    v_lshlrev_b32 v6, 2, v0
    s_mov_b32 s80, 0x49249249
    s_mov_b32 s81, 0x92492492
    s_lshl_b64 s[80:81], s[80:81], s12
    s_bitset0_b64 s[80:81], 63
    s_bitset0_b64 s[80:81], 62
    s_mov_b64 s[82:83], 0
    s_lshr_b32 s64, s72, 5
    s_bitset1_b64 s[82:83], s64
    s_lshr_b32 s64, s73, 5
    s_bitset1_b64 s[82:83], s64
    s_lshr_b32 s64, s74, 5
    s_bitset1_b64 s[82:83], s64
    s_lshr_b32 s64, s75, 5
    s_bitset1_b64 s[82:83], s64
    s_lshr_b32 s64, s76, 5
    s_bitset1_b64 s[82:83], s64
    s_lshr_b32 s64, s77, 5
    s_bitset1_b64 s[82:83], s64
    s_lshr_b32 s64, s78, 5
    s_bitset1_b64 s[82:83], s64
    s_lshr_b32 s64, s79, 5
    s_bitset1_b64 s[82:83], s64
OU_LOOP:
    s_cmp_eq_u64 s[80:81], 0
    s_cbranch_scc1 OU_END
    s_andn2_b64 s[84:85], s[80:81], s[82:83]
    s_cbranch_scc0 OU_WM
    s_ff1_i32_b64 s24, s[84:85]
    s_branch OU_GO
OU_WM:
    v_mov_b32 v8, 0
    s_mov_b32 s64, 0x298100
OUW_161:
    buffer_load_dword v7, v8, s[4:7], s64 offen sc1
    s_add_u32 s29, s29, 1
    s_waitcnt vmcnt(0)
    v_cmp_gt_u32 vcc, 40, v7
    s_cbranch_vccz OUWD_162
    s_cmp_gt_u32 s29, 262144
    s_cbranch_scc1 OUWD_162
    s_sleep 8
    s_branch OUW_161
OUWD_162:
    s_mov_b64 s[82:83], 0
    s_branch OU_LOOP
OU_GO:
    s_bitset0_b64 s[80:81], s24
    s_lshr_b32 s86, s14, 1
    s_mul_i32 s67, s24, 40960
    buffer_load_dwordx2 v[160:161], v5, s[48:51], s67 offen
    s_add_u32 s64, s67, 0x0
    buffer_load_dwordx2 v[162:163], v5, s[4:7], s64 offen
    s_mov_b32 s64, 0x298100
    buffer_load_dword v12, off, s[4:7], s64 sc1
    s_lshl_b32 s64, s24, 7
    s_add_u32 s64, s64, 0x296000
    s_mov_b64 exec, s[36:37]
OU_F_163:
    buffer_load_dword v7, v6, s[4:7], s64 offen sc1
    s_add_u32 s29, s29, 1
    s_waitcnt vmcnt(0)
    v_cmp_eq_u32 vcc, 0, v7
    s_cbranch_vccz OU_FD_164
    s_cmp_gt_u32 s29, 262144
    s_cbranch_scc1 OU_FD_164
    s_sleep 1
    s_branch OU_F_163
OU_FD_164:
    s_mov_b64 exec, -1
    s_lshl_b32 s25, s24, 18
    s_lshl_b32 s64, s14, 15
    s_add_u32 s25, s25, s64
    s_add_u32 s25, s25, 0x4400000
    s_add_u32 s64, s25, 0x0
    buffer_load_dwordx4 v[16:19], v1, s[4:7], s64 offen
    s_add_u32 s64, s25, 0x20000
    buffer_load_dwordx4 v[20:23], v1, s[4:7], s64 offen
    s_add_u32 s64, s25, 0x400
    buffer_load_dwordx4 v[24:27], v1, s[4:7], s64 offen
    s_add_u32 s64, s25, 0x20400
    buffer_load_dwordx4 v[28:31], v1, s[4:7], s64 offen
    s_add_u32 s64, s25, 0x800
    buffer_load_dwordx4 v[32:35], v1, s[4:7], s64 offen
    s_add_u32 s64, s25, 0x20800
    buffer_load_dwordx4 v[36:39], v1, s[4:7], s64 offen
    s_add_u32 s64, s25, 0xc00
    buffer_load_dwordx4 v[40:43], v1, s[4:7], s64 offen
    s_add_u32 s64, s25, 0x20c00
    buffer_load_dwordx4 v[44:47], v1, s[4:7], s64 offen
    s_add_u32 s64, s25, 0x1000
    buffer_load_dwordx4 v[48:51], v1, s[4:7], s64 offen
    s_add_u32 s64, s25, 0x21000
    buffer_load_dwordx4 v[52:55], v1, s[4:7], s64 offen
    s_add_u32 s64, s25, 0x1400
    buffer_load_dwordx4 v[56:59], v1, s[4:7], s64 offen
    s_add_u32 s64, s25, 0x21400
    buffer_load_dwordx4 v[60:63], v1, s[4:7], s64 offen
    s_add_u32 s64, s25, 0x1800
    buffer_load_dwordx4 v[64:67], v1, s[4:7], s64 offen
    s_add_u32 s64, s25, 0x21800
    buffer_load_dwordx4 v[68:71], v1, s[4:7], s64 offen
    s_add_u32 s64, s25, 0x1c00
    buffer_load_dwordx4 v[72:75], v1, s[4:7], s64 offen
    s_add_u32 s64, s25, 0x21c00
    buffer_load_dwordx4 v[76:79], v1, s[4:7], s64 offen
    s_add_u32 s64, s25, 0x2000
    buffer_load_dwordx4 v[80:83], v1, s[4:7], s64 offen
    s_add_u32 s64, s25, 0x22000
    buffer_load_dwordx4 v[84:87], v1, s[4:7], s64 offen
    s_add_u32 s64, s25, 0x2400
    buffer_load_dwordx4 v[88:91], v1, s[4:7], s64 offen
    s_add_u32 s64, s25, 0x22400
    buffer_load_dwordx4 v[92:95], v1, s[4:7], s64 offen
    s_add_u32 s64, s25, 0x2800
    buffer_load_dwordx4 v[96:99], v1, s[4:7], s64 offen
    s_add_u32 s64, s25, 0x22800
    buffer_load_dwordx4 v[100:103], v1, s[4:7], s64 offen
    s_add_u32 s64, s25, 0x2c00
    buffer_load_dwordx4 v[104:107], v1, s[4:7], s64 offen
    s_add_u32 s64, s25, 0x22c00
    buffer_load_dwordx4 v[108:111], v1, s[4:7], s64 offen
    s_add_u32 s64, s25, 0x3000
    buffer_load_dwordx4 v[112:115], v1, s[4:7], s64 offen
    s_add_u32 s64, s25, 0x23000
    buffer_load_dwordx4 v[116:119], v1, s[4:7], s64 offen
    s_add_u32 s64, s25, 0x3400
    buffer_load_dwordx4 v[120:123], v1, s[4:7], s64 offen
    s_add_u32 s64, s25, 0x23400
    buffer_load_dwordx4 v[124:127], v1, s[4:7], s64 offen
    s_add_u32 s64, s25, 0x3800
    buffer_load_dwordx4 v[128:131], v1, s[4:7], s64 offen
    s_add_u32 s64, s25, 0x23800
    buffer_load_dwordx4 v[132:135], v1, s[4:7], s64 offen
    s_add_u32 s64, s25, 0x3c00
    buffer_load_dwordx4 v[136:139], v1, s[4:7], s64 offen
    s_add_u32 s64, s25, 0x23c00
    buffer_load_dwordx4 v[140:143], v1, s[4:7], s64 offen
    s_waitcnt vmcnt(30)
    v_mfma_f32_16x16x32_bf16 v[144:147], a[0:3], v[16:19], 0
    v_mfma_f32_16x16x32_bf16 v[148:151], a[0:3], v[20:23], 0
    v_mfma_f32_16x16x32_bf16 v[152:155], a[4:7], v[16:19], 0
    v_mfma_f32_16x16x32_bf16 v[156:159], a[4:7], v[20:23], 0
    s_add_u32 s64, s25, 0x4000
    buffer_load_dwordx4 v[16:19], v1, s[4:7], s64 offen
    s_add_u32 s64, s25, 0x24000
    buffer_load_dwordx4 v[20:23], v1, s[4:7], s64 offen
    s_waitcnt vmcnt(30)
    v_mfma_f32_16x16x32_bf16 v[144:147], a[8:11], v[24:27], v[144:147]
    v_mfma_f32_16x16x32_bf16 v[148:151], a[8:11], v[28:31], v[148:151]
    v_mfma_f32_16x16x32_bf16 v[152:155], a[12:15], v[24:27], v[152:155]
    v_mfma_f32_16x16x32_bf16 v[156:159], a[12:15], v[28:31], v[156:159]
    s_add_u32 s64, s25, 0x4400
    buffer_load_dwordx4 v[24:27], v1, s[4:7], s64 offen
    s_add_u32 s64, s25, 0x24400
    buffer_load_dwordx4 v[28:31], v1, s[4:7], s64 offen
    s_waitcnt vmcnt(30)
    v_mfma_f32_16x16x32_bf16 v[144:147], a[16:19], v[32:35], v[144:147]
    v_mfma_f32_16x16x32_bf16 v[148:151], a[16:19], v[36:39], v[148:151]
    v_mfma_f32_16x16x32_bf16 v[152:155], a[20:23], v[32:35], v[152:155]
    v_mfma_f32_16x16x32_bf16 v[156:159], a[20:23], v[36:39], v[156:159]
    s_add_u32 s64, s25, 0x4800
    buffer_load_dwordx4 v[32:35], v1, s[4:7], s64 offen
    s_add_u32 s64, s25, 0x24800
    buffer_load_dwordx4 v[36:39], v1, s[4:7], s64 offen
    s_waitcnt vmcnt(30)
    v_mfma_f32_16x16x32_bf16 v[144:147], a[24:27], v[40:43], v[144:147]
    v_mfma_f32_16x16x32_bf16 v[148:151], a[24:27], v[44:47], v[148:151]
    v_mfma_f32_16x16x32_bf16 v[152:155], a[28:31], v[40:43], v[152:155]
    v_mfma_f32_16x16x32_bf16 v[156:159], a[28:31], v[44:47], v[156:159]
    s_add_u32 s64, s25, 0x4c00
    buffer_load_dwordx4 v[40:43], v1, s[4:7], s64 offen
    s_add_u32 s64, s25, 0x24c00
    buffer_load_dwordx4 v[44:47], v1, s[4:7], s64 offen
    s_waitcnt vmcnt(30)
    v_mfma_f32_16x16x32_bf16 v[144:147], a[32:35], v[48:51], v[144:147]
    v_mfma_f32_16x16x32_bf16 v[148:151], a[32:35], v[52:55], v[148:151]
    v_mfma_f32_16x16x32_bf16 v[152:155], a[36:39], v[48:51], v[152:155]
    v_mfma_f32_16x16x32_bf16 v[156:159], a[36:39], v[52:55], v[156:159]
    s_add_u32 s64, s25, 0x5000
    buffer_load_dwordx4 v[48:51], v1, s[4:7], s64 offen
    s_add_u32 s64, s25, 0x25000
    buffer_load_dwordx4 v[52:55], v1, s[4:7], s64 offen
    s_waitcnt vmcnt(30)
    v_mfma_f32_16x16x32_bf16 v[144:147], a[40:43], v[56:59], v[144:147]
    v_mfma_f32_16x16x32_bf16 v[148:151], a[40:43], v[60:63], v[148:151]
    v_mfma_f32_16x16x32_bf16 v[152:155], a[44:47], v[56:59], v[152:155]
    v_mfma_f32_16x16x32_bf16 v[156:159], a[44:47], v[60:63], v[156:159]
    s_add_u32 s64, s25, 0x5400
    buffer_load_dwordx4 v[56:59], v1, s[4:7], s64 offen
    s_add_u32 s64, s25, 0x25400
    buffer_load_dwordx4 v[60:63], v1, s[4:7], s64 offen
    s_waitcnt vmcnt(30)
    v_mfma_f32_16x16x32_bf16 v[144:147], a[48:51], v[64:67], v[144:147]
    v_mfma_f32_16x16x32_bf16 v[148:151], a[48:51], v[68:71], v[148:151]
    v_mfma_f32_16x16x32_bf16 v[152:155], a[52:55], v[64:67], v[152:155]
    v_mfma_f32_16x16x32_bf16 v[156:159], a[52:55], v[68:71], v[156:159]
    s_add_u32 s64, s25, 0x5800
    buffer_load_dwordx4 v[64:67], v1, s[4:7], s64 offen
    s_add_u32 s64, s25, 0x25800
    buffer_load_dwordx4 v[68:71], v1, s[4:7], s64 offen
    s_waitcnt vmcnt(30)
    v_mfma_f32_16x16x32_bf16 v[144:147], a[56:59], v[72:75], v[144:147]
    v_mfma_f32_16x16x32_bf16 v[148:151], a[56:59], v[76:79], v[148:151]
    v_mfma_f32_16x16x32_bf16 v[152:155], a[60:63], v[72:75], v[152:155]
    v_mfma_f32_16x16x32_bf16 v[156:159], a[60:63], v[76:79], v[156:159]
    s_add_u32 s64, s25, 0x5c00
    buffer_load_dwordx4 v[72:75], v1, s[4:7], s64 offen
    s_add_u32 s64, s25, 0x25c00
    buffer_load_dwordx4 v[76:79], v1, s[4:7], s64 offen
    s_waitcnt vmcnt(30)
    v_mfma_f32_16x16x32_bf16 v[144:147], a[64:67], v[80:83], v[144:147]
    v_mfma_f32_16x16x32_bf16 v[148:151], a[64:67], v[84:87], v[148:151]
    v_mfma_f32_16x16x32_bf16 v[152:155], a[68:71], v[80:83], v[152:155]
    v_mfma_f32_16x16x32_bf16 v[156:159], a[68:71], v[84:87], v[156:159]
    s_add_u32 s64, s25, 0x6000
    buffer_load_dwordx4 v[80:83], v1, s[4:7], s64 offen
    s_add_u32 s64, s25, 0x26000
    buffer_load_dwordx4 v[84:87], v1, s[4:7], s64 offen
    s_waitcnt vmcnt(30)
    v_mfma_f32_16x16x32_bf16 v[144:147], a[72:75], v[88:91], v[144:147]
    v_mfma_f32_16x16x32_bf16 v[148:151], a[72:75], v[92:95], v[148:151]
    v_mfma_f32_16x16x32_bf16 v[152:155], a[76:79], v[88:91], v[152:155]
    v_mfma_f32_16x16x32_bf16 v[156:159], a[76:79], v[92:95], v[156:159]
    s_add_u32 s64, s25, 0x6400
    buffer_load_dwordx4 v[88:91], v1, s[4:7], s64 offen
    s_add_u32 s64, s25, 0x26400
    buffer_load_dwordx4 v[92:95], v1, s[4:7], s64 offen
    s_waitcnt vmcnt(30)
    v_mfma_f32_16x16x32_bf16 v[144:147], a[80:83], v[96:99], v[144:147]
    v_mfma_f32_16x16x32_bf16 v[148:151], a[80:83], v[100:103], v[148:151]
    v_mfma_f32_16x16x32_bf16 v[152:155], a[84:87], v[96:99], v[152:155]
    v_mfma_f32_16x16x32_bf16 v[156:159], a[84:87], v[100:103], v[156:159]
    s_add_u32 s64, s25, 0x6800
    buffer_load_dwordx4 v[96:99], v1, s[4:7], s64 offen
    s_add_u32 s64, s25, 0x26800
    buffer_load_dwordx4 v[100:103], v1, s[4:7], s64 offen
    s_waitcnt vmcnt(30)
    v_mfma_f32_16x16x32_bf16 v[144:147], a[88:91], v[104:107], v[144:147]
    v_mfma_f32_16x16x32_bf16 v[148:151], a[88:91], v[108:111], v[148:151]
    v_mfma_f32_16x16x32_bf16 v[152:155], a[92:95], v[104:107], v[152:155]
    v_mfma_f32_16x16x32_bf16 v[156:159], a[92:95], v[108:111], v[156:159]
    s_add_u32 s64, s25, 0x6c00
    buffer_load_dwordx4 v[104:107], v1, s[4:7], s64 offen
    s_add_u32 s64, s25, 0x26c00
    buffer_load_dwordx4 v[108:111], v1, s[4:7], s64 offen
    s_waitcnt vmcnt(30)
    v_mfma_f32_16x16x32_bf16 v[144:147], a[96:99], v[112:115], v[144:147]
    v_mfma_f32_16x16x32_bf16 v[148:151], a[96:99], v[116:119], v[148:151]
    v_mfma_f32_16x16x32_bf16 v[152:155], a[100:103], v[112:115], v[152:155]
    v_mfma_f32_16x16x32_bf16 v[156:159], a[100:103], v[116:119], v[156:159]
    s_add_u32 s64, s25, 0x7000
    buffer_load_dwordx4 v[112:115], v1, s[4:7], s64 offen
    s_add_u32 s64, s25, 0x27000
    buffer_load_dwordx4 v[116:119], v1, s[4:7], s64 offen
    s_waitcnt vmcnt(30)
    v_mfma_f32_16x16x32_bf16 v[144:147], a[104:107], v[120:123], v[144:147]
    v_mfma_f32_16x16x32_bf16 v[148:151], a[104:107], v[124:127], v[148:151]
    v_mfma_f32_16x16x32_bf16 v[152:155], a[108:111], v[120:123], v[152:155]
    v_mfma_f32_16x16x32_bf16 v[156:159], a[108:111], v[124:127], v[156:159]
    s_add_u32 s64, s25, 0x7400
    buffer_load_dwordx4 v[120:123], v1, s[4:7], s64 offen
    s_add_u32 s64, s25, 0x27400
    buffer_load_dwordx4 v[124:127], v1, s[4:7], s64 offen
    s_waitcnt vmcnt(30)
    v_mfma_f32_16x16x32_bf16 v[144:147], a[112:115], v[128:131], v[144:147]
    v_mfma_f32_16x16x32_bf16 v[148:151], a[112:115], v[132:135], v[148:151]
    v_mfma_f32_16x16x32_bf16 v[152:155], a[116:119], v[128:131], v[152:155]
    v_mfma_f32_16x16x32_bf16 v[156:159], a[116:119], v[132:135], v[156:159]
    s_add_u32 s64, s25, 0x7800
    buffer_load_dwordx4 v[128:131], v1, s[4:7], s64 offen
    s_add_u32 s64, s25, 0x27800
    buffer_load_dwordx4 v[132:135], v1, s[4:7], s64 offen
    s_waitcnt vmcnt(30)
    v_mfma_f32_16x16x32_bf16 v[144:147], a[120:123], v[136:139], v[144:147]
    v_mfma_f32_16x16x32_bf16 v[148:151], a[120:123], v[140:143], v[148:151]
    v_mfma_f32_16x16x32_bf16 v[152:155], a[124:127], v[136:139], v[152:155]
    v_mfma_f32_16x16x32_bf16 v[156:159], a[124:127], v[140:143], v[156:159]
    s_add_u32 s64, s25, 0x7c00
    buffer_load_dwordx4 v[136:139], v1, s[4:7], s64 offen
    s_add_u32 s64, s25, 0x27c00
    buffer_load_dwordx4 v[140:143], v1, s[4:7], s64 offen
    s_waitcnt vmcnt(30)
    v_mfma_f32_16x16x32_bf16 v[144:147], a[128:131], v[16:19], v[144:147]
    v_mfma_f32_16x16x32_bf16 v[148:151], a[128:131], v[20:23], v[148:151]
    v_mfma_f32_16x16x32_bf16 v[152:155], a[132:135], v[16:19], v[152:155]
    v_mfma_f32_16x16x32_bf16 v[156:159], a[132:135], v[20:23], v[156:159]
    s_waitcnt vmcnt(28)
    v_mfma_f32_16x16x32_bf16 v[144:147], a[136:139], v[24:27], v[144:147]
    v_mfma_f32_16x16x32_bf16 v[148:151], a[136:139], v[28:31], v[148:151]
    v_mfma_f32_16x16x32_bf16 v[152:155], a[140:143], v[24:27], v[152:155]
    v_mfma_f32_16x16x32_bf16 v[156:159], a[140:143], v[28:31], v[156:159]
    s_waitcnt vmcnt(26)
    v_mfma_f32_16x16x32_bf16 v[144:147], a[144:147], v[32:35], v[144:147]
    v_mfma_f32_16x16x32_bf16 v[148:151], a[144:147], v[36:39], v[148:151]
    v_mfma_f32_16x16x32_bf16 v[152:155], a[148:151], v[32:35], v[152:155]
    v_mfma_f32_16x16x32_bf16 v[156:159], a[148:151], v[36:39], v[156:159]
    s_waitcnt vmcnt(24)
    v_mfma_f32_16x16x32_bf16 v[144:147], a[152:155], v[40:43], v[144:147]
    v_mfma_f32_16x16x32_bf16 v[148:151], a[152:155], v[44:47], v[148:151]
    v_mfma_f32_16x16x32_bf16 v[152:155], a[156:159], v[40:43], v[152:155]
    v_mfma_f32_16x16x32_bf16 v[156:159], a[156:159], v[44:47], v[156:159]
    s_waitcnt vmcnt(22)
    v_mfma_f32_16x16x32_bf16 v[144:147], a[160:163], v[48:51], v[144:147]
    v_mfma_f32_16x16x32_bf16 v[148:151], a[160:163], v[52:55], v[148:151]
    v_mfma_f32_16x16x32_bf16 v[152:155], a[164:167], v[48:51], v[152:155]
    v_mfma_f32_16x16x32_bf16 v[156:159], a[164:167], v[52:55], v[156:159]
    s_waitcnt vmcnt(20)
    v_mfma_f32_16x16x32_bf16 v[144:147], a[168:171], v[56:59], v[144:147]
    v_mfma_f32_16x16x32_bf16 v[148:151], a[168:171], v[60:63], v[148:151]
    v_mfma_f32_16x16x32_bf16 v[152:155], a[172:175], v[56:59], v[152:155]
    v_mfma_f32_16x16x32_bf16 v[156:159], a[172:175], v[60:63], v[156:159]
    s_waitcnt vmcnt(18)
    v_mfma_f32_16x16x32_bf16 v[144:147], a[176:179], v[64:67], v[144:147]
    v_mfma_f32_16x16x32_bf16 v[148:151], a[176:179], v[68:71], v[148:151]
    v_mfma_f32_16x16x32_bf16 v[152:155], a[180:183], v[64:67], v[152:155]
    v_mfma_f32_16x16x32_bf16 v[156:159], a[180:183], v[68:71], v[156:159]
    s_waitcnt vmcnt(16)
    v_mfma_f32_16x16x32_bf16 v[144:147], a[184:187], v[72:75], v[144:147]
    v_mfma_f32_16x16x32_bf16 v[148:151], a[184:187], v[76:79], v[148:151]
    v_mfma_f32_16x16x32_bf16 v[152:155], a[188:191], v[72:75], v[152:155]
    v_mfma_f32_16x16x32_bf16 v[156:159], a[188:191], v[76:79], v[156:159]
    s_waitcnt vmcnt(14)
    v_mfma_f32_16x16x32_bf16 v[144:147], a[192:195], v[80:83], v[144:147]
    v_mfma_f32_16x16x32_bf16 v[148:151], a[192:195], v[84:87], v[148:151]
    v_mfma_f32_16x16x32_bf16 v[152:155], a[196:199], v[80:83], v[152:155]
    v_mfma_f32_16x16x32_bf16 v[156:159], a[196:199], v[84:87], v[156:159]
    s_waitcnt vmcnt(12)
    v_mfma_f32_16x16x32_bf16 v[144:147], a[200:203], v[88:91], v[144:147]
    v_mfma_f32_16x16x32_bf16 v[148:151], a[200:203], v[92:95], v[148:151]
    v_mfma_f32_16x16x32_bf16 v[152:155], a[204:207], v[88:91], v[152:155]
    v_mfma_f32_16x16x32_bf16 v[156:159], a[204:207], v[92:95], v[156:159]
    s_waitcnt vmcnt(10)
    v_mfma_f32_16x16x32_bf16 v[144:147], a[208:211], v[96:99], v[144:147]
    v_mfma_f32_16x16x32_bf16 v[148:151], a[208:211], v[100:103], v[148:151]
    v_mfma_f32_16x16x32_bf16 v[152:155], a[212:215], v[96:99], v[152:155]
    v_mfma_f32_16x16x32_bf16 v[156:159], a[212:215], v[100:103], v[156:159]
    s_waitcnt vmcnt(8)
    v_mfma_f32_16x16x32_bf16 v[144:147], a[216:219], v[104:107], v[144:147]
    v_mfma_f32_16x16x32_bf16 v[148:151], a[216:219], v[108:111], v[148:151]
    v_mfma_f32_16x16x32_bf16 v[152:155], a[220:223], v[104:107], v[152:155]
    v_mfma_f32_16x16x32_bf16 v[156:159], a[220:223], v[108:111], v[156:159]
    s_waitcnt vmcnt(6)
    v_mfma_f32_16x16x32_bf16 v[144:147], a[224:227], v[112:115], v[144:147]
    v_mfma_f32_16x16x32_bf16 v[148:151], a[224:227], v[116:119], v[148:151]
    v_mfma_f32_16x16x32_bf16 v[152:155], a[228:231], v[112:115], v[152:155]
    v_mfma_f32_16x16x32_bf16 v[156:159], a[228:231], v[116:119], v[156:159]
    s_waitcnt vmcnt(4)
    v_mfma_f32_16x16x32_bf16 v[144:147], a[232:235], v[120:123], v[144:147]
    v_mfma_f32_16x16x32_bf16 v[148:151], a[232:235], v[124:127], v[148:151]
    v_mfma_f32_16x16x32_bf16 v[152:155], a[236:239], v[120:123], v[152:155]
    v_mfma_f32_16x16x32_bf16 v[156:159], a[236:239], v[124:127], v[156:159]
    s_waitcnt vmcnt(2)
    v_mfma_f32_16x16x32_bf16 v[144:147], a[240:243], v[128:131], v[144:147]
    v_mfma_f32_16x16x32_bf16 v[148:151], a[240:243], v[132:135], v[148:151]
    v_mfma_f32_16x16x32_bf16 v[152:155], a[244:247], v[128:131], v[152:155]
    v_mfma_f32_16x16x32_bf16 v[156:159], a[244:247], v[132:135], v[156:159]
    s_waitcnt vmcnt(0)
    v_mfma_f32_16x16x32_bf16 v[144:147], a[248:251], v[136:139], v[144:147]
    v_mfma_f32_16x16x32_bf16 v[148:151], a[248:251], v[140:143], v[148:151]
    v_mfma_f32_16x16x32_bf16 v[152:155], a[252:255], v[136:139], v[152:155]
    v_mfma_f32_16x16x32_bf16 v[156:159], a[252:255], v[140:143], v[156:159]
    s_lshl_b32 s64, s14, 12
    v_add_u32 v7, s64, v1
    s_barrier
    s_nop 3
    ds_write_b128 v7, v[144:147] offset:0
    ds_write_b128 v7, v[148:151] offset:1024
    ds_write_b128 v7, v[152:155] offset:2048
    ds_write_b128 v7, v[156:159] offset:3072
    v_mov_b32 v13, 16384
    s_cmp_lg_u32 s14, 0
    s_cbranch_scc1 OW0_165
    ds_write_b32 v13, v12
OW0_165:
    s_waitcnt lgkmcnt(0)
    s_barrier
    ds_read_b32 v12, v13
    s_waitcnt lgkmcnt(0)
    v_readfirstlane_b32 s64, v12
    s_cmp_lt_u32 s64, 40
    s_cselect_b64 s[82:83], s[82:83], 0
    s_lshl_b32 s64, s14, 10
    v_add_u32 v7, s64, v1
    ds_read_b128 v[16:19], v7 offset:0
    ds_read_b128 v[20:23], v7 offset:4096
    ds_read_b128 v[24:27], v7 offset:8192
    ds_read_b128 v[28:31], v7 offset:12288
    s_waitcnt lgkmcnt(0)
    v_add_f32 v16, v16, v20
    v_add_f32 v24, v24, v28
    v_add_f32 v16, v16, v24
    v_add_f32 v17, v17, v21
    v_add_f32 v25, v25, v29
    v_add_f32 v17, v17, v25
    v_add_f32 v18, v18, v22
    v_add_f32 v26, v26, v30
    v_add_f32 v18, v18, v26
    v_add_f32 v19, v19, v23
    v_add_f32 v27, v27, v31
    v_add_f32 v19, v19, v27
    v_cvt_pk_bf16_f32 v16, v16, v16
    v_lshlrev_b32 v16, 16, v16
    v_cvt_pk_bf16_f32 v17, v17, v17
    v_lshlrev_b32 v17, 16, v17
    v_cvt_pk_bf16_f32 v18, v18, v18
    v_lshlrev_b32 v18, 16, v18
    v_cvt_pk_bf16_f32 v19, v19, v19
    v_lshlrev_b32 v19, 16, v19
    v_lshlrev_b32 v20, 16, v162
    v_and_b32 v21, 0xffff0000, v162
    v_lshlrev_b32 v24, 16, v160
    v_and_b32 v25, 0xffff0000, v160
    v_lshlrev_b32 v22, 16, v163
    v_and_b32 v23, 0xffff0000, v163
    v_lshlrev_b32 v26, 16, v161
    v_and_b32 v27, 0xffff0000, v161
    s_lshl_b32 s64, s24, 5
    v_add_u32 v8, s64, v9
    v_mov_b32 v10, -1
    v_cmp_eq_u32 vcc, s72, v8
    s_nop 1
    v_cndmask_b32 v10, v10, 0, vcc
    v_cmp_eq_u32 vcc, s73, v8
    s_nop 1
    v_cndmask_b32 v10, v10, 1, vcc
    v_cmp_eq_u32 vcc, s74, v8
    s_nop 1
    v_cndmask_b32 v10, v10, 2, vcc
    v_cmp_eq_u32 vcc, s75, v8
    s_nop 1
    v_cndmask_b32 v10, v10, 3, vcc
    v_cmp_eq_u32 vcc, s76, v8
    s_nop 1
    v_cndmask_b32 v10, v10, 4, vcc
    v_cmp_eq_u32 vcc, s77, v8
    s_nop 1
    v_cndmask_b32 v10, v10, 5, vcc
    v_cmp_eq_u32 vcc, s78, v8
    s_nop 1
    v_cndmask_b32 v10, v10, 6, vcc
    v_cmp_eq_u32 vcc, s79, v8
    s_nop 1
    v_cndmask_b32 v10, v10, 7, vcc
    v_cmp_le_i32 vcc, 0, v10
    s_and_saveexec_b64 s[68:69], vcc
    s_cbranch_execz NOUPD_167
    v_mul_u32_u24 v10, 2560, v10
    v_lshrrev_b32 v11, 4, v0
    v_lshl_add_u32 v10, v11, 4, v10
    s_lshl_b32 s64, s86, 6
    s_lshl_b32 s65, s13, 7
    s_add_u32 s64, s64, s65
    s_add_u32 s64, s64, 0x5410000
    buffer_load_dwordx4 v[164:167], v10, s[4:7], s64 offen sc1
    s_waitcnt vmcnt(0)
    v_add_f32 v20, v20, v164
    v_cvt_pk_bf16_f32 v20, v20, v20
    v_lshlrev_b32 v20, 16, v20
    v_add_f32 v21, v21, v165
    v_cvt_pk_bf16_f32 v21, v21, v21
    v_lshlrev_b32 v21, 16, v21
    v_add_f32 v22, v22, v166
    v_cvt_pk_bf16_f32 v22, v22, v22
    v_lshlrev_b32 v22, 16, v22
    v_add_f32 v23, v23, v167
    v_cvt_pk_bf16_f32 v23, v23, v23
    v_lshlrev_b32 v23, 16, v23
NOUPD_167:
    s_mov_b64 exec, -1
    v_mul_f32 v28, 0xbfb8aa3b, v20
    v_exp_f32 v28, v28
    s_nop 0
    v_add_f32 v28, 1.0, v28
    v_rcp_f32 v28, v28
    s_nop 0
    v_mul_f32 v28, v28, v20
    v_cvt_pk_bf16_f32 v28, v28, v28
    v_lshlrev_b32 v28, 16, v28
    v_mul_f32 v28, v28, v16
    v_cvt_pk_bf16_f32 v28, v28, v28
    v_lshlrev_b32 v28, 16, v28
    v_add_f32 v28, v28, v24
    v_mul_f32 v29, 0xbfb8aa3b, v21
    v_exp_f32 v29, v29
    s_nop 0
    v_add_f32 v29, 1.0, v29
    v_rcp_f32 v29, v29
    s_nop 0
    v_mul_f32 v29, v29, v21
    v_cvt_pk_bf16_f32 v29, v29, v29
    v_lshlrev_b32 v29, 16, v29
    v_mul_f32 v29, v29, v17
    v_cvt_pk_bf16_f32 v29, v29, v29
    v_lshlrev_b32 v29, 16, v29
    v_add_f32 v29, v29, v25
    v_mul_f32 v30, 0xbfb8aa3b, v22
    v_exp_f32 v30, v30
    s_nop 0
    v_add_f32 v30, 1.0, v30
    v_rcp_f32 v30, v30
    s_nop 0
    v_mul_f32 v30, v30, v22
    v_cvt_pk_bf16_f32 v30, v30, v30
    v_lshlrev_b32 v30, 16, v30
    v_mul_f32 v30, v30, v18
    v_cvt_pk_bf16_f32 v30, v30, v30
    v_lshlrev_b32 v30, 16, v30
    v_add_f32 v30, v30, v26
    v_mul_f32 v31, 0xbfb8aa3b, v23
    v_exp_f32 v31, v31
    s_nop 0
    v_add_f32 v31, 1.0, v31
    v_rcp_f32 v31, v31
    s_nop 0
    v_mul_f32 v31, v31, v23
    v_cvt_pk_bf16_f32 v31, v31, v31
    v_lshlrev_b32 v31, 16, v31
    v_mul_f32 v31, v31, v19
    v_cvt_pk_bf16_f32 v31, v31, v31
    v_lshlrev_b32 v31, 16, v31
    v_add_f32 v31, v31, v27
    v_cvt_pk_bf16_f32 v164, v28, v29
    v_cvt_pk_bf16_f32 v165, v30, v31
    buffer_store_dwordx2 v[164:165], v5, s[52:55], s67 offen
OTD_166:
    s_branch OU_LOOP
OU_END:
    s_cmp_lg_u32 s12, 2
    s_cbranch_scc1 OU_X
    v_mov_b32 v8, 0
    s_mov_b32 s64, 0x298100
OUW_168:
    buffer_load_dword v7, v8, s[4:7], s64 offen sc1
    s_add_u32 s29, s29, 1
    s_waitcnt vmcnt(0)
    v_cmp_gt_u32 vcc, 40, v7
    s_cbranch_vccz OUWD_169
    s_cmp_gt_u32 s29, 262144
    s_cbranch_scc1 OUWD_169
    s_sleep 8
    s_branch OUW_168
OUWD_169:
    s_mov_b32 s24, 62
    s_mov_b32 s87, 0
    s_and_b32 s86, s14, 1
    s_lshl_b32 s64, s87, 4
    v_and_b32 v6, 15, v0
    v_add_u32 v6, s64, v6
    v_mov_b32 v9, v6
    v_mul_u32_u24 v5, 1280, v6
    v_lshrrev_b32 v6, 4, v0
    v_lshl_add_u32 v5, v6, 3, v5
    s_and_b32 s64, s14, 1
    s_lshl_b32 s64, s64, 5
    s_lshl_b32 s65, s13, 6
    s_add_u32 s64, s64, s65
    v_add_u32 v5, s64, v5
    v_lshlrev_b32 v6, 2, v0
    s_mul_i32 s67, s24, 40960
    buffer_load_dwordx2 v[160:161], v5, s[48:51], s67 offen
    s_add_u32 s64, s67, 0x0
    buffer_load_dwordx2 v[162:163], v5, s[4:7], s64 offen
    s_lshl_b32 s64, s24, 7
    s_add_u32 s64, s64, 0x296000
    s_mov_b64 exec, s[36:37]
OUH_F_170:
    buffer_load_dword v7, v6, s[4:7], s64 offen sc1
    s_add_u32 s29, s29, 1
    s_waitcnt vmcnt(0)
    v_cmp_eq_u32 vcc, 0, v7
    s_cbranch_vccz OUH_FD_171
    s_cmp_gt_u32 s29, 262144
    s_cbranch_scc1 OUH_FD_171
    s_sleep 1
    s_branch OUH_F_170
OUH_FD_171:
    s_mov_b64 exec, -1
    s_lshl_b32 s25, s24, 18
    s_lshl_b32 s64, s14, 15
    s_add_u32 s25, s25, s64
    s_add_u32 s25, s25, 0x4400000
    s_lshl_b32 s64, s87, 17
    s_add_u32 s25, s25, s64
    s_add_u32 s64, s25, 0x0
    buffer_load_dwordx4 v[16:19], v1, s[4:7], s64 offen
    s_add_u32 s64, s25, 0x400
    buffer_load_dwordx4 v[20:23], v1, s[4:7], s64 offen
    s_add_u32 s64, s25, 0x800
    buffer_load_dwordx4 v[24:27], v1, s[4:7], s64 offen
    s_add_u32 s64, s25, 0xc00
    buffer_load_dwordx4 v[28:31], v1, s[4:7], s64 offen
    s_add_u32 s64, s25, 0x1000
    buffer_load_dwordx4 v[32:35], v1, s[4:7], s64 offen
    s_add_u32 s64, s25, 0x1400
    buffer_load_dwordx4 v[36:39], v1, s[4:7], s64 offen
    s_add_u32 s64, s25, 0x1800
    buffer_load_dwordx4 v[40:43], v1, s[4:7], s64 offen
    s_add_u32 s64, s25, 0x1c00
    buffer_load_dwordx4 v[44:47], v1, s[4:7], s64 offen
    s_add_u32 s64, s25, 0x2000
    buffer_load_dwordx4 v[48:51], v1, s[4:7], s64 offen
    s_add_u32 s64, s25, 0x2400
    buffer_load_dwordx4 v[52:55], v1, s[4:7], s64 offen
    s_add_u32 s64, s25, 0x2800
    buffer_load_dwordx4 v[56:59], v1, s[4:7], s64 offen
    s_add_u32 s64, s25, 0x2c00
    buffer_load_dwordx4 v[60:63], v1, s[4:7], s64 offen
    s_add_u32 s64, s25, 0x3000
    buffer_load_dwordx4 v[64:67], v1, s[4:7], s64 offen
    s_add_u32 s64, s25, 0x3400
    buffer_load_dwordx4 v[68:71], v1, s[4:7], s64 offen
    s_add_u32 s64, s25, 0x3800
    buffer_load_dwordx4 v[72:75], v1, s[4:7], s64 offen
    s_add_u32 s64, s25, 0x3c00
    buffer_load_dwordx4 v[76:79], v1, s[4:7], s64 offen
    s_add_u32 s64, s25, 0x4000
    buffer_load_dwordx4 v[80:83], v1, s[4:7], s64 offen
    s_add_u32 s64, s25, 0x4400
    buffer_load_dwordx4 v[84:87], v1, s[4:7], s64 offen
    s_add_u32 s64, s25, 0x4800
    buffer_load_dwordx4 v[88:91], v1, s[4:7], s64 offen
    s_add_u32 s64, s25, 0x4c00
    buffer_load_dwordx4 v[92:95], v1, s[4:7], s64 offen
    s_add_u32 s64, s25, 0x5000
    buffer_load_dwordx4 v[96:99], v1, s[4:7], s64 offen
    s_add_u32 s64, s25, 0x5400
    buffer_load_dwordx4 v[100:103], v1, s[4:7], s64 offen
    s_add_u32 s64, s25, 0x5800
    buffer_load_dwordx4 v[104:107], v1, s[4:7], s64 offen
    s_add_u32 s64, s25, 0x5c00
    buffer_load_dwordx4 v[108:111], v1, s[4:7], s64 offen
    s_add_u32 s64, s25, 0x6000
    buffer_load_dwordx4 v[112:115], v1, s[4:7], s64 offen
    s_add_u32 s64, s25, 0x6400
    buffer_load_dwordx4 v[116:119], v1, s[4:7], s64 offen
    s_add_u32 s64, s25, 0x6800
    buffer_load_dwordx4 v[120:123], v1, s[4:7], s64 offen
    s_add_u32 s64, s25, 0x6c00
    buffer_load_dwordx4 v[124:127], v1, s[4:7], s64 offen
    s_add_u32 s64, s25, 0x7000
    buffer_load_dwordx4 v[128:131], v1, s[4:7], s64 offen
    s_add_u32 s64, s25, 0x7400
    buffer_load_dwordx4 v[132:135], v1, s[4:7], s64 offen
    s_add_u32 s64, s25, 0x7800
    buffer_load_dwordx4 v[136:139], v1, s[4:7], s64 offen
    s_add_u32 s64, s25, 0x7c00
    buffer_load_dwordx4 v[140:143], v1, s[4:7], s64 offen
    s_waitcnt vmcnt(31)
    v_mfma_f32_16x16x32_bf16 v[144:147], a[0:3], v[16:19], 0
    v_mfma_f32_16x16x32_bf16 v[148:151], a[4:7], v[16:19], 0
    s_waitcnt vmcnt(30)
    v_mfma_f32_16x16x32_bf16 v[144:147], a[8:11], v[20:23], v[144:147]
    v_mfma_f32_16x16x32_bf16 v[148:151], a[12:15], v[20:23], v[148:151]
    s_waitcnt vmcnt(29)
    v_mfma_f32_16x16x32_bf16 v[144:147], a[16:19], v[24:27], v[144:147]
    v_mfma_f32_16x16x32_bf16 v[148:151], a[20:23], v[24:27], v[148:151]
    s_waitcnt vmcnt(28)
    v_mfma_f32_16x16x32_bf16 v[144:147], a[24:27], v[28:31], v[144:147]
    v_mfma_f32_16x16x32_bf16 v[148:151], a[28:31], v[28:31], v[148:151]
    s_waitcnt vmcnt(27)
    v_mfma_f32_16x16x32_bf16 v[144:147], a[32:35], v[32:35], v[144:147]
    v_mfma_f32_16x16x32_bf16 v[148:151], a[36:39], v[32:35], v[148:151]
    s_waitcnt vmcnt(26)
    v_mfma_f32_16x16x32_bf16 v[144:147], a[40:43], v[36:39], v[144:147]
    v_mfma_f32_16x16x32_bf16 v[148:151], a[44:47], v[36:39], v[148:151]
    s_waitcnt vmcnt(25)
    v_mfma_f32_16x16x32_bf16 v[144:147], a[48:51], v[40:43], v[144:147]
    v_mfma_f32_16x16x32_bf16 v[148:151], a[52:55], v[40:43], v[148:151]
    s_waitcnt vmcnt(24)
    v_mfma_f32_16x16x32_bf16 v[144:147], a[56:59], v[44:47], v[144:147]
    v_mfma_f32_16x16x32_bf16 v[148:151], a[60:63], v[44:47], v[148:151]
    s_waitcnt vmcnt(23)
    v_mfma_f32_16x16x32_bf16 v[144:147], a[64:67], v[48:51], v[144:147]
    v_mfma_f32_16x16x32_bf16 v[148:151], a[68:71], v[48:51], v[148:151]
    s_waitcnt vmcnt(22)
    v_mfma_f32_16x16x32_bf16 v[144:147], a[72:75], v[52:55], v[144:147]
    v_mfma_f32_16x16x32_bf16 v[148:151], a[76:79], v[52:55], v[148:151]
    s_waitcnt vmcnt(21)
    v_mfma_f32_16x16x32_bf16 v[144:147], a[80:83], v[56:59], v[144:147]
    v_mfma_f32_16x16x32_bf16 v[148:151], a[84:87], v[56:59], v[148:151]
    s_waitcnt vmcnt(20)
    v_mfma_f32_16x16x32_bf16 v[144:147], a[88:91], v[60:63], v[144:147]
    v_mfma_f32_16x16x32_bf16 v[148:151], a[92:95], v[60:63], v[148:151]
    s_waitcnt vmcnt(19)
    v_mfma_f32_16x16x32_bf16 v[144:147], a[96:99], v[64:67], v[144:147]
    v_mfma_f32_16x16x32_bf16 v[148:151], a[100:103], v[64:67], v[148:151]
    s_waitcnt vmcnt(18)
    v_mfma_f32_16x16x32_bf16 v[144:147], a[104:107], v[68:71], v[144:147]
    v_mfma_f32_16x16x32_bf16 v[148:151], a[108:111], v[68:71], v[148:151]
    s_waitcnt vmcnt(17)
    v_mfma_f32_16x16x32_bf16 v[144:147], a[112:115], v[72:75], v[144:147]
    v_mfma_f32_16x16x32_bf16 v[148:151], a[116:119], v[72:75], v[148:151]
    s_waitcnt vmcnt(16)
    v_mfma_f32_16x16x32_bf16 v[144:147], a[120:123], v[76:79], v[144:147]
    v_mfma_f32_16x16x32_bf16 v[148:151], a[124:127], v[76:79], v[148:151]
    s_waitcnt vmcnt(15)
    v_mfma_f32_16x16x32_bf16 v[144:147], a[128:131], v[80:83], v[144:147]
    v_mfma_f32_16x16x32_bf16 v[148:151], a[132:135], v[80:83], v[148:151]
    s_waitcnt vmcnt(14)
    v_mfma_f32_16x16x32_bf16 v[144:147], a[136:139], v[84:87], v[144:147]
    v_mfma_f32_16x16x32_bf16 v[148:151], a[140:143], v[84:87], v[148:151]
    s_waitcnt vmcnt(13)
    v_mfma_f32_16x16x32_bf16 v[144:147], a[144:147], v[88:91], v[144:147]
    v_mfma_f32_16x16x32_bf16 v[148:151], a[148:151], v[88:91], v[148:151]
    s_waitcnt vmcnt(12)
    v_mfma_f32_16x16x32_bf16 v[144:147], a[152:155], v[92:95], v[144:147]
    v_mfma_f32_16x16x32_bf16 v[148:151], a[156:159], v[92:95], v[148:151]
    s_waitcnt vmcnt(11)
    v_mfma_f32_16x16x32_bf16 v[144:147], a[160:163], v[96:99], v[144:147]
    v_mfma_f32_16x16x32_bf16 v[148:151], a[164:167], v[96:99], v[148:151]
    s_waitcnt vmcnt(10)
    v_mfma_f32_16x16x32_bf16 v[144:147], a[168:171], v[100:103], v[144:147]
    v_mfma_f32_16x16x32_bf16 v[148:151], a[172:175], v[100:103], v[148:151]
    s_waitcnt vmcnt(9)
    v_mfma_f32_16x16x32_bf16 v[144:147], a[176:179], v[104:107], v[144:147]
    v_mfma_f32_16x16x32_bf16 v[148:151], a[180:183], v[104:107], v[148:151]
    s_waitcnt vmcnt(8)
    v_mfma_f32_16x16x32_bf16 v[144:147], a[184:187], v[108:111], v[144:147]
    v_mfma_f32_16x16x32_bf16 v[148:151], a[188:191], v[108:111], v[148:151]
    s_waitcnt vmcnt(7)
    v_mfma_f32_16x16x32_bf16 v[144:147], a[192:195], v[112:115], v[144:147]
    v_mfma_f32_16x16x32_bf16 v[148:151], a[196:199], v[112:115], v[148:151]
    s_waitcnt vmcnt(6)
    v_mfma_f32_16x16x32_bf16 v[144:147], a[200:203], v[116:119], v[144:147]
    v_mfma_f32_16x16x32_bf16 v[148:151], a[204:207], v[116:119], v[148:151]
    s_waitcnt vmcnt(5)
    v_mfma_f32_16x16x32_bf16 v[144:147], a[208:211], v[120:123], v[144:147]
    v_mfma_f32_16x16x32_bf16 v[148:151], a[212:215], v[120:123], v[148:151]
    s_waitcnt vmcnt(4)
    v_mfma_f32_16x16x32_bf16 v[144:147], a[216:219], v[124:127], v[144:147]
    v_mfma_f32_16x16x32_bf16 v[148:151], a[220:223], v[124:127], v[148:151]
    s_waitcnt vmcnt(3)
    v_mfma_f32_16x16x32_bf16 v[144:147], a[224:227], v[128:131], v[144:147]
    v_mfma_f32_16x16x32_bf16 v[148:151], a[228:231], v[128:131], v[148:151]
    s_waitcnt vmcnt(2)
    v_mfma_f32_16x16x32_bf16 v[144:147], a[232:235], v[132:135], v[144:147]
    v_mfma_f32_16x16x32_bf16 v[148:151], a[236:239], v[132:135], v[148:151]
    s_waitcnt vmcnt(1)
    v_mfma_f32_16x16x32_bf16 v[144:147], a[240:243], v[136:139], v[144:147]
    v_mfma_f32_16x16x32_bf16 v[148:151], a[244:247], v[136:139], v[148:151]
    s_waitcnt vmcnt(0)
    v_mfma_f32_16x16x32_bf16 v[144:147], a[248:251], v[140:143], v[144:147]
    v_mfma_f32_16x16x32_bf16 v[148:151], a[252:255], v[140:143], v[148:151]
    s_lshl_b32 s64, s14, 12
    v_add_u32 v7, s64, v1
    s_barrier
    s_nop 3
    ds_write_b128 v7, v[144:147] offset:0
    ds_write_b128 v7, v[148:151] offset:1024
    s_waitcnt lgkmcnt(0)
    s_barrier
    s_cmp_ge_u32 s14, 2
    s_cbranch_scc1 OTD_172
    s_lshl_b32 s64, s14, 10
    v_add_u32 v7, s64, v1
    ds_read_b128 v[16:19], v7 offset:0
    ds_read_b128 v[20:23], v7 offset:4096
    ds_read_b128 v[24:27], v7 offset:8192
    ds_read_b128 v[28:31], v7 offset:12288
    s_waitcnt lgkmcnt(0)
    v_add_f32 v16, v16, v20
    v_add_f32 v24, v24, v28
    v_add_f32 v16, v16, v24
    v_add_f32 v17, v17, v21
    v_add_f32 v25, v25, v29
    v_add_f32 v17, v17, v25
    v_add_f32 v18, v18, v22
    v_add_f32 v26, v26, v30
    v_add_f32 v18, v18, v26
    v_add_f32 v19, v19, v23
    v_add_f32 v27, v27, v31
    v_add_f32 v19, v19, v27
    v_cvt_pk_bf16_f32 v16, v16, v16
    v_lshlrev_b32 v16, 16, v16
    v_cvt_pk_bf16_f32 v17, v17, v17
    v_lshlrev_b32 v17, 16, v17
    v_cvt_pk_bf16_f32 v18, v18, v18
    v_lshlrev_b32 v18, 16, v18
    v_cvt_pk_bf16_f32 v19, v19, v19
    v_lshlrev_b32 v19, 16, v19
    v_lshlrev_b32 v20, 16, v162
    v_and_b32 v21, 0xffff0000, v162
    v_lshlrev_b32 v24, 16, v160
    v_and_b32 v25, 0xffff0000, v160
    v_lshlrev_b32 v22, 16, v163
    v_and_b32 v23, 0xffff0000, v163
    v_lshlrev_b32 v26, 16, v161
    v_and_b32 v27, 0xffff0000, v161
    s_lshl_b32 s64, s24, 5
    v_add_u32 v8, s64, v9
    v_mov_b32 v10, -1
    v_cmp_eq_u32 vcc, s72, v8
    s_nop 1
    v_cndmask_b32 v10, v10, 0, vcc
    v_cmp_eq_u32 vcc, s73, v8
    s_nop 1
    v_cndmask_b32 v10, v10, 1, vcc
    v_cmp_eq_u32 vcc, s74, v8
    s_nop 1
    v_cndmask_b32 v10, v10, 2, vcc
    v_cmp_eq_u32 vcc, s75, v8
    s_nop 1
    v_cndmask_b32 v10, v10, 3, vcc
    v_cmp_eq_u32 vcc, s76, v8
    s_nop 1
    v_cndmask_b32 v10, v10, 4, vcc
    v_cmp_eq_u32 vcc, s77, v8
    s_nop 1
    v_cndmask_b32 v10, v10, 5, vcc
    v_cmp_eq_u32 vcc, s78, v8
    s_nop 1
    v_cndmask_b32 v10, v10, 6, vcc
    v_cmp_eq_u32 vcc, s79, v8
    s_nop 1
    v_cndmask_b32 v10, v10, 7, vcc
    v_cmp_le_i32 vcc, 0, v10
    s_and_saveexec_b64 s[68:69], vcc
    s_cbranch_execz NOUPD_173
    v_mul_u32_u24 v10, 2560, v10
    v_lshrrev_b32 v11, 4, v0
    v_lshl_add_u32 v10, v11, 4, v10
    s_lshl_b32 s64, s86, 6
    s_lshl_b32 s65, s13, 7
    s_add_u32 s64, s64, s65
    s_add_u32 s64, s64, 0x5410000
    buffer_load_dwordx4 v[164:167], v10, s[4:7], s64 offen sc1
    s_waitcnt vmcnt(0)
    v_add_f32 v20, v20, v164
    v_cvt_pk_bf16_f32 v20, v20, v20
    v_lshlrev_b32 v20, 16, v20
    v_add_f32 v21, v21, v165
    v_cvt_pk_bf16_f32 v21, v21, v21
    v_lshlrev_b32 v21, 16, v21
    v_add_f32 v22, v22, v166
    v_cvt_pk_bf16_f32 v22, v22, v22
    v_lshlrev_b32 v22, 16, v22
    v_add_f32 v23, v23, v167
    v_cvt_pk_bf16_f32 v23, v23, v23
    v_lshlrev_b32 v23, 16, v23
NOUPD_173:
    s_mov_b64 exec, -1
    v_mul_f32 v28, 0xbfb8aa3b, v20
    v_exp_f32 v28, v28
    s_nop 0
    v_add_f32 v28, 1.0, v28
    v_rcp_f32 v28, v28
    s_nop 0
    v_mul_f32 v28, v28, v20
    v_cvt_pk_bf16_f32 v28, v28, v28
    v_lshlrev_b32 v28, 16, v28
    v_mul_f32 v28, v28, v16
    v_cvt_pk_bf16_f32 v28, v28, v28
    v_lshlrev_b32 v28, 16, v28
    v_add_f32 v28, v28, v24
    v_mul_f32 v29, 0xbfb8aa3b, v21
    v_exp_f32 v29, v29
    s_nop 0
    v_add_f32 v29, 1.0, v29
    v_rcp_f32 v29, v29
    s_nop 0
    v_mul_f32 v29, v29, v21
    v_cvt_pk_bf16_f32 v29, v29, v29
    v_lshlrev_b32 v29, 16, v29
    v_mul_f32 v29, v29, v17
    v_cvt_pk_bf16_f32 v29, v29, v29
    v_lshlrev_b32 v29, 16, v29
    v_add_f32 v29, v29, v25
    v_mul_f32 v30, 0xbfb8aa3b, v22
    v_exp_f32 v30, v30
    s_nop 0
    v_add_f32 v30, 1.0, v30
    v_rcp_f32 v30, v30
    s_nop 0
    v_mul_f32 v30, v30, v22
    v_cvt_pk_bf16_f32 v30, v30, v30
    v_lshlrev_b32 v30, 16, v30
    v_mul_f32 v30, v30, v18
    v_cvt_pk_bf16_f32 v30, v30, v30
    v_lshlrev_b32 v30, 16, v30
    v_add_f32 v30, v30, v26
    v_mul_f32 v31, 0xbfb8aa3b, v23
    v_exp_f32 v31, v31
    s_nop 0
    v_add_f32 v31, 1.0, v31
    v_rcp_f32 v31, v31
    s_nop 0
    v_mul_f32 v31, v31, v23
    v_cvt_pk_bf16_f32 v31, v31, v31
    v_lshlrev_b32 v31, 16, v31
    v_mul_f32 v31, v31, v19
    v_cvt_pk_bf16_f32 v31, v31, v31
    v_lshlrev_b32 v31, 16, v31
    v_add_f32 v31, v31, v27
    v_cvt_pk_bf16_f32 v164, v28, v29
    v_cvt_pk_bf16_f32 v165, v30, v31
    buffer_store_dwordx2 v[164:165], v5, s[52:55], s67 offen
OTD_172:
OU_X:
    s_branch M_EXIT
H_EXTRA:
    s_mul_hi_u32 s12, s88, 0xccccccd
    s_mul_i32 s65, s12, 20
    s_sub_u32 s13, s88, s65
    s_add_u32 s12, s12, 3
    s_load_dwordx2 s[48:49], s[0:1], 0
    s_mov_b32 s50, 0x280000
    s_mov_b32 s51, 0x00020000
    s_load_dwordx2 s[52:53], s[0:1], 96
    s_mov_b32 s54, 0x280000
    s_mov_b32 s55, 0x00020000
    s_mov_b32 s36, -1
    s_mov_b32 s37, 0
    s_waitcnt lgkmcnt(0)
    v_mbcnt_lo_u32_b32 v0, -1, 0
    v_mbcnt_hi_u32_b32 v0, -1, v0
    s_mov_b32 s29, 0
    v_lshlrev_b32 v1, 4, v0
    v_lshlrev_b32 v6, 2, v0
    v_mov_b32 v8, 0
    s_mov_b32 s64, 0x298100
OXW_174:
    buffer_load_dword v7, v8, s[4:7], s64 offen sc1
    s_add_u32 s29, s29, 1
    s_waitcnt vmcnt(0)
    v_cmp_gt_u32 vcc, 40, v7
    s_cbranch_vccz OXWD_175
    s_cmp_gt_u32 s29, 262144
    s_cbranch_scc1 OXWD_175
    s_sleep 8
    s_branch OXW_174
OXWD_175:
    v_lshlrev_b32 v6, 2, v0
    s_mov_b32 s64, 0x5400000
    buffer_load_dword v7, v6, s[4:7], s64 offen sc1
    s_waitcnt vmcnt(0)
    v_readlane_b32 s72, v7, 0
    v_readlane_b32 s73, v7, 1
    v_readlane_b32 s74, v7, 2
    v_readlane_b32 s75, v7, 3
    v_readlane_b32 s76, v7, 4
    v_readlane_b32 s77, v7, 5
    v_readlane_b32 s78, v7, 6
    v_readlane_b32 s79, v7, 7
    s_cmp_eq_u32 s12, 3
    s_cselect_b32 s24, 62, 63
    s_cmp_eq_u32 s12, 4
    s_cselect_b32 s87, 0, 1
    s_and_b32 s86, s14, 1
    s_lshl_b32 s64, s87, 4
    v_and_b32 v6, 15, v0
    v_add_u32 v6, s64, v6
    v_mov_b32 v9, v6
    v_mul_u32_u24 v5, 1280, v6
    v_lshrrev_b32 v6, 4, v0
    v_lshl_add_u32 v5, v6, 3, v5
    s_and_b32 s64, s14, 1
    s_lshl_b32 s64, s64, 5
    s_lshl_b32 s65, s13, 6
    s_add_u32 s64, s64, s65
    v_add_u32 v5, s64, v5
    v_lshlrev_b32 v6, 2, v0
    s_mul_i32 s67, s24, 40960
    buffer_load_dwordx2 v[160:161], v5, s[48:51], s67 offen
    s_add_u32 s64, s67, 0x0
    buffer_load_dwordx2 v[162:163], v5, s[4:7], s64 offen
    s_lshl_b32 s64, s24, 7
    s_add_u32 s64, s64, 0x296000
    s_mov_b64 exec, s[36:37]
OX_F_176:
    buffer_load_dword v7, v6, s[4:7], s64 offen sc1
    s_add_u32 s29, s29, 1
    s_waitcnt vmcnt(0)
    v_cmp_eq_u32 vcc, 0, v7
    s_cbranch_vccz OX_FD_177
    s_cmp_gt_u32 s29, 262144
    s_cbranch_scc1 OX_FD_177
    s_sleep 1
    s_branch OX_F_176
OX_FD_177:
    s_mov_b64 exec, -1
    s_lshl_b32 s25, s24, 18
    s_lshl_b32 s64, s14, 15
    s_add_u32 s25, s25, s64
    s_add_u32 s25, s25, 0x4400000
    s_lshl_b32 s64, s87, 17
    s_add_u32 s25, s25, s64
    s_add_u32 s64, s25, 0x0
    buffer_load_dwordx4 v[16:19], v1, s[4:7], s64 offen
    s_add_u32 s64, s25, 0x400
    buffer_load_dwordx4 v[20:23], v1, s[4:7], s64 offen
    s_add_u32 s64, s25, 0x800
    buffer_load_dwordx4 v[24:27], v1, s[4:7], s64 offen
    s_add_u32 s64, s25, 0xc00
    buffer_load_dwordx4 v[28:31], v1, s[4:7], s64 offen
    s_add_u32 s64, s25, 0x1000
    buffer_load_dwordx4 v[32:35], v1, s[4:7], s64 offen
    s_add_u32 s64, s25, 0x1400
    buffer_load_dwordx4 v[36:39], v1, s[4:7], s64 offen
    s_add_u32 s64, s25, 0x1800
    buffer_load_dwordx4 v[40:43], v1, s[4:7], s64 offen
    s_add_u32 s64, s25, 0x1c00
    buffer_load_dwordx4 v[44:47], v1, s[4:7], s64 offen
    s_add_u32 s64, s25, 0x2000
    buffer_load_dwordx4 v[48:51], v1, s[4:7], s64 offen
    s_add_u32 s64, s25, 0x2400
    buffer_load_dwordx4 v[52:55], v1, s[4:7], s64 offen
    s_add_u32 s64, s25, 0x2800
    buffer_load_dwordx4 v[56:59], v1, s[4:7], s64 offen
    s_add_u32 s64, s25, 0x2c00
    buffer_load_dwordx4 v[60:63], v1, s[4:7], s64 offen
    s_add_u32 s64, s25, 0x3000
    buffer_load_dwordx4 v[64:67], v1, s[4:7], s64 offen
    s_add_u32 s64, s25, 0x3400
    buffer_load_dwordx4 v[68:71], v1, s[4:7], s64 offen
    s_add_u32 s64, s25, 0x3800
    buffer_load_dwordx4 v[72:75], v1, s[4:7], s64 offen
    s_add_u32 s64, s25, 0x3c00
    buffer_load_dwordx4 v[76:79], v1, s[4:7], s64 offen
    s_add_u32 s64, s25, 0x4000
    buffer_load_dwordx4 v[80:83], v1, s[4:7], s64 offen
    s_add_u32 s64, s25, 0x4400
    buffer_load_dwordx4 v[84:87], v1, s[4:7], s64 offen
    s_add_u32 s64, s25, 0x4800
    buffer_load_dwordx4 v[88:91], v1, s[4:7], s64 offen
    s_add_u32 s64, s25, 0x4c00
    buffer_load_dwordx4 v[92:95], v1, s[4:7], s64 offen
    s_add_u32 s64, s25, 0x5000
    buffer_load_dwordx4 v[96:99], v1, s[4:7], s64 offen
    s_add_u32 s64, s25, 0x5400
    buffer_load_dwordx4 v[100:103], v1, s[4:7], s64 offen
    s_add_u32 s64, s25, 0x5800
    buffer_load_dwordx4 v[104:107], v1, s[4:7], s64 offen
    s_add_u32 s64, s25, 0x5c00
    buffer_load_dwordx4 v[108:111], v1, s[4:7], s64 offen
    s_add_u32 s64, s25, 0x6000
    buffer_load_dwordx4 v[112:115], v1, s[4:7], s64 offen
    s_add_u32 s64, s25, 0x6400
    buffer_load_dwordx4 v[116:119], v1, s[4:7], s64 offen
    s_add_u32 s64, s25, 0x6800
    buffer_load_dwordx4 v[120:123], v1, s[4:7], s64 offen
    s_add_u32 s64, s25, 0x6c00
    buffer_load_dwordx4 v[124:127], v1, s[4:7], s64 offen
    s_add_u32 s64, s25, 0x7000
    buffer_load_dwordx4 v[128:131], v1, s[4:7], s64 offen
    s_add_u32 s64, s25, 0x7400
    buffer_load_dwordx4 v[132:135], v1, s[4:7], s64 offen
    s_add_u32 s64, s25, 0x7800
    buffer_load_dwordx4 v[136:139], v1, s[4:7], s64 offen
    s_add_u32 s64, s25, 0x7c00
    buffer_load_dwordx4 v[140:143], v1, s[4:7], s64 offen
    s_waitcnt vmcnt(31)
    v_mfma_f32_16x16x32_bf16 v[144:147], a[0:3], v[16:19], 0
    v_mfma_f32_16x16x32_bf16 v[148:151], a[4:7], v[16:19], 0
    s_waitcnt vmcnt(30)
    v_mfma_f32_16x16x32_bf16 v[144:147], a[8:11], v[20:23], v[144:147]
    v_mfma_f32_16x16x32_bf16 v[148:151], a[12:15], v[20:23], v[148:151]
    s_waitcnt vmcnt(29)
    v_mfma_f32_16x16x32_bf16 v[144:147], a[16:19], v[24:27], v[144:147]
    v_mfma_f32_16x16x32_bf16 v[148:151], a[20:23], v[24:27], v[148:151]
    s_waitcnt vmcnt(28)
    v_mfma_f32_16x16x32_bf16 v[144:147], a[24:27], v[28:31], v[144:147]
    v_mfma_f32_16x16x32_bf16 v[148:151], a[28:31], v[28:31], v[148:151]
    s_waitcnt vmcnt(27)
    v_mfma_f32_16x16x32_bf16 v[144:147], a[32:35], v[32:35], v[144:147]
    v_mfma_f32_16x16x32_bf16 v[148:151], a[36:39], v[32:35], v[148:151]
    s_waitcnt vmcnt(26)
    v_mfma_f32_16x16x32_bf16 v[144:147], a[40:43], v[36:39], v[144:147]
    v_mfma_f32_16x16x32_bf16 v[148:151], a[44:47], v[36:39], v[148:151]
    s_waitcnt vmcnt(25)
    v_mfma_f32_16x16x32_bf16 v[144:147], a[48:51], v[40:43], v[144:147]
    v_mfma_f32_16x16x32_bf16 v[148:151], a[52:55], v[40:43], v[148:151]
    s_waitcnt vmcnt(24)
    v_mfma_f32_16x16x32_bf16 v[144:147], a[56:59], v[44:47], v[144:147]
    v_mfma_f32_16x16x32_bf16 v[148:151], a[60:63], v[44:47], v[148:151]
    s_waitcnt vmcnt(23)
    v_mfma_f32_16x16x32_bf16 v[144:147], a[64:67], v[48:51], v[144:147]
    v_mfma_f32_16x16x32_bf16 v[148:151], a[68:71], v[48:51], v[148:151]
    s_waitcnt vmcnt(22)
    v_mfma_f32_16x16x32_bf16 v[144:147], a[72:75], v[52:55], v[144:147]
    v_mfma_f32_16x16x32_bf16 v[148:151], a[76:79], v[52:55], v[148:151]
    s_waitcnt vmcnt(21)
    v_mfma_f32_16x16x32_bf16 v[144:147], a[80:83], v[56:59], v[144:147]
    v_mfma_f32_16x16x32_bf16 v[148:151], a[84:87], v[56:59], v[148:151]
    s_waitcnt vmcnt(20)
    v_mfma_f32_16x16x32_bf16 v[144:147], a[88:91], v[60:63], v[144:147]
    v_mfma_f32_16x16x32_bf16 v[148:151], a[92:95], v[60:63], v[148:151]
    s_waitcnt vmcnt(19)
    v_mfma_f32_16x16x32_bf16 v[144:147], a[96:99], v[64:67], v[144:147]
    v_mfma_f32_16x16x32_bf16 v[148:151], a[100:103], v[64:67], v[148:151]
    s_waitcnt vmcnt(18)
    v_mfma_f32_16x16x32_bf16 v[144:147], a[104:107], v[68:71], v[144:147]
    v_mfma_f32_16x16x32_bf16 v[148:151], a[108:111], v[68:71], v[148:151]
    s_waitcnt vmcnt(17)
    v_mfma_f32_16x16x32_bf16 v[144:147], a[112:115], v[72:75], v[144:147]
    v_mfma_f32_16x16x32_bf16 v[148:151], a[116:119], v[72:75], v[148:151]
    s_waitcnt vmcnt(16)
    v_mfma_f32_16x16x32_bf16 v[144:147], a[120:123], v[76:79], v[144:147]
    v_mfma_f32_16x16x32_bf16 v[148:151], a[124:127], v[76:79], v[148:151]
    s_waitcnt vmcnt(15)
    v_mfma_f32_16x16x32_bf16 v[144:147], a[128:131], v[80:83], v[144:147]
    v_mfma_f32_16x16x32_bf16 v[148:151], a[132:135], v[80:83], v[148:151]
    s_waitcnt vmcnt(14)
    v_mfma_f32_16x16x32_bf16 v[144:147], a[136:139], v[84:87], v[144:147]
    v_mfma_f32_16x16x32_bf16 v[148:151], a[140:143], v[84:87], v[148:151]
    s_waitcnt vmcnt(13)
    v_mfma_f32_16x16x32_bf16 v[144:147], a[144:147], v[88:91], v[144:147]
    v_mfma_f32_16x16x32_bf16 v[148:151], a[148:151], v[88:91], v[148:151]
    s_waitcnt vmcnt(12)
    v_mfma_f32_16x16x32_bf16 v[144:147], a[152:155], v[92:95], v[144:147]
    v_mfma_f32_16x16x32_bf16 v[148:151], a[156:159], v[92:95], v[148:151]
    s_waitcnt vmcnt(11)
    v_mfma_f32_16x16x32_bf16 v[144:147], a[160:163], v[96:99], v[144:147]
    v_mfma_f32_16x16x32_bf16 v[148:151], a[164:167], v[96:99], v[148:151]
    s_waitcnt vmcnt(10)
    v_mfma_f32_16x16x32_bf16 v[144:147], a[168:171], v[100:103], v[144:147]
    v_mfma_f32_16x16x32_bf16 v[148:151], a[172:175], v[100:103], v[148:151]
    s_waitcnt vmcnt(9)
    v_mfma_f32_16x16x32_bf16 v[144:147], a[176:179], v[104:107], v[144:147]
    v_mfma_f32_16x16x32_bf16 v[148:151], a[180:183], v[104:107], v[148:151]
    s_waitcnt vmcnt(8)
    v_mfma_f32_16x16x32_bf16 v[144:147], a[184:187], v[108:111], v[144:147]
    v_mfma_f32_16x16x32_bf16 v[148:151], a[188:191], v[108:111], v[148:151]
    s_waitcnt vmcnt(7)
    v_mfma_f32_16x16x32_bf16 v[144:147], a[192:195], v[112:115], v[144:147]
    v_mfma_f32_16x16x32_bf16 v[148:151], a[196:199], v[112:115], v[148:151]
    s_waitcnt vmcnt(6)
    v_mfma_f32_16x16x32_bf16 v[144:147], a[200:203], v[116:119], v[144:147]
    v_mfma_f32_16x16x32_bf16 v[148:151], a[204:207], v[116:119], v[148:151]
    s_waitcnt vmcnt(5)
    v_mfma_f32_16x16x32_bf16 v[144:147], a[208:211], v[120:123], v[144:147]
    v_mfma_f32_16x16x32_bf16 v[148:151], a[212:215], v[120:123], v[148:151]
    s_waitcnt vmcnt(4)
    v_mfma_f32_16x16x32_bf16 v[144:147], a[216:219], v[124:127], v[144:147]
    v_mfma_f32_16x16x32_bf16 v[148:151], a[220:223], v[124:127], v[148:151]
    s_waitcnt vmcnt(3)
    v_mfma_f32_16x16x32_bf16 v[144:147], a[224:227], v[128:131], v[144:147]
    v_mfma_f32_16x16x32_bf16 v[148:151], a[228:231], v[128:131], v[148:151]
    s_waitcnt vmcnt(2)
    v_mfma_f32_16x16x32_bf16 v[144:147], a[232:235], v[132:135], v[144:147]
    v_mfma_f32_16x16x32_bf16 v[148:151], a[236:239], v[132:135], v[148:151]
    s_waitcnt vmcnt(1)
    v_mfma_f32_16x16x32_bf16 v[144:147], a[240:243], v[136:139], v[144:147]
    v_mfma_f32_16x16x32_bf16 v[148:151], a[244:247], v[136:139], v[148:151]
    s_waitcnt vmcnt(0)
    v_mfma_f32_16x16x32_bf16 v[144:147], a[248:251], v[140:143], v[144:147]
    v_mfma_f32_16x16x32_bf16 v[148:151], a[252:255], v[140:143], v[148:151]
    s_lshl_b32 s64, s14, 12
    v_add_u32 v7, s64, v1
    s_barrier
    s_nop 3
    ds_write_b128 v7, v[144:147] offset:0
    ds_write_b128 v7, v[148:151] offset:1024
    s_waitcnt lgkmcnt(0)
    s_barrier
    s_cmp_ge_u32 s14, 2
    s_cbranch_scc1 OTD_178
    s_lshl_b32 s64, s14, 10
    v_add_u32 v7, s64, v1
    ds_read_b128 v[16:19], v7 offset:0
    ds_read_b128 v[20:23], v7 offset:4096
    ds_read_b128 v[24:27], v7 offset:8192
    ds_read_b128 v[28:31], v7 offset:12288
    s_waitcnt lgkmcnt(0)
    v_add_f32 v16, v16, v20
    v_add_f32 v24, v24, v28
    v_add_f32 v16, v16, v24
    v_add_f32 v17, v17, v21
    v_add_f32 v25, v25, v29
    v_add_f32 v17, v17, v25
    v_add_f32 v18, v18, v22
    v_add_f32 v26, v26, v30
    v_add_f32 v18, v18, v26
    v_add_f32 v19, v19, v23
    v_add_f32 v27, v27, v31
    v_add_f32 v19, v19, v27
    v_cvt_pk_bf16_f32 v16, v16, v16
    v_lshlrev_b32 v16, 16, v16
    v_cvt_pk_bf16_f32 v17, v17, v17
    v_lshlrev_b32 v17, 16, v17
    v_cvt_pk_bf16_f32 v18, v18, v18
    v_lshlrev_b32 v18, 16, v18
    v_cvt_pk_bf16_f32 v19, v19, v19
    v_lshlrev_b32 v19, 16, v19
    v_lshlrev_b32 v20, 16, v162
    v_and_b32 v21, 0xffff0000, v162
    v_lshlrev_b32 v24, 16, v160
    v_and_b32 v25, 0xffff0000, v160
    v_lshlrev_b32 v22, 16, v163
    v_and_b32 v23, 0xffff0000, v163
    v_lshlrev_b32 v26, 16, v161
    v_and_b32 v27, 0xffff0000, v161
    s_lshl_b32 s64, s24, 5
    v_add_u32 v8, s64, v9
    v_mov_b32 v10, -1
    v_cmp_eq_u32 vcc, s72, v8
    s_nop 1
    v_cndmask_b32 v10, v10, 0, vcc
    v_cmp_eq_u32 vcc, s73, v8
    s_nop 1
    v_cndmask_b32 v10, v10, 1, vcc
    v_cmp_eq_u32 vcc, s74, v8
    s_nop 1
    v_cndmask_b32 v10, v10, 2, vcc
    v_cmp_eq_u32 vcc, s75, v8
    s_nop 1
    v_cndmask_b32 v10, v10, 3, vcc
    v_cmp_eq_u32 vcc, s76, v8
    s_nop 1
    v_cndmask_b32 v10, v10, 4, vcc
    v_cmp_eq_u32 vcc, s77, v8
    s_nop 1
    v_cndmask_b32 v10, v10, 5, vcc
    v_cmp_eq_u32 vcc, s78, v8
    s_nop 1
    v_cndmask_b32 v10, v10, 6, vcc
    v_cmp_eq_u32 vcc, s79, v8
    s_nop 1
    v_cndmask_b32 v10, v10, 7, vcc
    v_cmp_le_i32 vcc, 0, v10
    s_and_saveexec_b64 s[68:69], vcc
    s_cbranch_execz NOUPD_179
    v_mul_u32_u24 v10, 2560, v10
    v_lshrrev_b32 v11, 4, v0
    v_lshl_add_u32 v10, v11, 4, v10
    s_lshl_b32 s64, s86, 6
    s_lshl_b32 s65, s13, 7
    s_add_u32 s64, s64, s65
    s_add_u32 s64, s64, 0x5410000
    buffer_load_dwordx4 v[164:167], v10, s[4:7], s64 offen sc1
    s_waitcnt vmcnt(0)
    v_add_f32 v20, v20, v164
    v_cvt_pk_bf16_f32 v20, v20, v20
    v_lshlrev_b32 v20, 16, v20
    v_add_f32 v21, v21, v165
    v_cvt_pk_bf16_f32 v21, v21, v21
    v_lshlrev_b32 v21, 16, v21
    v_add_f32 v22, v22, v166
    v_cvt_pk_bf16_f32 v22, v22, v22
    v_lshlrev_b32 v22, 16, v22
    v_add_f32 v23, v23, v167
    v_cvt_pk_bf16_f32 v23, v23, v23
    v_lshlrev_b32 v23, 16, v23
NOUPD_179:
    s_mov_b64 exec, -1
    v_mul_f32 v28, 0xbfb8aa3b, v20
    v_exp_f32 v28, v28
    s_nop 0
    v_add_f32 v28, 1.0, v28
    v_rcp_f32 v28, v28
    s_nop 0
    v_mul_f32 v28, v28, v20
    v_cvt_pk_bf16_f32 v28, v28, v28
    v_lshlrev_b32 v28, 16, v28
    v_mul_f32 v28, v28, v16
    v_cvt_pk_bf16_f32 v28, v28, v28
    v_lshlrev_b32 v28, 16, v28
    v_add_f32 v28, v28, v24
    v_mul_f32 v29, 0xbfb8aa3b, v21
    v_exp_f32 v29, v29
    s_nop 0
    v_add_f32 v29, 1.0, v29
    v_rcp_f32 v29, v29
    s_nop 0
    v_mul_f32 v29, v29, v21
    v_cvt_pk_bf16_f32 v29, v29, v29
    v_lshlrev_b32 v29, 16, v29
    v_mul_f32 v29, v29, v17
    v_cvt_pk_bf16_f32 v29, v29, v29
    v_lshlrev_b32 v29, 16, v29
    v_add_f32 v29, v29, v25
    v_mul_f32 v30, 0xbfb8aa3b, v22
    v_exp_f32 v30, v30
    s_nop 0
    v_add_f32 v30, 1.0, v30
    v_rcp_f32 v30, v30
    s_nop 0
    v_mul_f32 v30, v30, v22
    v_cvt_pk_bf16_f32 v30, v30, v30
    v_lshlrev_b32 v30, 16, v30
    v_mul_f32 v30, v30, v18
    v_cvt_pk_bf16_f32 v30, v30, v30
    v_lshlrev_b32 v30, 16, v30
    v_add_f32 v30, v30, v26
    v_mul_f32 v31, 0xbfb8aa3b, v23
    v_exp_f32 v31, v31
    s_nop 0
    v_add_f32 v31, 1.0, v31
    v_rcp_f32 v31, v31
    s_nop 0
    v_mul_f32 v31, v31, v23
    v_cvt_pk_bf16_f32 v31, v31, v31
    v_lshlrev_b32 v31, 16, v31
    v_mul_f32 v31, v31, v19
    v_cvt_pk_bf16_f32 v31, v31, v31
    v_lshlrev_b32 v31, 16, v31
    v_add_f32 v31, v31, v27
    v_cvt_pk_bf16_f32 v164, v28, v29
    v_cvt_pk_bf16_f32 v165, v30, v31
    buffer_store_dwordx2 v[164:165], v5, s[52:55], s67 offen
OTD_178:
    s_branch M_EXIT
H_Q:
    s_mov_b32 s29, 0
    v_lshlrev_b32 v1, 4, v0
    v_lshrrev_b32 v5, 4, v0
    v_lshlrev_b32 v2, 7, v5
    v_and_b32 v5, 7, v0
    v_lshl_add_u32 v2, v5, 4, v2
    v_bfe_u32 v5, v0, 4, 1
    v_lshlrev_b32 v3, 7, v5
    v_and_b32 v5, 15, v0
    v_lshl_add_u32 v3, v5, 3, v3
    s_mov_b32 s34, 0x3e0293ee
    s_mov_b32 s35, 0x3e0293ee
    s_mov_b32 s36, -1
    s_mov_b32 s37, 0
    v_lshrrev_b32 v5, 4, v0
    v_lshlrev_b32 v5, 2, v5
    v_and_b32 v6, 15, v0
    v_add_u32 v7, 0, v5
    v_cmp_le_u32 s[38:39], v7, v6
    v_add_u32 v7, 1, v5
    v_cmp_le_u32 s[40:41], v7, v6
    v_add_u32 v7, 2, v5
    v_cmp_le_u32 s[42:43], v7, v6
    v_add_u32 v7, 3, v5
    v_cmp_le_u32 s[44:45], v7, v6
    v_mov_b32 v248, 0x3f803f80
    v_mov_b32 v249, 0x3f803f80
    v_mov_b32 v250, 0x3f803f80
    v_mov_b32 v251, 0x3f803f80
    s_lshl_b32 s24, s12, 2
    s_add_u32 s24, s24, s14
    s_mov_b32 s25, 0
AT0_LOOP:
    s_cmp_eq_u32 s24, 63
    s_cbranch_scc1 AT0_END
    s_lshl_b32 s64, s24, 5
    s_add_u32 s64, s64, s13
    s_lshl_b32 s26, s64, 13
    s_add_u32 s26, s26, 0x3400000
    s_lshl_b32 s27, s64, 14
    s_add_u32 s27, s27, 0x1400000
    s_lshl_b32 s65, s64, 11
    s_add_u32 s30, s65, 0x640000
    s_add_u32 s31, s65, 0xa40000
    s_lshl_b32 s33, s64, 2
    s_add_u32 s33, s33, 0x296000
    s_lshl_b32 s32, s24, 18
    s_lshl_b32 s65, s13, 12
    s_add_u32 s32, s32, s65
    s_add_u32 s32, s32, 0x4400000
    s_lshr_b32 s65, s24, 2
    s_lshl_b32 s65, s65, 9
    s_lshl_b32 s66, s13, 4
    s_add_u32 s65, s65, s66
    s_add_u32 s65, s65, 0x291000
    s_lshr_b32 s66, s24, 1
    s_lshl_b32 s66, s66, 8
    s_lshl_b32 s64, s13, 3
    s_add_u32 s66, s66, s64
    s_add_u32 s66, s66, 0x293ff4
    v_lshlrev_b32 v5, 2, v0
    v_mov_b32 v6, s65
    v_mov_b32 v7, s66
    v_cmp_gt_u32 vcc, 3, v0
    s_nop 1
    v_cndmask_b32 v6, v7, v6, vcc
    v_add_u32 v4, v5, v6
    s_mov_b32 s64, 0
    s_mov_b64 exec, 7
AT0_F_180:
    buffer_load_dword v5, v4, s[4:7], s64 offen sc1
    s_add_u32 s29, s29, 1
    s_waitcnt vmcnt(0)
    v_cmp_eq_u32 vcc, 0, v5
    s_cbranch_vccz AT0_FD_181
    s_cmp_gt_u32 s29, 262144
    s_cbranch_scc1 AT0_FD_181
    s_sleep 1
    s_branch AT0_F_180
AT0_FD_181:
    s_mov_b64 exec, -1
    buffer_load_dwordx4 v[16:19], v1, s[4:7], s26 offen offset:0
    buffer_load_dwordx4 v[20:23], v1, s[4:7], s26 offen offset:1024
    buffer_load_dwordx4 v[24:27], v1, s[4:7], s26 offen offset:2048
    buffer_load_dwordx4 v[28:31], v1, s[4:7], s26 offen offset:3072
    s_add_u32 s26, s26, 4096
    buffer_load_dwordx4 v[32:35], v1, s[4:7], s26 offen offset:0
    buffer_load_dwordx4 v[36:39], v1, s[4:7], s26 offen offset:1024
    buffer_load_dwordx4 v[40:43], v1, s[4:7], s26 offen offset:2048
    buffer_load_dwordx4 v[44:47], v1, s[4:7], s26 offen offset:3072
    buffer_load_dwordx4 v[48:51], v1, s[4:7], s27 offen offset:0
    buffer_load_dwordx4 v[52:55], v1, s[4:7], s27 offen offset:1024
    buffer_load_dwordx4 v[56:59], v1, s[4:7], s27 offen offset:2048
    buffer_load_dwordx4 v[60:63], v1, s[4:7], s27 offen offset:3072
    s_add_u32 s27, s27, 4096
    buffer_load_dwordx4 v[64:67], v1, s[4:7], s27 offen offset:0
    buffer_load_dwordx4 v[68:71], v1, s[4:7], s27 offen offset:1024
    buffer_load_dwordx4 v[72:75], v1, s[4:7], s27 offen offset:2048
    buffer_load_dwordx4 v[76:79], v1, s[4:7], s27 offen offset:3072
    s_add_u32 s27, s27, 4096
    buffer_load_dwordx4 v[80:83], v1, s[4:7], s27 offen offset:0
    buffer_load_dwordx4 v[84:87], v1, s[4:7], s27 offen offset:1024
    buffer_load_dwordx4 v[88:91], v1, s[4:7], s27 offen offset:2048
    buffer_load_dwordx4 v[92:95], v1, s[4:7], s27 offen offset:3072
    s_add_u32 s27, s27, 4096
    buffer_load_dwordx4 v[96:99], v1, s[4:7], s27 offen offset:0
    buffer_load_dwordx4 v[100:103], v1, s[4:7], s27 offen offset:1024
    buffer_load_dwordx4 v[104:107], v1, s[4:7], s27 offen offset:2048
    buffer_load_dwordx4 v[108:111], v1, s[4:7], s27 offen offset:3072
    s_mov_b64 exec, 0x18
AT0_G_182:
    buffer_load_dword v5, v4, s[4:7], s64 offen sc1
    s_add_u32 s29, s29, 1
    s_waitcnt vmcnt(0)
    v_cmp_eq_u32 vcc, 0, v5
    s_cbranch_vccz AT0_GD_183
    s_cmp_gt_u32 s29, 262144
    s_cbranch_scc1 AT0_GD_183
    s_sleep 1
    s_branch AT0_G_182
AT0_GD_183:
    s_mov_b64 exec, -1
    buffer_load_dwordx4 v[112:115], v2, s[4:7], s30 offen offset:0
    buffer_load_dwordx4 v[116:119], v2, s[4:7], s30 offen offset:512
    buffer_load_dwordx4 v[120:123], v2, s[4:7], s30 offen offset:1024
    buffer_load_dwordx4 v[124:127], v2, s[4:7], s30 offen offset:1536
    buffer_load_dwordx2 v[128:129], v3, s[4:7], s31 offen offset:0
    buffer_load_dwordx2 v[130:131], v3, s[4:7], s31 offen offset:256
    buffer_load_dwordx2 v[132:133], v3, s[4:7], s31 offen offset:512
    buffer_load_dwordx2 v[134:135], v3, s[4:7], s31 offen offset:768
    buffer_load_dwordx2 v[136:137], v3, s[4:7], s31 offen offset:1024
    buffer_load_dwordx2 v[138:139], v3, s[4:7], s31 offen offset:1280
    buffer_load_dwordx2 v[140:141], v3, s[4:7], s31 offen offset:1536
    buffer_load_dwordx2 v[142:143], v3, s[4:7], s31 offen offset:1792
    v_mfma_f32_16x16x32_bf16 v[148:151], v[48:51], v[16:19], 0
    v_mfma_f32_16x16x32_bf16 v[156:159], v[48:51], v[32:35], 0
    v_mfma_f32_16x16x32_bf16 v[160:163], v[64:67], v[32:35], 0
    v_mfma_f32_16x16x32_bf16 v[148:151], v[52:55], v[20:23], v[148:151]
    v_mfma_f32_16x16x32_bf16 v[156:159], v[52:55], v[36:39], v[156:159]
    v_mfma_f32_16x16x32_bf16 v[160:163], v[68:71], v[36:39], v[160:163]
    v_mfma_f32_16x16x32_bf16 v[148:151], v[56:59], v[24:27], v[148:151]
    v_mfma_f32_16x16x32_bf16 v[156:159], v[56:59], v[40:43], v[156:159]
    v_mfma_f32_16x16x32_bf16 v[160:163], v[72:75], v[40:43], v[160:163]
    v_mfma_f32_16x16x32_bf16 v[148:151], v[60:63], v[28:31], v[148:151]
    v_mfma_f32_16x16x32_bf16 v[156:159], v[60:63], v[44:47], v[156:159]
    v_mfma_f32_16x16x32_bf16 v[160:163], v[76:79], v[44:47], v[160:163]
    s_waitcnt vmcnt(8)
    v_mfma_f32_16x16x32_bf16 v[144:147], v[112:115], v[16:19], 0
    v_mfma_f32_16x16x32_bf16 v[152:155], v[112:115], v[32:35], 0
    v_mfma_f32_16x16x32_bf16 v[144:147], v[116:119], v[20:23], v[144:147]
    v_mfma_f32_16x16x32_bf16 v[152:155], v[116:119], v[36:39], v[152:155]
    v_mfma_f32_16x16x32_bf16 v[144:147], v[120:123], v[24:27], v[144:147]
    v_mfma_f32_16x16x32_bf16 v[152:155], v[120:123], v[40:43], v[152:155]
    v_mfma_f32_16x16x32_bf16 v[144:147], v[124:127], v[28:31], v[144:147]
    v_mfma_f32_16x16x32_bf16 v[152:155], v[124:127], v[44:47], v[152:155]
    v_mov_b32 v11, 0xff800000
    s_nop 7
    v_cndmask_b32 v148, v11, v148, s[38:39]
    v_cndmask_b32 v160, v11, v160, s[38:39]
    v_cndmask_b32 v144, v11, v144, s[36:37]
    v_cndmask_b32 v152, v11, v152, s[36:37]
    v_cndmask_b32 v149, v11, v149, s[40:41]
    v_cndmask_b32 v161, v11, v161, s[40:41]
    v_cndmask_b32 v145, v11, v145, s[36:37]
    v_cndmask_b32 v153, v11, v153, s[36:37]
    v_cndmask_b32 v150, v11, v150, s[42:43]
    v_cndmask_b32 v162, v11, v162, s[42:43]
    v_cndmask_b32 v146, v11, v146, s[36:37]
    v_cndmask_b32 v154, v11, v154, s[36:37]
    v_cndmask_b32 v151, v11, v151, s[44:45]
    v_cndmask_b32 v163, v11, v163, s[44:45]
    v_cndmask_b32 v147, v11, v147, s[36:37]
    v_cndmask_b32 v155, v11, v155, s[36:37]
    v_max3_f32 v8, v144, v145, v146
    v_max3_f32 v8, v8, v147, v148
    v_max3_f32 v8, v8, v149, v150
    v_max_f32 v8, v8, v151
    v_mov_b32 v9, v8
    s_nop 1
    v_permlane16_swap_b32 v8, v9
    v_max_f32 v8, v8, v9
    v_mov_b32 v9, v8
    s_nop 1
    v_permlane32_swap_b32 v8, v9
    v_max_f32 v8, v8, v9
    v_mul_f32 v8, s34, v8
    v_fma_f32 v144, v144, s34, -v8
    v_fma_f32 v145, v145, s34, -v8
    v_fma_f32 v146, v146, s34, -v8
    v_fma_f32 v147, v147, s34, -v8
    v_fma_f32 v148, v148, s34, -v8
    v_fma_f32 v149, v149, s34, -v8
    v_fma_f32 v150, v150, s34, -v8
    v_fma_f32 v151, v151, s34, -v8
    v_exp_f32 v144, v144
    v_exp_f32 v145, v145
    v_exp_f32 v146, v146
    v_exp_f32 v147, v147
    v_exp_f32 v148, v148
    v_exp_f32 v149, v149
    v_exp_f32 v150, v150
    v_exp_f32 v151, v151
    s_nop 0
    v_cvt_pk_bf16_f32 v164, v148, v149
    v_cvt_pk_bf16_f32 v165, v150, v151
    v_mov_b32 v166, 0
    v_mov_b32 v167, 0
    v_cvt_pk_bf16_f32 v168, v144, v145
    v_cvt_pk_bf16_f32 v169, v146, v147
    v_max3_f32 v8, v152, v153, v154
    v_max3_f32 v8, v8, v155, v156
    v_max3_f32 v8, v8, v157, v158
    v_max3_f32 v8, v8, v159, v160
    v_max3_f32 v8, v8, v161, v162
    v_max_f32 v8, v8, v163
    v_mov_b32 v9, v8
    s_nop 1
    v_permlane16_swap_b32 v8, v9
    v_max_f32 v8, v8, v9
    v_mov_b32 v9, v8
    s_nop 1
    v_permlane32_swap_b32 v8, v9
    v_max_f32 v8, v8, v9
    v_mul_f32 v8, s34, v8
    v_fma_f32 v152, v152, s34, -v8
    v_fma_f32 v153, v153, s34, -v8
    v_fma_f32 v154, v154, s34, -v8
    v_fma_f32 v155, v155, s34, -v8
    v_fma_f32 v156, v156, s34, -v8
    v_fma_f32 v157, v157, s34, -v8
    v_fma_f32 v158, v158, s34, -v8
    v_fma_f32 v159, v159, s34, -v8
    v_fma_f32 v160, v160, s34, -v8
    v_fma_f32 v161, v161, s34, -v8
    v_fma_f32 v162, v162, s34, -v8
    v_fma_f32 v163, v163, s34, -v8
    v_exp_f32 v152, v152
    v_exp_f32 v153, v153
    v_exp_f32 v154, v154
    v_exp_f32 v155, v155
    v_exp_f32 v156, v156
    v_exp_f32 v157, v157
    v_exp_f32 v158, v158
    v_exp_f32 v159, v159
    v_exp_f32 v160, v160
    v_exp_f32 v161, v161
    v_exp_f32 v162, v162
    v_exp_f32 v163, v163
    s_nop 0
    v_cvt_pk_bf16_f32 v170, v156, v157
    v_cvt_pk_bf16_f32 v171, v158, v159
    v_cvt_pk_bf16_f32 v172, v160, v161
    v_cvt_pk_bf16_f32 v173, v162, v163
    v_cvt_pk_bf16_f32 v174, v152, v153
    v_cvt_pk_bf16_f32 v175, v154, v155
    s_waitcnt vmcnt(0)
    v_mfma_f32_16x16x32_bf16 v[240:243], v[248:251], v[164:167], 0
    v_mfma_f32_16x16x32_bf16 v[244:247], v[248:251], v[170:173], 0
    v_mfma_f32_16x16x32_bf16 v[176:179], v[80:83], v[164:167], 0
    v_mfma_f32_16x16x32_bf16 v[180:183], v[80:83], v[170:173], 0
    v_mfma_f32_16x16x32_bf16 v[184:187], v[84:87], v[164:167], 0
    v_mfma_f32_16x16x32_bf16 v[188:191], v[84:87], v[170:173], 0
    v_mfma_f32_16x16x32_bf16 v[192:195], v[88:91], v[164:167], 0
    v_mfma_f32_16x16x32_bf16 v[196:199], v[88:91], v[170:173], 0
    v_mfma_f32_16x16x32_bf16 v[200:203], v[92:95], v[164:167], 0
    v_mfma_f32_16x16x32_bf16 v[204:207], v[92:95], v[170:173], 0
    v_mfma_f32_16x16x32_bf16 v[208:211], v[96:99], v[164:167], 0
    v_mfma_f32_16x16x32_bf16 v[212:215], v[96:99], v[170:173], 0
    v_mfma_f32_16x16x32_bf16 v[216:219], v[100:103], v[164:167], 0
    v_mfma_f32_16x16x32_bf16 v[220:223], v[100:103], v[170:173], 0
    v_mfma_f32_16x16x32_bf16 v[224:227], v[104:107], v[164:167], 0
    v_mfma_f32_16x16x32_bf16 v[228:231], v[104:107], v[170:173], 0
    v_mfma_f32_16x16x32_bf16 v[232:235], v[108:111], v[164:167], 0
    v_mfma_f32_16x16x32_bf16 v[236:239], v[108:111], v[170:173], 0
    v_mfma_f32_16x16x16_bf16 v[240:243], v[248:249], v[168:169], v[240:243]
    v_mfma_f32_16x16x16_bf16 v[244:247], v[248:249], v[174:175], v[244:247]
    v_mfma_f32_16x16x16_bf16 v[176:179], v[128:129], v[168:169], v[176:179]
    v_mfma_f32_16x16x16_bf16 v[180:183], v[128:129], v[174:175], v[180:183]
    v_mfma_f32_16x16x16_bf16 v[184:187], v[130:131], v[168:169], v[184:187]
    v_mfma_f32_16x16x16_bf16 v[188:191], v[130:131], v[174:175], v[188:191]
    v_mfma_f32_16x16x16_bf16 v[192:195], v[132:133], v[168:169], v[192:195]
    v_mfma_f32_16x16x16_bf16 v[196:199], v[132:133], v[174:175], v[196:199]
    v_mfma_f32_16x16x16_bf16 v[200:203], v[134:135], v[168:169], v[200:203]
    v_mfma_f32_16x16x16_bf16 v[204:207], v[134:135], v[174:175], v[204:207]
    v_mfma_f32_16x16x16_bf16 v[208:211], v[136:137], v[168:169], v[208:211]
    v_mfma_f32_16x16x16_bf16 v[212:215], v[136:137], v[174:175], v[212:215]
    v_mfma_f32_16x16x16_bf16 v[216:219], v[138:139], v[168:169], v[216:219]
    v_mfma_f32_16x16x16_bf16 v[220:223], v[138:139], v[174:175], v[220:223]
    v_mfma_f32_16x16x16_bf16 v[224:227], v[140:141], v[168:169], v[224:227]
    v_mfma_f32_16x16x16_bf16 v[228:231], v[140:141], v[174:175], v[228:231]
    v_mfma_f32_16x16x16_bf16 v[232:235], v[142:143], v[168:169], v[232:235]
    v_mfma_f32_16x16x16_bf16 v[236:239], v[142:143], v[174:175], v[236:239]
    v_rcp_f32 v8, v240
    v_rcp_f32 v9, v244
    s_nop 7
    v_mul_f32 v176, v176, v8
    v_mul_f32 v177, v177, v8
    v_mul_f32 v178, v178, v8
    v_mul_f32 v179, v179, v8
    v_cvt_pk_bf16_f32 v16, v176, v177
    v_cvt_pk_bf16_f32 v17, v178, v179
    v_mul_f32 v184, v184, v8
    v_mul_f32 v185, v185, v8
    v_mul_f32 v186, v186, v8
    v_mul_f32 v187, v187, v8
    v_cvt_pk_bf16_f32 v18, v184, v185
    v_cvt_pk_bf16_f32 v19, v186, v187
    s_add_u32 s64, s32, 0x0
    buffer_store_dwordx4 v[16:19], v1, s[4:7], s64 offen offset:0 sc1
    v_mul_f32 v192, v192, v8
    v_mul_f32 v193, v193, v8
    v_mul_f32 v194, v194, v8
    v_mul_f32 v195, v195, v8
    v_cvt_pk_bf16_f32 v20, v192, v193
    v_cvt_pk_bf16_f32 v21, v194, v195
    v_mul_f32 v200, v200, v8
    v_mul_f32 v201, v201, v8
    v_mul_f32 v202, v202, v8
    v_mul_f32 v203, v203, v8
    v_cvt_pk_bf16_f32 v22, v200, v201
    v_cvt_pk_bf16_f32 v23, v202, v203
    s_add_u32 s64, s32, 0x0
    buffer_store_dwordx4 v[20:23], v1, s[4:7], s64 offen offset:1024 sc1
    v_mul_f32 v208, v208, v8
    v_mul_f32 v209, v209, v8
    v_mul_f32 v210, v210, v8
    v_mul_f32 v211, v211, v8
    v_cvt_pk_bf16_f32 v24, v208, v209
    v_cvt_pk_bf16_f32 v25, v210, v211
    v_mul_f32 v216, v216, v8
    v_mul_f32 v217, v217, v8
    v_mul_f32 v218, v218, v8
    v_mul_f32 v219, v219, v8
    v_cvt_pk_bf16_f32 v26, v216, v217
    v_cvt_pk_bf16_f32 v27, v218, v219
    s_add_u32 s64, s32, 0x0
    buffer_store_dwordx4 v[24:27], v1, s[4:7], s64 offen offset:2048 sc1
    v_mul_f32 v224, v224, v8
    v_mul_f32 v225, v225, v8
    v_mul_f32 v226, v226, v8
    v_mul_f32 v227, v227, v8
    v_cvt_pk_bf16_f32 v28, v224, v225
    v_cvt_pk_bf16_f32 v29, v226, v227
    v_mul_f32 v232, v232, v8
    v_mul_f32 v233, v233, v8
    v_mul_f32 v234, v234, v8
    v_mul_f32 v235, v235, v8
    v_cvt_pk_bf16_f32 v30, v232, v233
    v_cvt_pk_bf16_f32 v31, v234, v235
    s_add_u32 s64, s32, 0x0
    buffer_store_dwordx4 v[28:31], v1, s[4:7], s64 offen offset:3072 sc1
    v_mul_f32 v180, v180, v9
    v_mul_f32 v181, v181, v9
    v_mul_f32 v182, v182, v9
    v_mul_f32 v183, v183, v9
    v_cvt_pk_bf16_f32 v32, v180, v181
    v_cvt_pk_bf16_f32 v33, v182, v183
    v_mul_f32 v188, v188, v9
    v_mul_f32 v189, v189, v9
    v_mul_f32 v190, v190, v9
    v_mul_f32 v191, v191, v9
    v_cvt_pk_bf16_f32 v34, v188, v189
    v_cvt_pk_bf16_f32 v35, v190, v191
    s_add_u32 s64, s32, 0x20000
    buffer_store_dwordx4 v[32:35], v1, s[4:7], s64 offen offset:0 sc1
    v_mul_f32 v196, v196, v9
    v_mul_f32 v197, v197, v9
    v_mul_f32 v198, v198, v9
    v_mul_f32 v199, v199, v9
    v_cvt_pk_bf16_f32 v36, v196, v197
    v_cvt_pk_bf16_f32 v37, v198, v199
    v_mul_f32 v204, v204, v9
    v_mul_f32 v205, v205, v9
    v_mul_f32 v206, v206, v9
    v_mul_f32 v207, v207, v9
    v_cvt_pk_bf16_f32 v38, v204, v205
    v_cvt_pk_bf16_f32 v39, v206, v207
    s_add_u32 s64, s32, 0x20000
    buffer_store_dwordx4 v[36:39], v1, s[4:7], s64 offen offset:1024 sc1
    v_mul_f32 v212, v212, v9
    v_mul_f32 v213, v213, v9
    v_mul_f32 v214, v214, v9
    v_mul_f32 v215, v215, v9
    v_cvt_pk_bf16_f32 v40, v212, v213
    v_cvt_pk_bf16_f32 v41, v214, v215
    v_mul_f32 v220, v220, v9
    v_mul_f32 v221, v221, v9
    v_mul_f32 v222, v222, v9
    v_mul_f32 v223, v223, v9
    v_cvt_pk_bf16_f32 v42, v220, v221
    v_cvt_pk_bf16_f32 v43, v222, v223
    s_add_u32 s64, s32, 0x20000
    buffer_store_dwordx4 v[40:43], v1, s[4:7], s64 offen offset:2048 sc1
    v_mul_f32 v228, v228, v9
    v_mul_f32 v229, v229, v9
    v_mul_f32 v230, v230, v9
    v_mul_f32 v231, v231, v9
    v_cvt_pk_bf16_f32 v44, v228, v229
    v_cvt_pk_bf16_f32 v45, v230, v231
    v_mul_f32 v236, v236, v9
    v_mul_f32 v237, v237, v9
    v_mul_f32 v238, v238, v9
    v_mul_f32 v239, v239, v9
    v_cvt_pk_bf16_f32 v46, v236, v237
    v_cvt_pk_bf16_f32 v47, v238, v239
    s_add_u32 s64, s32, 0x20000
    buffer_store_dwordx4 v[44:47], v1, s[4:7], s64 offen offset:3072 sc1
    s_waitcnt vmcnt(0)
    v_mov_b32 v7, 1
    v_mov_b32 v8, 0
    s_mov_b64 exec, 1
    buffer_store_dword v7, v8, s[4:7], s33 offen sc1
    s_mov_b64 exec, -1
    s_add_u32 s24, s24, 8
    s_add_u32 s25, s25, 1
    s_cmp_lt_u32 s25, 1
    s_cbranch_scc1 AT0_LOOP
AT0_END:
    s_lshl_b32 s70, s13, 1
    s_add_u32 s70, s70, s12
    s_load_dwordx2 s[44:45], s[0:1], 72
    s_mov_b32 s46, 0x21c000
    s_mov_b32 s47, 0x00020000
    s_load_dwordx2 s[48:49], s[0:1], 80
    s_mov_b32 s50, 0x21c000
    s_mov_b32 s51, 0x00020000
    s_load_dwordx2 s[52:53], s[0:1], 88
    s_mov_b32 s54, 0x21c000
    s_mov_b32 s55, 0x00020000
    s_mov_b32 s29, 0
    s_waitcnt lgkmcnt(0)
    v_mbcnt_lo_u32_b32 v0, -1, 0
    v_mbcnt_hi_u32_b32 v0, -1, v0
    s_lshl_b32 s24, s70, 2
    s_add_u32 s24, s24, s14
    s_cmp_ge_u32 s24, 108
    s_cbranch_scc1 H_A1
    v_mov_b32 v8, 0
    s_mov_b32 s64, 0x298000
F1W_184:
    buffer_load_dword v7, v8, s[4:7], s64 offen sc1
    s_add_u32 s29, s29, 1
    s_waitcnt vmcnt(0)
    v_cmp_gt_u32 vcc, 1, v7
    s_cbranch_vccz F1WD_185
    s_cmp_gt_u32 s29, 262144
    s_cbranch_scc1 F1WD_185
    s_sleep 8
    s_branch F1W_184
F1WD_185:
    s_mul_i32 s25, s14, 40960
    v_lshrrev_b32 v7, 1, v0
    v_mul_u32_u24 v2, 3456, v7
    v_and_b32 v7, 1, v0
    v_lshl_add_u32 v2, v7, 4, v2
    v_lshrrev_b32 v7, 4, v0
    v_lshlrev_b32 v3, 8, v7
    v_bfe_u32 v7, v0, 2, 2
    v_lshl_add_u32 v3, v7, 5, v3
    v_and_b32 v7, 3, v0
    v_lshl_add_u32 v3, v7, 3, v3
    v_add_u32 v3, s25, v3
    v_and_b32 v7, 7, v0
    v_lshlrev_b32 v7, 2, v7
    s_mov_b32 s64, 0x5400000
    buffer_load_dword v4, v7, s[4:7], s64 offen sc1
    s_waitcnt vmcnt(0)
    v_mul_u32_u24 v4, 1280, v4
    v_lshrrev_b32 v7, 4, v0
    v_lshl_add_u32 v4, v7, 4, v4
    s_mov_b32 s65, 0x0
    buffer_load_dwordx4 v[16:19], v4, s[4:7], s65 offen offset:0 sc1
    buffer_load_dwordx4 v[20:23], v4, s[4:7], s65 offen offset:64 sc1
    buffer_load_dwordx4 v[24:27], v4, s[4:7], s65 offen offset:128 sc1
    buffer_load_dwordx4 v[28:31], v4, s[4:7], s65 offen offset:192 sc1
    buffer_load_dwordx4 v[32:35], v4, s[4:7], s65 offen offset:256 sc1
    buffer_load_dwordx4 v[36:39], v4, s[4:7], s65 offen offset:320 sc1
    buffer_load_dwordx4 v[40:43], v4, s[4:7], s65 offen offset:384 sc1
    buffer_load_dwordx4 v[44:47], v4, s[4:7], s65 offen offset:448 sc1
    buffer_load_dwordx4 v[48:51], v4, s[4:7], s65 offen offset:512 sc1
    buffer_load_dwordx4 v[52:55], v4, s[4:7], s65 offen offset:576 sc1
    buffer_load_dwordx4 v[56:59], v4, s[4:7], s65 offen offset:640 sc1
    buffer_load_dwordx4 v[60:63], v4, s[4:7], s65 offen offset:704 sc1
    buffer_load_dwordx4 v[64:67], v4, s[4:7], s65 offen offset:768 sc1
    buffer_load_dwordx4 v[68:71], v4, s[4:7], s65 offen offset:832 sc1
    buffer_load_dwordx4 v[72:75], v4, s[4:7], s65 offen offset:896 sc1
    buffer_load_dwordx4 v[76:79], v4, s[4:7], s65 offen offset:960 sc1
    buffer_load_dwordx4 v[80:83], v4, s[4:7], s65 offen offset:1024 sc1
    buffer_load_dwordx4 v[84:87], v4, s[4:7], s65 offen offset:1088 sc1
    buffer_load_dwordx4 v[88:91], v4, s[4:7], s65 offen offset:1152 sc1
    buffer_load_dwordx4 v[92:95], v4, s[4:7], s65 offen offset:1216 sc1
    s_lshl_b32 s26, s24, 5
    s_add_u32 m0, s25, 0
    s_add_u32 s64, s26, 0x0
    buffer_load_dwordx4 v2, s[44:47], s64 offen lds
    s_add_u32 m0, s25, 1024
    s_add_u32 s64, s26, 0x1b000
    buffer_load_dwordx4 v2, s[44:47], s64 offen lds
    s_add_u32 m0, s25, 2048
    s_add_u32 s64, s26, 0x36000
    buffer_load_dwordx4 v2, s[44:47], s64 offen lds
    s_add_u32 m0, s25, 3072
    s_add_u32 s64, s26, 0x51000
    buffer_load_dwordx4 v2, s[44:47], s64 offen lds
    s_add_u32 m0, s25, 4096
    s_add_u32 s64, s26, 0x6c000
    buffer_load_dwordx4 v2, s[44:47], s64 offen lds
    s_add_u32 m0, s25, 5120
    s_add_u32 s64, s26, 0x87000
    buffer_load_dwordx4 v2, s[44:47], s64 offen lds
    s_add_u32 m0, s25, 6144
    s_add_u32 s64, s26, 0xa2000
    buffer_load_dwordx4 v2, s[44:47], s64 offen lds
    s_add_u32 m0, s25, 7168
    s_add_u32 s64, s26, 0xbd000
    buffer_load_dwordx4 v2, s[44:47], s64 offen lds
    s_add_u32 m0, s25, 8192
    s_add_u32 s64, s26, 0xd8000
    buffer_load_dwordx4 v2, s[44:47], s64 offen lds
    s_add_u32 m0, s25, 9216
    s_add_u32 s64, s26, 0xf3000
    buffer_load_dwordx4 v2, s[44:47], s64 offen lds
    s_add_u32 m0, s25, 10240
    s_add_u32 s64, s26, 0x10e000
    buffer_load_dwordx4 v2, s[44:47], s64 offen lds
    s_add_u32 m0, s25, 11264
    s_add_u32 s64, s26, 0x129000
    buffer_load_dwordx4 v2, s[44:47], s64 offen lds
    s_add_u32 m0, s25, 12288
    s_add_u32 s64, s26, 0x144000
    buffer_load_dwordx4 v2, s[44:47], s64 offen lds
    s_add_u32 m0, s25, 13312
    s_add_u32 s64, s26, 0x15f000
    buffer_load_dwordx4 v2, s[44:47], s64 offen lds
    s_add_u32 m0, s25, 14336
    s_add_u32 s64, s26, 0x17a000
    buffer_load_dwordx4 v2, s[44:47], s64 offen lds
    s_add_u32 m0, s25, 15360
    s_add_u32 s64, s26, 0x195000
    buffer_load_dwordx4 v2, s[44:47], s64 offen lds
    s_add_u32 m0, s25, 16384
    s_add_u32 s64, s26, 0x1b0000
    buffer_load_dwordx4 v2, s[44:47], s64 offen lds
    s_add_u32 m0, s25, 17408
    s_add_u32 s64, s26, 0x1cb000
    buffer_load_dwordx4 v2, s[44:47], s64 offen lds
    s_add_u32 m0, s25, 18432
    s_add_u32 s64, s26, 0x1e6000
    buffer_load_dwordx4 v2, s[44:47], s64 offen lds
    s_add_u32 m0, s25, 19456
    s_add_u32 s64, s26, 0x201000
    buffer_load_dwordx4 v2, s[44:47], s64 offen lds
    s_waitcnt vmcnt(0)
    ds_read_b64_tr_b16 v[96:97], v3 offset:0
    ds_read_b64_tr_b16 v[98:99], v3 offset:128
    ds_read_b64_tr_b16 v[100:101], v3 offset:1024
    ds_read_b64_tr_b16 v[102:103], v3 offset:1152
    ds_read_b64_tr_b16 v[104:105], v3 offset:2048
    ds_read_b64_tr_b16 v[106:107], v3 offset:2176
    ds_read_b64_tr_b16 v[108:109], v3 offset:3072
    ds_read_b64_tr_b16 v[110:111], v3 offset:3200
    ds_read_b64_tr_b16 v[112:113], v3 offset:4096
    ds_read_b64_tr_b16 v[114:115], v3 offset:4224
    ds_read_b64_tr_b16 v[116:117], v3 offset:5120
    ds_read_b64_tr_b16 v[118:119], v3 offset:5248
    s_waitcnt lgkmcnt(4)
    ds_read_b64_tr_b16 v[120:121], v3 offset:6144
    ds_read_b64_tr_b16 v[122:123], v3 offset:6272
    ds_read_b64_tr_b16 v[124:125], v3 offset:7168
    ds_read_b64_tr_b16 v[126:127], v3 offset:7296
    ds_read_b64_tr_b16 v[128:129], v3 offset:8192
    ds_read_b64_tr_b16 v[130:131], v3 offset:8320
    ds_read_b64_tr_b16 v[132:133], v3 offset:9216
    ds_read_b64_tr_b16 v[134:135], v3 offset:9344
    ds_read_b64_tr_b16 v[136:137], v3 offset:10240
    ds_read_b64_tr_b16 v[138:139], v3 offset:10368
    ds_read_b64_tr_b16 v[140:141], v3 offset:11264
    ds_read_b64_tr_b16 v[142:143], v3 offset:11392
    s_waitcnt lgkmcnt(4)
    ds_read_b64_tr_b16 v[144:145], v3 offset:12288
    ds_read_b64_tr_b16 v[146:147], v3 offset:12416
    ds_read_b64_tr_b16 v[148:149], v3 offset:13312
    ds_read_b64_tr_b16 v[150:151], v3 offset:13440
    ds_read_b64_tr_b16 v[152:153], v3 offset:14336
    ds_read_b64_tr_b16 v[154:155], v3 offset:14464
    ds_read_b64_tr_b16 v[156:157], v3 offset:15360
    ds_read_b64_tr_b16 v[158:159], v3 offset:15488
    ds_read_b64_tr_b16 v[160:161], v3 offset:16384
    ds_read_b64_tr_b16 v[162:163], v3 offset:16512
    ds_read_b64_tr_b16 v[164:165], v3 offset:17408
    ds_read_b64_tr_b16 v[166:167], v3 offset:17536
    s_waitcnt lgkmcnt(4)
    ds_read_b64_tr_b16 v[168:169], v3 offset:18432
    ds_read_b64_tr_b16 v[170:171], v3 offset:18560
    ds_read_b64_tr_b16 v[172:173], v3 offset:19456
    ds_read_b64_tr_b16 v[174:175], v3 offset:19584
    s_waitcnt lgkmcnt(0)
    s_add_u32 s25, s25, 20480
    v_add_u32 v3, 20480, v3
    s_add_u32 m0, s25, 0
    s_add_u32 s64, s26, 0x0
    buffer_load_dwordx4 v2, s[48:51], s64 offen lds
    s_add_u32 m0, s25, 1024
    s_add_u32 s64, s26, 0x1b000
    buffer_load_dwordx4 v2, s[48:51], s64 offen lds
    s_add_u32 m0, s25, 2048
    s_add_u32 s64, s26, 0x36000
    buffer_load_dwordx4 v2, s[48:51], s64 offen lds
    s_add_u32 m0, s25, 3072
    s_add_u32 s64, s26, 0x51000
    buffer_load_dwordx4 v2, s[48:51], s64 offen lds
    s_add_u32 m0, s25, 4096
    s_add_u32 s64, s26, 0x6c000
    buffer_load_dwordx4 v2, s[48:51], s64 offen lds
    s_add_u32 m0, s25, 5120
    s_add_u32 s64, s26, 0x87000
    buffer_load_dwordx4 v2, s[48:51], s64 offen lds
    s_add_u32 m0, s25, 6144
    s_add_u32 s64, s26, 0xa2000
    buffer_load_dwordx4 v2, s[48:51], s64 offen lds
    s_add_u32 m0, s25, 7168
    s_add_u32 s64, s26, 0xbd000
    buffer_load_dwordx4 v2, s[48:51], s64 offen lds
    s_add_u32 m0, s25, 8192
    s_add_u32 s64, s26, 0xd8000
    buffer_load_dwordx4 v2, s[48:51], s64 offen lds
    s_add_u32 m0, s25, 9216
    s_add_u32 s64, s26, 0xf3000
    buffer_load_dwordx4 v2, s[48:51], s64 offen lds
    s_add_u32 m0, s25, 10240
    s_add_u32 s64, s26, 0x10e000
    buffer_load_dwordx4 v2, s[48:51], s64 offen lds
    s_add_u32 m0, s25, 11264
    s_add_u32 s64, s26, 0x129000
    buffer_load_dwordx4 v2, s[48:51], s64 offen lds
    s_add_u32 m0, s25, 12288
    s_add_u32 s64, s26, 0x144000
    buffer_load_dwordx4 v2, s[48:51], s64 offen lds
    s_add_u32 m0, s25, 13312
    s_add_u32 s64, s26, 0x15f000
    buffer_load_dwordx4 v2, s[48:51], s64 offen lds
    s_add_u32 m0, s25, 14336
    s_add_u32 s64, s26, 0x17a000
    buffer_load_dwordx4 v2, s[48:51], s64 offen lds
    s_add_u32 m0, s25, 15360
    s_add_u32 s64, s26, 0x195000
    buffer_load_dwordx4 v2, s[48:51], s64 offen lds
    s_add_u32 m0, s25, 16384
    s_add_u32 s64, s26, 0x1b0000
    buffer_load_dwordx4 v2, s[48:51], s64 offen lds
    s_add_u32 m0, s25, 17408
    s_add_u32 s64, s26, 0x1cb000
    buffer_load_dwordx4 v2, s[48:51], s64 offen lds
    s_add_u32 m0, s25, 18432
    s_add_u32 s64, s26, 0x1e6000
    buffer_load_dwordx4 v2, s[48:51], s64 offen lds
    s_add_u32 m0, s25, 19456
    s_add_u32 s64, s26, 0x201000
    buffer_load_dwordx4 v2, s[48:51], s64 offen lds
    s_waitcnt vmcnt(0)
    ds_read_b64_tr_b16 v[176:177], v3 offset:0
    ds_read_b64_tr_b16 v[178:179], v3 offset:128
    ds_read_b64_tr_b16 v[180:181], v3 offset:1024
    ds_read_b64_tr_b16 v[182:183], v3 offset:1152
    ds_read_b64_tr_b16 v[184:185], v3 offset:2048
    ds_read_b64_tr_b16 v[186:187], v3 offset:2176
    ds_read_b64_tr_b16 v[188:189], v3 offset:3072
    ds_read_b64_tr_b16 v[190:191], v3 offset:3200
    ds_read_b64_tr_b16 v[192:193], v3 offset:4096
    ds_read_b64_tr_b16 v[194:195], v3 offset:4224
    ds_read_b64_tr_b16 v[196:197], v3 offset:5120
    ds_read_b64_tr_b16 v[198:199], v3 offset:5248
    s_waitcnt lgkmcnt(4)
    ds_read_b64_tr_b16 v[200:201], v3 offset:6144
    ds_read_b64_tr_b16 v[202:203], v3 offset:6272
    ds_read_b64_tr_b16 v[204:205], v3 offset:7168
    ds_read_b64_tr_b16 v[206:207], v3 offset:7296
    ds_read_b64_tr_b16 v[208:209], v3 offset:8192
    ds_read_b64_tr_b16 v[210:211], v3 offset:8320
    ds_read_b64_tr_b16 v[212:213], v3 offset:9216
    ds_read_b64_tr_b16 v[214:215], v3 offset:9344
    ds_read_b64_tr_b16 v[216:217], v3 offset:10240
    ds_read_b64_tr_b16 v[218:219], v3 offset:10368
    ds_read_b64_tr_b16 v[220:221], v3 offset:11264
    ds_read_b64_tr_b16 v[222:223], v3 offset:11392
    s_waitcnt lgkmcnt(4)
    ds_read_b64_tr_b16 v[224:225], v3 offset:12288
    ds_read_b64_tr_b16 v[226:227], v3 offset:12416
    ds_read_b64_tr_b16 v[228:229], v3 offset:13312
    ds_read_b64_tr_b16 v[230:231], v3 offset:13440
    ds_read_b64_tr_b16 v[232:233], v3 offset:14336
    ds_read_b64_tr_b16 v[234:235], v3 offset:14464
    ds_read_b64_tr_b16 v[236:237], v3 offset:15360
    ds_read_b64_tr_b16 v[238:239], v3 offset:15488
    ds_read_b64_tr_b16 v[240:241], v3 offset:16384
    ds_read_b64_tr_b16 v[242:243], v3 offset:16512
    ds_read_b64_tr_b16 v[244:245], v3 offset:17408
    ds_read_b64_tr_b16 v[246:247], v3 offset:17536
    s_waitcnt lgkmcnt(4)
    ds_read_b64_tr_b16 v[248:249], v3 offset:18432
    ds_read_b64_tr_b16 v[250:251], v3 offset:18560
    ds_read_b64_tr_b16 v[252:253], v3 offset:19456
    ds_read_b64_tr_b16 v[254:255], v3 offset:19584
    s_waitcnt lgkmcnt(0)
    v_mfma_f32_16x16x32_bf16 v[8:11], v[96:99], v[16:19], 0
    v_mfma_f32_16x16x32_bf16 v[12:15], v[176:179], v[16:19], 0
    v_mfma_f32_16x16x32_bf16 v[8:11], v[100:103], v[20:23], v[8:11]
    v_mfma_f32_16x16x32_bf16 v[12:15], v[180:183], v[20:23], v[12:15]
    v_mfma_f32_16x16x32_bf16 v[8:11], v[104:107], v[24:27], v[8:11]
    v_mfma_f32_16x16x32_bf16 v[12:15], v[184:187], v[24:27], v[12:15]
    v_mfma_f32_16x16x32_bf16 v[8:11], v[108:111], v[28:31], v[8:11]
    v_mfma_f32_16x16x32_bf16 v[12:15], v[188:191], v[28:31], v[12:15]
    v_mfma_f32_16x16x32_bf16 v[8:11], v[112:115], v[32:35], v[8:11]
    v_mfma_f32_16x16x32_bf16 v[12:15], v[192:195], v[32:35], v[12:15]
    v_mfma_f32_16x16x32_bf16 v[8:11], v[116:119], v[36:39], v[8:11]
    v_mfma_f32_16x16x32_bf16 v[12:15], v[196:199], v[36:39], v[12:15]
    v_mfma_f32_16x16x32_bf16 v[8:11], v[120:123], v[40:43], v[8:11]
    v_mfma_f32_16x16x32_bf16 v[12:15], v[200:203], v[40:43], v[12:15]
    v_mfma_f32_16x16x32_bf16 v[8:11], v[124:127], v[44:47], v[8:11]
    v_mfma_f32_16x16x32_bf16 v[12:15], v[204:207], v[44:47], v[12:15]
    v_mfma_f32_16x16x32_bf16 v[8:11], v[128:131], v[48:51], v[8:11]
    v_mfma_f32_16x16x32_bf16 v[12:15], v[208:211], v[48:51], v[12:15]
    v_mfma_f32_16x16x32_bf16 v[8:11], v[132:135], v[52:55], v[8:11]
    v_mfma_f32_16x16x32_bf16 v[12:15], v[212:215], v[52:55], v[12:15]
    v_mfma_f32_16x16x32_bf16 v[8:11], v[136:139], v[56:59], v[8:11]
    v_mfma_f32_16x16x32_bf16 v[12:15], v[216:219], v[56:59], v[12:15]
    v_mfma_f32_16x16x32_bf16 v[8:11], v[140:143], v[60:63], v[8:11]
    v_mfma_f32_16x16x32_bf16 v[12:15], v[220:223], v[60:63], v[12:15]
    v_mfma_f32_16x16x32_bf16 v[8:11], v[144:147], v[64:67], v[8:11]
    v_mfma_f32_16x16x32_bf16 v[12:15], v[224:227], v[64:67], v[12:15]
    v_mfma_f32_16x16x32_bf16 v[8:11], v[148:151], v[68:71], v[8:11]
    v_mfma_f32_16x16x32_bf16 v[12:15], v[228:231], v[68:71], v[12:15]
    v_mfma_f32_16x16x32_bf16 v[8:11], v[152:155], v[72:75], v[8:11]
    v_mfma_f32_16x16x32_bf16 v[12:15], v[232:235], v[72:75], v[12:15]
    v_mfma_f32_16x16x32_bf16 v[8:11], v[156:159], v[76:79], v[8:11]
    v_mfma_f32_16x16x32_bf16 v[12:15], v[236:239], v[76:79], v[12:15]
    v_mfma_f32_16x16x32_bf16 v[8:11], v[160:163], v[80:83], v[8:11]
    v_mfma_f32_16x16x32_bf16 v[12:15], v[240:243], v[80:83], v[12:15]
    v_mfma_f32_16x16x32_bf16 v[8:11], v[164:167], v[84:87], v[8:11]
    v_mfma_f32_16x16x32_bf16 v[12:15], v[244:247], v[84:87], v[12:15]
    v_mfma_f32_16x16x32_bf16 v[8:11], v[168:171], v[88:91], v[8:11]
    v_mfma_f32_16x16x32_bf16 v[12:15], v[248:251], v[88:91], v[12:15]
    v_mfma_f32_16x16x32_bf16 v[8:11], v[172:175], v[92:95], v[8:11]
    v_mfma_f32_16x16x32_bf16 v[12:15], v[252:255], v[92:95], v[12:15]
    s_nop 7
    v_cvt_pk_bf16_f32 v8, v8, v8
    v_lshlrev_b32 v8, 16, v8
    v_cvt_pk_bf16_f32 v12, v12, v12
    v_lshlrev_b32 v12, 16, v12
    v_mul_f32 v16, 0xbfb8aa3b, v8
    v_exp_f32 v16, v16
    s_nop 0
    v_add_f32 v16, 1.0, v16
    v_rcp_f32 v16, v16
    s_nop 0
    v_mul_f32 v8, v8, v16
    v_cvt_pk_bf16_f32 v8, v8, v8
    v_lshlrev_b32 v8, 16, v8
    v_mul_f32 v8, v8, v12
    v_cvt_pk_bf16_f32 v9, v9, v9
    v_lshlrev_b32 v9, 16, v9
    v_cvt_pk_bf16_f32 v13, v13, v13
    v_lshlrev_b32 v13, 16, v13
    v_mul_f32 v17, 0xbfb8aa3b, v9
    v_exp_f32 v17, v17
    s_nop 0
    v_add_f32 v17, 1.0, v17
    v_rcp_f32 v17, v17
    s_nop 0
    v_mul_f32 v9, v9, v17
    v_cvt_pk_bf16_f32 v9, v9, v9
    v_lshlrev_b32 v9, 16, v9
    v_mul_f32 v9, v9, v13
    v_cvt_pk_bf16_f32 v10, v10, v10
    v_lshlrev_b32 v10, 16, v10
    v_cvt_pk_bf16_f32 v14, v14, v14
    v_lshlrev_b32 v14, 16, v14
    v_mul_f32 v18, 0xbfb8aa3b, v10
    v_exp_f32 v18, v18
    s_nop 0
    v_add_f32 v18, 1.0, v18
    v_rcp_f32 v18, v18
    s_nop 0
    v_mul_f32 v10, v10, v18
    v_cvt_pk_bf16_f32 v10, v10, v10
    v_lshlrev_b32 v10, 16, v10
    v_mul_f32 v10, v10, v14
    v_cvt_pk_bf16_f32 v11, v11, v11
    v_lshlrev_b32 v11, 16, v11
    v_cvt_pk_bf16_f32 v15, v15, v15
    v_lshlrev_b32 v15, 16, v15
    v_mul_f32 v19, 0xbfb8aa3b, v11
    v_exp_f32 v19, v19
    s_nop 0
    v_add_f32 v19, 1.0, v19
    v_rcp_f32 v19, v19
    s_nop 0
    v_mul_f32 v11, v11, v19
    v_cvt_pk_bf16_f32 v11, v11, v11
    v_lshlrev_b32 v11, 16, v11
    v_mul_f32 v11, v11, v15
    v_cvt_pk_bf16_f32 v16, v8, v9
    v_cvt_pk_bf16_f32 v17, v10, v11
    s_lshr_b32 s65, s24, 1
    s_lshl_b32 s65, s65, 10
    s_and_b32 s66, s24, 1
    s_lshl_b32 s66, s66, 3
    s_add_u32 s65, s65, s66
    s_add_u32 s65, s65, 0x5401000
    v_lshlrev_b32 v4, 4, v0
    buffer_store_dwordx2 v[16:17], v4, s[4:7], s65 offen sc1
    s_waitcnt vmcnt(0)
    v_mov_b32 v7, 1
    v_mov_b32 v8, 0
    s_mov_b32 s64, 0x298080
    s_mov_b64 exec, 1
    buffer_atomic_add v7, v8, s[4:7], s64 offen sc1
    s_mov_b64 exec, -1
H_A1:
    v_mbcnt_lo_u32_b32 v0, -1, 0
    v_mbcnt_hi_u32_b32 v0, -1, v0
    s_mov_b32 s29, 0
    v_lshlrev_b32 v1, 4, v0
    v_lshrrev_b32 v5, 4, v0
    v_lshlrev_b32 v2, 7, v5
    v_and_b32 v5, 7, v0
    v_lshl_add_u32 v2, v5, 4, v2
    v_bfe_u32 v5, v0, 4, 1
    v_lshlrev_b32 v3, 7, v5
    v_and_b32 v5, 15, v0
    v_lshl_add_u32 v3, v5, 3, v3
    s_mov_b32 s34, 0x3e0293ee
    s_mov_b32 s35, 0x3e0293ee
    s_mov_b32 s36, -1
    s_mov_b32 s37, 0
    v_lshrrev_b32 v5, 4, v0
    v_lshlrev_b32 v5, 2, v5
    v_and_b32 v6, 15, v0
    v_add_u32 v7, 0, v5
    v_cmp_le_u32 s[38:39], v7, v6
    v_add_u32 v7, 1, v5
    v_cmp_le_u32 s[40:41], v7, v6
    v_add_u32 v7, 2, v5
    v_cmp_le_u32 s[42:43], v7, v6
    v_add_u32 v7, 3, v5
    v_cmp_le_u32 s[44:45], v7, v6
    v_mov_b32 v248, 0x3f803f80
    v_mov_b32 v249, 0x3f803f80
    v_mov_b32 v250, 0x3f803f80
    v_mov_b32 v251, 0x3f803f80
    s_lshl_b32 s24, s12, 2
    s_add_u32 s24, s24, s14
    s_add_u32 s24, s24, 8
    s_mov_b32 s25, 1
AT1_LOOP:
    s_cmp_eq_u32 s24, 63
    s_cbranch_scc1 AT1_END
    s_lshl_b32 s64, s24, 5
    s_add_u32 s64, s64, s13
    s_lshl_b32 s26, s64, 13
    s_add_u32 s26, s26, 0x3400000
    s_lshl_b32 s27, s64, 14
    s_add_u32 s27, s27, 0x1400000
    s_lshl_b32 s65, s64, 11
    s_add_u32 s30, s65, 0x640000
    s_add_u32 s31, s65, 0xa40000
    s_lshl_b32 s33, s64, 2
    s_add_u32 s33, s33, 0x296000
    s_lshl_b32 s32, s24, 18
    s_lshl_b32 s65, s13, 12
    s_add_u32 s32, s32, s65
    s_add_u32 s32, s32, 0x4400000
    s_lshr_b32 s65, s24, 2
    s_lshl_b32 s65, s65, 9
    s_lshl_b32 s66, s13, 4
    s_add_u32 s65, s65, s66
    s_add_u32 s65, s65, 0x291000
    s_lshr_b32 s66, s24, 1
    s_lshl_b32 s66, s66, 8
    s_lshl_b32 s64, s13, 3
    s_add_u32 s66, s66, s64
    s_add_u32 s66, s66, 0x293ff4
    v_lshlrev_b32 v5, 2, v0
    v_mov_b32 v6, s65
    v_mov_b32 v7, s66
    v_cmp_gt_u32 vcc, 3, v0
    s_nop 1
    v_cndmask_b32 v6, v7, v6, vcc
    v_add_u32 v4, v5, v6
    s_mov_b32 s64, 0
    s_mov_b64 exec, 7
AT1_F_186:
    buffer_load_dword v5, v4, s[4:7], s64 offen sc1
    s_add_u32 s29, s29, 1
    s_waitcnt vmcnt(0)
    v_cmp_eq_u32 vcc, 0, v5
    s_cbranch_vccz AT1_FD_187
    s_cmp_gt_u32 s29, 262144
    s_cbranch_scc1 AT1_FD_187
    s_sleep 1
    s_branch AT1_F_186
AT1_FD_187:
    s_mov_b64 exec, -1
    buffer_load_dwordx4 v[16:19], v1, s[4:7], s26 offen offset:0
    buffer_load_dwordx4 v[20:23], v1, s[4:7], s26 offen offset:1024
    buffer_load_dwordx4 v[24:27], v1, s[4:7], s26 offen offset:2048
    buffer_load_dwordx4 v[28:31], v1, s[4:7], s26 offen offset:3072
    s_add_u32 s26, s26, 4096
    buffer_load_dwordx4 v[32:35], v1, s[4:7], s26 offen offset:0
    buffer_load_dwordx4 v[36:39], v1, s[4:7], s26 offen offset:1024
    buffer_load_dwordx4 v[40:43], v1, s[4:7], s26 offen offset:2048
    buffer_load_dwordx4 v[44:47], v1, s[4:7], s26 offen offset:3072
    buffer_load_dwordx4 v[48:51], v1, s[4:7], s27 offen offset:0
    buffer_load_dwordx4 v[52:55], v1, s[4:7], s27 offen offset:1024
    buffer_load_dwordx4 v[56:59], v1, s[4:7], s27 offen offset:2048
    buffer_load_dwordx4 v[60:63], v1, s[4:7], s27 offen offset:3072
    s_add_u32 s27, s27, 4096
    buffer_load_dwordx4 v[64:67], v1, s[4:7], s27 offen offset:0
    buffer_load_dwordx4 v[68:71], v1, s[4:7], s27 offen offset:1024
    buffer_load_dwordx4 v[72:75], v1, s[4:7], s27 offen offset:2048
    buffer_load_dwordx4 v[76:79], v1, s[4:7], s27 offen offset:3072
    s_add_u32 s27, s27, 4096
    buffer_load_dwordx4 v[80:83], v1, s[4:7], s27 offen offset:0
    buffer_load_dwordx4 v[84:87], v1, s[4:7], s27 offen offset:1024
    buffer_load_dwordx4 v[88:91], v1, s[4:7], s27 offen offset:2048
    buffer_load_dwordx4 v[92:95], v1, s[4:7], s27 offen offset:3072
    s_add_u32 s27, s27, 4096
    buffer_load_dwordx4 v[96:99], v1, s[4:7], s27 offen offset:0
    buffer_load_dwordx4 v[100:103], v1, s[4:7], s27 offen offset:1024
    buffer_load_dwordx4 v[104:107], v1, s[4:7], s27 offen offset:2048
    buffer_load_dwordx4 v[108:111], v1, s[4:7], s27 offen offset:3072
    s_mov_b64 exec, 0x18
AT1_G_188:
    buffer_load_dword v5, v4, s[4:7], s64 offen sc1
    s_add_u32 s29, s29, 1
    s_waitcnt vmcnt(0)
    v_cmp_eq_u32 vcc, 0, v5
    s_cbranch_vccz AT1_GD_189
    s_cmp_gt_u32 s29, 262144
    s_cbranch_scc1 AT1_GD_189
    s_sleep 1
    s_branch AT1_G_188
AT1_GD_189:
    s_mov_b64 exec, -1
    buffer_load_dwordx4 v[112:115], v2, s[4:7], s30 offen offset:0
    buffer_load_dwordx4 v[116:119], v2, s[4:7], s30 offen offset:512
    buffer_load_dwordx4 v[120:123], v2, s[4:7], s30 offen offset:1024
    buffer_load_dwordx4 v[124:127], v2, s[4:7], s30 offen offset:1536
    buffer_load_dwordx2 v[128:129], v3, s[4:7], s31 offen offset:0
    buffer_load_dwordx2 v[130:131], v3, s[4:7], s31 offen offset:256
    buffer_load_dwordx2 v[132:133], v3, s[4:7], s31 offen offset:512
    buffer_load_dwordx2 v[134:135], v3, s[4:7], s31 offen offset:768
    buffer_load_dwordx2 v[136:137], v3, s[4:7], s31 offen offset:1024
    buffer_load_dwordx2 v[138:139], v3, s[4:7], s31 offen offset:1280
    buffer_load_dwordx2 v[140:141], v3, s[4:7], s31 offen offset:1536
    buffer_load_dwordx2 v[142:143], v3, s[4:7], s31 offen offset:1792
    v_mfma_f32_16x16x32_bf16 v[148:151], v[48:51], v[16:19], 0
    v_mfma_f32_16x16x32_bf16 v[156:159], v[48:51], v[32:35], 0
    v_mfma_f32_16x16x32_bf16 v[160:163], v[64:67], v[32:35], 0
    v_mfma_f32_16x16x32_bf16 v[148:151], v[52:55], v[20:23], v[148:151]
    v_mfma_f32_16x16x32_bf16 v[156:159], v[52:55], v[36:39], v[156:159]
    v_mfma_f32_16x16x32_bf16 v[160:163], v[68:71], v[36:39], v[160:163]
    v_mfma_f32_16x16x32_bf16 v[148:151], v[56:59], v[24:27], v[148:151]
    v_mfma_f32_16x16x32_bf16 v[156:159], v[56:59], v[40:43], v[156:159]
    v_mfma_f32_16x16x32_bf16 v[160:163], v[72:75], v[40:43], v[160:163]
    v_mfma_f32_16x16x32_bf16 v[148:151], v[60:63], v[28:31], v[148:151]
    v_mfma_f32_16x16x32_bf16 v[156:159], v[60:63], v[44:47], v[156:159]
    v_mfma_f32_16x16x32_bf16 v[160:163], v[76:79], v[44:47], v[160:163]
    s_waitcnt vmcnt(8)
    v_mfma_f32_16x16x32_bf16 v[144:147], v[112:115], v[16:19], 0
    v_mfma_f32_16x16x32_bf16 v[152:155], v[112:115], v[32:35], 0
    v_mfma_f32_16x16x32_bf16 v[144:147], v[116:119], v[20:23], v[144:147]
    v_mfma_f32_16x16x32_bf16 v[152:155], v[116:119], v[36:39], v[152:155]
    v_mfma_f32_16x16x32_bf16 v[144:147], v[120:123], v[24:27], v[144:147]
    v_mfma_f32_16x16x32_bf16 v[152:155], v[120:123], v[40:43], v[152:155]
    v_mfma_f32_16x16x32_bf16 v[144:147], v[124:127], v[28:31], v[144:147]
    v_mfma_f32_16x16x32_bf16 v[152:155], v[124:127], v[44:47], v[152:155]
    v_mov_b32 v11, 0xff800000
    s_nop 7
    v_cndmask_b32 v148, v11, v148, s[38:39]
    v_cndmask_b32 v160, v11, v160, s[38:39]
    v_cndmask_b32 v144, v11, v144, s[36:37]
    v_cndmask_b32 v152, v11, v152, s[36:37]
    v_cndmask_b32 v149, v11, v149, s[40:41]
    v_cndmask_b32 v161, v11, v161, s[40:41]
    v_cndmask_b32 v145, v11, v145, s[36:37]
    v_cndmask_b32 v153, v11, v153, s[36:37]
    v_cndmask_b32 v150, v11, v150, s[42:43]
    v_cndmask_b32 v162, v11, v162, s[42:43]
    v_cndmask_b32 v146, v11, v146, s[36:37]
    v_cndmask_b32 v154, v11, v154, s[36:37]
    v_cndmask_b32 v151, v11, v151, s[44:45]
    v_cndmask_b32 v163, v11, v163, s[44:45]
    v_cndmask_b32 v147, v11, v147, s[36:37]
    v_cndmask_b32 v155, v11, v155, s[36:37]
    v_max3_f32 v8, v144, v145, v146
    v_max3_f32 v8, v8, v147, v148
    v_max3_f32 v8, v8, v149, v150
    v_max_f32 v8, v8, v151
    v_mov_b32 v9, v8
    s_nop 1
    v_permlane16_swap_b32 v8, v9
    v_max_f32 v8, v8, v9
    v_mov_b32 v9, v8
    s_nop 1
    v_permlane32_swap_b32 v8, v9
    v_max_f32 v8, v8, v9
    v_mul_f32 v8, s34, v8
    v_fma_f32 v144, v144, s34, -v8
    v_fma_f32 v145, v145, s34, -v8
    v_fma_f32 v146, v146, s34, -v8
    v_fma_f32 v147, v147, s34, -v8
    v_fma_f32 v148, v148, s34, -v8
    v_fma_f32 v149, v149, s34, -v8
    v_fma_f32 v150, v150, s34, -v8
    v_fma_f32 v151, v151, s34, -v8
    v_exp_f32 v144, v144
    v_exp_f32 v145, v145
    v_exp_f32 v146, v146
    v_exp_f32 v147, v147
    v_exp_f32 v148, v148
    v_exp_f32 v149, v149
    v_exp_f32 v150, v150
    v_exp_f32 v151, v151
    s_nop 0
    v_cvt_pk_bf16_f32 v164, v148, v149
    v_cvt_pk_bf16_f32 v165, v150, v151
    v_mov_b32 v166, 0
    v_mov_b32 v167, 0
    v_cvt_pk_bf16_f32 v168, v144, v145
    v_cvt_pk_bf16_f32 v169, v146, v147
    v_max3_f32 v8, v152, v153, v154
    v_max3_f32 v8, v8, v155, v156
    v_max3_f32 v8, v8, v157, v158
    v_max3_f32 v8, v8, v159, v160
    v_max3_f32 v8, v8, v161, v162
    v_max_f32 v8, v8, v163
    v_mov_b32 v9, v8
    s_nop 1
    v_permlane16_swap_b32 v8, v9
    v_max_f32 v8, v8, v9
    v_mov_b32 v9, v8
    s_nop 1
    v_permlane32_swap_b32 v8, v9
    v_max_f32 v8, v8, v9
    v_mul_f32 v8, s34, v8
    v_fma_f32 v152, v152, s34, -v8
    v_fma_f32 v153, v153, s34, -v8
    v_fma_f32 v154, v154, s34, -v8
    v_fma_f32 v155, v155, s34, -v8
    v_fma_f32 v156, v156, s34, -v8
    v_fma_f32 v157, v157, s34, -v8
    v_fma_f32 v158, v158, s34, -v8
    v_fma_f32 v159, v159, s34, -v8
    v_fma_f32 v160, v160, s34, -v8
    v_fma_f32 v161, v161, s34, -v8
    v_fma_f32 v162, v162, s34, -v8
    v_fma_f32 v163, v163, s34, -v8
    v_exp_f32 v152, v152
    v_exp_f32 v153, v153
    v_exp_f32 v154, v154
    v_exp_f32 v155, v155
    v_exp_f32 v156, v156
    v_exp_f32 v157, v157
    v_exp_f32 v158, v158
    v_exp_f32 v159, v159
    v_exp_f32 v160, v160
    v_exp_f32 v161, v161
    v_exp_f32 v162, v162
    v_exp_f32 v163, v163
    s_nop 0
    v_cvt_pk_bf16_f32 v170, v156, v157
    v_cvt_pk_bf16_f32 v171, v158, v159
    v_cvt_pk_bf16_f32 v172, v160, v161
    v_cvt_pk_bf16_f32 v173, v162, v163
    v_cvt_pk_bf16_f32 v174, v152, v153
    v_cvt_pk_bf16_f32 v175, v154, v155
    s_waitcnt vmcnt(0)
    v_mfma_f32_16x16x32_bf16 v[240:243], v[248:251], v[164:167], 0
    v_mfma_f32_16x16x32_bf16 v[244:247], v[248:251], v[170:173], 0
    v_mfma_f32_16x16x32_bf16 v[176:179], v[80:83], v[164:167], 0
    v_mfma_f32_16x16x32_bf16 v[180:183], v[80:83], v[170:173], 0
    v_mfma_f32_16x16x32_bf16 v[184:187], v[84:87], v[164:167], 0
    v_mfma_f32_16x16x32_bf16 v[188:191], v[84:87], v[170:173], 0
    v_mfma_f32_16x16x32_bf16 v[192:195], v[88:91], v[164:167], 0
    v_mfma_f32_16x16x32_bf16 v[196:199], v[88:91], v[170:173], 0
    v_mfma_f32_16x16x32_bf16 v[200:203], v[92:95], v[164:167], 0
    v_mfma_f32_16x16x32_bf16 v[204:207], v[92:95], v[170:173], 0
    v_mfma_f32_16x16x32_bf16 v[208:211], v[96:99], v[164:167], 0
    v_mfma_f32_16x16x32_bf16 v[212:215], v[96:99], v[170:173], 0
    v_mfma_f32_16x16x32_bf16 v[216:219], v[100:103], v[164:167], 0
    v_mfma_f32_16x16x32_bf16 v[220:223], v[100:103], v[170:173], 0
    v_mfma_f32_16x16x32_bf16 v[224:227], v[104:107], v[164:167], 0
    v_mfma_f32_16x16x32_bf16 v[228:231], v[104:107], v[170:173], 0
    v_mfma_f32_16x16x32_bf16 v[232:235], v[108:111], v[164:167], 0
    v_mfma_f32_16x16x32_bf16 v[236:239], v[108:111], v[170:173], 0
    v_mfma_f32_16x16x16_bf16 v[240:243], v[248:249], v[168:169], v[240:243]
    v_mfma_f32_16x16x16_bf16 v[244:247], v[248:249], v[174:175], v[244:247]
    v_mfma_f32_16x16x16_bf16 v[176:179], v[128:129], v[168:169], v[176:179]
    v_mfma_f32_16x16x16_bf16 v[180:183], v[128:129], v[174:175], v[180:183]
    v_mfma_f32_16x16x16_bf16 v[184:187], v[130:131], v[168:169], v[184:187]
    v_mfma_f32_16x16x16_bf16 v[188:191], v[130:131], v[174:175], v[188:191]
    v_mfma_f32_16x16x16_bf16 v[192:195], v[132:133], v[168:169], v[192:195]
    v_mfma_f32_16x16x16_bf16 v[196:199], v[132:133], v[174:175], v[196:199]
    v_mfma_f32_16x16x16_bf16 v[200:203], v[134:135], v[168:169], v[200:203]
    v_mfma_f32_16x16x16_bf16 v[204:207], v[134:135], v[174:175], v[204:207]
    v_mfma_f32_16x16x16_bf16 v[208:211], v[136:137], v[168:169], v[208:211]
    v_mfma_f32_16x16x16_bf16 v[212:215], v[136:137], v[174:175], v[212:215]
    v_mfma_f32_16x16x16_bf16 v[216:219], v[138:139], v[168:169], v[216:219]
    v_mfma_f32_16x16x16_bf16 v[220:223], v[138:139], v[174:175], v[220:223]
    v_mfma_f32_16x16x16_bf16 v[224:227], v[140:141], v[168:169], v[224:227]
    v_mfma_f32_16x16x16_bf16 v[228:231], v[140:141], v[174:175], v[228:231]
    v_mfma_f32_16x16x16_bf16 v[232:235], v[142:143], v[168:169], v[232:235]
    v_mfma_f32_16x16x16_bf16 v[236:239], v[142:143], v[174:175], v[236:239]
    v_rcp_f32 v8, v240
    v_rcp_f32 v9, v244
    s_nop 7
    v_mul_f32 v176, v176, v8
    v_mul_f32 v177, v177, v8
    v_mul_f32 v178, v178, v8
    v_mul_f32 v179, v179, v8
    v_cvt_pk_bf16_f32 v16, v176, v177
    v_cvt_pk_bf16_f32 v17, v178, v179
    v_mul_f32 v184, v184, v8
    v_mul_f32 v185, v185, v8
    v_mul_f32 v186, v186, v8
    v_mul_f32 v187, v187, v8
    v_cvt_pk_bf16_f32 v18, v184, v185
    v_cvt_pk_bf16_f32 v19, v186, v187
    s_add_u32 s64, s32, 0x0
    buffer_store_dwordx4 v[16:19], v1, s[4:7], s64 offen offset:0 sc1
    v_mul_f32 v192, v192, v8
    v_mul_f32 v193, v193, v8
    v_mul_f32 v194, v194, v8
    v_mul_f32 v195, v195, v8
    v_cvt_pk_bf16_f32 v20, v192, v193
    v_cvt_pk_bf16_f32 v21, v194, v195
    v_mul_f32 v200, v200, v8
    v_mul_f32 v201, v201, v8
    v_mul_f32 v202, v202, v8
    v_mul_f32 v203, v203, v8
    v_cvt_pk_bf16_f32 v22, v200, v201
    v_cvt_pk_bf16_f32 v23, v202, v203
    s_add_u32 s64, s32, 0x0
    buffer_store_dwordx4 v[20:23], v1, s[4:7], s64 offen offset:1024 sc1
    v_mul_f32 v208, v208, v8
    v_mul_f32 v209, v209, v8
    v_mul_f32 v210, v210, v8
    v_mul_f32 v211, v211, v8
    v_cvt_pk_bf16_f32 v24, v208, v209
    v_cvt_pk_bf16_f32 v25, v210, v211
    v_mul_f32 v216, v216, v8
    v_mul_f32 v217, v217, v8
    v_mul_f32 v218, v218, v8
    v_mul_f32 v219, v219, v8
    v_cvt_pk_bf16_f32 v26, v216, v217
    v_cvt_pk_bf16_f32 v27, v218, v219
    s_add_u32 s64, s32, 0x0
    buffer_store_dwordx4 v[24:27], v1, s[4:7], s64 offen offset:2048 sc1
    v_mul_f32 v224, v224, v8
    v_mul_f32 v225, v225, v8
    v_mul_f32 v226, v226, v8
    v_mul_f32 v227, v227, v8
    v_cvt_pk_bf16_f32 v28, v224, v225
    v_cvt_pk_bf16_f32 v29, v226, v227
    v_mul_f32 v232, v232, v8
    v_mul_f32 v233, v233, v8
    v_mul_f32 v234, v234, v8
    v_mul_f32 v235, v235, v8
    v_cvt_pk_bf16_f32 v30, v232, v233
    v_cvt_pk_bf16_f32 v31, v234, v235
    s_add_u32 s64, s32, 0x0
    buffer_store_dwordx4 v[28:31], v1, s[4:7], s64 offen offset:3072 sc1
    v_mul_f32 v180, v180, v9
    v_mul_f32 v181, v181, v9
    v_mul_f32 v182, v182, v9
    v_mul_f32 v183, v183, v9
    v_cvt_pk_bf16_f32 v32, v180, v181
    v_cvt_pk_bf16_f32 v33, v182, v183
    v_mul_f32 v188, v188, v9
    v_mul_f32 v189, v189, v9
    v_mul_f32 v190, v190, v9
    v_mul_f32 v191, v191, v9
    v_cvt_pk_bf16_f32 v34, v188, v189
    v_cvt_pk_bf16_f32 v35, v190, v191
    s_add_u32 s64, s32, 0x20000
    buffer_store_dwordx4 v[32:35], v1, s[4:7], s64 offen offset:0 sc1
    v_mul_f32 v196, v196, v9
    v_mul_f32 v197, v197, v9
    v_mul_f32 v198, v198, v9
    v_mul_f32 v199, v199, v9
    v_cvt_pk_bf16_f32 v36, v196, v197
    v_cvt_pk_bf16_f32 v37, v198, v199
    v_mul_f32 v204, v204, v9
    v_mul_f32 v205, v205, v9
    v_mul_f32 v206, v206, v9
    v_mul_f32 v207, v207, v9
    v_cvt_pk_bf16_f32 v38, v204, v205
    v_cvt_pk_bf16_f32 v39, v206, v207
    s_add_u32 s64, s32, 0x20000
    buffer_store_dwordx4 v[36:39], v1, s[4:7], s64 offen offset:1024 sc1
    v_mul_f32 v212, v212, v9
    v_mul_f32 v213, v213, v9
    v_mul_f32 v214, v214, v9
    v_mul_f32 v215, v215, v9
    v_cvt_pk_bf16_f32 v40, v212, v213
    v_cvt_pk_bf16_f32 v41, v214, v215
    v_mul_f32 v220, v220, v9
    v_mul_f32 v221, v221, v9
    v_mul_f32 v222, v222, v9
    v_mul_f32 v223, v223, v9
    v_cvt_pk_bf16_f32 v42, v220, v221
    v_cvt_pk_bf16_f32 v43, v222, v223
    s_add_u32 s64, s32, 0x20000
    buffer_store_dwordx4 v[40:43], v1, s[4:7], s64 offen offset:2048 sc1
    v_mul_f32 v228, v228, v9
    v_mul_f32 v229, v229, v9
    v_mul_f32 v230, v230, v9
    v_mul_f32 v231, v231, v9
    v_cvt_pk_bf16_f32 v44, v228, v229
    v_cvt_pk_bf16_f32 v45, v230, v231
    v_mul_f32 v236, v236, v9
    v_mul_f32 v237, v237, v9
    v_mul_f32 v238, v238, v9
    v_mul_f32 v239, v239, v9
    v_cvt_pk_bf16_f32 v46, v236, v237
    v_cvt_pk_bf16_f32 v47, v238, v239
    s_add_u32 s64, s32, 0x20000
    buffer_store_dwordx4 v[44:47], v1, s[4:7], s64 offen offset:3072 sc1
    s_waitcnt vmcnt(0)
    v_mov_b32 v7, 1
    v_mov_b32 v8, 0
    s_mov_b64 exec, 1
    buffer_store_dword v7, v8, s[4:7], s33 offen sc1
    s_mov_b64 exec, -1
    s_add_u32 s24, s24, 8
    s_add_u32 s25, s25, 1
    s_cmp_lt_u32 s25, 2
    s_cbranch_scc1 AT1_LOOP
AT1_END:
    s_lshl_b32 s70, s13, 1
    s_add_u32 s70, s70, s12
    s_load_dwordx2 s[44:45], s[0:1], 72
    s_mov_b32 s46, 0x21c000
    s_mov_b32 s47, 0x00020000
    s_load_dwordx2 s[48:49], s[0:1], 80
    s_mov_b32 s50, 0x21c000
    s_mov_b32 s51, 0x00020000
    s_load_dwordx2 s[52:53], s[0:1], 88
    s_mov_b32 s54, 0x21c000
    s_mov_b32 s55, 0x00020000
    s_mov_b32 s29, 0
    s_waitcnt lgkmcnt(0)
    v_mbcnt_lo_u32_b32 v0, -1, 0
    v_mbcnt_hi_u32_b32 v0, -1, v0
    s_cmp_lg_u32 s14, 0
    s_cbranch_scc1 H_ATT
    s_cmp_ge_u32 s70, 40
    s_cbranch_scc1 H_ATT
    s_mov_b32 s24, s70
    v_mov_b32 v8, 0
    s_mov_b32 s64, 0x298080
F2W_190:
    buffer_load_dword v7, v8, s[4:7], s64 offen sc1
    s_add_u32 s29, s29, 1
    s_waitcnt vmcnt(0)
    v_mov_b32 v9, 108
    v_cmp_gt_u32 vcc, v9, v7
    s_cbranch_vccz F2WD_191
    s_cmp_gt_u32 s29, 262144
    s_cbranch_scc1 F2WD_191
    s_sleep 8
    s_branch F2W_190
F2WD_191:
    s_mov_b32 s25, 0
    v_lshrrev_b32 v7, 1, v0
    v_mul_u32_u24 v2, 1280, v7
    v_and_b32 v7, 1, v0
    v_lshl_add_u32 v2, v7, 4, v2
    v_lshrrev_b32 v7, 4, v0
    v_lshlrev_b32 v3, 7, v7
    v_bfe_u32 v7, v0, 2, 2
    v_lshl_add_u32 v3, v7, 5, v3
    v_and_b32 v7, 3, v0
    v_lshl_add_u32 v3, v7, 3, v3
    v_add_u32 v3, s25, v3
    v_lshlrev_b32 v4, 4, v0
    s_mov_b32 s65, 0x5401000
    buffer_load_dwordx4 v[16:19], v4, s[4:7], s65 offen offset:0 sc1
    buffer_load_dwordx4 v[20:23], v4, s[4:7], s65 offen offset:1024 sc1
    buffer_load_dwordx4 v[24:27], v4, s[4:7], s65 offen offset:2048 sc1
    buffer_load_dwordx4 v[28:31], v4, s[4:7], s65 offen offset:3072 sc1
    s_add_u32 s65, s65, 4096
    buffer_load_dwordx4 v[32:35], v4, s[4:7], s65 offen offset:0 sc1
    buffer_load_dwordx4 v[36:39], v4, s[4:7], s65 offen offset:1024 sc1
    buffer_load_dwordx4 v[40:43], v4, s[4:7], s65 offen offset:2048 sc1
    buffer_load_dwordx4 v[44:47], v4, s[4:7], s65 offen offset:3072 sc1
    s_add_u32 s65, s65, 4096
    buffer_load_dwordx4 v[48:51], v4, s[4:7], s65 offen offset:0 sc1
    buffer_load_dwordx4 v[52:55], v4, s[4:7], s65 offen offset:1024 sc1
    buffer_load_dwordx4 v[56:59], v4, s[4:7], s65 offen offset:2048 sc1
    buffer_load_dwordx4 v[60:63], v4, s[4:7], s65 offen offset:3072 sc1
    s_add_u32 s65, s65, 4096
    buffer_load_dwordx4 v[64:67], v4, s[4:7], s65 offen offset:0 sc1
    buffer_load_dwordx4 v[68:71], v4, s[4:7], s65 offen offset:1024 sc1
    buffer_load_dwordx4 v[72:75], v4, s[4:7], s65 offen offset:2048 sc1
    buffer_load_dwordx4 v[76:79], v4, s[4:7], s65 offen offset:3072 sc1
    s_add_u32 s65, s65, 4096
    buffer_load_dwordx4 v[80:83], v4, s[4:7], s65 offen offset:0 sc1
    buffer_load_dwordx4 v[84:87], v4, s[4:7], s65 offen offset:1024 sc1
    buffer_load_dwordx4 v[88:91], v4, s[4:7], s65 offen offset:2048 sc1
    buffer_load_dwordx4 v[92:95], v4, s[4:7], s65 offen offset:3072 sc1
    s_add_u32 s65, s65, 4096
    buffer_load_dwordx4 v[96:99], v4, s[4:7], s65 offen offset:0 sc1
    buffer_load_dwordx4 v[100:103], v4, s[4:7], s65 offen offset:1024 sc1
    buffer_load_dwordx4 v[104:107], v4, s[4:7], s65 offen offset:2048 sc1
    buffer_load_dwordx4 v[108:111], v4, s[4:7], s65 offen offset:3072 sc1
    s_add_u32 s65, s65, 4096
    buffer_load_dwordx4 v[112:115], v4, s[4:7], s65 offen offset:0 sc1
    buffer_load_dwordx4 v[116:119], v4, s[4:7], s65 offen offset:1024 sc1
    buffer_load_dwordx4 v[120:123], v4, s[4:7], s65 offen offset:2048 sc1
    buffer_load_dwordx4 v[124:127], v4, s[4:7], s65 offen offset:3072 sc1
    s_add_u32 s65, s65, 4096
    buffer_load_dwordx4 v[128:131], v4, s[4:7], s65 offen offset:0 sc1
    buffer_load_dwordx4 v[132:135], v4, s[4:7], s65 offen offset:1024 sc1
    buffer_load_dwordx4 v[136:139], v4, s[4:7], s65 offen offset:2048 sc1
    buffer_load_dwordx4 v[140:143], v4, s[4:7], s65 offen offset:3072 sc1
    s_add_u32 s65, s65, 4096
    buffer_load_dwordx4 v[144:147], v4, s[4:7], s65 offen offset:0 sc1
    buffer_load_dwordx4 v[148:151], v4, s[4:7], s65 offen offset:1024 sc1
    buffer_load_dwordx4 v[152:155], v4, s[4:7], s65 offen offset:2048 sc1
    buffer_load_dwordx4 v[156:159], v4, s[4:7], s65 offen offset:3072 sc1
    s_add_u32 s65, s65, 4096
    buffer_load_dwordx4 v[160:163], v4, s[4:7], s65 offen offset:0 sc1
    buffer_load_dwordx4 v[164:167], v4, s[4:7], s65 offen offset:1024 sc1
    buffer_load_dwordx4 v[168:171], v4, s[4:7], s65 offen offset:2048 sc1
    buffer_load_dwordx4 v[172:175], v4, s[4:7], s65 offen offset:3072 sc1
    s_add_u32 s65, s65, 4096
    buffer_load_dwordx4 v[176:179], v4, s[4:7], s65 offen offset:0 sc1
    s_waitcnt vmcnt(20)
    buffer_load_dwordx4 v[180:183], v4, s[4:7], s65 offen offset:1024 sc1
    buffer_load_dwordx4 v[184:187], v4, s[4:7], s65 offen offset:2048 sc1
    buffer_load_dwordx4 v[188:191], v4, s[4:7], s65 offen offset:3072 sc1
    s_add_u32 s65, s65, 4096
    buffer_load_dwordx4 v[192:195], v4, s[4:7], s65 offen offset:0 sc1
    buffer_load_dwordx4 v[196:199], v4, s[4:7], s65 offen offset:1024 sc1
    buffer_load_dwordx4 v[200:203], v4, s[4:7], s65 offen offset:2048 sc1
    buffer_load_dwordx4 v[204:207], v4, s[4:7], s65 offen offset:3072 sc1
    s_add_u32 s65, s65, 4096
    buffer_load_dwordx4 v[208:211], v4, s[4:7], s65 offen offset:0 sc1
    buffer_load_dwordx4 v[212:215], v4, s[4:7], s65 offen offset:1024 sc1
    buffer_load_dwordx4 v[216:219], v4, s[4:7], s65 offen offset:2048 sc1
    buffer_load_dwordx4 v[220:223], v4, s[4:7], s65 offen offset:3072 sc1
    s_add_u32 s65, s65, 4096
    buffer_load_dwordx4 v[224:227], v4, s[4:7], s65 offen offset:0 sc1
    buffer_load_dwordx4 v[228:231], v4, s[4:7], s65 offen offset:1024 sc1
    s_waitcnt vmcnt(0)
    s_lshl_b32 s26, s24, 5
    s_add_u32 m0, s25, 0
    s_add_u32 s64, s26, 0x0
    buffer_load_dwordx4 v2, s[52:55], s64 offen lds
    s_add_u32 m0, s25, 1024
    s_add_u32 s64, s26, 0xa000
    buffer_load_dwordx4 v2, s[52:55], s64 offen lds
    s_add_u32 m0, s25, 2048
    s_add_u32 s64, s26, 0x14000
    buffer_load_dwordx4 v2, s[52:55], s64 offen lds
    s_add_u32 m0, s25, 3072
    s_add_u32 s64, s26, 0x1e000
    buffer_load_dwordx4 v2, s[52:55], s64 offen lds
    s_add_u32 m0, s25, 4096
    s_add_u32 s64, s26, 0x28000
    buffer_load_dwordx4 v2, s[52:55], s64 offen lds
    s_add_u32 m0, s25, 5120
    s_add_u32 s64, s26, 0x32000
    buffer_load_dwordx4 v2, s[52:55], s64 offen lds
    s_add_u32 m0, s25, 6144
    s_add_u32 s64, s26, 0x3c000
    buffer_load_dwordx4 v2, s[52:55], s64 offen lds
    s_add_u32 m0, s25, 7168
    s_add_u32 s64, s26, 0x46000
    buffer_load_dwordx4 v2, s[52:55], s64 offen lds
    s_add_u32 m0, s25, 8192
    s_add_u32 s64, s26, 0x50000
    buffer_load_dwordx4 v2, s[52:55], s64 offen lds
    s_add_u32 m0, s25, 9216
    s_add_u32 s64, s26, 0x5a000
    buffer_load_dwordx4 v2, s[52:55], s64 offen lds
    s_add_u32 m0, s25, 10240
    s_add_u32 s64, s26, 0x64000
    buffer_load_dwordx4 v2, s[52:55], s64 offen lds
    s_add_u32 m0, s25, 11264
    s_add_u32 s64, s26, 0x6e000
    buffer_load_dwordx4 v2, s[52:55], s64 offen lds
    s_add_u32 m0, s25, 12288
    s_add_u32 s64, s26, 0x78000
    buffer_load_dwordx4 v2, s[52:55], s64 offen lds
    s_add_u32 m0, s25, 13312
    s_add_u32 s64, s26, 0x82000
    buffer_load_dwordx4 v2, s[52:55], s64 offen lds
    s_add_u32 m0, s25, 14336
    s_add_u32 s64, s26, 0x8c000
    buffer_load_dwordx4 v2, s[52:55], s64 offen lds
    s_add_u32 m0, s25, 15360
    s_add_u32 s64, s26, 0x96000
    buffer_load_dwordx4 v2, s[52:55], s64 offen lds
    s_add_u32 m0, s25, 16384
    s_add_u32 s64, s26, 0xa0000
    buffer_load_dwordx4 v2, s[52:55], s64 offen lds
    s_add_u32 m0, s25, 17408
    s_add_u32 s64, s26, 0xaa000
    buffer_load_dwordx4 v2, s[52:55], s64 offen lds
    s_add_u32 m0, s25, 18432
    s_add_u32 s64, s26, 0xb4000
    buffer_load_dwordx4 v2, s[52:55], s64 offen lds
    s_add_u32 m0, s25, 19456
    s_add_u32 s64, s26, 0xbe000
    buffer_load_dwordx4 v2, s[52:55], s64 offen lds
    s_add_u32 m0, s25, 20480
    s_add_u32 s64, s26, 0xc8000
    buffer_load_dwordx4 v2, s[52:55], s64 offen lds
    s_add_u32 m0, s25, 21504
    s_add_u32 s64, s26, 0xd2000
    buffer_load_dwordx4 v2, s[52:55], s64 offen lds
    s_add_u32 m0, s25, 22528
    s_add_u32 s64, s26, 0xdc000
    buffer_load_dwordx4 v2, s[52:55], s64 offen lds
    s_add_u32 m0, s25, 23552
    s_add_u32 s64, s26, 0xe6000
    buffer_load_dwordx4 v2, s[52:55], s64 offen lds
    s_add_u32 m0, s25, 24576
    s_add_u32 s64, s26, 0xf0000
    buffer_load_dwordx4 v2, s[52:55], s64 offen lds
    s_add_u32 m0, s25, 25600
    s_add_u32 s64, s26, 0xfa000
    buffer_load_dwordx4 v2, s[52:55], s64 offen lds
    s_add_u32 m0, s25, 26624
    s_add_u32 s64, s26, 0x104000
    buffer_load_dwordx4 v2, s[52:55], s64 offen lds
    s_add_u32 m0, s25, 27648
    s_add_u32 s64, s26, 0x10e000
    buffer_load_dwordx4 v2, s[52:55], s64 offen lds
    s_add_u32 m0, s25, 28672
    s_add_u32 s64, s26, 0x118000
    buffer_load_dwordx4 v2, s[52:55], s64 offen lds
    s_add_u32 m0, s25, 29696
    s_add_u32 s64, s26, 0x122000
    buffer_load_dwordx4 v2, s[52:55], s64 offen lds
    s_add_u32 m0, s25, 30720
    s_add_u32 s64, s26, 0x12c000
    buffer_load_dwordx4 v2, s[52:55], s64 offen lds
    s_add_u32 m0, s25, 31744
    s_add_u32 s64, s26, 0x136000
    buffer_load_dwordx4 v2, s[52:55], s64 offen lds
    s_add_u32 m0, s25, 32768
    s_add_u32 s64, s26, 0x140000
    buffer_load_dwordx4 v2, s[52:55], s64 offen lds
    s_add_u32 m0, s25, 33792
    s_add_u32 s64, s26, 0x14a000
    buffer_load_dwordx4 v2, s[52:55], s64 offen lds
    s_add_u32 m0, s25, 34816
    s_add_u32 s64, s26, 0x154000
    buffer_load_dwordx4 v2, s[52:55], s64 offen lds
    s_add_u32 m0, s25, 35840
    s_add_u32 s64, s26, 0x15e000
    buffer_load_dwordx4 v2, s[52:55], s64 offen lds
    s_add_u32 m0, s25, 36864
    s_add_u32 s64, s26, 0x168000
    buffer_load_dwordx4 v2, s[52:55], s64 offen lds
    s_add_u32 m0, s25, 37888
    s_add_u32 s64, s26, 0x172000
    buffer_load_dwordx4 v2, s[52:55], s64 offen lds
    s_add_u32 m0, s25, 38912
    s_add_u32 s64, s26, 0x17c000
    buffer_load_dwordx4 v2, s[52:55], s64 offen lds
    s_add_u32 m0, s25, 39936
    s_add_u32 s64, s26, 0x186000
    buffer_load_dwordx4 v2, s[52:55], s64 offen lds
    s_add_u32 m0, s25, 40960
    s_add_u32 s64, s26, 0x190000
    buffer_load_dwordx4 v2, s[52:55], s64 offen lds
    s_waitcnt vmcnt(20)
    s_add_u32 m0, s25, 41984
    s_add_u32 s64, s26, 0x19a000
    buffer_load_dwordx4 v2, s[52:55], s64 offen lds
    s_add_u32 m0, s25, 43008
    s_add_u32 s64, s26, 0x1a4000
    buffer_load_dwordx4 v2, s[52:55], s64 offen lds
    s_add_u32 m0, s25, 44032
    s_add_u32 s64, s26, 0x1ae000
    buffer_load_dwordx4 v2, s[52:55], s64 offen lds
    s_add_u32 m0, s25, 45056
    s_add_u32 s64, s26, 0x1b8000
    buffer_load_dwordx4 v2, s[52:55], s64 offen lds
    s_add_u32 m0, s25, 46080
    s_add_u32 s64, s26, 0x1c2000
    buffer_load_dwordx4 v2, s[52:55], s64 offen lds
    s_add_u32 m0, s25, 47104
    s_add_u32 s64, s26, 0x1cc000
    buffer_load_dwordx4 v2, s[52:55], s64 offen lds
    s_add_u32 m0, s25, 48128
    s_add_u32 s64, s26, 0x1d6000
    buffer_load_dwordx4 v2, s[52:55], s64 offen lds
    s_add_u32 m0, s25, 49152
    s_add_u32 s64, s26, 0x1e0000
    buffer_load_dwordx4 v2, s[52:55], s64 offen lds
    s_add_u32 m0, s25, 50176
    s_add_u32 s64, s26, 0x1ea000
    buffer_load_dwordx4 v2, s[52:55], s64 offen lds
    s_add_u32 m0, s25, 51200
    s_add_u32 s64, s26, 0x1f4000
    buffer_load_dwordx4 v2, s[52:55], s64 offen lds
    s_add_u32 m0, s25, 52224
    s_add_u32 s64, s26, 0x1fe000
    buffer_load_dwordx4 v2, s[52:55], s64 offen lds
    s_add_u32 m0, s25, 53248
    s_add_u32 s64, s26, 0x208000
    buffer_load_dwordx4 v2, s[52:55], s64 offen lds
    s_add_u32 m0, s25, 54272
    s_add_u32 s64, s26, 0x212000
    buffer_load_dwordx4 v2, s[52:55], s64 offen lds
    s_waitcnt vmcnt(0)
    ds_read_b64_tr_b16 v[232:233], v3 offset:0
    ds_read_b64_tr_b16 v[234:235], v3 offset:512
    s_waitcnt lgkmcnt(0)
    v_mfma_f32_16x16x32_bf16 v[8:11], v[232:235], v[16:19], 0
    ds_read_b64_tr_b16 v[236:237], v3 offset:1024
    ds_read_b64_tr_b16 v[238:239], v3 offset:1536
    s_waitcnt lgkmcnt(0)
    v_mfma_f32_16x16x32_bf16 v[8:11], v[236:239], v[20:23], v[8:11]
    ds_read_b64_tr_b16 v[240:241], v3 offset:2048
    ds_read_b64_tr_b16 v[242:243], v3 offset:2560
    s_waitcnt lgkmcnt(0)
    v_mfma_f32_16x16x32_bf16 v[8:11], v[240:243], v[24:27], v[8:11]
    ds_read_b64_tr_b16 v[244:245], v3 offset:3072
    ds_read_b64_tr_b16 v[246:247], v3 offset:3584
    s_waitcnt lgkmcnt(0)
    v_mfma_f32_16x16x32_bf16 v[8:11], v[244:247], v[28:31], v[8:11]
    ds_read_b64_tr_b16 v[232:233], v3 offset:4096
    ds_read_b64_tr_b16 v[234:235], v3 offset:4608
    s_waitcnt lgkmcnt(0)
    v_mfma_f32_16x16x32_bf16 v[8:11], v[232:235], v[32:35], v[8:11]
    ds_read_b64_tr_b16 v[236:237], v3 offset:5120
    ds_read_b64_tr_b16 v[238:239], v3 offset:5632
    s_waitcnt lgkmcnt(0)
    v_mfma_f32_16x16x32_bf16 v[8:11], v[236:239], v[36:39], v[8:11]
    ds_read_b64_tr_b16 v[240:241], v3 offset:6144
    ds_read_b64_tr_b16 v[242:243], v3 offset:6656
    s_waitcnt lgkmcnt(0)
    v_mfma_f32_16x16x32_bf16 v[8:11], v[240:243], v[40:43], v[8:11]
    ds_read_b64_tr_b16 v[244:245], v3 offset:7168
    ds_read_b64_tr_b16 v[246:247], v3 offset:7680
    s_waitcnt lgkmcnt(0)
    v_mfma_f32_16x16x32_bf16 v[8:11], v[244:247], v[44:47], v[8:11]
    ds_read_b64_tr_b16 v[232:233], v3 offset:8192
    ds_read_b64_tr_b16 v[234:235], v3 offset:8704
    s_waitcnt lgkmcnt(0)
    v_mfma_f32_16x16x32_bf16 v[8:11], v[232:235], v[48:51], v[8:11]
    ds_read_b64_tr_b16 v[236:237], v3 offset:9216
    ds_read_b64_tr_b16 v[238:239], v3 offset:9728
    s_waitcnt lgkmcnt(0)
    v_mfma_f32_16x16x32_bf16 v[8:11], v[236:239], v[52:55], v[8:11]
    ds_read_b64_tr_b16 v[240:241], v3 offset:10240
    ds_read_b64_tr_b16 v[242:243], v3 offset:10752
    s_waitcnt lgkmcnt(0)
    v_mfma_f32_16x16x32_bf16 v[8:11], v[240:243], v[56:59], v[8:11]
    ds_read_b64_tr_b16 v[244:245], v3 offset:11264
    ds_read_b64_tr_b16 v[246:247], v3 offset:11776
    s_waitcnt lgkmcnt(0)
    v_mfma_f32_16x16x32_bf16 v[8:11], v[244:247], v[60:63], v[8:11]
    ds_read_b64_tr_b16 v[232:233], v3 offset:12288
    ds_read_b64_tr_b16 v[234:235], v3 offset:12800
    s_waitcnt lgkmcnt(0)
    v_mfma_f32_16x16x32_bf16 v[8:11], v[232:235], v[64:67], v[8:11]
    ds_read_b64_tr_b16 v[236:237], v3 offset:13312
    ds_read_b64_tr_b16 v[238:239], v3 offset:13824
    s_waitcnt lgkmcnt(0)
    v_mfma_f32_16x16x32_bf16 v[8:11], v[236:239], v[68:71], v[8:11]
    ds_read_b64_tr_b16 v[240:241], v3 offset:14336
    ds_read_b64_tr_b16 v[242:243], v3 offset:14848
    s_waitcnt lgkmcnt(0)
    v_mfma_f32_16x16x32_bf16 v[8:11], v[240:243], v[72:75], v[8:11]
    ds_read_b64_tr_b16 v[244:245], v3 offset:15360
    ds_read_b64_tr_b16 v[246:247], v3 offset:15872
    s_waitcnt lgkmcnt(0)
    v_mfma_f32_16x16x32_bf16 v[8:11], v[244:247], v[76:79], v[8:11]
    ds_read_b64_tr_b16 v[232:233], v3 offset:16384
    ds_read_b64_tr_b16 v[234:235], v3 offset:16896
    s_waitcnt lgkmcnt(0)
    v_mfma_f32_16x16x32_bf16 v[8:11], v[232:235], v[80:83], v[8:11]
    ds_read_b64_tr_b16 v[236:237], v3 offset:17408
    ds_read_b64_tr_b16 v[238:239], v3 offset:17920
    s_waitcnt lgkmcnt(0)
    v_mfma_f32_16x16x32_bf16 v[8:11], v[236:239], v[84:87], v[8:11]
    ds_read_b64_tr_b16 v[240:241], v3 offset:18432
    ds_read_b64_tr_b16 v[242:243], v3 offset:18944
    s_waitcnt lgkmcnt(0)
    v_mfma_f32_16x16x32_bf16 v[8:11], v[240:243], v[88:91], v[8:11]
    ds_read_b64_tr_b16 v[244:245], v3 offset:19456
    ds_read_b64_tr_b16 v[246:247], v3 offset:19968
    s_waitcnt lgkmcnt(0)
    v_mfma_f32_16x16x32_bf16 v[8:11], v[244:247], v[92:95], v[8:11]
    ds_read_b64_tr_b16 v[232:233], v3 offset:20480
    ds_read_b64_tr_b16 v[234:235], v3 offset:20992
    s_waitcnt lgkmcnt(0)
    v_mfma_f32_16x16x32_bf16 v[8:11], v[232:235], v[96:99], v[8:11]
    ds_read_b64_tr_b16 v[236:237], v3 offset:21504
    ds_read_b64_tr_b16 v[238:239], v3 offset:22016
    s_waitcnt lgkmcnt(0)
    v_mfma_f32_16x16x32_bf16 v[8:11], v[236:239], v[100:103], v[8:11]
    ds_read_b64_tr_b16 v[240:241], v3 offset:22528
    ds_read_b64_tr_b16 v[242:243], v3 offset:23040
    s_waitcnt lgkmcnt(0)
    v_mfma_f32_16x16x32_bf16 v[8:11], v[240:243], v[104:107], v[8:11]
    ds_read_b64_tr_b16 v[244:245], v3 offset:23552
    ds_read_b64_tr_b16 v[246:247], v3 offset:24064
    s_waitcnt lgkmcnt(0)
    v_mfma_f32_16x16x32_bf16 v[8:11], v[244:247], v[108:111], v[8:11]
    ds_read_b64_tr_b16 v[232:233], v3 offset:24576
    ds_read_b64_tr_b16 v[234:235], v3 offset:25088
    s_waitcnt lgkmcnt(0)
    v_mfma_f32_16x16x32_bf16 v[8:11], v[232:235], v[112:115], v[8:11]
    ds_read_b64_tr_b16 v[236:237], v3 offset:25600
    ds_read_b64_tr_b16 v[238:239], v3 offset:26112
    s_waitcnt lgkmcnt(0)
    v_mfma_f32_16x16x32_bf16 v[8:11], v[236:239], v[116:119], v[8:11]
    ds_read_b64_tr_b16 v[240:241], v3 offset:26624
    ds_read_b64_tr_b16 v[242:243], v3 offset:27136
    s_waitcnt lgkmcnt(0)
    v_mfma_f32_16x16x32_bf16 v[8:11], v[240:243], v[120:123], v[8:11]
    ds_read_b64_tr_b16 v[244:245], v3 offset:27648
    ds_read_b64_tr_b16 v[246:247], v3 offset:28160
    s_waitcnt lgkmcnt(0)
    v_mfma_f32_16x16x32_bf16 v[8:11], v[244:247], v[124:127], v[8:11]
    ds_read_b64_tr_b16 v[232:233], v3 offset:28672
    ds_read_b64_tr_b16 v[234:235], v3 offset:29184
    s_waitcnt lgkmcnt(0)
    v_mfma_f32_16x16x32_bf16 v[8:11], v[232:235], v[128:131], v[8:11]
    ds_read_b64_tr_b16 v[236:237], v3 offset:29696
    ds_read_b64_tr_b16 v[238:239], v3 offset:30208
    s_waitcnt lgkmcnt(0)
    v_mfma_f32_16x16x32_bf16 v[8:11], v[236:239], v[132:135], v[8:11]
    ds_read_b64_tr_b16 v[240:241], v3 offset:30720
    ds_read_b64_tr_b16 v[242:243], v3 offset:31232
    s_waitcnt lgkmcnt(0)
    v_mfma_f32_16x16x32_bf16 v[8:11], v[240:243], v[136:139], v[8:11]
    ds_read_b64_tr_b16 v[244:245], v3 offset:31744
    ds_read_b64_tr_b16 v[246:247], v3 offset:32256
    s_waitcnt lgkmcnt(0)
    v_mfma_f32_16x16x32_bf16 v[8:11], v[244:247], v[140:143], v[8:11]
    ds_read_b64_tr_b16 v[232:233], v3 offset:32768
    ds_read_b64_tr_b16 v[234:235], v3 offset:33280
    s_waitcnt lgkmcnt(0)
    v_mfma_f32_16x16x32_bf16 v[8:11], v[232:235], v[144:147], v[8:11]
    ds_read_b64_tr_b16 v[236:237], v3 offset:33792
    ds_read_b64_tr_b16 v[238:239], v3 offset:34304
    s_waitcnt lgkmcnt(0)
    v_mfma_f32_16x16x32_bf16 v[8:11], v[236:239], v[148:151], v[8:11]
    ds_read_b64_tr_b16 v[240:241], v3 offset:34816
    ds_read_b64_tr_b16 v[242:243], v3 offset:35328
    s_waitcnt lgkmcnt(0)
    v_mfma_f32_16x16x32_bf16 v[8:11], v[240:243], v[152:155], v[8:11]
    ds_read_b64_tr_b16 v[244:245], v3 offset:35840
    ds_read_b64_tr_b16 v[246:247], v3 offset:36352
    s_waitcnt lgkmcnt(0)
    v_mfma_f32_16x16x32_bf16 v[8:11], v[244:247], v[156:159], v[8:11]
    ds_read_b64_tr_b16 v[232:233], v3 offset:36864
    ds_read_b64_tr_b16 v[234:235], v3 offset:37376
    s_waitcnt lgkmcnt(0)
    v_mfma_f32_16x16x32_bf16 v[8:11], v[232:235], v[160:163], v[8:11]
    ds_read_b64_tr_b16 v[236:237], v3 offset:37888
    ds_read_b64_tr_b16 v[238:239], v3 offset:38400
    s_waitcnt lgkmcnt(0)
    v_mfma_f32_16x16x32_bf16 v[8:11], v[236:239], v[164:167], v[8:11]
    ds_read_b64_tr_b16 v[240:241], v3 offset:38912
    ds_read_b64_tr_b16 v[242:243], v3 offset:39424
    s_waitcnt lgkmcnt(0)
    v_mfma_f32_16x16x32_bf16 v[8:11], v[240:243], v[168:171], v[8:11]
    ds_read_b64_tr_b16 v[244:245], v3 offset:39936
    ds_read_b64_tr_b16 v[246:247], v3 offset:40448
    s_waitcnt lgkmcnt(0)
    v_mfma_f32_16x16x32_bf16 v[8:11], v[244:247], v[172:175], v[8:11]
    ds_read_b64_tr_b16 v[232:233], v3 offset:40960
    ds_read_b64_tr_b16 v[234:235], v3 offset:41472
    s_waitcnt lgkmcnt(0)
    v_mfma_f32_16x16x32_bf16 v[8:11], v[232:235], v[176:179], v[8:11]
    ds_read_b64_tr_b16 v[236:237], v3 offset:41984
    ds_read_b64_tr_b16 v[238:239], v3 offset:42496
    s_waitcnt lgkmcnt(0)
    v_mfma_f32_16x16x32_bf16 v[8:11], v[236:239], v[180:183], v[8:11]
    ds_read_b64_tr_b16 v[240:241], v3 offset:43008
    ds_read_b64_tr_b16 v[242:243], v3 offset:43520
    s_waitcnt lgkmcnt(0)
    v_mfma_f32_16x16x32_bf16 v[8:11], v[240:243], v[184:187], v[8:11]
    ds_read_b64_tr_b16 v[244:245], v3 offset:44032
    ds_read_b64_tr_b16 v[246:247], v3 offset:44544
    s_waitcnt lgkmcnt(0)
    v_mfma_f32_16x16x32_bf16 v[8:11], v[244:247], v[188:191], v[8:11]
    ds_read_b64_tr_b16 v[232:233], v3 offset:45056
    ds_read_b64_tr_b16 v[234:235], v3 offset:45568
    s_waitcnt lgkmcnt(0)
    v_mfma_f32_16x16x32_bf16 v[8:11], v[232:235], v[192:195], v[8:11]
    ds_read_b64_tr_b16 v[236:237], v3 offset:46080
    ds_read_b64_tr_b16 v[238:239], v3 offset:46592
    s_waitcnt lgkmcnt(0)
    v_mfma_f32_16x16x32_bf16 v[8:11], v[236:239], v[196:199], v[8:11]
    ds_read_b64_tr_b16 v[240:241], v3 offset:47104
    ds_read_b64_tr_b16 v[242:243], v3 offset:47616
    s_waitcnt lgkmcnt(0)
    v_mfma_f32_16x16x32_bf16 v[8:11], v[240:243], v[200:203], v[8:11]
    ds_read_b64_tr_b16 v[244:245], v3 offset:48128
    ds_read_b64_tr_b16 v[246:247], v3 offset:48640
    s_waitcnt lgkmcnt(0)
    v_mfma_f32_16x16x32_bf16 v[8:11], v[244:247], v[204:207], v[8:11]
    ds_read_b64_tr_b16 v[232:233], v3 offset:49152
    ds_read_b64_tr_b16 v[234:235], v3 offset:49664
    s_waitcnt lgkmcnt(0)
    v_mfma_f32_16x16x32_bf16 v[8:11], v[232:235], v[208:211], v[8:11]
    ds_read_b64_tr_b16 v[236:237], v3 offset:50176
    ds_read_b64_tr_b16 v[238:239], v3 offset:50688
    s_waitcnt lgkmcnt(0)
    v_mfma_f32_16x16x32_bf16 v[8:11], v[236:239], v[212:215], v[8:11]
    ds_read_b64_tr_b16 v[240:241], v3 offset:51200
    ds_read_b64_tr_b16 v[242:243], v3 offset:51712
    s_waitcnt lgkmcnt(0)
    v_mfma_f32_16x16x32_bf16 v[8:11], v[240:243], v[216:219], v[8:11]
    ds_read_b64_tr_b16 v[244:245], v3 offset:52224
    ds_read_b64_tr_b16 v[246:247], v3 offset:52736
    s_waitcnt lgkmcnt(0)
    v_mfma_f32_16x16x32_bf16 v[8:11], v[244:247], v[220:223], v[8:11]
    ds_read_b64_tr_b16 v[232:233], v3 offset:53248
    ds_read_b64_tr_b16 v[234:235], v3 offset:53760
    s_waitcnt lgkmcnt(0)
    v_mfma_f32_16x16x32_bf16 v[8:11], v[232:235], v[224:227], v[8:11]
    ds_read_b64_tr_b16 v[236:237], v3 offset:54272
    ds_read_b64_tr_b16 v[238:239], v3 offset:54784
    s_waitcnt lgkmcnt(0)
    v_mfma_f32_16x16x32_bf16 v[8:11], v[236:239], v[228:231], v[8:11]
    v_and_b32 v7, 7, v0
    v_lshlrev_b32 v7, 2, v7
    s_mov_b32 s64, 0x5400020
    buffer_load_dword v12, v7, s[4:7], s64 offen sc1
    s_waitcnt vmcnt(0)
    s_nop 7
    v_cvt_pk_bf16_f32 v8, v8, v8
    v_lshlrev_b32 v8, 16, v8
    v_mul_f32 v8, v8, v12
    v_cvt_pk_bf16_f32 v8, v8, v8
    v_lshlrev_b32 v8, 16, v8
    v_cvt_pk_bf16_f32 v9, v9, v9
    v_lshlrev_b32 v9, 16, v9
    v_mul_f32 v9, v9, v12
    v_cvt_pk_bf16_f32 v9, v9, v9
    v_lshlrev_b32 v9, 16, v9
    v_cvt_pk_bf16_f32 v10, v10, v10
    v_lshlrev_b32 v10, 16, v10
    v_mul_f32 v10, v10, v12
    v_cvt_pk_bf16_f32 v10, v10, v10
    v_lshlrev_b32 v10, 16, v10
    v_cvt_pk_bf16_f32 v11, v11, v11
    v_lshlrev_b32 v11, 16, v11
    v_mul_f32 v11, v11, v12
    v_cvt_pk_bf16_f32 v11, v11, v11
    v_lshlrev_b32 v11, 16, v11
    v_and_b32 v7, 7, v0
    v_mul_u32_u24 v7, 2560, v7
    v_lshrrev_b32 v13, 4, v0
    v_lshl_add_u32 v7, v13, 4, v7
    s_lshl_b32 s64, s24, 6
    s_add_u32 s64, s64, 0x5410000
    s_mov_b32 s68, 0x00ff00ff
    s_mov_b32 s69, 0x00ff00ff
    s_mov_b64 exec, s[68:69]
    buffer_store_dwordx4 v[8:11], v7, s[4:7], s64 offen sc1
    s_mov_b64 exec, -1
    s_waitcnt vmcnt(0)
    v_mov_b32 v7, 1
    v_mov_b32 v8, 0
    s_mov_b32 s64, 0x298100
    s_mov_b64 exec, 1
    buffer_atomic_add v7, v8, s[4:7], s64 offen sc1
    s_mov_b64 exec, -1
H_ATT:
    v_mbcnt_lo_u32_b32 v0, -1, 0
    v_mbcnt_hi_u32_b32 v0, -1, v0
    s_mov_b32 s29, 0
    v_lshlrev_b32 v1, 4, v0
    v_lshrrev_b32 v5, 4, v0
    v_lshlrev_b32 v2, 7, v5
    v_and_b32 v5, 7, v0
    v_lshl_add_u32 v2, v5, 4, v2
    v_bfe_u32 v5, v0, 4, 1
    v_lshlrev_b32 v3, 7, v5
    v_and_b32 v5, 15, v0
    v_lshl_add_u32 v3, v5, 3, v3
    s_mov_b32 s34, 0x3e0293ee
    s_mov_b32 s35, 0x3e0293ee
    s_mov_b32 s36, -1
    s_mov_b32 s37, 0
    v_lshrrev_b32 v5, 4, v0
    v_lshlrev_b32 v5, 2, v5
    v_and_b32 v6, 15, v0
    v_add_u32 v7, 0, v5
    v_cmp_le_u32 s[38:39], v7, v6
    v_add_u32 v7, 1, v5
    v_cmp_le_u32 s[40:41], v7, v6
    v_add_u32 v7, 2, v5
    v_cmp_le_u32 s[42:43], v7, v6
    v_add_u32 v7, 3, v5
    v_cmp_le_u32 s[44:45], v7, v6
    v_mov_b32 v248, 0x3f803f80
    v_mov_b32 v249, 0x3f803f80
    v_mov_b32 v250, 0x3f803f80
    v_mov_b32 v251, 0x3f803f80
    s_lshl_b32 s24, s12, 2
    s_add_u32 s24, s24, s14
    s_add_u32 s24, s24, 16
    s_mov_b32 s25, 2
AT2_LOOP:
    s_cmp_eq_u32 s24, 63
    s_cbranch_scc1 AT2_END
    s_lshl_b32 s64, s24, 5
    s_add_u32 s64, s64, s13
    s_lshl_b32 s26, s64, 13
    s_add_u32 s26, s26, 0x3400000
    s_lshl_b32 s27, s64, 14
    s_add_u32 s27, s27, 0x1400000
    s_lshl_b32 s65, s64, 11
    s_add_u32 s30, s65, 0x640000
    s_add_u32 s31, s65, 0xa40000
    s_lshl_b32 s33, s64, 2
    s_add_u32 s33, s33, 0x296000
    s_lshl_b32 s32, s24, 18
    s_lshl_b32 s65, s13, 12
    s_add_u32 s32, s32, s65
    s_add_u32 s32, s32, 0x4400000
    s_lshr_b32 s65, s24, 2
    s_lshl_b32 s65, s65, 9
    s_lshl_b32 s66, s13, 4
    s_add_u32 s65, s65, s66
    s_add_u32 s65, s65, 0x291000
    s_lshr_b32 s66, s24, 1
    s_lshl_b32 s66, s66, 8
    s_lshl_b32 s64, s13, 3
    s_add_u32 s66, s66, s64
    s_add_u32 s66, s66, 0x293ff4
    v_lshlrev_b32 v5, 2, v0
    v_mov_b32 v6, s65
    v_mov_b32 v7, s66
    v_cmp_gt_u32 vcc, 3, v0
    s_nop 1
    v_cndmask_b32 v6, v7, v6, vcc
    v_add_u32 v4, v5, v6
    s_mov_b32 s64, 0
    s_mov_b64 exec, 7
AT2_F_192:
    buffer_load_dword v5, v4, s[4:7], s64 offen sc1
    s_add_u32 s29, s29, 1
    s_waitcnt vmcnt(0)
    v_cmp_eq_u32 vcc, 0, v5
    s_cbranch_vccz AT2_FD_193
    s_cmp_gt_u32 s29, 262144
    s_cbranch_scc1 AT2_FD_193
    s_sleep 1
    s_branch AT2_F_192
AT2_FD_193:
    s_mov_b64 exec, -1
    buffer_load_dwordx4 v[16:19], v1, s[4:7], s26 offen offset:0
    buffer_load_dwordx4 v[20:23], v1, s[4:7], s26 offen offset:1024
    buffer_load_dwordx4 v[24:27], v1, s[4:7], s26 offen offset:2048
    buffer_load_dwordx4 v[28:31], v1, s[4:7], s26 offen offset:3072
    s_add_u32 s26, s26, 4096
    buffer_load_dwordx4 v[32:35], v1, s[4:7], s26 offen offset:0
    buffer_load_dwordx4 v[36:39], v1, s[4:7], s26 offen offset:1024
    buffer_load_dwordx4 v[40:43], v1, s[4:7], s26 offen offset:2048
    buffer_load_dwordx4 v[44:47], v1, s[4:7], s26 offen offset:3072
    buffer_load_dwordx4 v[48:51], v1, s[4:7], s27 offen offset:0
    buffer_load_dwordx4 v[52:55], v1, s[4:7], s27 offen offset:1024
    buffer_load_dwordx4 v[56:59], v1, s[4:7], s27 offen offset:2048
    buffer_load_dwordx4 v[60:63], v1, s[4:7], s27 offen offset:3072
    s_add_u32 s27, s27, 4096
    buffer_load_dwordx4 v[64:67], v1, s[4:7], s27 offen offset:0
    buffer_load_dwordx4 v[68:71], v1, s[4:7], s27 offen offset:1024
    buffer_load_dwordx4 v[72:75], v1, s[4:7], s27 offen offset:2048
    buffer_load_dwordx4 v[76:79], v1, s[4:7], s27 offen offset:3072
    s_add_u32 s27, s27, 4096
    buffer_load_dwordx4 v[80:83], v1, s[4:7], s27 offen offset:0
    buffer_load_dwordx4 v[84:87], v1, s[4:7], s27 offen offset:1024
    buffer_load_dwordx4 v[88:91], v1, s[4:7], s27 offen offset:2048
    buffer_load_dwordx4 v[92:95], v1, s[4:7], s27 offen offset:3072
    s_add_u32 s27, s27, 4096
    buffer_load_dwordx4 v[96:99], v1, s[4:7], s27 offen offset:0
    buffer_load_dwordx4 v[100:103], v1, s[4:7], s27 offen offset:1024
    buffer_load_dwordx4 v[104:107], v1, s[4:7], s27 offen offset:2048
    buffer_load_dwordx4 v[108:111], v1, s[4:7], s27 offen offset:3072
    s_mov_b64 exec, 0x18
AT2_G_194:
    buffer_load_dword v5, v4, s[4:7], s64 offen sc1
    s_add_u32 s29, s29, 1
    s_waitcnt vmcnt(0)
    v_cmp_eq_u32 vcc, 0, v5
    s_cbranch_vccz AT2_GD_195
    s_cmp_gt_u32 s29, 262144
    s_cbranch_scc1 AT2_GD_195
    s_sleep 1
    s_branch AT2_G_194
AT2_GD_195:
    s_mov_b64 exec, -1
    buffer_load_dwordx4 v[112:115], v2, s[4:7], s30 offen offset:0
    buffer_load_dwordx4 v[116:119], v2, s[4:7], s30 offen offset:512
    buffer_load_dwordx4 v[120:123], v2, s[4:7], s30 offen offset:1024
    buffer_load_dwordx4 v[124:127], v2, s[4:7], s30 offen offset:1536
    buffer_load_dwordx2 v[128:129], v3, s[4:7], s31 offen offset:0
    buffer_load_dwordx2 v[130:131], v3, s[4:7], s31 offen offset:256
    buffer_load_dwordx2 v[132:133], v3, s[4:7], s31 offen offset:512
    buffer_load_dwordx2 v[134:135], v3, s[4:7], s31 offen offset:768
    buffer_load_dwordx2 v[136:137], v3, s[4:7], s31 offen offset:1024
    buffer_load_dwordx2 v[138:139], v3, s[4:7], s31 offen offset:1280
    buffer_load_dwordx2 v[140:141], v3, s[4:7], s31 offen offset:1536
    buffer_load_dwordx2 v[142:143], v3, s[4:7], s31 offen offset:1792
    v_mfma_f32_16x16x32_bf16 v[148:151], v[48:51], v[16:19], 0
    v_mfma_f32_16x16x32_bf16 v[156:159], v[48:51], v[32:35], 0
    v_mfma_f32_16x16x32_bf16 v[160:163], v[64:67], v[32:35], 0
    v_mfma_f32_16x16x32_bf16 v[148:151], v[52:55], v[20:23], v[148:151]
    v_mfma_f32_16x16x32_bf16 v[156:159], v[52:55], v[36:39], v[156:159]
    v_mfma_f32_16x16x32_bf16 v[160:163], v[68:71], v[36:39], v[160:163]
    v_mfma_f32_16x16x32_bf16 v[148:151], v[56:59], v[24:27], v[148:151]
    v_mfma_f32_16x16x32_bf16 v[156:159], v[56:59], v[40:43], v[156:159]
    v_mfma_f32_16x16x32_bf16 v[160:163], v[72:75], v[40:43], v[160:163]
    v_mfma_f32_16x16x32_bf16 v[148:151], v[60:63], v[28:31], v[148:151]
    v_mfma_f32_16x16x32_bf16 v[156:159], v[60:63], v[44:47], v[156:159]
    v_mfma_f32_16x16x32_bf16 v[160:163], v[76:79], v[44:47], v[160:163]
    s_waitcnt vmcnt(8)
    v_mfma_f32_16x16x32_bf16 v[144:147], v[112:115], v[16:19], 0
    v_mfma_f32_16x16x32_bf16 v[152:155], v[112:115], v[32:35], 0
    v_mfma_f32_16x16x32_bf16 v[144:147], v[116:119], v[20:23], v[144:147]
    v_mfma_f32_16x16x32_bf16 v[152:155], v[116:119], v[36:39], v[152:155]
    v_mfma_f32_16x16x32_bf16 v[144:147], v[120:123], v[24:27], v[144:147]
    v_mfma_f32_16x16x32_bf16 v[152:155], v[120:123], v[40:43], v[152:155]
    v_mfma_f32_16x16x32_bf16 v[144:147], v[124:127], v[28:31], v[144:147]
    v_mfma_f32_16x16x32_bf16 v[152:155], v[124:127], v[44:47], v[152:155]
    v_mov_b32 v11, 0xff800000
    s_nop 7
    v_cndmask_b32 v148, v11, v148, s[38:39]
    v_cndmask_b32 v160, v11, v160, s[38:39]
    v_cndmask_b32 v144, v11, v144, s[36:37]
    v_cndmask_b32 v152, v11, v152, s[36:37]
    v_cndmask_b32 v149, v11, v149, s[40:41]
    v_cndmask_b32 v161, v11, v161, s[40:41]
    v_cndmask_b32 v145, v11, v145, s[36:37]
    v_cndmask_b32 v153, v11, v153, s[36:37]
    v_cndmask_b32 v150, v11, v150, s[42:43]
    v_cndmask_b32 v162, v11, v162, s[42:43]
    v_cndmask_b32 v146, v11, v146, s[36:37]
    v_cndmask_b32 v154, v11, v154, s[36:37]
    v_cndmask_b32 v151, v11, v151, s[44:45]
    v_cndmask_b32 v163, v11, v163, s[44:45]
    v_cndmask_b32 v147, v11, v147, s[36:37]
    v_cndmask_b32 v155, v11, v155, s[36:37]
    v_max3_f32 v8, v144, v145, v146
    v_max3_f32 v8, v8, v147, v148
    v_max3_f32 v8, v8, v149, v150
    v_max_f32 v8, v8, v151
    v_mov_b32 v9, v8
    s_nop 1
    v_permlane16_swap_b32 v8, v9
    v_max_f32 v8, v8, v9
    v_mov_b32 v9, v8
    s_nop 1
    v_permlane32_swap_b32 v8, v9
    v_max_f32 v8, v8, v9
    v_mul_f32 v8, s34, v8
    v_fma_f32 v144, v144, s34, -v8
    v_fma_f32 v145, v145, s34, -v8
    v_fma_f32 v146, v146, s34, -v8
    v_fma_f32 v147, v147, s34, -v8
    v_fma_f32 v148, v148, s34, -v8
    v_fma_f32 v149, v149, s34, -v8
    v_fma_f32 v150, v150, s34, -v8
    v_fma_f32 v151, v151, s34, -v8
    v_exp_f32 v144, v144
    v_exp_f32 v145, v145
    v_exp_f32 v146, v146
    v_exp_f32 v147, v147
    v_exp_f32 v148, v148
    v_exp_f32 v149, v149
    v_exp_f32 v150, v150
    v_exp_f32 v151, v151
    s_nop 0
    v_cvt_pk_bf16_f32 v164, v148, v149
    v_cvt_pk_bf16_f32 v165, v150, v151
    v_mov_b32 v166, 0
    v_mov_b32 v167, 0
    v_cvt_pk_bf16_f32 v168, v144, v145
    v_cvt_pk_bf16_f32 v169, v146, v147
    v_max3_f32 v8, v152, v153, v154
    v_max3_f32 v8, v8, v155, v156
    v_max3_f32 v8, v8, v157, v158
    v_max3_f32 v8, v8, v159, v160
    v_max3_f32 v8, v8, v161, v162
    v_max_f32 v8, v8, v163
    v_mov_b32 v9, v8
    s_nop 1
    v_permlane16_swap_b32 v8, v9
    v_max_f32 v8, v8, v9
    v_mov_b32 v9, v8
    s_nop 1
    v_permlane32_swap_b32 v8, v9
    v_max_f32 v8, v8, v9
    v_mul_f32 v8, s34, v8
    v_fma_f32 v152, v152, s34, -v8
    v_fma_f32 v153, v153, s34, -v8
    v_fma_f32 v154, v154, s34, -v8
    v_fma_f32 v155, v155, s34, -v8
    v_fma_f32 v156, v156, s34, -v8
    v_fma_f32 v157, v157, s34, -v8
    v_fma_f32 v158, v158, s34, -v8
    v_fma_f32 v159, v159, s34, -v8
    v_fma_f32 v160, v160, s34, -v8
    v_fma_f32 v161, v161, s34, -v8
    v_fma_f32 v162, v162, s34, -v8
    v_fma_f32 v163, v163, s34, -v8
    v_exp_f32 v152, v152
    v_exp_f32 v153, v153
    v_exp_f32 v154, v154
    v_exp_f32 v155, v155
    v_exp_f32 v156, v156
    v_exp_f32 v157, v157
    v_exp_f32 v158, v158
    v_exp_f32 v159, v159
    v_exp_f32 v160, v160
    v_exp_f32 v161, v161
    v_exp_f32 v162, v162
    v_exp_f32 v163, v163
    s_nop 0
    v_cvt_pk_bf16_f32 v170, v156, v157
    v_cvt_pk_bf16_f32 v171, v158, v159
    v_cvt_pk_bf16_f32 v172, v160, v161
    v_cvt_pk_bf16_f32 v173, v162, v163
    v_cvt_pk_bf16_f32 v174, v152, v153
    v_cvt_pk_bf16_f32 v175, v154, v155
    s_waitcnt vmcnt(0)
    v_mfma_f32_16x16x32_bf16 v[240:243], v[248:251], v[164:167], 0
    v_mfma_f32_16x16x32_bf16 v[244:247], v[248:251], v[170:173], 0
    v_mfma_f32_16x16x32_bf16 v[176:179], v[80:83], v[164:167], 0
    v_mfma_f32_16x16x32_bf16 v[180:183], v[80:83], v[170:173], 0
    v_mfma_f32_16x16x32_bf16 v[184:187], v[84:87], v[164:167], 0
    v_mfma_f32_16x16x32_bf16 v[188:191], v[84:87], v[170:173], 0
    v_mfma_f32_16x16x32_bf16 v[192:195], v[88:91], v[164:167], 0
    v_mfma_f32_16x16x32_bf16 v[196:199], v[88:91], v[170:173], 0
    v_mfma_f32_16x16x32_bf16 v[200:203], v[92:95], v[164:167], 0
    v_mfma_f32_16x16x32_bf16 v[204:207], v[92:95], v[170:173], 0
    v_mfma_f32_16x16x32_bf16 v[208:211], v[96:99], v[164:167], 0
    v_mfma_f32_16x16x32_bf16 v[212:215], v[96:99], v[170:173], 0
    v_mfma_f32_16x16x32_bf16 v[216:219], v[100:103], v[164:167], 0
    v_mfma_f32_16x16x32_bf16 v[220:223], v[100:103], v[170:173], 0
    v_mfma_f32_16x16x32_bf16 v[224:227], v[104:107], v[164:167], 0
    v_mfma_f32_16x16x32_bf16 v[228:231], v[104:107], v[170:173], 0
    v_mfma_f32_16x16x32_bf16 v[232:235], v[108:111], v[164:167], 0
    v_mfma_f32_16x16x32_bf16 v[236:239], v[108:111], v[170:173], 0
    v_mfma_f32_16x16x16_bf16 v[240:243], v[248:249], v[168:169], v[240:243]
    v_mfma_f32_16x16x16_bf16 v[244:247], v[248:249], v[174:175], v[244:247]
    v_mfma_f32_16x16x16_bf16 v[176:179], v[128:129], v[168:169], v[176:179]
    v_mfma_f32_16x16x16_bf16 v[180:183], v[128:129], v[174:175], v[180:183]
    v_mfma_f32_16x16x16_bf16 v[184:187], v[130:131], v[168:169], v[184:187]
    v_mfma_f32_16x16x16_bf16 v[188:191], v[130:131], v[174:175], v[188:191]
    v_mfma_f32_16x16x16_bf16 v[192:195], v[132:133], v[168:169], v[192:195]
    v_mfma_f32_16x16x16_bf16 v[196:199], v[132:133], v[174:175], v[196:199]
    v_mfma_f32_16x16x16_bf16 v[200:203], v[134:135], v[168:169], v[200:203]
    v_mfma_f32_16x16x16_bf16 v[204:207], v[134:135], v[174:175], v[204:207]
    v_mfma_f32_16x16x16_bf16 v[208:211], v[136:137], v[168:169], v[208:211]
    v_mfma_f32_16x16x16_bf16 v[212:215], v[136:137], v[174:175], v[212:215]
    v_mfma_f32_16x16x16_bf16 v[216:219], v[138:139], v[168:169], v[216:219]
    v_mfma_f32_16x16x16_bf16 v[220:223], v[138:139], v[174:175], v[220:223]
    v_mfma_f32_16x16x16_bf16 v[224:227], v[140:141], v[168:169], v[224:227]
    v_mfma_f32_16x16x16_bf16 v[228:231], v[140:141], v[174:175], v[228:231]
    v_mfma_f32_16x16x16_bf16 v[232:235], v[142:143], v[168:169], v[232:235]
    v_mfma_f32_16x16x16_bf16 v[236:239], v[142:143], v[174:175], v[236:239]
    v_rcp_f32 v8, v240
    v_rcp_f32 v9, v244
    s_nop 7
    v_mul_f32 v176, v176, v8
    v_mul_f32 v177, v177, v8
    v_mul_f32 v178, v178, v8
    v_mul_f32 v179, v179, v8
    v_cvt_pk_bf16_f32 v16, v176, v177
    v_cvt_pk_bf16_f32 v17, v178, v179
    v_mul_f32 v184, v184, v8
    v_mul_f32 v185, v185, v8
    v_mul_f32 v186, v186, v8
    v_mul_f32 v187, v187, v8
    v_cvt_pk_bf16_f32 v18, v184, v185
    v_cvt_pk_bf16_f32 v19, v186, v187
    s_add_u32 s64, s32, 0x0
    buffer_store_dwordx4 v[16:19], v1, s[4:7], s64 offen offset:0 sc1
    v_mul_f32 v192, v192, v8
    v_mul_f32 v193, v193, v8
    v_mul_f32 v194, v194, v8
    v_mul_f32 v195, v195, v8
    v_cvt_pk_bf16_f32 v20, v192, v193
    v_cvt_pk_bf16_f32 v21, v194, v195
    v_mul_f32 v200, v200, v8
    v_mul_f32 v201, v201, v8
    v_mul_f32 v202, v202, v8
    v_mul_f32 v203, v203, v8
    v_cvt_pk_bf16_f32 v22, v200, v201
    v_cvt_pk_bf16_f32 v23, v202, v203
    s_add_u32 s64, s32, 0x0
    buffer_store_dwordx4 v[20:23], v1, s[4:7], s64 offen offset:1024 sc1
    v_mul_f32 v208, v208, v8
    v_mul_f32 v209, v209, v8
    v_mul_f32 v210, v210, v8
    v_mul_f32 v211, v211, v8
    v_cvt_pk_bf16_f32 v24, v208, v209
    v_cvt_pk_bf16_f32 v25, v210, v211
    v_mul_f32 v216, v216, v8
    v_mul_f32 v217, v217, v8
    v_mul_f32 v218, v218, v8
    v_mul_f32 v219, v219, v8
    v_cvt_pk_bf16_f32 v26, v216, v217
    v_cvt_pk_bf16_f32 v27, v218, v219
    s_add_u32 s64, s32, 0x0
    buffer_store_dwordx4 v[24:27], v1, s[4:7], s64 offen offset:2048 sc1
    v_mul_f32 v224, v224, v8
    v_mul_f32 v225, v225, v8
    v_mul_f32 v226, v226, v8
    v_mul_f32 v227, v227, v8
    v_cvt_pk_bf16_f32 v28, v224, v225
    v_cvt_pk_bf16_f32 v29, v226, v227
    v_mul_f32 v232, v232, v8
    v_mul_f32 v233, v233, v8
    v_mul_f32 v234, v234, v8
    v_mul_f32 v235, v235, v8
    v_cvt_pk_bf16_f32 v30, v232, v233
    v_cvt_pk_bf16_f32 v31, v234, v235
    s_add_u32 s64, s32, 0x0
    buffer_store_dwordx4 v[28:31], v1, s[4:7], s64 offen offset:3072 sc1
    v_mul_f32 v180, v180, v9
    v_mul_f32 v181, v181, v9
    v_mul_f32 v182, v182, v9
    v_mul_f32 v183, v183, v9
    v_cvt_pk_bf16_f32 v32, v180, v181
    v_cvt_pk_bf16_f32 v33, v182, v183
    v_mul_f32 v188, v188, v9
    v_mul_f32 v189, v189, v9
    v_mul_f32 v190, v190, v9
    v_mul_f32 v191, v191, v9
    v_cvt_pk_bf16_f32 v34, v188, v189
    v_cvt_pk_bf16_f32 v35, v190, v191
    s_add_u32 s64, s32, 0x20000
    buffer_store_dwordx4 v[32:35], v1, s[4:7], s64 offen offset:0 sc1
    v_mul_f32 v196, v196, v9
    v_mul_f32 v197, v197, v9
    v_mul_f32 v198, v198, v9
    v_mul_f32 v199, v199, v9
    v_cvt_pk_bf16_f32 v36, v196, v197
    v_cvt_pk_bf16_f32 v37, v198, v199
    v_mul_f32 v204, v204, v9
    v_mul_f32 v205, v205, v9
    v_mul_f32 v206, v206, v9
    v_mul_f32 v207, v207, v9
    v_cvt_pk_bf16_f32 v38, v204, v205
    v_cvt_pk_bf16_f32 v39, v206, v207
    s_add_u32 s64, s32, 0x20000
    buffer_store_dwordx4 v[36:39], v1, s[4:7], s64 offen offset:1024 sc1
    v_mul_f32 v212, v212, v9
    v_mul_f32 v213, v213, v9
    v_mul_f32 v214, v214, v9
    v_mul_f32 v215, v215, v9
    v_cvt_pk_bf16_f32 v40, v212, v213
    v_cvt_pk_bf16_f32 v41, v214, v215
    v_mul_f32 v220, v220, v9
    v_mul_f32 v221, v221, v9
    v_mul_f32 v222, v222, v9
    v_mul_f32 v223, v223, v9
    v_cvt_pk_bf16_f32 v42, v220, v221
    v_cvt_pk_bf16_f32 v43, v222, v223
    s_add_u32 s64, s32, 0x20000
    buffer_store_dwordx4 v[40:43], v1, s[4:7], s64 offen offset:2048 sc1
    v_mul_f32 v228, v228, v9
    v_mul_f32 v229, v229, v9
    v_mul_f32 v230, v230, v9
    v_mul_f32 v231, v231, v9
    v_cvt_pk_bf16_f32 v44, v228, v229
    v_cvt_pk_bf16_f32 v45, v230, v231
    v_mul_f32 v236, v236, v9
    v_mul_f32 v237, v237, v9
    v_mul_f32 v238, v238, v9
    v_mul_f32 v239, v239, v9
    v_cvt_pk_bf16_f32 v46, v236, v237
    v_cvt_pk_bf16_f32 v47, v238, v239
    s_add_u32 s64, s32, 0x20000
    buffer_store_dwordx4 v[44:47], v1, s[4:7], s64 offen offset:3072 sc1
    s_waitcnt vmcnt(0)
    v_mov_b32 v7, 1
    v_mov_b32 v8, 0
    s_mov_b64 exec, 1
    buffer_store_dword v7, v8, s[4:7], s33 offen sc1
    s_mov_b64 exec, -1
    s_add_u32 s24, s24, 8
    s_add_u32 s25, s25, 1
    s_cmp_lt_u32 s25, 8
    s_cbranch_scc1 AT2_LOOP
AT2_END:
M_EXIT:
    s_endpgm
.section .rodata,"a"
.p2align 6
.amdhsa_kernel recurrent_scan__memory_aug_recurrent_mem_tr__moe_arch_mod__prompt_kernel
  .amdhsa_next_free_vgpr 512
  .amdhsa_next_free_sgpr 102
  .amdhsa_accum_offset 256
  .amdhsa_group_segment_fixed_size 0
  .amdhsa_kernarg_size 120
  .amdhsa_user_sgpr_count 2
  .amdhsa_user_sgpr_kernarg_segment_ptr 1
  .amdhsa_system_sgpr_workgroup_id_x 1
.end_amdhsa_kernel
```

```asm
; @launch grid=(256,1,1) block=(256,1,1) lds=163840
.amdgcn_target "amdgcn-amd-amdhsa--gfx950"
.text
.globl recurrent_scan__memory_aug_recurrent_mem_tr__moe_arch_mod__prompt_kernel
.p2align 8
.type recurrent_scan__memory_aug_recurrent_mem_tr__moe_arch_mod__prompt_kernel,@function
recurrent_scan__memory_aug_recurrent_mem_tr__moe_arch_mod__prompt_kernel:
    s_cmp_ge_u32 s2, 256
    s_cbranch_scc1 M_EXIT
    s_load_dwordx2 s[4:5], s[0:1], 112
    s_mov_b32 s6, 0x10000000
    s_mov_b32 s7, 0x00020000
    s_load_dwordx2 s[60:61], s[0:1], 104
    s_mov_b32 s62, 256
    s_mov_b32 s63, 0x00020000
    s_load_dwordx2 s[44:45], s[0:1], 16
    s_mov_b32 s46, 0x500000
    s_mov_b32 s47, 0x00020000
    s_load_dwordx2 s[48:49], s[0:1], 24
    s_mov_b32 s50, 0x500000
    s_mov_b32 s51, 0x00020000
    s_load_dwordx2 s[52:53], s[0:1], 32
    s_mov_b32 s54, 0x500000
    s_mov_b32 s55, 0x00020000
    s_load_dwordx2 s[56:57], s[0:1], 40
    s_mov_b32 s58, 0x500000
    s_mov_b32 s59, 0x00020000
    v_lshrrev_b32 v1, 6, v0
    v_and_b32 v0, 63, v0
    s_nop 0
    v_readfirstlane_b32 s14, v1
    s_getreg_b32 s98, hwreg(HW_REG_XCC_ID)
    s_and_b32 s98, s98, 7
    s_mov_b32 s97, 0
    s_mov_b32 s95, 4
    s_waitcnt lgkmcnt(0)
    s_cmp_lg_u32 s14, 0
    s_cbranch_scc1 NOMEAS_1
    s_and_b32 s64, s2, 0xfffffffd
    s_cmp_lg_u32 s64, 1
    s_cbranch_scc1 NOMEAS_1
    s_lshr_b32 s70, s2, 1
    s_mov_b32 s72, s60
    s_mov_b32 s73, s61
    s_mov_b32 s74, s62
    s_mov_b32 s75, s63
    s_lshl_b32 s60, s70, 21
    s_add_u32 s60, s60, 0x6001800
    v_mov_b32 v60, 0
    v_mov_b32 v61, -1
    s_mov_b32 s66, 0x7fffffff
    s_mov_b32 s67, 0x7fffffff
    s_mov_b32 s68, 0x7fffffff
    s_mov_b32 s69, 0x7fffffff
    s_mov_b64 exec, 1
    s_add_u32 s61, s60, 0
    s_memtime s[62:63]
    s_waitcnt lgkmcnt(0)
    buffer_store_dword v61, v60, s[4:7], s61 offen offset:0 sc1
    s_waitcnt vmcnt(0)
    s_memtime s[64:65]
    s_waitcnt lgkmcnt(0)
    s_sub_u32 s62, s64, s62
    s_min_u32 s66, s66, s62
    s_add_u32 s61, s60, 8192
    s_memtime s[62:63]
    s_waitcnt lgkmcnt(0)
    buffer_store_dword v61, v60, s[4:7], s61 offen offset:0 sc1
    s_waitcnt vmcnt(0)
    s_memtime s[64:65]
    s_waitcnt lgkmcnt(0)
    s_sub_u32 s62, s64, s62
    s_min_u32 s67, s67, s62
    s_add_u32 s61, s60, 16384
    s_memtime s[62:63]
    s_waitcnt lgkmcnt(0)
    buffer_store_dword v61, v60, s[4:7], s61 offen offset:0 sc1
    s_waitcnt vmcnt(0)
    s_memtime s[64:65]
    s_waitcnt lgkmcnt(0)
    s_sub_u32 s62, s64, s62
    s_min_u32 s68, s68, s62
    s_add_u32 s61, s60, 24576
    s_memtime s[62:63]
    s_waitcnt lgkmcnt(0)
    buffer_store_dword v61, v60, s[4:7], s61 offen offset:0 sc1
    s_waitcnt vmcnt(0)
    s_memtime s[64:65]
    s_waitcnt lgkmcnt(0)
    s_sub_u32 s62, s64, s62
    s_min_u32 s69, s69, s62
    s_add_u32 s61, s60, 0
    s_memtime s[62:63]
    s_waitcnt lgkmcnt(0)
    buffer_store_dword v61, v60, s[4:7], s61 offen offset:128 sc1
    s_waitcnt vmcnt(0)
    s_memtime s[64:65]
    s_waitcnt lgkmcnt(0)
    s_sub_u32 s62, s64, s62
    s_min_u32 s66, s66, s62
    s_add_u32 s61, s60, 8192
    s_memtime s[62:63]
    s_waitcnt lgkmcnt(0)
    buffer_store_dword v61, v60, s[4:7], s61 offen offset:128 sc1
    s_waitcnt vmcnt(0)
    s_memtime s[64:65]
    s_waitcnt lgkmcnt(0)
    s_sub_u32 s62, s64, s62
    s_min_u32 s67, s67, s62
    s_add_u32 s61, s60, 16384
    s_memtime s[62:63]
    s_waitcnt lgkmcnt(0)
    buffer_store_dword v61, v60, s[4:7], s61 offen offset:128 sc1
    s_waitcnt vmcnt(0)
    s_memtime s[64:65]
    s_waitcnt lgkmcnt(0)
    s_sub_u32 s62, s64, s62
    s_min_u32 s68, s68, s62
    s_add_u32 s61, s60, 24576
    s_memtime s[62:63]
    s_waitcnt lgkmcnt(0)
    buffer_store_dword v61, v60, s[4:7], s61 offen offset:128 sc1
    s_waitcnt vmcnt(0)
    s_memtime s[64:65]
    s_waitcnt lgkmcnt(0)
    s_sub_u32 s62, s64, s62
    s_min_u32 s69, s69, s62
    s_mov_b64 exec, -1
    s_mov_b32 s60, 0
    s_mov_b32 s61, s66
    s_cmp_lt_u32 s67, s61
    s_cselect_b32 s60, 1, s60
    s_min_u32 s61, s61, s67
    s_cmp_lt_u32 s68, s61
    s_cselect_b32 s60, 2, s60
    s_min_u32 s61, s61, s68
    s_cmp_lt_u32 s69, s61
    s_cselect_b32 s60, 3, s60
    s_min_u32 s61, s61, s69
    s_and_b32 s61, s98, 1
    s_lshl_b32 s61, s61, 1
    s_lshr_b32 s62, s98, 2
    s_add_u32 s61, s61, s62
    s_xor_b32 s60, s60, s61
    s_add_u32 s71, s60, 1
    s_mov_b32 s60, s72
    s_mov_b32 s61, s73
    s_mov_b32 s62, s74
    s_mov_b32 s63, s75
    s_lshl_b32 s70, s70, 2
    s_add_u32 s70, s70, 132
    v_mov_b32 v61, s71
    s_mov_b64 exec, 1
    buffer_store_dword v61, off, s[60:63], s70 sc1
    s_mov_b64 exec, -1
NOMEAS_1:
    s_cmp_eq_u32 s98, 0
    s_cselect_b32 s80, 1, 0
    s_cmp_eq_u32 s98, 2
    s_cselect_b32 s80, 1, s80
    s_mov_b32 s94, 0
    s_lshr_b32 s13, s2, 3
    s_and_b32 s13, s13, 31
    s_cmp_eq_u32 s14, 0
    s_cbranch_scc1 M_TICK0
    s_cmp_eq_u32 s80, 1
    s_cbranch_scc1 M_GUESS
    s_branch M_TICKW
M_TICK0:
    s_mul_i32 s64, s98, 32
    s_add_u32 s64, s64, 0x0
    v_mov_b32 v1, 0
    v_mov_b32 v70, 1
    s_mov_b64 exec, 1
    s_cmp_eq_u32 s98, 0
    s_cselect_b32 s65, 24, 28
    s_cmp_eq_u32 s80, 1
    s_cselect_b32 s65, s65, 0x1000
    s_lshl_b32 s66, 1, s13
    v_mov_b32 v4, s66
    buffer_atomic_or v4, off, s[60:63], s65 sc1
    buffer_atomic_add v70, v1, s[60:63], s64 offen sc0
    s_mov_b64 exec, -1
    s_getpc_b64 s[76:77]
M_PCREF:
    s_cmp_eq_u32 s80, 1
    s_mov_b32 s82, M_REC-M_PCREF
    s_mov_b32 s83, M_HELP-M_PCREF
    s_cselect_b32 s81, s82, s83
    s_mov_b32 s82, M_HELP-M_REC
    s_mov_b32 s83, M_EXIT-M_HELP
    s_cselect_b32 s78, s82, s83
    s_add_u32 s76, s76, s81
    s_addc_u32 s77, s77, 0
    s_and_b32 s77, s77, 0xffff
    s_mov_b32 s79, 0x00020000
    s_lshr_b32 s81, s2, 3
    s_and_b32 s81, s81, 3
    s_lshl_b32 s81, s81, 12
    v_mbcnt_lo_u32_b32 v3, -1, 0
    v_mbcnt_hi_u32_b32 v3, -1, v3
    v_lshlrev_b32 v3, 6, v3
    s_mov_b32 m0, 1024
    s_nop 0
    buffer_load_dword v3, s[76:79], s81 offen lds
    s_add_u32 s81, s81, 16384
    buffer_load_dword v3, s[76:79], s81 offen lds
    s_add_u32 s81, s81, 16384
    buffer_load_dword v3, s[76:79], s81 offen lds
    s_add_u32 s81, s81, 16384
    buffer_load_dword v3, s[76:79], s81 offen lds
    s_add_u32 s81, s81, 16384
    buffer_load_dword v3, s[76:79], s81 offen lds
    s_add_u32 s81, s81, 16384
    s_cmp_eq_u32 s80, 1
    s_cbranch_scc1 M_GUESS
    s_mov_b64 exec, 1
    s_waitcnt vmcnt(5)
    ds_write_b32 v1, v70
    s_waitcnt lgkmcnt(0)
    s_mov_b64 exec, -1
M_TICKW:
    s_barrier
    v_mov_b32 v1, 0
    ds_read_b32 v2, v1
    s_waitcnt lgkmcnt(0)
    v_readfirstlane_b32 s99, v2
    s_barrier
    s_cmp_ge_u32 s99, 32
    s_cbranch_scc1 M_SLOW0
    s_mov_b32 s12, s98
    s_cmp_eq_u32 s12, 0
    s_cbranch_scc1 XOK_2
    s_cmp_eq_u32 s12, 2
    s_cbranch_scc0 M_FH
    s_mov_b32 s12, 1
XOK_2:
    s_mov_b32 s13, s99
    s_branch M_REC
M_FH:
    s_sub_u32 s96, s98, 1
    s_cmp_gt_u32 s98, 2
    s_cselect_b32 s64, 1, 0
    s_sub_u32 s96, s96, s64
    s_lshl_b32 s96, s96, 5
    s_add_u32 s96, s96, s99
    s_branch M_HELP
M_GUESS:
    s_mov_b32 s94, 1
    s_cmp_eq_u32 s98, 0
    s_cselect_b32 s12, 0, 1
    s_branch M_REC
M_GFAIL:
    s_waitcnt vmcnt(0) lgkmcnt(0)
    s_barrier
    s_cmp_lg_u32 s14, 0
    s_cbranch_scc1 M_GF1
    v_mov_b32 v1, 0
    s_mov_b64 exec, 1
    ds_write_b32 v1, v70
    s_waitcnt lgkmcnt(0)
    s_mov_b64 exec, -1
M_GF1:
    s_barrier
    v_mov_b32 v1, 0
    ds_read_b32 v2, v1
    s_waitcnt lgkmcnt(0)
    v_readfirstlane_b32 s99, v2
    s_barrier
    s_mov_b32 s94, 0
    s_cmp_ge_u32 s99, 32
    s_cbranch_scc1 M_SLOW0
    s_mov_b32 s13, s99
    v_mbcnt_lo_u32_b32 v0, -1, 0
    v_mbcnt_hi_u32_b32 v0, -1, v0
    s_branch M_REC
M_SLOW0:
    v_mbcnt_lo_u32_b32 v0, -1, 0
    v_mbcnt_hi_u32_b32 v0, -1, v0
    v_mul_u32_u24 v8, 32, v0
    s_mov_b32 s64, 0x0
    s_mov_b32 s65, 0
    s_mov_b64 exec, 0xff
TK_3:
    buffer_load_dword v9, v8, s[60:63], s64 offen sc1
    s_add_u32 s65, s65, 1
    s_waitcnt vmcnt(0)
    s_mov_b32 s66, 0
    v_readlane_b32 s67, v9, 0
    s_add_u32 s66, s66, s67
    v_readlane_b32 s67, v9, 1
    s_add_u32 s66, s66, s67
    v_readlane_b32 s67, v9, 2
    s_add_u32 s66, s66, s67
    v_readlane_b32 s67, v9, 3
    s_add_u32 s66, s66, s67
    v_readlane_b32 s67, v9, 4
    s_add_u32 s66, s66, s67
    v_readlane_b32 s67, v9, 5
    s_add_u32 s66, s66, s67
    v_readlane_b32 s67, v9, 6
    s_add_u32 s66, s66, s67
    v_readlane_b32 s67, v9, 7
    s_add_u32 s66, s66, s67
    s_cmp_ge_u32 s66, 256
    s_cbranch_scc1 TKD_4
    s_cmp_gt_u32 s65, 262144
    s_cbranch_scc0 TK_3
TKD_4:
    v_cmp_ne_u32 vcc, 32, v9
    s_mov_b64 exec, -1
M_SLOW:
    s_waitcnt vmcnt(0) lgkmcnt(0)
    s_barrier
    s_cmp_lg_u32 s14, 0
    s_cbranch_scc1 M_SLOWB
    v_mov_b32 v8, 1
    s_mov_b64 exec, 1
    buffer_atomic_add v8, off, s[60:63], 12 sc1
    s_mov_b64 exec, -1
M_SLOWB:
    s_mov_b32 s95, 12
    s_mov_b32 s65, 0
SB_5:
    buffer_load_dword v8, off, s[60:63], s95 sc1
    s_add_u32 s65, s65, 1
    s_waitcnt vmcnt(0)
    v_readfirstlane_b32 s64, v8
    s_cmp_ge_u32 s64, 256
    s_cbranch_scc1 SBD_6
    s_cmp_gt_u32 s65, 65536
    s_cbranch_scc1 SBD_6
    s_sleep 4
    s_branch SB_5
SBD_6:
    s_mov_b32 s95, 8
    s_mov_b32 s97, 1
    s_mov_b32 s94, 0
    s_cmp_lt_u32 s2, 64
    s_cbranch_scc0 M_SH
    s_load_dwordx2 s[44:45], s[0:1], 16
    s_mov_b32 s46, 0x500000
    s_mov_b32 s47, 0x00020000
    s_load_dwordx2 s[48:49], s[0:1], 24
    s_mov_b32 s50, 0x500000
    s_mov_b32 s51, 0x00020000
    s_load_dwordx2 s[52:53], s[0:1], 32
    s_mov_b32 s54, 0x500000
    s_mov_b32 s55, 0x00020000
    s_load_dwordx2 s[56:57], s[0:1], 40
    s_mov_b32 s58, 0x500000
    s_mov_b32 s59, 0x00020000
    s_waitcnt lgkmcnt(0)
    s_lshr_b32 s12, s2, 5
    s_and_b32 s13, s2, 31
    s_branch M_REC
M_SH:
    s_sub_u32 s96, s2, 64
    s_branch M_HELP
M_REC:
    v_mbcnt_lo_u32_b32 v0, -1, 0
    v_mbcnt_hi_u32_b32 v0, -1, v0
    v_and_b32 v0, 63, v0
    s_mul_i32 s40, s14, 36864
    s_add_u32 s40, s40, 16384
    v_lshrrev_b32 v95, 4, v0
    v_lshlrev_b32 v8, 13, v95
    v_and_b32 v95, 1, v95
    v_lshlrev_b32 v95, 1, v95
    v_and_b32 v9, 15, v0
    v_xor_b32 v9, v9, v95
    v_xor_b32 v95, 0, v9
    v_lshl_add_u32 v76, v95, 4, v8
    v_xor_b32 v95, 4, v9
    v_lshl_add_u32 v77, v95, 4, v8
    v_xor_b32 v95, 8, v9
    v_lshl_add_u32 v78, v95, 4, v8
    v_xor_b32 v95, 12, v9
    v_lshl_add_u32 v79, v95, 4, v8
    s_lshl_b32 s64, s13, 8
    s_lshl_b32 s65, s14, 17
    s_add_u32 s64, s64, s65
    s_mul_i32 s65, s12, 2621440
    s_add_u32 s71, s64, s65
    s_sub_u32 s65, 2621440, s65
    s_add_u32 s72, s64, s65
    s_add_u32 m0, s40, 0
    s_add_u32 s64, s71, 0x0
    buffer_load_dwordx4 v76, s[44:47], s64 offen lds
    s_add_u32 m0, s40, 1024
    s_add_u32 s64, s71, 0x8000
    buffer_load_dwordx4 v77, s[44:47], s64 offen lds
    s_add_u32 m0, s40, 2048
    s_add_u32 s64, s71, 0x10000
    buffer_load_dwordx4 v78, s[44:47], s64 offen lds
    s_add_u32 m0, s40, 3072
    s_add_u32 s64, s71, 0x18000
    buffer_load_dwordx4 v79, s[44:47], s64 offen lds
    s_add_u32 m0, s40, 4096
    s_add_u32 s64, s71, 0x80000
    buffer_load_dwordx4 v76, s[44:47], s64 offen lds
    s_add_u32 m0, s40, 5120
    s_add_u32 s64, s71, 0x88000
    buffer_load_dwordx4 v77, s[44:47], s64 offen lds
    s_add_u32 m0, s40, 6144
    s_add_u32 s64, s71, 0x90000
    buffer_load_dwordx4 v78, s[44:47], s64 offen lds
    s_add_u32 m0, s40, 7168
    s_add_u32 s64, s71, 0x98000
    buffer_load_dwordx4 v79, s[44:47], s64 offen lds
    s_add_u32 m0, s40, 8192
    s_add_u32 s64, s71, 0x100000
    buffer_load_dwordx4 v76, s[44:47], s64 offen lds
    s_add_u32 m0, s40, 9216
    s_add_u32 s64, s71, 0x108000
    buffer_load_dwordx4 v77, s[44:47], s64 offen lds
    s_add_u32 m0, s40, 10240
    s_add_u32 s64, s71, 0x110000
    buffer_load_dwordx4 v78, s[44:47], s64 offen lds
    s_add_u32 m0, s40, 11264
    s_add_u32 s64, s71, 0x118000
    buffer_load_dwordx4 v79, s[44:47], s64 offen lds
    s_add_u32 m0, s40, 12288
    s_add_u32 s64, s71, 0x180000
    buffer_load_dwordx4 v76, s[44:47], s64 offen lds
    s_add_u32 m0, s40, 13312
    s_add_u32 s64, s71, 0x188000
    buffer_load_dwordx4 v77, s[44:47], s64 offen lds
    s_add_u32 m0, s40, 14336
    s_add_u32 s64, s71, 0x190000
    buffer_load_dwordx4 v78, s[44:47], s64 offen lds
    s_add_u32 m0, s40, 15360
    s_add_u32 s64, s71, 0x198000
    buffer_load_dwordx4 v79, s[44:47], s64 offen lds
    s_add_u32 m0, s40, 16384
    s_add_u32 s64, s71, 0x200000
    buffer_load_dwordx4 v76, s[44:47], s64 offen lds
    s_add_u32 m0, s40, 17408
    s_add_u32 s64, s71, 0x208000
    buffer_load_dwordx4 v77, s[44:47], s64 offen lds
    s_add_u32 m0, s40, 18432
    s_add_u32 s64, s71, 0x210000
    buffer_load_dwordx4 v78, s[44:47], s64 offen lds
    s_add_u32 m0, s40, 19456
    s_add_u32 s64, s71, 0x218000
    buffer_load_dwordx4 v79, s[44:47], s64 offen lds
    s_add_u32 m0, s40, 20480
    s_add_u32 s64, s72, 0x0
    buffer_load_dwordx4 v76, s[44:47], s64 offen lds
    s_add_u32 m0, s40, 21504
    s_add_u32 s64, s72, 0x8000
    buffer_load_dwordx4 v77, s[44:47], s64 offen lds
    s_add_u32 m0, s40, 22528
    s_add_u32 s64, s72, 0x10000
    buffer_load_dwordx4 v78, s[44:47], s64 offen lds
    s_add_u32 m0, s40, 23552
    s_add_u32 s64, s72, 0x18000
    buffer_load_dwordx4 v79, s[44:47], s64 offen lds
    s_add_u32 m0, s40, 24576
    s_add_u32 s64, s72, 0x80000
    buffer_load_dwordx4 v76, s[44:47], s64 offen lds
    s_add_u32 m0, s40, 25600
    s_add_u32 s64, s72, 0x88000
    buffer_load_dwordx4 v77, s[44:47], s64 offen lds
    s_add_u32 m0, s40, 26624
    s_add_u32 s64, s72, 0x90000
    buffer_load_dwordx4 v78, s[44:47], s64 offen lds
    s_add_u32 m0, s40, 27648
    s_add_u32 s64, s72, 0x98000
    buffer_load_dwordx4 v79, s[44:47], s64 offen lds
    s_add_u32 m0, s40, 28672
    s_add_u32 s64, s72, 0x100000
    buffer_load_dwordx4 v76, s[44:47], s64 offen lds
    s_add_u32 m0, s40, 29696
    s_add_u32 s64, s72, 0x108000
    buffer_load_dwordx4 v77, s[44:47], s64 offen lds
    s_add_u32 m0, s40, 30720
    s_add_u32 s64, s72, 0x110000
    buffer_load_dwordx4 v78, s[44:47], s64 offen lds
    s_add_u32 m0, s40, 31744
    s_add_u32 s64, s72, 0x118000
    buffer_load_dwordx4 v79, s[44:47], s64 offen lds
    v_lshrrev_b32 v95, 5, v0
    v_mul_u32_u24 v8, 36864, v95
    v_bfe_u32 v95, v0, 3, 1
    v_lshl_add_u32 v8, v95, 11, v8
    v_lshlrev_b32 v9, 3, v95
    v_bfe_u32 v95, v0, 4, 1
    v_lshl_add_u32 v8, v95, 10, v8
    v_lshl_add_u32 v9, v95, 2, v9
    v_bfe_u32 v95, v0, 2, 1
    v_lshl_add_u32 v8, v95, 8, v8
    v_lshl_add_u32 v9, v95, 1, v9
    v_and_b32 v95, 1, v0
    v_lshl_add_u32 v8, v95, 3, v8
    v_add_u32 v8, 16384, v8
    v_bfe_u32 v95, v0, 1, 1
    s_lshl_b32 s64, s14, 2
    v_add_u32 v10, s64, v95
    v_add_u32 v95, 0, v10
    v_xor_b32 v95, v95, v9
    v_lshl_add_u32 v72, v95, 4, v8
    v_add_u32 v73, 73728, v72
    v_add_u32 v95, 2, v10
    v_xor_b32 v95, v95, v9
    v_lshl_add_u32 v74, v95, 4, v8
    v_add_u32 v75, 73728, v74
    v_bfe_u32 v95, v0, 2, 1
    v_mov_b32 v8, v95
    v_bfe_u32 v95, v0, 3, 1
    v_lshl_add_u32 v8, v95, 2, v8
    v_bfe_u32 v95, v0, 4, 1
    v_lshl_add_u32 v8, v95, 1, v8
    v_bfe_u32 v95, v0, 5, 1
    v_lshl_add_u32 v8, v95, 3, v8
    v_mul_u32_u24 v8, 1280, v8
    v_and_b32 v95, 3, v0
    v_lshl_add_u32 v89, v95, 4, v8
    v_lshrrev_b32 v95, 1, v0
    v_mul_u32_u24 v8, 1280, v95
    v_and_b32 v95, 1, v0
    v_lshl_add_u32 v90, v95, 4, v8
    v_lshrrev_b32 v95, 5, v0
    v_lshlrev_b32 v93, 9, v95
    v_bfe_u32 v95, v0, 4, 1
    v_lshl_add_u32 v93, v95, 7, v93
    v_bfe_u32 v95, v0, 2, 1
    v_lshl_add_u32 v93, v95, 6, v93
    v_bfe_u32 v95, v0, 3, 1
    v_lshl_add_u32 v93, v95, 5, v93
    v_and_b32 v95, 3, v0
    v_lshl_add_u32 v93, v95, 3, v93
    v_add_u32 v93, s40, v93
    v_lshrrev_b32 v95, 4, v0
    v_lshlrev_b32 v94, 8, v95
    v_bfe_u32 v95, v0, 2, 2
    v_lshl_add_u32 v94, v95, 5, v94
    v_and_b32 v95, 3, v0
    v_lshl_add_u32 v94, v95, 3, v94
    v_add_u32 v94, s40, v94
    s_mul_i32 s39, s13, 163840
    s_mul_i32 s64, s12, 640
    s_add_u32 s39, s39, s64
    s_lshl_b32 s64, s14, 5
    s_add_u32 s41, s39, s64
    s_add_u32 s41, s41, 0x200
    s_lshl_b32 s64, s14, 6
    s_add_u32 s39, s39, s64
    v_and_b32 v0, 63, v0
    v_lshlrev_b32 v1, 4, v0
    s_mul_i32 s64, s14, 36864
    s_add_u32 s64, s64, 16384
    v_add_u32 v2, s64, v1
    v_bfe_u32 v8, v0, 4, 1
    v_mul_u32_u24 v8, 1152, v8
    v_lshrrev_b32 v9, 5, v0
    v_lshlrev_b32 v9, 4, v9
    v_and_b32 v10, 15, v0
    v_add_u32 v9, v9, v10
    s_lshl_b32 s64, s14, 5
    v_add_u32 v9, s64, v9
    v_lshl_add_u32 v8, v9, 3, v8
    v_add_u32 v3, 8192, v8
    v_and_b32 v8, 1, v0
    v_mul_u32_u24 v8, 1152, v8
    v_lshrrev_b32 v9, 4, v0
    v_lshlrev_b32 v9, 2, v9
    v_bfe_u32 v10, v0, 2, 2
    v_add_u32 v9, v9, v10
    v_lshl_add_u32 v8, v9, 3, v8
    v_add_u32 v4, 8192, v8
    v_and_b32 v8, 7, v0
    v_mul_u32_u24 v8, 288, v8
    v_bfe_u32 v9, v0, 3, 1
    v_lshl_add_u32 v8, v9, 5, v8
    v_lshrrev_b32 v9, 4, v0
    v_lshl_add_u32 v8, v9, 3, v8
    s_lshl_b32 s64, s14, 6
    s_add_u32 s64, s64, 12800
    v_add_u32 v5, s64, v8
    s_mov_b32 s32, 0x00ff00ff
    s_mov_b32 s33, 0x00ff00ff
    s_mov_b32 s34, -1
    s_mov_b32 s35, 0
    s_mov_b32 s36, 0x00010001
    s_mov_b32 s37, 0x00010001
    v_mov_b32 v8, 0xeeee
    v_mov_b32 v9, 0x4444
    v_cndmask_b32 v6, v8, v9, s[32:33]
    v_lshrrev_b32 v8, 5, v0
    v_lshlrev_b32 v8, 13, v8
    v_bfe_u32 v9, v0, 3, 1
    v_lshl_add_u32 v8, v9, 12, v8
    v_and_b32 v9, 7, v0
    v_lshl_add_u32 v8, v9, 4, v8
    v_bfe_u32 v9, v0, 4, 1
    v_lshl_add_u32 v7, v9, 3, v8
    s_mov_b32 s10, 0x3e0293ee
    s_mov_b32 s11, 0x3e0293ee
    s_cmp_eq_u32 s14, 0
    s_cselect_b32 s42, 1, 0
    s_cmp_ge_u32 s13, 24
    s_cselect_b32 s65, 1, 0
    s_cmp_eq_u32 s14, 1
    s_cselect_b32 s65, s65, 0
    s_or_b32 s42, s42, s65
    s_lshl_b32 s65, s65, 3
    s_add_u32 s64, s13, s65
    s_cmp_eq_u32 s64, 39
    s_cselect_b32 s22, s42, 0
    s_mul_i32 s24, s12, 163840
    s_add_u32 s24, s24, 0x300000
    s_lshl_b32 s67, s13, 7
    s_add_u32 s26, s24, s67
    s_lshl_b32 s67, s14, 14
    s_add_u32 s23, s26, s67
    s_add_u32 s25, s23, 0x10000
    s_lshl_b32 s67, s14, 13
    s_add_u32 s26, s26, s67
    s_add_u32 s26, s26, 0x20000
    s_lshl_b32 s67, s64, 12
    s_add_u32 s24, s24, s67
    s_lshl_b32 s64, s64, 7
    s_lshl_b32 s65, s12, 13
    s_add_u32 s17, s65, 0x5900000
    s_add_u32 s18, s17, s64
    s_lshl_b32 s65, s12, 21
    s_add_u32 s66, s65, 0x6000000
    s_add_u32 s21, s66, s64
    s_xor_b32 s65, s65, 0x200000
    s_add_u32 s20, s65, 0x5ff8000
    s_and_b32 s64, s13, 1
    s_cmp_eq_u32 s64, s12
    s_cselect_b32 s43, 1, 0
    s_mov_b32 s43, 0
    s_lshl_b32 s64, s13, 4
    s_add_u32 s69, s64, 0x291000
    s_lshl_b32 s64, s13, 2
    s_add_u32 s70, s64, 0x294000
    s_lshl_b32 s64, s13, 14
    s_lshl_b32 s73, s14, 11
    s_lshl_b32 s65, s14, 12
    s_add_u32 s65, s65, s64
    s_add_u32 s3, s65, 0x1500000
    s_add_u32 s64, s64, s73
    s_add_u32 s28, s64, 0x1400000
    s_add_u32 s29, s64, 0x1402000
    s_lshl_b32 s64, s13, 11
    s_add_u32 s30, s64, 0x640000
    s_lshl_b32 s64, s13, 12
    s_lshl_b32 s65, s14, 10
    s_add_u32 s64, s64, s65
    s_add_u32 s31, s64, 0xa40000
    s_waitcnt vmcnt(28)
    s_barrier
    s_add_u32 m0, s40, 32768
    s_add_u32 s64, s72, 0x180000
    buffer_load_dwordx4 v76, s[44:47], s64 offen lds
    s_add_u32 m0, s40, 33792
    s_add_u32 s64, s72, 0x188000
    buffer_load_dwordx4 v77, s[44:47], s64 offen lds
    s_add_u32 m0, s40, 34816
    s_add_u32 s64, s72, 0x190000
    buffer_load_dwordx4 v78, s[44:47], s64 offen lds
    s_add_u32 m0, s40, 35840
    s_add_u32 s64, s72, 0x198000
    buffer_load_dwordx4 v79, s[44:47], s64 offen lds
    ds_read_b64_tr_b16 v[96:97], v72 offset:0
    ds_read_b64_tr_b16 v[98:99], v72 offset:512
    ds_read_b64_tr_b16 v[100:101], v73 offset:0
    ds_read_b64_tr_b16 v[102:103], v73 offset:512
    ds_read_b64_tr_b16 v[104:105], v74 offset:0
    ds_read_b64_tr_b16 v[106:107], v74 offset:512
    ds_read_b64_tr_b16 v[108:109], v75 offset:0
    ds_read_b64_tr_b16 v[110:111], v75 offset:512
    s_waitcnt lgkmcnt(0)
    s_waitcnt vmcnt(28)
    s_barrier
    s_add_u32 m0, s40, 0
    s_add_u32 s64, s72, 0x200000
    buffer_load_dwordx4 v76, s[44:47], s64 offen lds
    s_add_u32 m0, s40, 1024
    s_add_u32 s64, s72, 0x208000
    buffer_load_dwordx4 v77, s[44:47], s64 offen lds
    s_add_u32 m0, s40, 2048
    s_add_u32 s64, s72, 0x210000
    buffer_load_dwordx4 v78, s[44:47], s64 offen lds
    s_add_u32 m0, s40, 3072
    s_add_u32 s64, s72, 0x218000
    buffer_load_dwordx4 v79, s[44:47], s64 offen lds
    ds_read_b64_tr_b16 v[112:113], v72 offset:4096
    ds_read_b64_tr_b16 v[114:115], v72 offset:4608
    ds_read_b64_tr_b16 v[116:117], v73 offset:4096
    ds_read_b64_tr_b16 v[118:119], v73 offset:4608
    ds_read_b64_tr_b16 v[120:121], v74 offset:4096
    ds_read_b64_tr_b16 v[122:123], v74 offset:4608
    ds_read_b64_tr_b16 v[124:125], v75 offset:4096
    ds_read_b64_tr_b16 v[126:127], v75 offset:4608
    s_waitcnt lgkmcnt(0)
    s_waitcnt vmcnt(28)
    s_barrier
    s_add_u32 m0, s40, 4096
    s_add_u32 s64, s72, 0x200000
    buffer_load_dwordx4 v76, s[48:51], s64 offen lds
    s_add_u32 m0, s40, 5120
    s_add_u32 s64, s72, 0x208000
    buffer_load_dwordx4 v77, s[48:51], s64 offen lds
    s_add_u32 m0, s40, 6144
    s_add_u32 s64, s72, 0x210000
    buffer_load_dwordx4 v78, s[48:51], s64 offen lds
    s_add_u32 m0, s40, 7168
    s_add_u32 s64, s72, 0x218000
    buffer_load_dwordx4 v79, s[48:51], s64 offen lds
    ds_read_b64_tr_b16 v[128:129], v72 offset:8192
    ds_read_b64_tr_b16 v[130:131], v72 offset:8704
    ds_read_b64_tr_b16 v[132:133], v73 offset:8192
    ds_read_b64_tr_b16 v[134:135], v73 offset:8704
    ds_read_b64_tr_b16 v[136:137], v74 offset:8192
    ds_read_b64_tr_b16 v[138:139], v74 offset:8704
    ds_read_b64_tr_b16 v[140:141], v75 offset:8192
    ds_read_b64_tr_b16 v[142:143], v75 offset:8704
    s_waitcnt lgkmcnt(0)
    s_waitcnt vmcnt(28)
    s_barrier
    s_add_u32 m0, s40, 8192
    s_add_u32 s64, s71, 0x0
    buffer_load_dwordx4 v76, s[52:55], s64 offen lds
    s_add_u32 m0, s40, 9216
    s_add_u32 s64, s71, 0x8000
    buffer_load_dwordx4 v77, s[52:55], s64 offen lds
    s_add_u32 m0, s40, 10240
    s_add_u32 s64, s71, 0x10000
    buffer_load_dwordx4 v78, s[52:55], s64 offen lds
    s_add_u32 m0, s40, 11264
    s_add_u32 s64, s71, 0x18000
    buffer_load_dwordx4 v79, s[52:55], s64 offen lds
    ds_read_b64_tr_b16 v[144:145], v72 offset:12288
    ds_read_b64_tr_b16 v[146:147], v72 offset:12800
    ds_read_b64_tr_b16 v[148:149], v73 offset:12288
    ds_read_b64_tr_b16 v[150:151], v73 offset:12800
    ds_read_b64_tr_b16 v[152:153], v74 offset:12288
    ds_read_b64_tr_b16 v[154:155], v74 offset:12800
    ds_read_b64_tr_b16 v[156:157], v75 offset:12288
    ds_read_b64_tr_b16 v[158:159], v75 offset:12800
    s_waitcnt lgkmcnt(0)
    s_waitcnt vmcnt(28)
    s_barrier
    s_add_u32 m0, s40, 12288
    s_add_u32 s64, s71, 0x80000
    buffer_load_dwordx4 v76, s[52:55], s64 offen lds
    s_add_u32 m0, s40, 13312
    s_add_u32 s64, s71, 0x88000
    buffer_load_dwordx4 v77, s[52:55], s64 offen lds
    s_add_u32 m0, s40, 14336
    s_add_u32 s64, s71, 0x90000
    buffer_load_dwordx4 v78, s[52:55], s64 offen lds
    s_add_u32 m0, s40, 15360
    s_add_u32 s64, s71, 0x98000
    buffer_load_dwordx4 v79, s[52:55], s64 offen lds
    ds_read_b64_tr_b16 v[160:161], v72 offset:16384
    ds_read_b64_tr_b16 v[162:163], v72 offset:16896
    ds_read_b64_tr_b16 v[164:165], v73 offset:16384
    ds_read_b64_tr_b16 v[166:167], v73 offset:16896
    ds_read_b64_tr_b16 v[168:169], v74 offset:16384
    ds_read_b64_tr_b16 v[170:171], v74 offset:16896
    ds_read_b64_tr_b16 v[172:173], v75 offset:16384
    ds_read_b64_tr_b16 v[174:175], v75 offset:16896
    s_waitcnt lgkmcnt(0)
    s_waitcnt vmcnt(28)
    s_barrier
    s_add_u32 m0, s40, 16384
    s_add_u32 s64, s71, 0x100000
    buffer_load_dwordx4 v76, s[52:55], s64 offen lds
    s_add_u32 m0, s40, 17408
    s_add_u32 s64, s71, 0x108000
    buffer_load_dwordx4 v77, s[52:55], s64 offen lds
    s_add_u32 m0, s40, 18432
    s_add_u32 s64, s71, 0x110000
    buffer_load_dwordx4 v78, s[52:55], s64 offen lds
    s_add_u32 m0, s40, 19456
    s_add_u32 s64, s71, 0x118000
    buffer_load_dwordx4 v79, s[52:55], s64 offen lds
    ds_read_b64_tr_b16 v[176:177], v72 offset:20480
    ds_read_b64_tr_b16 v[178:179], v72 offset:20992
    ds_read_b64_tr_b16 v[180:181], v73 offset:20480
    ds_read_b64_tr_b16 v[182:183], v73 offset:20992
    ds_read_b64_tr_b16 v[184:185], v74 offset:20480
    ds_read_b64_tr_b16 v[186:187], v74 offset:20992
    ds_read_b64_tr_b16 v[188:189], v75 offset:20480
    ds_read_b64_tr_b16 v[190:191], v75 offset:20992
    s_waitcnt lgkmcnt(0)
    s_waitcnt vmcnt(28)
    s_barrier
    s_add_u32 m0, s40, 20480
    s_add_u32 s64, s71, 0x180000
    buffer_load_dwordx4 v76, s[52:55], s64 offen lds
    s_add_u32 m0, s40, 21504
    s_add_u32 s64, s71, 0x188000
    buffer_load_dwordx4 v77, s[52:55], s64 offen lds
    s_add_u32 m0, s40, 22528
    s_add_u32 s64, s71, 0x190000
    buffer_load_dwordx4 v78, s[52:55], s64 offen lds
    s_add_u32 m0, s40, 23552
    s_add_u32 s64, s71, 0x198000
    buffer_load_dwordx4 v79, s[52:55], s64 offen lds
    ds_read_b64_tr_b16 v[192:193], v72 offset:24576
    ds_read_b64_tr_b16 v[194:195], v72 offset:25088
    ds_read_b64_tr_b16 v[196:197], v73 offset:24576
    ds_read_b64_tr_b16 v[198:199], v73 offset:25088
    ds_read_b64_tr_b16 v[200:201], v74 offset:24576
    ds_read_b64_tr_b16 v[202:203], v74 offset:25088
    ds_read_b64_tr_b16 v[204:205], v75 offset:24576
    ds_read_b64_tr_b16 v[206:207], v75 offset:25088
    s_waitcnt lgkmcnt(0)
    s_waitcnt vmcnt(28)
    s_barrier
    s_add_u32 m0, s40, 24576
    s_add_u32 s64, s71, 0x200000
    buffer_load_dwordx4 v76, s[52:55], s64 offen lds
    s_add_u32 m0, s40, 25600
    s_add_u32 s64, s71, 0x208000
    buffer_load_dwordx4 v77, s[52:55], s64 offen lds
    s_add_u32 m0, s40, 26624
    s_add_u32 s64, s71, 0x210000
    buffer_load_dwordx4 v78, s[52:55], s64 offen lds
    s_add_u32 m0, s40, 27648
    s_add_u32 s64, s71, 0x218000
    buffer_load_dwordx4 v79, s[52:55], s64 offen lds
    ds_read_b64_tr_b16 v[208:209], v72 offset:28672
    ds_read_b64_tr_b16 v[210:211], v72 offset:29184
    ds_read_b64_tr_b16 v[212:213], v73 offset:28672
    ds_read_b64_tr_b16 v[214:215], v73 offset:29184
    ds_read_b64_tr_b16 v[216:217], v74 offset:28672
    ds_read_b64_tr_b16 v[218:219], v74 offset:29184
    ds_read_b64_tr_b16 v[220:221], v75 offset:28672
    ds_read_b64_tr_b16 v[222:223], v75 offset:29184
    s_waitcnt lgkmcnt(0)
    s_waitcnt vmcnt(28)
    s_barrier
    s_add_u32 m0, s40, 28672
    s_add_u32 s64, s72, 0x0
    buffer_load_dwordx4 v76, s[52:55], s64 offen lds
    s_add_u32 m0, s40, 29696
    s_add_u32 s64, s72, 0x8000
    buffer_load_dwordx4 v77, s[52:55], s64 offen lds
    s_add_u32 m0, s40, 30720
    s_add_u32 s64, s72, 0x10000
    buffer_load_dwordx4 v78, s[52:55], s64 offen lds
    s_add_u32 m0, s40, 31744
    s_add_u32 s64, s72, 0x18000
    buffer_load_dwordx4 v79, s[52:55], s64 offen lds
    ds_read_b64_tr_b16 v[224:225], v72 offset:32768
    ds_read_b64_tr_b16 v[226:227], v72 offset:33280
    ds_read_b64_tr_b16 v[228:229], v73 offset:32768
    ds_read_b64_tr_b16 v[230:231], v73 offset:33280
    ds_read_b64_tr_b16 v[232:233], v74 offset:32768
    ds_read_b64_tr_b16 v[234:235], v74 offset:33280
    ds_read_b64_tr_b16 v[236:237], v75 offset:32768
    ds_read_b64_tr_b16 v[238:239], v75 offset:33280
    s_waitcnt lgkmcnt(0)
    s_waitcnt vmcnt(28)
    s_barrier
    s_add_u32 m0, s40, 32768
    s_add_u32 s64, s72, 0x80000
    buffer_load_dwordx4 v76, s[52:55], s64 offen lds
    s_add_u32 m0, s40, 33792
    s_add_u32 s64, s72, 0x88000
    buffer_load_dwordx4 v77, s[52:55], s64 offen lds
    s_add_u32 m0, s40, 34816
    s_add_u32 s64, s72, 0x90000
    buffer_load_dwordx4 v78, s[52:55], s64 offen lds
    s_add_u32 m0, s40, 35840
    s_add_u32 s64, s72, 0x98000
    buffer_load_dwordx4 v79, s[52:55], s64 offen lds
    ds_read_b64_tr_b16 v[240:241], v72 offset:0
    ds_read_b64_tr_b16 v[242:243], v72 offset:512
    ds_read_b64_tr_b16 v[244:245], v73 offset:0
    ds_read_b64_tr_b16 v[246:247], v73 offset:512
    ds_read_b64_tr_b16 v[248:249], v74 offset:0
    ds_read_b64_tr_b16 v[250:251], v74 offset:512
    ds_read_b64_tr_b16 v[252:253], v75 offset:0
    ds_read_b64_tr_b16 v[254:255], v75 offset:512
    s_waitcnt lgkmcnt(0)
    s_waitcnt vmcnt(28)
    s_barrier
    s_add_u32 m0, s40, 0
    s_add_u32 s64, s72, 0x100000
    buffer_load_dwordx4 v76, s[52:55], s64 offen lds
    s_add_u32 m0, s40, 1024
    s_add_u32 s64, s72, 0x108000
    buffer_load_dwordx4 v77, s[52:55], s64 offen lds
    s_add_u32 m0, s40, 2048
    s_add_u32 s64, s72, 0x110000
    buffer_load_dwordx4 v78, s[52:55], s64 offen lds
    s_add_u32 m0, s40, 3072
    s_add_u32 s64, s72, 0x118000
    buffer_load_dwordx4 v79, s[52:55], s64 offen lds
    ds_read_b64_tr_b16 a[240:241], v72 offset:4096
    ds_read_b64_tr_b16 a[242:243], v72 offset:4608
    ds_read_b64_tr_b16 a[244:245], v73 offset:4096
    ds_read_b64_tr_b16 a[246:247], v73 offset:4608
    ds_read_b64_tr_b16 a[248:249], v74 offset:4096
    ds_read_b64_tr_b16 a[250:251], v74 offset:4608
    ds_read_b64_tr_b16 a[252:253], v75 offset:4096
    ds_read_b64_tr_b16 a[254:255], v75 offset:4608
    s_waitcnt lgkmcnt(0)
    s_waitcnt vmcnt(28)
    s_barrier
    s_add_u32 m0, s40, 4096
    s_add_u32 s64, s72, 0x180000
    buffer_load_dwordx4 v76, s[52:55], s64 offen lds
    s_add_u32 m0, s40, 5120
    s_add_u32 s64, s72, 0x188000
    buffer_load_dwordx4 v77, s[52:55], s64 offen lds
    s_add_u32 m0, s40, 6144
    s_add_u32 s64, s72, 0x190000
    buffer_load_dwordx4 v78, s[52:55], s64 offen lds
    s_add_u32 m0, s40, 7168
    s_add_u32 s64, s72, 0x198000
    buffer_load_dwordx4 v79, s[52:55], s64 offen lds
    ds_read_b64_tr_b16 a[0:1], v72 offset:8192
    ds_read_b64_tr_b16 a[2:3], v72 offset:8704
    ds_read_b64_tr_b16 a[4:5], v73 offset:8192
    ds_read_b64_tr_b16 a[6:7], v73 offset:8704
    ds_read_b64_tr_b16 a[8:9], v74 offset:8192
    ds_read_b64_tr_b16 a[10:11], v74 offset:8704
    ds_read_b64_tr_b16 a[12:13], v75 offset:8192
    ds_read_b64_tr_b16 a[14:15], v75 offset:8704
    s_waitcnt lgkmcnt(0)
    s_waitcnt vmcnt(28)
    s_barrier
    s_add_u32 m0, s40, 8192
    s_add_u32 s64, s72, 0x200000
    buffer_load_dwordx4 v76, s[52:55], s64 offen lds
    s_add_u32 m0, s40, 9216
    s_add_u32 s64, s72, 0x208000
    buffer_load_dwordx4 v77, s[52:55], s64 offen lds
    s_add_u32 m0, s40, 10240
    s_add_u32 s64, s72, 0x210000
    buffer_load_dwordx4 v78, s[52:55], s64 offen lds
    s_add_u32 m0, s40, 11264
    s_add_u32 s64, s72, 0x218000
    buffer_load_dwordx4 v79, s[52:55], s64 offen lds
    ds_read_b64_tr_b16 a[16:17], v72 offset:12288
    ds_read_b64_tr_b16 a[18:19], v72 offset:12800
    ds_read_b64_tr_b16 a[20:21], v73 offset:12288
    ds_read_b64_tr_b16 a[22:23], v73 offset:12800
    ds_read_b64_tr_b16 a[24:25], v74 offset:12288
    ds_read_b64_tr_b16 a[26:27], v74 offset:12800
    ds_read_b64_tr_b16 a[28:29], v75 offset:12288
    ds_read_b64_tr_b16 a[30:31], v75 offset:12800
    s_waitcnt lgkmcnt(0)
    s_waitcnt vmcnt(28)
    s_barrier
    s_add_u32 m0, s40, 12288
    s_add_u32 s64, s39, 0x0
    buffer_load_dwordx4 v89, s[56:59], s64 offen lds
    s_add_u32 m0, s40, 13312
    s_add_u32 s64, s39, 0x5000
    buffer_load_dwordx4 v89, s[56:59], s64 offen lds
    s_add_u32 m0, s40, 14336
    s_add_u32 s64, s39, 0xa000
    buffer_load_dwordx4 v89, s[56:59], s64 offen lds
    s_add_u32 m0, s40, 15360
    s_add_u32 s64, s39, 0xf000
    buffer_load_dwordx4 v89, s[56:59], s64 offen lds
    ds_read_b64_tr_b16 a[32:33], v72 offset:16384
    ds_read_b64_tr_b16 a[34:35], v72 offset:16896
    ds_read_b64_tr_b16 a[36:37], v73 offset:16384
    ds_read_b64_tr_b16 a[38:39], v73 offset:16896
    ds_read_b64_tr_b16 a[40:41], v74 offset:16384
    ds_read_b64_tr_b16 a[42:43], v74 offset:16896
    ds_read_b64_tr_b16 a[44:45], v75 offset:16384
    ds_read_b64_tr_b16 a[46:47], v75 offset:16896
    s_waitcnt lgkmcnt(0)
    s_waitcnt vmcnt(28)
    s_barrier
    s_add_u32 m0, s40, 16384
    s_add_u32 s64, s39, 0x14000
    buffer_load_dwordx4 v89, s[56:59], s64 offen lds
    s_add_u32 m0, s40, 17408
    s_add_u32 s64, s39, 0x19000
    buffer_load_dwordx4 v89, s[56:59], s64 offen lds
    s_add_u32 m0, s40, 18432
    s_add_u32 s64, s39, 0x1e000
    buffer_load_dwordx4 v89, s[56:59], s64 offen lds
    s_add_u32 m0, s40, 19456
    s_add_u32 s64, s39, 0x23000
    buffer_load_dwordx4 v89, s[56:59], s64 offen lds
    ds_read_b64_tr_b16 a[48:49], v72 offset:20480
    ds_read_b64_tr_b16 a[50:51], v72 offset:20992
    ds_read_b64_tr_b16 a[52:53], v73 offset:20480
    ds_read_b64_tr_b16 a[54:55], v73 offset:20992
    ds_read_b64_tr_b16 a[56:57], v74 offset:20480
    ds_read_b64_tr_b16 a[58:59], v74 offset:20992
    ds_read_b64_tr_b16 a[60:61], v75 offset:20480
    ds_read_b64_tr_b16 a[62:63], v75 offset:20992
    s_waitcnt lgkmcnt(0)
    s_waitcnt vmcnt(28)
    s_barrier
    s_add_u32 m0, s40, 20480
    s_add_u32 s64, s39, 0x100
    buffer_load_dwordx4 v89, s[56:59], s64 offen lds
    s_add_u32 m0, s40, 21504
    s_add_u32 s64, s39, 0x5100
    buffer_load_dwordx4 v89, s[56:59], s64 offen lds
    s_add_u32 m0, s40, 22528
    s_add_u32 s64, s39, 0xa100
    buffer_load_dwordx4 v89, s[56:59], s64 offen lds
    s_add_u32 m0, s40, 23552
    s_add_u32 s64, s39, 0xf100
    buffer_load_dwordx4 v89, s[56:59], s64 offen lds
    ds_read_b64_tr_b16 a[64:65], v72 offset:24576
    ds_read_b64_tr_b16 a[66:67], v72 offset:25088
    ds_read_b64_tr_b16 a[68:69], v73 offset:24576
    ds_read_b64_tr_b16 a[70:71], v73 offset:25088
    ds_read_b64_tr_b16 a[72:73], v74 offset:24576
    ds_read_b64_tr_b16 a[74:75], v74 offset:25088
    ds_read_b64_tr_b16 a[76:77], v75 offset:24576
    ds_read_b64_tr_b16 a[78:79], v75 offset:25088
    s_waitcnt lgkmcnt(0)
    s_waitcnt vmcnt(28)
    s_barrier
    s_add_u32 m0, s40, 24576
    s_add_u32 s64, s39, 0x14100
    buffer_load_dwordx4 v89, s[56:59], s64 offen lds
    s_add_u32 m0, s40, 25600
    s_add_u32 s64, s39, 0x19100
    buffer_load_dwordx4 v89, s[56:59], s64 offen lds
    s_add_u32 m0, s40, 26624
    s_add_u32 s64, s39, 0x1e100
    buffer_load_dwordx4 v89, s[56:59], s64 offen lds
    s_add_u32 m0, s40, 27648
    s_add_u32 s64, s39, 0x23100
    buffer_load_dwordx4 v89, s[56:59], s64 offen lds
    ds_read_b64_tr_b16 a[80:81], v72 offset:28672
    ds_read_b64_tr_b16 a[82:83], v72 offset:29184
    ds_read_b64_tr_b16 a[84:85], v73 offset:28672
    ds_read_b64_tr_b16 a[86:87], v73 offset:29184
    ds_read_b64_tr_b16 a[88:89], v74 offset:28672
    ds_read_b64_tr_b16 a[90:91], v74 offset:29184
    ds_read_b64_tr_b16 a[92:93], v75 offset:28672
    ds_read_b64_tr_b16 a[94:95], v75 offset:29184
    s_waitcnt lgkmcnt(0)
    s_waitcnt vmcnt(28)
    s_barrier
    s_add_u32 m0, s40, 28672
    s_add_u32 s64, s41, 0x0
    buffer_load_dwordx4 v90, s[56:59], s64 offen lds
    s_add_u32 m0, s40, 29696
    s_add_u32 s64, s41, 0xa000
    buffer_load_dwordx4 v90, s[56:59], s64 offen lds
    s_add_u32 m0, s40, 30720
    s_add_u32 s64, s41, 0x14000
    buffer_load_dwordx4 v90, s[56:59], s64 offen lds
    s_add_u32 m0, s40, 31744
    s_add_u32 s64, s41, 0x1e000
    buffer_load_dwordx4 v90, s[56:59], s64 offen lds
    ds_read_b64_tr_b16 a[96:97], v72 offset:32768
    ds_read_b64_tr_b16 a[98:99], v72 offset:33280
    ds_read_b64_tr_b16 a[100:101], v73 offset:32768
    ds_read_b64_tr_b16 a[102:103], v73 offset:33280
    ds_read_b64_tr_b16 a[104:105], v74 offset:32768
    ds_read_b64_tr_b16 a[106:107], v74 offset:33280
    ds_read_b64_tr_b16 a[108:109], v75 offset:32768
    ds_read_b64_tr_b16 a[110:111], v75 offset:33280
    s_waitcnt lgkmcnt(0)
    s_waitcnt vmcnt(28)
    s_barrier
    s_add_u32 m0, s40, 32768
    s_add_u32 s64, s72, 0x180000
    buffer_load_dwordx4 v76, s[48:51], s64 offen lds
    s_add_u32 m0, s40, 33792
    s_add_u32 s64, s72, 0x188000
    buffer_load_dwordx4 v77, s[48:51], s64 offen lds
    s_add_u32 m0, s40, 34816
    s_add_u32 s64, s72, 0x190000
    buffer_load_dwordx4 v78, s[48:51], s64 offen lds
    s_add_u32 m0, s40, 35840
    s_add_u32 s64, s72, 0x198000
    buffer_load_dwordx4 v79, s[48:51], s64 offen lds
    v_lshlrev_b32 v80, 2, v0
    buffer_load_dword v81, v80, s[60:63], 0 offen sc1
    ds_read_b64_tr_b16 a[112:113], v72 offset:0
    ds_read_b64_tr_b16 a[114:115], v72 offset:512
    ds_read_b64_tr_b16 a[116:117], v73 offset:0
    ds_read_b64_tr_b16 a[118:119], v73 offset:512
    ds_read_b64_tr_b16 a[120:121], v74 offset:0
    ds_read_b64_tr_b16 a[122:123], v74 offset:512
    ds_read_b64_tr_b16 a[124:125], v75 offset:0
    ds_read_b64_tr_b16 a[126:127], v75 offset:512
    s_waitcnt lgkmcnt(0)
    s_waitcnt vmcnt(29)
    s_barrier
    s_add_u32 m0, s40, 0
    s_add_u32 s64, s71, 0x0
    buffer_load_dwordx4 v76, s[48:51], s64 offen lds
    s_add_u32 m0, s40, 1024
    s_add_u32 s64, s71, 0x8000
    buffer_load_dwordx4 v77, s[48:51], s64 offen lds
    s_add_u32 m0, s40, 2048
    s_add_u32 s64, s71, 0x10000
    buffer_load_dwordx4 v78, s[48:51], s64 offen lds
    s_add_u32 m0, s40, 3072
    s_add_u32 s64, s71, 0x18000
    buffer_load_dwordx4 v79, s[48:51], s64 offen lds
    ds_read_b64_tr_b16 a[128:129], v72 offset:4096
    ds_read_b64_tr_b16 a[130:131], v72 offset:4608
    ds_read_b64_tr_b16 a[132:133], v73 offset:4096
    ds_read_b64_tr_b16 a[134:135], v73 offset:4608
    ds_read_b64_tr_b16 a[136:137], v74 offset:4096
    ds_read_b64_tr_b16 a[138:139], v74 offset:4608
    ds_read_b64_tr_b16 a[140:141], v75 offset:4096
    ds_read_b64_tr_b16 a[142:143], v75 offset:4608
    s_waitcnt lgkmcnt(0)
    s_waitcnt vmcnt(29)
    s_barrier
    s_add_u32 m0, s40, 4096
    s_add_u32 s64, s71, 0x80000
    buffer_load_dwordx4 v76, s[48:51], s64 offen lds
    s_add_u32 m0, s40, 5120
    s_add_u32 s64, s71, 0x88000
    buffer_load_dwordx4 v77, s[48:51], s64 offen lds
    s_add_u32 m0, s40, 6144
    s_add_u32 s64, s71, 0x90000
    buffer_load_dwordx4 v78, s[48:51], s64 offen lds
    s_add_u32 m0, s40, 7168
    s_add_u32 s64, s71, 0x98000
    buffer_load_dwordx4 v79, s[48:51], s64 offen lds
    ds_read_b64_tr_b16 a[144:145], v72 offset:8192
    ds_read_b64_tr_b16 a[146:147], v72 offset:8704
    ds_read_b64_tr_b16 a[148:149], v73 offset:8192
    ds_read_b64_tr_b16 a[150:151], v73 offset:8704
    ds_read_b64_tr_b16 a[152:153], v74 offset:8192
    ds_read_b64_tr_b16 a[154:155], v74 offset:8704
    ds_read_b64_tr_b16 a[156:157], v75 offset:8192
    ds_read_b64_tr_b16 a[158:159], v75 offset:8704
    s_waitcnt lgkmcnt(0)
    s_waitcnt vmcnt(29)
    s_barrier
    s_add_u32 m0, s40, 8192
    s_add_u32 s64, s71, 0x100000
    buffer_load_dwordx4 v76, s[48:51], s64 offen lds
    s_add_u32 m0, s40, 9216
    s_add_u32 s64, s71, 0x108000
    buffer_load_dwordx4 v77, s[48:51], s64 offen lds
    s_add_u32 m0, s40, 10240
    s_add_u32 s64, s71, 0x110000
    buffer_load_dwordx4 v78, s[48:51], s64 offen lds
    s_add_u32 m0, s40, 11264
    s_add_u32 s64, s71, 0x118000
    buffer_load_dwordx4 v79, s[48:51], s64 offen lds
    ds_read_b64_tr_b16 a[160:161], v93 offset:12288
    ds_read_b64_tr_b16 a[162:163], v93 offset:12544
    ds_read_b64_tr_b16 a[164:165], v93 offset:13312
    ds_read_b64_tr_b16 a[166:167], v93 offset:13568
    ds_read_b64_tr_b16 a[168:169], v93 offset:14336
    ds_read_b64_tr_b16 a[170:171], v93 offset:14592
    ds_read_b64_tr_b16 a[172:173], v93 offset:15360
    ds_read_b64_tr_b16 a[174:175], v93 offset:15616
    s_waitcnt lgkmcnt(0)
    s_waitcnt vmcnt(29)
    s_barrier
    s_add_u32 m0, s40, 12288
    s_add_u32 s64, s71, 0x180000
    buffer_load_dwordx4 v76, s[48:51], s64 offen lds
    s_add_u32 m0, s40, 13312
    s_add_u32 s64, s71, 0x188000
    buffer_load_dwordx4 v77, s[48:51], s64 offen lds
    s_add_u32 m0, s40, 14336
    s_add_u32 s64, s71, 0x190000
    buffer_load_dwordx4 v78, s[48:51], s64 offen lds
    s_add_u32 m0, s40, 15360
    s_add_u32 s64, s71, 0x198000
    buffer_load_dwordx4 v79, s[48:51], s64 offen lds
    ds_read_b64_tr_b16 a[176:177], v93 offset:16384
    ds_read_b64_tr_b16 a[178:179], v93 offset:16640
    ds_read_b64_tr_b16 a[180:181], v93 offset:17408
    ds_read_b64_tr_b16 a[182:183], v93 offset:17664
    ds_read_b64_tr_b16 a[184:185], v93 offset:18432
    ds_read_b64_tr_b16 a[186:187], v93 offset:18688
    ds_read_b64_tr_b16 a[188:189], v93 offset:19456
    ds_read_b64_tr_b16 a[190:191], v93 offset:19712
    s_waitcnt lgkmcnt(0)
    s_waitcnt vmcnt(29)
    s_barrier
    s_add_u32 m0, s40, 16384
    s_add_u32 s64, s71, 0x200000
    buffer_load_dwordx4 v76, s[48:51], s64 offen lds
    s_add_u32 m0, s40, 17408
    s_add_u32 s64, s71, 0x208000
    buffer_load_dwordx4 v77, s[48:51], s64 offen lds
    s_add_u32 m0, s40, 18432
    s_add_u32 s64, s71, 0x210000
    buffer_load_dwordx4 v78, s[48:51], s64 offen lds
    s_add_u32 m0, s40, 19456
    s_add_u32 s64, s71, 0x218000
    buffer_load_dwordx4 v79, s[48:51], s64 offen lds
    ds_read_b64_tr_b16 a[192:193], v93 offset:20480
    ds_read_b64_tr_b16 a[194:195], v93 offset:20736
    ds_read_b64_tr_b16 a[196:197], v93 offset:21504
    ds_read_b64_tr_b16 a[198:199], v93 offset:21760
    ds_read_b64_tr_b16 a[200:201], v93 offset:22528
    ds_read_b64_tr_b16 a[202:203], v93 offset:22784
    ds_read_b64_tr_b16 a[204:205], v93 offset:23552
    ds_read_b64_tr_b16 a[206:207], v93 offset:23808
    s_waitcnt lgkmcnt(0)
    s_waitcnt vmcnt(29)
    s_barrier
    s_add_u32 m0, s40, 20480
    s_add_u32 s64, s72, 0x0
    buffer_load_dwordx4 v76, s[48:51], s64 offen lds
    s_add_u32 m0, s40, 21504
    s_add_u32 s64, s72, 0x8000
    buffer_load_dwordx4 v77, s[48:51], s64 offen lds
    s_add_u32 m0, s40, 22528
    s_add_u32 s64, s72, 0x10000
    buffer_load_dwordx4 v78, s[48:51], s64 offen lds
    s_add_u32 m0, s40, 23552
    s_add_u32 s64, s72, 0x18000
    buffer_load_dwordx4 v79, s[48:51], s64 offen lds
    ds_read_b64_tr_b16 a[208:209], v93 offset:24576
    ds_read_b64_tr_b16 a[210:211], v93 offset:24832
    ds_read_b64_tr_b16 a[212:213], v93 offset:25600
    ds_read_b64_tr_b16 a[214:215], v93 offset:25856
    ds_read_b64_tr_b16 a[216:217], v93 offset:26624
    ds_read_b64_tr_b16 a[218:219], v93 offset:26880
    ds_read_b64_tr_b16 a[220:221], v93 offset:27648
    ds_read_b64_tr_b16 a[222:223], v93 offset:27904
    s_waitcnt lgkmcnt(0)
    s_waitcnt vmcnt(29)
    s_barrier
    s_add_u32 m0, s40, 24576
    s_add_u32 s64, s72, 0x80000
    buffer_load_dwordx4 v76, s[48:51], s64 offen lds
    s_add_u32 m0, s40, 25600
    s_add_u32 s64, s72, 0x88000
    buffer_load_dwordx4 v77, s[48:51], s64 offen lds
    s_add_u32 m0, s40, 26624
    s_add_u32 s64, s72, 0x90000
    buffer_load_dwordx4 v78, s[48:51], s64 offen lds
    s_add_u32 m0, s40, 27648
    s_add_u32 s64, s72, 0x98000
    buffer_load_dwordx4 v79, s[48:51], s64 offen lds
    ds_read_b64_tr_b16 a[224:225], v94 offset:28672
    ds_read_b64_tr_b16 a[226:227], v94 offset:28800
    ds_read_b64_tr_b16 a[228:229], v94 offset:29696
    ds_read_b64_tr_b16 a[230:231], v94 offset:29824
    ds_read_b64_tr_b16 a[232:233], v94 offset:30720
    ds_read_b64_tr_b16 a[234:235], v94 offset:30848
    ds_read_b64_tr_b16 a[236:237], v94 offset:31744
    ds_read_b64_tr_b16 a[238:239], v94 offset:31872
    s_waitcnt lgkmcnt(0)
    s_waitcnt vmcnt(29)
    s_barrier
    s_add_u32 m0, s40, 28672
    s_add_u32 s64, s72, 0x100000
    buffer_load_dwordx4 v76, s[48:51], s64 offen lds
    s_add_u32 m0, s40, 29696
    s_add_u32 s64, s72, 0x108000
    buffer_load_dwordx4 v77, s[48:51], s64 offen lds
    s_add_u32 m0, s40, 30720
    s_add_u32 s64, s72, 0x110000
    buffer_load_dwordx4 v78, s[48:51], s64 offen lds
    s_add_u32 m0, s40, 31744
    s_add_u32 s64, s72, 0x118000
    buffer_load_dwordx4 v79, s[48:51], s64 offen lds
    s_mov_b32 s65, 0x290800
    buffer_load_dword v84, off, s[4:7], s65 sc1
    buffer_load_dwordx2 v[82:83], off, s[4:7], s69 sc1
    ds_read_b64_tr_b16 v[12:13], v72 offset:32768
    ds_read_b64_tr_b16 v[14:15], v72 offset:33280
    ds_read_b64_tr_b16 v[16:17], v73 offset:32768
    ds_read_b64_tr_b16 v[18:19], v73 offset:33280
    ds_read_b64_tr_b16 v[20:21], v74 offset:32768
    ds_read_b64_tr_b16 v[22:23], v74 offset:33280
    ds_read_b64_tr_b16 v[24:25], v75 offset:32768
    ds_read_b64_tr_b16 v[26:27], v75 offset:33280
    s_waitcnt lgkmcnt(0)
    s_barrier
    ds_write_b128 v2, v[12:15] offset:32768
    ds_write_b128 v2, v[16:19] offset:33792
    ds_write_b128 v2, v[20:23] offset:34816
    ds_write_b128 v2, v[24:27] offset:35840
    s_waitcnt lgkmcnt(0)
    s_waitcnt vmcnt(30)
    s_barrier
    ds_read_b64_tr_b16 v[12:13], v72 offset:0
    ds_read_b64_tr_b16 v[14:15], v72 offset:512
    ds_read_b64_tr_b16 v[16:17], v73 offset:0
    ds_read_b64_tr_b16 v[18:19], v73 offset:512
    ds_read_b64_tr_b16 v[20:21], v74 offset:0
    ds_read_b64_tr_b16 v[22:23], v74 offset:512
    ds_read_b64_tr_b16 v[24:25], v75 offset:0
    ds_read_b64_tr_b16 v[26:27], v75 offset:512
    s_waitcnt lgkmcnt(0)
    s_barrier
    ds_write_b128 v2, v[12:15] offset:0
    ds_write_b128 v2, v[16:19] offset:1024
    ds_write_b128 v2, v[20:23] offset:2048
    ds_write_b128 v2, v[24:27] offset:3072
    s_waitcnt lgkmcnt(0)
    s_waitcnt vmcnt(26)
    s_barrier
    ds_read_b64_tr_b16 v[12:13], v72 offset:4096
    ds_read_b64_tr_b16 v[14:15], v72 offset:4608
    ds_read_b64_tr_b16 v[16:17], v73 offset:4096
    ds_read_b64_tr_b16 v[18:19], v73 offset:4608
    ds_read_b64_tr_b16 v[20:21], v74 offset:4096
    ds_read_b64_tr_b16 v[22:23], v74 offset:4608
    ds_read_b64_tr_b16 v[24:25], v75 offset:4096
    ds_read_b64_tr_b16 v[26:27], v75 offset:4608
    s_waitcnt lgkmcnt(0)
    s_barrier
    ds_write_b128 v2, v[12:15] offset:4096
    ds_write_b128 v2, v[16:19] offset:5120
    ds_write_b128 v2, v[20:23] offset:6144
    ds_write_b128 v2, v[24:27] offset:7168
    s_waitcnt lgkmcnt(0)
    s_waitcnt vmcnt(22)
    s_barrier
    ds_read_b64_tr_b16 v[12:13], v72 offset:8192
    ds_read_b64_tr_b16 v[14:15], v72 offset:8704
    ds_read_b64_tr_b16 v[16:17], v73 offset:8192
    ds_read_b64_tr_b16 v[18:19], v73 offset:8704
    ds_read_b64_tr_b16 v[20:21], v74 offset:8192
    ds_read_b64_tr_b16 v[22:23], v74 offset:8704
    ds_read_b64_tr_b16 v[24:25], v75 offset:8192
    ds_read_b64_tr_b16 v[26:27], v75 offset:8704
    s_waitcnt lgkmcnt(0)
    s_barrier
    ds_write_b128 v2, v[12:15] offset:8192
    ds_write_b128 v2, v[16:19] offset:9216
    ds_write_b128 v2, v[20:23] offset:10240
    ds_write_b128 v2, v[24:27] offset:11264
    s_waitcnt lgkmcnt(0)
    s_waitcnt vmcnt(18)
    s_barrier
    ds_read_b64_tr_b16 v[12:13], v72 offset:12288
    ds_read_b64_tr_b16 v[14:15], v72 offset:12800
    ds_read_b64_tr_b16 v[16:17], v73 offset:12288
    ds_read_b64_tr_b16 v[18:19], v73 offset:12800
    ds_read_b64_tr_b16 v[20:21], v74 offset:12288
    ds_read_b64_tr_b16 v[22:23], v74 offset:12800
    ds_read_b64_tr_b16 v[24:25], v75 offset:12288
    ds_read_b64_tr_b16 v[26:27], v75 offset:12800
    s_waitcnt lgkmcnt(0)
    s_barrier
    ds_write_b128 v2, v[12:15] offset:12288
    ds_write_b128 v2, v[16:19] offset:13312
    ds_write_b128 v2, v[20:23] offset:14336
    ds_write_b128 v2, v[24:27] offset:15360
    s_waitcnt lgkmcnt(0)
    s_waitcnt vmcnt(14)
    s_barrier
    ds_read_b64_tr_b16 v[12:13], v72 offset:16384
    ds_read_b64_tr_b16 v[14:15], v72 offset:16896
    ds_read_b64_tr_b16 v[16:17], v73 offset:16384
    ds_read_b64_tr_b16 v[18:19], v73 offset:16896
    ds_read_b64_tr_b16 v[20:21], v74 offset:16384
    ds_read_b64_tr_b16 v[22:23], v74 offset:16896
    ds_read_b64_tr_b16 v[24:25], v75 offset:16384
    ds_read_b64_tr_b16 v[26:27], v75 offset:16896
    s_waitcnt lgkmcnt(0)
    s_barrier
    ds_write_b128 v2, v[12:15] offset:16384
    ds_write_b128 v2, v[16:19] offset:17408
    ds_write_b128 v2, v[20:23] offset:18432
    ds_write_b128 v2, v[24:27] offset:19456
    s_waitcnt lgkmcnt(0)
    s_waitcnt vmcnt(10)
    s_barrier
    ds_read_b64_tr_b16 v[12:13], v72 offset:20480
    ds_read_b64_tr_b16 v[14:15], v72 offset:20992
    ds_read_b64_tr_b16 v[16:17], v73 offset:20480
    ds_read_b64_tr_b16 v[18:19], v73 offset:20992
    ds_read_b64_tr_b16 v[20:21], v74 offset:20480
    ds_read_b64_tr_b16 v[22:23], v74 offset:20992
    ds_read_b64_tr_b16 v[24:25], v75 offset:20480
    ds_read_b64_tr_b16 v[26:27], v75 offset:20992
    s_waitcnt lgkmcnt(0)
    s_barrier
    ds_write_b128 v2, v[12:15] offset:20480
    ds_write_b128 v2, v[16:19] offset:21504
    ds_write_b128 v2, v[20:23] offset:22528
    ds_write_b128 v2, v[24:27] offset:23552
    s_waitcnt lgkmcnt(0)
    s_waitcnt vmcnt(6)
    s_barrier
    ds_read_b64_tr_b16 v[12:13], v72 offset:24576
    ds_read_b64_tr_b16 v[14:15], v72 offset:25088
    ds_read_b64_tr_b16 v[16:17], v73 offset:24576
    ds_read_b64_tr_b16 v[18:19], v73 offset:25088
    ds_read_b64_tr_b16 v[20:21], v74 offset:24576
    ds_read_b64_tr_b16 v[22:23], v74 offset:25088
    ds_read_b64_tr_b16 v[24:25], v75 offset:24576
    ds_read_b64_tr_b16 v[26:27], v75 offset:25088
    s_waitcnt lgkmcnt(0)
    s_barrier
    ds_write_b128 v2, v[12:15] offset:24576
    ds_write_b128 v2, v[16:19] offset:25600
    ds_write_b128 v2, v[20:23] offset:26624
    ds_write_b128 v2, v[24:27] offset:27648
    s_waitcnt lgkmcnt(0)
    s_waitcnt vmcnt(2)
    s_barrier
    ds_read_b64_tr_b16 v[12:13], v72 offset:28672
    ds_read_b64_tr_b16 v[14:15], v72 offset:29184
    ds_read_b64_tr_b16 v[16:17], v73 offset:28672
    ds_read_b64_tr_b16 v[18:19], v73 offset:29184
    ds_read_b64_tr_b16 v[20:21], v74 offset:28672
    ds_read_b64_tr_b16 v[22:23], v74 offset:29184
    ds_read_b64_tr_b16 v[24:25], v75 offset:28672
    ds_read_b64_tr_b16 v[26:27], v75 offset:29184
    s_waitcnt lgkmcnt(0)
    s_barrier
    ds_write_b128 v2, v[12:15] offset:28672
    ds_write_b128 v2, v[16:19] offset:29696
    ds_write_b128 v2, v[20:23] offset:30720
    ds_write_b128 v2, v[24:27] offset:31744
    s_waitcnt lgkmcnt(0)
    s_waitcnt vmcnt(0)
    s_cmp_lg_u32 s97, 0
    s_cbranch_scc1 NOTEARLY_8
    v_cmp_ne_u32 vcc, 32, v81
    v_readlane_b32 s64, v81, 1
    v_readlane_b32 s66, v81, 33
    v_readlane_b32 s67, v81, 34
    s_and_b32 s65, vcc_lo, 0x01010101
    s_cbranch_scc1 NOTEARLY_8
    s_and_b32 s65, vcc_hi, 0x01010101
    s_cbranch_scc1 NOTEARLY_8
    s_cmp_lt_u32 s64, 186
    s_cbranch_scc1 NOTEARLY_8
    v_readfirstlane_b32 s64, v84
    s_cmp_lt_u32 s64, 192
    s_cbranch_scc1 NOTEARLY_8
    s_min_u32 s65, s66, s67
    s_cmp_eq_u32 s65, 0
    s_cbranch_scc1 NOTEARLY_8
    v_readlane_b32 s64, v81, 6
    v_readlane_b32 s65, v81, 7
    s_and_b32 s64, s64, s65
    s_cmp_eq_u32 s64, -1
    s_cselect_b32 s64, 0, s94
    s_cmp_lg_u32 s64, 0
    s_cbranch_scc1 M_GFAIL
    s_sub_u32 s66, s66, 1
    s_sub_u32 s67, s67, 1
    s_branch EARLY_7
NOTEARLY_8:
    s_cmp_lg_u32 s97, 0
    s_cbranch_scc1 CM_9
    v_mbcnt_lo_u32_b32 v0, -1, 0
    v_mbcnt_hi_u32_b32 v0, -1, v0
    v_mul_u32_u24 v8, 32, v0
    s_mov_b32 s64, 0x0
    s_mov_b32 s65, 0
    s_mov_b64 exec, 0xff
TK_10:
    buffer_load_dword v9, v8, s[60:63], s64 offen sc1
    s_add_u32 s65, s65, 1
    s_waitcnt vmcnt(0)
    s_mov_b32 s66, 0
    v_readlane_b32 s67, v9, 0
    s_add_u32 s66, s66, s67
    v_readlane_b32 s67, v9, 1
    s_add_u32 s66, s66, s67
    v_readlane_b32 s67, v9, 2
    s_add_u32 s66, s66, s67
    v_readlane_b32 s67, v9, 3
    s_add_u32 s66, s66, s67
    v_readlane_b32 s67, v9, 4
    s_add_u32 s66, s66, s67
    v_readlane_b32 s67, v9, 5
    s_add_u32 s66, s66, s67
    v_readlane_b32 s67, v9, 6
    s_add_u32 s66, s66, s67
    v_readlane_b32 s67, v9, 7
    s_add_u32 s66, s66, s67
    s_cmp_ge_u32 s66, 256
    s_cbranch_scc1 TKD_11
    s_cmp_gt_u32 s65, 262144
    s_cbranch_scc0 TK_10
TKD_11:
    v_cmp_ne_u32 vcc, 32, v9
    s_mov_b64 exec, -1
    s_cbranch_vccnz M_SLOW
CM_9:
    s_mov_b32 s65, 0
RI_12:
    buffer_load_dword v8, off, s[60:63], s95 sc1
    s_add_u32 s65, s65, 1
    s_waitcnt vmcnt(0)
    v_readfirstlane_b32 s64, v8
    s_cmp_ge_u32 s64, 186
    s_cbranch_scc1 RID_13
    s_cmp_gt_u32 s65, 65536
    s_cbranch_scc1 RID_13
    s_sleep 4
    s_branch RI_12
RID_13:
    s_mov_b32 s65, 0
    s_mov_b32 s66, 0x290800
RB_14:
    buffer_load_dword v8, off, s[4:7], s66 sc1
    s_add_u32 s65, s65, 1
    s_waitcnt vmcnt(0)
    v_readfirstlane_b32 s64, v8
    s_cmp_ge_u32 s64, 192
    s_cbranch_scc1 RBD_15
    s_cmp_gt_u32 s65, 65536
    s_cbranch_scc1 RBD_15
    s_sleep 8
    s_branch RB_14
RBD_15:
    s_cmp_eq_u32 s94, 0
    s_cbranch_scc1 GOK_16
    buffer_load_dwordx2 v[8:9], off, s[60:63], 0 offset:24 sc1
    s_waitcnt vmcnt(0)
    v_and_b32 v8, v8, v9
    s_nop 0
    v_readfirstlane_b32 s64, v8
    s_cmp_lg_u32 s64, -1
    s_cbranch_scc1 M_GFAIL
GOK_16:
    s_mov_b32 s65, 0
CW_17:
    buffer_load_dwordx2 v[8:9], off, s[60:63], 0 offset:132 sc1
    s_add_u32 s65, s65, 1
    s_waitcnt vmcnt(0)
    v_readfirstlane_b32 s66, v8
    v_readfirstlane_b32 s67, v9
    s_min_u32 s64, s66, s67
    s_cmp_lg_u32 s64, 0
    s_cbranch_scc1 CWD_18
    s_cmp_gt_u32 s65, 65536
    s_cbranch_scc1 CWD_18
    s_sleep 4
    s_branch CW_17
CWD_18:
    s_sub_u32 s66, s66, 1
    s_and_b32 s66, s66, 3
    s_sub_u32 s67, s67, 1
    s_and_b32 s67, s67, 3
EARLY_7:
    s_mov_b32 s56, s66
    s_mov_b32 s57, s67
    s_mov_b32 s38, 0x3f80
    s_mov_b32 s53, 0
    s_cmp_eq_u32 s14, 2
    s_cselect_b32 s52, 1024, 0
    s_cmp_eq_u32 s14, 3
    s_cselect_b32 s58, 0, 1
    s_mov_b32 s59, 0
    s_cmp_eq_u32 s12, 0
    s_cselect_b32 s55, 2, 0
    s_mov_b32 s44, 0x3030303
    s_mov_b32 s45, 0x3030303
    s_mov_b32 s46, 0xc0c0c0c
    s_mov_b32 s47, 0xc0c0c0c
    s_mov_b32 s48, 0x30303030
    s_mov_b32 s49, 0x30303030
    s_mov_b32 s50, 0xc0c0c0c0
    s_mov_b32 s51, 0xc0c0c0c0
    v_and_b32 v8, 7, v0
    v_mul_u32_u24 v8, 288, v8
    v_lshrrev_b32 v9, 4, v0
    v_lshl_add_u32 v8, v9, 4, v8
    v_add_u32 v0, 12800, v8
    s_mov_b32 s68, 0
    s_mov_b32 s40, 0
    s_mov_b32 s64, s56
    s_mov_b32 s65, s57
    s_cmp_eq_u32 s12, 0
    s_cselect_b32 s66, s65, s64
    s_cselect_b32 s64, s64, s65
    s_and_b32 s64, s64, 3
    s_lshl_b32 s64, s64, 13
    s_and_b32 s66, s66, 3
    s_lshl_b32 s66, s66, 13
    s_add_u32 s21, s21, s64
    s_add_u32 s20, s20, s66
    s_cmp_eq_u32 s42, 0
    s_cselect_b32 s18, 0x40000000, s18
    s_cselect_b32 s21, 0x40000000, s21
    s_lshl_b32 s65, s12, 7
    s_add_u32 s65, s65, 0x29a000
    s_cmp_eq_u32 s22, 0
    s_cselect_b32 s22, 0x40000000, s65
    s_lshl_b32 s64, s13, 2
    s_add_u32 s64, s64, s14
    s_cmp_ge_u32 s64, 40
    s_cselect_b32 s65, 40, 0
    s_sub_u32 s64, s64, s65
    s_cmp_ge_u32 s64, 40
    s_cselect_b32 s65, 40, 0
    s_sub_u32 s64, s64, s65
    s_cmp_ge_u32 s64, 40
    s_cselect_b32 s65, 40, 0
    s_sub_u32 s64, s64, s65
    s_lshl_b32 s27, s64, 7
    s_add_u32 s19, s27, 0x4000
    v_and_b32 v82, v82, v83
    v_cmp_eq_u32 vcc, 0, v82
    s_cmp_lg_u32 s97, 0
    s_cselect_b64 vcc, -1, vcc
    s_cbranch_vccz KVOK_19
    v_mov_b32 v29, 0
FSPIN_20:
    buffer_load_dwordx2 v[12:13], v29, s[4:7], s69 offen sc1
    s_add_u32 s68, s68, 1
    s_waitcnt vmcnt(0)
    v_and_b32 v12, v12, v13
    v_cmp_eq_u32 vcc, 0, v12
    s_cbranch_vccz FDONE_21
    s_cmp_gt_u32 s68, 262144
    s_cbranch_scc0 FSPIN_20
FDONE_21:
KVOK_19:
    s_barrier
    s_mov_b32 m0, s73
    s_nop 0
    buffer_load_dwordx4 v1, s[4:7], s28 offen lds
    buffer_load_dwordx4 v1, s[4:7], s28 offen offset:1024 lds
    s_mov_b32 m0, 16128
    v_lshlrev_b32 v12, 2, v1
    s_add_u32 s65, s3, 0xfff80000
    buffer_load_dword v12, s[4:7], s65 offen lds
    s_mov_b32 s15, 0
    s_mov_b32 s16, 0
    s_add_u32 s66, s17, s52
    buffer_load_dwordx4 v[12:15], v1, s[4:7], s66 offen sc1
    buffer_load_dwordx4 v[16:19], v1, s[4:7], s17 offen offset:2048 sc1
    v_add_u32 v29, s52, v1
    s_waitcnt vmcnt(0)
    ds_write_b128 v29, v[12:15] offset:12800
    ds_write_b128 v1, v[16:19] offset:15104
    s_waitcnt lgkmcnt(0)
    v_mov_b64 v[32:33], 0
    v_mov_b64 v[34:35], 0
    v_mov_b64 v[36:37], 0
    v_mov_b64 v[38:39], 0
    v_mov_b64 v[40:41], 0
    v_mov_b64 v[42:43], 0
    v_mov_b64 v[44:45], 0
    v_mov_b64 v[46:47], 0
    v_mov_b64 v[48:49], 0
    v_mov_b64 v[50:51], 0
    v_mov_b64 v[52:53], 0
    v_mov_b64 v[54:55], 0
    v_mov_b32 v9, 0x40000000
    ds_read_b128 v[56:59], v2 offset:0
    ds_read_b128 v[60:63], v2 offset:1024
    ds_read_b128 v[64:67], v2 offset:2048
    ds_read_b128 v[68:71], v2 offset:3072
    s_cmp_eq_u32 s97, 0
    s_cbranch_scc1 REC_LOOP
    s_branch REC_LOOP_S
REC_POLL_S:
    s_cmp_eq_u32 s59, 0
    s_cbranch_scc1 NOFLG_22
    s_waitcnt vmcnt(0)
    v_lshrrev_b32 v29, 2, v1
    ds_read_b32 v12, v29 offset:15104
    s_add_u32 s64, s15, 2
    s_lshr_b32 s65, s64, 1
    s_add_u32 s67, s65, 1
    s_waitcnt lgkmcnt(0)
    v_cmp_ne_u32 vcc, 0, v12
    v_readlane_b32 s65, v12, s65
    v_readlane_b32 s67, v12, s67
    s_cmp_eq_u32 vcc_lo, -1
    s_cselect_b32 s58, 1, 0
    s_and_b32 s65, s65, s67
    s_cbranch_scc1 NOFLG_22
    s_lshl_b32 s64, s64, 7
    s_add_u32 s64, s64, s69
    v_mov_b32 v29, 0
FSPIN_24:
    buffer_load_dwordx2 v[12:13], v29, s[4:7], s64 offen sc1
    s_add_u32 s68, s68, 1
    s_waitcnt vmcnt(0)
    v_and_b32 v12, v12, v13
    v_cmp_eq_u32 vcc, 0, v12
    s_cbranch_vccz FDONE_25
    s_cmp_gt_u32 s68, 262144
    s_cbranch_scc0 FSPIN_24
FDONE_25:
NOFLG_22:
    s_add_u32 s64, s15, 3
    s_and_b32 s64, s64, 0x43
    s_or_b32 s64, s64, s58
    s_cmp_eq_u32 s64, 0
    s_cselect_b32 s59, 1, 0
    s_cmp_eq_u32 s15, 63
    s_cselect_b32 s59, s55, s59
    s_add_u32 s66, s17, s52
    v_add_u32 v10, s52, v1
    s_xor_b32 s16, s16, 1
    v_mov_b64 v[32:33], 0
    v_mov_b64 v[34:35], 0
    v_mov_b64 v[36:37], 0
    v_mov_b64 v[38:39], 0
    v_mov_b64 v[40:41], 0
    v_mov_b64 v[42:43], 0
    v_mov_b64 v[44:45], 0
    v_mov_b64 v[46:47], 0
    v_mov_b64 v[48:49], 0
    v_mov_b64 v[50:51], 0
    v_mov_b64 v[52:53], 0
    v_mov_b64 v[54:55], 0
    ds_read_b128 v[56:59], v2 offset:0
    ds_read_b128 v[60:63], v2 offset:1024
    ds_read_b128 v[64:67], v2 offset:2048
    ds_read_b128 v[68:71], v2 offset:3072
    s_barrier
    s_nop 14
    buffer_load_dwordx4 v[20:23], v1, s[4:7], s66 offen offset:0 sc1
    s_nop 7
    buffer_load_dwordx4 v[24:27], v1, s[4:7], s66 offen offset:0 sc1
    s_nop 7
    buffer_load_dwordx4 v[28:31], v1, s[4:7], s66 offen offset:0 sc1
IPOLL_27:
    s_waitcnt vmcnt(2)
    ds_write_b128 v10, v[20:23] offset:12800
    v_max3_u32 v11, v20, v21, v22
    v_max_u32 v11, v11, v23
    v_cmp_eq_u32 vcc, -1, v11
    s_cbranch_vccz IOK_26
    buffer_load_dwordx4 v[20:23], v1, s[4:7], s66 offen offset:0 sc1
    s_waitcnt vmcnt(2)
    ds_write_b128 v10, v[24:27] offset:12800
    v_max3_u32 v11, v24, v25, v26
    v_max_u32 v11, v11, v27
    v_cmp_eq_u32 vcc, -1, v11
    s_cbranch_vccz IOK_26
    buffer_load_dwordx4 v[24:27], v1, s[4:7], s66 offen offset:0 sc1
    s_waitcnt vmcnt(2)
    ds_write_b128 v10, v[28:31] offset:12800
    v_max3_u32 v11, v28, v29, v30
    v_max_u32 v11, v11, v31
    v_cmp_eq_u32 vcc, -1, v11
    s_add_u32 s68, s68, 1
    s_add_u32 s53, s53, 1
    s_cmp_gt_u32 s68, 262144
    s_cbranch_scc1 IOK_26
    s_cbranch_vccz IOK_26
    buffer_load_dwordx4 v[28:31], v1, s[4:7], s66 offen offset:0 sc1
    s_branch IPOLL_27
IOK_26:
    s_waitcnt lgkmcnt(0)
REC_LOOP_S:
    s_barrier
    ds_read_b128 v[12:15], v1 offset:12800
    ds_read_b128 v[16:19], v1 offset:13824
    buffer_load_dwordx4 v[20:23], v1, s[4:7], s17 offen offset:2048
    ds_read_b128 v[72:75], v2 offset:4096
    ds_read_b128 v[76:79], v2 offset:5120
    ds_read_b128 v[80:83], v2 offset:6144
    ds_read_b128 v[84:87], v2 offset:7168
    s_add_u32 s74, s17, 0x1000
    s_add_u32 s20, s20, 0x8000
    s_add_u32 s75, s20, 0x1000
    s_mov_b32 m0, 16128
    s_add_u32 s65, s20, s27
    s_waitcnt lgkmcnt(5)
    v_smfmac_f32_16x16x64_bf16 v[32:35], v[12:15], v[96:103], v6
    buffer_load_dwordx4 v[24:27], v1, s[4:7], s17 offen offset:3072
    v_smfmac_f32_16x16x64_bf16 v[36:39], v[12:15], v[104:111], v6
    v_smfmac_f32_16x16x64_bf16 v[40:43], v[12:15], v[56:63], v6
    buffer_load_dwordx4 v[28:31], v1, s[4:7], s74 offen offset:0
    ds_read_b128 v[56:59], v2 offset:8192
    ds_read_b128 v[60:63], v2 offset:9216
    v_smfmac_f32_16x16x64_bf16 v[44:47], v[12:15], v[64:71], v6
    ds_read_b128 v[64:67], v2 offset:10240
    ds_read_b128 v[68:71], v2 offset:11264
    s_waitcnt lgkmcnt(8)
    v_smfmac_f32_16x16x64_bf16 v[48:51], v[12:15], a[0:7], v6
    v_smfmac_f32_16x16x64_bf16 v[52:55], v[12:15], a[8:15], v6
    buffer_load_dwordx4 v[12:15], v1, s[4:7], s20 offen offset:0
    buffer_load_dword off, s[4:7], s65 lds
    v_smfmac_f32_16x16x64_bf16 v[32:35], v[16:19], v[112:119], v6
    v_smfmac_f32_16x16x64_bf16 v[36:39], v[16:19], v[120:127], v6
    s_waitcnt lgkmcnt(4)
    v_smfmac_f32_16x16x64_bf16 v[40:43], v[16:19], v[72:79], v6
    ds_read_b128 v[72:75], v2 offset:12288
    ds_read_b128 v[76:79], v2 offset:13312
    v_smfmac_f32_16x16x64_bf16 v[44:47], v[16:19], v[80:87], v6
    ds_read_b128 v[80:83], v2 offset:14336
    ds_read_b128 v[84:87], v2 offset:15360
    s_waitcnt vmcnt(4)
    v_cmp_eq_u32 vcc, -1, v23
    v_smfmac_f32_16x16x64_bf16 v[48:51], v[16:19], a[16:23], v6
    v_smfmac_f32_16x16x64_bf16 v[52:55], v[16:19], a[24:31], v6
    s_cbranch_vccnz RETRY_28
BACK_29:
    buffer_load_dwordx4 v[16:19], v1, s[4:7], s20 offen offset:1024
    v_smfmac_f32_16x16x64_bf16 v[32:35], v[20:23], v[128:135], v6
    v_smfmac_f32_16x16x64_bf16 v[36:39], v[20:23], v[136:143], v6
    s_waitcnt lgkmcnt(4)
    v_smfmac_f32_16x16x64_bf16 v[40:43], v[20:23], v[56:63], v6
    ds_read_b128 v[56:59], v2 offset:16384
    ds_read_b128 v[60:63], v2 offset:17408
    v_smfmac_f32_16x16x64_bf16 v[44:47], v[20:23], v[64:71], v6
    ds_read_b128 v[64:67], v2 offset:18432
    ds_read_b128 v[68:71], v2 offset:19456
    s_waitcnt vmcnt(4)
    v_cmp_eq_u32 vcc, -1, v27
    v_smfmac_f32_16x16x64_bf16 v[48:51], v[20:23], a[32:39], v6
    v_smfmac_f32_16x16x64_bf16 v[52:55], v[20:23], a[40:47], v6
    s_cbranch_vccnz RETRY_30
BACK_31:
    buffer_load_dwordx4 v[20:23], v1, s[4:7], s20 offen offset:2048
    v_smfmac_f32_16x16x64_bf16 v[32:35], v[24:27], v[144:151], v6
    v_smfmac_f32_16x16x64_bf16 v[36:39], v[24:27], v[152:159], v6
    s_waitcnt lgkmcnt(4)
    v_smfmac_f32_16x16x64_bf16 v[40:43], v[24:27], v[72:79], v6
    ds_read_b128 v[72:75], v2 offset:20480
    ds_read_b128 v[76:79], v2 offset:21504
    v_smfmac_f32_16x16x64_bf16 v[44:47], v[24:27], v[80:87], v6
    ds_read_b128 v[80:83], v2 offset:22528
    ds_read_b128 v[84:87], v2 offset:23552
    s_waitcnt vmcnt(4)
    v_cmp_eq_u32 vcc, -1, v31
    v_smfmac_f32_16x16x64_bf16 v[48:51], v[24:27], a[48:55], v6
    v_smfmac_f32_16x16x64_bf16 v[52:55], v[24:27], a[56:63], v6
    s_cbranch_vccnz RETRY_32
BACK_33:
    buffer_load_dwordx4 v[24:27], v1, s[4:7], s20 offen offset:3072
    v_smfmac_f32_16x16x64_bf16 v[32:35], v[28:31], v[160:167], v6
    v_smfmac_f32_16x16x64_bf16 v[36:39], v[28:31], v[168:175], v6
    s_waitcnt lgkmcnt(4)
    v_smfmac_f32_16x16x64_bf16 v[40:43], v[28:31], v[56:63], v6
    ds_read_b128 v[56:59], v2 offset:24576
    ds_read_b128 v[60:63], v2 offset:25600
    v_smfmac_f32_16x16x64_bf16 v[44:47], v[28:31], v[64:71], v6
    ds_read_b128 v[64:67], v2 offset:26624
    ds_read_b128 v[68:71], v2 offset:27648
    s_waitcnt vmcnt(4)
    v_cmp_eq_u32 vcc, -1, v15
    v_smfmac_f32_16x16x64_bf16 v[48:51], v[28:31], a[64:71], v6
    v_smfmac_f32_16x16x64_bf16 v[52:55], v[28:31], a[72:79], v6
    s_cbranch_vccnz RETRY_34
BACK_35:
    buffer_load_dwordx4 v[28:31], v1, s[4:7], s75 offen offset:0
    v_smfmac_f32_16x16x64_bf16 v[32:35], v[12:15], v[176:183], v6
    s_waitcnt vmcnt(3)
    v_cmp_eq_u32 vcc, -1, v19
    v_smfmac_f32_16x16x64_bf16 v[36:39], v[12:15], v[184:191], v6
    s_waitcnt lgkmcnt(4)
    v_smfmac_f32_16x16x64_bf16 v[40:43], v[12:15], v[72:79], v6
    ds_read_b128 v[72:75], v2 offset:28672
    ds_read_b128 v[76:79], v2 offset:29696
    v_smfmac_f32_16x16x64_bf16 v[44:47], v[12:15], v[80:87], v6
    ds_read_b128 v[80:83], v2 offset:30720
    ds_read_b128 v[84:87], v2 offset:31744
    buffer_load_dwordx4 v[88:91], v1, s[4:7], s29 offen offset:0
    s_cbranch_vccnz RETRY_36
BACK_37:
    v_smfmac_f32_16x16x64_bf16 v[32:35], v[16:19], v[192:199], v6
    s_waitcnt vmcnt(3)
    v_cmp_eq_u32 vcc, -1, v23
    v_smfmac_f32_16x16x64_bf16 v[36:39], v[16:19], v[200:207], v6
    s_waitcnt lgkmcnt(4)
    v_smfmac_f32_16x16x64_bf16 v[40:43], v[16:19], v[56:63], v6
    ds_read_b128 v[56:59], v2 offset:32768
    ds_read_b128 v[60:63], v2 offset:33792
    v_smfmac_f32_16x16x64_bf16 v[44:47], v[16:19], v[64:71], v6
    ds_read_b128 v[64:67], v2 offset:34816
    ds_read_b128 v[68:71], v2 offset:35840
    s_cbranch_vccnz RETRY_38
BACK_39:
    v_smfmac_f32_16x16x64_bf16 v[32:35], v[20:23], v[208:215], v6
    s_waitcnt vmcnt(2)
    v_cmp_eq_u32 vcc, -1, v27
    v_smfmac_f32_16x16x64_bf16 v[36:39], v[20:23], v[216:223], v6
    s_waitcnt lgkmcnt(4)
    v_smfmac_f32_16x16x64_bf16 v[40:43], v[20:23], v[72:79], v6
    ds_read_b128 v[72:75], v1 offset:0
    ds_read_b128 v[76:79], v1 offset:4096
    v_smfmac_f32_16x16x64_bf16 v[44:47], v[20:23], v[80:87], v6
    ds_read_b128 v[80:83], v1 offset:1024
    ds_read_b128 v[84:87], v1 offset:5120
    buffer_load_dwordx4 v[92:95], v1, s[4:7], s29 offen offset:1024
    s_cbranch_vccnz RETRY_40
BACK_41:
    v_smfmac_f32_16x16x64_bf16 v[32:35], v[24:27], v[224:231], v6
    s_waitcnt vmcnt(2)
    v_cmp_eq_u32 vcc, -1, v31
    v_smfmac_f32_16x16x64_bf16 v[36:39], v[24:27], v[232:239], v6
    s_waitcnt lgkmcnt(4)
    v_smfmac_f32_16x16x64_bf16 v[40:43], v[24:27], v[56:63], v6
    ds_read_b128 v[56:59], v1 offset:2048
    ds_read_b128 v[60:63], v1 offset:6144
    v_smfmac_f32_16x16x64_bf16 v[44:47], v[24:27], v[64:71], v6
    ds_read_b128 v[64:67], v1 offset:3072
    ds_read_b128 v[68:71], v1 offset:7168
    s_cbranch_vccnz RETRY_42
BACK_43:
    v_smfmac_f32_16x16x64_bf16 v[32:35], v[28:31], v[240:247], v6
    v_lshlrev_b32 v8, 2, v1
    v_smfmac_f32_16x16x64_bf16 v[36:39], v[28:31], v[248:255], v6
    s_add_u32 s65, s17, s19
    v_smfmac_f32_16x16x64_bf16 v[40:43], v[28:31], a[240:247], v6
    buffer_load_dword v8, s[4:7], s3 offen lds
    v_smfmac_f32_16x16x64_bf16 v[44:47], v[28:31], a[248:255], v6
    buffer_load_dword off, s[4:7], s65 sc1 lds
    buffer_store_dword v6, off, s[4:7], s22 sc1
    s_add_u32 s22, s22, 256
    s_cmp_lg_u32 s59, 0
    s_cbranch_scc1 KVOUT_45
KVLOOK_44:
    v_permlane32_swap_b32 v32, v36
    v_permlane32_swap_b32 v33, v37
    v_permlane32_swap_b32 v34, v38
    v_permlane32_swap_b32 v35, v39
    v_pk_add_f32 v[32:33], v[32:33], v[36:37]
    v_pk_add_f32 v[34:35], v[34:35], v[38:39]
    v_cvt_pk_bf16_f32 v36, v32, v33
    v_cvt_pk_bf16_f32 v37, v34, v35
    ds_write_b64 v3, v[36:37] offset:0
    v_permlane32_swap_b32 v40, v44
    v_permlane32_swap_b32 v41, v45
    v_permlane32_swap_b32 v42, v46
    v_permlane32_swap_b32 v43, v47
    v_pk_add_f32 v[40:41], v[40:41], v[44:45]
    v_pk_add_f32 v[42:43], v[42:43], v[46:47]
    v_cvt_pk_bf16_f32 v44, v40, v41
    v_cvt_pk_bf16_f32 v45, v42, v43
    ds_write_b64 v3, v[44:45] offset:2304
    v_smfmac_f32_16x16x64_bf16 v[48:51], v[12:15], a[80:87], v6
    v_smfmac_f32_16x16x64_bf16 v[52:55], v[12:15], a[88:95], v6
    v_smfmac_f32_16x16x64_bf16 v[48:51], v[16:19], a[96:103], v6
    v_smfmac_f32_16x16x64_bf16 v[52:55], v[16:19], a[104:111], v6
    s_waitcnt lgkmcnt(0)
    s_barrier
    ds_read_b64_tr_b16 v[32:33], v4 offset:0
    ds_read_b64_tr_b16 v[34:35], v4 offset:128
    ds_read_b64_tr_b16 v[36:37], v4 offset:256
    ds_read_b64_tr_b16 v[38:39], v4 offset:384
    s_cmp_eq_u32 s15, 63
    s_cbranch_scc1 REC_FINAL
    v_smfmac_f32_16x16x64_bf16 v[48:51], v[20:23], a[112:119], v6
    v_smfmac_f32_16x16x64_bf16 v[52:55], v[20:23], a[120:127], v6
    ds_read_b64_tr_b16 v[40:41], v4 offset:512
    ds_read_b64_tr_b16 v[42:43], v4 offset:640
    ds_read_b64_tr_b16 v[44:45], v4 offset:768
    ds_read_b64_tr_b16 v[46:47], v4 offset:896
    v_smfmac_f32_16x16x64_bf16 v[48:51], v[24:27], a[128:135], v6
    v_smfmac_f32_16x16x64_bf16 v[52:55], v[24:27], a[136:143], v6
    s_waitcnt lgkmcnt(4)
    v_mfma_f32_16x16x32_bf16 v[8:11], v[72:75], v[32:35], 0
    ds_read_b64_tr_b16 v[12:13], v4 offset:2304
    ds_read_b64_tr_b16 v[14:15], v4 offset:2432
    v_mfma_f32_16x16x32_bf16 v[8:11], v[80:83], v[36:39], v[8:11]
    ds_read_b64_tr_b16 v[16:17], v4 offset:2560
    ds_read_b64_tr_b16 v[18:19], v4 offset:2688
    s_waitcnt lgkmcnt(4)
    v_mfma_f32_16x16x32_bf16 v[8:11], v[56:59], v[40:43], v[8:11]
    ds_read_b64_tr_b16 v[56:57], v4 offset:2816
    ds_read_b64_tr_b16 v[58:59], v4 offset:2944
    v_mfma_f32_16x16x32_bf16 v[8:11], v[64:67], v[44:47], v[8:11]
    ds_read_b64_tr_b16 v[64:65], v4 offset:3072
    ds_read_b64_tr_b16 v[66:67], v4 offset:3200
    v_mfma_f32_16x16x32_bf16 v[72:75], v[76:79], v[32:35], 0
    v_mfma_f32_16x16x32_bf16 v[72:75], v[84:87], v[36:39], v[72:75]
    v_mfma_f32_16x16x32_bf16 v[72:75], v[60:63], v[40:43], v[72:75]
    v_mfma_f32_16x16x32_bf16 v[72:75], v[68:71], v[44:47], v[72:75]
    s_waitcnt lgkmcnt(4)
    v_mfma_f32_16x16x32_bf16 v[80:83], v[12:15], v[32:35], 0
    v_mov_b32 v84, 0x3f803f80
    v_mfma_f32_16x16x32_bf16 v[80:83], v[16:19], v[36:39], v[80:83]
    v_mov_b32 v85, 0x3f803f80
    s_waitcnt lgkmcnt(0)
    v_mfma_f32_16x16x32_bf16 v[80:83], v[56:59], v[40:43], v[80:83]
    v_mov_b32 v86, 0x3f803f80
    v_mfma_f32_16x16x32_bf16 v[80:83], v[64:67], v[44:47], v[80:83]
    v_mov_b32 v87, 0x3f803f80
    v_smfmac_f32_16x16x64_bf16 v[48:51], v[28:31], a[144:151], v6
    v_cndmask_b32 v60, 0, v84, s[34:35]
    v_smfmac_f32_16x16x64_bf16 v[52:55], v[28:31], a[152:159], v6
    v_cndmask_b32 v61, 0, v84, s[34:35]
    v_max3_f32 v20, v8, v9, v10
    v_max3_f32 v21, v11, v72, v73
    v_max3_f32 v20, v20, v21, v74
    v_max3_f32 v21, v80, v81, v82
    v_max3_f32 v20, v20, v75, v83
    v_max_f32 v20, v20, v21
    v_mov_b32 v21, v20
    v_cvt_pk_bf16_f32 v48, v48, v49
    v_cvt_pk_bf16_f32 v49, v50, v51
    v_permlane16_swap_b32 v20, v21
    v_max_f32 v20, v20, v21
    v_mov_b32 v21, v20
    v_cvt_pk_bf16_f32 v50, v52, v53
    v_cvt_pk_bf16_f32 v51, v54, v55
    v_permlane32_swap_b32 v20, v21
    v_max_f32 v20, v20, v21
    v_mul_f32 v22, s10, v20
    v_pk_fma_f32 v[8:9], v[8:9], s[10:11], v[22:23] op_sel_hi:[1,1,0] neg_lo:[0,0,1] neg_hi:[0,0,1]
    v_pk_fma_f32 v[10:11], v[10:11], s[10:11], v[22:23] op_sel_hi:[1,1,0] neg_lo:[0,0,1] neg_hi:[0,0,1]
    v_pk_fma_f32 v[72:73], v[72:73], s[10:11], v[22:23] op_sel_hi:[1,1,0] neg_lo:[0,0,1] neg_hi:[0,0,1]
    v_pk_fma_f32 v[74:75], v[74:75], s[10:11], v[22:23] op_sel_hi:[1,1,0] neg_lo:[0,0,1] neg_hi:[0,0,1]
    v_pk_fma_f32 v[80:81], v[80:81], s[10:11], v[22:23] op_sel_hi:[1,1,0] neg_lo:[0,0,1] neg_hi:[0,0,1]
    v_pk_fma_f32 v[82:83], v[82:83], s[10:11], v[22:23] op_sel_hi:[1,1,0] neg_lo:[0,0,1] neg_hi:[0,0,1]
    v_exp_f32 v8, v8
    v_exp_f32 v9, v9
    v_exp_f32 v10, v10
    v_exp_f32 v11, v11
    v_exp_f32 v72, v72
    v_exp_f32 v73, v73
    v_exp_f32 v74, v74
    v_exp_f32 v75, v75
    v_cvt_pk_bf16_f32 v32, v8, v9
    v_cvt_pk_bf16_f32 v33, v10, v11
    v_exp_f32 v80, v80
    v_exp_f32 v81, v81
    v_exp_f32 v82, v82
    v_exp_f32 v83, v83
    v_cvt_pk_bf16_f32 v34, v72, v73
    v_cvt_pk_bf16_f32 v35, v74, v75
    v_cvt_pk_bf16_f32 v36, v80, v81
    s_waitcnt vmcnt(3)
    v_mfma_f32_16x16x32_bf16 v[8:11], v[84:87], v[32:35], 0
    v_mfma_f32_16x16x32_bf16 v[40:43], v[88:91], v[32:35], 0
    v_cvt_pk_bf16_f32 v37, v82, v83
    v_mfma_f32_16x16x32_bf16 v[44:47], v[92:95], v[32:35], 0
    v_mfma_f32_16x16x16_bf16 v[8:11], v[60:61], v[36:37], v[8:11]
    v_mov_b64 v[72:73], 0
    v_mfma_f32_16x16x16_bf16 v[40:43], v[48:49], v[36:37], v[40:43]
    v_mov_b64 v[74:75], 0
    v_mfma_f32_16x16x16_bf16 v[44:47], v[50:51], v[36:37], v[44:47]
    v_mov_b64 v[76:77], 0
    v_mov_b64 v[78:79], 0
    v_mov_b64 v[80:81], 0
    v_mov_b64 v[82:83], 0
    v_rcp_f32 v22, v8
    s_nop 2
    v_cndmask_b32 v40, v44, v40, s[32:33]
    v_cndmask_b32 v41, v45, v41, s[32:33]
    v_cndmask_b32 v42, v46, v42, s[32:33]
    v_cndmask_b32 v43, v47, v43, s[32:33]
    v_pk_mul_f32 v[40:41], v[40:41], v[22:23] op_sel_hi:[1,0]
    v_pk_mul_f32 v[42:43], v[42:43], v[22:23] op_sel_hi:[1,0]
    v_cvt_pk_bf16_f32 v44, v40, v41
    v_cvt_pk_bf16_f32 v45, v42, v43
    ds_write_b64 v5, v[44:45]
    s_mov_b32 m0, s73
    s_add_u32 s28, s28, 0x80000
    buffer_load_dwordx4 v1, s[4:7], s28 offen lds
    buffer_load_dwordx4 v1, s[4:7], s28 offen offset:1024 lds
    v_and_b32 v9, 0x70, v1
    v_bfe_u32 v29, v1, 8, 1
    v_lshl_add_u32 v9, v29, 3, v9
    v_bfe_u32 v29, v1, 9, 1
    v_lshl_add_u32 v9, v29, 2, v9
    v_mov_b32 v29, 0x40000000
    s_waitcnt lgkmcnt(0)
    s_barrier
    ds_read_b128 v[12:15], v0 offset:0
    ds_read_b128 v[16:19], v0 offset:64
    ds_read_b128 v[20:23], v0 offset:128
    ds_read_b128 v[24:27], v0 offset:192
    v_cndmask_b32 v9, v29, v9, s[32:33]
    v_and_b32 v29, 16, v1
    v_lshlrev_b32 v29, v29, s38
    v_cndmask_b32 v88, 0, v29, s[44:45]
    v_cndmask_b32 v89, 0, v29, s[46:47]
    v_cndmask_b32 v90, 0, v29, s[48:49]
    v_cndmask_b32 v91, 0, v29, s[50:51]
    s_waitcnt lgkmcnt(3)
    v_smfmac_f32_16x16x64_bf16 v[72:75], v[12:15], a[160:167], v6
    s_waitcnt lgkmcnt(2)
    v_smfmac_f32_16x16x64_bf16 v[72:75], v[16:19], a[168:175], v6
    s_waitcnt lgkmcnt(1)
    v_smfmac_f32_16x16x64_bf16 v[72:75], v[20:23], a[176:183], v6
    s_waitcnt lgkmcnt(0)
    v_smfmac_f32_16x16x64_bf16 v[72:75], v[24:27], a[184:191], v6
    v_smfmac_f32_16x16x64_bf16 v[76:79], v[12:15], a[192:199], v6
    v_smfmac_f32_16x16x64_bf16 v[76:79], v[16:19], a[200:207], v6
    v_cvt_pk_bf16_f32 v72, v72, v73
    v_smfmac_f32_16x16x64_bf16 v[76:79], v[20:23], a[208:215], v6
    v_cvt_pk_bf16_f32 v73, v74, v75
    v_smfmac_f32_16x16x64_bf16 v[76:79], v[24:27], a[216:223], v6
    v_and_or_b32 v72, v72, -2, s16
    v_mfma_f32_16x16x32_bf16 v[80:83], v[12:15], a[224:227], 0
    buffer_store_dwordx2 v[72:73], v7, s[4:7], s23 offen sc1
    v_mfma_f32_16x16x32_bf16 v[80:83], v[16:19], a[228:231], v[80:83]
    v_mfma_f32_16x16x32_bf16 v[80:83], v[20:23], a[232:235], v[80:83]
    v_cvt_pk_bf16_f32 v76, v76, v77
    v_cvt_pk_bf16_f32 v77, v78, v79
    v_mfma_f32_16x16x32_bf16 v[80:83], v[24:27], a[236:239], v[80:83]
    v_and_or_b32 v76, v76, -2, s16
    buffer_store_dwordx2 v[76:77], v7, s[4:7], s25 offen sc1
    s_add_u32 s17, s17, 0x4000
    s_add_u32 s3, s3, 0x80000
    s_add_u32 s29, s29, 0x80000
    s_add_u32 s18, s18, 0x4000
    s_add_u32 s21, s21, 0x8000
    s_add_u32 s15, s15, 1
    s_nop 0
    v_cvt_pk_bf16_f32 v80, v80, v81
    v_cvt_pk_bf16_f32 v81, v82, v83
    v_and_or_b32 v80, v80, -2, s16
    s_mov_b64 exec, s[34:35]
    buffer_store_dwordx2 v[80:81], v7, s[4:7], s26 offen sc1
    s_mov_b64 exec, -1
    s_cmp_lg_u32 s42, 0
    s_cbranch_scc1 OWN_47
    s_cmp_lt_u32 s14, 2
    s_cbranch_scc1 IDLE_46
    s_branch REC_POLL_S
OWN_47:
    s_nop 15
    s_nop 13
    buffer_load_dwordx4 v[12:15], v1, s[4:7], s24 offen offset:0 sc1
    buffer_load_dwordx4 v[16:19], v1, s[4:7], s24 offen offset:1024 sc1
    buffer_load_dwordx4 v[20:23], v1, s[4:7], s24 offen offset:2048 sc1
    buffer_load_dwordx4 v[24:27], v1, s[4:7], s24 offen offset:3072 sc1
    ds_read_b128 v[56:59], v2 offset:0
    ds_read_b128 v[60:63], v2 offset:1024
    ds_read_b128 v[64:67], v2 offset:2048
    ds_read_b128 v[68:71], v2 offset:3072
    v_mov_b64 v[32:33], 0
    v_mov_b64 v[34:35], 0
    v_mov_b64 v[36:37], 0
    v_mov_b64 v[38:39], 0
    v_mov_b64 v[40:41], 0
    v_mov_b64 v[42:43], 0
    v_mov_b64 v[44:45], 0
    v_mov_b64 v[46:47], 0
    buffer_load_dwordx4 v[72:75], v1, s[4:7], s24 offen offset:0 sc1
    buffer_load_dwordx4 v[76:79], v1, s[4:7], s24 offen offset:1024 sc1
    buffer_load_dwordx4 v[80:83], v1, s[4:7], s24 offen offset:2048 sc1
    buffer_load_dwordx4 v[84:87], v1, s[4:7], s24 offen offset:3072 sc1
    v_mov_b64 v[48:49], 0
    v_mov_b64 v[50:51], 0
    v_mov_b64 v[52:53], 0
    v_mov_b64 v[54:55], 0
OPOLL_49:
    s_waitcnt vmcnt(7)
    v_mfma_f32_16x16x32_bf16 v[92:95], v[12:15], v[88:91], 0
    v_bitop3_b32 v10, v12, v14, s16 bitop3:0x7e
    s_waitcnt vmcnt(6)
    v_mfma_f32_16x16x32_bf16 v[92:95], v[16:19], v[88:91], v[92:95]
    v_bitop3_b32 v11, v16, v18, s16 bitop3:0x7e
    s_waitcnt vmcnt(5)
    v_mfma_f32_16x16x32_bf16 v[92:95], v[20:23], v[88:91], v[92:95]
    v_bitop3_b32 v30, v20, v22, s16 bitop3:0x7e
    s_waitcnt vmcnt(4)
    v_mfma_f32_16x16x32_bf16 v[92:95], v[24:27], v[88:91], v[92:95]
    v_bitop3_b32 v31, v24, v26, s16 bitop3:0x7e
    v_or3_b32 v10, v10, v11, v30
    v_bitop3_b32 v10, v10, v31, 1 bitop3:0xa8
    v_cmp_ne_u32 vcc, 0, v10
    s_nop 3
    s_cbranch_vccz ODONE_48
    s_add_u32 s40, s40, 1
    buffer_load_dwordx4 v[12:15], v1, s[4:7], s24 offen offset:0 sc1
    buffer_load_dwordx4 v[16:19], v1, s[4:7], s24 offen offset:1024 sc1
    buffer_load_dwordx4 v[20:23], v1, s[4:7], s24 offen offset:2048 sc1
    buffer_load_dwordx4 v[24:27], v1, s[4:7], s24 offen offset:3072 sc1
    s_waitcnt vmcnt(7)
    v_mfma_f32_16x16x32_bf16 v[92:95], v[72:75], v[88:91], 0
    v_bitop3_b32 v10, v72, v74, s16 bitop3:0x7e
    s_waitcnt vmcnt(6)
    v_mfma_f32_16x16x32_bf16 v[92:95], v[76:79], v[88:91], v[92:95]
    v_bitop3_b32 v11, v76, v78, s16 bitop3:0x7e
    s_waitcnt vmcnt(5)
    v_mfma_f32_16x16x32_bf16 v[92:95], v[80:83], v[88:91], v[92:95]
    v_bitop3_b32 v30, v80, v82, s16 bitop3:0x7e
    s_waitcnt vmcnt(4)
    v_mfma_f32_16x16x32_bf16 v[92:95], v[84:87], v[88:91], v[92:95]
    v_bitop3_b32 v31, v84, v86, s16 bitop3:0x7e
    v_or3_b32 v10, v10, v11, v30
    v_bitop3_b32 v10, v10, v31, 1 bitop3:0xa8
    v_cmp_ne_u32 vcc, 0, v10
    s_add_u32 s68, s68, 1
    s_cmp_gt_u32 s68, 262144
    s_cbranch_scc1 ODONE_48
    s_nop 0
    s_cbranch_vccz ODONE_48
    s_add_u32 s40, s40, 1
    buffer_load_dwordx4 v[72:75], v1, s[4:7], s24 offen offset:0 sc1
    buffer_load_dwordx4 v[76:79], v1, s[4:7], s24 offen offset:1024 sc1
    buffer_load_dwordx4 v[80:83], v1, s[4:7], s24 offen offset:2048 sc1
    buffer_load_dwordx4 v[84:87], v1, s[4:7], s24 offen offset:3072 sc1
    s_branch OPOLL_49
ODONE_48:
    v_permlane32_swap_b32 v92, v94
    v_permlane32_swap_b32 v93, v95
    v_add_f32 v92, v92, v94
    v_add_f32 v93, v93, v95
    v_cvt_pk_bf16_f32 v8, v92, v93
    buffer_store_dword v8, v9, s[4:7], s18 offen sc1
    s_cmp_eq_u32 s15, 63
    s_cselect_b32 s59, s55, 0
    s_barrier
    s_nop 15
    s_nop 15
    s_nop 12
    buffer_store_dword v8, v9, s[4:7], s21 offen sc1
    s_cmp_lt_u32 s15, 61
    s_cbranch_scc1 EFLG_50
    buffer_store_dword v6, off, s[4:7], s22 sc1
EFLG_50:
    s_xor_b32 s16, s16, 1
    s_waitcnt vmcnt(2) lgkmcnt(0)
    s_branch REC_LOOP_S
IDLE_46:
    s_barrier
    s_cmp_eq_u32 s15, 63
    s_cselect_b32 s59, s55, 0
    v_mov_b64 v[32:33], 0
    v_mov_b64 v[34:35], 0
    v_mov_b64 v[36:37], 0
    v_mov_b64 v[38:39], 0
    v_mov_b64 v[40:41], 0
    v_mov_b64 v[42:43], 0
    v_mov_b64 v[44:45], 0
    v_mov_b64 v[46:47], 0
    v_mov_b64 v[48:49], 0
    v_mov_b64 v[50:51], 0
    v_mov_b64 v[52:53], 0
    v_mov_b64 v[54:55], 0
    ds_read_b128 v[56:59], v2 offset:0
    ds_read_b128 v[60:63], v2 offset:1024
    ds_read_b128 v[64:67], v2 offset:2048
    ds_read_b128 v[68:71], v2 offset:3072
    s_xor_b32 s16, s16, 1
    s_waitcnt vmcnt(0)
    s_branch REC_LOOP_S
REC_TAIL_S:
KVOUT_45:
    s_cmp_eq_u32 s59, 1
    s_cbranch_scc1 KVL1_51
    s_lshl_b32 s64, s13, 13
    s_add_u32 s64, s64, 0x43c0000
    buffer_load_dwordx4 v[96:99], v1, s[4:7], s64 offen offset:0
    buffer_load_dwordx4 v[100:103], v1, s[4:7], s64 offen offset:1024
    buffer_load_dwordx4 v[104:107], v1, s[4:7], s64 offen offset:2048
    buffer_load_dwordx4 v[108:111], v1, s[4:7], s64 offen offset:3072
    s_add_u32 s64, s64, 0x1000
    buffer_load_dwordx4 v[112:115], v1, s[4:7], s64 offen offset:0
    buffer_load_dwordx4 v[116:119], v1, s[4:7], s64 offen offset:1024
    buffer_load_dwordx4 v[120:123], v1, s[4:7], s64 offen offset:2048
    buffer_load_dwordx4 v[124:127], v1, s[4:7], s64 offen offset:3072
    s_branch KVLOOK_44
KVL1_51:
    v_lshrrev_b32 v9, 5, v1
    v_lshlrev_b32 v9, 9, v9
    v_bfe_u32 v10, v1, 4, 1
    v_lshl_add_u32 v9, v10, 2, v9
    s_mov_b32 m0, 15104
    s_mov_b64 exec, s[34:35]
    buffer_load_dword v9, s[4:7], s69 offen sc1 lds
    s_mov_b64 exec, -1
    s_mov_b32 m0, 16128
    s_branch KVLOOK_44
RETRY_28:
SPIN_52:
    buffer_load_dwordx4 v[20:23], v1, s[4:7], s17 offen offset:2048 sc1
    buffer_load_dwordx4 v[24:27], v1, s[4:7], s17 offen offset:3072 sc1
    buffer_load_dwordx4 v[28:31], v1, s[4:7], s74 offen offset:0 sc1
    s_add_u32 s68, s68, 1
    s_add_u32 s40, s40, 1024
    s_cmp_gt_u32 s68, 262144
    s_waitcnt vmcnt(0)
    s_cbranch_scc1 BACK_29
    v_cmp_eq_u32 vcc, -1, v23
    s_cbranch_vccnz SPIN_52
    s_branch BACK_29
RETRY_30:
SPIN_53:
    buffer_load_dwordx4 v[24:27], v1, s[4:7], s17 offen offset:3072 sc1
    buffer_load_dwordx4 v[28:31], v1, s[4:7], s74 offen offset:0 sc1
    s_add_u32 s68, s68, 1
    s_add_u32 s40, s40, 1024
    s_cmp_gt_u32 s68, 262144
    s_waitcnt vmcnt(0)
    s_cbranch_scc1 BACK_31
    v_cmp_eq_u32 vcc, -1, v27
    s_cbranch_vccnz SPIN_53
    s_branch BACK_31
RETRY_32:
SPIN_54:
    buffer_load_dwordx4 v[28:31], v1, s[4:7], s74 offen offset:0 sc1
    s_add_u32 s68, s68, 1
    s_add_u32 s40, s40, 1024
    s_cmp_gt_u32 s68, 262144
    s_waitcnt vmcnt(0)
    s_cbranch_scc1 BACK_33
    v_cmp_eq_u32 vcc, -1, v31
    s_cbranch_vccnz SPIN_54
    s_branch BACK_33
RETRY_34:
SPIN_55:
    buffer_load_dwordx4 v[12:15], v1, s[4:7], s20 offen offset:0 sc1
    buffer_load_dwordx4 v[16:19], v1, s[4:7], s20 offen offset:1024 sc1
    buffer_load_dwordx4 v[20:23], v1, s[4:7], s20 offen offset:2048 sc1
    buffer_load_dwordx4 v[24:27], v1, s[4:7], s20 offen offset:3072 sc1
    s_add_u32 s68, s68, 1
    s_add_u32 s40, s40, 1048576
    s_cmp_gt_u32 s68, 262144
    s_waitcnt vmcnt(0)
    s_cbranch_scc1 BACK_35
    v_cmp_eq_u32 vcc, -1, v15
    s_cbranch_vccnz SPIN_55
    s_branch BACK_35
RETRY_36:
SPIN_56:
    buffer_load_dwordx4 v[16:19], v1, s[4:7], s20 offen offset:1024 sc1
    buffer_load_dwordx4 v[20:23], v1, s[4:7], s20 offen offset:2048 sc1
    buffer_load_dwordx4 v[24:27], v1, s[4:7], s20 offen offset:3072 sc1
    buffer_load_dwordx4 v[28:31], v1, s[4:7], s75 offen offset:0 sc1
    s_add_u32 s68, s68, 1
    s_add_u32 s40, s40, 1048576
    s_cmp_gt_u32 s68, 262144
    s_waitcnt vmcnt(0)
    s_cbranch_scc1 BACK_37
    v_cmp_eq_u32 vcc, -1, v19
    s_cbranch_vccnz SPIN_56
    s_branch BACK_37
RETRY_38:
SPIN_57:
    buffer_load_dwordx4 v[20:23], v1, s[4:7], s20 offen offset:2048 sc1
    buffer_load_dwordx4 v[24:27], v1, s[4:7], s20 offen offset:3072 sc1
    buffer_load_dwordx4 v[28:31], v1, s[4:7], s75 offen offset:0 sc1
    s_add_u32 s68, s68, 1
    s_add_u32 s40, s40, 1048576
    s_cmp_gt_u32 s68, 262144
    s_waitcnt vmcnt(0)
    s_cbranch_scc1 BACK_39
    v_cmp_eq_u32 vcc, -1, v23
    s_cbranch_vccnz SPIN_57
    s_branch BACK_39
RETRY_40:
SPIN_58:
    buffer_load_dwordx4 v[24:27], v1, s[4:7], s20 offen offset:3072 sc1
    buffer_load_dwordx4 v[28:31], v1, s[4:7], s75 offen offset:0 sc1
    s_add_u32 s68, s68, 1
    s_add_u32 s40, s40, 1048576
    s_cmp_gt_u32 s68, 262144
    s_waitcnt vmcnt(0)
    s_cbranch_scc1 BACK_41
    v_cmp_eq_u32 vcc, -1, v27
    s_cbranch_vccnz SPIN_58
    s_branch BACK_41
RETRY_42:
SPIN_59:
    buffer_load_dwordx4 v[28:31], v1, s[4:7], s75 offen offset:0 sc1
    s_add_u32 s68, s68, 1
    s_add_u32 s40, s40, 1048576
    s_cmp_gt_u32 s68, 262144
    s_waitcnt vmcnt(0)
    s_cbranch_scc1 BACK_43
    v_cmp_eq_u32 vcc, -1, v31
    s_cbranch_vccnz SPIN_59
    s_branch BACK_43
REC_POLL:
    s_cmp_eq_u32 s59, 0
    s_cbranch_scc1 NOFLG_60
    s_waitcnt vmcnt(0)
    v_lshrrev_b32 v29, 2, v1
    ds_read_b32 v12, v29 offset:15104
    s_add_u32 s64, s15, 2
    s_lshr_b32 s65, s64, 1
    s_add_u32 s67, s65, 1
    s_waitcnt lgkmcnt(0)
    v_cmp_ne_u32 vcc, 0, v12
    v_readlane_b32 s65, v12, s65
    v_readlane_b32 s67, v12, s67
    s_cmp_eq_u32 vcc_lo, -1
    s_cselect_b32 s58, 1, 0
    s_and_b32 s65, s65, s67
    s_cbranch_scc1 NOFLG_60
    s_lshl_b32 s64, s64, 7
    s_add_u32 s64, s64, s69
    v_mov_b32 v29, 0
FSPIN_62:
    buffer_load_dwordx2 v[12:13], v29, s[4:7], s64 offen sc1
    s_add_u32 s68, s68, 1
    s_waitcnt vmcnt(0)
    v_and_b32 v12, v12, v13
    v_cmp_eq_u32 vcc, 0, v12
    s_cbranch_vccz FDONE_63
    s_cmp_gt_u32 s68, 262144
    s_cbranch_scc0 FSPIN_62
FDONE_63:
NOFLG_60:
    s_add_u32 s64, s15, 3
    s_and_b32 s64, s64, 0x43
    s_or_b32 s64, s64, s58
    s_cmp_eq_u32 s64, 0
    s_cselect_b32 s59, 1, 0
    s_cmp_eq_u32 s15, 63
    s_cselect_b32 s59, s55, s59
    s_add_u32 s66, s17, s52
    v_add_u32 v10, s52, v1
    s_xor_b32 s16, s16, 1
    v_mov_b64 v[32:33], 0
    v_mov_b64 v[34:35], 0
    v_mov_b64 v[36:37], 0
    v_mov_b64 v[38:39], 0
    v_mov_b64 v[40:41], 0
    v_mov_b64 v[42:43], 0
    v_mov_b64 v[44:45], 0
    v_mov_b64 v[46:47], 0
    v_mov_b64 v[48:49], 0
    v_mov_b64 v[50:51], 0
    v_mov_b64 v[52:53], 0
    v_mov_b64 v[54:55], 0
    ds_read_b128 v[56:59], v2 offset:0
    ds_read_b128 v[60:63], v2 offset:1024
    ds_read_b128 v[64:67], v2 offset:2048
    ds_read_b128 v[68:71], v2 offset:3072
    s_barrier
    s_nop 14
    buffer_load_dwordx4 v[20:23], v1, s[4:7], s66 offen offset:0 sc1
    s_nop 7
    buffer_load_dwordx4 v[24:27], v1, s[4:7], s66 offen offset:0 sc1
    s_nop 7
    buffer_load_dwordx4 v[28:31], v1, s[4:7], s66 offen offset:0 sc1
IPOLL_65:
    s_waitcnt vmcnt(2)
    ds_write_b128 v10, v[20:23] offset:12800
    v_max3_u32 v11, v20, v21, v22
    v_max_u32 v11, v11, v23
    v_cmp_eq_u32 vcc, -1, v11
    s_cbranch_vccz IOK_64
    buffer_load_dwordx4 v[20:23], v1, s[4:7], s66 offen offset:0 sc1
    s_waitcnt vmcnt(2)
    ds_write_b128 v10, v[24:27] offset:12800
    v_max3_u32 v11, v24, v25, v26
    v_max_u32 v11, v11, v27
    v_cmp_eq_u32 vcc, -1, v11
    s_cbranch_vccz IOK_64
    buffer_load_dwordx4 v[24:27], v1, s[4:7], s66 offen offset:0 sc1
    s_waitcnt vmcnt(2)
    ds_write_b128 v10, v[28:31] offset:12800
    v_max3_u32 v11, v28, v29, v30
    v_max_u32 v11, v11, v31
    v_cmp_eq_u32 vcc, -1, v11
    s_add_u32 s68, s68, 1
    s_add_u32 s53, s53, 1
    s_cmp_gt_u32 s68, 262144
    s_cbranch_scc1 IOK_64
    s_cbranch_vccz IOK_64
    buffer_load_dwordx4 v[28:31], v1, s[4:7], s66 offen offset:0 sc1
    s_branch IPOLL_65
IOK_64:
    s_waitcnt lgkmcnt(0)
REC_LOOP:
    s_barrier
    ds_read_b128 v[12:15], v1 offset:12800
    ds_read_b128 v[16:19], v1 offset:13824
    buffer_load_dwordx4 v[20:23], v1, s[4:7], s17 offen offset:2048
    ds_read_b128 v[72:75], v2 offset:4096
    ds_read_b128 v[76:79], v2 offset:5120
    ds_read_b128 v[80:83], v2 offset:6144
    ds_read_b128 v[84:87], v2 offset:7168
    s_add_u32 s74, s17, 0x1000
    s_add_u32 s20, s20, 0x8000
    s_add_u32 s75, s20, 0x1000
    s_mov_b32 m0, 16128
    s_add_u32 s65, s20, s27
    s_waitcnt lgkmcnt(5)
    v_smfmac_f32_16x16x64_bf16 v[32:35], v[12:15], v[96:103], v6
    buffer_load_dwordx4 v[24:27], v1, s[4:7], s17 offen offset:3072
    v_smfmac_f32_16x16x64_bf16 v[36:39], v[12:15], v[104:111], v6
    v_smfmac_f32_16x16x64_bf16 v[40:43], v[12:15], v[56:63], v6
    buffer_load_dwordx4 v[28:31], v1, s[4:7], s74 offen offset:0
    ds_read_b128 v[56:59], v2 offset:8192
    ds_read_b128 v[60:63], v2 offset:9216
    v_smfmac_f32_16x16x64_bf16 v[44:47], v[12:15], v[64:71], v6
    ds_read_b128 v[64:67], v2 offset:10240
    ds_read_b128 v[68:71], v2 offset:11264
    s_waitcnt lgkmcnt(8)
    v_smfmac_f32_16x16x64_bf16 v[48:51], v[12:15], a[0:7], v6
    v_smfmac_f32_16x16x64_bf16 v[52:55], v[12:15], a[8:15], v6
    buffer_load_dwordx4 v[12:15], v1, s[4:7], s20 offen offset:0
    buffer_load_dword off, s[4:7], s65 lds
    v_smfmac_f32_16x16x64_bf16 v[32:35], v[16:19], v[112:119], v6
    v_smfmac_f32_16x16x64_bf16 v[36:39], v[16:19], v[120:127], v6
    s_waitcnt lgkmcnt(4)
    v_smfmac_f32_16x16x64_bf16 v[40:43], v[16:19], v[72:79], v6
    ds_read_b128 v[72:75], v2 offset:12288
    ds_read_b128 v[76:79], v2 offset:13312
    v_smfmac_f32_16x16x64_bf16 v[44:47], v[16:19], v[80:87], v6
    ds_read_b128 v[80:83], v2 offset:14336
    ds_read_b128 v[84:87], v2 offset:15360
    s_waitcnt vmcnt(4)
    v_cmp_eq_u32 vcc, -1, v23
    v_smfmac_f32_16x16x64_bf16 v[48:51], v[16:19], a[16:23], v6
    v_smfmac_f32_16x16x64_bf16 v[52:55], v[16:19], a[24:31], v6
    s_cbranch_vccnz RETRY_66
BACK_67:
    buffer_load_dwordx4 v[16:19], v1, s[4:7], s20 offen offset:1024
    v_smfmac_f32_16x16x64_bf16 v[32:35], v[20:23], v[128:135], v6
    v_smfmac_f32_16x16x64_bf16 v[36:39], v[20:23], v[136:143], v6
    s_waitcnt lgkmcnt(4)
    v_smfmac_f32_16x16x64_bf16 v[40:43], v[20:23], v[56:63], v6
    ds_read_b128 v[56:59], v2 offset:16384
    ds_read_b128 v[60:63], v2 offset:17408
    v_smfmac_f32_16x16x64_bf16 v[44:47], v[20:23], v[64:71], v6
    ds_read_b128 v[64:67], v2 offset:18432
    ds_read_b128 v[68:71], v2 offset:19456
    s_waitcnt vmcnt(4)
    v_cmp_eq_u32 vcc, -1, v27
    v_smfmac_f32_16x16x64_bf16 v[48:51], v[20:23], a[32:39], v6
    v_smfmac_f32_16x16x64_bf16 v[52:55], v[20:23], a[40:47], v6
    s_cbranch_vccnz RETRY_68
BACK_69:
    buffer_load_dwordx4 v[20:23], v1, s[4:7], s20 offen offset:2048
    v_smfmac_f32_16x16x64_bf16 v[32:35], v[24:27], v[144:151], v6
    v_smfmac_f32_16x16x64_bf16 v[36:39], v[24:27], v[152:159], v6
    s_waitcnt lgkmcnt(4)
    v_smfmac_f32_16x16x64_bf16 v[40:43], v[24:27], v[72:79], v6
    ds_read_b128 v[72:75], v2 offset:20480
    ds_read_b128 v[76:79], v2 offset:21504
    v_smfmac_f32_16x16x64_bf16 v[44:47], v[24:27], v[80:87], v6
    ds_read_b128 v[80:83], v2 offset:22528
    ds_read_b128 v[84:87], v2 offset:23552
    s_waitcnt vmcnt(4)
    v_cmp_eq_u32 vcc, -1, v31
    v_smfmac_f32_16x16x64_bf16 v[48:51], v[24:27], a[48:55], v6
    v_smfmac_f32_16x16x64_bf16 v[52:55], v[24:27], a[56:63], v6
    s_cbranch_vccnz RETRY_70
BACK_71:
    buffer_load_dwordx4 v[24:27], v1, s[4:7], s20 offen offset:3072
    v_smfmac_f32_16x16x64_bf16 v[32:35], v[28:31], v[160:167], v6
    v_smfmac_f32_16x16x64_bf16 v[36:39], v[28:31], v[168:175], v6
    s_waitcnt lgkmcnt(4)
    v_smfmac_f32_16x16x64_bf16 v[40:43], v[28:31], v[56:63], v6
    ds_read_b128 v[56:59], v2 offset:24576
    ds_read_b128 v[60:63], v2 offset:25600
    v_smfmac_f32_16x16x64_bf16 v[44:47], v[28:31], v[64:71], v6
    ds_read_b128 v[64:67], v2 offset:26624
    ds_read_b128 v[68:71], v2 offset:27648
    s_waitcnt vmcnt(4)
    v_cmp_eq_u32 vcc, -1, v15
    v_smfmac_f32_16x16x64_bf16 v[48:51], v[28:31], a[64:71], v6
    v_smfmac_f32_16x16x64_bf16 v[52:55], v[28:31], a[72:79], v6
    s_cbranch_vccnz RETRY_72
BACK_73:
    buffer_load_dwordx4 v[28:31], v1, s[4:7], s75 offen offset:0
    v_smfmac_f32_16x16x64_bf16 v[32:35], v[12:15], v[176:183], v6
    s_waitcnt vmcnt(3)
    v_cmp_eq_u32 vcc, -1, v19
    v_smfmac_f32_16x16x64_bf16 v[36:39], v[12:15], v[184:191], v6
    s_waitcnt lgkmcnt(4)
    v_smfmac_f32_16x16x64_bf16 v[40:43], v[12:15], v[72:79], v6
    ds_read_b128 v[72:75], v2 offset:28672
    ds_read_b128 v[76:79], v2 offset:29696
    v_smfmac_f32_16x16x64_bf16 v[44:47], v[12:15], v[80:87], v6
    ds_read_b128 v[80:83], v2 offset:30720
    ds_read_b128 v[84:87], v2 offset:31744
    buffer_load_dwordx4 v[88:91], v1, s[4:7], s29 offen offset:0
    s_cbranch_vccnz RETRY_74
BACK_75:
    v_smfmac_f32_16x16x64_bf16 v[32:35], v[16:19], v[192:199], v6
    s_waitcnt vmcnt(3)
    v_cmp_eq_u32 vcc, -1, v23
    v_smfmac_f32_16x16x64_bf16 v[36:39], v[16:19], v[200:207], v6
    s_waitcnt lgkmcnt(4)
    v_smfmac_f32_16x16x64_bf16 v[40:43], v[16:19], v[56:63], v6
    ds_read_b128 v[56:59], v2 offset:32768
    ds_read_b128 v[60:63], v2 offset:33792
    v_smfmac_f32_16x16x64_bf16 v[44:47], v[16:19], v[64:71], v6
    ds_read_b128 v[64:67], v2 offset:34816
    ds_read_b128 v[68:71], v2 offset:35840
    s_cbranch_vccnz RETRY_76
BACK_77:
    v_smfmac_f32_16x16x64_bf16 v[32:35], v[20:23], v[208:215], v6
    s_waitcnt vmcnt(2)
    v_cmp_eq_u32 vcc, -1, v27
    v_smfmac_f32_16x16x64_bf16 v[36:39], v[20:23], v[216:223], v6
    s_waitcnt lgkmcnt(4)
    v_smfmac_f32_16x16x64_bf16 v[40:43], v[20:23], v[72:79], v6
    ds_read_b128 v[72:75], v1 offset:0
    ds_read_b128 v[76:79], v1 offset:4096
    v_smfmac_f32_16x16x64_bf16 v[44:47], v[20:23], v[80:87], v6
    ds_read_b128 v[80:83], v1 offset:1024
    ds_read_b128 v[84:87], v1 offset:5120
    buffer_load_dwordx4 v[92:95], v1, s[4:7], s29 offen offset:1024
    s_cbranch_vccnz RETRY_78
BACK_79:
    v_smfmac_f32_16x16x64_bf16 v[32:35], v[24:27], v[224:231], v6
    s_waitcnt vmcnt(2)
    v_cmp_eq_u32 vcc, -1, v31
    v_smfmac_f32_16x16x64_bf16 v[36:39], v[24:27], v[232:239], v6
    s_waitcnt lgkmcnt(4)
    v_smfmac_f32_16x16x64_bf16 v[40:43], v[24:27], v[56:63], v6
    ds_read_b128 v[56:59], v1 offset:2048
    ds_read_b128 v[60:63], v1 offset:6144
    v_smfmac_f32_16x16x64_bf16 v[44:47], v[24:27], v[64:71], v6
    ds_read_b128 v[64:67], v1 offset:3072
    ds_read_b128 v[68:71], v1 offset:7168
    s_cbranch_vccnz RETRY_80
BACK_81:
    v_smfmac_f32_16x16x64_bf16 v[32:35], v[28:31], v[240:247], v6
    v_lshlrev_b32 v8, 2, v1
    v_smfmac_f32_16x16x64_bf16 v[36:39], v[28:31], v[248:255], v6
    s_add_u32 s65, s17, s19
    v_smfmac_f32_16x16x64_bf16 v[40:43], v[28:31], a[240:247], v6
    buffer_load_dword v8, s[4:7], s3 offen lds
    v_smfmac_f32_16x16x64_bf16 v[44:47], v[28:31], a[248:255], v6
    buffer_load_dword off, s[4:7], s65 sc1 lds
    buffer_store_dword v6, off, s[4:7], s22 sc1
    s_add_u32 s22, s22, 256
    s_cmp_lg_u32 s59, 0
    s_cbranch_scc1 KVOUT_83
KVLOOK_82:
    v_permlane32_swap_b32 v32, v36
    v_permlane32_swap_b32 v33, v37
    v_permlane32_swap_b32 v34, v38
    v_permlane32_swap_b32 v35, v39
    v_pk_add_f32 v[32:33], v[32:33], v[36:37]
    v_pk_add_f32 v[34:35], v[34:35], v[38:39]
    v_cvt_pk_bf16_f32 v36, v32, v33
    v_cvt_pk_bf16_f32 v37, v34, v35
    ds_write_b64 v3, v[36:37] offset:0
    v_permlane32_swap_b32 v40, v44
    v_permlane32_swap_b32 v41, v45
    v_permlane32_swap_b32 v42, v46
    v_permlane32_swap_b32 v43, v47
    v_pk_add_f32 v[40:41], v[40:41], v[44:45]
    v_pk_add_f32 v[42:43], v[42:43], v[46:47]
    v_cvt_pk_bf16_f32 v44, v40, v41
    v_cvt_pk_bf16_f32 v45, v42, v43
    ds_write_b64 v3, v[44:45] offset:2304
    v_smfmac_f32_16x16x64_bf16 v[48:51], v[12:15], a[80:87], v6
    v_smfmac_f32_16x16x64_bf16 v[52:55], v[12:15], a[88:95], v6
    v_smfmac_f32_16x16x64_bf16 v[48:51], v[16:19], a[96:103], v6
    v_smfmac_f32_16x16x64_bf16 v[52:55], v[16:19], a[104:111], v6
    s_waitcnt lgkmcnt(0)
    s_barrier
    ds_read_b64_tr_b16 v[32:33], v4 offset:0
    ds_read_b64_tr_b16 v[34:35], v4 offset:128
    ds_read_b64_tr_b16 v[36:37], v4 offset:256
    ds_read_b64_tr_b16 v[38:39], v4 offset:384
    s_cmp_eq_u32 s15, 63
    s_cbranch_scc1 REC_FINAL
    v_smfmac_f32_16x16x64_bf16 v[48:51], v[20:23], a[112:119], v6
    v_smfmac_f32_16x16x64_bf16 v[52:55], v[20:23], a[120:127], v6
    ds_read_b64_tr_b16 v[40:41], v4 offset:512
    ds_read_b64_tr_b16 v[42:43], v4 offset:640
    ds_read_b64_tr_b16 v[44:45], v4 offset:768
    ds_read_b64_tr_b16 v[46:47], v4 offset:896
    v_smfmac_f32_16x16x64_bf16 v[48:51], v[24:27], a[128:135], v6
    v_smfmac_f32_16x16x64_bf16 v[52:55], v[24:27], a[136:143], v6
    s_waitcnt lgkmcnt(4)
    v_mfma_f32_16x16x32_bf16 v[8:11], v[72:75], v[32:35], 0
    ds_read_b64_tr_b16 v[12:13], v4 offset:2304
    ds_read_b64_tr_b16 v[14:15], v4 offset:2432
    v_mfma_f32_16x16x32_bf16 v[8:11], v[80:83], v[36:39], v[8:11]
    ds_read_b64_tr_b16 v[16:17], v4 offset:2560
    ds_read_b64_tr_b16 v[18:19], v4 offset:2688
    s_waitcnt lgkmcnt(4)
    v_mfma_f32_16x16x32_bf16 v[8:11], v[56:59], v[40:43], v[8:11]
    ds_read_b64_tr_b16 v[56:57], v4 offset:2816
    ds_read_b64_tr_b16 v[58:59], v4 offset:2944
    v_mfma_f32_16x16x32_bf16 v[8:11], v[64:67], v[44:47], v[8:11]
    ds_read_b64_tr_b16 v[64:65], v4 offset:3072
    ds_read_b64_tr_b16 v[66:67], v4 offset:3200
    v_mfma_f32_16x16x32_bf16 v[72:75], v[76:79], v[32:35], 0
    v_mfma_f32_16x16x32_bf16 v[72:75], v[84:87], v[36:39], v[72:75]
    v_mfma_f32_16x16x32_bf16 v[72:75], v[60:63], v[40:43], v[72:75]
    v_mfma_f32_16x16x32_bf16 v[72:75], v[68:71], v[44:47], v[72:75]
    s_waitcnt lgkmcnt(4)
    v_mfma_f32_16x16x32_bf16 v[80:83], v[12:15], v[32:35], 0
    v_mov_b32 v84, 0x3f803f80
    v_mfma_f32_16x16x32_bf16 v[80:83], v[16:19], v[36:39], v[80:83]
    v_mov_b32 v85, 0x3f803f80
    s_waitcnt lgkmcnt(0)
    v_mfma_f32_16x16x32_bf16 v[80:83], v[56:59], v[40:43], v[80:83]
    v_mov_b32 v86, 0x3f803f80
    v_mfma_f32_16x16x32_bf16 v[80:83], v[64:67], v[44:47], v[80:83]
    v_mov_b32 v87, 0x3f803f80
    v_smfmac_f32_16x16x64_bf16 v[48:51], v[28:31], a[144:151], v6
    v_cndmask_b32 v60, 0, v84, s[34:35]
    v_smfmac_f32_16x16x64_bf16 v[52:55], v[28:31], a[152:159], v6
    v_cndmask_b32 v61, 0, v84, s[34:35]
    v_max3_f32 v20, v8, v9, v10
    v_max3_f32 v21, v11, v72, v73
    v_max3_f32 v20, v20, v21, v74
    v_max3_f32 v21, v80, v81, v82
    v_max3_f32 v20, v20, v75, v83
    v_max_f32 v20, v20, v21
    v_mov_b32 v21, v20
    v_cvt_pk_bf16_f32 v48, v48, v49
    v_cvt_pk_bf16_f32 v49, v50, v51
    v_permlane16_swap_b32 v20, v21
    v_max_f32 v20, v20, v21
    v_mov_b32 v21, v20
    v_cvt_pk_bf16_f32 v50, v52, v53
    v_cvt_pk_bf16_f32 v51, v54, v55
    v_permlane32_swap_b32 v20, v21
    v_max_f32 v20, v20, v21
    v_mul_f32 v22, s10, v20
    v_pk_fma_f32 v[8:9], v[8:9], s[10:11], v[22:23] op_sel_hi:[1,1,0] neg_lo:[0,0,1] neg_hi:[0,0,1]
    v_pk_fma_f32 v[10:11], v[10:11], s[10:11], v[22:23] op_sel_hi:[1,1,0] neg_lo:[0,0,1] neg_hi:[0,0,1]
    v_pk_fma_f32 v[72:73], v[72:73], s[10:11], v[22:23] op_sel_hi:[1,1,0] neg_lo:[0,0,1] neg_hi:[0,0,1]
    v_pk_fma_f32 v[74:75], v[74:75], s[10:11], v[22:23] op_sel_hi:[1,1,0] neg_lo:[0,0,1] neg_hi:[0,0,1]
    v_pk_fma_f32 v[80:81], v[80:81], s[10:11], v[22:23] op_sel_hi:[1,1,0] neg_lo:[0,0,1] neg_hi:[0,0,1]
    v_pk_fma_f32 v[82:83], v[82:83], s[10:11], v[22:23] op_sel_hi:[1,1,0] neg_lo:[0,0,1] neg_hi:[0,0,1]
    v_exp_f32 v8, v8
    v_exp_f32 v9, v9
    v_exp_f32 v10, v10
    v_exp_f32 v11, v11
    v_exp_f32 v72, v72
    v_exp_f32 v73, v73
    v_exp_f32 v74, v74
    v_exp_f32 v75, v75
    v_cvt_pk_bf16_f32 v32, v8, v9
    v_cvt_pk_bf16_f32 v33, v10, v11
    v_exp_f32 v80, v80
    v_exp_f32 v81, v81
    v_exp_f32 v82, v82
    v_exp_f32 v83, v83
    v_cvt_pk_bf16_f32 v34, v72, v73
    v_cvt_pk_bf16_f32 v35, v74, v75
    v_cvt_pk_bf16_f32 v36, v80, v81
    s_waitcnt vmcnt(3)
    v_mfma_f32_16x16x32_bf16 v[8:11], v[84:87], v[32:35], 0
    v_mfma_f32_16x16x32_bf16 v[40:43], v[88:91], v[32:35], 0
    v_cvt_pk_bf16_f32 v37, v82, v83
    v_mfma_f32_16x16x32_bf16 v[44:47], v[92:95], v[32:35], 0
    v_mfma_f32_16x16x16_bf16 v[8:11], v[60:61], v[36:37], v[8:11]
    v_mov_b64 v[72:73], 0
    v_mfma_f32_16x16x16_bf16 v[40:43], v[48:49], v[36:37], v[40:43]
    v_mov_b64 v[74:75], 0
    v_mfma_f32_16x16x16_bf16 v[44:47], v[50:51], v[36:37], v[44:47]
    v_mov_b64 v[76:77], 0
    v_mov_b64 v[78:79], 0
    v_mov_b64 v[80:81], 0
    v_mov_b64 v[82:83], 0
    v_rcp_f32 v22, v8
    s_nop 2
    v_cndmask_b32 v40, v44, v40, s[32:33]
    v_cndmask_b32 v41, v45, v41, s[32:33]
    v_cndmask_b32 v42, v46, v42, s[32:33]
    v_cndmask_b32 v43, v47, v43, s[32:33]
    v_pk_mul_f32 v[40:41], v[40:41], v[22:23] op_sel_hi:[1,0]
    v_pk_mul_f32 v[42:43], v[42:43], v[22:23] op_sel_hi:[1,0]
    v_cvt_pk_bf16_f32 v44, v40, v41
    v_cvt_pk_bf16_f32 v45, v42, v43
    ds_write_b64 v5, v[44:45]
    s_mov_b32 m0, s73
    s_add_u32 s28, s28, 0x80000
    buffer_load_dwordx4 v1, s[4:7], s28 offen lds
    buffer_load_dwordx4 v1, s[4:7], s28 offen offset:1024 lds
    v_and_b32 v9, 0x70, v1
    v_bfe_u32 v29, v1, 8, 1
    v_lshl_add_u32 v9, v29, 3, v9
    v_bfe_u32 v29, v1, 9, 1
    v_lshl_add_u32 v9, v29, 2, v9
    v_mov_b32 v29, 0x40000000
    s_waitcnt lgkmcnt(0)
    s_barrier
    ds_read_b128 v[12:15], v0 offset:0
    ds_read_b128 v[16:19], v0 offset:64
    ds_read_b128 v[20:23], v0 offset:128
    ds_read_b128 v[24:27], v0 offset:192
    v_cndmask_b32 v9, v29, v9, s[32:33]
    v_and_b32 v29, 16, v1
    v_lshlrev_b32 v29, v29, s38
    v_cndmask_b32 v88, 0, v29, s[44:45]
    v_cndmask_b32 v89, 0, v29, s[46:47]
    v_cndmask_b32 v90, 0, v29, s[48:49]
    v_cndmask_b32 v91, 0, v29, s[50:51]
    s_waitcnt lgkmcnt(3)
    v_smfmac_f32_16x16x64_bf16 v[72:75], v[12:15], a[160:167], v6
    s_waitcnt lgkmcnt(2)
    v_smfmac_f32_16x16x64_bf16 v[72:75], v[16:19], a[168:175], v6
    s_waitcnt lgkmcnt(1)
    v_smfmac_f32_16x16x64_bf16 v[72:75], v[20:23], a[176:183], v6
    s_waitcnt lgkmcnt(0)
    v_smfmac_f32_16x16x64_bf16 v[72:75], v[24:27], a[184:191], v6
    v_smfmac_f32_16x16x64_bf16 v[76:79], v[12:15], a[192:199], v6
    v_smfmac_f32_16x16x64_bf16 v[76:79], v[16:19], a[200:207], v6
    v_cvt_pk_bf16_f32 v72, v72, v73
    v_smfmac_f32_16x16x64_bf16 v[76:79], v[20:23], a[208:215], v6
    v_cvt_pk_bf16_f32 v73, v74, v75
    v_smfmac_f32_16x16x64_bf16 v[76:79], v[24:27], a[216:223], v6
    v_and_or_b32 v72, v72, -2, s16
    v_mfma_f32_16x16x32_bf16 v[80:83], v[12:15], a[224:227], 0
    buffer_store_dwordx2 v[72:73], v7, s[4:7], s23 offen
    v_mfma_f32_16x16x32_bf16 v[80:83], v[16:19], a[228:231], v[80:83]
    v_mfma_f32_16x16x32_bf16 v[80:83], v[20:23], a[232:235], v[80:83]
    v_cvt_pk_bf16_f32 v76, v76, v77
    v_cvt_pk_bf16_f32 v77, v78, v79
    v_mfma_f32_16x16x32_bf16 v[80:83], v[24:27], a[236:239], v[80:83]
    v_and_or_b32 v76, v76, -2, s16
    buffer_store_dwordx2 v[76:77], v7, s[4:7], s25 offen
    s_add_u32 s17, s17, 0x4000
    s_add_u32 s3, s3, 0x80000
    s_add_u32 s29, s29, 0x80000
    s_add_u32 s18, s18, 0x4000
    s_add_u32 s21, s21, 0x8000
    s_add_u32 s15, s15, 1
    s_nop 0
    v_cvt_pk_bf16_f32 v80, v80, v81
    v_cvt_pk_bf16_f32 v81, v82, v83
    v_and_or_b32 v80, v80, -2, s16
    s_mov_b64 exec, s[34:35]
    buffer_store_dwordx2 v[80:81], v7, s[4:7], s26 offen
    s_mov_b64 exec, -1
    s_cmp_lg_u32 s42, 0
    s_cbranch_scc1 OWN_85
    s_cmp_lt_u32 s14, 2
    s_cbranch_scc1 IDLE_84
    s_branch REC_POLL
OWN_85:
    s_nop 15
    s_nop 13
    buffer_load_dwordx4 v[12:15], v1, s[4:7], s24 offen offset:0 sc1
    buffer_load_dwordx4 v[16:19], v1, s[4:7], s24 offen offset:1024 sc1
    buffer_load_dwordx4 v[20:23], v1, s[4:7], s24 offen offset:2048 sc1
    buffer_load_dwordx4 v[24:27], v1, s[4:7], s24 offen offset:3072 sc1
    ds_read_b128 v[56:59], v2 offset:0
    ds_read_b128 v[60:63], v2 offset:1024
    ds_read_b128 v[64:67], v2 offset:2048
    ds_read_b128 v[68:71], v2 offset:3072
    v_mov_b64 v[32:33], 0
    v_mov_b64 v[34:35], 0
    v_mov_b64 v[36:37], 0
    v_mov_b64 v[38:39], 0
    v_mov_b64 v[40:41], 0
    v_mov_b64 v[42:43], 0
    v_mov_b64 v[44:45], 0
    v_mov_b64 v[46:47], 0
    buffer_load_dwordx4 v[72:75], v1, s[4:7], s24 offen offset:0 sc1
    buffer_load_dwordx4 v[76:79], v1, s[4:7], s24 offen offset:1024 sc1
    buffer_load_dwordx4 v[80:83], v1, s[4:7], s24 offen offset:2048 sc1
    buffer_load_dwordx4 v[84:87], v1, s[4:7], s24 offen offset:3072 sc1
    v_mov_b64 v[48:49], 0
    v_mov_b64 v[50:51], 0
    v_mov_b64 v[52:53], 0
    v_mov_b64 v[54:55], 0
OPOLL_87:
    s_waitcnt vmcnt(7)
    v_mfma_f32_16x16x32_bf16 v[92:95], v[12:15], v[88:91], 0
    v_bitop3_b32 v10, v12, v14, s16 bitop3:0x7e
    s_waitcnt vmcnt(6)
    v_mfma_f32_16x16x32_bf16 v[92:95], v[16:19], v[88:91], v[92:95]
    v_bitop3_b32 v11, v16, v18, s16 bitop3:0x7e
    s_waitcnt vmcnt(5)
    v_mfma_f32_16x16x32_bf16 v[92:95], v[20:23], v[88:91], v[92:95]
    v_bitop3_b32 v30, v20, v22, s16 bitop3:0x7e
    s_waitcnt vmcnt(4)
    v_mfma_f32_16x16x32_bf16 v[92:95], v[24:27], v[88:91], v[92:95]
    v_bitop3_b32 v31, v24, v26, s16 bitop3:0x7e
    v_or3_b32 v10, v10, v11, v30
    v_bitop3_b32 v10, v10, v31, 1 bitop3:0xa8
    v_cmp_ne_u32 vcc, 0, v10
    s_nop 3
    s_cbranch_vccz ODONE_86
    s_add_u32 s40, s40, 1
    buffer_load_dwordx4 v[12:15], v1, s[4:7], s24 offen offset:0 sc1
    buffer_load_dwordx4 v[16:19], v1, s[4:7], s24 offen offset:1024 sc1
    buffer_load_dwordx4 v[20:23], v1, s[4:7], s24 offen offset:2048 sc1
    buffer_load_dwordx4 v[24:27], v1, s[4:7], s24 offen offset:3072 sc1
    s_waitcnt vmcnt(7)
    v_mfma_f32_16x16x32_bf16 v[92:95], v[72:75], v[88:91], 0
    v_bitop3_b32 v10, v72, v74, s16 bitop3:0x7e
    s_waitcnt vmcnt(6)
    v_mfma_f32_16x16x32_bf16 v[92:95], v[76:79], v[88:91], v[92:95]
    v_bitop3_b32 v11, v76, v78, s16 bitop3:0x7e
    s_waitcnt vmcnt(5)
    v_mfma_f32_16x16x32_bf16 v[92:95], v[80:83], v[88:91], v[92:95]
    v_bitop3_b32 v30, v80, v82, s16 bitop3:0x7e
    s_waitcnt vmcnt(4)
    v_mfma_f32_16x16x32_bf16 v[92:95], v[84:87], v[88:91], v[92:95]
    v_bitop3_b32 v31, v84, v86, s16 bitop3:0x7e
    v_or3_b32 v10, v10, v11, v30
    v_bitop3_b32 v10, v10, v31, 1 bitop3:0xa8
    v_cmp_ne_u32 vcc, 0, v10
    s_add_u32 s68, s68, 1
    s_cmp_gt_u32 s68, 262144
    s_cbranch_scc1 ODONE_86
    s_nop 0
    s_cbranch_vccz ODONE_86
    s_add_u32 s40, s40, 1
    buffer_load_dwordx4 v[72:75], v1, s[4:7], s24 offen offset:0 sc1
    buffer_load_dwordx4 v[76:79], v1, s[4:7], s24 offen offset:1024 sc1
    buffer_load_dwordx4 v[80:83], v1, s[4:7], s24 offen offset:2048 sc1
    buffer_load_dwordx4 v[84:87], v1, s[4:7], s24 offen offset:3072 sc1
    s_branch OPOLL_87
ODONE_86:
    v_permlane32_swap_b32 v92, v94
    v_permlane32_swap_b32 v93, v95
    v_add_f32 v92, v92, v94
    v_add_f32 v93, v93, v95
    v_cvt_pk_bf16_f32 v8, v92, v93
    buffer_store_dword v8, v9, s[4:7], s18 offen
    s_cmp_eq_u32 s15, 63
    s_cselect_b32 s59, s55, 0
    s_barrier
    s_nop 15
    s_nop 15
    s_nop 12
    buffer_store_dword v8, v9, s[4:7], s21 offen sc1
    s_cmp_lt_u32 s15, 61
    s_cbranch_scc1 EFLG_88
    buffer_store_dword v6, off, s[4:7], s22 sc1
EFLG_88:
    s_xor_b32 s16, s16, 1
    s_waitcnt vmcnt(2) lgkmcnt(0)
    s_branch REC_LOOP
IDLE_84:
    s_barrier
    s_cmp_eq_u32 s15, 63
    s_cselect_b32 s59, s55, 0
    v_mov_b64 v[32:33], 0
    v_mov_b64 v[34:35], 0
    v_mov_b64 v[36:37], 0
    v_mov_b64 v[38:39], 0
    v_mov_b64 v[40:41], 0
    v_mov_b64 v[42:43], 0
    v_mov_b64 v[44:45], 0
    v_mov_b64 v[46:47], 0
    v_mov_b64 v[48:49], 0
    v_mov_b64 v[50:51], 0
    v_mov_b64 v[52:53], 0
    v_mov_b64 v[54:55], 0
    ds_read_b128 v[56:59], v2 offset:0
    ds_read_b128 v[60:63], v2 offset:1024
    ds_read_b128 v[64:67], v2 offset:2048
    ds_read_b128 v[68:71], v2 offset:3072
    s_xor_b32 s16, s16, 1
    s_waitcnt vmcnt(0)
    s_branch REC_LOOP
REC_TAIL:
KVOUT_83:
    s_cmp_eq_u32 s59, 1
    s_cbranch_scc1 KVL1_89
    s_lshl_b32 s64, s13, 13
    s_add_u32 s64, s64, 0x43c0000
    buffer_load_dwordx4 v[96:99], v1, s[4:7], s64 offen offset:0
    buffer_load_dwordx4 v[100:103], v1, s[4:7], s64 offen offset:1024
    buffer_load_dwordx4 v[104:107], v1, s[4:7], s64 offen offset:2048
    buffer_load_dwordx4 v[108:111], v1, s[4:7], s64 offen offset:3072
    s_add_u32 s64, s64, 0x1000
    buffer_load_dwordx4 v[112:115], v1, s[4:7], s64 offen offset:0
    buffer_load_dwordx4 v[116:119], v1, s[4:7], s64 offen offset:1024
    buffer_load_dwordx4 v[120:123], v1, s[4:7], s64 offen offset:2048
    buffer_load_dwordx4 v[124:127], v1, s[4:7], s64 offen offset:3072
    s_branch KVLOOK_82
KVL1_89:
    v_lshrrev_b32 v9, 5, v1
    v_lshlrev_b32 v9, 9, v9
    v_bfe_u32 v10, v1, 4, 1
    v_lshl_add_u32 v9, v10, 2, v9
    s_mov_b32 m0, 15104
    s_mov_b64 exec, s[34:35]
    buffer_load_dword v9, s[4:7], s69 offen sc1 lds
    s_mov_b64 exec, -1
    s_mov_b32 m0, 16128
    s_branch KVLOOK_82
RETRY_66:
SPIN_90:
    buffer_load_dwordx4 v[20:23], v1, s[4:7], s17 offen offset:2048 sc1
    buffer_load_dwordx4 v[24:27], v1, s[4:7], s17 offen offset:3072 sc1
    buffer_load_dwordx4 v[28:31], v1, s[4:7], s74 offen offset:0 sc1
    s_add_u32 s68, s68, 1
    s_add_u32 s40, s40, 1024
    s_cmp_gt_u32 s68, 262144
    s_waitcnt vmcnt(0)
    s_cbranch_scc1 BACK_67
    v_cmp_eq_u32 vcc, -1, v23
    s_cbranch_vccnz SPIN_90
    s_branch BACK_67
RETRY_68:
SPIN_91:
    buffer_load_dwordx4 v[24:27], v1, s[4:7], s17 offen offset:3072 sc1
    buffer_load_dwordx4 v[28:31], v1, s[4:7], s74 offen offset:0 sc1
    s_add_u32 s68, s68, 1
    s_add_u32 s40, s40, 1024
    s_cmp_gt_u32 s68, 262144
    s_waitcnt vmcnt(0)
    s_cbranch_scc1 BACK_69
    v_cmp_eq_u32 vcc, -1, v27
    s_cbranch_vccnz SPIN_91
    s_branch BACK_69
RETRY_70:
SPIN_92:
    buffer_load_dwordx4 v[28:31], v1, s[4:7], s74 offen offset:0 sc1
    s_add_u32 s68, s68, 1
    s_add_u32 s40, s40, 1024
    s_cmp_gt_u32 s68, 262144
    s_waitcnt vmcnt(0)
    s_cbranch_scc1 BACK_71
    v_cmp_eq_u32 vcc, -1, v31
    s_cbranch_vccnz SPIN_92
    s_branch BACK_71
RETRY_72:
SPIN_93:
    buffer_load_dwordx4 v[12:15], v1, s[4:7], s20 offen offset:0 sc1
    buffer_load_dwordx4 v[16:19], v1, s[4:7], s20 offen offset:1024 sc1
    buffer_load_dwordx4 v[20:23], v1, s[4:7], s20 offen offset:2048 sc1
    buffer_load_dwordx4 v[24:27], v1, s[4:7], s20 offen offset:3072 sc1
    s_add_u32 s68, s68, 1
    s_add_u32 s40, s40, 1048576
    s_cmp_gt_u32 s68, 262144
    s_waitcnt vmcnt(0)
    s_cbranch_scc1 BACK_73
    v_cmp_eq_u32 vcc, -1, v15
    s_cbranch_vccnz SPIN_93
    s_branch BACK_73
RETRY_74:
SPIN_94:
    buffer_load_dwordx4 v[16:19], v1, s[4:7], s20 offen offset:1024 sc1
    buffer_load_dwordx4 v[20:23], v1, s[4:7], s20 offen offset:2048 sc1
    buffer_load_dwordx4 v[24:27], v1, s[4:7], s20 offen offset:3072 sc1
    buffer_load_dwordx4 v[28:31], v1, s[4:7], s75 offen offset:0 sc1
    s_add_u32 s68, s68, 1
    s_add_u32 s40, s40, 1048576
    s_cmp_gt_u32 s68, 262144
    s_waitcnt vmcnt(0)
    s_cbranch_scc1 BACK_75
    v_cmp_eq_u32 vcc, -1, v19
    s_cbranch_vccnz SPIN_94
    s_branch BACK_75
RETRY_76:
SPIN_95:
    buffer_load_dwordx4 v[20:23], v1, s[4:7], s20 offen offset:2048 sc1
    buffer_load_dwordx4 v[24:27], v1, s[4:7], s20 offen offset:3072 sc1
    buffer_load_dwordx4 v[28:31], v1, s[4:7], s75 offen offset:0 sc1
    s_add_u32 s68, s68, 1
    s_add_u32 s40, s40, 1048576
    s_cmp_gt_u32 s68, 262144
    s_waitcnt vmcnt(0)
    s_cbranch_scc1 BACK_77
    v_cmp_eq_u32 vcc, -1, v23
    s_cbranch_vccnz SPIN_95
    s_branch BACK_77
RETRY_78:
SPIN_96:
    buffer_load_dwordx4 v[24:27], v1, s[4:7], s20 offen offset:3072 sc1
    buffer_load_dwordx4 v[28:31], v1, s[4:7], s75 offen offset:0 sc1
    s_add_u32 s68, s68, 1
    s_add_u32 s40, s40, 1048576
    s_cmp_gt_u32 s68, 262144
    s_waitcnt vmcnt(0)
    s_cbranch_scc1 BACK_79
    v_cmp_eq_u32 vcc, -1, v27
    s_cbranch_vccnz SPIN_96
    s_branch BACK_79
RETRY_80:
SPIN_97:
    buffer_load_dwordx4 v[28:31], v1, s[4:7], s75 offen offset:0 sc1
    s_add_u32 s68, s68, 1
    s_add_u32 s40, s40, 1048576
    s_cmp_gt_u32 s68, 262144
    s_waitcnt vmcnt(0)
    s_cbranch_scc1 BACK_81
    v_cmp_eq_u32 vcc, -1, v31
    s_cbranch_vccnz SPIN_97
    s_branch BACK_81
REC_FINAL:
    s_cmp_lg_u32 s12, 0
    s_cbranch_scc1 REC_END
    s_waitcnt lgkmcnt(0)
    v_smfmac_f32_16x16x64_bf16 v[48:51], v[20:23], a[112:119], v6
    v_smfmac_f32_16x16x64_bf16 v[52:55], v[20:23], a[120:127], v6
    v_smfmac_f32_16x16x64_bf16 v[48:51], v[24:27], a[128:135], v6
    v_smfmac_f32_16x16x64_bf16 v[52:55], v[24:27], a[136:143], v6
    v_smfmac_f32_16x16x64_bf16 v[48:51], v[28:31], a[144:151], v6
    v_smfmac_f32_16x16x64_bf16 v[52:55], v[28:31], a[152:159], v6
    ds_read_b64_tr_b16 v[192:193], v4 offset:2304
    ds_read_b64_tr_b16 v[194:195], v4 offset:2432
    ds_read_b64_tr_b16 v[196:197], v4 offset:2560
    ds_read_b64_tr_b16 v[198:199], v4 offset:2688
    ds_read_b64_tr_b16 v[200:201], v4 offset:2816
    ds_read_b64_tr_b16 v[202:203], v4 offset:2944
    ds_read_b64_tr_b16 v[204:205], v4 offset:3072
    ds_read_b64_tr_b16 v[206:207], v4 offset:3200
    ds_read_b128 v[160:163], v1 offset:0
    ds_read_b128 v[164:167], v1 offset:1024
    ds_read_b128 v[168:171], v1 offset:2048
    ds_read_b128 v[172:175], v1 offset:3072
    ds_read_b128 v[176:179], v1 offset:4096
    ds_read_b128 v[180:183], v1 offset:5120
    ds_read_b128 v[184:187], v1 offset:6144
    ds_read_b128 v[188:191], v1 offset:7168
    v_mbcnt_lo_u32_b32 v0, -1, 0
    v_mbcnt_hi_u32_b32 v0, -1, v0
    s_mov_b32 s34, 0x3e0293ee
    s_mov_b32 s35, 0x3e0293ee
    s_mov_b32 s36, -1
    s_mov_b32 s37, 0
    v_lshrrev_b32 v5, 4, v0
    v_lshlrev_b32 v5, 2, v5
    v_and_b32 v6, 15, v0
    v_add_u32 v7, 0, v5
    v_cmp_le_u32 s[38:39], v7, v6
    v_add_u32 v7, 1, v5
    v_cmp_le_u32 s[40:41], v7, v6
    v_add_u32 v7, 2, v5
    v_cmp_le_u32 s[42:43], v7, v6
    v_add_u32 v7, 3, v5
    v_cmp_le_u32 s[44:45], v7, v6
    v_mov_b32 v252, 0x3f803f80
    v_mov_b32 v253, 0x3f803f80
    v_mov_b32 v254, 0x3f803f80
    v_mov_b32 v255, 0x3f803f80
    v_permlane32_swap_b32 v48, v52
    v_permlane32_swap_b32 v49, v53
    v_permlane32_swap_b32 v50, v54
    v_permlane32_swap_b32 v51, v55
    v_pk_add_f32 v[48:49], v[48:49], v[52:53]
    v_pk_add_f32 v[50:51], v[50:51], v[54:55]
    v_cvt_pk_bf16_f32 v208, v48, v49
    v_cvt_pk_bf16_f32 v209, v50, v51
    v_mov_b32 v210, v208
    v_mov_b32 v211, v209
    s_nop 1
    v_permlane32_swap_b32 v208, v210
    v_permlane32_swap_b32 v209, v211
    s_mov_b32 s24, 63
    s_lshl_b32 s64, s24, 5
    s_add_u32 s64, s64, s13
    s_lshl_b32 s33, s64, 2
    s_add_u32 s33, s33, 0x296000
    s_lshl_b32 s32, s24, 18
    s_lshl_b32 s65, s13, 12
    s_add_u32 s32, s32, s65
    s_add_u32 s32, s32, 0x4400000
    s_lshl_b32 s64, s14, 10
    s_add_u32 s32, s32, s64
    s_waitcnt vmcnt(0) lgkmcnt(0)
    v_mfma_f32_16x16x32_bf16 v[228:231], v[160:163], v[96:99], 0
    v_mfma_f32_16x16x32_bf16 v[236:239], v[160:163], v[112:115], 0
    v_mfma_f32_16x16x32_bf16 v[240:243], v[176:179], v[112:115], 0
    v_mfma_f32_16x16x32_bf16 v[228:231], v[164:167], v[100:103], v[228:231]
    v_mfma_f32_16x16x32_bf16 v[236:239], v[164:167], v[116:119], v[236:239]
    v_mfma_f32_16x16x32_bf16 v[240:243], v[180:183], v[116:119], v[240:243]
    v_mfma_f32_16x16x32_bf16 v[228:231], v[168:171], v[104:107], v[228:231]
    v_mfma_f32_16x16x32_bf16 v[236:239], v[168:171], v[120:123], v[236:239]
    v_mfma_f32_16x16x32_bf16 v[240:243], v[184:187], v[120:123], v[240:243]
    v_mfma_f32_16x16x32_bf16 v[228:231], v[172:175], v[108:111], v[228:231]
    v_mfma_f32_16x16x32_bf16 v[236:239], v[172:175], v[124:127], v[236:239]
    v_mfma_f32_16x16x32_bf16 v[240:243], v[188:191], v[124:127], v[240:243]
    v_mfma_f32_16x16x32_bf16 v[224:227], v[192:195], v[96:99], 0
    v_mfma_f32_16x16x32_bf16 v[232:235], v[192:195], v[112:115], 0
    v_mfma_f32_16x16x32_bf16 v[224:227], v[196:199], v[100:103], v[224:227]
    v_mfma_f32_16x16x32_bf16 v[232:235], v[196:199], v[116:119], v[232:235]
    v_mfma_f32_16x16x32_bf16 v[224:227], v[200:203], v[104:107], v[224:227]
    v_mfma_f32_16x16x32_bf16 v[232:235], v[200:203], v[120:123], v[232:235]
    v_mfma_f32_16x16x32_bf16 v[224:227], v[204:207], v[108:111], v[224:227]
    v_mfma_f32_16x16x32_bf16 v[232:235], v[204:207], v[124:127], v[232:235]
    v_mov_b32 v11, 0xff800000
    s_nop 7
    v_cndmask_b32 v228, v11, v228, s[38:39]
    v_cndmask_b32 v240, v11, v240, s[38:39]
    v_cndmask_b32 v224, v11, v224, s[36:37]
    v_cndmask_b32 v232, v11, v232, s[36:37]
    v_cndmask_b32 v229, v11, v229, s[40:41]
    v_cndmask_b32 v241, v11, v241, s[40:41]
    v_cndmask_b32 v225, v11, v225, s[36:37]
    v_cndmask_b32 v233, v11, v233, s[36:37]
    v_cndmask_b32 v230, v11, v230, s[42:43]
    v_cndmask_b32 v242, v11, v242, s[42:43]
    v_cndmask_b32 v226, v11, v226, s[36:37]
    v_cndmask_b32 v234, v11, v234, s[36:37]
    v_cndmask_b32 v231, v11, v231, s[44:45]
    v_cndmask_b32 v243, v11, v243, s[44:45]
    v_cndmask_b32 v227, v11, v227, s[36:37]
    v_cndmask_b32 v235, v11, v235, s[36:37]
    v_max3_f32 v8, v224, v225, v226
    v_max3_f32 v8, v8, v227, v228
    v_max3_f32 v8, v8, v229, v230
    v_max_f32 v8, v8, v231
    v_mov_b32 v9, v8
    s_nop 1
    v_permlane16_swap_b32 v8, v9
    v_max_f32 v8, v8, v9
    v_mov_b32 v9, v8
    s_nop 1
    v_permlane32_swap_b32 v8, v9
    v_max_f32 v8, v8, v9
    v_mul_f32 v8, s34, v8
    v_fma_f32 v224, v224, s34, -v8
    v_fma_f32 v225, v225, s34, -v8
    v_fma_f32 v226, v226, s34, -v8
    v_fma_f32 v227, v227, s34, -v8
    v_fma_f32 v228, v228, s34, -v8
    v_fma_f32 v229, v229, s34, -v8
    v_fma_f32 v230, v230, s34, -v8
    v_fma_f32 v231, v231, s34, -v8
    v_exp_f32 v224, v224
    v_exp_f32 v225, v225
    v_exp_f32 v226, v226
    v_exp_f32 v227, v227
    v_exp_f32 v228, v228
    v_exp_f32 v229, v229
    v_exp_f32 v230, v230
    v_exp_f32 v231, v231
    s_nop 0
    v_cvt_pk_bf16_f32 v16, v228, v229
    v_cvt_pk_bf16_f32 v17, v230, v231
    v_mov_b32 v18, 0
    v_mov_b32 v19, 0
    v_cvt_pk_bf16_f32 v20, v224, v225
    v_cvt_pk_bf16_f32 v21, v226, v227
    v_max3_f32 v8, v232, v233, v234
    v_max3_f32 v8, v8, v235, v236
    v_max3_f32 v8, v8, v237, v238
    v_max3_f32 v8, v8, v239, v240
    v_max3_f32 v8, v8, v241, v242
    v_max_f32 v8, v8, v243
    v_mov_b32 v9, v8
    s_nop 1
    v_permlane16_swap_b32 v8, v9
    v_max_f32 v8, v8, v9
    v_mov_b32 v9, v8
    s_nop 1
    v_permlane32_swap_b32 v8, v9
    v_max_f32 v8, v8, v9
    v_mul_f32 v8, s34, v8
    v_fma_f32 v232, v232, s34, -v8
    v_fma_f32 v233, v233, s34, -v8
    v_fma_f32 v234, v234, s34, -v8
    v_fma_f32 v235, v235, s34, -v8
    v_fma_f32 v236, v236, s34, -v8
    v_fma_f32 v237, v237, s34, -v8
    v_fma_f32 v238, v238, s34, -v8
    v_fma_f32 v239, v239, s34, -v8
    v_fma_f32 v240, v240, s34, -v8
    v_fma_f32 v241, v241, s34, -v8
    v_fma_f32 v242, v242, s34, -v8
    v_fma_f32 v243, v243, s34, -v8
    v_exp_f32 v232, v232
    v_exp_f32 v233, v233
    v_exp_f32 v234, v234
    v_exp_f32 v235, v235
    v_exp_f32 v236, v236
    v_exp_f32 v237, v237
    v_exp_f32 v238, v238
    v_exp_f32 v239, v239
    v_exp_f32 v240, v240
    v_exp_f32 v241, v241
    v_exp_f32 v242, v242
    v_exp_f32 v243, v243
    s_nop 0
    v_cvt_pk_bf16_f32 v22, v236, v237
    v_cvt_pk_bf16_f32 v23, v238, v239
    v_cvt_pk_bf16_f32 v24, v240, v241
    v_cvt_pk_bf16_f32 v25, v242, v243
    v_cvt_pk_bf16_f32 v26, v232, v233
    v_cvt_pk_bf16_f32 v27, v234, v235
    v_mfma_f32_16x16x32_bf16 v[244:247], v[252:255], v[16:19], 0
    v_mfma_f32_16x16x32_bf16 v[248:251], v[252:255], v[22:25], 0
    v_mfma_f32_16x16x32_bf16 v[32:35], v[88:91], v[16:19], 0
    v_mfma_f32_16x16x32_bf16 v[36:39], v[88:91], v[22:25], 0
    v_mfma_f32_16x16x32_bf16 v[40:43], v[92:95], v[16:19], 0
    v_mfma_f32_16x16x32_bf16 v[44:47], v[92:95], v[22:25], 0
    v_mfma_f32_16x16x16_bf16 v[244:247], v[252:253], v[20:21], v[244:247]
    v_mfma_f32_16x16x16_bf16 v[248:251], v[252:253], v[26:27], v[248:251]
    v_mfma_f32_16x16x16_bf16 v[32:35], v[208:209], v[20:21], v[32:35]
    v_mfma_f32_16x16x16_bf16 v[36:39], v[208:209], v[26:27], v[36:39]
    v_mfma_f32_16x16x16_bf16 v[40:43], v[210:211], v[20:21], v[40:43]
    v_mfma_f32_16x16x16_bf16 v[44:47], v[210:211], v[26:27], v[44:47]
    v_rcp_f32 v8, v244
    v_rcp_f32 v9, v248
    s_nop 7
    v_mul_f32 v32, v32, v8
    v_mul_f32 v33, v33, v8
    v_mul_f32 v34, v34, v8
    v_mul_f32 v35, v35, v8
    v_cvt_pk_bf16_f32 v96, v32, v33
    v_cvt_pk_bf16_f32 v97, v34, v35
    v_mul_f32 v40, v40, v8
    v_mul_f32 v41, v41, v8
    v_mul_f32 v42, v42, v8
    v_mul_f32 v43, v43, v8
    v_cvt_pk_bf16_f32 v98, v40, v41
    v_cvt_pk_bf16_f32 v99, v42, v43
    s_add_u32 s64, s32, 0x0
    buffer_store_dwordx4 v[96:99], v1, s[4:7], s64 offen offset:0 sc1
    v_mul_f32 v36, v36, v9
    v_mul_f32 v37, v37, v9
    v_mul_f32 v38, v38, v9
    v_mul_f32 v39, v39, v9
    v_cvt_pk_bf16_f32 v100, v36, v37
    v_cvt_pk_bf16_f32 v101, v38, v39
    v_mul_f32 v44, v44, v9
    v_mul_f32 v45, v45, v9
    v_mul_f32 v46, v46, v9
    v_mul_f32 v47, v47, v9
    v_cvt_pk_bf16_f32 v102, v44, v45
    v_cvt_pk_bf16_f32 v103, v46, v47
    s_add_u32 s64, s32, 0x20000
    buffer_store_dwordx4 v[100:103], v1, s[4:7], s64 offen offset:0 sc1
    s_waitcnt vmcnt(0)
    s_barrier
    s_cmp_lg_u32 s14, 0
    s_cbranch_scc1 REC_END
    v_mov_b32 v7, 1
    v_mov_b32 v8, 0
    s_mov_b64 exec, 1
    buffer_store_dword v7, v8, s[4:7], s33 offen sc1
    s_mov_b64 exec, -1
    s_branch REC_END
REC_END:
    s_branch M_EXIT
M_HELP:
    v_mbcnt_lo_u32_b32 v0, -1, 0
    v_mbcnt_hi_u32_b32 v0, -1, v0
    s_and_b32 s12, s96, 1
    s_lshr_b32 s3, s96, 1
    s_and_b32 s13, s3, 31
    s_lshr_b32 s3, s3, 5
    s_load_dwordx4 s[48:51], s[0:1], 16
    s_load_dwordx2 s[52:53], s[0:1], 32
    s_waitcnt lgkmcnt(0)
    s_mov_b32 s46, 5242880
    s_mov_b32 s47, 0x00020000
    s_cmp_eq_u32 s3, 1
    s_cselect_b32 s44, s52, s50
    s_cselect_b32 s45, s53, s51
    s_cmp_eq_u32 s3, 2
    s_cselect_b32 s44, s48, s44
    s_cselect_b32 s45, s49, s45
    s_load_dwordx2 s[16:17], s[0:1], 0
    s_mov_b32 s18, 2621440
    s_mov_b32 s19, 0x00020000
    s_load_dwordx2 s[20:21], s[0:1], 64
    s_mov_b32 s22, 1280
    s_mov_b32 s23, 0x00020000
    s_load_dwordx2 s[24:25], s[0:1], 8
    s_mov_b32 s26, 10240
    s_mov_b32 s27, 0x00020000
    s_lshr_b32 s29, s96, 5
    s_sub_u32 s28, s96, s29
    s_lshl_b32 s28, s28, 2
    s_add_u32 s28, s28, s14
    s_mul_i32 s28, s28, 3
    v_lshlrev_b32 v3, 4, v0
    v_lshlrev_b32 v4, 2, v0
    s_waitcnt lgkmcnt(0)
    s_and_b32 s29, s96, 31
    s_cmp_eq_u32 s29, 31
    s_cbranch_scc1 INP2_98
    s_add_u32 s29, s28, 0
    s_mul_i32 s33, s29, 1280
    buffer_load_dwordx4 v[10:13], v3, s[16:19], s33 offen
    buffer_load_dword v14, v4, s[16:19], s33 offen offset:1024
    s_add_u32 s29, s28, 1
    s_mul_i32 s34, s29, 1280
    buffer_load_dwordx4 v[16:19], v3, s[16:19], s34 offen
    buffer_load_dword v20, v4, s[16:19], s34 offen offset:1024
    s_add_u32 s29, s28, 2
    s_mul_i32 s35, s29, 1280
    buffer_load_dwordx4 v[22:25], v3, s[16:19], s35 offen
    buffer_load_dword v26, v4, s[16:19], s35 offen offset:1024
    buffer_load_dwordx4 v[28:31], v3, s[20:23], 0 offen
    buffer_load_dword v32, v4, s[20:23], 0 offen offset:1024
    s_cmp_ge_u32 s96, 10
    s_cbranch_scc1 INM0_99
    v_and_b32 v5, 7, v0
    v_mul_u32_u24 v5, 1280, v5
    v_lshrrev_b32 v6, 4, v0
    v_lshl_add_u32 v5, v6, 5, v5
    v_bfe_u32 v6, v0, 3, 1
    v_lshl_add_u32 v5, v6, 4, v5
    s_lshl_b32 s29, s96, 7
    buffer_load_dwordx4 v[34:37], v5, s[24:27], s29 offen
INM0_99:
    s_waitcnt vmcnt(0)
    s_add_u32 s29, s28, 0
    s_cmp_ge_u32 s29, 2048
    s_cbranch_scc1 INR_100
    v_lshlrev_b32 v50, 16, v10
    v_and_b32 v60, 0xffff0000, v10
    v_lshlrev_b32 v51, 16, v11
    v_and_b32 v61, 0xffff0000, v11
    v_lshlrev_b32 v52, 16, v12
    v_and_b32 v62, 0xffff0000, v12
    v_lshlrev_b32 v53, 16, v13
    v_and_b32 v63, 0xffff0000, v13
    v_lshlrev_b32 v54, 16, v14
    v_and_b32 v64, 0xffff0000, v14
    v_add_f32 v70, v50, v60
    v_add_f32 v70, v70, v51
    v_add_f32 v70, v70, v61
    v_add_f32 v70, v70, v52
    v_add_f32 v70, v70, v62
    v_add_f32 v70, v70, v53
    v_add_f32 v70, v70, v63
    v_add_f32 v70, v70, v54
    v_add_f32 v70, v70, v64
    s_nop 1
    v_add_f32_dpp v70, v70, v70 quad_perm:[1,0,3,2] row_mask:0xf bank_mask:0xf
    s_nop 1
    v_add_f32_dpp v70, v70, v70 quad_perm:[2,3,0,1] row_mask:0xf bank_mask:0xf
    s_nop 1
    v_add_f32_dpp v70, v70, v70 row_half_mirror row_mask:0xf bank_mask:0xf
    s_nop 1
    v_add_f32_dpp v70, v70, v70 row_mirror row_mask:0xf bank_mask:0xf
    v_mov_b32 v71, v70
    s_nop 1
    v_permlane16_swap_b32 v70, v71
    v_add_f32 v70, v70, v71
    v_mov_b32 v71, v70
    s_nop 1
    v_permlane32_swap_b32 v70, v71
    v_add_f32 v70, v70, v71
    v_mul_f32 v72, 0x3acccccd, v70
    v_mov_b32 v73, 0
    v_sub_f32 v74, v50, v72
    v_fmac_f32 v73, v74, v74
    v_sub_f32 v74, v60, v72
    v_fmac_f32 v73, v74, v74
    v_sub_f32 v74, v51, v72
    v_fmac_f32 v73, v74, v74
    v_sub_f32 v74, v61, v72
    v_fmac_f32 v73, v74, v74
    v_sub_f32 v74, v52, v72
    v_fmac_f32 v73, v74, v74
    v_sub_f32 v74, v62, v72
    v_fmac_f32 v73, v74, v74
    v_sub_f32 v74, v53, v72
    v_fmac_f32 v73, v74, v74
    v_sub_f32 v74, v63, v72
    v_fmac_f32 v73, v74, v74
    v_sub_f32 v74, v54, v72
    v_fmac_f32 v73, v74, v74
    v_sub_f32 v74, v64, v72
    v_fmac_f32 v73, v74, v74
    s_nop 1
    v_add_f32_dpp v73, v73, v73 quad_perm:[1,0,3,2] row_mask:0xf bank_mask:0xf
    s_nop 1
    v_add_f32_dpp v73, v73, v73 quad_perm:[2,3,0,1] row_mask:0xf bank_mask:0xf
    s_nop 1
    v_add_f32_dpp v73, v73, v73 row_half_mirror row_mask:0xf bank_mask:0xf
    s_nop 1
    v_add_f32_dpp v73, v73, v73 row_mirror row_mask:0xf bank_mask:0xf
    v_mov_b32 v71, v73
    s_nop 1
    v_permlane16_swap_b32 v73, v71
    v_add_f32 v73, v73, v71
    v_mov_b32 v71, v73
    s_nop 1
    v_permlane32_swap_b32 v73, v71
    v_add_f32 v73, v73, v71
    v_mul_f32 v73, 0x3acccccd, v73
    v_cvt_pk_bf16_f32 v72, v72, v72
    v_lshlrev_b32 v72, 16, v72
    v_cvt_pk_bf16_f32 v73, v73, v73
    v_lshlrev_b32 v73, 16, v73
    v_add_f32 v73, 0x3727c5ac, v73
    v_cvt_pk_bf16_f32 v73, v73, v73
    v_lshlrev_b32 v73, 16, v73
    v_sqrt_f32 v73, v73
    s_nop 0
    v_cvt_pk_bf16_f32 v73, v73, v73
    v_lshlrev_b32 v73, 16, v73
    v_rcp_f32 v75, v73
    s_nop 0
    v_mov_b32 v76, 0
    v_sub_f32 v50, v50, v72
    v_cvt_pk_bf16_f32 v50, v50, v50
    v_lshlrev_b32 v50, 16, v50
    v_mul_f32 v74, v50, v75
    v_fma_f32 v77, -v74, v73, v50
    v_fma_f32 v50, v77, v75, v74
    v_sub_f32 v60, v60, v72
    v_cvt_pk_bf16_f32 v60, v60, v60
    v_lshlrev_b32 v60, 16, v60
    v_mul_f32 v74, v60, v75
    v_fma_f32 v77, -v74, v73, v60
    v_fma_f32 v60, v77, v75, v74
    v_cvt_pk_bf16_f32 v10, v50, v60
    v_lshlrev_b32 v74, 16, v10
    v_lshlrev_b32 v77, 16, v28
    v_fmac_f32 v76, v74, v77
    v_and_b32 v74, 0xffff0000, v10
    v_and_b32 v77, 0xffff0000, v28
    v_fmac_f32 v76, v74, v77
    v_sub_f32 v51, v51, v72
    v_cvt_pk_bf16_f32 v51, v51, v51
    v_lshlrev_b32 v51, 16, v51
    v_mul_f32 v74, v51, v75
    v_fma_f32 v77, -v74, v73, v51
    v_fma_f32 v51, v77, v75, v74
    v_sub_f32 v61, v61, v72
    v_cvt_pk_bf16_f32 v61, v61, v61
    v_lshlrev_b32 v61, 16, v61
    v_mul_f32 v74, v61, v75
    v_fma_f32 v77, -v74, v73, v61
    v_fma_f32 v61, v77, v75, v74
    v_cvt_pk_bf16_f32 v11, v51, v61
    v_lshlrev_b32 v74, 16, v11
    v_lshlrev_b32 v77, 16, v29
    v_fmac_f32 v76, v74, v77
    v_and_b32 v74, 0xffff0000, v11
    v_and_b32 v77, 0xffff0000, v29
    v_fmac_f32 v76, v74, v77
    v_sub_f32 v52, v52, v72
    v_cvt_pk_bf16_f32 v52, v52, v52
    v_lshlrev_b32 v52, 16, v52
    v_mul_f32 v74, v52, v75
    v_fma_f32 v77, -v74, v73, v52
    v_fma_f32 v52, v77, v75, v74
    v_sub_f32 v62, v62, v72
    v_cvt_pk_bf16_f32 v62, v62, v62
    v_lshlrev_b32 v62, 16, v62
    v_mul_f32 v74, v62, v75
    v_fma_f32 v77, -v74, v73, v62
    v_fma_f32 v62, v77, v75, v74
    v_cvt_pk_bf16_f32 v12, v52, v62
    v_lshlrev_b32 v74, 16, v12
    v_lshlrev_b32 v77, 16, v30
    v_fmac_f32 v76, v74, v77
    v_and_b32 v74, 0xffff0000, v12
    v_and_b32 v77, 0xffff0000, v30
    v_fmac_f32 v76, v74, v77
    v_sub_f32 v53, v53, v72
    v_cvt_pk_bf16_f32 v53, v53, v53
    v_lshlrev_b32 v53, 16, v53
    v_mul_f32 v74, v53, v75
    v_fma_f32 v77, -v74, v73, v53
    v_fma_f32 v53, v77, v75, v74
    v_sub_f32 v63, v63, v72
    v_cvt_pk_bf16_f32 v63, v63, v63
    v_lshlrev_b32 v63, 16, v63
    v_mul_f32 v74, v63, v75
    v_fma_f32 v77, -v74, v73, v63
    v_fma_f32 v63, v77, v75, v74
    v_cvt_pk_bf16_f32 v13, v53, v63
    v_lshlrev_b32 v74, 16, v13
    v_lshlrev_b32 v77, 16, v31
    v_fmac_f32 v76, v74, v77
    v_and_b32 v74, 0xffff0000, v13
    v_and_b32 v77, 0xffff0000, v31
    v_fmac_f32 v76, v74, v77
    v_sub_f32 v54, v54, v72
    v_cvt_pk_bf16_f32 v54, v54, v54
    v_lshlrev_b32 v54, 16, v54
    v_mul_f32 v74, v54, v75
    v_fma_f32 v77, -v74, v73, v54
    v_fma_f32 v54, v77, v75, v74
    v_sub_f32 v64, v64, v72
    v_cvt_pk_bf16_f32 v64, v64, v64
    v_lshlrev_b32 v64, 16, v64
    v_mul_f32 v74, v64, v75
    v_fma_f32 v77, -v74, v73, v64
    v_fma_f32 v64, v77, v75, v74
    v_cvt_pk_bf16_f32 v14, v54, v64
    v_lshlrev_b32 v74, 16, v14
    v_lshlrev_b32 v77, 16, v32
    v_fmac_f32 v76, v74, v77
    v_and_b32 v74, 0xffff0000, v14
    v_and_b32 v77, 0xffff0000, v32
    v_fmac_f32 v76, v74, v77
    s_add_u32 s30, s33, 0x0
    buffer_store_dwordx4 v[10:13], v3, s[4:7], s30 offen sc1
    buffer_store_dword v14, v4, s[4:7], s30 offen offset:1024 sc1
    s_nop 1
    v_add_f32_dpp v76, v76, v76 quad_perm:[1,0,3,2] row_mask:0xf bank_mask:0xf
    s_nop 1
    v_add_f32_dpp v76, v76, v76 quad_perm:[2,3,0,1] row_mask:0xf bank_mask:0xf
    s_nop 1
    v_add_f32_dpp v76, v76, v76 row_half_mirror row_mask:0xf bank_mask:0xf
    s_nop 1
    v_add_f32_dpp v76, v76, v76 row_mirror row_mask:0xf bank_mask:0xf
    v_mov_b32 v71, v76
    s_nop 1
    v_permlane16_swap_b32 v76, v71
    v_add_f32 v76, v76, v71
    v_mov_b32 v71, v76
    s_nop 1
    v_permlane32_swap_b32 v76, v71
    v_add_f32 v76, v76, v71
    v_cvt_pk_bf16_f32 v76, v76, v76
    v_lshlrev_b32 v76, 16, v76
    s_lshl_b32 s30, s29, 2
    s_add_u32 s30, s30, 0x280000
    s_mov_b64 exec, 1
    buffer_store_dword v76, off, s[4:7], s30 sc1
    s_mov_b64 exec, -1
INR_100:
    s_add_u32 s29, s28, 1
    s_cmp_ge_u32 s29, 2048
    s_cbranch_scc1 INR_101
    v_lshlrev_b32 v50, 16, v16
    v_and_b32 v60, 0xffff0000, v16
    v_lshlrev_b32 v51, 16, v17
    v_and_b32 v61, 0xffff0000, v17
    v_lshlrev_b32 v52, 16, v18
    v_and_b32 v62, 0xffff0000, v18
    v_lshlrev_b32 v53, 16, v19
    v_and_b32 v63, 0xffff0000, v19
    v_lshlrev_b32 v54, 16, v20
    v_and_b32 v64, 0xffff0000, v20
    v_add_f32 v70, v50, v60
    v_add_f32 v70, v70, v51
    v_add_f32 v70, v70, v61
    v_add_f32 v70, v70, v52
    v_add_f32 v70, v70, v62
    v_add_f32 v70, v70, v53
    v_add_f32 v70, v70, v63
    v_add_f32 v70, v70, v54
    v_add_f32 v70, v70, v64
    s_nop 1
    v_add_f32_dpp v70, v70, v70 quad_perm:[1,0,3,2] row_mask:0xf bank_mask:0xf
    s_nop 1
    v_add_f32_dpp v70, v70, v70 quad_perm:[2,3,0,1] row_mask:0xf bank_mask:0xf
    s_nop 1
    v_add_f32_dpp v70, v70, v70 row_half_mirror row_mask:0xf bank_mask:0xf
    s_nop 1
    v_add_f32_dpp v70, v70, v70 row_mirror row_mask:0xf bank_mask:0xf
    v_mov_b32 v71, v70
    s_nop 1
    v_permlane16_swap_b32 v70, v71
    v_add_f32 v70, v70, v71
    v_mov_b32 v71, v70
    s_nop 1
    v_permlane32_swap_b32 v70, v71
    v_add_f32 v70, v70, v71
    v_mul_f32 v72, 0x3acccccd, v70
    v_mov_b32 v73, 0
    v_sub_f32 v74, v50, v72
    v_fmac_f32 v73, v74, v74
    v_sub_f32 v74, v60, v72
    v_fmac_f32 v73, v74, v74
    v_sub_f32 v74, v51, v72
    v_fmac_f32 v73, v74, v74
    v_sub_f32 v74, v61, v72
    v_fmac_f32 v73, v74, v74
    v_sub_f32 v74, v52, v72
    v_fmac_f32 v73, v74, v74
    v_sub_f32 v74, v62, v72
    v_fmac_f32 v73, v74, v74
    v_sub_f32 v74, v53, v72
    v_fmac_f32 v73, v74, v74
    v_sub_f32 v74, v63, v72
    v_fmac_f32 v73, v74, v74
    v_sub_f32 v74, v54, v72
    v_fmac_f32 v73, v74, v74
    v_sub_f32 v74, v64, v72
    v_fmac_f32 v73, v74, v74
    s_nop 1
    v_add_f32_dpp v73, v73, v73 quad_perm:[1,0,3,2] row_mask:0xf bank_mask:0xf
    s_nop 1
    v_add_f32_dpp v73, v73, v73 quad_perm:[2,3,0,1] row_mask:0xf bank_mask:0xf
    s_nop 1
    v_add_f32_dpp v73, v73, v73 row_half_mirror row_mask:0xf bank_mask:0xf
    s_nop 1
    v_add_f32_dpp v73, v73, v73 row_mirror row_mask:0xf bank_mask:0xf
    v_mov_b32 v71, v73
    s_nop 1
    v_permlane16_swap_b32 v73, v71
    v_add_f32 v73, v73, v71
    v_mov_b32 v71, v73
    s_nop 1
    v_permlane32_swap_b32 v73, v71
    v_add_f32 v73, v73, v71
    v_mul_f32 v73, 0x3acccccd, v73
    v_cvt_pk_bf16_f32 v72, v72, v72
    v_lshlrev_b32 v72, 16, v72
    v_cvt_pk_bf16_f32 v73, v73, v73
    v_lshlrev_b32 v73, 16, v73
    v_add_f32 v73, 0x3727c5ac, v73
    v_cvt_pk_bf16_f32 v73, v73, v73
    v_lshlrev_b32 v73, 16, v73
    v_sqrt_f32 v73, v73
    s_nop 0
    v_cvt_pk_bf16_f32 v73, v73, v73
    v_lshlrev_b32 v73, 16, v73
    v_rcp_f32 v75, v73
    s_nop 0
    v_mov_b32 v76, 0
    v_sub_f32 v50, v50, v72
    v_cvt_pk_bf16_f32 v50, v50, v50
    v_lshlrev_b32 v50, 16, v50
    v_mul_f32 v74, v50, v75
    v_fma_f32 v77, -v74, v73, v50
    v_fma_f32 v50, v77, v75, v74
    v_sub_f32 v60, v60, v72
    v_cvt_pk_bf16_f32 v60, v60, v60
    v_lshlrev_b32 v60, 16, v60
    v_mul_f32 v74, v60, v75
    v_fma_f32 v77, -v74, v73, v60
    v_fma_f32 v60, v77, v75, v74
    v_cvt_pk_bf16_f32 v16, v50, v60
    v_lshlrev_b32 v74, 16, v16
    v_lshlrev_b32 v77, 16, v28
    v_fmac_f32 v76, v74, v77
    v_and_b32 v74, 0xffff0000, v16
    v_and_b32 v77, 0xffff0000, v28
    v_fmac_f32 v76, v74, v77
    v_sub_f32 v51, v51, v72
    v_cvt_pk_bf16_f32 v51, v51, v51
    v_lshlrev_b32 v51, 16, v51
    v_mul_f32 v74, v51, v75
    v_fma_f32 v77, -v74, v73, v51
    v_fma_f32 v51, v77, v75, v74
    v_sub_f32 v61, v61, v72
    v_cvt_pk_bf16_f32 v61, v61, v61
    v_lshlrev_b32 v61, 16, v61
    v_mul_f32 v74, v61, v75
    v_fma_f32 v77, -v74, v73, v61
    v_fma_f32 v61, v77, v75, v74
    v_cvt_pk_bf16_f32 v17, v51, v61
    v_lshlrev_b32 v74, 16, v17
    v_lshlrev_b32 v77, 16, v29
    v_fmac_f32 v76, v74, v77
    v_and_b32 v74, 0xffff0000, v17
    v_and_b32 v77, 0xffff0000, v29
    v_fmac_f32 v76, v74, v77
    v_sub_f32 v52, v52, v72
    v_cvt_pk_bf16_f32 v52, v52, v52
    v_lshlrev_b32 v52, 16, v52
    v_mul_f32 v74, v52, v75
    v_fma_f32 v77, -v74, v73, v52
    v_fma_f32 v52, v77, v75, v74
    v_sub_f32 v62, v62, v72
    v_cvt_pk_bf16_f32 v62, v62, v62
    v_lshlrev_b32 v62, 16, v62
    v_mul_f32 v74, v62, v75
    v_fma_f32 v77, -v74, v73, v62
    v_fma_f32 v62, v77, v75, v74
    v_cvt_pk_bf16_f32 v18, v52, v62
    v_lshlrev_b32 v74, 16, v18
    v_lshlrev_b32 v77, 16, v30
    v_fmac_f32 v76, v74, v77
    v_and_b32 v74, 0xffff0000, v18
    v_and_b32 v77, 0xffff0000, v30
    v_fmac_f32 v76, v74, v77
    v_sub_f32 v53, v53, v72
    v_cvt_pk_bf16_f32 v53, v53, v53
    v_lshlrev_b32 v53, 16, v53
    v_mul_f32 v74, v53, v75
    v_fma_f32 v77, -v74, v73, v53
    v_fma_f32 v53, v77, v75, v74
    v_sub_f32 v63, v63, v72
    v_cvt_pk_bf16_f32 v63, v63, v63
    v_lshlrev_b32 v63, 16, v63
    v_mul_f32 v74, v63, v75
    v_fma_f32 v77, -v74, v73, v63
    v_fma_f32 v63, v77, v75, v74
    v_cvt_pk_bf16_f32 v19, v53, v63
    v_lshlrev_b32 v74, 16, v19
    v_lshlrev_b32 v77, 16, v31
    v_fmac_f32 v76, v74, v77
    v_and_b32 v74, 0xffff0000, v19
    v_and_b32 v77, 0xffff0000, v31
    v_fmac_f32 v76, v74, v77
    v_sub_f32 v54, v54, v72
    v_cvt_pk_bf16_f32 v54, v54, v54
    v_lshlrev_b32 v54, 16, v54
    v_mul_f32 v74, v54, v75
    v_fma_f32 v77, -v74, v73, v54
    v_fma_f32 v54, v77, v75, v74
    v_sub_f32 v64, v64, v72
    v_cvt_pk_bf16_f32 v64, v64, v64
    v_lshlrev_b32 v64, 16, v64
    v_mul_f32 v74, v64, v75
    v_fma_f32 v77, -v74, v73, v64
    v_fma_f32 v64, v77, v75, v74
    v_cvt_pk_bf16_f32 v20, v54, v64
    v_lshlrev_b32 v74, 16, v20
    v_lshlrev_b32 v77, 16, v32
    v_fmac_f32 v76, v74, v77
    v_and_b32 v74, 0xffff0000, v20
    v_and_b32 v77, 0xffff0000, v32
    v_fmac_f32 v76, v74, v77
    s_add_u32 s30, s34, 0x0
    buffer_store_dwordx4 v[16:19], v3, s[4:7], s30 offen sc1
    buffer_store_dword v20, v4, s[4:7], s30 offen offset:1024 sc1
    s_nop 1
    v_add_f32_dpp v76, v76, v76 quad_perm:[1,0,3,2] row_mask:0xf bank_mask:0xf
    s_nop 1
    v_add_f32_dpp v76, v76, v76 quad_perm:[2,3,0,1] row_mask:0xf bank_mask:0xf
    s_nop 1
    v_add_f32_dpp v76, v76, v76 row_half_mirror row_mask:0xf bank_mask:0xf
    s_nop 1
    v_add_f32_dpp v76, v76, v76 row_mirror row_mask:0xf bank_mask:0xf
    v_mov_b32 v71, v76
    s_nop 1
    v_permlane16_swap_b32 v76, v71
    v_add_f32 v76, v76, v71
    v_mov_b32 v71, v76
    s_nop 1
    v_permlane32_swap_b32 v76, v71
    v_add_f32 v76, v76, v71
    v_cvt_pk_bf16_f32 v76, v76, v76
    v_lshlrev_b32 v76, 16, v76
    s_lshl_b32 s30, s29, 2
    s_add_u32 s30, s30, 0x280000
    s_mov_b64 exec, 1
    buffer_store_dword v76, off, s[4:7], s30 sc1
    s_mov_b64 exec, -1
INR_101:
    s_add_u32 s29, s28, 2
    s_cmp_ge_u32 s29, 2048
    s_cbranch_scc1 INR_102
    v_lshlrev_b32 v50, 16, v22
    v_and_b32 v60, 0xffff0000, v22
    v_lshlrev_b32 v51, 16, v23
    v_and_b32 v61, 0xffff0000, v23
    v_lshlrev_b32 v52, 16, v24
    v_and_b32 v62, 0xffff0000, v24
    v_lshlrev_b32 v53, 16, v25
    v_and_b32 v63, 0xffff0000, v25
    v_lshlrev_b32 v54, 16, v26
    v_and_b32 v64, 0xffff0000, v26
    v_add_f32 v70, v50, v60
    v_add_f32 v70, v70, v51
    v_add_f32 v70, v70, v61
    v_add_f32 v70, v70, v52
    v_add_f32 v70, v70, v62
    v_add_f32 v70, v70, v53
    v_add_f32 v70, v70, v63
    v_add_f32 v70, v70, v54
    v_add_f32 v70, v70, v64
    s_nop 1
    v_add_f32_dpp v70, v70, v70 quad_perm:[1,0,3,2] row_mask:0xf bank_mask:0xf
    s_nop 1
    v_add_f32_dpp v70, v70, v70 quad_perm:[2,3,0,1] row_mask:0xf bank_mask:0xf
    s_nop 1
    v_add_f32_dpp v70, v70, v70 row_half_mirror row_mask:0xf bank_mask:0xf
    s_nop 1
    v_add_f32_dpp v70, v70, v70 row_mirror row_mask:0xf bank_mask:0xf
    v_mov_b32 v71, v70
    s_nop 1
    v_permlane16_swap_b32 v70, v71
    v_add_f32 v70, v70, v71
    v_mov_b32 v71, v70
    s_nop 1
    v_permlane32_swap_b32 v70, v71
    v_add_f32 v70, v70, v71
    v_mul_f32 v72, 0x3acccccd, v70
    v_mov_b32 v73, 0
    v_sub_f32 v74, v50, v72
    v_fmac_f32 v73, v74, v74
    v_sub_f32 v74, v60, v72
    v_fmac_f32 v73, v74, v74
    v_sub_f32 v74, v51, v72
    v_fmac_f32 v73, v74, v74
    v_sub_f32 v74, v61, v72
    v_fmac_f32 v73, v74, v74
    v_sub_f32 v74, v52, v72
    v_fmac_f32 v73, v74, v74
    v_sub_f32 v74, v62, v72
    v_fmac_f32 v73, v74, v74
    v_sub_f32 v74, v53, v72
    v_fmac_f32 v73, v74, v74
    v_sub_f32 v74, v63, v72
    v_fmac_f32 v73, v74, v74
    v_sub_f32 v74, v54, v72
    v_fmac_f32 v73, v74, v74
    v_sub_f32 v74, v64, v72
    v_fmac_f32 v73, v74, v74
    s_nop 1
    v_add_f32_dpp v73, v73, v73 quad_perm:[1,0,3,2] row_mask:0xf bank_mask:0xf
    s_nop 1
    v_add_f32_dpp v73, v73, v73 quad_perm:[2,3,0,1] row_mask:0xf bank_mask:0xf
    s_nop 1
    v_add_f32_dpp v73, v73, v73 row_half_mirror row_mask:0xf bank_mask:0xf
    s_nop 1
    v_add_f32_dpp v73, v73, v73 row_mirror row_mask:0xf bank_mask:0xf
    v_mov_b32 v71, v73
    s_nop 1
    v_permlane16_swap_b32 v73, v71
    v_add_f32 v73, v73, v71
    v_mov_b32 v71, v73
    s_nop 1
    v_permlane32_swap_b32 v73, v71
    v_add_f32 v73, v73, v71
    v_mul_f32 v73, 0x3acccccd, v73
    v_cvt_pk_bf16_f32 v72, v72, v72
    v_lshlrev_b32 v72, 16, v72
    v_cvt_pk_bf16_f32 v73, v73, v73
    v_lshlrev_b32 v73, 16, v73
    v_add_f32 v73, 0x3727c5ac, v73
    v_cvt_pk_bf16_f32 v73, v73, v73
    v_lshlrev_b32 v73, 16, v73
    v_sqrt_f32 v73, v73
    s_nop 0
    v_cvt_pk_bf16_f32 v73, v73, v73
    v_lshlrev_b32 v73, 16, v73
    v_rcp_f32 v75, v73
    s_nop 0
    v_mov_b32 v76, 0
    v_sub_f32 v50, v50, v72
    v_cvt_pk_bf16_f32 v50, v50, v50
    v_lshlrev_b32 v50, 16, v50
    v_mul_f32 v74, v50, v75
    v_fma_f32 v77, -v74, v73, v50
    v_fma_f32 v50, v77, v75, v74
    v_sub_f32 v60, v60, v72
    v_cvt_pk_bf16_f32 v60, v60, v60
    v_lshlrev_b32 v60, 16, v60
    v_mul_f32 v74, v60, v75
    v_fma_f32 v77, -v74, v73, v60
    v_fma_f32 v60, v77, v75, v74
    v_cvt_pk_bf16_f32 v22, v50, v60
    v_lshlrev_b32 v74, 16, v22
    v_lshlrev_b32 v77, 16, v28
    v_fmac_f32 v76, v74, v77
    v_and_b32 v74, 0xffff0000, v22
    v_and_b32 v77, 0xffff0000, v28
    v_fmac_f32 v76, v74, v77
    v_sub_f32 v51, v51, v72
    v_cvt_pk_bf16_f32 v51, v51, v51
    v_lshlrev_b32 v51, 16, v51
    v_mul_f32 v74, v51, v75
    v_fma_f32 v77, -v74, v73, v51
    v_fma_f32 v51, v77, v75, v74
    v_sub_f32 v61, v61, v72
    v_cvt_pk_bf16_f32 v61, v61, v61
    v_lshlrev_b32 v61, 16, v61
    v_mul_f32 v74, v61, v75
    v_fma_f32 v77, -v74, v73, v61
    v_fma_f32 v61, v77, v75, v74
    v_cvt_pk_bf16_f32 v23, v51, v61
    v_lshlrev_b32 v74, 16, v23
    v_lshlrev_b32 v77, 16, v29
    v_fmac_f32 v76, v74, v77
    v_and_b32 v74, 0xffff0000, v23
    v_and_b32 v77, 0xffff0000, v29
    v_fmac_f32 v76, v74, v77
    v_sub_f32 v52, v52, v72
    v_cvt_pk_bf16_f32 v52, v52, v52
    v_lshlrev_b32 v52, 16, v52
    v_mul_f32 v74, v52, v75
    v_fma_f32 v77, -v74, v73, v52
    v_fma_f32 v52, v77, v75, v74
    v_sub_f32 v62, v62, v72
    v_cvt_pk_bf16_f32 v62, v62, v62
    v_lshlrev_b32 v62, 16, v62
    v_mul_f32 v74, v62, v75
    v_fma_f32 v77, -v74, v73, v62
    v_fma_f32 v62, v77, v75, v74
    v_cvt_pk_bf16_f32 v24, v52, v62
    v_lshlrev_b32 v74, 16, v24
    v_lshlrev_b32 v77, 16, v30
    v_fmac_f32 v76, v74, v77
    v_and_b32 v74, 0xffff0000, v24
    v_and_b32 v77, 0xffff0000, v30
    v_fmac_f32 v76, v74, v77
    v_sub_f32 v53, v53, v72
    v_cvt_pk_bf16_f32 v53, v53, v53
    v_lshlrev_b32 v53, 16, v53
    v_mul_f32 v74, v53, v75
    v_fma_f32 v77, -v74, v73, v53
    v_fma_f32 v53, v77, v75, v74
    v_sub_f32 v63, v63, v72
    v_cvt_pk_bf16_f32 v63, v63, v63
    v_lshlrev_b32 v63, 16, v63
    v_mul_f32 v74, v63, v75
    v_fma_f32 v77, -v74, v73, v63
    v_fma_f32 v63, v77, v75, v74
    v_cvt_pk_bf16_f32 v25, v53, v63
    v_lshlrev_b32 v74, 16, v25
    v_lshlrev_b32 v77, 16, v31
    v_fmac_f32 v76, v74, v77
    v_and_b32 v74, 0xffff0000, v25
    v_and_b32 v77, 0xffff0000, v31
    v_fmac_f32 v76, v74, v77
    v_sub_f32 v54, v54, v72
    v_cvt_pk_bf16_f32 v54, v54, v54
    v_lshlrev_b32 v54, 16, v54
    v_mul_f32 v74, v54, v75
    v_fma_f32 v77, -v74, v73, v54
    v_fma_f32 v54, v77, v75, v74
    v_sub_f32 v64, v64, v72
    v_cvt_pk_bf16_f32 v64, v64, v64
    v_lshlrev_b32 v64, 16, v64
    v_mul_f32 v74, v64, v75
    v_fma_f32 v77, -v74, v73, v64
    v_fma_f32 v64, v77, v75, v74
    v_cvt_pk_bf16_f32 v26, v54, v64
    v_lshlrev_b32 v74, 16, v26
    v_lshlrev_b32 v77, 16, v32
    v_fmac_f32 v76, v74, v77
    v_and_b32 v74, 0xffff0000, v26
    v_and_b32 v77, 0xffff0000, v32
    v_fmac_f32 v76, v74, v77
    s_add_u32 s30, s35, 0x0
    buffer_store_dwordx4 v[22:25], v3, s[4:7], s30 offen sc1
    buffer_store_dword v26, v4, s[4:7], s30 offen offset:1024 sc1
    s_nop 1
    v_add_f32_dpp v76, v76, v76 quad_perm:[1,0,3,2] row_mask:0xf bank_mask:0xf
    s_nop 1
    v_add_f32_dpp v76, v76, v76 quad_perm:[2,3,0,1] row_mask:0xf bank_mask:0xf
    s_nop 1
    v_add_f32_dpp v76, v76, v76 row_half_mirror row_mask:0xf bank_mask:0xf
    s_nop 1
    v_add_f32_dpp v76, v76, v76 row_mirror row_mask:0xf bank_mask:0xf
    v_mov_b32 v71, v76
    s_nop 1
    v_permlane16_swap_b32 v76, v71
    v_add_f32 v76, v76, v71
    v_mov_b32 v71, v76
    s_nop 1
    v_permlane32_swap_b32 v76, v71
    v_add_f32 v76, v76, v71
    v_cvt_pk_bf16_f32 v76, v76, v76
    v_lshlrev_b32 v76, 16, v76
    s_lshl_b32 s30, s29, 2
    s_add_u32 s30, s30, 0x280000
    s_mov_b64 exec, 1
    buffer_store_dword v76, off, s[4:7], s30 sc1
    s_mov_b64 exec, -1
INR_102:
    s_lshl_b32 s29, s96, 2
    s_add_u32 s29, s29, s14
    s_lshl_b32 s29, s29, 6
    v_add_u32 v5, s29, v0
    v_lshlrev_b32 v6, 4, v5
    v_mov_b32 v44, 0
    v_mov_b32 v45, 0
    v_mov_b32 v46, 0
    v_mov_b32 v47, 0
    v_cmp_gt_u32 vcc, 0x1000, v5
    s_nop 0
    s_and_saveexec_b64 s[38:39], vcc
    s_cbranch_execz INF_103
    s_mov_b32 s30, 0x290000
    buffer_store_dwordx4 v[44:47], v6, s[4:7], s30 offen sc1
INF_103:
    s_mov_b64 exec, s[38:39]
    s_waitcnt vmcnt(0)
    s_barrier
    s_cmp_lg_u32 s14, 0
    s_cbranch_scc1 INA_104
    v_mov_b32 v8, 1
    s_mov_b64 exec, 1
    buffer_atomic_add v8, off, s[60:63], s95 sc1
    s_mov_b64 exec, -1
INA_104:
INP2_98:
    s_lshl_b32 s29, s96, 2
    s_add_u32 s29, s29, s14
    s_lshl_b32 s29, s29, 6
    v_add_u32 v5, s29, v0
    v_lshlrev_b32 v6, 4, v5
    v_mov_b32 v40, -1
    v_mov_b32 v41, -1
    v_mov_b32 v42, -1
    v_mov_b32 v43, -1
    v_cmp_gt_u32 vcc, 0x5000, v5
    s_nop 0
    s_and_saveexec_b64 s[38:39], vcc
    s_cbranch_execz INF_105
    s_mov_b32 s30, 0x300000
    buffer_store_dwordx4 v[40:43], v6, s[4:7], s30 offen sc1
INF_105:
    s_mov_b64 exec, s[38:39]
    v_lshrrev_b32 v7, 6, v5
    v_mul_u32_u24 v7, 52429, v7
    v_lshrrev_b32 v7, 18, v7
    v_mul_u32_u24 v8, 320, v7
    v_sub_u32 v8, v5, v8
    v_lshlrev_b32 v48, 4, v8
    v_lshl_add_u32 v49, v7, 13, v48
    v_cmp_gt_u32 vcc, 0xa000, v5
    s_nop 0
    s_and_saveexec_b64 s[38:39], vcc
    s_cbranch_execz INF_106
    s_mov_b32 s30, 0x5904000
    buffer_store_dwordx4 v[40:43], v49, s[4:7], s30 offen sc1
INF_106:
    s_mov_b64 exec, s[38:39]
    s_cmp_ge_u32 s96, 10
    s_cbranch_scc1 INM1_107
    s_cmp_lg_u32 s14, 0
    s_cbranch_scc1 INM1_107
    s_cmp_ge_u32 s96, 5
    s_cselect_b32 s36, 1, 0
    s_mul_i32 s29, s36, 5
    s_sub_u32 s29, s96, s29
    s_lshl_b32 s29, s29, 10
    s_lshl_b32 s30, s36, 13
    s_add_u32 s30, s30, 0x5900000
    s_add_u32 s30, s30, s29
    buffer_store_dwordx4 v[34:37], v3, s[4:7], s30 offen sc1
INM1_107:
    s_lshl_b32 s40, s13, 8
    s_lshl_b32 s42, s14, 17
    s_add_u32 s40, s40, s42
    s_mul_i32 s41, s14, 40960
    v_lshrrev_b32 v81, 4, v0
    v_lshlrev_b32 v79, 13, v81
    v_lshlrev_b32 v81, 1, v81
    v_and_b32 v82, 15, v0
    v_xor_b32 v81, v81, v82
    v_xor_b32 v82, 8, v81
    v_lshl_add_u32 v80, v82, 4, v79
    v_lshl_add_u32 v79, v81, 4, v79
    s_add_u32 m0, s41, 0
    s_add_u32 s42, s40, 0x0
    buffer_load_dwordx4 v79, s[44:47], s42 offen lds
    s_add_u32 m0, s41, 1024
    s_add_u32 s42, s40, 0x8000
    buffer_load_dwordx4 v79, s[44:47], s42 offen lds
    s_add_u32 m0, s41, 2048
    s_add_u32 s42, s40, 0x10000
    buffer_load_dwordx4 v80, s[44:47], s42 offen lds
    s_add_u32 m0, s41, 3072
    s_add_u32 s42, s40, 0x18000
    buffer_load_dwordx4 v80, s[44:47], s42 offen lds
    s_add_u32 m0, s41, 4096
    s_add_u32 s42, s40, 0x80000
    buffer_load_dwordx4 v79, s[44:47], s42 offen lds
    s_add_u32 m0, s41, 5120
    s_add_u32 s42, s40, 0x88000
    buffer_load_dwordx4 v79, s[44:47], s42 offen lds
    s_add_u32 m0, s41, 6144
    s_add_u32 s42, s40, 0x90000
    buffer_load_dwordx4 v80, s[44:47], s42 offen lds
    s_add_u32 m0, s41, 7168
    s_add_u32 s42, s40, 0x98000
    buffer_load_dwordx4 v80, s[44:47], s42 offen lds
    s_add_u32 m0, s41, 8192
    s_add_u32 s42, s40, 0x100000
    buffer_load_dwordx4 v79, s[44:47], s42 offen lds
    s_add_u32 m0, s41, 9216
    s_add_u32 s42, s40, 0x108000
    buffer_load_dwordx4 v79, s[44:47], s42 offen lds
    s_add_u32 m0, s41, 10240
    s_add_u32 s42, s40, 0x110000
    buffer_load_dwordx4 v80, s[44:47], s42 offen lds
    s_add_u32 m0, s41, 11264
    s_add_u32 s42, s40, 0x118000
    buffer_load_dwordx4 v80, s[44:47], s42 offen lds
    s_add_u32 m0, s41, 12288
    s_add_u32 s42, s40, 0x180000
    buffer_load_dwordx4 v79, s[44:47], s42 offen lds
    s_add_u32 m0, s41, 13312
    s_add_u32 s42, s40, 0x188000
    buffer_load_dwordx4 v79, s[44:47], s42 offen lds
    s_add_u32 m0, s41, 14336
    s_add_u32 s42, s40, 0x190000
    buffer_load_dwordx4 v80, s[44:47], s42 offen lds
    s_add_u32 m0, s41, 15360
    s_add_u32 s42, s40, 0x198000
    buffer_load_dwordx4 v80, s[44:47], s42 offen lds
    s_add_u32 m0, s41, 16384
    s_add_u32 s42, s40, 0x200000
    buffer_load_dwordx4 v79, s[44:47], s42 offen lds
    s_add_u32 m0, s41, 17408
    s_add_u32 s42, s40, 0x208000
    buffer_load_dwordx4 v79, s[44:47], s42 offen lds
    s_add_u32 m0, s41, 18432
    s_add_u32 s42, s40, 0x210000
    buffer_load_dwordx4 v80, s[44:47], s42 offen lds
    s_add_u32 m0, s41, 19456
    s_add_u32 s42, s40, 0x218000
    buffer_load_dwordx4 v80, s[44:47], s42 offen lds
    s_add_u32 m0, s41, 20480
    s_add_u32 s42, s40, 0x280000
    buffer_load_dwordx4 v79, s[44:47], s42 offen lds
    s_add_u32 m0, s41, 21504
    s_add_u32 s42, s40, 0x288000
    buffer_load_dwordx4 v79, s[44:47], s42 offen lds
    s_add_u32 m0, s41, 22528
    s_add_u32 s42, s40, 0x290000
    buffer_load_dwordx4 v80, s[44:47], s42 offen lds
    s_add_u32 m0, s41, 23552
    s_add_u32 s42, s40, 0x298000
    buffer_load_dwordx4 v80, s[44:47], s42 offen lds
    s_add_u32 m0, s41, 24576
    s_add_u32 s42, s40, 0x300000
    buffer_load_dwordx4 v79, s[44:47], s42 offen lds
    s_add_u32 m0, s41, 25600
    s_add_u32 s42, s40, 0x308000
    buffer_load_dwordx4 v79, s[44:47], s42 offen lds
    s_add_u32 m0, s41, 26624
    s_add_u32 s42, s40, 0x310000
    buffer_load_dwordx4 v80, s[44:47], s42 offen lds
    s_add_u32 m0, s41, 27648
    s_add_u32 s42, s40, 0x318000
    buffer_load_dwordx4 v80, s[44:47], s42 offen lds
    s_add_u32 m0, s41, 28672
    s_add_u32 s42, s40, 0x380000
    buffer_load_dwordx4 v79, s[44:47], s42 offen lds
    s_add_u32 m0, s41, 29696
    s_add_u32 s42, s40, 0x388000
    buffer_load_dwordx4 v79, s[44:47], s42 offen lds
    s_add_u32 m0, s41, 30720
    s_add_u32 s42, s40, 0x390000
    buffer_load_dwordx4 v80, s[44:47], s42 offen lds
    s_add_u32 m0, s41, 31744
    s_add_u32 s42, s40, 0x398000
    buffer_load_dwordx4 v80, s[44:47], s42 offen lds
    s_add_u32 m0, s41, 32768
    s_add_u32 s42, s40, 0x400000
    buffer_load_dwordx4 v79, s[44:47], s42 offen lds
    s_add_u32 m0, s41, 33792
    s_add_u32 s42, s40, 0x408000
    buffer_load_dwordx4 v79, s[44:47], s42 offen lds
    s_add_u32 m0, s41, 34816
    s_add_u32 s42, s40, 0x410000
    buffer_load_dwordx4 v80, s[44:47], s42 offen lds
    s_add_u32 m0, s41, 35840
    s_add_u32 s42, s40, 0x418000
    buffer_load_dwordx4 v80, s[44:47], s42 offen lds
    s_add_u32 m0, s41, 36864
    s_add_u32 s42, s40, 0x480000
    buffer_load_dwordx4 v79, s[44:47], s42 offen lds
    s_add_u32 m0, s41, 37888
    s_add_u32 s42, s40, 0x488000
    buffer_load_dwordx4 v79, s[44:47], s42 offen lds
    s_add_u32 m0, s41, 38912
    s_add_u32 s42, s40, 0x490000
    buffer_load_dwordx4 v80, s[44:47], s42 offen lds
    s_add_u32 m0, s41, 39936
    s_add_u32 s42, s40, 0x498000
    buffer_load_dwordx4 v80, s[44:47], s42 offen lds
    v_mbcnt_lo_u32_b32 v0, -1, 0
    v_mbcnt_hi_u32_b32 v0, -1, v0
    s_cmp_eq_u32 s3, 0
    s_cbranch_scc1 H_E0
    s_cmp_eq_u32 s3, 1
    s_cbranch_scc1 H_E1
    s_cmp_eq_u32 s3, 2
    s_cbranch_scc1 H_E2
    s_branch M_EXIT
H_E0:
    s_lshl_b32 s16, s13, 14
    s_mov_b32 s17, 0x80000
    s_lshl_b32 s64, s14, 10
    s_add_u32 s16, s16, 0x1400000
    s_add_u32 s16, s16, s64
    s_mul_i32 s64, s12, s17
    s_lshl_b32 s64, s64, 2
    s_add_u32 s16, s16, s64
    s_lshl_b32 s18, s13, 4
    s_add_u32 s18, s18, 0x291000
    s_branch G_T
H_E1:
    s_lshl_b32 s16, s13, 14
    s_mov_b32 s17, 0x80000
    s_lshl_b32 s64, s14, 11
    s_add_u32 s16, s16, 0x1402000
    s_add_u32 s16, s16, s64
    s_mul_i32 s64, s12, s17
    s_lshl_b32 s64, s64, 2
    s_add_u32 s16, s16, s64
    s_lshl_b32 s18, s13, 4
    s_add_u32 s18, s18, 0x291004
    s_branch G_N
H_E2:
    s_lshl_b32 s16, s13, 13
    s_mov_b32 s17, 0x40000
    s_lshl_b32 s64, s14, 10
    s_add_u32 s16, s16, 0x3400000
    s_add_u32 s16, s16, s64
    s_mul_i32 s64, s12, s17
    s_lshl_b32 s64, s64, 2
    s_add_u32 s16, s16, s64
    s_lshl_b32 s18, s13, 4
    s_add_u32 s18, s18, 0x291008
    s_branch G_T
G_T:
    v_lshrrev_b32 v6, 5, v0
    v_mul_u32_u24 v7, 40960, v6
    v_bfe_u32 v6, v0, 4, 1
    v_lshl_add_u32 v7, v6, 11, v7
    v_lshlrev_b32 v8, 3, v6
    v_bfe_u32 v6, v0, 2, 2
    v_lshl_add_u32 v7, v6, 8, v7
    v_lshl_add_u32 v8, v6, 1, v8
    v_and_b32 v6, 1, v0
    v_lshl_add_u32 v7, v6, 3, v7
    v_bfe_u32 v6, v0, 1, 1
    s_lshl_b32 s64, s14, 2
    v_add_u32 v10, s64, v6
    v_add_u32 v6, 0, v10
    v_xor_b32 v6, v6, v8
    v_lshl_add_u32 v3, v6, 4, v7
    v_add_u32 v4, 81920, v3
    v_add_u32 v6, 2, v10
    v_xor_b32 v6, v6, v8
    v_lshl_add_u32 v5, v6, 4, v7
    v_add_u32 v9, 81920, v5
    s_waitcnt vmcnt(0)
    s_barrier
    ds_read_b64_tr_b16 v[96:97], v3 offset:0
    ds_read_b64_tr_b16 v[98:99], v3 offset:1024
    ds_read_b64_tr_b16 v[100:101], v5 offset:0
    ds_read_b64_tr_b16 v[102:103], v5 offset:1024
    ds_read_b64_tr_b16 v[104:105], v4 offset:0
    ds_read_b64_tr_b16 v[106:107], v4 offset:1024
    ds_read_b64_tr_b16 v[108:109], v9 offset:0
    ds_read_b64_tr_b16 v[110:111], v9 offset:1024
    ds_read_b64_tr_b16 v[112:113], v3 offset:4096
    ds_read_b64_tr_b16 v[114:115], v3 offset:5120
    ds_read_b64_tr_b16 v[116:117], v5 offset:4096
    ds_read_b64_tr_b16 v[118:119], v5 offset:5120
    ds_read_b64_tr_b16 v[120:121], v4 offset:4096
    ds_read_b64_tr_b16 v[122:123], v4 offset:5120
    ds_read_b64_tr_b16 v[124:125], v9 offset:4096
    ds_read_b64_tr_b16 v[126:127], v9 offset:5120
    s_waitcnt lgkmcnt(4)
    ds_read_b64_tr_b16 v[128:129], v3 offset:8192
    ds_read_b64_tr_b16 v[130:131], v3 offset:9216
    ds_read_b64_tr_b16 v[132:133], v5 offset:8192
    ds_read_b64_tr_b16 v[134:135], v5 offset:9216
    ds_read_b64_tr_b16 v[136:137], v4 offset:8192
    ds_read_b64_tr_b16 v[138:139], v4 offset:9216
    ds_read_b64_tr_b16 v[140:141], v9 offset:8192
    ds_read_b64_tr_b16 v[142:143], v9 offset:9216
    ds_read_b64_tr_b16 v[144:145], v3 offset:12288
    ds_read_b64_tr_b16 v[146:147], v3 offset:13312
    ds_read_b64_tr_b16 v[148:149], v5 offset:12288
    ds_read_b64_tr_b16 v[150:151], v5 offset:13312
    ds_read_b64_tr_b16 v[152:153], v4 offset:12288
    ds_read_b64_tr_b16 v[154:155], v4 offset:13312
    ds_read_b64_tr_b16 v[156:157], v9 offset:12288
    ds_read_b64_tr_b16 v[158:159], v9 offset:13312
    s_waitcnt lgkmcnt(4)
    ds_read_b64_tr_b16 v[160:161], v3 offset:16384
    ds_read_b64_tr_b16 v[162:163], v3 offset:17408
    ds_read_b64_tr_b16 v[164:165], v5 offset:16384
    ds_read_b64_tr_b16 v[166:167], v5 offset:17408
    ds_read_b64_tr_b16 v[168:169], v4 offset:16384
    ds_read_b64_tr_b16 v[170:171], v4 offset:17408
    ds_read_b64_tr_b16 v[172:173], v9 offset:16384
    ds_read_b64_tr_b16 v[174:175], v9 offset:17408
    ds_read_b64_tr_b16 v[176:177], v3 offset:20480
    ds_read_b64_tr_b16 v[178:179], v3 offset:21504
    ds_read_b64_tr_b16 v[180:181], v5 offset:20480
    ds_read_b64_tr_b16 v[182:183], v5 offset:21504
    ds_read_b64_tr_b16 v[184:185], v4 offset:20480
    ds_read_b64_tr_b16 v[186:187], v4 offset:21504
    ds_read_b64_tr_b16 v[188:189], v9 offset:20480
    ds_read_b64_tr_b16 v[190:191], v9 offset:21504
    s_waitcnt lgkmcnt(4)
    ds_read_b64_tr_b16 v[192:193], v3 offset:24576
    ds_read_b64_tr_b16 v[194:195], v3 offset:25600
    ds_read_b64_tr_b16 v[196:197], v5 offset:24576
    ds_read_b64_tr_b16 v[198:199], v5 offset:25600
    ds_read_b64_tr_b16 v[200:201], v4 offset:24576
    ds_read_b64_tr_b16 v[202:203], v4 offset:25600
    ds_read_b64_tr_b16 v[204:205], v9 offset:24576
    ds_read_b64_tr_b16 v[206:207], v9 offset:25600
    ds_read_b64_tr_b16 v[208:209], v3 offset:28672
    ds_read_b64_tr_b16 v[210:211], v3 offset:29696
    ds_read_b64_tr_b16 v[212:213], v5 offset:28672
    ds_read_b64_tr_b16 v[214:215], v5 offset:29696
    ds_read_b64_tr_b16 v[216:217], v4 offset:28672
    ds_read_b64_tr_b16 v[218:219], v4 offset:29696
    ds_read_b64_tr_b16 v[220:221], v9 offset:28672
    ds_read_b64_tr_b16 v[222:223], v9 offset:29696
    s_waitcnt lgkmcnt(4)
    ds_read_b64_tr_b16 v[224:225], v3 offset:32768
    ds_read_b64_tr_b16 v[226:227], v3 offset:33792
    ds_read_b64_tr_b16 v[228:229], v5 offset:32768
    ds_read_b64_tr_b16 v[230:231], v5 offset:33792
    ds_read_b64_tr_b16 v[232:233], v4 offset:32768
    ds_read_b64_tr_b16 v[234:235], v4 offset:33792
    ds_read_b64_tr_b16 v[236:237], v9 offset:32768
    ds_read_b64_tr_b16 v[238:239], v9 offset:33792
    ds_read_b64_tr_b16 v[240:241], v3 offset:36864
    ds_read_b64_tr_b16 v[242:243], v3 offset:37888
    ds_read_b64_tr_b16 v[244:245], v5 offset:36864
    ds_read_b64_tr_b16 v[246:247], v5 offset:37888
    ds_read_b64_tr_b16 v[248:249], v4 offset:36864
    ds_read_b64_tr_b16 v[250:251], v4 offset:37888
    ds_read_b64_tr_b16 v[252:253], v9 offset:36864
    ds_read_b64_tr_b16 v[254:255], v9 offset:37888
    s_waitcnt lgkmcnt(0)
    s_cmp_lg_u32 s97, 0
    s_cbranch_scc1 CM_108
    v_mbcnt_lo_u32_b32 v0, -1, 0
    v_mbcnt_hi_u32_b32 v0, -1, v0
    v_mul_u32_u24 v8, 32, v0
    s_mov_b32 s64, 0x0
    s_mov_b32 s65, 0
    s_mov_b64 exec, 0xff
TK_109:
    buffer_load_dword v9, v8, s[60:63], s64 offen sc1
    s_add_u32 s65, s65, 1
    s_waitcnt vmcnt(0)
    s_mov_b32 s66, 0
    v_readlane_b32 s67, v9, 0
    s_add_u32 s66, s66, s67
    v_readlane_b32 s67, v9, 1
    s_add_u32 s66, s66, s67
    v_readlane_b32 s67, v9, 2
    s_add_u32 s66, s66, s67
    v_readlane_b32 s67, v9, 3
    s_add_u32 s66, s66, s67
    v_readlane_b32 s67, v9, 4
    s_add_u32 s66, s66, s67
    v_readlane_b32 s67, v9, 5
    s_add_u32 s66, s66, s67
    v_readlane_b32 s67, v9, 6
    s_add_u32 s66, s66, s67
    v_readlane_b32 s67, v9, 7
    s_add_u32 s66, s66, s67
    s_cmp_ge_u32 s66, 256
    s_cbranch_scc1 TKD_110
    s_cmp_gt_u32 s65, 262144
    s_cbranch_scc0 TK_109
TKD_110:
    v_cmp_ne_u32 vcc, 32, v9
    s_mov_b64 exec, -1
    s_cbranch_vccnz M_SLOW
CM_108:
    s_mov_b32 s65, 0
GI_111:
    buffer_load_dword v8, off, s[60:63], s95 sc1
    s_add_u32 s65, s65, 1
    s_waitcnt vmcnt(0)
    v_readfirstlane_b32 s64, v8
    s_cmp_ge_u32 s64, 186
    s_cbranch_scc1 GID_112
    s_cmp_gt_u32 s65, 65536
    s_cbranch_scc1 GID_112
    s_sleep 4
    s_branch GI_111
GID_112:
    v_mbcnt_lo_u32_b32 v0, -1, 0
    v_mbcnt_hi_u32_b32 v0, -1, v0
    s_mov_b32 s65, 0
CW_113:
    buffer_load_dwordx2 v[8:9], off, s[60:63], 0 offset:132 sc1
    s_add_u32 s65, s65, 1
    s_waitcnt vmcnt(0)
    v_readfirstlane_b32 s30, v8
    v_readfirstlane_b32 s31, v9
    s_min_u32 s64, s30, s31
    s_cmp_lg_u32 s64, 0
    s_cbranch_scc1 CWD_114
    s_cmp_gt_u32 s65, 65536
    s_cbranch_scc1 CWD_114
    s_sleep 4
    s_branch CW_113
CWD_114:
    s_sub_u32 s30, s30, 1
    s_and_b32 s30, s30, 3
    s_sub_u32 s31, s31, 1
    s_and_b32 s31, s31, 3
    s_lshl_b32 s34, s96, 2
    s_add_u32 s34, s34, s14
    s_lshl_b32 s34, s34, 6
    v_add_u32 v5, s34, v0
    v_lshlrev_b32 v3, 4, v0
    v_mov_b32 v40, -1
    v_mov_b32 v41, -1
    v_mov_b32 v42, -1
    v_mov_b32 v43, -1
    v_lshrrev_b32 v7, 6, v5
    v_mul_u32_u24 v7, 52429, v7
    v_lshrrev_b32 v7, 18, v7
    v_mul_u32_u24 v8, 320, v7
    v_sub_u32 v8, v5, v8
    v_lshlrev_b32 v48, 4, v8
    s_lshl_b32 s30, s30, 13
    s_lshl_b32 s31, s31, 13
    s_add_u32 s31, s31, 0x200000
    v_and_b32 v8, 1, v7
    v_cmp_eq_u32 vcc, 1, v8
    v_mov_b32 v8, s30
    v_mov_b32 v9, s31
    v_cndmask_b32 v8, v8, v9, vcc
    v_lshrrev_b32 v9, 1, v7
    v_lshl_add_u32 v8, v9, 15, v8
    v_add_u32 v49, v8, v48
    v_cmp_le_u32 vcc, 640, v5
    v_mov_b32 v9, 0x40000000
    s_nop 0
    v_cndmask_b32 v49, v9, v49, vcc
    v_cmp_gt_u32 vcc, 0xa000, v5
    s_nop 0
    s_and_saveexec_b64 s[38:39], vcc
    s_cbranch_execz INF_115
    s_mov_b32 s35, 0x6000000
    buffer_store_dwordx4 v[40:43], v49, s[4:7], s35 offen sc1
INF_115:
    s_mov_b64 exec, s[38:39]
    s_cmp_ge_u32 s96, 10
    s_cbranch_scc1 INM2_116
    s_cmp_lg_u32 s14, 1
    s_cbranch_scc1 INM2_116
    s_cmp_ge_u32 s96, 5
    s_cselect_b32 s36, 1, 0
    s_mul_i32 s34, s36, 5
    s_sub_u32 s34, s96, s34
    s_lshl_b32 s34, s34, 10
    s_cmp_eq_u32 s36, 0
    s_cselect_b32 s37, s30, s31
    s_add_u32 s37, s37, 0x6000000
    s_add_u32 s37, s37, s34
    buffer_store_dwordx4 v[34:37], v3, s[4:7], s37 offen sc1
INM2_116:
    s_cmp_lg_u32 s3, 2
    s_cbranch_scc1 NOSEL_117
    s_or_b32 s64, s13, s12
    s_or_b32 s64, s64, s14
    s_cmp_lg_u32 s64, 0
    s_cbranch_scc1 NOSEL_117
    s_mov_b32 s29, 0
    v_lshlrev_b32 v1, 4, v0
    s_mov_b32 s64, 0x280000
    buffer_load_dwordx4 v[16:19], v1, s[4:7], s64 offen offset:0 sc1
    buffer_load_dwordx4 v[20:23], v1, s[4:7], s64 offen offset:1024 sc1
    buffer_load_dwordx4 v[24:27], v1, s[4:7], s64 offen offset:2048 sc1
    buffer_load_dwordx4 v[28:31], v1, s[4:7], s64 offen offset:3072 sc1
    s_add_u32 s64, s64, 4096
    buffer_load_dwordx4 v[32:35], v1, s[4:7], s64 offen offset:0 sc1
    buffer_load_dwordx4 v[36:39], v1, s[4:7], s64 offen offset:1024 sc1
    buffer_load_dwordx4 v[40:43], v1, s[4:7], s64 offen offset:2048 sc1
    buffer_load_dwordx4 v[44:47], v1, s[4:7], s64 offen offset:3072 sc1
    s_waitcnt vmcnt(0)
    v_lshlrev_b32 v2, 2, v0
    v_ashrrev_i32 v3, 31, v16
    v_or_b32 v3, 0x80000000, v3
    v_xor_b32 v16, v16, v3
    v_and_b32 v16, 0xffff0000, v16
    v_sub_u32 v3, 65535, v2
    v_or_b32 v16, v16, v3
    v_ashrrev_i32 v3, 31, v17
    v_or_b32 v3, 0x80000000, v3
    v_xor_b32 v17, v17, v3
    v_and_b32 v17, 0xffff0000, v17
    v_sub_u32 v3, 65534, v2
    v_or_b32 v17, v17, v3
    v_ashrrev_i32 v3, 31, v18
    v_or_b32 v3, 0x80000000, v3
    v_xor_b32 v18, v18, v3
    v_and_b32 v18, 0xffff0000, v18
    v_sub_u32 v3, 65533, v2
    v_or_b32 v18, v18, v3
    v_ashrrev_i32 v3, 31, v19
    v_or_b32 v3, 0x80000000, v3
    v_xor_b32 v19, v19, v3
    v_and_b32 v19, 0xffff0000, v19
    v_sub_u32 v3, 65532, v2
    v_or_b32 v19, v19, v3
    v_ashrrev_i32 v3, 31, v20
    v_or_b32 v3, 0x80000000, v3
    v_xor_b32 v20, v20, v3
    v_and_b32 v20, 0xffff0000, v20
    v_sub_u32 v3, 65279, v2
    v_or_b32 v20, v20, v3
    v_ashrrev_i32 v3, 31, v21
    v_or_b32 v3, 0x80000000, v3
    v_xor_b32 v21, v21, v3
    v_and_b32 v21, 0xffff0000, v21
    v_sub_u32 v3, 65278, v2
    v_or_b32 v21, v21, v3
    v_ashrrev_i32 v3, 31, v22
    v_or_b32 v3, 0x80000000, v3
    v_xor_b32 v22, v22, v3
    v_and_b32 v22, 0xffff0000, v22
    v_sub_u32 v3, 65277, v2
    v_or_b32 v22, v22, v3
    v_ashrrev_i32 v3, 31, v23
    v_or_b32 v3, 0x80000000, v3
    v_xor_b32 v23, v23, v3
    v_and_b32 v23, 0xffff0000, v23
    v_sub_u32 v3, 65276, v2
    v_or_b32 v23, v23, v3
    v_ashrrev_i32 v3, 31, v24
    v_or_b32 v3, 0x80000000, v3
    v_xor_b32 v24, v24, v3
    v_and_b32 v24, 0xffff0000, v24
    v_sub_u32 v3, 65023, v2
    v_or_b32 v24, v24, v3
    v_ashrrev_i32 v3, 31, v25
    v_or_b32 v3, 0x80000000, v3
    v_xor_b32 v25, v25, v3
    v_and_b32 v25, 0xffff0000, v25
    v_sub_u32 v3, 65022, v2
    v_or_b32 v25, v25, v3
    v_ashrrev_i32 v3, 31, v26
    v_or_b32 v3, 0x80000000, v3
    v_xor_b32 v26, v26, v3
    v_and_b32 v26, 0xffff0000, v26
    v_sub_u32 v3, 65021, v2
    v_or_b32 v26, v26, v3
    v_ashrrev_i32 v3, 31, v27
    v_or_b32 v3, 0x80000000, v3
    v_xor_b32 v27, v27, v3
    v_and_b32 v27, 0xffff0000, v27
    v_sub_u32 v3, 65020, v2
    v_or_b32 v27, v27, v3
    v_ashrrev_i32 v3, 31, v28
    v_or_b32 v3, 0x80000000, v3
    v_xor_b32 v28, v28, v3
    v_and_b32 v28, 0xffff0000, v28
    v_sub_u32 v3, 64767, v2
    v_or_b32 v28, v28, v3
    v_ashrrev_i32 v3, 31, v29
    v_or_b32 v3, 0x80000000, v3
    v_xor_b32 v29, v29, v3
    v_and_b32 v29, 0xffff0000, v29
    v_sub_u32 v3, 64766, v2
    v_or_b32 v29, v29, v3
    v_ashrrev_i32 v3, 31, v30
    v_or_b32 v3, 0x80000000, v3
    v_xor_b32 v30, v30, v3
    v_and_b32 v30, 0xffff0000, v30
    v_sub_u32 v3, 64765, v2
    v_or_b32 v30, v30, v3
    v_ashrrev_i32 v3, 31, v31
    v_or_b32 v3, 0x80000000, v3
    v_xor_b32 v31, v31, v3
    v_and_b32 v31, 0xffff0000, v31
    v_sub_u32 v3, 64764, v2
    v_or_b32 v31, v31, v3
    v_ashrrev_i32 v3, 31, v32
    v_or_b32 v3, 0x80000000, v3
    v_xor_b32 v32, v32, v3
    v_and_b32 v32, 0xffff0000, v32
    v_sub_u32 v3, 64511, v2
    v_or_b32 v32, v32, v3
    v_ashrrev_i32 v3, 31, v33
    v_or_b32 v3, 0x80000000, v3
    v_xor_b32 v33, v33, v3
    v_and_b32 v33, 0xffff0000, v33
    v_sub_u32 v3, 64510, v2
    v_or_b32 v33, v33, v3
    v_ashrrev_i32 v3, 31, v34
    v_or_b32 v3, 0x80000000, v3
    v_xor_b32 v34, v34, v3
    v_and_b32 v34, 0xffff0000, v34
    v_sub_u32 v3, 64509, v2
    v_or_b32 v34, v34, v3
    v_ashrrev_i32 v3, 31, v35
    v_or_b32 v3, 0x80000000, v3
    v_xor_b32 v35, v35, v3
    v_and_b32 v35, 0xffff0000, v35
    v_sub_u32 v3, 64508, v2
    v_or_b32 v35, v35, v3
    v_ashrrev_i32 v3, 31, v36
    v_or_b32 v3, 0x80000000, v3
    v_xor_b32 v36, v36, v3
    v_and_b32 v36, 0xffff0000, v36
    v_sub_u32 v3, 64255, v2
    v_or_b32 v36, v36, v3
    v_ashrrev_i32 v3, 31, v37
    v_or_b32 v3, 0x80000000, v3
    v_xor_b32 v37, v37, v3
    v_and_b32 v37, 0xffff0000, v37
    v_sub_u32 v3, 64254, v2
    v_or_b32 v37, v37, v3
    v_ashrrev_i32 v3, 31, v38
    v_or_b32 v3, 0x80000000, v3
    v_xor_b32 v38, v38, v3
    v_and_b32 v38, 0xffff0000, v38
    v_sub_u32 v3, 64253, v2
    v_or_b32 v38, v38, v3
    v_ashrrev_i32 v3, 31, v39
    v_or_b32 v3, 0x80000000, v3
    v_xor_b32 v39, v39, v3
    v_and_b32 v39, 0xffff0000, v39
    v_sub_u32 v3, 64252, v2
    v_or_b32 v39, v39, v3
    v_ashrrev_i32 v3, 31, v40
    v_or_b32 v3, 0x80000000, v3
    v_xor_b32 v40, v40, v3
    v_and_b32 v40, 0xffff0000, v40
    v_sub_u32 v3, 63999, v2
    v_or_b32 v40, v40, v3
    v_ashrrev_i32 v3, 31, v41
    v_or_b32 v3, 0x80000000, v3
    v_xor_b32 v41, v41, v3
    v_and_b32 v41, 0xffff0000, v41
    v_sub_u32 v3, 63998, v2
    v_or_b32 v41, v41, v3
    v_ashrrev_i32 v3, 31, v42
    v_or_b32 v3, 0x80000000, v3
    v_xor_b32 v42, v42, v3
    v_and_b32 v42, 0xffff0000, v42
    v_sub_u32 v3, 63997, v2
    v_or_b32 v42, v42, v3
    v_ashrrev_i32 v3, 31, v43
    v_or_b32 v3, 0x80000000, v3
    v_xor_b32 v43, v43, v3
    v_and_b32 v43, 0xffff0000, v43
    v_sub_u32 v3, 63996, v2
    v_or_b32 v43, v43, v3
    v_ashrrev_i32 v3, 31, v44
    v_or_b32 v3, 0x80000000, v3
    v_xor_b32 v44, v44, v3
    v_and_b32 v44, 0xffff0000, v44
    v_sub_u32 v3, 63743, v2
    v_or_b32 v44, v44, v3
    v_ashrrev_i32 v3, 31, v45
    v_or_b32 v3, 0x80000000, v3
    v_xor_b32 v45, v45, v3
    v_and_b32 v45, 0xffff0000, v45
    v_sub_u32 v3, 63742, v2
    v_or_b32 v45, v45, v3
    v_ashrrev_i32 v3, 31, v46
    v_or_b32 v3, 0x80000000, v3
    v_xor_b32 v46, v46, v3
    v_and_b32 v46, 0xffff0000, v46
    v_sub_u32 v3, 63741, v2
    v_or_b32 v46, v46, v3
    v_ashrrev_i32 v3, 31, v47
    v_or_b32 v3, 0x80000000, v3
    v_xor_b32 v47, v47, v3
    v_and_b32 v47, 0xffff0000, v47
    v_sub_u32 v3, 63740, v2
    v_or_b32 v47, v47, v3
    v_max3_u32 v4, v16, v17, v18
    v_max3_u32 v4, v4, v19, v20
    v_max3_u32 v4, v4, v21, v22
    v_max3_u32 v4, v4, v23, v24
    v_max3_u32 v4, v4, v25, v26
    v_max3_u32 v4, v4, v27, v28
    v_max3_u32 v4, v4, v29, v30
    v_max3_u32 v4, v4, v31, v32
    v_max3_u32 v4, v4, v33, v34
    v_max3_u32 v4, v4, v35, v36
    v_max3_u32 v4, v4, v37, v38
    v_max3_u32 v4, v4, v39, v40
    v_max3_u32 v4, v4, v41, v42
    v_max3_u32 v4, v4, v43, v44
    v_max3_u32 v4, v4, v45, v46
    v_max_u32 v4, v4, v47
    s_nop 1
    v_max_u32_dpp v4, v4, v4 quad_perm:[1,0,3,2] row_mask:0xf bank_mask:0xf
    s_nop 1
    v_max_u32_dpp v4, v4, v4 quad_perm:[2,3,0,1] row_mask:0xf bank_mask:0xf
    s_nop 1
    v_max_u32_dpp v4, v4, v4 row_half_mirror row_mask:0xf bank_mask:0xf
    s_nop 1
    v_max_u32_dpp v4, v4, v4 row_mirror row_mask:0xf bank_mask:0xf
    v_mov_b32 v5, v4
    s_nop 1
    v_permlane16_swap_b32 v4, v5
    v_max_u32 v4, v4, v5
    v_mov_b32 v5, v4
    s_nop 1
    v_permlane32_swap_b32 v4, v5
    v_max_u32 v4, v4, v5
    v_mov_b32 v56, v4
    v_cmp_eq_u32 vcc, v4, v16
    s_nop 1
    v_cndmask_b32 v16, v16, 0, vcc
    v_cmp_eq_u32 vcc, v4, v17
    s_nop 1
    v_cndmask_b32 v17, v17, 0, vcc
    v_cmp_eq_u32 vcc, v4, v18
    s_nop 1
    v_cndmask_b32 v18, v18, 0, vcc
    v_cmp_eq_u32 vcc, v4, v19
    s_nop 1
    v_cndmask_b32 v19, v19, 0, vcc
    v_cmp_eq_u32 vcc, v4, v20
    s_nop 1
    v_cndmask_b32 v20, v20, 0, vcc
    v_cmp_eq_u32 vcc, v4, v21
    s_nop 1
    v_cndmask_b32 v21, v21, 0, vcc
    v_cmp_eq_u32 vcc, v4, v22
    s_nop 1
    v_cndmask_b32 v22, v22, 0, vcc
    v_cmp_eq_u32 vcc, v4, v23
    s_nop 1
    v_cndmask_b32 v23, v23, 0, vcc
    v_cmp_eq_u32 vcc, v4, v24
    s_nop 1
    v_cndmask_b32 v24, v24, 0, vcc
    v_cmp_eq_u32 vcc, v4, v25
    s_nop 1
    v_cndmask_b32 v25, v25, 0, vcc
    v_cmp_eq_u32 vcc, v4, v26
    s_nop 1
    v_cndmask_b32 v26, v26, 0, vcc
    v_cmp_eq_u32 vcc, v4, v27
    s_nop 1
    v_cndmask_b32 v27, v27, 0, vcc
    v_cmp_eq_u32 vcc, v4, v28
    s_nop 1
    v_cndmask_b32 v28, v28, 0, vcc
    v_cmp_eq_u32 vcc, v4, v29
    s_nop 1
    v_cndmask_b32 v29, v29, 0, vcc
    v_cmp_eq_u32 vcc, v4, v30
    s_nop 1
    v_cndmask_b32 v30, v30, 0, vcc
    v_cmp_eq_u32 vcc, v4, v31
    s_nop 1
    v_cndmask_b32 v31, v31, 0, vcc
    v_cmp_eq_u32 vcc, v4, v32
    s_nop 1
    v_cndmask_b32 v32, v32, 0, vcc
    v_cmp_eq_u32 vcc, v4, v33
    s_nop 1
    v_cndmask_b32 v33, v33, 0, vcc
    v_cmp_eq_u32 vcc, v4, v34
    s_nop 1
    v_cndmask_b32 v34, v34, 0, vcc
    v_cmp_eq_u32 vcc, v4, v35
    s_nop 1
    v_cndmask_b32 v35, v35, 0, vcc
    v_cmp_eq_u32 vcc, v4, v36
    s_nop 1
    v_cndmask_b32 v36, v36, 0, vcc
    v_cmp_eq_u32 vcc, v4, v37
    s_nop 1
    v_cndmask_b32 v37, v37, 0, vcc
    v_cmp_eq_u32 vcc, v4, v38
    s_nop 1
    v_cndmask_b32 v38, v38, 0, vcc
    v_cmp_eq_u32 vcc, v4, v39
    s_nop 1
    v_cndmask_b32 v39, v39, 0, vcc
    v_cmp_eq_u32 vcc, v4, v40
    s_nop 1
    v_cndmask_b32 v40, v40, 0, vcc
    v_cmp_eq_u32 vcc, v4, v41
    s_nop 1
    v_cndmask_b32 v41, v41, 0, vcc
    v_cmp_eq_u32 vcc, v4, v42
    s_nop 1
    v_cndmask_b32 v42, v42, 0, vcc
    v_cmp_eq_u32 vcc, v4, v43
    s_nop 1
    v_cndmask_b32 v43, v43, 0, vcc
    v_cmp_eq_u32 vcc, v4, v44
    s_nop 1
    v_cndmask_b32 v44, v44, 0, vcc
    v_cmp_eq_u32 vcc, v4, v45
    s_nop 1
    v_cndmask_b32 v45, v45, 0, vcc
    v_cmp_eq_u32 vcc, v4, v46
    s_nop 1
    v_cndmask_b32 v46, v46, 0, vcc
    v_cmp_eq_u32 vcc, v4, v47
    s_nop 1
    v_cndmask_b32 v47, v47, 0, vcc
    v_max3_u32 v4, v16, v17, v18
    v_max3_u32 v4, v4, v19, v20
    v_max3_u32 v4, v4, v21, v22
    v_max3_u32 v4, v4, v23, v24
    v_max3_u32 v4, v4, v25, v26
    v_max3_u32 v4, v4, v27, v28
    v_max3_u32 v4, v4, v29, v30
    v_max3_u32 v4, v4, v31, v32
    v_max3_u32 v4, v4, v33, v34
    v_max3_u32 v4, v4, v35, v36
    v_max3_u32 v4, v4, v37, v38
    v_max3_u32 v4, v4, v39, v40
    v_max3_u32 v4, v4, v41, v42
    v_max3_u32 v4, v4, v43, v44
    v_max3_u32 v4, v4, v45, v46
    v_max_u32 v4, v4, v47
    s_nop 1
    v_max_u32_dpp v4, v4, v4 quad_perm:[1,0,3,2] row_mask:0xf bank_mask:0xf
    s_nop 1
    v_max_u32_dpp v4, v4, v4 quad_perm:[2,3,0,1] row_mask:0xf bank_mask:0xf
    s_nop 1
    v_max_u32_dpp v4, v4, v4 row_half_mirror row_mask:0xf bank_mask:0xf
    s_nop 1
    v_max_u32_dpp v4, v4, v4 row_mirror row_mask:0xf bank_mask:0xf
    v_mov_b32 v5, v4
    s_nop 1
    v_permlane16_swap_b32 v4, v5
    v_max_u32 v4, v4, v5
    v_mov_b32 v5, v4
    s_nop 1
    v_permlane32_swap_b32 v4, v5
    v_max_u32 v4, v4, v5
    v_mov_b32 v57, v4
    v_cmp_eq_u32 vcc, v4, v16
    s_nop 1
    v_cndmask_b32 v16, v16, 0, vcc
    v_cmp_eq_u32 vcc, v4, v17
    s_nop 1
    v_cndmask_b32 v17, v17, 0, vcc
    v_cmp_eq_u32 vcc, v4, v18
    s_nop 1
    v_cndmask_b32 v18, v18, 0, vcc
    v_cmp_eq_u32 vcc, v4, v19
    s_nop 1
    v_cndmask_b32 v19, v19, 0, vcc
    v_cmp_eq_u32 vcc, v4, v20
    s_nop 1
    v_cndmask_b32 v20, v20, 0, vcc
    v_cmp_eq_u32 vcc, v4, v21
    s_nop 1
    v_cndmask_b32 v21, v21, 0, vcc
    v_cmp_eq_u32 vcc, v4, v22
    s_nop 1
    v_cndmask_b32 v22, v22, 0, vcc
    v_cmp_eq_u32 vcc, v4, v23
    s_nop 1
    v_cndmask_b32 v23, v23, 0, vcc
    v_cmp_eq_u32 vcc, v4, v24
    s_nop 1
    v_cndmask_b32 v24, v24, 0, vcc
    v_cmp_eq_u32 vcc, v4, v25
    s_nop 1
    v_cndmask_b32 v25, v25, 0, vcc
    v_cmp_eq_u32 vcc, v4, v26
    s_nop 1
    v_cndmask_b32 v26, v26, 0, vcc
    v_cmp_eq_u32 vcc, v4, v27
    s_nop 1
    v_cndmask_b32 v27, v27, 0, vcc
    v_cmp_eq_u32 vcc, v4, v28
    s_nop 1
    v_cndmask_b32 v28, v28, 0, vcc
    v_cmp_eq_u32 vcc, v4, v29
    s_nop 1
    v_cndmask_b32 v29, v29, 0, vcc
    v_cmp_eq_u32 vcc, v4, v30
    s_nop 1
    v_cndmask_b32 v30, v30, 0, vcc
    v_cmp_eq_u32 vcc, v4, v31
    s_nop 1
    v_cndmask_b32 v31, v31, 0, vcc
    v_cmp_eq_u32 vcc, v4, v32
    s_nop 1
    v_cndmask_b32 v32, v32, 0, vcc
    v_cmp_eq_u32 vcc, v4, v33
    s_nop 1
    v_cndmask_b32 v33, v33, 0, vcc
    v_cmp_eq_u32 vcc, v4, v34
    s_nop 1
    v_cndmask_b32 v34, v34, 0, vcc
    v_cmp_eq_u32 vcc, v4, v35
    s_nop 1
    v_cndmask_b32 v35, v35, 0, vcc
    v_cmp_eq_u32 vcc, v4, v36
    s_nop 1
    v_cndmask_b32 v36, v36, 0, vcc
    v_cmp_eq_u32 vcc, v4, v37
    s_nop 1
    v_cndmask_b32 v37, v37, 0, vcc
    v_cmp_eq_u32 vcc, v4, v38
    s_nop 1
    v_cndmask_b32 v38, v38, 0, vcc
    v_cmp_eq_u32 vcc, v4, v39
    s_nop 1
    v_cndmask_b32 v39, v39, 0, vcc
    v_cmp_eq_u32 vcc, v4, v40
    s_nop 1
    v_cndmask_b32 v40, v40, 0, vcc
    v_cmp_eq_u32 vcc, v4, v41
    s_nop 1
    v_cndmask_b32 v41, v41, 0, vcc
    v_cmp_eq_u32 vcc, v4, v42
    s_nop 1
    v_cndmask_b32 v42, v42, 0, vcc
    v_cmp_eq_u32 vcc, v4, v43
    s_nop 1
    v_cndmask_b32 v43, v43, 0, vcc
    v_cmp_eq_u32 vcc, v4, v44
    s_nop 1
    v_cndmask_b32 v44, v44, 0, vcc
    v_cmp_eq_u32 vcc, v4, v45
    s_nop 1
    v_cndmask_b32 v45, v45, 0, vcc
    v_cmp_eq_u32 vcc, v4, v46
    s_nop 1
    v_cndmask_b32 v46, v46, 0, vcc
    v_cmp_eq_u32 vcc, v4, v47
    s_nop 1
    v_cndmask_b32 v47, v47, 0, vcc
    v_max3_u32 v4, v16, v17, v18
    v_max3_u32 v4, v4, v19, v20
    v_max3_u32 v4, v4, v21, v22
    v_max3_u32 v4, v4, v23, v24
    v_max3_u32 v4, v4, v25, v26
    v_max3_u32 v4, v4, v27, v28
    v_max3_u32 v4, v4, v29, v30
    v_max3_u32 v4, v4, v31, v32
    v_max3_u32 v4, v4, v33, v34
    v_max3_u32 v4, v4, v35, v36
    v_max3_u32 v4, v4, v37, v38
    v_max3_u32 v4, v4, v39, v40
    v_max3_u32 v4, v4, v41, v42
    v_max3_u32 v4, v4, v43, v44
    v_max3_u32 v4, v4, v45, v46
    v_max_u32 v4, v4, v47
    s_nop 1
    v_max_u32_dpp v4, v4, v4 quad_perm:[1,0,3,2] row_mask:0xf bank_mask:0xf
    s_nop 1
    v_max_u32_dpp v4, v4, v4 quad_perm:[2,3,0,1] row_mask:0xf bank_mask:0xf
    s_nop 1
    v_max_u32_dpp v4, v4, v4 row_half_mirror row_mask:0xf bank_mask:0xf
    s_nop 1
    v_max_u32_dpp v4, v4, v4 row_mirror row_mask:0xf bank_mask:0xf
    v_mov_b32 v5, v4
    s_nop 1
    v_permlane16_swap_b32 v4, v5
    v_max_u32 v4, v4, v5
    v_mov_b32 v5, v4
    s_nop 1
    v_permlane32_swap_b32 v4, v5
    v_max_u32 v4, v4, v5
    v_mov_b32 v58, v4
    v_cmp_eq_u32 vcc, v4, v16
    s_nop 1
    v_cndmask_b32 v16, v16, 0, vcc
    v_cmp_eq_u32 vcc, v4, v17
    s_nop 1
    v_cndmask_b32 v17, v17, 0, vcc
    v_cmp_eq_u32 vcc, v4, v18
    s_nop 1
    v_cndmask_b32 v18, v18, 0, vcc
    v_cmp_eq_u32 vcc, v4, v19
    s_nop 1
    v_cndmask_b32 v19, v19, 0, vcc
    v_cmp_eq_u32 vcc, v4, v20
    s_nop 1
    v_cndmask_b32 v20, v20, 0, vcc
    v_cmp_eq_u32 vcc, v4, v21
    s_nop 1
    v_cndmask_b32 v21, v21, 0, vcc
    v_cmp_eq_u32 vcc, v4, v22
    s_nop 1
    v_cndmask_b32 v22, v22, 0, vcc
    v_cmp_eq_u32 vcc, v4, v23
    s_nop 1
    v_cndmask_b32 v23, v23, 0, vcc
    v_cmp_eq_u32 vcc, v4, v24
    s_nop 1
    v_cndmask_b32 v24, v24, 0, vcc
    v_cmp_eq_u32 vcc, v4, v25
    s_nop 1
    v_cndmask_b32 v25, v25, 0, vcc
    v_cmp_eq_u32 vcc, v4, v26
    s_nop 1
    v_cndmask_b32 v26, v26, 0, vcc
    v_cmp_eq_u32 vcc, v4, v27
    s_nop 1
    v_cndmask_b32 v27, v27, 0, vcc
    v_cmp_eq_u32 vcc, v4, v28
    s_nop 1
    v_cndmask_b32 v28, v28, 0, vcc
    v_cmp_eq_u32 vcc, v4, v29
    s_nop 1
    v_cndmask_b32 v29, v29, 0, vcc
    v_cmp_eq_u32 vcc, v4, v30
    s_nop 1
    v_cndmask_b32 v30, v30, 0, vcc
    v_cmp_eq_u32 vcc, v4, v31
    s_nop 1
    v_cndmask_b32 v31, v31, 0, vcc
    v_cmp_eq_u32 vcc, v4, v32
    s_nop 1
    v_cndmask_b32 v32, v32, 0, vcc
    v_cmp_eq_u32 vcc, v4, v33
    s_nop 1
    v_cndmask_b32 v33, v33, 0, vcc
    v_cmp_eq_u32 vcc, v4, v34
    s_nop 1
    v_cndmask_b32 v34, v34, 0, vcc
    v_cmp_eq_u32 vcc, v4, v35
    s_nop 1
    v_cndmask_b32 v35, v35, 0, vcc
    v_cmp_eq_u32 vcc, v4, v36
    s_nop 1
    v_cndmask_b32 v36, v36, 0, vcc
    v_cmp_eq_u32 vcc, v4, v37
    s_nop 1
    v_cndmask_b32 v37, v37, 0, vcc
    v_cmp_eq_u32 vcc, v4, v38
    s_nop 1
    v_cndmask_b32 v38, v38, 0, vcc
    v_cmp_eq_u32 vcc, v4, v39
    s_nop 1
    v_cndmask_b32 v39, v39, 0, vcc
    v_cmp_eq_u32 vcc, v4, v40
    s_nop 1
    v_cndmask_b32 v40, v40, 0, vcc
    v_cmp_eq_u32 vcc, v4, v41
    s_nop 1
    v_cndmask_b32 v41, v41, 0, vcc
    v_cmp_eq_u32 vcc, v4, v42
    s_nop 1
    v_cndmask_b32 v42, v42, 0, vcc
    v_cmp_eq_u32 vcc, v4, v43
    s_nop 1
    v_cndmask_b32 v43, v43, 0, vcc
    v_cmp_eq_u32 vcc, v4, v44
    s_nop 1
    v_cndmask_b32 v44, v44, 0, vcc
    v_cmp_eq_u32 vcc, v4, v45
    s_nop 1
    v_cndmask_b32 v45, v45, 0, vcc
    v_cmp_eq_u32 vcc, v4, v46
    s_nop 1
    v_cndmask_b32 v46, v46, 0, vcc
    v_cmp_eq_u32 vcc, v4, v47
    s_nop 1
    v_cndmask_b32 v47, v47, 0, vcc
    v_max3_u32 v4, v16, v17, v18
    v_max3_u32 v4, v4, v19, v20
    v_max3_u32 v4, v4, v21, v22
    v_max3_u32 v4, v4, v23, v24
    v_max3_u32 v4, v4, v25, v26
    v_max3_u32 v4, v4, v27, v28
    v_max3_u32 v4, v4, v29, v30
    v_max3_u32 v4, v4, v31, v32
    v_max3_u32 v4, v4, v33, v34
    v_max3_u32 v4, v4, v35, v36
    v_max3_u32 v4, v4, v37, v38
    v_max3_u32 v4, v4, v39, v40
    v_max3_u32 v4, v4, v41, v42
    v_max3_u32 v4, v4, v43, v44
    v_max3_u32 v4, v4, v45, v46
    v_max_u32 v4, v4, v47
    s_nop 1
    v_max_u32_dpp v4, v4, v4 quad_perm:[1,0,3,2] row_mask:0xf bank_mask:0xf
    s_nop 1
    v_max_u32_dpp v4, v4, v4 quad_perm:[2,3,0,1] row_mask:0xf bank_mask:0xf
    s_nop 1
    v_max_u32_dpp v4, v4, v4 row_half_mirror row_mask:0xf bank_mask:0xf
    s_nop 1
    v_max_u32_dpp v4, v4, v4 row_mirror row_mask:0xf bank_mask:0xf
    v_mov_b32 v5, v4
    s_nop 1
    v_permlane16_swap_b32 v4, v5
    v_max_u32 v4, v4, v5
    v_mov_b32 v5, v4
    s_nop 1
    v_permlane32_swap_b32 v4, v5
    v_max_u32 v4, v4, v5
    v_mov_b32 v59, v4
    v_cmp_eq_u32 vcc, v4, v16
    s_nop 1
    v_cndmask_b32 v16, v16, 0, vcc
    v_cmp_eq_u32 vcc, v4, v17
    s_nop 1
    v_cndmask_b32 v17, v17, 0, vcc
    v_cmp_eq_u32 vcc, v4, v18
    s_nop 1
    v_cndmask_b32 v18, v18, 0, vcc
    v_cmp_eq_u32 vcc, v4, v19
    s_nop 1
    v_cndmask_b32 v19, v19, 0, vcc
    v_cmp_eq_u32 vcc, v4, v20
    s_nop 1
    v_cndmask_b32 v20, v20, 0, vcc
    v_cmp_eq_u32 vcc, v4, v21
    s_nop 1
    v_cndmask_b32 v21, v21, 0, vcc
    v_cmp_eq_u32 vcc, v4, v22
    s_nop 1
    v_cndmask_b32 v22, v22, 0, vcc
    v_cmp_eq_u32 vcc, v4, v23
    s_nop 1
    v_cndmask_b32 v23, v23, 0, vcc
    v_cmp_eq_u32 vcc, v4, v24
    s_nop 1
    v_cndmask_b32 v24, v24, 0, vcc
    v_cmp_eq_u32 vcc, v4, v25
    s_nop 1
    v_cndmask_b32 v25, v25, 0, vcc
    v_cmp_eq_u32 vcc, v4, v26
    s_nop 1
    v_cndmask_b32 v26, v26, 0, vcc
    v_cmp_eq_u32 vcc, v4, v27
    s_nop 1
    v_cndmask_b32 v27, v27, 0, vcc
    v_cmp_eq_u32 vcc, v4, v28
    s_nop 1
    v_cndmask_b32 v28, v28, 0, vcc
    v_cmp_eq_u32 vcc, v4, v29
    s_nop 1
    v_cndmask_b32 v29, v29, 0, vcc
    v_cmp_eq_u32 vcc, v4, v30
    s_nop 1
    v_cndmask_b32 v30, v30, 0, vcc
    v_cmp_eq_u32 vcc, v4, v31
    s_nop 1
    v_cndmask_b32 v31, v31, 0, vcc
    v_cmp_eq_u32 vcc, v4, v32
    s_nop 1
    v_cndmask_b32 v32, v32, 0, vcc
    v_cmp_eq_u32 vcc, v4, v33
    s_nop 1
    v_cndmask_b32 v33, v33, 0, vcc
    v_cmp_eq_u32 vcc, v4, v34
    s_nop 1
    v_cndmask_b32 v34, v34, 0, vcc
    v_cmp_eq_u32 vcc, v4, v35
    s_nop 1
    v_cndmask_b32 v35, v35, 0, vcc
    v_cmp_eq_u32 vcc, v4, v36
    s_nop 1
    v_cndmask_b32 v36, v36, 0, vcc
    v_cmp_eq_u32 vcc, v4, v37
    s_nop 1
    v_cndmask_b32 v37, v37, 0, vcc
    v_cmp_eq_u32 vcc, v4, v38
    s_nop 1
    v_cndmask_b32 v38, v38, 0, vcc
    v_cmp_eq_u32 vcc, v4, v39
    s_nop 1
    v_cndmask_b32 v39, v39, 0, vcc
    v_cmp_eq_u32 vcc, v4, v40
    s_nop 1
    v_cndmask_b32 v40, v40, 0, vcc
    v_cmp_eq_u32 vcc, v4, v41
    s_nop 1
    v_cndmask_b32 v41, v41, 0, vcc
    v_cmp_eq_u32 vcc, v4, v42
    s_nop 1
    v_cndmask_b32 v42, v42, 0, vcc
    v_cmp_eq_u32 vcc, v4, v43
    s_nop 1
    v_cndmask_b32 v43, v43, 0, vcc
    v_cmp_eq_u32 vcc, v4, v44
    s_nop 1
    v_cndmask_b32 v44, v44, 0, vcc
    v_cmp_eq_u32 vcc, v4, v45
    s_nop 1
    v_cndmask_b32 v45, v45, 0, vcc
    v_cmp_eq_u32 vcc, v4, v46
    s_nop 1
    v_cndmask_b32 v46, v46, 0, vcc
    v_cmp_eq_u32 vcc, v4, v47
    s_nop 1
    v_cndmask_b32 v47, v47, 0, vcc
    v_max3_u32 v4, v16, v17, v18
    v_max3_u32 v4, v4, v19, v20
    v_max3_u32 v4, v4, v21, v22
    v_max3_u32 v4, v4, v23, v24
    v_max3_u32 v4, v4, v25, v26
    v_max3_u32 v4, v4, v27, v28
    v_max3_u32 v4, v4, v29, v30
    v_max3_u32 v4, v4, v31, v32
    v_max3_u32 v4, v4, v33, v34
    v_max3_u32 v4, v4, v35, v36
    v_max3_u32 v4, v4, v37, v38
    v_max3_u32 v4, v4, v39, v40
    v_max3_u32 v4, v4, v41, v42
    v_max3_u32 v4, v4, v43, v44
    v_max3_u32 v4, v4, v45, v46
    v_max_u32 v4, v4, v47
    s_nop 1
    v_max_u32_dpp v4, v4, v4 quad_perm:[1,0,3,2] row_mask:0xf bank_mask:0xf
    s_nop 1
    v_max_u32_dpp v4, v4, v4 quad_perm:[2,3,0,1] row_mask:0xf bank_mask:0xf
    s_nop 1
    v_max_u32_dpp v4, v4, v4 row_half_mirror row_mask:0xf bank_mask:0xf
    s_nop 1
    v_max_u32_dpp v4, v4, v4 row_mirror row_mask:0xf bank_mask:0xf
    v_mov_b32 v5, v4
    s_nop 1
    v_permlane16_swap_b32 v4, v5
    v_max_u32 v4, v4, v5
    v_mov_b32 v5, v4
    s_nop 1
    v_permlane32_swap_b32 v4, v5
    v_max_u32 v4, v4, v5
    v_mov_b32 v60, v4
    v_cmp_eq_u32 vcc, v4, v16
    s_nop 1
    v_cndmask_b32 v16, v16, 0, vcc
    v_cmp_eq_u32 vcc, v4, v17
    s_nop 1
    v_cndmask_b32 v17, v17, 0, vcc
    v_cmp_eq_u32 vcc, v4, v18
    s_nop 1
    v_cndmask_b32 v18, v18, 0, vcc
    v_cmp_eq_u32 vcc, v4, v19
    s_nop 1
    v_cndmask_b32 v19, v19, 0, vcc
    v_cmp_eq_u32 vcc, v4, v20
    s_nop 1
    v_cndmask_b32 v20, v20, 0, vcc
    v_cmp_eq_u32 vcc, v4, v21
    s_nop 1
    v_cndmask_b32 v21, v21, 0, vcc
    v_cmp_eq_u32 vcc, v4, v22
    s_nop 1
    v_cndmask_b32 v22, v22, 0, vcc
    v_cmp_eq_u32 vcc, v4, v23
    s_nop 1
    v_cndmask_b32 v23, v23, 0, vcc
    v_cmp_eq_u32 vcc, v4, v24
    s_nop 1
    v_cndmask_b32 v24, v24, 0, vcc
    v_cmp_eq_u32 vcc, v4, v25
    s_nop 1
    v_cndmask_b32 v25, v25, 0, vcc
    v_cmp_eq_u32 vcc, v4, v26
    s_nop 1
    v_cndmask_b32 v26, v26, 0, vcc
    v_cmp_eq_u32 vcc, v4, v27
    s_nop 1
    v_cndmask_b32 v27, v27, 0, vcc
    v_cmp_eq_u32 vcc, v4, v28
    s_nop 1
    v_cndmask_b32 v28, v28, 0, vcc
    v_cmp_eq_u32 vcc, v4, v29
    s_nop 1
    v_cndmask_b32 v29, v29, 0, vcc
    v_cmp_eq_u32 vcc, v4, v30
    s_nop 1
    v_cndmask_b32 v30, v30, 0, vcc
    v_cmp_eq_u32 vcc, v4, v31
    s_nop 1
    v_cndmask_b32 v31, v31, 0, vcc
    v_cmp_eq_u32 vcc, v4, v32
    s_nop 1
    v_cndmask_b32 v32, v32, 0, vcc
    v_cmp_eq_u32 vcc, v4, v33
    s_nop 1
    v_cndmask_b32 v33, v33, 0, vcc
    v_cmp_eq_u32 vcc, v4, v34
    s_nop 1
    v_cndmask_b32 v34, v34, 0, vcc
    v_cmp_eq_u32 vcc, v4, v35
    s_nop 1
    v_cndmask_b32 v35, v35, 0, vcc
    v_cmp_eq_u32 vcc, v4, v36
    s_nop 1
    v_cndmask_b32 v36, v36, 0, vcc
    v_cmp_eq_u32 vcc, v4, v37
    s_nop 1
    v_cndmask_b32 v37, v37, 0, vcc
    v_cmp_eq_u32 vcc, v4, v38
    s_nop 1
    v_cndmask_b32 v38, v38, 0, vcc
    v_cmp_eq_u32 vcc, v4, v39
    s_nop 1
    v_cndmask_b32 v39, v39, 0, vcc
    v_cmp_eq_u32 vcc, v4, v40
    s_nop 1
    v_cndmask_b32 v40, v40, 0, vcc
    v_cmp_eq_u32 vcc, v4, v41
    s_nop 1
    v_cndmask_b32 v41, v41, 0, vcc
    v_cmp_eq_u32 vcc, v4, v42
    s_nop 1
    v_cndmask_b32 v42, v42, 0, vcc
    v_cmp_eq_u32 vcc, v4, v43
    s_nop 1
    v_cndmask_b32 v43, v43, 0, vcc
    v_cmp_eq_u32 vcc, v4, v44
    s_nop 1
    v_cndmask_b32 v44, v44, 0, vcc
    v_cmp_eq_u32 vcc, v4, v45
    s_nop 1
    v_cndmask_b32 v45, v45, 0, vcc
    v_cmp_eq_u32 vcc, v4, v46
    s_nop 1
    v_cndmask_b32 v46, v46, 0, vcc
    v_cmp_eq_u32 vcc, v4, v47
    s_nop 1
    v_cndmask_b32 v47, v47, 0, vcc
    v_max3_u32 v4, v16, v17, v18
    v_max3_u32 v4, v4, v19, v20
    v_max3_u32 v4, v4, v21, v22
    v_max3_u32 v4, v4, v23, v24
    v_max3_u32 v4, v4, v25, v26
    v_max3_u32 v4, v4, v27, v28
    v_max3_u32 v4, v4, v29, v30
    v_max3_u32 v4, v4, v31, v32
    v_max3_u32 v4, v4, v33, v34
    v_max3_u32 v4, v4, v35, v36
    v_max3_u32 v4, v4, v37, v38
    v_max3_u32 v4, v4, v39, v40
    v_max3_u32 v4, v4, v41, v42
    v_max3_u32 v4, v4, v43, v44
    v_max3_u32 v4, v4, v45, v46
    v_max_u32 v4, v4, v47
    s_nop 1
    v_max_u32_dpp v4, v4, v4 quad_perm:[1,0,3,2] row_mask:0xf bank_mask:0xf
    s_nop 1
    v_max_u32_dpp v4, v4, v4 quad_perm:[2,3,0,1] row_mask:0xf bank_mask:0xf
    s_nop 1
    v_max_u32_dpp v4, v4, v4 row_half_mirror row_mask:0xf bank_mask:0xf
    s_nop 1
    v_max_u32_dpp v4, v4, v4 row_mirror row_mask:0xf bank_mask:0xf
    v_mov_b32 v5, v4
    s_nop 1
    v_permlane16_swap_b32 v4, v5
    v_max_u32 v4, v4, v5
    v_mov_b32 v5, v4
    s_nop 1
    v_permlane32_swap_b32 v4, v5
    v_max_u32 v4, v4, v5
    v_mov_b32 v61, v4
    v_cmp_eq_u32 vcc, v4, v16
    s_nop 1
    v_cndmask_b32 v16, v16, 0, vcc
    v_cmp_eq_u32 vcc, v4, v17
    s_nop 1
    v_cndmask_b32 v17, v17, 0, vcc
    v_cmp_eq_u32 vcc, v4, v18
    s_nop 1
    v_cndmask_b32 v18, v18, 0, vcc
    v_cmp_eq_u32 vcc, v4, v19
    s_nop 1
    v_cndmask_b32 v19, v19, 0, vcc
    v_cmp_eq_u32 vcc, v4, v20
    s_nop 1
    v_cndmask_b32 v20, v20, 0, vcc
    v_cmp_eq_u32 vcc, v4, v21
    s_nop 1
    v_cndmask_b32 v21, v21, 0, vcc
    v_cmp_eq_u32 vcc, v4, v22
    s_nop 1
    v_cndmask_b32 v22, v22, 0, vcc
    v_cmp_eq_u32 vcc, v4, v23
    s_nop 1
    v_cndmask_b32 v23, v23, 0, vcc
    v_cmp_eq_u32 vcc, v4, v24
    s_nop 1
    v_cndmask_b32 v24, v24, 0, vcc
    v_cmp_eq_u32 vcc, v4, v25
    s_nop 1
    v_cndmask_b32 v25, v25, 0, vcc
    v_cmp_eq_u32 vcc, v4, v26
    s_nop 1
    v_cndmask_b32 v26, v26, 0, vcc
    v_cmp_eq_u32 vcc, v4, v27
    s_nop 1
    v_cndmask_b32 v27, v27, 0, vcc
    v_cmp_eq_u32 vcc, v4, v28
    s_nop 1
    v_cndmask_b32 v28, v28, 0, vcc
    v_cmp_eq_u32 vcc, v4, v29
    s_nop 1
    v_cndmask_b32 v29, v29, 0, vcc
    v_cmp_eq_u32 vcc, v4, v30
    s_nop 1
    v_cndmask_b32 v30, v30, 0, vcc
    v_cmp_eq_u32 vcc, v4, v31
    s_nop 1
    v_cndmask_b32 v31, v31, 0, vcc
    v_cmp_eq_u32 vcc, v4, v32
    s_nop 1
    v_cndmask_b32 v32, v32, 0, vcc
    v_cmp_eq_u32 vcc, v4, v33
    s_nop 1
    v_cndmask_b32 v33, v33, 0, vcc
    v_cmp_eq_u32 vcc, v4, v34
    s_nop 1
    v_cndmask_b32 v34, v34, 0, vcc
    v_cmp_eq_u32 vcc, v4, v35
    s_nop 1
    v_cndmask_b32 v35, v35, 0, vcc
    v_cmp_eq_u32 vcc, v4, v36
    s_nop 1
    v_cndmask_b32 v36, v36, 0, vcc
    v_cmp_eq_u32 vcc, v4, v37
    s_nop 1
    v_cndmask_b32 v37, v37, 0, vcc
    v_cmp_eq_u32 vcc, v4, v38
    s_nop 1
    v_cndmask_b32 v38, v38, 0, vcc
    v_cmp_eq_u32 vcc, v4, v39
    s_nop 1
    v_cndmask_b32 v39, v39, 0, vcc
    v_cmp_eq_u32 vcc, v4, v40
    s_nop 1
    v_cndmask_b32 v40, v40, 0, vcc
    v_cmp_eq_u32 vcc, v4, v41
    s_nop 1
    v_cndmask_b32 v41, v41, 0, vcc
    v_cmp_eq_u32 vcc, v4, v42
    s_nop 1
    v_cndmask_b32 v42, v42, 0, vcc
    v_cmp_eq_u32 vcc, v4, v43
    s_nop 1
    v_cndmask_b32 v43, v43, 0, vcc
    v_cmp_eq_u32 vcc, v4, v44
    s_nop 1
    v_cndmask_b32 v44, v44, 0, vcc
    v_cmp_eq_u32 vcc, v4, v45
    s_nop 1
    v_cndmask_b32 v45, v45, 0, vcc
    v_cmp_eq_u32 vcc, v4, v46
    s_nop 1
    v_cndmask_b32 v46, v46, 0, vcc
    v_cmp_eq_u32 vcc, v4, v47
    s_nop 1
    v_cndmask_b32 v47, v47, 0, vcc
    v_max3_u32 v4, v16, v17, v18
    v_max3_u32 v4, v4, v19, v20
    v_max3_u32 v4, v4, v21, v22
    v_max3_u32 v4, v4, v23, v24
    v_max3_u32 v4, v4, v25, v26
    v_max3_u32 v4, v4, v27, v28
    v_max3_u32 v4, v4, v29, v30
    v_max3_u32 v4, v4, v31, v32
    v_max3_u32 v4, v4, v33, v34
    v_max3_u32 v4, v4, v35, v36
    v_max3_u32 v4, v4, v37, v38
    v_max3_u32 v4, v4, v39, v40
    v_max3_u32 v4, v4, v41, v42
    v_max3_u32 v4, v4, v43, v44
    v_max3_u32 v4, v4, v45, v46
    v_max_u32 v4, v4, v47
    s_nop 1
    v_max_u32_dpp v4, v4, v4 quad_perm:[1,0,3,2] row_mask:0xf bank_mask:0xf
    s_nop 1
    v_max_u32_dpp v4, v4, v4 quad_perm:[2,3,0,1] row_mask:0xf bank_mask:0xf
    s_nop 1
    v_max_u32_dpp v4, v4, v4 row_half_mirror row_mask:0xf bank_mask:0xf
    s_nop 1
    v_max_u32_dpp v4, v4, v4 row_mirror row_mask:0xf bank_mask:0xf
    v_mov_b32 v5, v4
    s_nop 1
    v_permlane16_swap_b32 v4, v5
    v_max_u32 v4, v4, v5
    v_mov_b32 v5, v4
    s_nop 1
    v_permlane32_swap_b32 v4, v5
    v_max_u32 v4, v4, v5
    v_mov_b32 v62, v4
    v_cmp_eq_u32 vcc, v4, v16
    s_nop 1
    v_cndmask_b32 v16, v16, 0, vcc
    v_cmp_eq_u32 vcc, v4, v17
    s_nop 1
    v_cndmask_b32 v17, v17, 0, vcc
    v_cmp_eq_u32 vcc, v4, v18
    s_nop 1
    v_cndmask_b32 v18, v18, 0, vcc
    v_cmp_eq_u32 vcc, v4, v19
    s_nop 1
    v_cndmask_b32 v19, v19, 0, vcc
    v_cmp_eq_u32 vcc, v4, v20
    s_nop 1
    v_cndmask_b32 v20, v20, 0, vcc
    v_cmp_eq_u32 vcc, v4, v21
    s_nop 1
    v_cndmask_b32 v21, v21, 0, vcc
    v_cmp_eq_u32 vcc, v4, v22
    s_nop 1
    v_cndmask_b32 v22, v22, 0, vcc
    v_cmp_eq_u32 vcc, v4, v23
    s_nop 1
    v_cndmask_b32 v23, v23, 0, vcc
    v_cmp_eq_u32 vcc, v4, v24
    s_nop 1
    v_cndmask_b32 v24, v24, 0, vcc
    v_cmp_eq_u32 vcc, v4, v25
    s_nop 1
    v_cndmask_b32 v25, v25, 0, vcc
    v_cmp_eq_u32 vcc, v4, v26
    s_nop 1
    v_cndmask_b32 v26, v26, 0, vcc
    v_cmp_eq_u32 vcc, v4, v27
    s_nop 1
    v_cndmask_b32 v27, v27, 0, vcc
    v_cmp_eq_u32 vcc, v4, v28
    s_nop 1
    v_cndmask_b32 v28, v28, 0, vcc
    v_cmp_eq_u32 vcc, v4, v29
    s_nop 1
    v_cndmask_b32 v29, v29, 0, vcc
    v_cmp_eq_u32 vcc, v4, v30
    s_nop 1
    v_cndmask_b32 v30, v30, 0, vcc
    v_cmp_eq_u32 vcc, v4, v31
    s_nop 1
    v_cndmask_b32 v31, v31, 0, vcc
    v_cmp_eq_u32 vcc, v4, v32
    s_nop 1
    v_cndmask_b32 v32, v32, 0, vcc
    v_cmp_eq_u32 vcc, v4, v33
    s_nop 1
    v_cndmask_b32 v33, v33, 0, vcc
    v_cmp_eq_u32 vcc, v4, v34
    s_nop 1
    v_cndmask_b32 v34, v34, 0, vcc
    v_cmp_eq_u32 vcc, v4, v35
    s_nop 1
    v_cndmask_b32 v35, v35, 0, vcc
    v_cmp_eq_u32 vcc, v4, v36
    s_nop 1
    v_cndmask_b32 v36, v36, 0, vcc
    v_cmp_eq_u32 vcc, v4, v37
    s_nop 1
    v_cndmask_b32 v37, v37, 0, vcc
    v_cmp_eq_u32 vcc, v4, v38
    s_nop 1
    v_cndmask_b32 v38, v38, 0, vcc
    v_cmp_eq_u32 vcc, v4, v39
    s_nop 1
    v_cndmask_b32 v39, v39, 0, vcc
    v_cmp_eq_u32 vcc, v4, v40
    s_nop 1
    v_cndmask_b32 v40, v40, 0, vcc
    v_cmp_eq_u32 vcc, v4, v41
    s_nop 1
    v_cndmask_b32 v41, v41, 0, vcc
    v_cmp_eq_u32 vcc, v4, v42
    s_nop 1
    v_cndmask_b32 v42, v42, 0, vcc
    v_cmp_eq_u32 vcc, v4, v43
    s_nop 1
    v_cndmask_b32 v43, v43, 0, vcc
    v_cmp_eq_u32 vcc, v4, v44
    s_nop 1
    v_cndmask_b32 v44, v44, 0, vcc
    v_cmp_eq_u32 vcc, v4, v45
    s_nop 1
    v_cndmask_b32 v45, v45, 0, vcc
    v_cmp_eq_u32 vcc, v4, v46
    s_nop 1
    v_cndmask_b32 v46, v46, 0, vcc
    v_cmp_eq_u32 vcc, v4, v47
    s_nop 1
    v_cndmask_b32 v47, v47, 0, vcc
    v_max3_u32 v4, v16, v17, v18
    v_max3_u32 v4, v4, v19, v20
    v_max3_u32 v4, v4, v21, v22
    v_max3_u32 v4, v4, v23, v24
    v_max3_u32 v4, v4, v25, v26
    v_max3_u32 v4, v4, v27, v28
    v_max3_u32 v4, v4, v29, v30
    v_max3_u32 v4, v4, v31, v32
    v_max3_u32 v4, v4, v33, v34
    v_max3_u32 v4, v4, v35, v36
    v_max3_u32 v4, v4, v37, v38
    v_max3_u32 v4, v4, v39, v40
    v_max3_u32 v4, v4, v41, v42
    v_max3_u32 v4, v4, v43, v44
    v_max3_u32 v4, v4, v45, v46
    v_max_u32 v4, v4, v47
    s_nop 1
    v_max_u32_dpp v4, v4, v4 quad_perm:[1,0,3,2] row_mask:0xf bank_mask:0xf
    s_nop 1
    v_max_u32_dpp v4, v4, v4 quad_perm:[2,3,0,1] row_mask:0xf bank_mask:0xf
    s_nop 1
    v_max_u32_dpp v4, v4, v4 row_half_mirror row_mask:0xf bank_mask:0xf
    s_nop 1
    v_max_u32_dpp v4, v4, v4 row_mirror row_mask:0xf bank_mask:0xf
    v_mov_b32 v5, v4
    s_nop 1
    v_permlane16_swap_b32 v4, v5
    v_max_u32 v4, v4, v5
    v_mov_b32 v5, v4
    s_nop 1
    v_permlane32_swap_b32 v4, v5
    v_max_u32 v4, v4, v5
    v_mov_b32 v63, v4
    v_mov_b32 v4, v56
    v_cmp_eq_u32 vcc, 1, v0
    s_nop 1
    v_cndmask_b32 v4, v4, v57, vcc
    v_cmp_eq_u32 vcc, 2, v0
    s_nop 1
    v_cndmask_b32 v4, v4, v58, vcc
    v_cmp_eq_u32 vcc, 3, v0
    s_nop 1
    v_cndmask_b32 v4, v4, v59, vcc
    v_cmp_eq_u32 vcc, 4, v0
    s_nop 1
    v_cndmask_b32 v4, v4, v60, vcc
    v_cmp_eq_u32 vcc, 5, v0
    s_nop 1
    v_cndmask_b32 v4, v4, v61, vcc
    v_cmp_eq_u32 vcc, 6, v0
    s_nop 1
    v_cndmask_b32 v4, v4, v62, vcc
    v_cmp_eq_u32 vcc, 7, v0
    s_nop 1
    v_cndmask_b32 v4, v4, v63, vcc
    v_and_b32 v5, 0xffff, v4
    v_sub_u32 v5, 0xffff, v5
    v_and_b32 v4, 0xffff0000, v4
    v_ashrrev_i32 v3, 31, v4
    v_not_b32 v3, v3
    v_or_b32 v3, 0x80000000, v3
    v_xor_b32 v4, v4, v3
    v_and_b32 v4, 0xffff0000, v4
    v_mul_f32 v4, 0xbfb8aa3b, v4
    v_exp_f32 v4, v4
    s_nop 0
    v_add_f32 v4, 1.0, v4
    v_rcp_f32 v4, v4
    s_nop 0
    v_cvt_pk_bf16_f32 v4, v4, v4
    v_lshlrev_b32 v4, 16, v4
    v_lshlrev_b32 v6, 2, v0
    s_mov_b32 s64, 0x5400000
    s_mov_b64 exec, 0xff
    buffer_store_dword v5, v6, s[4:7], s64 offen sc1
    buffer_store_dword v4, v6, s[4:7], s64 offen offset:32 sc1
    s_mov_b64 exec, -1
    s_waitcnt vmcnt(0)
    v_mov_b32 v7, 1
    v_mov_b32 v8, 0
    s_mov_b32 s64, 0x298000
    s_mov_b64 exec, 1
    buffer_atomic_add v7, v8, s[4:7], s64 offen sc1
    s_mov_b64 exec, -1
    v_mbcnt_lo_u32_b32 v0, -1, 0
    v_mbcnt_hi_u32_b32 v0, -1, v0
NOSEL_117:
    v_lshlrev_b32 v1, 4, v0
    v_lshrrev_b32 v6, 3, v0
    v_mul_u32_u24 v2, 1280, v6
    v_and_b32 v7, 7, v0
    v_xor_b32 v7, v7, v6
    v_lshl_add_u32 v2, v7, 4, v2
    v_bfe_u32 v6, v0, 3, 1
    v_lshlrev_b32 v9, 10, v6
    v_and_b32 v6, 7, v0
    v_lshl_add_u32 v9, v6, 7, v9
    v_lshrrev_b32 v7, 4, v0
    v_xor_b32 v7, v7, v6
    v_lshl_add_u32 v3, v7, 4, v9
    v_xor_b32 v7, 4, v7
    v_lshl_add_u32 v4, v7, 4, v9
    v_add_u32 v6, 0x10000, v3
    v_add_u32 v9, 0x10000, v4
    s_barrier
    s_mul_i32 s20, s12, 163840
    s_mul_i32 s64, s14, 40960
    s_add_u32 s20, s20, s64
    s_add_u32 s20, s20, 0x0
    s_lshl_b32 s21, s14, 12
    s_add_u32 m0, s21, 0
    s_add_u32 s64, s20, 0x0
    buffer_load_dwordx4 v2, s[4:7], s64 offen lds
    s_add_u32 m0, s21, 1024
    s_add_u32 s64, s20, 0x2800
    buffer_load_dwordx4 v2, s[4:7], s64 offen lds
    s_add_u32 m0, s21, 2048
    s_add_u32 s64, s20, 0x5000
    buffer_load_dwordx4 v2, s[4:7], s64 offen lds
    s_add_u32 m0, s21, 3072
    s_add_u32 s64, s20, 0x7800
    buffer_load_dwordx4 v2, s[4:7], s64 offen lds
    s_add_u32 m0, s21, 16384
    s_add_u32 s64, s20, 0x80
    buffer_load_dwordx4 v2, s[4:7], s64 offen lds
    s_add_u32 m0, s21, 17408
    s_add_u32 s64, s20, 0x2880
    buffer_load_dwordx4 v2, s[4:7], s64 offen lds
    s_add_u32 m0, s21, 18432
    s_add_u32 s64, s20, 0x5080
    buffer_load_dwordx4 v2, s[4:7], s64 offen lds
    s_add_u32 m0, s21, 19456
    s_add_u32 s64, s20, 0x7880
    buffer_load_dwordx4 v2, s[4:7], s64 offen lds
    s_add_u32 m0, s21, 32768
    s_add_u32 s64, s20, 0x100
    buffer_load_dwordx4 v2, s[4:7], s64 offen lds
    s_add_u32 m0, s21, 33792
    s_add_u32 s64, s20, 0x2900
    buffer_load_dwordx4 v2, s[4:7], s64 offen lds
    s_add_u32 m0, s21, 34816
    s_add_u32 s64, s20, 0x5100
    buffer_load_dwordx4 v2, s[4:7], s64 offen lds
    s_add_u32 m0, s21, 35840
    s_add_u32 s64, s20, 0x7900
    buffer_load_dwordx4 v2, s[4:7], s64 offen lds
    s_add_u32 m0, s21, 49152
    s_add_u32 s64, s20, 0x180
    buffer_load_dwordx4 v2, s[4:7], s64 offen lds
    s_add_u32 m0, s21, 50176
    s_add_u32 s64, s20, 0x2980
    buffer_load_dwordx4 v2, s[4:7], s64 offen lds
    s_add_u32 m0, s21, 51200
    s_add_u32 s64, s20, 0x5180
    buffer_load_dwordx4 v2, s[4:7], s64 offen lds
    s_add_u32 m0, s21, 52224
    s_add_u32 s64, s20, 0x7980
    buffer_load_dwordx4 v2, s[4:7], s64 offen lds
    s_mov_b32 s64, 0x40000000
    buffer_store_dword v7, v1, s[4:7], s64 offen
    buffer_store_dword v7, v1, s[4:7], s64 offen
    buffer_store_dword v7, v1, s[4:7], s64 offen
    buffer_store_dword v7, v1, s[4:7], s64 offen
    buffer_store_dword v7, v1, s[4:7], s64 offen
    buffer_store_dword v7, v1, s[4:7], s64 offen
    buffer_store_dword v7, v1, s[4:7], s64 offen
    buffer_store_dword v7, v1, s[4:7], s64 offen
    s_waitcnt vmcnt(20)
    s_barrier
    ds_read_b128 a[0:3], v3 offset:0
    ds_read_b128 a[4:7], v3 offset:2048
    ds_read_b128 a[8:11], v3 offset:4096
    ds_read_b128 a[12:15], v3 offset:6144
    ds_read_b128 a[16:19], v3 offset:8192
    ds_read_b128 a[20:23], v3 offset:10240
    ds_read_b128 a[24:27], v3 offset:12288
    ds_read_b128 a[28:31], v3 offset:14336
    s_mov_b32 s19, 0
    s_mov_b32 s22, s16
    s_mov_b32 s23, 0x40000000
G_T_LOOP:
    s_waitcnt lgkmcnt(4)
    v_mfma_f32_16x16x32_bf16 v[16:19], v[96:99], a[0:3], 0
    v_mfma_f32_16x16x32_bf16 v[20:23], v[100:103], a[0:3], 0
    ds_read_b128 a[32:35], v4 offset:0
    v_mfma_f32_16x16x32_bf16 v[24:27], v[96:99], a[4:7], 0
    v_mfma_f32_16x16x32_bf16 v[28:31], v[100:103], a[4:7], 0
    ds_read_b128 a[36:39], v4 offset:2048
    v_mfma_f32_16x16x32_bf16 v[32:35], v[96:99], a[8:11], 0
    v_mfma_f32_16x16x32_bf16 v[36:39], v[100:103], a[8:11], 0
    ds_read_b128 a[40:43], v4 offset:4096
    v_mfma_f32_16x16x32_bf16 v[40:43], v[96:99], a[12:15], 0
    v_mfma_f32_16x16x32_bf16 v[44:47], v[100:103], a[12:15], 0
    ds_read_b128 a[44:47], v4 offset:6144
    s_waitcnt lgkmcnt(4)
    v_mfma_f32_16x16x32_bf16 v[48:51], v[96:99], a[16:19], 0
    v_mfma_f32_16x16x32_bf16 v[52:55], v[100:103], a[16:19], 0
    ds_read_b128 a[48:51], v4 offset:8192
    v_mfma_f32_16x16x32_bf16 v[56:59], v[96:99], a[20:23], 0
    v_mfma_f32_16x16x32_bf16 v[60:63], v[100:103], a[20:23], 0
    ds_read_b128 a[52:55], v4 offset:10240
    v_mfma_f32_16x16x32_bf16 v[64:67], v[96:99], a[24:27], 0
    v_mfma_f32_16x16x32_bf16 v[68:71], v[100:103], a[24:27], 0
    ds_read_b128 a[56:59], v4 offset:12288
    v_mfma_f32_16x16x32_bf16 v[72:75], v[96:99], a[28:31], 0
    v_mfma_f32_16x16x32_bf16 v[76:79], v[100:103], a[28:31], 0
    ds_read_b128 a[60:63], v4 offset:14336
    s_waitcnt vmcnt(16)
    s_barrier
    s_waitcnt lgkmcnt(4)
    v_mfma_f32_16x16x32_bf16 v[16:19], v[104:107], a[32:35], v[16:19]
    v_mfma_f32_16x16x32_bf16 v[20:23], v[108:111], a[32:35], v[20:23]
    ds_read_b128 a[0:3], v3 offset:16384
    s_add_u32 m0, s21, 65536
    v_mfma_f32_16x16x32_bf16 v[24:27], v[104:107], a[36:39], v[24:27]
    v_mfma_f32_16x16x32_bf16 v[28:31], v[108:111], a[36:39], v[28:31]
    ds_read_b128 a[4:7], v3 offset:18432
    s_add_u32 s64, s20, 0x200
    buffer_load_dwordx4 v2, s[4:7], s64 offen lds
    v_mfma_f32_16x16x32_bf16 v[32:35], v[104:107], a[40:43], v[32:35]
    v_mfma_f32_16x16x32_bf16 v[36:39], v[108:111], a[40:43], v[36:39]
    ds_read_b128 a[8:11], v3 offset:20480
    s_add_u32 m0, s21, 66560
    v_mfma_f32_16x16x32_bf16 v[40:43], v[104:107], a[44:47], v[40:43]
    v_mfma_f32_16x16x32_bf16 v[44:47], v[108:111], a[44:47], v[44:47]
    ds_read_b128 a[12:15], v3 offset:22528
    s_add_u32 s64, s20, 0x2a00
    buffer_load_dwordx4 v2, s[4:7], s64 offen lds
    s_waitcnt lgkmcnt(4)
    v_mfma_f32_16x16x32_bf16 v[48:51], v[104:107], a[48:51], v[48:51]
    v_mfma_f32_16x16x32_bf16 v[52:55], v[108:111], a[48:51], v[52:55]
    ds_read_b128 a[16:19], v3 offset:24576
    s_add_u32 m0, s21, 67584
    v_mfma_f32_16x16x32_bf16 v[56:59], v[104:107], a[52:55], v[56:59]
    v_mfma_f32_16x16x32_bf16 v[60:63], v[108:111], a[52:55], v[60:63]
    ds_read_b128 a[20:23], v3 offset:26624
    s_add_u32 s64, s20, 0x5200
    buffer_load_dwordx4 v2, s[4:7], s64 offen lds
    v_mfma_f32_16x16x32_bf16 v[64:67], v[104:107], a[56:59], v[64:67]
    v_mfma_f32_16x16x32_bf16 v[68:71], v[108:111], a[56:59], v[68:71]
    ds_read_b128 a[24:27], v3 offset:28672
    s_add_u32 m0, s21, 68608
    v_mfma_f32_16x16x32_bf16 v[72:75], v[104:107], a[60:63], v[72:75]
    v_mfma_f32_16x16x32_bf16 v[76:79], v[108:111], a[60:63], v[76:79]
    ds_read_b128 a[28:31], v3 offset:30720
    s_add_u32 s64, s20, 0x7a00
    buffer_load_dwordx4 v2, s[4:7], s64 offen lds
    s_waitcnt lgkmcnt(4)
    v_mfma_f32_16x16x32_bf16 v[16:19], v[112:115], a[0:3], v[16:19]
    v_mfma_f32_16x16x32_bf16 v[20:23], v[116:119], a[0:3], v[20:23]
    ds_read_b128 a[32:35], v4 offset:16384
    v_mfma_f32_16x16x32_bf16 v[24:27], v[112:115], a[4:7], v[24:27]
    v_mfma_f32_16x16x32_bf16 v[28:31], v[116:119], a[4:7], v[28:31]
    ds_read_b128 a[36:39], v4 offset:18432
    v_mfma_f32_16x16x32_bf16 v[32:35], v[112:115], a[8:11], v[32:35]
    v_mfma_f32_16x16x32_bf16 v[36:39], v[116:119], a[8:11], v[36:39]
    ds_read_b128 a[40:43], v4 offset:20480
    v_mfma_f32_16x16x32_bf16 v[40:43], v[112:115], a[12:15], v[40:43]
    v_mfma_f32_16x16x32_bf16 v[44:47], v[116:119], a[12:15], v[44:47]
    ds_read_b128 a[44:47], v4 offset:22528
    s_waitcnt lgkmcnt(4)
    v_mfma_f32_16x16x32_bf16 v[48:51], v[112:115], a[16:19], v[48:51]
    v_mfma_f32_16x16x32_bf16 v[52:55], v[116:119], a[16:19], v[52:55]
    ds_read_b128 a[48:51], v4 offset:24576
    v_mfma_f32_16x16x32_bf16 v[56:59], v[112:115], a[20:23], v[56:59]
    v_mfma_f32_16x16x32_bf16 v[60:63], v[116:119], a[20:23], v[60:63]
    ds_read_b128 a[52:55], v4 offset:26624
    v_mfma_f32_16x16x32_bf16 v[64:67], v[112:115], a[24:27], v[64:67]
    v_mfma_f32_16x16x32_bf16 v[68:71], v[116:119], a[24:27], v[68:71]
    ds_read_b128 a[56:59], v4 offset:28672
    v_mfma_f32_16x16x32_bf16 v[72:75], v[112:115], a[28:31], v[72:75]
    v_mfma_f32_16x16x32_bf16 v[76:79], v[116:119], a[28:31], v[76:79]
    ds_read_b128 a[60:63], v4 offset:30720
    s_waitcnt vmcnt(16)
    s_barrier
    s_cmp_lg_u32 s19, 0
    s_cbranch_scc1 GFD_118
    s_cmp_lg_u32 s14, 0
    s_cbranch_scc1 INE_119
    s_cmp_lg_u32 s96, 10
    s_cbranch_scc1 ING_120
    v_mov_b32 v7, 1
    v_lshlrev_b32 v8, 7, v0
    s_mov_b32 s65, 0x29a000
    s_mov_b64 exec, 3
    buffer_store_dword v7, v8, s[4:7], s65 offen sc1
    s_mov_b64 exec, -1
    s_waitcnt vmcnt(0)
ING_120:
    v_mov_b32 v8, 1
    s_mov_b32 s65, 0x290800
    s_mov_b64 exec, 1
    buffer_atomic_add v8, off, s[4:7], s65 sc1
    s_mov_b64 exec, -1
INE_119:
GFD_118:
    s_waitcnt lgkmcnt(4)
    v_mfma_f32_16x16x32_bf16 v[16:19], v[120:123], a[32:35], v[16:19]
    v_mfma_f32_16x16x32_bf16 v[20:23], v[124:127], a[32:35], v[20:23]
    ds_read_b128 a[0:3], v3 offset:32768
    s_add_u32 m0, s21, 0
    v_mfma_f32_16x16x32_bf16 v[24:27], v[120:123], a[36:39], v[24:27]
    v_mfma_f32_16x16x32_bf16 v[28:31], v[124:127], a[36:39], v[28:31]
    ds_read_b128 a[4:7], v3 offset:34816
    s_add_u32 s64, s20, 0x280
    buffer_load_dwordx4 v2, s[4:7], s64 offen lds
    v_mfma_f32_16x16x32_bf16 v[32:35], v[120:123], a[40:43], v[32:35]
    v_mfma_f32_16x16x32_bf16 v[36:39], v[124:127], a[40:43], v[36:39]
    ds_read_b128 a[8:11], v3 offset:36864
    s_add_u32 m0, s21, 1024
    v_mfma_f32_16x16x32_bf16 v[40:43], v[120:123], a[44:47], v[40:43]
    v_mfma_f32_16x16x32_bf16 v[44:47], v[124:127], a[44:47], v[44:47]
    ds_read_b128 a[12:15], v3 offset:38912
    s_add_u32 s64, s20, 0x2a80
    buffer_load_dwordx4 v2, s[4:7], s64 offen lds
    s_waitcnt lgkmcnt(4)
    v_mfma_f32_16x16x32_bf16 v[48:51], v[120:123], a[48:51], v[48:51]
    v_mfma_f32_16x16x32_bf16 v[52:55], v[124:127], a[48:51], v[52:55]
    ds_read_b128 a[16:19], v3 offset:40960
    s_add_u32 m0, s21, 2048
    v_mfma_f32_16x16x32_bf16 v[56:59], v[120:123], a[52:55], v[56:59]
    v_mfma_f32_16x16x32_bf16 v[60:63], v[124:127], a[52:55], v[60:63]
    ds_read_b128 a[20:23], v3 offset:43008
    s_add_u32 s64, s20, 0x5280
    buffer_load_dwordx4 v2, s[4:7], s64 offen lds
    v_mfma_f32_16x16x32_bf16 v[64:67], v[120:123], a[56:59], v[64:67]
    v_mfma_f32_16x16x32_bf16 v[68:71], v[124:127], a[56:59], v[68:71]
    ds_read_b128 a[24:27], v3 offset:45056
    s_add_u32 m0, s21, 3072
    v_mfma_f32_16x16x32_bf16 v[72:75], v[120:123], a[60:63], v[72:75]
    v_mfma_f32_16x16x32_bf16 v[76:79], v[124:127], a[60:63], v[76:79]
    ds_read_b128 a[28:31], v3 offset:47104
    s_add_u32 s64, s20, 0x7a80
    buffer_load_dwordx4 v2, s[4:7], s64 offen lds
    s_waitcnt lgkmcnt(4)
    v_mfma_f32_16x16x32_bf16 v[16:19], v[128:131], a[0:3], v[16:19]
    v_mfma_f32_16x16x32_bf16 v[20:23], v[132:135], a[0:3], v[20:23]
    ds_read_b128 a[32:35], v4 offset:32768
    v_mfma_f32_16x16x32_bf16 v[24:27], v[128:131], a[4:7], v[24:27]
    v_mfma_f32_16x16x32_bf16 v[28:31], v[132:135], a[4:7], v[28:31]
    ds_read_b128 a[36:39], v4 offset:34816
    v_mfma_f32_16x16x32_bf16 v[32:35], v[128:131], a[8:11], v[32:35]
    v_mfma_f32_16x16x32_bf16 v[36:39], v[132:135], a[8:11], v[36:39]
    ds_read_b128 a[40:43], v4 offset:36864
    v_mfma_f32_16x16x32_bf16 v[40:43], v[128:131], a[12:15], v[40:43]
    v_mfma_f32_16x16x32_bf16 v[44:47], v[132:135], a[12:15], v[44:47]
    ds_read_b128 a[44:47], v4 offset:38912
    s_waitcnt lgkmcnt(4)
    v_mfma_f32_16x16x32_bf16 v[48:51], v[128:131], a[16:19], v[48:51]
    v_mfma_f32_16x16x32_bf16 v[52:55], v[132:135], a[16:19], v[52:55]
    ds_read_b128 a[48:51], v4 offset:40960
    v_mfma_f32_16x16x32_bf16 v[56:59], v[128:131], a[20:23], v[56:59]
    v_mfma_f32_16x16x32_bf16 v[60:63], v[132:135], a[20:23], v[60:63]
    ds_read_b128 a[52:55], v4 offset:43008
    v_mfma_f32_16x16x32_bf16 v[64:67], v[128:131], a[24:27], v[64:67]
    v_mfma_f32_16x16x32_bf16 v[68:71], v[132:135], a[24:27], v[68:71]
    ds_read_b128 a[56:59], v4 offset:45056
    v_mfma_f32_16x16x32_bf16 v[72:75], v[128:131], a[28:31], v[72:75]
    v_mfma_f32_16x16x32_bf16 v[76:79], v[132:135], a[28:31], v[76:79]
    ds_read_b128 a[60:63], v4 offset:47104
    s_waitcnt vmcnt(16)
    s_barrier
    s_waitcnt lgkmcnt(4)
    v_mfma_f32_16x16x32_bf16 v[16:19], v[136:139], a[32:35], v[16:19]
    v_mfma_f32_16x16x32_bf16 v[20:23], v[140:143], a[32:35], v[20:23]
    ds_read_b128 a[0:3], v3 offset:49152
    s_add_u32 m0, s21, 16384
    v_mfma_f32_16x16x32_bf16 v[24:27], v[136:139], a[36:39], v[24:27]
    v_mfma_f32_16x16x32_bf16 v[28:31], v[140:143], a[36:39], v[28:31]
    ds_read_b128 a[4:7], v3 offset:51200
    s_add_u32 s64, s20, 0x300
    buffer_load_dwordx4 v2, s[4:7], s64 offen lds
    v_mfma_f32_16x16x32_bf16 v[32:35], v[136:139], a[40:43], v[32:35]
    v_mfma_f32_16x16x32_bf16 v[36:39], v[140:143], a[40:43], v[36:39]
    ds_read_b128 a[8:11], v3 offset:53248
    s_add_u32 m0, s21, 17408
    v_mfma_f32_16x16x32_bf16 v[40:43], v[136:139], a[44:47], v[40:43]
    v_mfma_f32_16x16x32_bf16 v[44:47], v[140:143], a[44:47], v[44:47]
    ds_read_b128 a[12:15], v3 offset:55296
    s_add_u32 s64, s20, 0x2b00
    buffer_load_dwordx4 v2, s[4:7], s64 offen lds
    s_waitcnt lgkmcnt(4)
    v_mfma_f32_16x16x32_bf16 v[48:51], v[136:139], a[48:51], v[48:51]
    v_mfma_f32_16x16x32_bf16 v[52:55], v[140:143], a[48:51], v[52:55]
    ds_read_b128 a[16:19], v3 offset:57344
    s_add_u32 m0, s21, 18432
    v_mfma_f32_16x16x32_bf16 v[56:59], v[136:139], a[52:55], v[56:59]
    v_mfma_f32_16x16x32_bf16 v[60:63], v[140:143], a[52:55], v[60:63]
    ds_read_b128 a[20:23], v3 offset:59392
    s_add_u32 s64, s20, 0x5300
    buffer_load_dwordx4 v2, s[4:7], s64 offen lds
    v_mfma_f32_16x16x32_bf16 v[64:67], v[136:139], a[56:59], v[64:67]
    v_mfma_f32_16x16x32_bf16 v[68:71], v[140:143], a[56:59], v[68:71]
    ds_read_b128 a[24:27], v3 offset:61440
    s_add_u32 m0, s21, 19456
    v_mfma_f32_16x16x32_bf16 v[72:75], v[136:139], a[60:63], v[72:75]
    v_mfma_f32_16x16x32_bf16 v[76:79], v[140:143], a[60:63], v[76:79]
    ds_read_b128 a[28:31], v3 offset:63488
    s_add_u32 s64, s20, 0x7b00
    buffer_load_dwordx4 v2, s[4:7], s64 offen lds
    s_waitcnt lgkmcnt(4)
    v_mfma_f32_16x16x32_bf16 v[16:19], v[144:147], a[0:3], v[16:19]
    v_mfma_f32_16x16x32_bf16 v[20:23], v[148:151], a[0:3], v[20:23]
    ds_read_b128 a[32:35], v4 offset:49152
    v_mfma_f32_16x16x32_bf16 v[24:27], v[144:147], a[4:7], v[24:27]
    v_mfma_f32_16x16x32_bf16 v[28:31], v[148:151], a[4:7], v[28:31]
    ds_read_b128 a[36:39], v4 offset:51200
    v_mfma_f32_16x16x32_bf16 v[32:35], v[144:147], a[8:11], v[32:35]
    v_mfma_f32_16x16x32_bf16 v[36:39], v[148:151], a[8:11], v[36:39]
    ds_read_b128 a[40:43], v4 offset:53248
    v_mfma_f32_16x16x32_bf16 v[40:43], v[144:147], a[12:15], v[40:43]
    v_mfma_f32_16x16x32_bf16 v[44:47], v[148:151], a[12:15], v[44:47]
    ds_read_b128 a[44:47], v4 offset:55296
    s_waitcnt lgkmcnt(4)
    v_mfma_f32_16x16x32_bf16 v[48:51], v[144:147], a[16:19], v[48:51]
    v_mfma_f32_16x16x32_bf16 v[52:55], v[148:151], a[16:19], v[52:55]
    ds_read_b128 a[48:51], v4 offset:57344
    v_mfma_f32_16x16x32_bf16 v[56:59], v[144:147], a[20:23], v[56:59]
    v_mfma_f32_16x16x32_bf16 v[60:63], v[148:151], a[20:23], v[60:63]
    ds_read_b128 a[52:55], v4 offset:59392
    v_mfma_f32_16x16x32_bf16 v[64:67], v[144:147], a[24:27], v[64:67]
    v_mfma_f32_16x16x32_bf16 v[68:71], v[148:151], a[24:27], v[68:71]
    ds_read_b128 a[56:59], v4 offset:61440
    v_mfma_f32_16x16x32_bf16 v[72:75], v[144:147], a[28:31], v[72:75]
    v_mfma_f32_16x16x32_bf16 v[76:79], v[148:151], a[28:31], v[76:79]
    ds_read_b128 a[60:63], v4 offset:63488
    s_waitcnt vmcnt(8)
    s_barrier
    s_cmp_lg_u32 s14, 0
    s_cbranch_scc1 GF_121
    v_mov_b32 v7, 1
    v_mov_b32 v8, 0
    s_mov_b64 exec, 1
    buffer_store_dword v7, v8, s[4:7], s23 offen sc1
    s_mov_b64 exec, -1
GF_121:
    s_waitcnt lgkmcnt(4)
    v_mfma_f32_16x16x32_bf16 v[16:19], v[152:155], a[32:35], v[16:19]
    v_mfma_f32_16x16x32_bf16 v[20:23], v[156:159], a[32:35], v[20:23]
    ds_read_b128 a[0:3], v6 offset:0
    s_add_u32 m0, s21, 32768
    v_mfma_f32_16x16x32_bf16 v[24:27], v[152:155], a[36:39], v[24:27]
    v_mfma_f32_16x16x32_bf16 v[28:31], v[156:159], a[36:39], v[28:31]
    ds_read_b128 a[4:7], v6 offset:2048
    s_add_u32 s64, s20, 0x380
    buffer_load_dwordx4 v2, s[4:7], s64 offen lds
    v_mfma_f32_16x16x32_bf16 v[32:35], v[152:155], a[40:43], v[32:35]
    v_mfma_f32_16x16x32_bf16 v[36:39], v[156:159], a[40:43], v[36:39]
    ds_read_b128 a[8:11], v6 offset:4096
    s_add_u32 m0, s21, 33792
    v_mfma_f32_16x16x32_bf16 v[40:43], v[152:155], a[44:47], v[40:43]
    v_mfma_f32_16x16x32_bf16 v[44:47], v[156:159], a[44:47], v[44:47]
    ds_read_b128 a[12:15], v6 offset:6144
    s_add_u32 s64, s20, 0x2b80
    buffer_load_dwordx4 v2, s[4:7], s64 offen lds
    s_waitcnt lgkmcnt(4)
    v_mfma_f32_16x16x32_bf16 v[48:51], v[152:155], a[48:51], v[48:51]
    v_mfma_f32_16x16x32_bf16 v[52:55], v[156:159], a[48:51], v[52:55]
    ds_read_b128 a[16:19], v6 offset:8192
    s_add_u32 m0, s21, 34816
    v_mfma_f32_16x16x32_bf16 v[56:59], v[152:155], a[52:55], v[56:59]
    v_mfma_f32_16x16x32_bf16 v[60:63], v[156:159], a[52:55], v[60:63]
    ds_read_b128 a[20:23], v6 offset:10240
    s_add_u32 s64, s20, 0x5380
    buffer_load_dwordx4 v2, s[4:7], s64 offen lds
    v_mfma_f32_16x16x32_bf16 v[64:67], v[152:155], a[56:59], v[64:67]
    v_mfma_f32_16x16x32_bf16 v[68:71], v[156:159], a[56:59], v[68:71]
    ds_read_b128 a[24:27], v6 offset:12288
    s_add_u32 m0, s21, 35840
    v_mfma_f32_16x16x32_bf16 v[72:75], v[152:155], a[60:63], v[72:75]
    v_mfma_f32_16x16x32_bf16 v[76:79], v[156:159], a[60:63], v[76:79]
    ds_read_b128 a[28:31], v6 offset:14336
    s_add_u32 s64, s20, 0x7b80
    buffer_load_dwordx4 v2, s[4:7], s64 offen lds
    s_waitcnt lgkmcnt(4)
    v_mfma_f32_16x16x32_bf16 v[16:19], v[160:163], a[0:3], v[16:19]
    v_mfma_f32_16x16x32_bf16 v[20:23], v[164:167], a[0:3], v[20:23]
    ds_read_b128 a[32:35], v9 offset:0
    v_mfma_f32_16x16x32_bf16 v[24:27], v[160:163], a[4:7], v[24:27]
    v_mfma_f32_16x16x32_bf16 v[28:31], v[164:167], a[4:7], v[28:31]
    ds_read_b128 a[36:39], v9 offset:2048
    v_mfma_f32_16x16x32_bf16 v[32:35], v[160:163], a[8:11], v[32:35]
    v_mfma_f32_16x16x32_bf16 v[36:39], v[164:167], a[8:11], v[36:39]
    ds_read_b128 a[40:43], v9 offset:4096
    v_mfma_f32_16x16x32_bf16 v[40:43], v[160:163], a[12:15], v[40:43]
    v_mfma_f32_16x16x32_bf16 v[44:47], v[164:167], a[12:15], v[44:47]
    ds_read_b128 a[44:47], v9 offset:6144
    s_waitcnt lgkmcnt(4)
    v_mfma_f32_16x16x32_bf16 v[48:51], v[160:163], a[16:19], v[48:51]
    v_mfma_f32_16x16x32_bf16 v[52:55], v[164:167], a[16:19], v[52:55]
    ds_read_b128 a[48:51], v9 offset:8192
    v_mfma_f32_16x16x32_bf16 v[56:59], v[160:163], a[20:23], v[56:59]
    v_mfma_f32_16x16x32_bf16 v[60:63], v[164:167], a[20:23], v[60:63]
    ds_read_b128 a[52:55], v9 offset:10240
    v_mfma_f32_16x16x32_bf16 v[64:67], v[160:163], a[24:27], v[64:67]
    v_mfma_f32_16x16x32_bf16 v[68:71], v[164:167], a[24:27], v[68:71]
    ds_read_b128 a[56:59], v9 offset:12288
    v_mfma_f32_16x16x32_bf16 v[72:75], v[160:163], a[28:31], v[72:75]
    v_mfma_f32_16x16x32_bf16 v[76:79], v[164:167], a[28:31], v[76:79]
    ds_read_b128 a[60:63], v9 offset:14336
    s_waitcnt vmcnt(8)
    s_barrier
    s_waitcnt lgkmcnt(4)
    v_mfma_f32_16x16x32_bf16 v[16:19], v[168:171], a[32:35], v[16:19]
    v_mfma_f32_16x16x32_bf16 v[20:23], v[172:175], a[32:35], v[20:23]
    ds_read_b128 a[0:3], v3 offset:0
    s_add_u32 m0, s21, 49152
    v_mfma_f32_16x16x32_bf16 v[24:27], v[168:171], a[36:39], v[24:27]
    v_mfma_f32_16x16x32_bf16 v[28:31], v[172:175], a[36:39], v[28:31]
    ds_read_b128 a[4:7], v3 offset:2048
    s_add_u32 s64, s20, 0x400
    buffer_load_dwordx4 v2, s[4:7], s64 offen lds
    v_mfma_f32_16x16x32_bf16 v[32:35], v[168:171], a[40:43], v[32:35]
    v_mfma_f32_16x16x32_bf16 v[36:39], v[172:175], a[40:43], v[36:39]
    ds_read_b128 a[8:11], v3 offset:4096
    s_add_u32 m0, s21, 50176
    v_mfma_f32_16x16x32_bf16 v[40:43], v[168:171], a[44:47], v[40:43]
    v_mfma_f32_16x16x32_bf16 v[44:47], v[172:175], a[44:47], v[44:47]
    ds_read_b128 a[12:15], v3 offset:6144
    s_add_u32 s64, s20, 0x2c00
    buffer_load_dwordx4 v2, s[4:7], s64 offen lds
    s_waitcnt lgkmcnt(4)
    v_mfma_f32_16x16x32_bf16 v[48:51], v[168:171], a[48:51], v[48:51]
    v_mfma_f32_16x16x32_bf16 v[52:55], v[172:175], a[48:51], v[52:55]
    ds_read_b128 a[16:19], v3 offset:8192
    s_add_u32 m0, s21, 51200
    v_mfma_f32_16x16x32_bf16 v[56:59], v[168:171], a[52:55], v[56:59]
    v_mfma_f32_16x16x32_bf16 v[60:63], v[172:175], a[52:55], v[60:63]
    ds_read_b128 a[20:23], v3 offset:10240
    s_add_u32 s64, s20, 0x5400
    buffer_load_dwordx4 v2, s[4:7], s64 offen lds
    v_mfma_f32_16x16x32_bf16 v[64:67], v[168:171], a[56:59], v[64:67]
    v_mfma_f32_16x16x32_bf16 v[68:71], v[172:175], a[56:59], v[68:71]
    ds_read_b128 a[24:27], v3 offset:12288
    s_add_u32 m0, s21, 52224
    v_mfma_f32_16x16x32_bf16 v[72:75], v[168:171], a[60:63], v[72:75]
    v_mfma_f32_16x16x32_bf16 v[76:79], v[172:175], a[60:63], v[76:79]
    ds_read_b128 a[28:31], v3 offset:14336
    s_add_u32 s64, s20, 0x7c00
    buffer_load_dwordx4 v2, s[4:7], s64 offen lds
    s_waitcnt lgkmcnt(4)
    v_mfma_f32_16x16x32_bf16 v[16:19], v[176:179], a[0:3], v[16:19]
    v_mfma_f32_16x16x32_bf16 v[20:23], v[180:183], a[0:3], v[20:23]
    ds_read_b128 a[32:35], v4 offset:0
    v_mfma_f32_16x16x32_bf16 v[24:27], v[176:179], a[4:7], v[24:27]
    v_mfma_f32_16x16x32_bf16 v[28:31], v[180:183], a[4:7], v[28:31]
    ds_read_b128 a[36:39], v4 offset:2048
    v_mfma_f32_16x16x32_bf16 v[32:35], v[176:179], a[8:11], v[32:35]
    v_mfma_f32_16x16x32_bf16 v[36:39], v[180:183], a[8:11], v[36:39]
    ds_read_b128 a[40:43], v4 offset:4096
    v_mfma_f32_16x16x32_bf16 v[40:43], v[176:179], a[12:15], v[40:43]
    v_mfma_f32_16x16x32_bf16 v[44:47], v[180:183], a[12:15], v[44:47]
    ds_read_b128 a[44:47], v4 offset:6144
    s_waitcnt lgkmcnt(4)
    v_mfma_f32_16x16x32_bf16 v[48:51], v[176:179], a[16:19], v[48:51]
    v_mfma_f32_16x16x32_bf16 v[52:55], v[180:183], a[16:19], v[52:55]
    ds_read_b128 a[48:51], v4 offset:8192
    v_mfma_f32_16x16x32_bf16 v[56:59], v[176:179], a[20:23], v[56:59]
    v_mfma_f32_16x16x32_bf16 v[60:63], v[180:183], a[20:23], v[60:63]
    ds_read_b128 a[52:55], v4 offset:10240
    v_mfma_f32_16x16x32_bf16 v[64:67], v[176:179], a[24:27], v[64:67]
    v_mfma_f32_16x16x32_bf16 v[68:71], v[180:183], a[24:27], v[68:71]
    ds_read_b128 a[56:59], v4 offset:12288
    v_mfma_f32_16x16x32_bf16 v[72:75], v[176:179], a[28:31], v[72:75]
    v_mfma_f32_16x16x32_bf16 v[76:79], v[180:183], a[28:31], v[76:79]
    ds_read_b128 a[60:63], v4 offset:14336
    s_waitcnt vmcnt(8)
    s_barrier
    s_waitcnt lgkmcnt(4)
    v_mfma_f32_16x16x32_bf16 v[16:19], v[184:187], a[32:35], v[16:19]
    v_mfma_f32_16x16x32_bf16 v[20:23], v[188:191], a[32:35], v[20:23]
    ds_read_b128 a[0:3], v3 offset:16384
    s_add_u32 m0, s21, 65536
    v_mfma_f32_16x16x32_bf16 v[24:27], v[184:187], a[36:39], v[24:27]
    v_mfma_f32_16x16x32_bf16 v[28:31], v[188:191], a[36:39], v[28:31]
    ds_read_b128 a[4:7], v3 offset:18432
    s_add_u32 s64, s20, 0x480
    buffer_load_dwordx4 v2, s[4:7], s64 offen lds
    v_mfma_f32_16x16x32_bf16 v[32:35], v[184:187], a[40:43], v[32:35]
    v_mfma_f32_16x16x32_bf16 v[36:39], v[188:191], a[40:43], v[36:39]
    ds_read_b128 a[8:11], v3 offset:20480
    s_add_u32 m0, s21, 66560
    v_mfma_f32_16x16x32_bf16 v[40:43], v[184:187], a[44:47], v[40:43]
    v_mfma_f32_16x16x32_bf16 v[44:47], v[188:191], a[44:47], v[44:47]
    ds_read_b128 a[12:15], v3 offset:22528
    s_add_u32 s64, s20, 0x2c80
    buffer_load_dwordx4 v2, s[4:7], s64 offen lds
    s_waitcnt lgkmcnt(4)
    v_mfma_f32_16x16x32_bf16 v[48:51], v[184:187], a[48:51], v[48:51]
    v_mfma_f32_16x16x32_bf16 v[52:55], v[188:191], a[48:51], v[52:55]
    ds_read_b128 a[16:19], v3 offset:24576
    s_add_u32 m0, s21, 67584
    v_mfma_f32_16x16x32_bf16 v[56:59], v[184:187], a[52:55], v[56:59]
    v_mfma_f32_16x16x32_bf16 v[60:63], v[188:191], a[52:55], v[60:63]
    ds_read_b128 a[20:23], v3 offset:26624
    s_add_u32 s64, s20, 0x5480
    buffer_load_dwordx4 v2, s[4:7], s64 offen lds
    v_mfma_f32_16x16x32_bf16 v[64:67], v[184:187], a[56:59], v[64:67]
    v_mfma_f32_16x16x32_bf16 v[68:71], v[188:191], a[56:59], v[68:71]
    ds_read_b128 a[24:27], v3 offset:28672
    s_add_u32 m0, s21, 68608
    v_mfma_f32_16x16x32_bf16 v[72:75], v[184:187], a[60:63], v[72:75]
    v_mfma_f32_16x16x32_bf16 v[76:79], v[188:191], a[60:63], v[76:79]
    ds_read_b128 a[28:31], v3 offset:30720
    s_add_u32 s64, s20, 0x7c80
    buffer_load_dwordx4 v2, s[4:7], s64 offen lds
    s_waitcnt lgkmcnt(4)
    v_mfma_f32_16x16x32_bf16 v[16:19], v[192:195], a[0:3], v[16:19]
    v_mfma_f32_16x16x32_bf16 v[20:23], v[196:199], a[0:3], v[20:23]
    ds_read_b128 a[32:35], v4 offset:16384
    v_mfma_f32_16x16x32_bf16 v[24:27], v[192:195], a[4:7], v[24:27]
    v_mfma_f32_16x16x32_bf16 v[28:31], v[196:199], a[4:7], v[28:31]
    ds_read_b128 a[36:39], v4 offset:18432
    v_mfma_f32_16x16x32_bf16 v[32:35], v[192:195], a[8:11], v[32:35]
    v_mfma_f32_16x16x32_bf16 v[36:39], v[196:199], a[8:11], v[36:39]
    ds_read_b128 a[40:43], v4 offset:20480
    v_mfma_f32_16x16x32_bf16 v[40:43], v[192:195], a[12:15], v[40:43]
    v_mfma_f32_16x16x32_bf16 v[44:47], v[196:199], a[12:15], v[44:47]
    ds_read_b128 a[44:47], v4 offset:22528
    s_waitcnt lgkmcnt(4)
    v_mfma_f32_16x16x32_bf16 v[48:51], v[192:195], a[16:19], v[48:51]
    v_mfma_f32_16x16x32_bf16 v[52:55], v[196:199], a[16:19], v[52:55]
    ds_read_b128 a[48:51], v4 offset:24576
    v_mfma_f32_16x16x32_bf16 v[56:59], v[192:195], a[20:23], v[56:59]
    v_mfma_f32_16x16x32_bf16 v[60:63], v[196:199], a[20:23], v[60:63]
    ds_read_b128 a[52:55], v4 offset:26624
    v_mfma_f32_16x16x32_bf16 v[64:67], v[192:195], a[24:27], v[64:67]
    v_mfma_f32_16x16x32_bf16 v[68:71], v[196:199], a[24:27], v[68:71]
    ds_read_b128 a[56:59], v4 offset:28672
    v_mfma_f32_16x16x32_bf16 v[72:75], v[192:195], a[28:31], v[72:75]
    v_mfma_f32_16x16x32_bf16 v[76:79], v[196:199], a[28:31], v[76:79]
    ds_read_b128 a[60:63], v4 offset:30720
    s_waitcnt vmcnt(8)
    s_barrier
    s_waitcnt lgkmcnt(4)
    v_mfma_f32_16x16x32_bf16 v[16:19], v[200:203], a[32:35], v[16:19]
    v_mfma_f32_16x16x32_bf16 v[20:23], v[204:207], a[32:35], v[20:23]
    ds_read_b128 a[0:3], v3 offset:32768
    s_add_u32 m0, s21, 0
    v_mfma_f32_16x16x32_bf16 v[24:27], v[200:203], a[36:39], v[24:27]
    v_mfma_f32_16x16x32_bf16 v[28:31], v[204:207], a[36:39], v[28:31]
    ds_read_b128 a[4:7], v3 offset:34816
    s_add_u32 s64, s20, 0x50000
    buffer_load_dwordx4 v2, s[4:7], s64 offen lds
    v_mfma_f32_16x16x32_bf16 v[32:35], v[200:203], a[40:43], v[32:35]
    v_mfma_f32_16x16x32_bf16 v[36:39], v[204:207], a[40:43], v[36:39]
    ds_read_b128 a[8:11], v3 offset:36864
    s_add_u32 m0, s21, 1024
    v_mfma_f32_16x16x32_bf16 v[40:43], v[200:203], a[44:47], v[40:43]
    v_mfma_f32_16x16x32_bf16 v[44:47], v[204:207], a[44:47], v[44:47]
    ds_read_b128 a[12:15], v3 offset:38912
    s_add_u32 s64, s20, 0x52800
    buffer_load_dwordx4 v2, s[4:7], s64 offen lds
    s_waitcnt lgkmcnt(4)
    v_mfma_f32_16x16x32_bf16 v[48:51], v[200:203], a[48:51], v[48:51]
    v_mfma_f32_16x16x32_bf16 v[52:55], v[204:207], a[48:51], v[52:55]
    ds_read_b128 a[16:19], v3 offset:40960
    s_add_u32 m0, s21, 2048
    v_mfma_f32_16x16x32_bf16 v[56:59], v[200:203], a[52:55], v[56:59]
    v_mfma_f32_16x16x32_bf16 v[60:63], v[204:207], a[52:55], v[60:63]
    ds_read_b128 a[20:23], v3 offset:43008
    s_add_u32 s64, s20, 0x55000
    buffer_load_dwordx4 v2, s[4:7], s64 offen lds
    v_mfma_f32_16x16x32_bf16 v[64:67], v[200:203], a[56:59], v[64:67]
    v_mfma_f32_16x16x32_bf16 v[68:71], v[204:207], a[56:59], v[68:71]
    ds_read_b128 a[24:27], v3 offset:45056
    s_add_u32 m0, s21, 3072
    v_mfma_f32_16x16x32_bf16 v[72:75], v[200:203], a[60:63], v[72:75]
    v_mfma_f32_16x16x32_bf16 v[76:79], v[204:207], a[60:63], v[76:79]
    ds_read_b128 a[28:31], v3 offset:47104
    s_add_u32 s64, s20, 0x57800
    buffer_load_dwordx4 v2, s[4:7], s64 offen lds
    s_waitcnt lgkmcnt(4)
    v_mfma_f32_16x16x32_bf16 v[16:19], v[208:211], a[0:3], v[16:19]
    v_mfma_f32_16x16x32_bf16 v[20:23], v[212:215], a[0:3], v[20:23]
    ds_read_b128 a[32:35], v4 offset:32768
    v_mfma_f32_16x16x32_bf16 v[24:27], v[208:211], a[4:7], v[24:27]
    v_mfma_f32_16x16x32_bf16 v[28:31], v[212:215], a[4:7], v[28:31]
    ds_read_b128 a[36:39], v4 offset:34816
    v_mfma_f32_16x16x32_bf16 v[32:35], v[208:211], a[8:11], v[32:35]
    v_mfma_f32_16x16x32_bf16 v[36:39], v[212:215], a[8:11], v[36:39]
    ds_read_b128 a[40:43], v4 offset:36864
    v_mfma_f32_16x16x32_bf16 v[40:43], v[208:211], a[12:15], v[40:43]
    v_mfma_f32_16x16x32_bf16 v[44:47], v[212:215], a[12:15], v[44:47]
    ds_read_b128 a[44:47], v4 offset:38912
    s_waitcnt lgkmcnt(4)
    v_mfma_f32_16x16x32_bf16 v[48:51], v[208:211], a[16:19], v[48:51]
    v_mfma_f32_16x16x32_bf16 v[52:55], v[212:215], a[16:19], v[52:55]
    ds_read_b128 a[48:51], v4 offset:40960
    v_mfma_f32_16x16x32_bf16 v[56:59], v[208:211], a[20:23], v[56:59]
    v_mfma_f32_16x16x32_bf16 v[60:63], v[212:215], a[20:23], v[60:63]
    ds_read_b128 a[52:55], v4 offset:43008
    v_mfma_f32_16x16x32_bf16 v[64:67], v[208:211], a[24:27], v[64:67]
    v_mfma_f32_16x16x32_bf16 v[68:71], v[212:215], a[24:27], v[68:71]
    ds_read_b128 a[56:59], v4 offset:45056
    v_mfma_f32_16x16x32_bf16 v[72:75], v[208:211], a[28:31], v[72:75]
    v_mfma_f32_16x16x32_bf16 v[76:79], v[212:215], a[28:31], v[76:79]
    ds_read_b128 a[60:63], v4 offset:47104
    s_waitcnt vmcnt(8)
    s_barrier
    s_waitcnt lgkmcnt(4)
    v_mfma_f32_16x16x32_bf16 v[16:19], v[216:219], a[32:35], v[16:19]
    v_mfma_f32_16x16x32_bf16 v[20:23], v[220:223], a[32:35], v[20:23]
    ds_read_b128 a[0:3], v3 offset:49152
    s_add_u32 m0, s21, 16384
    v_mfma_f32_16x16x32_bf16 v[24:27], v[216:219], a[36:39], v[24:27]
    v_mfma_f32_16x16x32_bf16 v[28:31], v[220:223], a[36:39], v[28:31]
    ds_read_b128 a[4:7], v3 offset:51200
    s_add_u32 s64, s20, 0x50080
    buffer_load_dwordx4 v2, s[4:7], s64 offen lds
    v_mfma_f32_16x16x32_bf16 v[32:35], v[216:219], a[40:43], v[32:35]
    v_mfma_f32_16x16x32_bf16 v[36:39], v[220:223], a[40:43], v[36:39]
    ds_read_b128 a[8:11], v3 offset:53248
    s_add_u32 m0, s21, 17408
    v_mfma_f32_16x16x32_bf16 v[40:43], v[216:219], a[44:47], v[40:43]
    v_mfma_f32_16x16x32_bf16 v[44:47], v[220:223], a[44:47], v[44:47]
    ds_read_b128 a[12:15], v3 offset:55296
    s_add_u32 s64, s20, 0x52880
    buffer_load_dwordx4 v2, s[4:7], s64 offen lds
    s_waitcnt lgkmcnt(4)
    v_mfma_f32_16x16x32_bf16 v[48:51], v[216:219], a[48:51], v[48:51]
    v_mfma_f32_16x16x32_bf16 v[52:55], v[220:223], a[48:51], v[52:55]
    ds_read_b128 a[16:19], v3 offset:57344
    s_add_u32 m0, s21, 18432
    v_mfma_f32_16x16x32_bf16 v[56:59], v[216:219], a[52:55], v[56:59]
    v_mfma_f32_16x16x32_bf16 v[60:63], v[220:223], a[52:55], v[60:63]
    ds_read_b128 a[20:23], v3 offset:59392
    s_add_u32 s64, s20, 0x55080
    buffer_load_dwordx4 v2, s[4:7], s64 offen lds
    v_mfma_f32_16x16x32_bf16 v[64:67], v[216:219], a[56:59], v[64:67]
    v_mfma_f32_16x16x32_bf16 v[68:71], v[220:223], a[56:59], v[68:71]
    ds_read_b128 a[24:27], v3 offset:61440
    s_add_u32 m0, s21, 19456
    v_mfma_f32_16x16x32_bf16 v[72:75], v[216:219], a[60:63], v[72:75]
    v_mfma_f32_16x16x32_bf16 v[76:79], v[220:223], a[60:63], v[76:79]
    ds_read_b128 a[28:31], v3 offset:63488
    s_add_u32 s64, s20, 0x57880
    buffer_load_dwordx4 v2, s[4:7], s64 offen lds
    s_waitcnt lgkmcnt(4)
    v_mfma_f32_16x16x32_bf16 v[16:19], v[224:227], a[0:3], v[16:19]
    v_mfma_f32_16x16x32_bf16 v[20:23], v[228:231], a[0:3], v[20:23]
    ds_read_b128 a[32:35], v4 offset:49152
    v_mfma_f32_16x16x32_bf16 v[24:27], v[224:227], a[4:7], v[24:27]
    v_mfma_f32_16x16x32_bf16 v[28:31], v[228:231], a[4:7], v[28:31]
    ds_read_b128 a[36:39], v4 offset:51200
    v_mfma_f32_16x16x32_bf16 v[32:35], v[224:227], a[8:11], v[32:35]
    v_mfma_f32_16x16x32_bf16 v[36:39], v[228:231], a[8:11], v[36:39]
    ds_read_b128 a[40:43], v4 offset:53248
    v_mfma_f32_16x16x32_bf16 v[40:43], v[224:227], a[12:15], v[40:43]
    v_mfma_f32_16x16x32_bf16 v[44:47], v[228:231], a[12:15], v[44:47]
    ds_read_b128 a[44:47], v4 offset:55296
    s_waitcnt lgkmcnt(4)
    v_mfma_f32_16x16x32_bf16 v[48:51], v[224:227], a[16:19], v[48:51]
    v_mfma_f32_16x16x32_bf16 v[52:55], v[228:231], a[16:19], v[52:55]
    ds_read_b128 a[48:51], v4 offset:57344
    v_mfma_f32_16x16x32_bf16 v[56:59], v[224:227], a[20:23], v[56:59]
    v_mfma_f32_16x16x32_bf16 v[60:63], v[228:231], a[20:23], v[60:63]
    ds_read_b128 a[52:55], v4 offset:59392
    v_mfma_f32_16x16x32_bf16 v[64:67], v[224:227], a[24:27], v[64:67]
    v_mfma_f32_16x16x32_bf16 v[68:71], v[228:231], a[24:27], v[68:71]
    ds_read_b128 a[56:59], v4 offset:61440
    v_mfma_f32_16x16x32_bf16 v[72:75], v[224:227], a[28:31], v[72:75]
    v_mfma_f32_16x16x32_bf16 v[76:79], v[228:231], a[28:31], v[76:79]
    ds_read_b128 a[60:63], v4 offset:63488
    s_waitcnt vmcnt(8)
    s_barrier
    s_waitcnt lgkmcnt(4)
    v_mfma_f32_16x16x32_bf16 v[16:19], v[232:235], a[32:35], v[16:19]
    v_mfma_f32_16x16x32_bf16 v[20:23], v[236:239], a[32:35], v[20:23]
    ds_read_b128 a[0:3], v6 offset:0
    s_add_u32 m0, s21, 32768
    v_mfma_f32_16x16x32_bf16 v[24:27], v[232:235], a[36:39], v[24:27]
    v_mfma_f32_16x16x32_bf16 v[28:31], v[236:239], a[36:39], v[28:31]
    ds_read_b128 a[4:7], v6 offset:2048
    s_add_u32 s64, s20, 0x50100
    buffer_load_dwordx4 v2, s[4:7], s64 offen lds
    v_mfma_f32_16x16x32_bf16 v[32:35], v[232:235], a[40:43], v[32:35]
    v_mfma_f32_16x16x32_bf16 v[36:39], v[236:239], a[40:43], v[36:39]
    ds_read_b128 a[8:11], v6 offset:4096
    s_add_u32 m0, s21, 33792
    v_mfma_f32_16x16x32_bf16 v[40:43], v[232:235], a[44:47], v[40:43]
    v_mfma_f32_16x16x32_bf16 v[44:47], v[236:239], a[44:47], v[44:47]
    ds_read_b128 a[12:15], v6 offset:6144
    s_add_u32 s64, s20, 0x52900
    buffer_load_dwordx4 v2, s[4:7], s64 offen lds
    s_waitcnt lgkmcnt(4)
    v_mfma_f32_16x16x32_bf16 v[48:51], v[232:235], a[48:51], v[48:51]
    v_mfma_f32_16x16x32_bf16 v[52:55], v[236:239], a[48:51], v[52:55]
    ds_read_b128 a[16:19], v6 offset:8192
    s_add_u32 m0, s21, 34816
    v_mfma_f32_16x16x32_bf16 v[56:59], v[232:235], a[52:55], v[56:59]
    v_mfma_f32_16x16x32_bf16 v[60:63], v[236:239], a[52:55], v[60:63]
    ds_read_b128 a[20:23], v6 offset:10240
    s_add_u32 s64, s20, 0x55100
    buffer_load_dwordx4 v2, s[4:7], s64 offen lds
    v_mfma_f32_16x16x32_bf16 v[64:67], v[232:235], a[56:59], v[64:67]
    v_mfma_f32_16x16x32_bf16 v[68:71], v[236:239], a[56:59], v[68:71]
    ds_read_b128 a[24:27], v6 offset:12288
    s_add_u32 m0, s21, 35840
    v_mfma_f32_16x16x32_bf16 v[72:75], v[232:235], a[60:63], v[72:75]
    v_mfma_f32_16x16x32_bf16 v[76:79], v[236:239], a[60:63], v[76:79]
    ds_read_b128 a[28:31], v6 offset:14336
    s_add_u32 s64, s20, 0x57900
    buffer_load_dwordx4 v2, s[4:7], s64 offen lds
    s_waitcnt lgkmcnt(4)
    v_mfma_f32_16x16x32_bf16 v[16:19], v[240:243], a[0:3], v[16:19]
    v_mfma_f32_16x16x32_bf16 v[20:23], v[244:247], a[0:3], v[20:23]
    ds_read_b128 a[32:35], v9 offset:0
    v_mfma_f32_16x16x32_bf16 v[24:27], v[240:243], a[4:7], v[24:27]
    v_mfma_f32_16x16x32_bf16 v[28:31], v[244:247], a[4:7], v[28:31]
    ds_read_b128 a[36:39], v9 offset:2048
    v_mfma_f32_16x16x32_bf16 v[32:35], v[240:243], a[8:11], v[32:35]
    v_mfma_f32_16x16x32_bf16 v[36:39], v[244:247], a[8:11], v[36:39]
    ds_read_b128 a[40:43], v9 offset:4096
    v_mfma_f32_16x16x32_bf16 v[40:43], v[240:243], a[12:15], v[40:43]
    v_mfma_f32_16x16x32_bf16 v[44:47], v[244:247], a[12:15], v[44:47]
    ds_read_b128 a[44:47], v9 offset:6144
    s_waitcnt lgkmcnt(4)
    v_mfma_f32_16x16x32_bf16 v[48:51], v[240:243], a[16:19], v[48:51]
    v_mfma_f32_16x16x32_bf16 v[52:55], v[244:247], a[16:19], v[52:55]
    ds_read_b128 a[48:51], v9 offset:8192
    v_mfma_f32_16x16x32_bf16 v[56:59], v[240:243], a[20:23], v[56:59]
    v_mfma_f32_16x16x32_bf16 v[60:63], v[244:247], a[20:23], v[60:63]
    ds_read_b128 a[52:55], v9 offset:10240
    v_mfma_f32_16x16x32_bf16 v[64:67], v[240:243], a[24:27], v[64:67]
    v_mfma_f32_16x16x32_bf16 v[68:71], v[244:247], a[24:27], v[68:71]
    ds_read_b128 a[56:59], v9 offset:12288
    v_mfma_f32_16x16x32_bf16 v[72:75], v[240:243], a[28:31], v[72:75]
    v_mfma_f32_16x16x32_bf16 v[76:79], v[244:247], a[28:31], v[76:79]
    ds_read_b128 a[60:63], v9 offset:14336
    s_waitcnt vmcnt(8)
    s_barrier
    s_waitcnt lgkmcnt(4)
    v_mfma_f32_16x16x32_bf16 v[16:19], v[248:251], a[32:35], v[16:19]
    v_mfma_f32_16x16x32_bf16 v[20:23], v[252:255], a[32:35], v[20:23]
    ds_read_b128 a[0:3], v3 offset:0
    s_add_u32 m0, s21, 49152
    v_mfma_f32_16x16x32_bf16 v[24:27], v[248:251], a[36:39], v[24:27]
    v_mfma_f32_16x16x32_bf16 v[28:31], v[252:255], a[36:39], v[28:31]
    ds_read_b128 a[4:7], v3 offset:2048
    s_add_u32 s64, s20, 0x50180
    buffer_load_dwordx4 v2, s[4:7], s64 offen lds
    v_mfma_f32_16x16x32_bf16 v[32:35], v[248:251], a[40:43], v[32:35]
    v_mfma_f32_16x16x32_bf16 v[36:39], v[252:255], a[40:43], v[36:39]
    ds_read_b128 a[8:11], v3 offset:4096
    s_add_u32 m0, s21, 50176
    v_mfma_f32_16x16x32_bf16 v[40:43], v[248:251], a[44:47], v[40:43]
    v_mfma_f32_16x16x32_bf16 v[44:47], v[252:255], a[44:47], v[44:47]
    ds_read_b128 a[12:15], v3 offset:6144
    s_add_u32 s64, s20, 0x52980
    buffer_load_dwordx4 v2, s[4:7], s64 offen lds
    s_waitcnt lgkmcnt(4)
    v_mfma_f32_16x16x32_bf16 v[48:51], v[248:251], a[48:51], v[48:51]
    v_mfma_f32_16x16x32_bf16 v[52:55], v[252:255], a[48:51], v[52:55]
    ds_read_b128 a[16:19], v3 offset:8192
    s_add_u32 m0, s21, 51200
    v_mfma_f32_16x16x32_bf16 v[56:59], v[248:251], a[52:55], v[56:59]
    v_mfma_f32_16x16x32_bf16 v[60:63], v[252:255], a[52:55], v[60:63]
    ds_read_b128 a[20:23], v3 offset:10240
    s_add_u32 s64, s20, 0x55180
    buffer_load_dwordx4 v2, s[4:7], s64 offen lds
    v_mfma_f32_16x16x32_bf16 v[64:67], v[248:251], a[56:59], v[64:67]
    v_mfma_f32_16x16x32_bf16 v[68:71], v[252:255], a[56:59], v[68:71]
    ds_read_b128 a[24:27], v3 offset:12288
    s_add_u32 m0, s21, 52224
    v_mfma_f32_16x16x32_bf16 v[72:75], v[248:251], a[60:63], v[72:75]
    v_mfma_f32_16x16x32_bf16 v[76:79], v[252:255], a[60:63], v[76:79]
    ds_read_b128 a[28:31], v3 offset:14336
    s_add_u32 s64, s20, 0x57980
    buffer_load_dwordx4 v2, s[4:7], s64 offen lds
    s_nop 5
    s_mul_i32 s65, s17, 0
    s_add_u32 s65, s65, s22
    s_add_u32 s64, s65, 0
    v_cvt_pk_bf16_f32 v80, v16, v17
    v_cvt_pk_bf16_f32 v81, v18, v19
    v_cvt_pk_bf16_f32 v82, v20, v21
    v_cvt_pk_bf16_f32 v83, v22, v23
    buffer_store_dwordx4 v[80:83], v1, s[4:7], s64 offen sc1
    s_add_u32 s64, s65, 4096
    v_cvt_pk_bf16_f32 v84, v24, v25
    v_cvt_pk_bf16_f32 v85, v26, v27
    v_cvt_pk_bf16_f32 v86, v28, v29
    v_cvt_pk_bf16_f32 v87, v30, v31
    buffer_store_dwordx4 v[84:87], v1, s[4:7], s64 offen sc1
    s_mul_i32 s65, s17, 1
    s_add_u32 s65, s65, s22
    s_add_u32 s64, s65, 0
    v_cvt_pk_bf16_f32 v88, v32, v33
    v_cvt_pk_bf16_f32 v89, v34, v35
    v_cvt_pk_bf16_f32 v90, v36, v37
    v_cvt_pk_bf16_f32 v91, v38, v39
    buffer_store_dwordx4 v[88:91], v1, s[4:7], s64 offen sc1
    s_add_u32 s64, s65, 4096
    v_cvt_pk_bf16_f32 v92, v40, v41
    v_cvt_pk_bf16_f32 v93, v42, v43
    v_cvt_pk_bf16_f32 v94, v44, v45
    v_cvt_pk_bf16_f32 v95, v46, v47
    buffer_store_dwordx4 v[92:95], v1, s[4:7], s64 offen sc1
    s_mul_i32 s65, s17, 2
    s_add_u32 s65, s65, s22
    s_add_u32 s64, s65, 0
    v_cvt_pk_bf16_f32 v80, v48, v49
    v_cvt_pk_bf16_f32 v81, v50, v51
    v_cvt_pk_bf16_f32 v82, v52, v53
    v_cvt_pk_bf16_f32 v83, v54, v55
    buffer_store_dwordx4 v[80:83], v1, s[4:7], s64 offen sc1
    s_add_u32 s64, s65, 4096
    v_cvt_pk_bf16_f32 v84, v56, v57
    v_cvt_pk_bf16_f32 v85, v58, v59
    v_cvt_pk_bf16_f32 v86, v60, v61
    v_cvt_pk_bf16_f32 v87, v62, v63
    buffer_store_dwordx4 v[84:87], v1, s[4:7], s64 offen sc1
    s_mul_i32 s65, s17, 3
    s_add_u32 s65, s65, s22
    s_add_u32 s64, s65, 0
    v_cvt_pk_bf16_f32 v88, v64, v65
    v_cvt_pk_bf16_f32 v89, v66, v67
    v_cvt_pk_bf16_f32 v90, v68, v69
    v_cvt_pk_bf16_f32 v91, v70, v71
    buffer_store_dwordx4 v[88:91], v1, s[4:7], s64 offen sc1
    s_add_u32 s64, s65, 4096
    v_cvt_pk_bf16_f32 v92, v72, v73
    v_cvt_pk_bf16_f32 v93, v74, v75
    v_cvt_pk_bf16_f32 v94, v76, v77
    v_cvt_pk_bf16_f32 v95, v78, v79
    buffer_store_dwordx4 v[92:95], v1, s[4:7], s64 offen sc1
    s_lshl_b32 s64, s19, 1
    s_add_u32 s64, s64, s12
    s_lshl_b32 s64, s64, 9
    s_add_u32 s23, s18, s64
    s_lshl_b32 s64, s17, 3
    s_add_u32 s22, s22, s64
    s_add_u32 s19, s19, 1
    s_add_u32 s20, s20, 0x50000
    s_cmp_lg_u32 s19, 1
    s_cbranch_scc1 GE0_122
    s_waitcnt vmcnt(0)
    s_barrier
    s_cmp_lg_u32 s14, 0
    s_cbranch_scc1 GF_123
    v_mov_b32 v7, 1
    v_mov_b32 v8, 0
    s_mov_b64 exec, 1
    buffer_store_dword v7, v8, s[4:7], s23 offen sc1
    s_mov_b64 exec, -1
GF_123:
GE0_122:
    s_cmp_lt_u32 s19, 8
    s_cbranch_scc1 G_T_LOOP
    s_waitcnt vmcnt(0) lgkmcnt(0)
    s_barrier
    s_cmp_lg_u32 s14, 0
    s_cbranch_scc1 GF_124
    v_mov_b32 v7, 1
    v_mov_b32 v8, 0
    s_mov_b64 exec, 1
    buffer_store_dword v7, v8, s[4:7], s23 offen sc1
    s_mov_b64 exec, -1
GF_124:
    s_cmp_eq_u32 s3, 2
    s_cbranch_scc1 H_Q
    s_cmp_eq_u32 s12, 1
    s_cbranch_scc1 H_OUT
    s_lshl_b32 s88, s3, 5
    s_add_u32 s88, s88, s13
    s_mov_b32 s29, 0
    v_lshlrev_b32 v1, 4, v0
    s_mov_b32 s65, 0
CW_125:
    buffer_load_dwordx2 v[8:9], off, s[60:63], 0 offset:132 sc1
    s_add_u32 s65, s65, 1
    s_waitcnt vmcnt(0)
    v_readfirstlane_b32 s66, v8
    v_readfirstlane_b32 s67, v9
    s_min_u32 s64, s66, s67
    s_cmp_lg_u32 s64, 0
    s_cbranch_scc1 CWD_126
    s_cmp_gt_u32 s65, 65536
    s_cbranch_scc1 CWD_126
    s_sleep 4
    s_branch CW_125
CWD_126:
    s_sub_u32 s66, s66, 1
    s_and_b32 s66, s66, 3
    s_sub_u32 s67, s67, 1
    s_and_b32 s67, s67, 3
    s_mov_b32 s64, s66
    s_mov_b32 s65, s67
    s_and_b32 s64, s64, 3
    s_lshl_b32 s64, s64, 13
    s_and_b32 s65, s65, 3
    s_lshl_b32 s65, s65, 13
    s_add_u32 s25, s64, 0x6000000
    s_add_u32 s30, s65, 0x6200000
    v_bfe_u32 v4, v0, 3, 1
    v_mul_u32_u24 v2, 0x8000, v4
    v_lshrrev_b32 v4, 5, v0
    v_lshl_add_u32 v2, v4, 8, v2
    v_bfe_u32 v4, v0, 4, 1
    v_lshl_add_u32 v2, v4, 7, v2
    v_and_b32 v4, 7, v0
    v_lshl_add_u32 v2, v4, 4, v2
    v_bfe_u32 v4, v0, 3, 1
    v_lshlrev_b32 v3, 16, v4
    v_lshrrev_b32 v4, 4, v0
    v_lshl_add_u32 v3, v4, 7, v3
    v_and_b32 v4, 7, v0
    v_lshl_add_u32 v3, v4, 4, v3
    s_lshl_b32 s26, s13, 11
    s_lshl_b32 s64, s14, 9
    s_add_u32 s26, s26, s64
    s_add_u32 s26, s26, 0x640000
    s_lshl_b32 s27, s13, 3
    s_add_u32 s27, s27, 0x294000
    s_mov_b32 s28, 0x29a000
    s_mov_b32 s24, 0
    v_lshlrev_b32 v6, 7, v0
MKT_LOOP:
    s_cmp_lg_u32 s24, 10
    s_cbranch_scc1 MKH_127
    v_mov_b32 v10, v2
    v_mov_b32 v11, v3
    s_cmp_ge_u32 s88, 60
    s_cbranch_scc1 NOWO_128
    s_mov_b32 s89, s13
    s_mul_hi_u32 s65, s88, 0xccccccd
    s_mul_i32 s65, s65, 20
    s_sub_u32 s13, s88, s65
    s_load_dwordx2 s[44:45], s[0:1], 40
    s_mov_b32 s46, 0x500000
    s_mov_b32 s47, 0x00020000
    s_waitcnt lgkmcnt(0)
    s_mul_i32 s21, s14, 36864
    v_lshrrev_b32 v7, 2, v0
    v_mul_u32_u24 v4, 1280, v7
    v_bfe_u32 v7, v0, 4, 1
    v_lshlrev_b32 v7, 1, v7
    v_and_b32 v8, 3, v0
    v_xor_b32 v7, v7, v8
    v_lshl_add_u32 v4, v7, 4, v4
    v_lshrrev_b32 v7, 4, v0
    v_lshlrev_b32 v2, 8, v7
    v_bfe_u32 v7, v0, 2, 2
    v_lshl_add_u32 v2, v7, 6, v2
    v_and_b32 v7, 3, v0
    v_lshl_add_u32 v2, v7, 3, v2
    v_add_u32 v2, s21, v2
    v_bfe_u32 v7, v0, 4, 1
    v_lshlrev_b32 v7, 5, v7
    v_sub_u32 v3, 32, v7
    v_add_u32 v3, v3, v2
    v_add_u32 v2, v2, v7
    s_mul_i32 s65, s14, 1310720
    s_lshl_b32 s66, s13, 6
    s_add_u32 s65, s65, s66
    s_add_u32 m0, s21, 0
    s_add_u32 s64, s65, 0x0
    buffer_load_dwordx4 v4, s[44:47], s64 offen lds
    s_add_u32 m0, s21, 1024
    s_add_u32 s64, s65, 0x5000
    buffer_load_dwordx4 v4, s[44:47], s64 offen lds
    s_add_u32 m0, s21, 2048
    s_add_u32 s64, s65, 0xa000
    buffer_load_dwordx4 v4, s[44:47], s64 offen lds
    s_add_u32 m0, s21, 3072
    s_add_u32 s64, s65, 0xf000
    buffer_load_dwordx4 v4, s[44:47], s64 offen lds
    s_add_u32 m0, s21, 4096
    s_add_u32 s64, s65, 0x14000
    buffer_load_dwordx4 v4, s[44:47], s64 offen lds
    s_add_u32 m0, s21, 5120
    s_add_u32 s64, s65, 0x19000
    buffer_load_dwordx4 v4, s[44:47], s64 offen lds
    s_add_u32 m0, s21, 6144
    s_add_u32 s64, s65, 0x1e000
    buffer_load_dwordx4 v4, s[44:47], s64 offen lds
    s_add_u32 m0, s21, 7168
    s_add_u32 s64, s65, 0x23000
    buffer_load_dwordx4 v4, s[44:47], s64 offen lds
    s_add_u32 m0, s21, 8192
    s_add_u32 s64, s65, 0x28000
    buffer_load_dwordx4 v4, s[44:47], s64 offen lds
    s_add_u32 m0, s21, 9216
    s_add_u32 s64, s65, 0x2d000
    buffer_load_dwordx4 v4, s[44:47], s64 offen lds
    s_add_u32 m0, s21, 10240
    s_add_u32 s64, s65, 0x32000
    buffer_load_dwordx4 v4, s[44:47], s64 offen lds
    s_add_u32 m0, s21, 11264
    s_add_u32 s64, s65, 0x37000
    buffer_load_dwordx4 v4, s[44:47], s64 offen lds
    s_add_u32 m0, s21, 12288
    s_add_u32 s64, s65, 0x3c000
    buffer_load_dwordx4 v4, s[44:47], s64 offen lds
    s_add_u32 m0, s21, 13312
    s_add_u32 s64, s65, 0x41000
    buffer_load_dwordx4 v4, s[44:47], s64 offen lds
    s_add_u32 m0, s21, 14336
    s_add_u32 s64, s65, 0x46000
    buffer_load_dwordx4 v4, s[44:47], s64 offen lds
    s_add_u32 m0, s21, 15360
    s_add_u32 s64, s65, 0x4b000
    buffer_load_dwordx4 v4, s[44:47], s64 offen lds
    s_add_u32 m0, s21, 16384
    s_add_u32 s64, s65, 0x50000
    buffer_load_dwordx4 v4, s[44:47], s64 offen lds
    s_add_u32 m0, s21, 17408
    s_add_u32 s64, s65, 0x55000
    buffer_load_dwordx4 v4, s[44:47], s64 offen lds
    s_add_u32 m0, s21, 18432
    s_add_u32 s64, s65, 0x5a000
    buffer_load_dwordx4 v4, s[44:47], s64 offen lds
    s_add_u32 m0, s21, 19456
    s_add_u32 s64, s65, 0x5f000
    buffer_load_dwordx4 v4, s[44:47], s64 offen lds
    s_add_u32 m0, s21, 20480
    s_add_u32 s64, s65, 0x64000
    buffer_load_dwordx4 v4, s[44:47], s64 offen lds
    s_add_u32 m0, s21, 21504
    s_add_u32 s64, s65, 0x69000
    buffer_load_dwordx4 v4, s[44:47], s64 offen lds
    s_add_u32 m0, s21, 22528
    s_add_u32 s64, s65, 0x6e000
    buffer_load_dwordx4 v4, s[44:47], s64 offen lds
    s_add_u32 m0, s21, 23552
    s_add_u32 s64, s65, 0x73000
    buffer_load_dwordx4 v4, s[44:47], s64 offen lds
    s_add_u32 m0, s21, 24576
    s_add_u32 s64, s65, 0x78000
    buffer_load_dwordx4 v4, s[44:47], s64 offen lds
    s_add_u32 m0, s21, 25600
    s_add_u32 s64, s65, 0x7d000
    buffer_load_dwordx4 v4, s[44:47], s64 offen lds
    s_add_u32 m0, s21, 26624
    s_add_u32 s64, s65, 0x82000
    buffer_load_dwordx4 v4, s[44:47], s64 offen lds
    s_add_u32 m0, s21, 27648
    s_add_u32 s64, s65, 0x87000
    buffer_load_dwordx4 v4, s[44:47], s64 offen lds
    s_add_u32 m0, s21, 28672
    s_add_u32 s64, s65, 0x8c000
    buffer_load_dwordx4 v4, s[44:47], s64 offen lds
    s_add_u32 m0, s21, 29696
    s_add_u32 s64, s65, 0x91000
    buffer_load_dwordx4 v4, s[44:47], s64 offen lds
    s_add_u32 m0, s21, 30720
    s_add_u32 s64, s65, 0x96000
    buffer_load_dwordx4 v4, s[44:47], s64 offen lds
    s_add_u32 m0, s21, 31744
    s_add_u32 s64, s65, 0x9b000
    buffer_load_dwordx4 v4, s[44:47], s64 offen lds
    s_add_u32 m0, s21, 32768
    s_add_u32 s64, s65, 0xa0000
    buffer_load_dwordx4 v4, s[44:47], s64 offen lds
    s_add_u32 m0, s21, 33792
    s_add_u32 s64, s65, 0xa5000
    buffer_load_dwordx4 v4, s[44:47], s64 offen lds
    s_add_u32 m0, s21, 34816
    s_add_u32 s64, s65, 0xaa000
    buffer_load_dwordx4 v4, s[44:47], s64 offen lds
    s_add_u32 m0, s21, 35840
    s_add_u32 s64, s65, 0xaf000
    buffer_load_dwordx4 v4, s[44:47], s64 offen lds
    s_waitcnt vmcnt(32)
    ds_read_b64_tr_b16 a[0:1], v2 offset:0
    ds_read_b64_tr_b16 a[2:3], v2 offset:1024
    ds_read_b64_tr_b16 a[4:5], v3 offset:0
    ds_read_b64_tr_b16 a[6:7], v3 offset:1024
    ds_read_b64_tr_b16 a[8:9], v2 offset:2048
    ds_read_b64_tr_b16 a[10:11], v2 offset:3072
    ds_read_b64_tr_b16 a[12:13], v3 offset:2048
    ds_read_b64_tr_b16 a[14:15], v3 offset:3072
    s_waitcnt lgkmcnt(0)
    s_add_u32 m0, s21, 0
    s_add_u32 s64, s65, 0xb4000
    buffer_load_dwordx4 v4, s[44:47], s64 offen lds
    s_add_u32 m0, s21, 1024
    s_add_u32 s64, s65, 0xb9000
    buffer_load_dwordx4 v4, s[44:47], s64 offen lds
    s_add_u32 m0, s21, 2048
    s_add_u32 s64, s65, 0xbe000
    buffer_load_dwordx4 v4, s[44:47], s64 offen lds
    s_add_u32 m0, s21, 3072
    s_add_u32 s64, s65, 0xc3000
    buffer_load_dwordx4 v4, s[44:47], s64 offen lds
    s_waitcnt vmcnt(32)
    ds_read_b64_tr_b16 a[16:17], v2 offset:4096
    ds_read_b64_tr_b16 a[18:19], v2 offset:5120
    ds_read_b64_tr_b16 a[20:21], v3 offset:4096
    ds_read_b64_tr_b16 a[22:23], v3 offset:5120
    ds_read_b64_tr_b16 a[24:25], v2 offset:6144
    ds_read_b64_tr_b16 a[26:27], v2 offset:7168
    ds_read_b64_tr_b16 a[28:29], v3 offset:6144
    ds_read_b64_tr_b16 a[30:31], v3 offset:7168
    s_waitcnt lgkmcnt(0)
    s_add_u32 m0, s21, 4096
    s_add_u32 s64, s65, 0xc8000
    buffer_load_dwordx4 v4, s[44:47], s64 offen lds
    s_add_u32 m0, s21, 5120
    s_add_u32 s64, s65, 0xcd000
    buffer_load_dwordx4 v4, s[44:47], s64 offen lds
    s_add_u32 m0, s21, 6144
    s_add_u32 s64, s65, 0xd2000
    buffer_load_dwordx4 v4, s[44:47], s64 offen lds
    s_add_u32 m0, s21, 7168
    s_add_u32 s64, s65, 0xd7000
    buffer_load_dwordx4 v4, s[44:47], s64 offen lds
    s_waitcnt vmcnt(32)
    ds_read_b64_tr_b16 a[32:33], v2 offset:8192
    ds_read_b64_tr_b16 a[34:35], v2 offset:9216
    ds_read_b64_tr_b16 a[36:37], v3 offset:8192
    ds_read_b64_tr_b16 a[38:39], v3 offset:9216
    ds_read_b64_tr_b16 a[40:41], v2 offset:10240
    ds_read_b64_tr_b16 a[42:43], v2 offset:11264
    ds_read_b64_tr_b16 a[44:45], v3 offset:10240
    ds_read_b64_tr_b16 a[46:47], v3 offset:11264
    s_waitcnt lgkmcnt(0)
    s_add_u32 m0, s21, 8192
    s_add_u32 s64, s65, 0xdc000
    buffer_load_dwordx4 v4, s[44:47], s64 offen lds
    s_add_u32 m0, s21, 9216
    s_add_u32 s64, s65, 0xe1000
    buffer_load_dwordx4 v4, s[44:47], s64 offen lds
    s_add_u32 m0, s21, 10240
    s_add_u32 s64, s65, 0xe6000
    buffer_load_dwordx4 v4, s[44:47], s64 offen lds
    s_add_u32 m0, s21, 11264
    s_add_u32 s64, s65, 0xeb000
    buffer_load_dwordx4 v4, s[44:47], s64 offen lds
    s_waitcnt vmcnt(32)
    ds_read_b64_tr_b16 a[48:49], v2 offset:12288
    ds_read_b64_tr_b16 a[50:51], v2 offset:13312
    ds_read_b64_tr_b16 a[52:53], v3 offset:12288
    ds_read_b64_tr_b16 a[54:55], v3 offset:13312
    ds_read_b64_tr_b16 a[56:57], v2 offset:14336
    ds_read_b64_tr_b16 a[58:59], v2 offset:15360
    ds_read_b64_tr_b16 a[60:61], v3 offset:14336
    ds_read_b64_tr_b16 a[62:63], v3 offset:15360
    s_waitcnt lgkmcnt(0)
    s_add_u32 m0, s21, 12288
    s_add_u32 s64, s65, 0xf0000
    buffer_load_dwordx4 v4, s[44:47], s64 offen lds
    s_add_u32 m0, s21, 13312
    s_add_u32 s64, s65, 0xf5000
    buffer_load_dwordx4 v4, s[44:47], s64 offen lds
    s_add_u32 m0, s21, 14336
    s_add_u32 s64, s65, 0xfa000
    buffer_load_dwordx4 v4, s[44:47], s64 offen lds
    s_add_u32 m0, s21, 15360
    s_add_u32 s64, s65, 0xff000
    buffer_load_dwordx4 v4, s[44:47], s64 offen lds
    s_waitcnt vmcnt(32)
    ds_read_b64_tr_b16 a[64:65], v2 offset:16384
    ds_read_b64_tr_b16 a[66:67], v2 offset:17408
    ds_read_b64_tr_b16 a[68:69], v3 offset:16384
    ds_read_b64_tr_b16 a[70:71], v3 offset:17408
    ds_read_b64_tr_b16 a[72:73], v2 offset:18432
    ds_read_b64_tr_b16 a[74:75], v2 offset:19456
    ds_read_b64_tr_b16 a[76:77], v3 offset:18432
    ds_read_b64_tr_b16 a[78:79], v3 offset:19456
    s_waitcnt lgkmcnt(0)
    s_add_u32 m0, s21, 16384
    s_add_u32 s64, s65, 0x104000
    buffer_load_dwordx4 v4, s[44:47], s64 offen lds
    s_add_u32 m0, s21, 17408
    s_add_u32 s64, s65, 0x109000
    buffer_load_dwordx4 v4, s[44:47], s64 offen lds
    s_add_u32 m0, s21, 18432
    s_add_u32 s64, s65, 0x10e000
    buffer_load_dwordx4 v4, s[44:47], s64 offen lds
    s_add_u32 m0, s21, 19456
    s_add_u32 s64, s65, 0x113000
    buffer_load_dwordx4 v4, s[44:47], s64 offen lds
    s_waitcnt vmcnt(32)
    ds_read_b64_tr_b16 a[80:81], v2 offset:20480
    ds_read_b64_tr_b16 a[82:83], v2 offset:21504
    ds_read_b64_tr_b16 a[84:85], v3 offset:20480
    ds_read_b64_tr_b16 a[86:87], v3 offset:21504
    ds_read_b64_tr_b16 a[88:89], v2 offset:22528
    ds_read_b64_tr_b16 a[90:91], v2 offset:23552
    ds_read_b64_tr_b16 a[92:93], v3 offset:22528
    ds_read_b64_tr_b16 a[94:95], v3 offset:23552
    s_waitcnt lgkmcnt(0)
    s_add_u32 m0, s21, 20480
    s_add_u32 s64, s65, 0x118000
    buffer_load_dwordx4 v4, s[44:47], s64 offen lds
    s_add_u32 m0, s21, 21504
    s_add_u32 s64, s65, 0x11d000
    buffer_load_dwordx4 v4, s[44:47], s64 offen lds
    s_add_u32 m0, s21, 22528
    s_add_u32 s64, s65, 0x122000
    buffer_load_dwordx4 v4, s[44:47], s64 offen lds
    s_add_u32 m0, s21, 23552
    s_add_u32 s64, s65, 0x127000
    buffer_load_dwordx4 v4, s[44:47], s64 offen lds
    s_waitcnt vmcnt(32)
    ds_read_b64_tr_b16 a[96:97], v2 offset:24576
    ds_read_b64_tr_b16 a[98:99], v2 offset:25600
    ds_read_b64_tr_b16 a[100:101], v3 offset:24576
    ds_read_b64_tr_b16 a[102:103], v3 offset:25600
    ds_read_b64_tr_b16 a[104:105], v2 offset:26624
    ds_read_b64_tr_b16 a[106:107], v2 offset:27648
    ds_read_b64_tr_b16 a[108:109], v3 offset:26624
    ds_read_b64_tr_b16 a[110:111], v3 offset:27648
    s_waitcnt lgkmcnt(0)
    s_add_u32 m0, s21, 24576
    s_add_u32 s64, s65, 0x12c000
    buffer_load_dwordx4 v4, s[44:47], s64 offen lds
    s_add_u32 m0, s21, 25600
    s_add_u32 s64, s65, 0x131000
    buffer_load_dwordx4 v4, s[44:47], s64 offen lds
    s_add_u32 m0, s21, 26624
    s_add_u32 s64, s65, 0x136000
    buffer_load_dwordx4 v4, s[44:47], s64 offen lds
    s_add_u32 m0, s21, 27648
    s_add_u32 s64, s65, 0x13b000
    buffer_load_dwordx4 v4, s[44:47], s64 offen lds
    s_waitcnt vmcnt(32)
    ds_read_b64_tr_b16 a[112:113], v2 offset:28672
    ds_read_b64_tr_b16 a[114:115], v2 offset:29696
    ds_read_b64_tr_b16 a[116:117], v3 offset:28672
    ds_read_b64_tr_b16 a[118:119], v3 offset:29696
    ds_read_b64_tr_b16 a[120:121], v2 offset:30720
    ds_read_b64_tr_b16 a[122:123], v2 offset:31744
    ds_read_b64_tr_b16 a[124:125], v3 offset:30720
    ds_read_b64_tr_b16 a[126:127], v3 offset:31744
    s_waitcnt lgkmcnt(0)
    s_waitcnt vmcnt(28)
    ds_read_b64_tr_b16 a[128:129], v2 offset:32768
    ds_read_b64_tr_b16 a[130:131], v2 offset:33792
    ds_read_b64_tr_b16 a[132:133], v3 offset:32768
    ds_read_b64_tr_b16 a[134:135], v3 offset:33792
    ds_read_b64_tr_b16 a[136:137], v2 offset:34816
    ds_read_b64_tr_b16 a[138:139], v2 offset:35840
    ds_read_b64_tr_b16 a[140:141], v3 offset:34816
    ds_read_b64_tr_b16 a[142:143], v3 offset:35840
    s_waitcnt lgkmcnt(0)
    s_waitcnt vmcnt(24)
    ds_read_b64_tr_b16 a[144:145], v2 offset:0
    ds_read_b64_tr_b16 a[146:147], v2 offset:1024
    ds_read_b64_tr_b16 a[148:149], v3 offset:0
    ds_read_b64_tr_b16 a[150:151], v3 offset:1024
    ds_read_b64_tr_b16 a[152:153], v2 offset:2048
    ds_read_b64_tr_b16 a[154:155], v2 offset:3072
    ds_read_b64_tr_b16 a[156:157], v3 offset:2048
    ds_read_b64_tr_b16 a[158:159], v3 offset:3072
    s_waitcnt lgkmcnt(0)
    s_waitcnt vmcnt(20)
    ds_read_b64_tr_b16 a[160:161], v2 offset:4096
    ds_read_b64_tr_b16 a[162:163], v2 offset:5120
    ds_read_b64_tr_b16 a[164:165], v3 offset:4096
    ds_read_b64_tr_b16 a[166:167], v3 offset:5120
    ds_read_b64_tr_b16 a[168:169], v2 offset:6144
    ds_read_b64_tr_b16 a[170:171], v2 offset:7168
    ds_read_b64_tr_b16 a[172:173], v3 offset:6144
    ds_read_b64_tr_b16 a[174:175], v3 offset:7168
    s_waitcnt lgkmcnt(0)
    s_waitcnt vmcnt(16)
    ds_read_b64_tr_b16 a[176:177], v2 offset:8192
    ds_read_b64_tr_b16 a[178:179], v2 offset:9216
    ds_read_b64_tr_b16 a[180:181], v3 offset:8192
    ds_read_b64_tr_b16 a[182:183], v3 offset:9216
    ds_read_b64_tr_b16 a[184:185], v2 offset:10240
    ds_read_b64_tr_b16 a[186:187], v2 offset:11264
    ds_read_b64_tr_b16 a[188:189], v3 offset:10240
    ds_read_b64_tr_b16 a[190:191], v3 offset:11264
    s_waitcnt lgkmcnt(0)
    s_waitcnt vmcnt(12)
    ds_read_b64_tr_b16 a[192:193], v2 offset:12288
    ds_read_b64_tr_b16 a[194:195], v2 offset:13312
    ds_read_b64_tr_b16 a[196:197], v3 offset:12288
    ds_read_b64_tr_b16 a[198:199], v3 offset:13312
    ds_read_b64_tr_b16 a[200:201], v2 offset:14336
    ds_read_b64_tr_b16 a[202:203], v2 offset:15360
    ds_read_b64_tr_b16 a[204:205], v3 offset:14336
    ds_read_b64_tr_b16 a[206:207], v3 offset:15360
    s_waitcnt lgkmcnt(0)
    s_waitcnt vmcnt(8)
    ds_read_b64_tr_b16 a[208:209], v2 offset:16384
    ds_read_b64_tr_b16 a[210:211], v2 offset:17408
    ds_read_b64_tr_b16 a[212:213], v3 offset:16384
    ds_read_b64_tr_b16 a[214:215], v3 offset:17408
    ds_read_b64_tr_b16 a[216:217], v2 offset:18432
    ds_read_b64_tr_b16 a[218:219], v2 offset:19456
    ds_read_b64_tr_b16 a[220:221], v3 offset:18432
    ds_read_b64_tr_b16 a[222:223], v3 offset:19456
    s_waitcnt lgkmcnt(0)
    s_waitcnt vmcnt(4)
    ds_read_b64_tr_b16 a[224:225], v2 offset:20480
    ds_read_b64_tr_b16 a[226:227], v2 offset:21504
    ds_read_b64_tr_b16 a[228:229], v3 offset:20480
    ds_read_b64_tr_b16 a[230:231], v3 offset:21504
    ds_read_b64_tr_b16 a[232:233], v2 offset:22528
    ds_read_b64_tr_b16 a[234:235], v2 offset:23552
    ds_read_b64_tr_b16 a[236:237], v3 offset:22528
    ds_read_b64_tr_b16 a[238:239], v3 offset:23552
    s_waitcnt lgkmcnt(0)
    s_waitcnt vmcnt(0)
    ds_read_b64_tr_b16 a[240:241], v2 offset:24576
    ds_read_b64_tr_b16 a[242:243], v2 offset:25600
    ds_read_b64_tr_b16 a[244:245], v3 offset:24576
    ds_read_b64_tr_b16 a[246:247], v3 offset:25600
    ds_read_b64_tr_b16 a[248:249], v2 offset:26624
    ds_read_b64_tr_b16 a[250:251], v2 offset:27648
    ds_read_b64_tr_b16 a[252:253], v3 offset:26624
    ds_read_b64_tr_b16 a[254:255], v3 offset:27648
    s_waitcnt lgkmcnt(0)
    s_mov_b32 s13, s89
NOWO_128:
    v_mov_b32 v2, v10
    v_mov_b32 v3, v11
MKH_127:
    s_cmp_lg_u32 s24, 31
    s_mov_b64 exec, 0xf
    s_cbranch_scc1 MKL_129
    s_mov_b64 exec, -1
    v_bfe_u32 v4, v0, 3, 1
    v_mul_u32_u24 v4, 0x8000, v4
    v_sub_u32 v2, v2, v4
    s_mov_b64 exec, 3
MKL_129:
MKT_M_130:
    buffer_load_dword v5, v6, s[4:7], s28 offen sc1
    s_add_u32 s29, s29, 1
    s_waitcnt vmcnt(0)
    v_cmp_eq_u32 vcc, 0, v5
    s_cbranch_vccz MKT_MD_131
    s_cmp_gt_u32 s29, 262144
    s_cbranch_scc1 MKT_MD_131
    s_sleep 1
    s_branch MKT_M_130
MKT_MD_131:
    s_mov_b64 exec, -1
MKR_132:
    s_add_u32 s64, s25, 0x0
    buffer_load_dwordx4 v[16:19], v2, s[4:7], s64 offen sc1
    s_add_u32 s64, s25, 0x200
    buffer_load_dwordx4 v[20:23], v2, s[4:7], s64 offen sc1
    s_add_u32 s64, s25, 0x400
    buffer_load_dwordx4 v[24:27], v2, s[4:7], s64 offen sc1
    s_add_u32 s64, s25, 0x600
    buffer_load_dwordx4 v[28:31], v2, s[4:7], s64 offen sc1
    s_add_u32 s64, s25, 0x800
    buffer_load_dwordx4 v[32:35], v2, s[4:7], s64 offen sc1
    s_add_u32 s64, s25, 0xa00
    buffer_load_dwordx4 v[36:39], v2, s[4:7], s64 offen sc1
    s_add_u32 s64, s25, 0xc00
    buffer_load_dwordx4 v[40:43], v2, s[4:7], s64 offen sc1
    s_add_u32 s64, s25, 0xe00
    buffer_load_dwordx4 v[44:47], v2, s[4:7], s64 offen sc1
    s_add_u32 s64, s25, 0x1000
    buffer_load_dwordx4 v[48:51], v2, s[4:7], s64 offen sc1
    s_add_u32 s64, s25, 0x1200
    buffer_load_dwordx4 v[52:55], v2, s[4:7], s64 offen sc1
    s_add_u32 s64, s30, 0x0
    buffer_load_dwordx4 v[56:59], v2, s[4:7], s64 offen sc1
    s_add_u32 s64, s30, 0x200
    buffer_load_dwordx4 v[60:63], v2, s[4:7], s64 offen sc1
    s_add_u32 s64, s30, 0x400
    buffer_load_dwordx4 v[64:67], v2, s[4:7], s64 offen sc1
    s_add_u32 s64, s30, 0x600
    buffer_load_dwordx4 v[68:71], v2, s[4:7], s64 offen sc1
    s_add_u32 s64, s30, 0x800
    buffer_load_dwordx4 v[72:75], v2, s[4:7], s64 offen sc1
    s_add_u32 s64, s30, 0xa00
    buffer_load_dwordx4 v[76:79], v2, s[4:7], s64 offen sc1
    s_add_u32 s64, s30, 0xc00
    buffer_load_dwordx4 v[80:83], v2, s[4:7], s64 offen sc1
    s_add_u32 s64, s30, 0xe00
    buffer_load_dwordx4 v[84:87], v2, s[4:7], s64 offen sc1
    s_add_u32 s64, s30, 0x1000
    buffer_load_dwordx4 v[88:91], v2, s[4:7], s64 offen sc1
    s_add_u32 s64, s30, 0x1200
    buffer_load_dwordx4 v[92:95], v2, s[4:7], s64 offen sc1
    s_add_u32 s29, s29, 1
    s_waitcnt vmcnt(0)
    v_max3_u32 v4, v19, v23, v27
    v_max3_u32 v4, v4, v31, v35
    v_max3_u32 v4, v4, v39, v43
    v_max3_u32 v4, v4, v47, v51
    v_max3_u32 v4, v4, v55, v59
    v_max3_u32 v4, v4, v63, v67
    v_max3_u32 v4, v4, v71, v75
    v_max3_u32 v4, v4, v79, v83
    v_max3_u32 v4, v4, v87, v91
    v_max_u32 v4, v4, v95
    v_cmp_eq_u32 vcc, -1, v4
    s_cbranch_vccz MKO_133
    s_cmp_gt_u32 s29, 262144
    s_cbranch_scc0 MKR_132
MKO_133:
    v_mfma_f32_16x16x32_bf16 v[8:11], v[96:99], v[16:19], 0
    v_mfma_f32_16x16x32_bf16 v[12:15], v[100:103], v[16:19], 0
    v_mfma_f32_16x16x32_bf16 v[8:11], v[104:107], v[20:23], v[8:11]
    v_mfma_f32_16x16x32_bf16 v[12:15], v[108:111], v[20:23], v[12:15]
    v_mfma_f32_16x16x32_bf16 v[8:11], v[112:115], v[24:27], v[8:11]
    v_mfma_f32_16x16x32_bf16 v[12:15], v[116:119], v[24:27], v[12:15]
    v_mfma_f32_16x16x32_bf16 v[8:11], v[120:123], v[28:31], v[8:11]
    v_mfma_f32_16x16x32_bf16 v[12:15], v[124:127], v[28:31], v[12:15]
    v_mfma_f32_16x16x32_bf16 v[8:11], v[128:131], v[32:35], v[8:11]
    v_mfma_f32_16x16x32_bf16 v[12:15], v[132:135], v[32:35], v[12:15]
    v_mfma_f32_16x16x32_bf16 v[8:11], v[136:139], v[36:39], v[8:11]
    v_mfma_f32_16x16x32_bf16 v[12:15], v[140:143], v[36:39], v[12:15]
    v_mfma_f32_16x16x32_bf16 v[8:11], v[144:147], v[40:43], v[8:11]
    v_mfma_f32_16x16x32_bf16 v[12:15], v[148:151], v[40:43], v[12:15]
    v_mfma_f32_16x16x32_bf16 v[8:11], v[152:155], v[44:47], v[8:11]
    v_mfma_f32_16x16x32_bf16 v[12:15], v[156:159], v[44:47], v[12:15]
    v_mfma_f32_16x16x32_bf16 v[8:11], v[160:163], v[48:51], v[8:11]
    v_mfma_f32_16x16x32_bf16 v[12:15], v[164:167], v[48:51], v[12:15]
    v_mfma_f32_16x16x32_bf16 v[8:11], v[168:171], v[52:55], v[8:11]
    v_mfma_f32_16x16x32_bf16 v[12:15], v[172:175], v[52:55], v[12:15]
    v_mfma_f32_16x16x32_bf16 v[8:11], v[176:179], v[56:59], v[8:11]
    v_mfma_f32_16x16x32_bf16 v[12:15], v[180:183], v[56:59], v[12:15]
    v_mfma_f32_16x16x32_bf16 v[8:11], v[184:187], v[60:63], v[8:11]
    v_mfma_f32_16x16x32_bf16 v[12:15], v[188:191], v[60:63], v[12:15]
    v_mfma_f32_16x16x32_bf16 v[8:11], v[192:195], v[64:67], v[8:11]
    v_mfma_f32_16x16x32_bf16 v[12:15], v[196:199], v[64:67], v[12:15]
    v_mfma_f32_16x16x32_bf16 v[8:11], v[200:203], v[68:71], v[8:11]
    v_mfma_f32_16x16x32_bf16 v[12:15], v[204:207], v[68:71], v[12:15]
    v_mfma_f32_16x16x32_bf16 v[8:11], v[208:211], v[72:75], v[8:11]
    v_mfma_f32_16x16x32_bf16 v[12:15], v[212:215], v[72:75], v[12:15]
    v_mfma_f32_16x16x32_bf16 v[8:11], v[216:219], v[76:79], v[8:11]
    v_mfma_f32_16x16x32_bf16 v[12:15], v[220:223], v[76:79], v[12:15]
    v_mfma_f32_16x16x32_bf16 v[8:11], v[224:227], v[80:83], v[8:11]
    v_mfma_f32_16x16x32_bf16 v[12:15], v[228:231], v[80:83], v[12:15]
    v_mfma_f32_16x16x32_bf16 v[8:11], v[232:235], v[84:87], v[8:11]
    v_mfma_f32_16x16x32_bf16 v[12:15], v[236:239], v[84:87], v[12:15]
    v_mfma_f32_16x16x32_bf16 v[8:11], v[240:243], v[88:91], v[8:11]
    v_mfma_f32_16x16x32_bf16 v[12:15], v[244:247], v[88:91], v[12:15]
    v_mfma_f32_16x16x32_bf16 v[8:11], v[248:251], v[92:95], v[8:11]
    v_mfma_f32_16x16x32_bf16 v[12:15], v[252:255], v[92:95], v[12:15]
    s_nop 7
    v_cvt_pk_bf16_f32 v16, v8, v9
    v_cvt_pk_bf16_f32 v17, v10, v11
    v_cvt_pk_bf16_f32 v18, v12, v13
    v_cvt_pk_bf16_f32 v19, v14, v15
    buffer_store_dwordx4 v[16:19], v3, s[4:7], s26 offen sc1
    s_waitcnt vmcnt(0)
    s_barrier
    s_cmp_lg_u32 s14, 0
    s_cbranch_scc1 GF_134
    v_mov_b32 v7, 1
    v_mov_b32 v8, 0
    s_mov_b64 exec, 1
    buffer_store_dword v7, v8, s[4:7], s27 offen sc1
    s_mov_b64 exec, -1
GF_134:
    s_add_u32 s25, s25, 0x10000
    s_add_u32 s30, s30, 0x10000
    s_add_u32 s26, s26, 0x20000
    s_add_u32 s27, s27, 256
    s_add_u32 s28, s28, 512
    s_add_u32 s24, s24, 1
    s_cmp_lt_u32 s24, 32
    s_cbranch_scc1 MKT_LOOP
    s_cmp_ge_u32 s88, 60
    s_cbranch_scc1 M_EXIT
    s_branch H_EXTRA
G_N:
    v_lshrrev_b32 v6, 5, v0
    v_mul_u32_u24 v7, 40960, v6
    v_bfe_u32 v6, v0, 4, 1
    v_lshl_add_u32 v7, v6, 11, v7
    v_lshlrev_b32 v8, 3, v6
    v_bfe_u32 v6, v0, 2, 2
    v_lshl_add_u32 v7, v6, 8, v7
    v_lshl_add_u32 v8, v6, 1, v8
    v_and_b32 v6, 1, v0
    v_lshl_add_u32 v7, v6, 3, v7
    v_bfe_u32 v6, v0, 1, 1
    s_lshl_b32 s64, s14, 2
    v_add_u32 v10, s64, v6
    v_add_u32 v6, 0, v10
    v_xor_b32 v6, v6, v8
    v_lshl_add_u32 v3, v6, 4, v7
    v_add_u32 v4, 81920, v3
    v_add_u32 v6, 2, v10
    v_xor_b32 v6, v6, v8
    v_lshl_add_u32 v5, v6, 4, v7
    v_add_u32 v9, 81920, v5
    s_waitcnt vmcnt(0)
    s_barrier
    ds_read_b64_tr_b16 v[96:97], v3 offset:0
    ds_read_b64_tr_b16 v[98:99], v3 offset:1024
    ds_read_b64_tr_b16 v[100:101], v5 offset:0
    ds_read_b64_tr_b16 v[102:103], v5 offset:1024
    ds_read_b64_tr_b16 v[104:105], v4 offset:0
    ds_read_b64_tr_b16 v[106:107], v4 offset:1024
    ds_read_b64_tr_b16 v[108:109], v9 offset:0
    ds_read_b64_tr_b16 v[110:111], v9 offset:1024
    ds_read_b64_tr_b16 v[112:113], v3 offset:4096
    ds_read_b64_tr_b16 v[114:115], v3 offset:5120
    ds_read_b64_tr_b16 v[116:117], v5 offset:4096
    ds_read_b64_tr_b16 v[118:119], v5 offset:5120
    ds_read_b64_tr_b16 v[120:121], v4 offset:4096
    ds_read_b64_tr_b16 v[122:123], v4 offset:5120
    ds_read_b64_tr_b16 v[124:125], v9 offset:4096
    ds_read_b64_tr_b16 v[126:127], v9 offset:5120
    s_waitcnt lgkmcnt(4)
    ds_read_b64_tr_b16 v[128:129], v3 offset:8192
    ds_read_b64_tr_b16 v[130:131], v3 offset:9216
    ds_read_b64_tr_b16 v[132:133], v5 offset:8192
    ds_read_b64_tr_b16 v[134:135], v5 offset:9216
    ds_read_b64_tr_b16 v[136:137], v4 offset:8192
    ds_read_b64_tr_b16 v[138:139], v4 offset:9216
    ds_read_b64_tr_b16 v[140:141], v9 offset:8192
    ds_read_b64_tr_b16 v[142:143], v9 offset:9216
    ds_read_b64_tr_b16 v[144:145], v3 offset:12288
    ds_read_b64_tr_b16 v[146:147], v3 offset:13312
    ds_read_b64_tr_b16 v[148:149], v5 offset:12288
    ds_read_b64_tr_b16 v[150:151], v5 offset:13312
    ds_read_b64_tr_b16 v[152:153], v4 offset:12288
    ds_read_b64_tr_b16 v[154:155], v4 offset:13312
    ds_read_b64_tr_b16 v[156:157], v9 offset:12288
    ds_read_b64_tr_b16 v[158:159], v9 offset:13312
    s_waitcnt lgkmcnt(4)
    ds_read_b64_tr_b16 v[160:161], v3 offset:16384
    ds_read_b64_tr_b16 v[162:163], v3 offset:17408
    ds_read_b64_tr_b16 v[164:165], v5 offset:16384
    ds_read_b64_tr_b16 v[166:167], v5 offset:17408
    ds_read_b64_tr_b16 v[168:169], v4 offset:16384
    ds_read_b64_tr_b16 v[170:171], v4 offset:17408
    ds_read_b64_tr_b16 v[172:173], v9 offset:16384
    ds_read_b64_tr_b16 v[174:175], v9 offset:17408
    ds_read_b64_tr_b16 v[176:177], v3 offset:20480
    ds_read_b64_tr_b16 v[178:179], v3 offset:21504
    ds_read_b64_tr_b16 v[180:181], v5 offset:20480
    ds_read_b64_tr_b16 v[182:183], v5 offset:21504
    ds_read_b64_tr_b16 v[184:185], v4 offset:20480
    ds_read_b64_tr_b16 v[186:187], v4 offset:21504
    ds_read_b64_tr_b16 v[188:189], v9 offset:20480
    ds_read_b64_tr_b16 v[190:191], v9 offset:21504
    s_waitcnt lgkmcnt(4)
    ds_read_b64_tr_b16 v[192:193], v3 offset:24576
    ds_read_b64_tr_b16 v[194:195], v3 offset:25600
    ds_read_b64_tr_b16 v[196:197], v5 offset:24576
    ds_read_b64_tr_b16 v[198:199], v5 offset:25600
    ds_read_b64_tr_b16 v[200:201], v4 offset:24576
    ds_read_b64_tr_b16 v[202:203], v4 offset:25600
    ds_read_b64_tr_b16 v[204:205], v9 offset:24576
    ds_read_b64_tr_b16 v[206:207], v9 offset:25600
    ds_read_b64_tr_b16 v[208:209], v3 offset:28672
    ds_read_b64_tr_b16 v[210:211], v3 offset:29696
    ds_read_b64_tr_b16 v[212:213], v5 offset:28672
    ds_read_b64_tr_b16 v[214:215], v5 offset:29696
    ds_read_b64_tr_b16 v[216:217], v4 offset:28672
    ds_read_b64_tr_b16 v[218:219], v4 offset:29696
    ds_read_b64_tr_b16 v[220:221], v9 offset:28672
    ds_read_b64_tr_b16 v[222:223], v9 offset:29696
    s_waitcnt lgkmcnt(4)
    ds_read_b64_tr_b16 v[224:225], v3 offset:32768
    ds_read_b64_tr_b16 v[226:227], v3 offset:33792
    ds_read_b64_tr_b16 v[228:229], v5 offset:32768
    ds_read_b64_tr_b16 v[230:231], v5 offset:33792
    ds_read_b64_tr_b16 v[232:233], v4 offset:32768
    ds_read_b64_tr_b16 v[234:235], v4 offset:33792
    ds_read_b64_tr_b16 v[236:237], v9 offset:32768
    ds_read_b64_tr_b16 v[238:239], v9 offset:33792
    ds_read_b64_tr_b16 v[240:241], v3 offset:36864
    ds_read_b64_tr_b16 v[242:243], v3 offset:37888
    ds_read_b64_tr_b16 v[244:245], v5 offset:36864
    ds_read_b64_tr_b16 v[246:247], v5 offset:37888
    ds_read_b64_tr_b16 v[248:249], v4 offset:36864
    ds_read_b64_tr_b16 v[250:251], v4 offset:37888
    ds_read_b64_tr_b16 v[252:253], v9 offset:36864
    ds_read_b64_tr_b16 v[254:255], v9 offset:37888
    s_waitcnt lgkmcnt(0)
    s_cmp_lg_u32 s97, 0
    s_cbranch_scc1 CM_135
    v_mbcnt_lo_u32_b32 v0, -1, 0
    v_mbcnt_hi_u32_b32 v0, -1, v0
    v_mul_u32_u24 v8, 32, v0
    s_mov_b32 s64, 0x0
    s_mov_b32 s65, 0
    s_mov_b64 exec, 0xff
TK_136:
    buffer_load_dword v9, v8, s[60:63], s64 offen sc1
    s_add_u32 s65, s65, 1
    s_waitcnt vmcnt(0)
    s_mov_b32 s66, 0
    v_readlane_b32 s67, v9, 0
    s_add_u32 s66, s66, s67
    v_readlane_b32 s67, v9, 1
    s_add_u32 s66, s66, s67
    v_readlane_b32 s67, v9, 2
    s_add_u32 s66, s66, s67
    v_readlane_b32 s67, v9, 3
    s_add_u32 s66, s66, s67
    v_readlane_b32 s67, v9, 4
    s_add_u32 s66, s66, s67
    v_readlane_b32 s67, v9, 5
    s_add_u32 s66, s66, s67
    v_readlane_b32 s67, v9, 6
    s_add_u32 s66, s66, s67
    v_readlane_b32 s67, v9, 7
    s_add_u32 s66, s66, s67
    s_cmp_ge_u32 s66, 256
    s_cbranch_scc1 TKD_137
    s_cmp_gt_u32 s65, 262144
    s_cbranch_scc0 TK_136
TKD_137:
    v_cmp_ne_u32 vcc, 32, v9
    s_mov_b64 exec, -1
    s_cbranch_vccnz M_SLOW
CM_135:
    s_mov_b32 s65, 0
GI_138:
    buffer_load_dword v8, off, s[60:63], s95 sc1
    s_add_u32 s65, s65, 1
    s_waitcnt vmcnt(0)
    v_readfirstlane_b32 s64, v8
    s_cmp_ge_u32 s64, 186
    s_cbranch_scc1 GID_139
    s_cmp_gt_u32 s65, 65536
    s_cbranch_scc1 GID_139
    s_sleep 4
    s_branch GI_138
GID_139:
    v_mbcnt_lo_u32_b32 v0, -1, 0
    v_mbcnt_hi_u32_b32 v0, -1, v0
    s_mov_b32 s65, 0
CW_140:
    buffer_load_dwordx2 v[8:9], off, s[60:63], 0 offset:132 sc1
    s_add_u32 s65, s65, 1
    s_waitcnt vmcnt(0)
    v_readfirstlane_b32 s30, v8
    v_readfirstlane_b32 s31, v9
    s_min_u32 s64, s30, s31
    s_cmp_lg_u32 s64, 0
    s_cbranch_scc1 CWD_141
    s_cmp_gt_u32 s65, 65536
    s_cbranch_scc1 CWD_141
    s_sleep 4
    s_branch CW_140
CWD_141:
    s_sub_u32 s30, s30, 1
    s_and_b32 s30, s30, 3
    s_sub_u32 s31, s31, 1
    s_and_b32 s31, s31, 3
    s_lshl_b32 s34, s96, 2
    s_add_u32 s34, s34, s14
    s_lshl_b32 s34, s34, 6
    v_add_u32 v5, s34, v0
    v_lshlrev_b32 v3, 4, v0
    v_mov_b32 v40, -1
    v_mov_b32 v41, -1
    v_mov_b32 v42, -1
    v_mov_b32 v43, -1
    v_lshrrev_b32 v7, 6, v5
    v_mul_u32_u24 v7, 52429, v7
    v_lshrrev_b32 v7, 18, v7
    v_mul_u32_u24 v8, 320, v7
    v_sub_u32 v8, v5, v8
    v_lshlrev_b32 v48, 4, v8
    s_lshl_b32 s30, s30, 13
    s_lshl_b32 s31, s31, 13
    s_add_u32 s31, s31, 0x200000
    v_and_b32 v8, 1, v7
    v_cmp_eq_u32 vcc, 1, v8
    v_mov_b32 v8, s30
    v_mov_b32 v9, s31
    v_cndmask_b32 v8, v8, v9, vcc
    v_lshrrev_b32 v9, 1, v7
    v_lshl_add_u32 v8, v9, 15, v8
    v_add_u32 v49, v8, v48
    v_cmp_le_u32 vcc, 640, v5
    v_mov_b32 v9, 0x40000000
    s_nop 0
    v_cndmask_b32 v49, v9, v49, vcc
    v_cmp_gt_u32 vcc, 0xa000, v5
    s_nop 0
    s_and_saveexec_b64 s[38:39], vcc
    s_cbranch_execz INF_142
    s_mov_b32 s35, 0x6000000
    buffer_store_dwordx4 v[40:43], v49, s[4:7], s35 offen sc1
INF_142:
    s_mov_b64 exec, s[38:39]
    s_cmp_ge_u32 s96, 10
    s_cbranch_scc1 INM2_143
    s_cmp_lg_u32 s14, 1
    s_cbranch_scc1 INM2_143
    s_cmp_ge_u32 s96, 5
    s_cselect_b32 s36, 1, 0
    s_mul_i32 s34, s36, 5
    s_sub_u32 s34, s96, s34
    s_lshl_b32 s34, s34, 10
    s_cmp_eq_u32 s36, 0
    s_cselect_b32 s37, s30, s31
    s_add_u32 s37, s37, 0x6000000
    s_add_u32 s37, s37, s34
    buffer_store_dwordx4 v[34:37], v3, s[4:7], s37 offen sc1
INM2_143:
    v_lshlrev_b32 v1, 4, v0
    v_lshrrev_b32 v6, 3, v0
    v_mul_u32_u24 v2, 1280, v6
    v_and_b32 v7, 7, v0
    v_xor_b32 v7, v7, v6
    v_lshl_add_u32 v2, v7, 4, v2
    v_bfe_u32 v6, v0, 3, 1
    v_lshlrev_b32 v9, 10, v6
    v_and_b32 v6, 7, v0
    v_lshl_add_u32 v9, v6, 7, v9
    v_lshrrev_b32 v7, 4, v0
    v_xor_b32 v7, v7, v6
    v_lshl_add_u32 v3, v7, 4, v9
    v_xor_b32 v7, 4, v7
    v_lshl_add_u32 v4, v7, 4, v9
    v_add_u32 v6, 0x10000, v3
    v_add_u32 v9, 0x10000, v4
    s_barrier
    s_mul_i32 s20, s12, 163840
    s_mul_i32 s64, s14, 40960
    s_add_u32 s20, s20, s64
    s_add_u32 s20, s20, 0x0
    s_lshl_b32 s21, s14, 12
    s_add_u32 m0, s21, 0
    s_add_u32 s64, s20, 0x0
    buffer_load_dwordx4 v2, s[4:7], s64 offen lds
    s_add_u32 m0, s21, 1024
    s_add_u32 s64, s20, 0x2800
    buffer_load_dwordx4 v2, s[4:7], s64 offen lds
    s_add_u32 m0, s21, 2048
    s_add_u32 s64, s20, 0x5000
    buffer_load_dwordx4 v2, s[4:7], s64 offen lds
    s_add_u32 m0, s21, 3072
    s_add_u32 s64, s20, 0x7800
    buffer_load_dwordx4 v2, s[4:7], s64 offen lds
    s_add_u32 m0, s21, 16384
    s_add_u32 s64, s20, 0x80
    buffer_load_dwordx4 v2, s[4:7], s64 offen lds
    s_add_u32 m0, s21, 17408
    s_add_u32 s64, s20, 0x2880
    buffer_load_dwordx4 v2, s[4:7], s64 offen lds
    s_add_u32 m0, s21, 18432
    s_add_u32 s64, s20, 0x5080
    buffer_load_dwordx4 v2, s[4:7], s64 offen lds
    s_add_u32 m0, s21, 19456
    s_add_u32 s64, s20, 0x7880
    buffer_load_dwordx4 v2, s[4:7], s64 offen lds
    s_add_u32 m0, s21, 32768
    s_add_u32 s64, s20, 0x100
    buffer_load_dwordx4 v2, s[4:7], s64 offen lds
    s_add_u32 m0, s21, 33792
    s_add_u32 s64, s20, 0x2900
    buffer_load_dwordx4 v2, s[4:7], s64 offen lds
    s_add_u32 m0, s21, 34816
    s_add_u32 s64, s20, 0x5100
    buffer_load_dwordx4 v2, s[4:7], s64 offen lds
    s_add_u32 m0, s21, 35840
    s_add_u32 s64, s20, 0x7900
    buffer_load_dwordx4 v2, s[4:7], s64 offen lds
    s_add_u32 m0, s21, 49152
    s_add_u32 s64, s20, 0x180
    buffer_load_dwordx4 v2, s[4:7], s64 offen lds
    s_add_u32 m0, s21, 50176
    s_add_u32 s64, s20, 0x2980
    buffer_load_dwordx4 v2, s[4:7], s64 offen lds
    s_add_u32 m0, s21, 51200
    s_add_u32 s64, s20, 0x5180
    buffer_load_dwordx4 v2, s[4:7], s64 offen lds
    s_add_u32 m0, s21, 52224
    s_add_u32 s64, s20, 0x7980
    buffer_load_dwordx4 v2, s[4:7], s64 offen lds
    s_mov_b32 s64, 0x40000000
    buffer_store_dword v7, v1, s[4:7], s64 offen
    buffer_store_dword v7, v1, s[4:7], s64 offen
    buffer_store_dword v7, v1, s[4:7], s64 offen
    buffer_store_dword v7, v1, s[4:7], s64 offen
    buffer_store_dword v7, v1, s[4:7], s64 offen
    buffer_store_dword v7, v1, s[4:7], s64 offen
    buffer_store_dword v7, v1, s[4:7], s64 offen
    buffer_store_dword v7, v1, s[4:7], s64 offen
    s_waitcnt vmcnt(20)
    s_barrier
    ds_read_b128 a[0:3], v3 offset:0
    ds_read_b128 a[4:7], v3 offset:2048
    ds_read_b128 a[8:11], v3 offset:4096
    ds_read_b128 a[12:15], v3 offset:6144
    ds_read_b128 a[16:19], v3 offset:8192
    ds_read_b128 a[20:23], v3 offset:10240
    ds_read_b128 a[24:27], v3 offset:12288
    ds_read_b128 a[28:31], v3 offset:14336
    s_mov_b32 s19, 0
    s_mov_b32 s22, s16
    s_mov_b32 s23, 0x40000000
G_N_LOOP:
    s_waitcnt lgkmcnt(4)
    v_mfma_f32_16x16x32_bf16 v[16:19], a[0:3], v[96:99], 0
    v_mfma_f32_16x16x32_bf16 v[20:23], a[0:3], v[100:103], 0
    ds_read_b128 a[32:35], v4 offset:0
    v_mfma_f32_16x16x32_bf16 v[24:27], a[4:7], v[96:99], 0
    v_mfma_f32_16x16x32_bf16 v[28:31], a[4:7], v[100:103], 0
    ds_read_b128 a[36:39], v4 offset:2048
    v_mfma_f32_16x16x32_bf16 v[32:35], a[8:11], v[96:99], 0
    v_mfma_f32_16x16x32_bf16 v[36:39], a[8:11], v[100:103], 0
    ds_read_b128 a[40:43], v4 offset:4096
    v_mfma_f32_16x16x32_bf16 v[40:43], a[12:15], v[96:99], 0
    v_mfma_f32_16x16x32_bf16 v[44:47], a[12:15], v[100:103], 0
    ds_read_b128 a[44:47], v4 offset:6144
    s_waitcnt lgkmcnt(4)
    v_mfma_f32_16x16x32_bf16 v[48:51], a[16:19], v[96:99], 0
    v_mfma_f32_16x16x32_bf16 v[52:55], a[16:19], v[100:103], 0
    ds_read_b128 a[48:51], v4 offset:8192
    v_mfma_f32_16x16x32_bf16 v[56:59], a[20:23], v[96:99], 0
    v_mfma_f32_16x16x32_bf16 v[60:63], a[20:23], v[100:103], 0
    ds_read_b128 a[52:55], v4 offset:10240
    v_mfma_f32_16x16x32_bf16 v[64:67], a[24:27], v[96:99], 0
    v_mfma_f32_16x16x32_bf16 v[68:71], a[24:27], v[100:103], 0
    ds_read_b128 a[56:59], v4 offset:12288
    v_mfma_f32_16x16x32_bf16 v[72:75], a[28:31], v[96:99], 0
    v_mfma_f32_16x16x32_bf16 v[76:79], a[28:31], v[100:103], 0
    ds_read_b128 a[60:63], v4 offset:14336
    s_waitcnt vmcnt(16)
    s_barrier
    s_waitcnt lgkmcnt(4)
    v_mfma_f32_16x16x32_bf16 v[16:19], a[32:35], v[104:107], v[16:19]
    v_mfma_f32_16x16x32_bf16 v[20:23], a[32:35], v[108:111], v[20:23]
    ds_read_b128 a[0:3], v3 offset:16384
    s_add_u32 m0, s21, 65536
    v_mfma_f32_16x16x32_bf16 v[24:27], a[36:39], v[104:107], v[24:27]
    v_mfma_f32_16x16x32_bf16 v[28:31], a[36:39], v[108:111], v[28:31]
    ds_read_b128 a[4:7], v3 offset:18432
    s_add_u32 s64, s20, 0x200
    buffer_load_dwordx4 v2, s[4:7], s64 offen lds
    v_mfma_f32_16x16x32_bf16 v[32:35], a[40:43], v[104:107], v[32:35]
    v_mfma_f32_16x16x32_bf16 v[36:39], a[40:43], v[108:111], v[36:39]
    ds_read_b128 a[8:11], v3 offset:20480
    s_add_u32 m0, s21, 66560
    v_mfma_f32_16x16x32_bf16 v[40:43], a[44:47], v[104:107], v[40:43]
    v_mfma_f32_16x16x32_bf16 v[44:47], a[44:47], v[108:111], v[44:47]
    ds_read_b128 a[12:15], v3 offset:22528
    s_add_u32 s64, s20, 0x2a00
    buffer_load_dwordx4 v2, s[4:7], s64 offen lds
    s_waitcnt lgkmcnt(4)
    v_mfma_f32_16x16x32_bf16 v[48:51], a[48:51], v[104:107], v[48:51]
    v_mfma_f32_16x16x32_bf16 v[52:55], a[48:51], v[108:111], v[52:55]
    ds_read_b128 a[16:19], v3 offset:24576
    s_add_u32 m0, s21, 67584
    v_mfma_f32_16x16x32_bf16 v[56:59], a[52:55], v[104:107], v[56:59]
    v_mfma_f32_16x16x32_bf16 v[60:63], a[52:55], v[108:111], v[60:63]
    ds_read_b128 a[20:23], v3 offset:26624
    s_add_u32 s64, s20, 0x5200
    buffer_load_dwordx4 v2, s[4:7], s64 offen lds
    v_mfma_f32_16x16x32_bf16 v[64:67], a[56:59], v[104:107], v[64:67]
    v_mfma_f32_16x16x32_bf16 v[68:71], a[56:59], v[108:111], v[68:71]
    ds_read_b128 a[24:27], v3 offset:28672
    s_add_u32 m0, s21, 68608
    v_mfma_f32_16x16x32_bf16 v[72:75], a[60:63], v[104:107], v[72:75]
    v_mfma_f32_16x16x32_bf16 v[76:79], a[60:63], v[108:111], v[76:79]
    ds_read_b128 a[28:31], v3 offset:30720
    s_add_u32 s64, s20, 0x7a00
    buffer_load_dwordx4 v2, s[4:7], s64 offen lds
    s_waitcnt lgkmcnt(4)
    v_mfma_f32_16x16x32_bf16 v[16:19], a[0:3], v[112:115], v[16:19]
    v_mfma_f32_16x16x32_bf16 v[20:23], a[0:3], v[116:119], v[20:23]
    ds_read_b128 a[32:35], v4 offset:16384
    v_mfma_f32_16x16x32_bf16 v[24:27], a[4:7], v[112:115], v[24:27]
    v_mfma_f32_16x16x32_bf16 v[28:31], a[4:7], v[116:119], v[28:31]
    ds_read_b128 a[36:39], v4 offset:18432
    v_mfma_f32_16x16x32_bf16 v[32:35], a[8:11], v[112:115], v[32:35]
    v_mfma_f32_16x16x32_bf16 v[36:39], a[8:11], v[116:119], v[36:39]
    ds_read_b128 a[40:43], v4 offset:20480
    v_mfma_f32_16x16x32_bf16 v[40:43], a[12:15], v[112:115], v[40:43]
    v_mfma_f32_16x16x32_bf16 v[44:47], a[12:15], v[116:119], v[44:47]
    ds_read_b128 a[44:47], v4 offset:22528
    s_waitcnt lgkmcnt(4)
    v_mfma_f32_16x16x32_bf16 v[48:51], a[16:19], v[112:115], v[48:51]
    v_mfma_f32_16x16x32_bf16 v[52:55], a[16:19], v[116:119], v[52:55]
    ds_read_b128 a[48:51], v4 offset:24576
    v_mfma_f32_16x16x32_bf16 v[56:59], a[20:23], v[112:115], v[56:59]
    v_mfma_f32_16x16x32_bf16 v[60:63], a[20:23], v[116:119], v[60:63]
    ds_read_b128 a[52:55], v4 offset:26624
    v_mfma_f32_16x16x32_bf16 v[64:67], a[24:27], v[112:115], v[64:67]
    v_mfma_f32_16x16x32_bf16 v[68:71], a[24:27], v[116:119], v[68:71]
    ds_read_b128 a[56:59], v4 offset:28672
    v_mfma_f32_16x16x32_bf16 v[72:75], a[28:31], v[112:115], v[72:75]
    v_mfma_f32_16x16x32_bf16 v[76:79], a[28:31], v[116:119], v[76:79]
    ds_read_b128 a[60:63], v4 offset:30720
    s_waitcnt vmcnt(16)
    s_barrier
    s_cmp_lg_u32 s19, 0
    s_cbranch_scc1 GFD_144
    s_cmp_lg_u32 s14, 0
    s_cbranch_scc1 INE_145
    s_cmp_lg_u32 s96, 10
    s_cbranch_scc1 ING_146
    v_mov_b32 v7, 1
    v_lshlrev_b32 v8, 7, v0
    s_mov_b32 s65, 0x29a000
    s_mov_b64 exec, 3
    buffer_store_dword v7, v8, s[4:7], s65 offen sc1
    s_mov_b64 exec, -1
    s_waitcnt vmcnt(0)
ING_146:
    v_mov_b32 v8, 1
    s_mov_b32 s65, 0x290800
    s_mov_b64 exec, 1
    buffer_atomic_add v8, off, s[4:7], s65 sc1
    s_mov_b64 exec, -1
INE_145:
GFD_144:
    s_waitcnt lgkmcnt(4)
    v_mfma_f32_16x16x32_bf16 v[16:19], a[32:35], v[120:123], v[16:19]
    v_mfma_f32_16x16x32_bf16 v[20:23], a[32:35], v[124:127], v[20:23]
    ds_read_b128 a[0:3], v3 offset:32768
    s_add_u32 m0, s21, 0
    v_mfma_f32_16x16x32_bf16 v[24:27], a[36:39], v[120:123], v[24:27]
    v_mfma_f32_16x16x32_bf16 v[28:31], a[36:39], v[124:127], v[28:31]
    ds_read_b128 a[4:7], v3 offset:34816
    s_add_u32 s64, s20, 0x280
    buffer_load_dwordx4 v2, s[4:7], s64 offen lds
    v_mfma_f32_16x16x32_bf16 v[32:35], a[40:43], v[120:123], v[32:35]
    v_mfma_f32_16x16x32_bf16 v[36:39], a[40:43], v[124:127], v[36:39]
    ds_read_b128 a[8:11], v3 offset:36864
    s_add_u32 m0, s21, 1024
    v_mfma_f32_16x16x32_bf16 v[40:43], a[44:47], v[120:123], v[40:43]
    v_mfma_f32_16x16x32_bf16 v[44:47], a[44:47], v[124:127], v[44:47]
    ds_read_b128 a[12:15], v3 offset:38912
    s_add_u32 s64, s20, 0x2a80
    buffer_load_dwordx4 v2, s[4:7], s64 offen lds
    s_waitcnt lgkmcnt(4)
    v_mfma_f32_16x16x32_bf16 v[48:51], a[48:51], v[120:123], v[48:51]
    v_mfma_f32_16x16x32_bf16 v[52:55], a[48:51], v[124:127], v[52:55]
    ds_read_b128 a[16:19], v3 offset:40960
    s_add_u32 m0, s21, 2048
    v_mfma_f32_16x16x32_bf16 v[56:59], a[52:55], v[120:123], v[56:59]
    v_mfma_f32_16x16x32_bf16 v[60:63], a[52:55], v[124:127], v[60:63]
    ds_read_b128 a[20:23], v3 offset:43008
    s_add_u32 s64, s20, 0x5280
    buffer_load_dwordx4 v2, s[4:7], s64 offen lds
    v_mfma_f32_16x16x32_bf16 v[64:67], a[56:59], v[120:123], v[64:67]
    v_mfma_f32_16x16x32_bf16 v[68:71], a[56:59], v[124:127], v[68:71]
    ds_read_b128 a[24:27], v3 offset:45056
    s_add_u32 m0, s21, 3072
    v_mfma_f32_16x16x32_bf16 v[72:75], a[60:63], v[120:123], v[72:75]
    v_mfma_f32_16x16x32_bf16 v[76:79], a[60:63], v[124:127], v[76:79]
    ds_read_b128 a[28:31], v3 offset:47104
    s_add_u32 s64, s20, 0x7a80
    buffer_load_dwordx4 v2, s[4:7], s64 offen lds
    s_waitcnt lgkmcnt(4)
    v_mfma_f32_16x16x32_bf16 v[16:19], a[0:3], v[128:131], v[16:19]
    v_mfma_f32_16x16x32_bf16 v[20:23], a[0:3], v[132:135], v[20:23]
    ds_read_b128 a[32:35], v4 offset:32768
    v_mfma_f32_16x16x32_bf16 v[24:27], a[4:7], v[128:131], v[24:27]
    v_mfma_f32_16x16x32_bf16 v[28:31], a[4:7], v[132:135], v[28:31]
    ds_read_b128 a[36:39], v4 offset:34816
    v_mfma_f32_16x16x32_bf16 v[32:35], a[8:11], v[128:131], v[32:35]
    v_mfma_f32_16x16x32_bf16 v[36:39], a[8:11], v[132:135], v[36:39]
    ds_read_b128 a[40:43], v4 offset:36864
    v_mfma_f32_16x16x32_bf16 v[40:43], a[12:15], v[128:131], v[40:43]
    v_mfma_f32_16x16x32_bf16 v[44:47], a[12:15], v[132:135], v[44:47]
    ds_read_b128 a[44:47], v4 offset:38912
    s_waitcnt lgkmcnt(4)
    v_mfma_f32_16x16x32_bf16 v[48:51], a[16:19], v[128:131], v[48:51]
    v_mfma_f32_16x16x32_bf16 v[52:55], a[16:19], v[132:135], v[52:55]
    ds_read_b128 a[48:51], v4 offset:40960
    v_mfma_f32_16x16x32_bf16 v[56:59], a[20:23], v[128:131], v[56:59]
    v_mfma_f32_16x16x32_bf16 v[60:63], a[20:23], v[132:135], v[60:63]
    ds_read_b128 a[52:55], v4 offset:43008
    v_mfma_f32_16x16x32_bf16 v[64:67], a[24:27], v[128:131], v[64:67]
    v_mfma_f32_16x16x32_bf16 v[68:71], a[24:27], v[132:135], v[68:71]
    ds_read_b128 a[56:59], v4 offset:45056
    v_mfma_f32_16x16x32_bf16 v[72:75], a[28:31], v[128:131], v[72:75]
    v_mfma_f32_16x16x32_bf16 v[76:79], a[28:31], v[132:135], v[76:79]
    ds_read_b128 a[60:63], v4 offset:47104
    s_waitcnt vmcnt(16)
    s_barrier
    s_waitcnt lgkmcnt(4)
    v_mfma_f32_16x16x32_bf16 v[16:19], a[32:35], v[136:139], v[16:19]
    v_mfma_f32_16x16x32_bf16 v[20:23], a[32:35], v[140:143], v[20:23]
    ds_read_b128 a[0:3], v3 offset:49152
    s_add_u32 m0, s21, 16384
    v_mfma_f32_16x16x32_bf16 v[24:27], a[36:39], v[136:139], v[24:27]
    v_mfma_f32_16x16x32_bf16 v[28:31], a[36:39], v[140:143], v[28:31]
    ds_read_b128 a[4:7], v3 offset:51200
    s_add_u32 s64, s20, 0x300
    buffer_load_dwordx4 v2, s[4:7], s64 offen lds
    v_mfma_f32_16x16x32_bf16 v[32:35], a[40:43], v[136:139], v[32:35]
    v_mfma_f32_16x16x32_bf16 v[36:39], a[40:43], v[140:143], v[36:39]
    ds_read_b128 a[8:11], v3 offset:53248
    s_add_u32 m0, s21, 17408
    v_mfma_f32_16x16x32_bf16 v[40:43], a[44:47], v[136:139], v[40:43]
    v_mfma_f32_16x16x32_bf16 v[44:47], a[44:47], v[140:143], v[44:47]
    ds_read_b128 a[12:15], v3 offset:55296
    s_add_u32 s64, s20, 0x2b00
    buffer_load_dwordx4 v2, s[4:7], s64 offen lds
    s_waitcnt lgkmcnt(4)
    v_mfma_f32_16x16x32_bf16 v[48:51], a[48:51], v[136:139], v[48:51]
    v_mfma_f32_16x16x32_bf16 v[52:55], a[48:51], v[140:143], v[52:55]
    ds_read_b128 a[16:19], v3 offset:57344
    s_add_u32 m0, s21, 18432
    v_mfma_f32_16x16x32_bf16 v[56:59], a[52:55], v[136:139], v[56:59]
    v_mfma_f32_16x16x32_bf16 v[60:63], a[52:55], v[140:143], v[60:63]
    ds_read_b128 a[20:23], v3 offset:59392
    s_add_u32 s64, s20, 0x5300
    buffer_load_dwordx4 v2, s[4:7], s64 offen lds
    v_mfma_f32_16x16x32_bf16 v[64:67], a[56:59], v[136:139], v[64:67]
    v_mfma_f32_16x16x32_bf16 v[68:71], a[56:59], v[140:143], v[68:71]
    ds_read_b128 a[24:27], v3 offset:61440
    s_add_u32 m0, s21, 19456
    v_mfma_f32_16x16x32_bf16 v[72:75], a[60:63], v[136:139], v[72:75]
    v_mfma_f32_16x16x32_bf16 v[76:79], a[60:63], v[140:143], v[76:79]
    ds_read_b128 a[28:31], v3 offset:63488
    s_add_u32 s64, s20, 0x7b00
    buffer_load_dwordx4 v2, s[4:7], s64 offen lds
    s_waitcnt lgkmcnt(4)
    v_mfma_f32_16x16x32_bf16 v[16:19], a[0:3], v[144:147], v[16:19]
    v_mfma_f32_16x16x32_bf16 v[20:23], a[0:3], v[148:151], v[20:23]
    ds_read_b128 a[32:35], v4 offset:49152
    v_mfma_f32_16x16x32_bf16 v[24:27], a[4:7], v[144:147], v[24:27]
    v_mfma_f32_16x16x32_bf16 v[28:31], a[4:7], v[148:151], v[28:31]
    ds_read_b128 a[36:39], v4 offset:51200
    v_mfma_f32_16x16x32_bf16 v[32:35], a[8:11], v[144:147], v[32:35]
    v_mfma_f32_16x16x32_bf16 v[36:39], a[8:11], v[148:151], v[36:39]
    ds_read_b128 a[40:43], v4 offset:53248
    v_mfma_f32_16x16x32_bf16 v[40:43], a[12:15], v[144:147], v[40:43]
    v_mfma_f32_16x16x32_bf16 v[44:47], a[12:15], v[148:151], v[44:47]
    ds_read_b128 a[44:47], v4 offset:55296
    s_waitcnt lgkmcnt(4)
    v_mfma_f32_16x16x32_bf16 v[48:51], a[16:19], v[144:147], v[48:51]
    v_mfma_f32_16x16x32_bf16 v[52:55], a[16:19], v[148:151], v[52:55]
    ds_read_b128 a[48:51], v4 offset:57344
    v_mfma_f32_16x16x32_bf16 v[56:59], a[20:23], v[144:147], v[56:59]
    v_mfma_f32_16x16x32_bf16 v[60:63], a[20:23], v[148:151], v[60:63]
    ds_read_b128 a[52:55], v4 offset:59392
    v_mfma_f32_16x16x32_bf16 v[64:67], a[24:27], v[144:147], v[64:67]
    v_mfma_f32_16x16x32_bf16 v[68:71], a[24:27], v[148:151], v[68:71]
    ds_read_b128 a[56:59], v4 offset:61440
    v_mfma_f32_16x16x32_bf16 v[72:75], a[28:31], v[144:147], v[72:75]
    v_mfma_f32_16x16x32_bf16 v[76:79], a[28:31], v[148:151], v[76:79]
    ds_read_b128 a[60:63], v4 offset:63488
    s_waitcnt vmcnt(8)
    s_barrier
    s_cmp_lg_u32 s14, 0
    s_cbranch_scc1 GF_147
    v_mov_b32 v7, 1
    v_mov_b32 v8, 0
    s_mov_b64 exec, 1
    buffer_store_dword v7, v8, s[4:7], s23 offen sc1
    s_mov_b64 exec, -1
GF_147:
    s_waitcnt lgkmcnt(4)
    v_mfma_f32_16x16x32_bf16 v[16:19], a[32:35], v[152:155], v[16:19]
    v_mfma_f32_16x16x32_bf16 v[20:23], a[32:35], v[156:159], v[20:23]
    ds_read_b128 a[0:3], v6 offset:0
    s_add_u32 m0, s21, 32768
    v_mfma_f32_16x16x32_bf16 v[24:27], a[36:39], v[152:155], v[24:27]
    v_mfma_f32_16x16x32_bf16 v[28:31], a[36:39], v[156:159], v[28:31]
    ds_read_b128 a[4:7], v6 offset:2048
    s_add_u32 s64, s20, 0x380
    buffer_load_dwordx4 v2, s[4:7], s64 offen lds
    v_mfma_f32_16x16x32_bf16 v[32:35], a[40:43], v[152:155], v[32:35]
    v_mfma_f32_16x16x32_bf16 v[36:39], a[40:43], v[156:159], v[36:39]
    ds_read_b128 a[8:11], v6 offset:4096
    s_add_u32 m0, s21, 33792
    v_mfma_f32_16x16x32_bf16 v[40:43], a[44:47], v[152:155], v[40:43]
    v_mfma_f32_16x16x32_bf16 v[44:47], a[44:47], v[156:159], v[44:47]
    ds_read_b128 a[12:15], v6 offset:6144
    s_add_u32 s64, s20, 0x2b80
    buffer_load_dwordx4 v2, s[4:7], s64 offen lds
    s_waitcnt lgkmcnt(4)
    v_mfma_f32_16x16x32_bf16 v[48:51], a[48:51], v[152:155], v[48:51]
    v_mfma_f32_16x16x32_bf16 v[52:55], a[48:51], v[156:159], v[52:55]
    ds_read_b128 a[16:19], v6 offset:8192
    s_add_u32 m0, s21, 34816
    v_mfma_f32_16x16x32_bf16 v[56:59], a[52:55], v[152:155], v[56:59]
    v_mfma_f32_16x16x32_bf16 v[60:63], a[52:55], v[156:159], v[60:63]
    ds_read_b128 a[20:23], v6 offset:10240
    s_add_u32 s64, s20, 0x5380
    buffer_load_dwordx4 v2, s[4:7], s64 offen lds
    v_mfma_f32_16x16x32_bf16 v[64:67], a[56:59], v[152:155], v[64:67]
    v_mfma_f32_16x16x32_bf16 v[68:71], a[56:59], v[156:159], v[68:71]
    ds_read_b128 a[24:27], v6 offset:12288
    s_add_u32 m0, s21, 35840
    v_mfma_f32_16x16x32_bf16 v[72:75], a[60:63], v[152:155], v[72:75]
    v_mfma_f32_16x16x32_bf16 v[76:79], a[60:63], v[156:159], v[76:79]
    ds_read_b128 a[28:31], v6 offset:14336
    s_add_u32 s64, s20, 0x7b80
    buffer_load_dwordx4 v2, s[4:7], s64 offen lds
    s_waitcnt lgkmcnt(4)
    v_mfma_f32_16x16x32_bf16 v[16:19], a[0:3], v[160:163], v[16:19]
    v_mfma_f32_16x16x32_bf16 v[20:23], a[0:3], v[164:167], v[20:23]
    ds_read_b128 a[32:35], v9 offset:0
    v_mfma_f32_16x16x32_bf16 v[24:27], a[4:7], v[160:163], v[24:27]
    v_mfma_f32_16x16x32_bf16 v[28:31], a[4:7], v[164:167], v[28:31]
    ds_read_b128 a[36:39], v9 offset:2048
    v_mfma_f32_16x16x32_bf16 v[32:35], a[8:11], v[160:163], v[32:35]
    v_mfma_f32_16x16x32_bf16 v[36:39], a[8:11], v[164:167], v[36:39]
    ds_read_b128 a[40:43], v9 offset:4096
    v_mfma_f32_16x16x32_bf16 v[40:43], a[12:15], v[160:163], v[40:43]
    v_mfma_f32_16x16x32_bf16 v[44:47], a[12:15], v[164:167], v[44:47]
    ds_read_b128 a[44:47], v9 offset:6144
    s_waitcnt lgkmcnt(4)
    v_mfma_f32_16x16x32_bf16 v[48:51], a[16:19], v[160:163], v[48:51]
    v_mfma_f32_16x16x32_bf16 v[52:55], a[16:19], v[164:167], v[52:55]
    ds_read_b128 a[48:51], v9 offset:8192
    v_mfma_f32_16x16x32_bf16 v[56:59], a[20:23], v[160:163], v[56:59]
    v_mfma_f32_16x16x32_bf16 v[60:63], a[20:23], v[164:167], v[60:63]
    ds_read_b128 a[52:55], v9 offset:10240
    v_mfma_f32_16x16x32_bf16 v[64:67], a[24:27], v[160:163], v[64:67]
    v_mfma_f32_16x16x32_bf16 v[68:71], a[24:27], v[164:167], v[68:71]
    ds_read_b128 a[56:59], v9 offset:12288
    v_mfma_f32_16x16x32_bf16 v[72:75], a[28:31], v[160:163], v[72:75]
    v_mfma_f32_16x16x32_bf16 v[76:79], a[28:31], v[164:167], v[76:79]
    ds_read_b128 a[60:63], v9 offset:14336
    s_waitcnt vmcnt(8)
    s_barrier
    s_waitcnt lgkmcnt(4)
    v_mfma_f32_16x16x32_bf16 v[16:19], a[32:35], v[168:171], v[16:19]
    v_mfma_f32_16x16x32_bf16 v[20:23], a[32:35], v[172:175], v[20:23]
    ds_read_b128 a[0:3], v3 offset:0
    s_add_u32 m0, s21, 49152
    v_mfma_f32_16x16x32_bf16 v[24:27], a[36:39], v[168:171], v[24:27]
    v_mfma_f32_16x16x32_bf16 v[28:31], a[36:39], v[172:175], v[28:31]
    ds_read_b128 a[4:7], v3 offset:2048
    s_add_u32 s64, s20, 0x400
    buffer_load_dwordx4 v2, s[4:7], s64 offen lds
    v_mfma_f32_16x16x32_bf16 v[32:35], a[40:43], v[168:171], v[32:35]
    v_mfma_f32_16x16x32_bf16 v[36:39], a[40:43], v[172:175], v[36:39]
    ds_read_b128 a[8:11], v3 offset:4096
    s_add_u32 m0, s21, 50176
    v_mfma_f32_16x16x32_bf16 v[40:43], a[44:47], v[168:171], v[40:43]
    v_mfma_f32_16x16x32_bf16 v[44:47], a[44:47], v[172:175], v[44:47]
    ds_read_b128 a[12:15], v3 offset:6144
    s_add_u32 s64, s20, 0x2c00
    buffer_load_dwordx4 v2, s[4:7], s64 offen lds
    s_waitcnt lgkmcnt(4)
    v_mfma_f32_16x16x32_bf16 v[48:51], a[48:51], v[168:171], v[48:51]
    v_mfma_f32_16x16x32_bf16 v[52:55], a[48:51], v[172:175], v[52:55]
    ds_read_b128 a[16:19], v3 offset:8192
    s_add_u32 m0, s21, 51200
    v_mfma_f32_16x16x32_bf16 v[56:59], a[52:55], v[168:171], v[56:59]
    v_mfma_f32_16x16x32_bf16 v[60:63], a[52:55], v[172:175], v[60:63]
    ds_read_b128 a[20:23], v3 offset:10240
    s_add_u32 s64, s20, 0x5400
    buffer_load_dwordx4 v2, s[4:7], s64 offen lds
    v_mfma_f32_16x16x32_bf16 v[64:67], a[56:59], v[168:171], v[64:67]
    v_mfma_f32_16x16x32_bf16 v[68:71], a[56:59], v[172:175], v[68:71]
    ds_read_b128 a[24:27], v3 offset:12288
    s_add_u32 m0, s21, 52224
    v_mfma_f32_16x16x32_bf16 v[72:75], a[60:63], v[168:171], v[72:75]
    v_mfma_f32_16x16x32_bf16 v[76:79], a[60:63], v[172:175], v[76:79]
    ds_read_b128 a[28:31], v3 offset:14336
    s_add_u32 s64, s20, 0x7c00
    buffer_load_dwordx4 v2, s[4:7], s64 offen lds
    s_waitcnt lgkmcnt(4)
    v_mfma_f32_16x16x32_bf16 v[16:19], a[0:3], v[176:179], v[16:19]
    v_mfma_f32_16x16x32_bf16 v[20:23], a[0:3], v[180:183], v[20:23]
    ds_read_b128 a[32:35], v4 offset:0
    v_mfma_f32_16x16x32_bf16 v[24:27], a[4:7], v[176:179], v[24:27]
    v_mfma_f32_16x16x32_bf16 v[28:31], a[4:7], v[180:183], v[28:31]
    ds_read_b128 a[36:39], v4 offset:2048
    v_mfma_f32_16x16x32_bf16 v[32:35], a[8:11], v[176:179], v[32:35]
    v_mfma_f32_16x16x32_bf16 v[36:39], a[8:11], v[180:183], v[36:39]
    ds_read_b128 a[40:43], v4 offset:4096
    v_mfma_f32_16x16x32_bf16 v[40:43], a[12:15], v[176:179], v[40:43]
    v_mfma_f32_16x16x32_bf16 v[44:47], a[12:15], v[180:183], v[44:47]
    ds_read_b128 a[44:47], v4 offset:6144
    s_waitcnt lgkmcnt(4)
    v_mfma_f32_16x16x32_bf16 v[48:51], a[16:19], v[176:179], v[48:51]
    v_mfma_f32_16x16x32_bf16 v[52:55], a[16:19], v[180:183], v[52:55]
    ds_read_b128 a[48:51], v4 offset:8192
    v_mfma_f32_16x16x32_bf16 v[56:59], a[20:23], v[176:179], v[56:59]
    v_mfma_f32_16x16x32_bf16 v[60:63], a[20:23], v[180:183], v[60:63]
    ds_read_b128 a[52:55], v4 offset:10240
    v_mfma_f32_16x16x32_bf16 v[64:67], a[24:27], v[176:179], v[64:67]
    v_mfma_f32_16x16x32_bf16 v[68:71], a[24:27], v[180:183], v[68:71]
    ds_read_b128 a[56:59], v4 offset:12288
    v_mfma_f32_16x16x32_bf16 v[72:75], a[28:31], v[176:179], v[72:75]
    v_mfma_f32_16x16x32_bf16 v[76:79], a[28:31], v[180:183], v[76:79]
    ds_read_b128 a[60:63], v4 offset:14336
    s_waitcnt vmcnt(8)
    s_barrier
    s_waitcnt lgkmcnt(4)
    v_mfma_f32_16x16x32_bf16 v[16:19], a[32:35], v[184:187], v[16:19]
    v_mfma_f32_16x16x32_bf16 v[20:23], a[32:35], v[188:191], v[20:23]
    ds_read_b128 a[0:3], v3 offset:16384
    s_add_u32 m0, s21, 65536
    v_mfma_f32_16x16x32_bf16 v[24:27], a[36:39], v[184:187], v[24:27]
    v_mfma_f32_16x16x32_bf16 v[28:31], a[36:39], v[188:191], v[28:31]
    ds_read_b128 a[4:7], v3 offset:18432
    s_add_u32 s64, s20, 0x480
    buffer_load_dwordx4 v2, s[4:7], s64 offen lds
    v_mfma_f32_16x16x32_bf16 v[32:35], a[40:43], v[184:187], v[32:35]
    v_mfma_f32_16x16x32_bf16 v[36:39], a[40:43], v[188:191], v[36:39]
    ds_read_b128 a[8:11], v3 offset:20480
    s_add_u32 m0, s21, 66560
    v_mfma_f32_16x16x32_bf16 v[40:43], a[44:47], v[184:187], v[40:43]
    v_mfma_f32_16x16x32_bf16 v[44:47], a[44:47], v[188:191], v[44:47]
    ds_read_b128 a[12:15], v3 offset:22528
    s_add_u32 s64, s20, 0x2c80
    buffer_load_dwordx4 v2, s[4:7], s64 offen lds
    s_waitcnt lgkmcnt(4)
    v_mfma_f32_16x16x32_bf16 v[48:51], a[48:51], v[184:187], v[48:51]
    v_mfma_f32_16x16x32_bf16 v[52:55], a[48:51], v[188:191], v[52:55]
    ds_read_b128 a[16:19], v3 offset:24576
    s_add_u32 m0, s21, 67584
    v_mfma_f32_16x16x32_bf16 v[56:59], a[52:55], v[184:187], v[56:59]
    v_mfma_f32_16x16x32_bf16 v[60:63], a[52:55], v[188:191], v[60:63]
    ds_read_b128 a[20:23], v3 offset:26624
    s_add_u32 s64, s20, 0x5480
    buffer_load_dwordx4 v2, s[4:7], s64 offen lds
    v_mfma_f32_16x16x32_bf16 v[64:67], a[56:59], v[184:187], v[64:67]
    v_mfma_f32_16x16x32_bf16 v[68:71], a[56:59], v[188:191], v[68:71]
    ds_read_b128 a[24:27], v3 offset:28672
    s_add_u32 m0, s21, 68608
    v_mfma_f32_16x16x32_bf16 v[72:75], a[60:63], v[184:187], v[72:75]
    v_mfma_f32_16x16x32_bf16 v[76:79], a[60:63], v[188:191], v[76:79]
    ds_read_b128 a[28:31], v3 offset:30720
    s_add_u32 s64, s20, 0x7c80
    buffer_load_dwordx4 v2, s[4:7], s64 offen lds
    s_waitcnt lgkmcnt(4)
    v_mfma_f32_16x16x32_bf16 v[16:19], a[0:3], v[192:195], v[16:19]
    v_mfma_f32_16x16x32_bf16 v[20:23], a[0:3], v[196:199], v[20:23]
    ds_read_b128 a[32:35], v4 offset:16384
    v_mfma_f32_16x16x32_bf16 v[24:27], a[4:7], v[192:195], v[24:27]
    v_mfma_f32_16x16x32_bf16 v[28:31], a[4:7], v[196:199], v[28:31]
    ds_read_b128 a[36:39], v4 offset:18432
    v_mfma_f32_16x16x32_bf16 v[32:35], a[8:11], v[192:195], v[32:35]
    v_mfma_f32_16x16x32_bf16 v[36:39], a[8:11], v[196:199], v[36:39]
    ds_read_b128 a[40:43], v4 offset:20480
    v_mfma_f32_16x16x32_bf16 v[40:43], a[12:15], v[192:195], v[40:43]
    v_mfma_f32_16x16x32_bf16 v[44:47], a[12:15], v[196:199], v[44:47]
    ds_read_b128 a[44:47], v4 offset:22528
    s_waitcnt lgkmcnt(4)
    v_mfma_f32_16x16x32_bf16 v[48:51], a[16:19], v[192:195], v[48:51]
    v_mfma_f32_16x16x32_bf16 v[52:55], a[16:19], v[196:199], v[52:55]
    ds_read_b128 a[48:51], v4 offset:24576
    v_mfma_f32_16x16x32_bf16 v[56:59], a[20:23], v[192:195], v[56:59]
    v_mfma_f32_16x16x32_bf16 v[60:63], a[20:23], v[196:199], v[60:63]
    ds_read_b128 a[52:55], v4 offset:26624
    v_mfma_f32_16x16x32_bf16 v[64:67], a[24:27], v[192:195], v[64:67]
    v_mfma_f32_16x16x32_bf16 v[68:71], a[24:27], v[196:199], v[68:71]
    ds_read_b128 a[56:59], v4 offset:28672
    v_mfma_f32_16x16x32_bf16 v[72:75], a[28:31], v[192:195], v[72:75]
    v_mfma_f32_16x16x32_bf16 v[76:79], a[28:31], v[196:199], v[76:79]
    ds_read_b128 a[60:63], v4 offset:30720
    s_waitcnt vmcnt(8)
    s_barrier
    s_waitcnt lgkmcnt(4)
    v_mfma_f32_16x16x32_bf16 v[16:19], a[32:35], v[200:203], v[16:19]
    v_mfma_f32_16x16x32_bf16 v[20:23], a[32:35], v[204:207], v[20:23]
    ds_read_b128 a[0:3], v3 offset:32768
    s_add_u32 m0, s21, 0
    v_mfma_f32_16x16x32_bf16 v[24:27], a[36:39], v[200:203], v[24:27]
    v_mfma_f32_16x16x32_bf16 v[28:31], a[36:39], v[204:207], v[28:31]
    ds_read_b128 a[4:7], v3 offset:34816
    s_add_u32 s64, s20, 0x50000
    buffer_load_dwordx4 v2, s[4:7], s64 offen lds
    v_mfma_f32_16x16x32_bf16 v[32:35], a[40:43], v[200:203], v[32:35]
    v_mfma_f32_16x16x32_bf16 v[36:39], a[40:43], v[204:207], v[36:39]
    ds_read_b128 a[8:11], v3 offset:36864
    s_add_u32 m0, s21, 1024
    v_mfma_f32_16x16x32_bf16 v[40:43], a[44:47], v[200:203], v[40:43]
    v_mfma_f32_16x16x32_bf16 v[44:47], a[44:47], v[204:207], v[44:47]
    ds_read_b128 a[12:15], v3 offset:38912
    s_add_u32 s64, s20, 0x52800
    buffer_load_dwordx4 v2, s[4:7], s64 offen lds
    s_waitcnt lgkmcnt(4)
    v_mfma_f32_16x16x32_bf16 v[48:51], a[48:51], v[200:203], v[48:51]
    v_mfma_f32_16x16x32_bf16 v[52:55], a[48:51], v[204:207], v[52:55]
    ds_read_b128 a[16:19], v3 offset:40960
    s_add_u32 m0, s21, 2048
    v_mfma_f32_16x16x32_bf16 v[56:59], a[52:55], v[200:203], v[56:59]
    v_mfma_f32_16x16x32_bf16 v[60:63], a[52:55], v[204:207], v[60:63]
    ds_read_b128 a[20:23], v3 offset:43008
    s_add_u32 s64, s20, 0x55000
    buffer_load_dwordx4 v2, s[4:7], s64 offen lds
    v_mfma_f32_16x16x32_bf16 v[64:67], a[56:59], v[200:203], v[64:67]
    v_mfma_f32_16x16x32_bf16 v[68:71], a[56:59], v[204:207], v[68:71]
    ds_read_b128 a[24:27], v3 offset:45056
    s_add_u32 m0, s21, 3072
    v_mfma_f32_16x16x32_bf16 v[72:75], a[60:63], v[200:203], v[72:75]
    v_mfma_f32_16x16x32_bf16 v[76:79], a[60:63], v[204:207], v[76:79]
    ds_read_b128 a[28:31], v3 offset:47104
    s_add_u32 s64, s20, 0x57800
    buffer_load_dwordx4 v2, s[4:7], s64 offen lds
    s_waitcnt lgkmcnt(4)
    v_mfma_f32_16x16x32_bf16 v[16:19], a[0:3], v[208:211], v[16:19]
    v_mfma_f32_16x16x32_bf16 v[20:23], a[0:3], v[212:215], v[20:23]
    ds_read_b128 a[32:35], v4 offset:32768
    v_mfma_f32_16x16x32_bf16 v[24:27], a[4:7], v[208:211], v[24:27]
    v_mfma_f32_16x16x32_bf16 v[28:31], a[4:7], v[212:215], v[28:31]
    ds_read_b128 a[36:39], v4 offset:34816
    v_mfma_f32_16x16x32_bf16 v[32:35], a[8:11], v[208:211], v[32:35]
    v_mfma_f32_16x16x32_bf16 v[36:39], a[8:11], v[212:215], v[36:39]
    ds_read_b128 a[40:43], v4 offset:36864
    v_mfma_f32_16x16x32_bf16 v[40:43], a[12:15], v[208:211], v[40:43]
    v_mfma_f32_16x16x32_bf16 v[44:47], a[12:15], v[212:215], v[44:47]
    ds_read_b128 a[44:47], v4 offset:38912
    s_waitcnt lgkmcnt(4)
    v_mfma_f32_16x16x32_bf16 v[48:51], a[16:19], v[208:211], v[48:51]
    v_mfma_f32_16x16x32_bf16 v[52:55], a[16:19], v[212:215], v[52:55]
    ds_read_b128 a[48:51], v4 offset:40960
    v_mfma_f32_16x16x32_bf16 v[56:59], a[20:23], v[208:211], v[56:59]
    v_mfma_f32_16x16x32_bf16 v[60:63], a[20:23], v[212:215], v[60:63]
    ds_read_b128 a[52:55], v4 offset:43008
    v_mfma_f32_16x16x32_bf16 v[64:67], a[24:27], v[208:211], v[64:67]
    v_mfma_f32_16x16x32_bf16 v[68:71], a[24:27], v[212:215], v[68:71]
    ds_read_b128 a[56:59], v4 offset:45056
    v_mfma_f32_16x16x32_bf16 v[72:75], a[28:31], v[208:211], v[72:75]
    v_mfma_f32_16x16x32_bf16 v[76:79], a[28:31], v[212:215], v[76:79]
    ds_read_b128 a[60:63], v4 offset:47104
    s_waitcnt vmcnt(8)
    s_barrier
    s_waitcnt lgkmcnt(4)
    v_mfma_f32_16x16x32_bf16 v[16:19], a[32:35], v[216:219], v[16:19]
    v_mfma_f32_16x16x32_bf16 v[20:23], a[32:35], v[220:223], v[20:23]
    ds_read_b128 a[0:3], v3 offset:49152
    s_add_u32 m0, s21, 16384
    v_mfma_f32_16x16x32_bf16 v[24:27], a[36:39], v[216:219], v[24:27]
    v_mfma_f32_16x16x32_bf16 v[28:31], a[36:39], v[220:223], v[28:31]
    ds_read_b128 a[4:7], v3 offset:51200
    s_add_u32 s64, s20, 0x50080
    buffer_load_dwordx4 v2, s[4:7], s64 offen lds
    v_mfma_f32_16x16x32_bf16 v[32:35], a[40:43], v[216:219], v[32:35]
    v_mfma_f32_16x16x32_bf16 v[36:39], a[40:43], v[220:223], v[36:39]
    ds_read_b128 a[8:11], v3 offset:53248
    s_add_u32 m0, s21, 17408
    v_mfma_f32_16x16x32_bf16 v[40:43], a[44:47], v[216:219], v[40:43]
    v_mfma_f32_16x16x32_bf16 v[44:47], a[44:47], v[220:223], v[44:47]
    ds_read_b128 a[12:15], v3 offset:55296
    s_add_u32 s64, s20, 0x52880
    buffer_load_dwordx4 v2, s[4:7], s64 offen lds
    s_waitcnt lgkmcnt(4)
    v_mfma_f32_16x16x32_bf16 v[48:51], a[48:51], v[216:219], v[48:51]
    v_mfma_f32_16x16x32_bf16 v[52:55], a[48:51], v[220:223], v[52:55]
    ds_read_b128 a[16:19], v3 offset:57344
    s_add_u32 m0, s21, 18432
    v_mfma_f32_16x16x32_bf16 v[56:59], a[52:55], v[216:219], v[56:59]
    v_mfma_f32_16x16x32_bf16 v[60:63], a[52:55], v[220:223], v[60:63]
    ds_read_b128 a[20:23], v3 offset:59392
    s_add_u32 s64, s20, 0x55080
    buffer_load_dwordx4 v2, s[4:7], s64 offen lds
    v_mfma_f32_16x16x32_bf16 v[64:67], a[56:59], v[216:219], v[64:67]
    v_mfma_f32_16x16x32_bf16 v[68:71], a[56:59], v[220:223], v[68:71]
    ds_read_b128 a[24:27], v3 offset:61440
    s_add_u32 m0, s21, 19456
    v_mfma_f32_16x16x32_bf16 v[72:75], a[60:63], v[216:219], v[72:75]
    v_mfma_f32_16x16x32_bf16 v[76:79], a[60:63], v[220:223], v[76:79]
    ds_read_b128 a[28:31], v3 offset:63488
    s_add_u32 s64, s20, 0x57880
    buffer_load_dwordx4 v2, s[4:7], s64 offen lds
    s_waitcnt lgkmcnt(4)
    v_mfma_f32_16x16x32_bf16 v[16:19], a[0:3], v[224:227], v[16:19]
    v_mfma_f32_16x16x32_bf16 v[20:23], a[0:3], v[228:231], v[20:23]
    ds_read_b128 a[32:35], v4 offset:49152
    v_mfma_f32_16x16x32_bf16 v[24:27], a[4:7], v[224:227], v[24:27]
    v_mfma_f32_16x16x32_bf16 v[28:31], a[4:7], v[228:231], v[28:31]
    ds_read_b128 a[36:39], v4 offset:51200
    v_mfma_f32_16x16x32_bf16 v[32:35], a[8:11], v[224:227], v[32:35]
    v_mfma_f32_16x16x32_bf16 v[36:39], a[8:11], v[228:231], v[36:39]
    ds_read_b128 a[40:43], v4 offset:53248
    v_mfma_f32_16x16x32_bf16 v[40:43], a[12:15], v[224:227], v[40:43]
    v_mfma_f32_16x16x32_bf16 v[44:47], a[12:15], v[228:231], v[44:47]
    ds_read_b128 a[44:47], v4 offset:55296
    s_waitcnt lgkmcnt(4)
    v_mfma_f32_16x16x32_bf16 v[48:51], a[16:19], v[224:227], v[48:51]
    v_mfma_f32_16x16x32_bf16 v[52:55], a[16:19], v[228:231], v[52:55]
    ds_read_b128 a[48:51], v4 offset:57344
    v_mfma_f32_16x16x32_bf16 v[56:59], a[20:23], v[224:227], v[56:59]
    v_mfma_f32_16x16x32_bf16 v[60:63], a[20:23], v[228:231], v[60:63]
    ds_read_b128 a[52:55], v4 offset:59392
    v_mfma_f32_16x16x32_bf16 v[64:67], a[24:27], v[224:227], v[64:67]
    v_mfma_f32_16x16x32_bf16 v[68:71], a[24:27], v[228:231], v[68:71]
    ds_read_b128 a[56:59], v4 offset:61440
    v_mfma_f32_16x16x32_bf16 v[72:75], a[28:31], v[224:227], v[72:75]
    v_mfma_f32_16x16x32_bf16 v[76:79], a[28:31], v[228:231], v[76:79]
    ds_read_b128 a[60:63], v4 offset:63488
    s_waitcnt vmcnt(8)
    s_barrier
    s_waitcnt lgkmcnt(4)
    v_mfma_f32_16x16x32_bf16 v[16:19], a[32:35], v[232:235], v[16:19]
    v_mfma_f32_16x16x32_bf16 v[20:23], a[32:35], v[236:239], v[20:23]
    ds_read_b128 a[0:3], v6 offset:0
    s_add_u32 m0, s21, 32768
    v_mfma_f32_16x16x32_bf16 v[24:27], a[36:39], v[232:235], v[24:27]
    v_mfma_f32_16x16x32_bf16 v[28:31], a[36:39], v[236:239], v[28:31]
    ds_read_b128 a[4:7], v6 offset:2048
    s_add_u32 s64, s20, 0x50100
    buffer_load_dwordx4 v2, s[4:7], s64 offen lds
    v_mfma_f32_16x16x32_bf16 v[32:35], a[40:43], v[232:235], v[32:35]
    v_mfma_f32_16x16x32_bf16 v[36:39], a[40:43], v[236:239], v[36:39]
    ds_read_b128 a[8:11], v6 offset:4096
    s_add_u32 m0, s21, 33792
    v_mfma_f32_16x16x32_bf16 v[40:43], a[44:47], v[232:235], v[40:43]
    v_mfma_f32_16x16x32_bf16 v[44:47], a[44:47], v[236:239], v[44:47]
    ds_read_b128 a[12:15], v6 offset:6144
    s_add_u32 s64, s20, 0x52900
    buffer_load_dwordx4 v2, s[4:7], s64 offen lds
    s_waitcnt lgkmcnt(4)
    v_mfma_f32_16x16x32_bf16 v[48:51], a[48:51], v[232:235], v[48:51]
    v_mfma_f32_16x16x32_bf16 v[52:55], a[48:51], v[236:239], v[52:55]
    ds_read_b128 a[16:19], v6 offset:8192
    s_add_u32 m0, s21, 34816
    v_mfma_f32_16x16x32_bf16 v[56:59], a[52:55], v[232:235], v[56:59]
    v_mfma_f32_16x16x32_bf16 v[60:63], a[52:55], v[236:239], v[60:63]
    ds_read_b128 a[20:23], v6 offset:10240
    s_add_u32 s64, s20, 0x55100
    buffer_load_dwordx4 v2, s[4:7], s64 offen lds
    v_mfma_f32_16x16x32_bf16 v[64:67], a[56:59], v[232:235], v[64:67]
    v_mfma_f32_16x16x32_bf16 v[68:71], a[56:59], v[236:239], v[68:71]
    ds_read_b128 a[24:27], v6 offset:12288
    s_add_u32 m0, s21, 35840
    v_mfma_f32_16x16x32_bf16 v[72:75], a[60:63], v[232:235], v[72:75]
    v_mfma_f32_16x16x32_bf16 v[76:79], a[60:63], v[236:239], v[76:79]
    ds_read_b128 a[28:31], v6 offset:14336
    s_add_u32 s64, s20, 0x57900
    buffer_load_dwordx4 v2, s[4:7], s64 offen lds
    s_waitcnt lgkmcnt(4)
    v_mfma_f32_16x16x32_bf16 v[16:19], a[0:3], v[240:243], v[16:19]
    v_mfma_f32_16x16x32_bf16 v[20:23], a[0:3], v[244:247], v[20:23]
    ds_read_b128 a[32:35], v9 offset:0
    v_mfma_f32_16x16x32_bf16 v[24:27], a[4:7], v[240:243], v[24:27]
    v_mfma_f32_16x16x32_bf16 v[28:31], a[4:7], v[244:247], v[28:31]
    ds_read_b128 a[36:39], v9 offset:2048
    v_mfma_f32_16x16x32_bf16 v[32:35], a[8:11], v[240:243], v[32:35]
    v_mfma_f32_16x16x32_bf16 v[36:39], a[8:11], v[244:247], v[36:39]
    ds_read_b128 a[40:43], v9 offset:4096
    v_mfma_f32_16x16x32_bf16 v[40:43], a[12:15], v[240:243], v[40:43]
    v_mfma_f32_16x16x32_bf16 v[44:47], a[12:15], v[244:247], v[44:47]
    ds_read_b128 a[44:47], v9 offset:6144
    s_waitcnt lgkmcnt(4)
    v_mfma_f32_16x16x32_bf16 v[48:51], a[16:19], v[240:243], v[48:51]
    v_mfma_f32_16x16x32_bf16 v[52:55], a[16:19], v[244:247], v[52:55]
    ds_read_b128 a[48:51], v9 offset:8192
    v_mfma_f32_16x16x32_bf16 v[56:59], a[20:23], v[240:243], v[56:59]
    v_mfma_f32_16x16x32_bf16 v[60:63], a[20:23], v[244:247], v[60:63]
    ds_read_b128 a[52:55], v9 offset:10240
    v_mfma_f32_16x16x32_bf16 v[64:67], a[24:27], v[240:243], v[64:67]
    v_mfma_f32_16x16x32_bf16 v[68:71], a[24:27], v[244:247], v[68:71]
    ds_read_b128 a[56:59], v9 offset:12288
    v_mfma_f32_16x16x32_bf16 v[72:75], a[28:31], v[240:243], v[72:75]
    v_mfma_f32_16x16x32_bf16 v[76:79], a[28:31], v[244:247], v[76:79]
    ds_read_b128 a[60:63], v9 offset:14336
    s_waitcnt vmcnt(8)
    s_barrier
    s_waitcnt lgkmcnt(4)
    v_mfma_f32_16x16x32_bf16 v[16:19], a[32:35], v[248:251], v[16:19]
    v_mfma_f32_16x16x32_bf16 v[20:23], a[32:35], v[252:255], v[20:23]
    ds_read_b128 a[0:3], v3 offset:0
    s_add_u32 m0, s21, 49152
    v_mfma_f32_16x16x32_bf16 v[24:27], a[36:39], v[248:251], v[24:27]
    v_mfma_f32_16x16x32_bf16 v[28:31], a[36:39], v[252:255], v[28:31]
    ds_read_b128 a[4:7], v3 offset:2048
    s_add_u32 s64, s20, 0x50180
    buffer_load_dwordx4 v2, s[4:7], s64 offen lds
    v_mfma_f32_16x16x32_bf16 v[32:35], a[40:43], v[248:251], v[32:35]
    v_mfma_f32_16x16x32_bf16 v[36:39], a[40:43], v[252:255], v[36:39]
    ds_read_b128 a[8:11], v3 offset:4096
    s_add_u32 m0, s21, 50176
    v_mfma_f32_16x16x32_bf16 v[40:43], a[44:47], v[248:251], v[40:43]
    v_mfma_f32_16x16x32_bf16 v[44:47], a[44:47], v[252:255], v[44:47]
    ds_read_b128 a[12:15], v3 offset:6144
    s_add_u32 s64, s20, 0x52980
    buffer_load_dwordx4 v2, s[4:7], s64 offen lds
    s_waitcnt lgkmcnt(4)
    v_mfma_f32_16x16x32_bf16 v[48:51], a[48:51], v[248:251], v[48:51]
    v_mfma_f32_16x16x32_bf16 v[52:55], a[48:51], v[252:255], v[52:55]
    ds_read_b128 a[16:19], v3 offset:8192
    s_add_u32 m0, s21, 51200
    v_mfma_f32_16x16x32_bf16 v[56:59], a[52:55], v[248:251], v[56:59]
    v_mfma_f32_16x16x32_bf16 v[60:63], a[52:55], v[252:255], v[60:63]
    ds_read_b128 a[20:23], v3 offset:10240
    s_add_u32 s64, s20, 0x55180
    buffer_load_dwordx4 v2, s[4:7], s64 offen lds
    v_mfma_f32_16x16x32_bf16 v[64:67], a[56:59], v[248:251], v[64:67]
    v_mfma_f32_16x16x32_bf16 v[68:71], a[56:59], v[252:255], v[68:71]
    ds_read_b128 a[24:27], v3 offset:12288
    s_add_u32 m0, s21, 52224
    v_mfma_f32_16x16x32_bf16 v[72:75], a[60:63], v[248:251], v[72:75]
    v_mfma_f32_16x16x32_bf16 v[76:79], a[60:63], v[252:255], v[76:79]
    ds_read_b128 a[28:31], v3 offset:14336
    s_add_u32 s64, s20, 0x57980
    buffer_load_dwordx4 v2, s[4:7], s64 offen lds
    s_nop 5
    s_mul_i32 s65, s17, 0
    s_add_u32 s65, s65, s22
    s_add_u32 s64, s65, 0
    v_cvt_pk_bf16_f32 v80, v16, v17
    v_cvt_pk_bf16_f32 v81, v18, v19
    v_cvt_pk_bf16_f32 v82, v24, v25
    v_cvt_pk_bf16_f32 v83, v26, v27
    buffer_store_dwordx4 v[80:83], v1, s[4:7], s64 offen sc1
    s_add_u32 s64, s65, 1024
    v_cvt_pk_bf16_f32 v84, v20, v21
    v_cvt_pk_bf16_f32 v85, v22, v23
    v_cvt_pk_bf16_f32 v86, v28, v29
    v_cvt_pk_bf16_f32 v87, v30, v31
    buffer_store_dwordx4 v[84:87], v1, s[4:7], s64 offen sc1
    s_mul_i32 s65, s17, 1
    s_add_u32 s65, s65, s22
    s_add_u32 s64, s65, 0
    v_cvt_pk_bf16_f32 v88, v32, v33
    v_cvt_pk_bf16_f32 v89, v34, v35
    v_cvt_pk_bf16_f32 v90, v40, v41
    v_cvt_pk_bf16_f32 v91, v42, v43
    buffer_store_dwordx4 v[88:91], v1, s[4:7], s64 offen sc1
    s_add_u32 s64, s65, 1024
    v_cvt_pk_bf16_f32 v92, v36, v37
    v_cvt_pk_bf16_f32 v93, v38, v39
    v_cvt_pk_bf16_f32 v94, v44, v45
    v_cvt_pk_bf16_f32 v95, v46, v47
    buffer_store_dwordx4 v[92:95], v1, s[4:7], s64 offen sc1
    s_mul_i32 s65, s17, 2
    s_add_u32 s65, s65, s22
    s_add_u32 s64, s65, 0
    v_cvt_pk_bf16_f32 v80, v48, v49
    v_cvt_pk_bf16_f32 v81, v50, v51
    v_cvt_pk_bf16_f32 v82, v56, v57
    v_cvt_pk_bf16_f32 v83, v58, v59
    buffer_store_dwordx4 v[80:83], v1, s[4:7], s64 offen sc1
    s_add_u32 s64, s65, 1024
    v_cvt_pk_bf16_f32 v84, v52, v53
    v_cvt_pk_bf16_f32 v85, v54, v55
    v_cvt_pk_bf16_f32 v86, v60, v61
    v_cvt_pk_bf16_f32 v87, v62, v63
    buffer_store_dwordx4 v[84:87], v1, s[4:7], s64 offen sc1
    s_mul_i32 s65, s17, 3
    s_add_u32 s65, s65, s22
    s_add_u32 s64, s65, 0
    v_cvt_pk_bf16_f32 v88, v64, v65
    v_cvt_pk_bf16_f32 v89, v66, v67
    v_cvt_pk_bf16_f32 v90, v72, v73
    v_cvt_pk_bf16_f32 v91, v74, v75
    buffer_store_dwordx4 v[88:91], v1, s[4:7], s64 offen sc1
    s_add_u32 s64, s65, 1024
    v_cvt_pk_bf16_f32 v92, v68, v69
    v_cvt_pk_bf16_f32 v93, v70, v71
    v_cvt_pk_bf16_f32 v94, v76, v77
    v_cvt_pk_bf16_f32 v95, v78, v79
    buffer_store_dwordx4 v[92:95], v1, s[4:7], s64 offen sc1
    s_lshl_b32 s64, s19, 1
    s_add_u32 s64, s64, s12
    s_lshl_b32 s64, s64, 9
    s_add_u32 s23, s18, s64
    s_lshl_b32 s64, s17, 3
    s_add_u32 s22, s22, s64
    s_add_u32 s19, s19, 1
    s_add_u32 s20, s20, 0x50000
    s_cmp_lg_u32 s19, 1
    s_cbranch_scc1 GE0_148
    s_waitcnt vmcnt(0)
    s_barrier
    s_cmp_lg_u32 s14, 0
    s_cbranch_scc1 GF_149
    v_mov_b32 v7, 1
    v_mov_b32 v8, 0
    s_mov_b64 exec, 1
    buffer_store_dword v7, v8, s[4:7], s23 offen sc1
    s_mov_b64 exec, -1
GF_149:
GE0_148:
    s_cmp_lt_u32 s19, 8
    s_cbranch_scc1 G_N_LOOP
    s_waitcnt vmcnt(0) lgkmcnt(0)
    s_barrier
    s_cmp_lg_u32 s14, 0
    s_cbranch_scc1 GF_150
    v_mov_b32 v7, 1
    v_mov_b32 v8, 0
    s_mov_b64 exec, 1
    buffer_store_dword v7, v8, s[4:7], s23 offen sc1
    s_mov_b64 exec, -1
GF_150:
    s_cmp_eq_u32 s12, 1
    s_cbranch_scc1 H_OUT
    s_lshl_b32 s88, s3, 5
    s_add_u32 s88, s88, s13
    s_mov_b32 s29, 0
    v_lshlrev_b32 v1, 4, v0
    s_mov_b32 s65, 0
CW_151:
    buffer_load_dwordx2 v[8:9], off, s[60:63], 0 offset:132 sc1
    s_add_u32 s65, s65, 1
    s_waitcnt vmcnt(0)
    v_readfirstlane_b32 s66, v8
    v_readfirstlane_b32 s67, v9
    s_min_u32 s64, s66, s67
    s_cmp_lg_u32 s64, 0
    s_cbranch_scc1 CWD_152
    s_cmp_gt_u32 s65, 65536
    s_cbranch_scc1 CWD_152
    s_sleep 4
    s_branch CW_151
CWD_152:
    s_sub_u32 s66, s66, 1
    s_and_b32 s66, s66, 3
    s_sub_u32 s67, s67, 1
    s_and_b32 s67, s67, 3
    s_mov_b32 s64, s66
    s_mov_b32 s65, s67
    s_and_b32 s64, s64, 3
    s_lshl_b32 s64, s64, 13
    s_and_b32 s65, s65, 3
    s_lshl_b32 s65, s65, 13
    s_add_u32 s25, s64, 0x6000000
    s_add_u32 s30, s65, 0x6200000
    v_bfe_u32 v4, v0, 3, 1
    v_mul_u32_u24 v2, 0x8000, v4
    v_lshrrev_b32 v4, 5, v0
    v_lshl_add_u32 v2, v4, 8, v2
    v_bfe_u32 v4, v0, 4, 1
    v_lshl_add_u32 v2, v4, 7, v2
    v_and_b32 v4, 7, v0
    v_lshl_add_u32 v2, v4, 4, v2
    v_lshrrev_b32 v4, 5, v0
    v_lshlrev_b32 v3, 16, v4
    v_bfe_u32 v4, v0, 4, 1
    v_lshl_add_u32 v3, v4, 7, v3
    v_and_b32 v4, 15, v0
    v_lshl_add_u32 v3, v4, 3, v3
    s_lshl_b32 s26, s13, 11
    s_lshl_b32 s64, s14, 9
    s_add_u32 s26, s26, s64
    s_add_u32 s26, s26, 0xa40000
    s_lshl_b32 s27, s13, 3
    s_add_u32 s27, s27, 0x294004
    s_mov_b32 s28, 0x29a000
    s_mov_b32 s24, 0
    v_lshlrev_b32 v6, 7, v0
MKN_LOOP:
    s_cmp_lg_u32 s24, 10
    s_cbranch_scc1 MKH_153
    v_mov_b32 v10, v2
    v_mov_b32 v11, v3
    s_cmp_ge_u32 s88, 60
    s_cbranch_scc1 NOWO_154
    s_mov_b32 s89, s13
    s_mul_hi_u32 s65, s88, 0xccccccd
    s_mul_i32 s65, s65, 20
    s_sub_u32 s13, s88, s65
    s_load_dwordx2 s[44:45], s[0:1], 40
    s_mov_b32 s46, 0x500000
    s_mov_b32 s47, 0x00020000
    s_waitcnt lgkmcnt(0)
    s_mul_i32 s21, s14, 36864
    v_lshrrev_b32 v7, 2, v0
    v_mul_u32_u24 v4, 1280, v7
    v_bfe_u32 v7, v0, 4, 1
    v_lshlrev_b32 v7, 1, v7
    v_and_b32 v8, 3, v0
    v_xor_b32 v7, v7, v8
    v_lshl_add_u32 v4, v7, 4, v4
    v_lshrrev_b32 v7, 4, v0
    v_lshlrev_b32 v2, 8, v7
    v_bfe_u32 v7, v0, 2, 2
    v_lshl_add_u32 v2, v7, 6, v2
    v_and_b32 v7, 3, v0
    v_lshl_add_u32 v2, v7, 3, v2
    v_add_u32 v2, s21, v2
    v_bfe_u32 v7, v0, 4, 1
    v_lshlrev_b32 v7, 5, v7
    v_sub_u32 v3, 32, v7
    v_add_u32 v3, v3, v2
    v_add_u32 v2, v2, v7
    s_mul_i32 s65, s14, 1310720
    s_lshl_b32 s66, s13, 6
    s_add_u32 s65, s65, s66
    s_add_u32 m0, s21, 0
    s_add_u32 s64, s65, 0x0
    buffer_load_dwordx4 v4, s[44:47], s64 offen lds
    s_add_u32 m0, s21, 1024
    s_add_u32 s64, s65, 0x5000
    buffer_load_dwordx4 v4, s[44:47], s64 offen lds
    s_add_u32 m0, s21, 2048
    s_add_u32 s64, s65, 0xa000
    buffer_load_dwordx4 v4, s[44:47], s64 offen lds
    s_add_u32 m0, s21, 3072
    s_add_u32 s64, s65, 0xf000
    buffer_load_dwordx4 v4, s[44:47], s64 offen lds
    s_add_u32 m0, s21, 4096
    s_add_u32 s64, s65, 0x14000
    buffer_load_dwordx4 v4, s[44:47], s64 offen lds
    s_add_u32 m0, s21, 5120
    s_add_u32 s64, s65, 0x19000
    buffer_load_dwordx4 v4, s[44:47], s64 offen lds
    s_add_u32 m0, s21, 6144
    s_add_u32 s64, s65, 0x1e000
    buffer_load_dwordx4 v4, s[44:47], s64 offen lds
    s_add_u32 m0, s21, 7168
    s_add_u32 s64, s65, 0x23000
    buffer_load_dwordx4 v4, s[44:47], s64 offen lds
    s_add_u32 m0, s21, 8192
    s_add_u32 s64, s65, 0x28000
    buffer_load_dwordx4 v4, s[44:47], s64 offen lds
    s_add_u32 m0, s21, 9216
    s_add_u32 s64, s65, 0x2d000
    buffer_load_dwordx4 v4, s[44:47], s64 offen lds
    s_add_u32 m0, s21, 10240
    s_add_u32 s64, s65, 0x32000
    buffer_load_dwordx4 v4, s[44:47], s64 offen lds
    s_add_u32 m0, s21, 11264
    s_add_u32 s64, s65, 0x37000
    buffer_load_dwordx4 v4, s[44:47], s64 offen lds
    s_add_u32 m0, s21, 12288
    s_add_u32 s64, s65, 0x3c000
    buffer_load_dwordx4 v4, s[44:47], s64 offen lds
    s_add_u32 m0, s21, 13312
    s_add_u32 s64, s65, 0x41000
    buffer_load_dwordx4 v4, s[44:47], s64 offen lds
    s_add_u32 m0, s21, 14336
    s_add_u32 s64, s65, 0x46000
    buffer_load_dwordx4 v4, s[44:47], s64 offen lds
    s_add_u32 m0, s21, 15360
    s_add_u32 s64, s65, 0x4b000
    buffer_load_dwordx4 v4, s[44:47], s64 offen lds
    s_add_u32 m0, s21, 16384
    s_add_u32 s64, s65, 0x50000
    buffer_load_dwordx4 v4, s[44:47], s64 offen lds
    s_add_u32 m0, s21, 17408
    s_add_u32 s64, s65, 0x55000
    buffer_load_dwordx4 v4, s[44:47], s64 offen lds
    s_add_u32 m0, s21, 18432
    s_add_u32 s64, s65, 0x5a000
    buffer_load_dwordx4 v4, s[44:47], s64 offen lds
    s_add_u32 m0, s21, 19456
    s_add_u32 s64, s65, 0x5f000
    buffer_load_dwordx4 v4, s[44:47], s64 offen lds
    s_add_u32 m0, s21, 20480
    s_add_u32 s64, s65, 0x64000
    buffer_load_dwordx4 v4, s[44:47], s64 offen lds
    s_add_u32 m0, s21, 21504
    s_add_u32 s64, s65, 0x69000
    buffer_load_dwordx4 v4, s[44:47], s64 offen lds
    s_add_u32 m0, s21, 22528
    s_add_u32 s64, s65, 0x6e000
    buffer_load_dwordx4 v4, s[44:47], s64 offen lds
    s_add_u32 m0, s21, 23552
    s_add_u32 s64, s65, 0x73000
    buffer_load_dwordx4 v4, s[44:47], s64 offen lds
    s_add_u32 m0, s21, 24576
    s_add_u32 s64, s65, 0x78000
    buffer_load_dwordx4 v4, s[44:47], s64 offen lds
    s_add_u32 m0, s21, 25600
    s_add_u32 s64, s65, 0x7d000
    buffer_load_dwordx4 v4, s[44:47], s64 offen lds
    s_add_u32 m0, s21, 26624
    s_add_u32 s64, s65, 0x82000
    buffer_load_dwordx4 v4, s[44:47], s64 offen lds
    s_add_u32 m0, s21, 27648
    s_add_u32 s64, s65, 0x87000
    buffer_load_dwordx4 v4, s[44:47], s64 offen lds
    s_add_u32 m0, s21, 28672
    s_add_u32 s64, s65, 0x8c000
    buffer_load_dwordx4 v4, s[44:47], s64 offen lds
    s_add_u32 m0, s21, 29696
    s_add_u32 s64, s65, 0x91000
    buffer_load_dwordx4 v4, s[44:47], s64 offen lds
    s_add_u32 m0, s21, 30720
    s_add_u32 s64, s65, 0x96000
    buffer_load_dwordx4 v4, s[44:47], s64 offen lds
    s_add_u32 m0, s21, 31744
    s_add_u32 s64, s65, 0x9b000
    buffer_load_dwordx4 v4, s[44:47], s64 offen lds
    s_add_u32 m0, s21, 32768
    s_add_u32 s64, s65, 0xa0000
    buffer_load_dwordx4 v4, s[44:47], s64 offen lds
    s_add_u32 m0, s21, 33792
    s_add_u32 s64, s65, 0xa5000
    buffer_load_dwordx4 v4, s[44:47], s64 offen lds
    s_add_u32 m0, s21, 34816
    s_add_u32 s64, s65, 0xaa000
    buffer_load_dwordx4 v4, s[44:47], s64 offen lds
    s_add_u32 m0, s21, 35840
    s_add_u32 s64, s65, 0xaf000
    buffer_load_dwordx4 v4, s[44:47], s64 offen lds
    s_waitcnt vmcnt(32)
    ds_read_b64_tr_b16 a[0:1], v2 offset:0
    ds_read_b64_tr_b16 a[2:3], v2 offset:1024
    ds_read_b64_tr_b16 a[4:5], v3 offset:0
    ds_read_b64_tr_b16 a[6:7], v3 offset:1024
    ds_read_b64_tr_b16 a[8:9], v2 offset:2048
    ds_read_b64_tr_b16 a[10:11], v2 offset:3072
    ds_read_b64_tr_b16 a[12:13], v3 offset:2048
    ds_read_b64_tr_b16 a[14:15], v3 offset:3072
    s_waitcnt lgkmcnt(0)
    s_add_u32 m0, s21, 0
    s_add_u32 s64, s65, 0xb4000
    buffer_load_dwordx4 v4, s[44:47], s64 offen lds
    s_add_u32 m0, s21, 1024
    s_add_u32 s64, s65, 0xb9000
    buffer_load_dwordx4 v4, s[44:47], s64 offen lds
    s_add_u32 m0, s21, 2048
    s_add_u32 s64, s65, 0xbe000
    buffer_load_dwordx4 v4, s[44:47], s64 offen lds
    s_add_u32 m0, s21, 3072
    s_add_u32 s64, s65, 0xc3000
    buffer_load_dwordx4 v4, s[44:47], s64 offen lds
    s_waitcnt vmcnt(32)
    ds_read_b64_tr_b16 a[16:17], v2 offset:4096
    ds_read_b64_tr_b16 a[18:19], v2 offset:5120
    ds_read_b64_tr_b16 a[20:21], v3 offset:4096
    ds_read_b64_tr_b16 a[22:23], v3 offset:5120
    ds_read_b64_tr_b16 a[24:25], v2 offset:6144
    ds_read_b64_tr_b16 a[26:27], v2 offset:7168
    ds_read_b64_tr_b16 a[28:29], v3 offset:6144
    ds_read_b64_tr_b16 a[30:31], v3 offset:7168
    s_waitcnt lgkmcnt(0)
    s_add_u32 m0, s21, 4096
    s_add_u32 s64, s65, 0xc8000
    buffer_load_dwordx4 v4, s[44:47], s64 offen lds
    s_add_u32 m0, s21, 5120
    s_add_u32 s64, s65, 0xcd000
    buffer_load_dwordx4 v4, s[44:47], s64 offen lds
    s_add_u32 m0, s21, 6144
    s_add_u32 s64, s65, 0xd2000
    buffer_load_dwordx4 v4, s[44:47], s64 offen lds
    s_add_u32 m0, s21, 7168
    s_add_u32 s64, s65, 0xd7000
    buffer_load_dwordx4 v4, s[44:47], s64 offen lds
    s_waitcnt vmcnt(32)
    ds_read_b64_tr_b16 a[32:33], v2 offset:8192
    ds_read_b64_tr_b16 a[34:35], v2 offset:9216
    ds_read_b64_tr_b16 a[36:37], v3 offset:8192
    ds_read_b64_tr_b16 a[38:39], v3 offset:9216
    ds_read_b64_tr_b16 a[40:41], v2 offset:10240
    ds_read_b64_tr_b16 a[42:43], v2 offset:11264
    ds_read_b64_tr_b16 a[44:45], v3 offset:10240
    ds_read_b64_tr_b16 a[46:47], v3 offset:11264
    s_waitcnt lgkmcnt(0)
    s_add_u32 m0, s21, 8192
    s_add_u32 s64, s65, 0xdc000
    buffer_load_dwordx4 v4, s[44:47], s64 offen lds
    s_add_u32 m0, s21, 9216
    s_add_u32 s64, s65, 0xe1000
    buffer_load_dwordx4 v4, s[44:47], s64 offen lds
    s_add_u32 m0, s21, 10240
    s_add_u32 s64, s65, 0xe6000
    buffer_load_dwordx4 v4, s[44:47], s64 offen lds
    s_add_u32 m0, s21, 11264
    s_add_u32 s64, s65, 0xeb000
    buffer_load_dwordx4 v4, s[44:47], s64 offen lds
    s_waitcnt vmcnt(32)
    ds_read_b64_tr_b16 a[48:49], v2 offset:12288
    ds_read_b64_tr_b16 a[50:51], v2 offset:13312
    ds_read_b64_tr_b16 a[52:53], v3 offset:12288
    ds_read_b64_tr_b16 a[54:55], v3 offset:13312
    ds_read_b64_tr_b16 a[56:57], v2 offset:14336
    ds_read_b64_tr_b16 a[58:59], v2 offset:15360
    ds_read_b64_tr_b16 a[60:61], v3 offset:14336
    ds_read_b64_tr_b16 a[62:63], v3 offset:15360
    s_waitcnt lgkmcnt(0)
    s_add_u32 m0, s21, 12288
    s_add_u32 s64, s65, 0xf0000
    buffer_load_dwordx4 v4, s[44:47], s64 offen lds
    s_add_u32 m0, s21, 13312
    s_add_u32 s64, s65, 0xf5000
    buffer_load_dwordx4 v4, s[44:47], s64 offen lds
    s_add_u32 m0, s21, 14336
    s_add_u32 s64, s65, 0xfa000
    buffer_load_dwordx4 v4, s[44:47], s64 offen lds
    s_add_u32 m0, s21, 15360
    s_add_u32 s64, s65, 0xff000
    buffer_load_dwordx4 v4, s[44:47], s64 offen lds
    s_waitcnt vmcnt(32)
    ds_read_b64_tr_b16 a[64:65], v2 offset:16384
    ds_read_b64_tr_b16 a[66:67], v2 offset:17408
    ds_read_b64_tr_b16 a[68:69], v3 offset:16384
    ds_read_b64_tr_b16 a[70:71], v3 offset:17408
    ds_read_b64_tr_b16 a[72:73], v2 offset:18432
    ds_read_b64_tr_b16 a[74:75], v2 offset:19456
    ds_read_b64_tr_b16 a[76:77], v3 offset:18432
    ds_read_b64_tr_b16 a[78:79], v3 offset:19456
    s_waitcnt lgkmcnt(0)
    s_add_u32 m0, s21, 16384
    s_add_u32 s64, s65, 0x104000
    buffer_load_dwordx4 v4, s[44:47], s64 offen lds
    s_add_u32 m0, s21, 17408
    s_add_u32 s64, s65, 0x109000
    buffer_load_dwordx4 v4, s[44:47], s64 offen lds
    s_add_u32 m0, s21, 18432
    s_add_u32 s64, s65, 0x10e000
    buffer_load_dwordx4 v4, s[44:47], s64 offen lds
    s_add_u32 m0, s21, 19456
    s_add_u32 s64, s65, 0x113000
    buffer_load_dwordx4 v4, s[44:47], s64 offen lds
    s_waitcnt vmcnt(32)
    ds_read_b64_tr_b16 a[80:81], v2 offset:20480
    ds_read_b64_tr_b16 a[82:83], v2 offset:21504
    ds_read_b64_tr_b16 a[84:85], v3 offset:20480
    ds_read_b64_tr_b16 a[86:87], v3 offset:21504
    ds_read_b64_tr_b16 a[88:89], v2 offset:22528
    ds_read_b64_tr_b16 a[90:91], v2 offset:23552
    ds_read_b64_tr_b16 a[92:93], v3 offset:22528
    ds_read_b64_tr_b16 a[94:95], v3 offset:23552
    s_waitcnt lgkmcnt(0)
    s_add_u32 m0, s21, 20480
    s_add_u32 s64, s65, 0x118000
    buffer_load_dwordx4 v4, s[44:47], s64 offen lds
    s_add_u32 m0, s21, 21504
    s_add_u32 s64, s65, 0x11d000
    buffer_load_dwordx4 v4, s[44:47], s64 offen lds
    s_add_u32 m0, s21, 22528
    s_add_u32 s64, s65, 0x122000
    buffer_load_dwordx4 v4, s[44:47], s64 offen lds
    s_add_u32 m0, s21, 23552
    s_add_u32 s64, s65, 0x127000
    buffer_load_dwordx4 v4, s[44:47], s64 offen lds
    s_waitcnt vmcnt(32)
    ds_read_b64_tr_b16 a[96:97], v2 offset:24576
    ds_read_b64_tr_b16 a[98:99], v2 offset:25600
    ds_read_b64_tr_b16 a[100:101], v3 offset:24576
    ds_read_b64_tr_b16 a[102:103], v3 offset:25600
    ds_read_b64_tr_b16 a[104:105], v2 offset:26624
    ds_read_b64_tr_b16 a[106:107], v2 offset:27648
    ds_read_b64_tr_b16 a[108:109], v3 offset:26624
    ds_read_b64_tr_b16 a[110:111], v3 offset:27648
    s_waitcnt lgkmcnt(0)
    s_add_u32 m0, s21, 24576
    s_add_u32 s64, s65, 0x12c000
    buffer_load_dwordx4 v4, s[44:47], s64 offen lds
    s_add_u32 m0, s21, 25600
    s_add_u32 s64, s65, 0x131000
    buffer_load_dwordx4 v4, s[44:47], s64 offen lds
    s_add_u32 m0, s21, 26624
    s_add_u32 s64, s65, 0x136000
    buffer_load_dwordx4 v4, s[44:47], s64 offen lds
    s_add_u32 m0, s21, 27648
    s_add_u32 s64, s65, 0x13b000
    buffer_load_dwordx4 v4, s[44:47], s64 offen lds
    s_waitcnt vmcnt(32)
    ds_read_b64_tr_b16 a[112:113], v2 offset:28672
    ds_read_b64_tr_b16 a[114:115], v2 offset:29696
    ds_read_b64_tr_b16 a[116:117], v3 offset:28672
    ds_read_b64_tr_b16 a[118:119], v3 offset:29696
    ds_read_b64_tr_b16 a[120:121], v2 offset:30720
    ds_read_b64_tr_b16 a[122:123], v2 offset:31744
    ds_read_b64_tr_b16 a[124:125], v3 offset:30720
    ds_read_b64_tr_b16 a[126:127], v3 offset:31744
    s_waitcnt lgkmcnt(0)
    s_waitcnt vmcnt(28)
    ds_read_b64_tr_b16 a[128:129], v2 offset:32768
    ds_read_b64_tr_b16 a[130:131], v2 offset:33792
    ds_read_b64_tr_b16 a[132:133], v3 offset:32768
    ds_read_b64_tr_b16 a[134:135], v3 offset:33792
    ds_read_b64_tr_b16 a[136:137], v2 offset:34816
    ds_read_b64_tr_b16 a[138:139], v2 offset:35840
    ds_read_b64_tr_b16 a[140:141], v3 offset:34816
    ds_read_b64_tr_b16 a[142:143], v3 offset:35840
    s_waitcnt lgkmcnt(0)
    s_waitcnt vmcnt(24)
    ds_read_b64_tr_b16 a[144:145], v2 offset:0
    ds_read_b64_tr_b16 a[146:147], v2 offset:1024
    ds_read_b64_tr_b16 a[148:149], v3 offset:0
    ds_read_b64_tr_b16 a[150:151], v3 offset:1024
    ds_read_b64_tr_b16 a[152:153], v2 offset:2048
    ds_read_b64_tr_b16 a[154:155], v2 offset:3072
    ds_read_b64_tr_b16 a[156:157], v3 offset:2048
    ds_read_b64_tr_b16 a[158:159], v3 offset:3072
    s_waitcnt lgkmcnt(0)
    s_waitcnt vmcnt(20)
    ds_read_b64_tr_b16 a[160:161], v2 offset:4096
    ds_read_b64_tr_b16 a[162:163], v2 offset:5120
    ds_read_b64_tr_b16 a[164:165], v3 offset:4096
    ds_read_b64_tr_b16 a[166:167], v3 offset:5120
    ds_read_b64_tr_b16 a[168:169], v2 offset:6144
    ds_read_b64_tr_b16 a[170:171], v2 offset:7168
    ds_read_b64_tr_b16 a[172:173], v3 offset:6144
    ds_read_b64_tr_b16 a[174:175], v3 offset:7168
    s_waitcnt lgkmcnt(0)
    s_waitcnt vmcnt(16)
    ds_read_b64_tr_b16 a[176:177], v2 offset:8192
    ds_read_b64_tr_b16 a[178:179], v2 offset:9216
    ds_read_b64_tr_b16 a[180:181], v3 offset:8192
    ds_read_b64_tr_b16 a[182:183], v3 offset:9216
    ds_read_b64_tr_b16 a[184:185], v2 offset:10240
    ds_read_b64_tr_b16 a[186:187], v2 offset:11264
    ds_read_b64_tr_b16 a[188:189], v3 offset:10240
    ds_read_b64_tr_b16 a[190:191], v3 offset:11264
    s_waitcnt lgkmcnt(0)
    s_waitcnt vmcnt(12)
    ds_read_b64_tr_b16 a[192:193], v2 offset:12288
    ds_read_b64_tr_b16 a[194:195], v2 offset:13312
    ds_read_b64_tr_b16 a[196:197], v3 offset:12288
    ds_read_b64_tr_b16 a[198:199], v3 offset:13312
    ds_read_b64_tr_b16 a[200:201], v2 offset:14336
    ds_read_b64_tr_b16 a[202:203], v2 offset:15360
    ds_read_b64_tr_b16 a[204:205], v3 offset:14336
    ds_read_b64_tr_b16 a[206:207], v3 offset:15360
    s_waitcnt lgkmcnt(0)
    s_waitcnt vmcnt(8)
    ds_read_b64_tr_b16 a[208:209], v2 offset:16384
    ds_read_b64_tr_b16 a[210:211], v2 offset:17408
    ds_read_b64_tr_b16 a[212:213], v3 offset:16384
    ds_read_b64_tr_b16 a[214:215], v3 offset:17408
    ds_read_b64_tr_b16 a[216:217], v2 offset:18432
    ds_read_b64_tr_b16 a[218:219], v2 offset:19456
    ds_read_b64_tr_b16 a[220:221], v3 offset:18432
    ds_read_b64_tr_b16 a[222:223], v3 offset:19456
    s_waitcnt lgkmcnt(0)
    s_waitcnt vmcnt(4)
    ds_read_b64_tr_b16 a[224:225], v2 offset:20480
    ds_read_b64_tr_b16 a[226:227], v2 offset:21504
    ds_read_b64_tr_b16 a[228:229], v3 offset:20480
    ds_read_b64_tr_b16 a[230:231], v3 offset:21504
    ds_read_b64_tr_b16 a[232:233], v2 offset:22528
    ds_read_b64_tr_b16 a[234:235], v2 offset:23552
    ds_read_b64_tr_b16 a[236:237], v3 offset:22528
    ds_read_b64_tr_b16 a[238:239], v3 offset:23552
    s_waitcnt lgkmcnt(0)
    s_waitcnt vmcnt(0)
    ds_read_b64_tr_b16 a[240:241], v2 offset:24576
    ds_read_b64_tr_b16 a[242:243], v2 offset:25600
    ds_read_b64_tr_b16 a[244:245], v3 offset:24576
    ds_read_b64_tr_b16 a[246:247], v3 offset:25600
    ds_read_b64_tr_b16 a[248:249], v2 offset:26624
    ds_read_b64_tr_b16 a[250:251], v2 offset:27648
    ds_read_b64_tr_b16 a[252:253], v3 offset:26624
    ds_read_b64_tr_b16 a[254:255], v3 offset:27648
    s_waitcnt lgkmcnt(0)
    s_mov_b32 s13, s89
NOWO_154:
    v_mov_b32 v2, v10
    v_mov_b32 v3, v11
MKH_153:
    s_cmp_lg_u32 s24, 31
    s_mov_b64 exec, 0xf
    s_cbranch_scc1 MKL_155
    s_mov_b64 exec, -1
    v_bfe_u32 v4, v0, 3, 1
    v_mul_u32_u24 v4, 0x8000, v4
    v_sub_u32 v2, v2, v4
    s_mov_b64 exec, 3
MKL_155:
MKN_M_156:
    buffer_load_dword v5, v6, s[4:7], s28 offen sc1
    s_add_u32 s29, s29, 1
    s_waitcnt vmcnt(0)
    v_cmp_eq_u32 vcc, 0, v5
    s_cbranch_vccz MKN_MD_157
    s_cmp_gt_u32 s29, 262144
    s_cbranch_scc1 MKN_MD_157
    s_sleep 1
    s_branch MKN_M_156
MKN_MD_157:
    s_mov_b64 exec, -1
MKR_158:
    s_add_u32 s64, s25, 0x0
    buffer_load_dwordx4 v[16:19], v2, s[4:7], s64 offen sc1
    s_add_u32 s64, s25, 0x200
    buffer_load_dwordx4 v[20:23], v2, s[4:7], s64 offen sc1
    s_add_u32 s64, s25, 0x400
    buffer_load_dwordx4 v[24:27], v2, s[4:7], s64 offen sc1
    s_add_u32 s64, s25, 0x600
    buffer_load_dwordx4 v[28:31], v2, s[4:7], s64 offen sc1
    s_add_u32 s64, s25, 0x800
    buffer_load_dwordx4 v[32:35], v2, s[4:7], s64 offen sc1
    s_add_u32 s64, s25, 0xa00
    buffer_load_dwordx4 v[36:39], v2, s[4:7], s64 offen sc1
    s_add_u32 s64, s25, 0xc00
    buffer_load_dwordx4 v[40:43], v2, s[4:7], s64 offen sc1
    s_add_u32 s64, s25, 0xe00
    buffer_load_dwordx4 v[44:47], v2, s[4:7], s64 offen sc1
    s_add_u32 s64, s25, 0x1000
    buffer_load_dwordx4 v[48:51], v2, s[4:7], s64 offen sc1
    s_add_u32 s64, s25, 0x1200
    buffer_load_dwordx4 v[52:55], v2, s[4:7], s64 offen sc1
    s_add_u32 s64, s30, 0x0
    buffer_load_dwordx4 v[56:59], v2, s[4:7], s64 offen sc1
    s_add_u32 s64, s30, 0x200
    buffer_load_dwordx4 v[60:63], v2, s[4:7], s64 offen sc1
    s_add_u32 s64, s30, 0x400
    buffer_load_dwordx4 v[64:67], v2, s[4:7], s64 offen sc1
    s_add_u32 s64, s30, 0x600
    buffer_load_dwordx4 v[68:71], v2, s[4:7], s64 offen sc1
    s_add_u32 s64, s30, 0x800
    buffer_load_dwordx4 v[72:75], v2, s[4:7], s64 offen sc1
    s_add_u32 s64, s30, 0xa00
    buffer_load_dwordx4 v[76:79], v2, s[4:7], s64 offen sc1
    s_add_u32 s64, s30, 0xc00
    buffer_load_dwordx4 v[80:83], v2, s[4:7], s64 offen sc1
    s_add_u32 s64, s30, 0xe00
    buffer_load_dwordx4 v[84:87], v2, s[4:7], s64 offen sc1
    s_add_u32 s64, s30, 0x1000
    buffer_load_dwordx4 v[88:91], v2, s[4:7], s64 offen sc1
    s_add_u32 s64, s30, 0x1200
    buffer_load_dwordx4 v[92:95], v2, s[4:7], s64 offen sc1
    s_add_u32 s29, s29, 1
    s_waitcnt vmcnt(0)
    v_max3_u32 v4, v19, v23, v27
    v_max3_u32 v4, v4, v31, v35
    v_max3_u32 v4, v4, v39, v43
    v_max3_u32 v4, v4, v47, v51
    v_max3_u32 v4, v4, v55, v59
    v_max3_u32 v4, v4, v63, v67
    v_max3_u32 v4, v4, v71, v75
    v_max3_u32 v4, v4, v79, v83
    v_max3_u32 v4, v4, v87, v91
    v_max_u32 v4, v4, v95
    v_cmp_eq_u32 vcc, -1, v4
    s_cbranch_vccz MKO_159
    s_cmp_gt_u32 s29, 262144
    s_cbranch_scc0 MKR_158
MKO_159:
    v_mfma_f32_16x16x32_bf16 v[8:11], v[16:19], v[96:99], 0
    v_mfma_f32_16x16x32_bf16 v[12:15], v[16:19], v[100:103], 0
    v_mfma_f32_16x16x32_bf16 v[8:11], v[20:23], v[104:107], v[8:11]
    v_mfma_f32_16x16x32_bf16 v[12:15], v[20:23], v[108:111], v[12:15]
    v_mfma_f32_16x16x32_bf16 v[8:11], v[24:27], v[112:115], v[8:11]
    v_mfma_f32_16x16x32_bf16 v[12:15], v[24:27], v[116:119], v[12:15]
    v_mfma_f32_16x16x32_bf16 v[8:11], v[28:31], v[120:123], v[8:11]
    v_mfma_f32_16x16x32_bf16 v[12:15], v[28:31], v[124:127], v[12:15]
    v_mfma_f32_16x16x32_bf16 v[8:11], v[32:35], v[128:131], v[8:11]
    v_mfma_f32_16x16x32_bf16 v[12:15], v[32:35], v[132:135], v[12:15]
    v_mfma_f32_16x16x32_bf16 v[8:11], v[36:39], v[136:139], v[8:11]
    v_mfma_f32_16x16x32_bf16 v[12:15], v[36:39], v[140:143], v[12:15]
    v_mfma_f32_16x16x32_bf16 v[8:11], v[40:43], v[144:147], v[8:11]
    v_mfma_f32_16x16x32_bf16 v[12:15], v[40:43], v[148:151], v[12:15]
    v_mfma_f32_16x16x32_bf16 v[8:11], v[44:47], v[152:155], v[8:11]
    v_mfma_f32_16x16x32_bf16 v[12:15], v[44:47], v[156:159], v[12:15]
    v_mfma_f32_16x16x32_bf16 v[8:11], v[48:51], v[160:163], v[8:11]
    v_mfma_f32_16x16x32_bf16 v[12:15], v[48:51], v[164:167], v[12:15]
    v_mfma_f32_16x16x32_bf16 v[8:11], v[52:55], v[168:171], v[8:11]
    v_mfma_f32_16x16x32_bf16 v[12:15], v[52:55], v[172:175], v[12:15]
    v_mfma_f32_16x16x32_bf16 v[8:11], v[56:59], v[176:179], v[8:11]
    v_mfma_f32_16x16x32_bf16 v[12:15], v[56:59], v[180:183], v[12:15]
    v_mfma_f32_16x16x32_bf16 v[8:11], v[60:63], v[184:187], v[8:11]
    v_mfma_f32_16x16x32_bf16 v[12:15], v[60:63], v[188:191], v[12:15]
    v_mfma_f32_16x16x32_bf16 v[8:11], v[64:67], v[192:195], v[8:11]
    v_mfma_f32_16x16x32_bf16 v[12:15], v[64:67], v[196:199], v[12:15]
    v_mfma_f32_16x16x32_bf16 v[8:11], v[68:71], v[200:203], v[8:11]
    v_mfma_f32_16x16x32_bf16 v[12:15], v[68:71], v[204:207], v[12:15]
    v_mfma_f32_16x16x32_bf16 v[8:11], v[72:75], v[208:211], v[8:11]
    v_mfma_f32_16x16x32_bf16 v[12:15], v[72:75], v[212:215], v[12:15]
    v_mfma_f32_16x16x32_bf16 v[8:11], v[76:79], v[216:219], v[8:11]
    v_mfma_f32_16x16x32_bf16 v[12:15], v[76:79], v[220:223], v[12:15]
    v_mfma_f32_16x16x32_bf16 v[8:11], v[80:83], v[224:227], v[8:11]
    v_mfma_f32_16x16x32_bf16 v[12:15], v[80:83], v[228:231], v[12:15]
    v_mfma_f32_16x16x32_bf16 v[8:11], v[84:87], v[232:235], v[8:11]
    v_mfma_f32_16x16x32_bf16 v[12:15], v[84:87], v[236:239], v[12:15]
    v_mfma_f32_16x16x32_bf16 v[8:11], v[88:91], v[240:243], v[8:11]
    v_mfma_f32_16x16x32_bf16 v[12:15], v[88:91], v[244:247], v[12:15]
    v_mfma_f32_16x16x32_bf16 v[8:11], v[92:95], v[248:251], v[8:11]
    v_mfma_f32_16x16x32_bf16 v[12:15], v[92:95], v[252:255], v[12:15]
    s_nop 7
    v_cvt_pk_bf16_f32 v16, v8, v9
    v_cvt_pk_bf16_f32 v17, v10, v11
    v_cvt_pk_bf16_f32 v18, v12, v13
    v_cvt_pk_bf16_f32 v19, v14, v15
    buffer_store_dwordx2 v[16:17], v3, s[4:7], s26 offen sc1
    buffer_store_dwordx2 v[18:19], v3, s[4:7], s26 offen offset:256 sc1
    s_waitcnt vmcnt(0)
    s_barrier
    s_cmp_lg_u32 s14, 0
    s_cbranch_scc1 GF_160
    v_mov_b32 v7, 1
    v_mov_b32 v8, 0
    s_mov_b64 exec, 1
    buffer_store_dword v7, v8, s[4:7], s27 offen sc1
    s_mov_b64 exec, -1
GF_160:
    s_add_u32 s25, s25, 0x10000
    s_add_u32 s30, s30, 0x10000
    s_add_u32 s26, s26, 0x20000
    s_add_u32 s27, s27, 256
    s_add_u32 s28, s28, 512
    s_add_u32 s24, s24, 1
    s_cmp_lt_u32 s24, 32
    s_cbranch_scc1 MKN_LOOP
    s_cmp_ge_u32 s88, 60
    s_cbranch_scc1 M_EXIT
    s_branch H_EXTRA
H_OUT:
    s_lshl_b32 s64, s3, 5
    s_add_u32 s64, s64, s13
    s_cmp_ge_u32 s64, 60
    s_cbranch_scc1 M_EXIT
    s_mul_hi_u32 s12, s64, 0xccccccd
    s_mul_i32 s65, s12, 20
    s_sub_u32 s13, s64, s65
    s_load_dwordx2 s[44:45], s[0:1], 40
    s_mov_b32 s46, 0x500000
    s_mov_b32 s47, 0x00020000
    s_load_dwordx2 s[48:49], s[0:1], 0
    s_mov_b32 s50, 0x280000
    s_mov_b32 s51, 0x00020000
    s_load_dwordx2 s[52:53], s[0:1], 96
    s_mov_b32 s54, 0x280000
    s_mov_b32 s55, 0x00020000
    s_mov_b32 s36, -1
    s_mov_b32 s37, 0
    s_waitcnt lgkmcnt(0)
    s_mul_i32 s21, s14, 36864
    v_lshrrev_b32 v7, 2, v0
    v_mul_u32_u24 v4, 1280, v7
    v_bfe_u32 v7, v0, 4, 1
    v_lshlrev_b32 v7, 1, v7
    v_and_b32 v8, 3, v0
    v_xor_b32 v7, v7, v8
    v_lshl_add_u32 v4, v7, 4, v4
    v_lshrrev_b32 v7, 4, v0
    v_lshlrev_b32 v2, 8, v7
    v_bfe_u32 v7, v0, 2, 2
    v_lshl_add_u32 v2, v7, 6, v2
    v_and_b32 v7, 3, v0
    v_lshl_add_u32 v2, v7, 3, v2
    v_add_u32 v2, s21, v2
    v_bfe_u32 v7, v0, 4, 1
    v_lshlrev_b32 v7, 5, v7
    v_sub_u32 v3, 32, v7
    v_add_u32 v3, v3, v2
    v_add_u32 v2, v2, v7
    s_mul_i32 s65, s14, 1310720
    s_lshl_b32 s66, s13, 6
    s_add_u32 s65, s65, s66
    s_add_u32 m0, s21, 0
    s_add_u32 s64, s65, 0x0
    buffer_load_dwordx4 v4, s[44:47], s64 offen lds
    s_add_u32 m0, s21, 1024
    s_add_u32 s64, s65, 0x5000
    buffer_load_dwordx4 v4, s[44:47], s64 offen lds
    s_add_u32 m0, s21, 2048
    s_add_u32 s64, s65, 0xa000
    buffer_load_dwordx4 v4, s[44:47], s64 offen lds
    s_add_u32 m0, s21, 3072
    s_add_u32 s64, s65, 0xf000
    buffer_load_dwordx4 v4, s[44:47], s64 offen lds
    s_add_u32 m0, s21, 4096
    s_add_u32 s64, s65, 0x14000
    buffer_load_dwordx4 v4, s[44:47], s64 offen lds
    s_add_u32 m0, s21, 5120
    s_add_u32 s64, s65, 0x19000
    buffer_load_dwordx4 v4, s[44:47], s64 offen lds
    s_add_u32 m0, s21, 6144
    s_add_u32 s64, s65, 0x1e000
    buffer_load_dwordx4 v4, s[44:47], s64 offen lds
    s_add_u32 m0, s21, 7168
    s_add_u32 s64, s65, 0x23000
    buffer_load_dwordx4 v4, s[44:47], s64 offen lds
    s_add_u32 m0, s21, 8192
    s_add_u32 s64, s65, 0x28000
    buffer_load_dwordx4 v4, s[44:47], s64 offen lds
    s_add_u32 m0, s21, 9216
    s_add_u32 s64, s65, 0x2d000
    buffer_load_dwordx4 v4, s[44:47], s64 offen lds
    s_add_u32 m0, s21, 10240
    s_add_u32 s64, s65, 0x32000
    buffer_load_dwordx4 v4, s[44:47], s64 offen lds
    s_add_u32 m0, s21, 11264
    s_add_u32 s64, s65, 0x37000
    buffer_load_dwordx4 v4, s[44:47], s64 offen lds
    s_add_u32 m0, s21, 12288
    s_add_u32 s64, s65, 0x3c000
    buffer_load_dwordx4 v4, s[44:47], s64 offen lds
    s_add_u32 m0, s21, 13312
    s_add_u32 s64, s65, 0x41000
    buffer_load_dwordx4 v4, s[44:47], s64 offen lds
    s_add_u32 m0, s21, 14336
    s_add_u32 s64, s65, 0x46000
    buffer_load_dwordx4 v4, s[44:47], s64 offen lds
    s_add_u32 m0, s21, 15360
    s_add_u32 s64, s65, 0x4b000
    buffer_load_dwordx4 v4, s[44:47], s64 offen lds
    s_add_u32 m0, s21, 16384
    s_add_u32 s64, s65, 0x50000
    buffer_load_dwordx4 v4, s[44:47], s64 offen lds
    s_add_u32 m0, s21, 17408
    s_add_u32 s64, s65, 0x55000
    buffer_load_dwordx4 v4, s[44:47], s64 offen lds
    s_add_u32 m0, s21, 18432
    s_add_u32 s64, s65, 0x5a000
    buffer_load_dwordx4 v4, s[44:47], s64 offen lds
    s_add_u32 m0, s21, 19456
    s_add_u32 s64, s65, 0x5f000
    buffer_load_dwordx4 v4, s[44:47], s64 offen lds
    s_add_u32 m0, s21, 20480
    s_add_u32 s64, s65, 0x64000
    buffer_load_dwordx4 v4, s[44:47], s64 offen lds
    s_add_u32 m0, s21, 21504
    s_add_u32 s64, s65, 0x69000
    buffer_load_dwordx4 v4, s[44:47], s64 offen lds
    s_add_u32 m0, s21, 22528
    s_add_u32 s64, s65, 0x6e000
    buffer_load_dwordx4 v4, s[44:47], s64 offen lds
    s_add_u32 m0, s21, 23552
    s_add_u32 s64, s65, 0x73000
    buffer_load_dwordx4 v4, s[44:47], s64 offen lds
    s_add_u32 m0, s21, 24576
    s_add_u32 s64, s65, 0x78000
    buffer_load_dwordx4 v4, s[44:47], s64 offen lds
    s_add_u32 m0, s21, 25600
    s_add_u32 s64, s65, 0x7d000
    buffer_load_dwordx4 v4, s[44:47], s64 offen lds
    s_add_u32 m0, s21, 26624
    s_add_u32 s64, s65, 0x82000
    buffer_load_dwordx4 v4, s[44:47], s64 offen lds
    s_add_u32 m0, s21, 27648
    s_add_u32 s64, s65, 0x87000
    buffer_load_dwordx4 v4, s[44:47], s64 offen lds
    s_add_u32 m0, s21, 28672
    s_add_u32 s64, s65, 0x8c000
    buffer_load_dwordx4 v4, s[44:47], s64 offen lds
    s_add_u32 m0, s21, 29696
    s_add_u32 s64, s65, 0x91000
    buffer_load_dwordx4 v4, s[44:47], s64 offen lds
    s_add_u32 m0, s21, 30720
    s_add_u32 s64, s65, 0x96000
    buffer_load_dwordx4 v4, s[44:47], s64 offen lds
    s_add_u32 m0, s21, 31744
    s_add_u32 s64, s65, 0x9b000
    buffer_load_dwordx4 v4, s[44:47], s64 offen lds
    s_add_u32 m0, s21, 32768
    s_add_u32 s64, s65, 0xa0000
    buffer_load_dwordx4 v4, s[44:47], s64 offen lds
    s_add_u32 m0, s21, 33792
    s_add_u32 s64, s65, 0xa5000
    buffer_load_dwordx4 v4, s[44:47], s64 offen lds
    s_add_u32 m0, s21, 34816
    s_add_u32 s64, s65, 0xaa000
    buffer_load_dwordx4 v4, s[44:47], s64 offen lds
    s_add_u32 m0, s21, 35840
    s_add_u32 s64, s65, 0xaf000
    buffer_load_dwordx4 v4, s[44:47], s64 offen lds
    s_waitcnt vmcnt(32)
    ds_read_b64_tr_b16 a[0:1], v2 offset:0
    ds_read_b64_tr_b16 a[2:3], v2 offset:1024
    ds_read_b64_tr_b16 a[4:5], v3 offset:0
    ds_read_b64_tr_b16 a[6:7], v3 offset:1024
    ds_read_b64_tr_b16 a[8:9], v2 offset:2048
    ds_read_b64_tr_b16 a[10:11], v2 offset:3072
    ds_read_b64_tr_b16 a[12:13], v3 offset:2048
    ds_read_b64_tr_b16 a[14:15], v3 offset:3072
    s_waitcnt lgkmcnt(0)
    s_add_u32 m0, s21, 0
    s_add_u32 s64, s65, 0xb4000
    buffer_load_dwordx4 v4, s[44:47], s64 offen lds
    s_add_u32 m0, s21, 1024
    s_add_u32 s64, s65, 0xb9000
    buffer_load_dwordx4 v4, s[44:47], s64 offen lds
    s_add_u32 m0, s21, 2048
    s_add_u32 s64, s65, 0xbe000
    buffer_load_dwordx4 v4, s[44:47], s64 offen lds
    s_add_u32 m0, s21, 3072
    s_add_u32 s64, s65, 0xc3000
    buffer_load_dwordx4 v4, s[44:47], s64 offen lds
    s_waitcnt vmcnt(32)
    ds_read_b64_tr_b16 a[16:17], v2 offset:4096
    ds_read_b64_tr_b16 a[18:19], v2 offset:5120
    ds_read_b64_tr_b16 a[20:21], v3 offset:4096
    ds_read_b64_tr_b16 a[22:23], v3 offset:5120
    ds_read_b64_tr_b16 a[24:25], v2 offset:6144
    ds_read_b64_tr_b16 a[26:27], v2 offset:7168
    ds_read_b64_tr_b16 a[28:29], v3 offset:6144
    ds_read_b64_tr_b16 a[30:31], v3 offset:7168
    s_waitcnt lgkmcnt(0)
    s_add_u32 m0, s21, 4096
    s_add_u32 s64, s65, 0xc8000
    buffer_load_dwordx4 v4, s[44:47], s64 offen lds
    s_add_u32 m0, s21, 5120
    s_add_u32 s64, s65, 0xcd000
    buffer_load_dwordx4 v4, s[44:47], s64 offen lds
    s_add_u32 m0, s21, 6144
    s_add_u32 s64, s65, 0xd2000
    buffer_load_dwordx4 v4, s[44:47], s64 offen lds
    s_add_u32 m0, s21, 7168
    s_add_u32 s64, s65, 0xd7000
    buffer_load_dwordx4 v4, s[44:47], s64 offen lds
    s_waitcnt vmcnt(32)
    ds_read_b64_tr_b16 a[32:33], v2 offset:8192
    ds_read_b64_tr_b16 a[34:35], v2 offset:9216
    ds_read_b64_tr_b16 a[36:37], v3 offset:8192
    ds_read_b64_tr_b16 a[38:39], v3 offset:9216
    ds_read_b64_tr_b16 a[40:41], v2 offset:10240
    ds_read_b64_tr_b16 a[42:43], v2 offset:11264
    ds_read_b64_tr_b16 a[44:45], v3 offset:10240
    ds_read_b64_tr_b16 a[46:47], v3 offset:11264
    s_waitcnt lgkmcnt(0)
    s_add_u32 m0, s21, 8192
    s_add_u32 s64, s65, 0xdc000
    buffer_load_dwordx4 v4, s[44:47], s64 offen lds
    s_add_u32 m0, s21, 9216
    s_add_u32 s64, s65, 0xe1000
    buffer_load_dwordx4 v4, s[44:47], s64 offen lds
    s_add_u32 m0, s21, 10240
    s_add_u32 s64, s65, 0xe6000
    buffer_load_dwordx4 v4, s[44:47], s64 offen lds
    s_add_u32 m0, s21, 11264
    s_add_u32 s64, s65, 0xeb000
    buffer_load_dwordx4 v4, s[44:47], s64 offen lds
    s_waitcnt vmcnt(32)
    ds_read_b64_tr_b16 a[48:49], v2 offset:12288
    ds_read_b64_tr_b16 a[50:51], v2 offset:13312
    ds_read_b64_tr_b16 a[52:53], v3 offset:12288
    ds_read_b64_tr_b16 a[54:55], v3 offset:13312
    ds_read_b64_tr_b16 a[56:57], v2 offset:14336
    ds_read_b64_tr_b16 a[58:59], v2 offset:15360
    ds_read_b64_tr_b16 a[60:61], v3 offset:14336
    ds_read_b64_tr_b16 a[62:63], v3 offset:15360
    s_waitcnt lgkmcnt(0)
    s_add_u32 m0, s21, 12288
    s_add_u32 s64, s65, 0xf0000
    buffer_load_dwordx4 v4, s[44:47], s64 offen lds
    s_add_u32 m0, s21, 13312
    s_add_u32 s64, s65, 0xf5000
    buffer_load_dwordx4 v4, s[44:47], s64 offen lds
    s_add_u32 m0, s21, 14336
    s_add_u32 s64, s65, 0xfa000
    buffer_load_dwordx4 v4, s[44:47], s64 offen lds
    s_add_u32 m0, s21, 15360
    s_add_u32 s64, s65, 0xff000
    buffer_load_dwordx4 v4, s[44:47], s64 offen lds
    s_waitcnt vmcnt(32)
    ds_read_b64_tr_b16 a[64:65], v2 offset:16384
    ds_read_b64_tr_b16 a[66:67], v2 offset:17408
    ds_read_b64_tr_b16 a[68:69], v3 offset:16384
    ds_read_b64_tr_b16 a[70:71], v3 offset:17408
    ds_read_b64_tr_b16 a[72:73], v2 offset:18432
    ds_read_b64_tr_b16 a[74:75], v2 offset:19456
    ds_read_b64_tr_b16 a[76:77], v3 offset:18432
    ds_read_b64_tr_b16 a[78:79], v3 offset:19456
    s_waitcnt lgkmcnt(0)
    s_add_u32 m0, s21, 16384
    s_add_u32 s64, s65, 0x104000
    buffer_load_dwordx4 v4, s[44:47], s64 offen lds
    s_add_u32 m0, s21, 17408
    s_add_u32 s64, s65, 0x109000
    buffer_load_dwordx4 v4, s[44:47], s64 offen lds
    s_add_u32 m0, s21, 18432
    s_add_u32 s64, s65, 0x10e000
    buffer_load_dwordx4 v4, s[44:47], s64 offen lds
    s_add_u32 m0, s21, 19456
    s_add_u32 s64, s65, 0x113000
    buffer_load_dwordx4 v4, s[44:47], s64 offen lds
    s_waitcnt vmcnt(32)
    ds_read_b64_tr_b16 a[80:81], v2 offset:20480
    ds_read_b64_tr_b16 a[82:83], v2 offset:21504
    ds_read_b64_tr_b16 a[84:85], v3 offset:20480
    ds_read_b64_tr_b16 a[86:87], v3 offset:21504
    ds_read_b64_tr_b16 a[88:89], v2 offset:22528
    ds_read_b64_tr_b16 a[90:91], v2 offset:23552
    ds_read_b64_tr_b16 a[92:93], v3 offset:22528
    ds_read_b64_tr_b16 a[94:95], v3 offset:23552
    s_waitcnt lgkmcnt(0)
    s_add_u32 m0, s21, 20480
    s_add_u32 s64, s65, 0x118000
    buffer_load_dwordx4 v4, s[44:47], s64 offen lds
    s_add_u32 m0, s21, 21504
    s_add_u32 s64, s65, 0x11d000
    buffer_load_dwordx4 v4, s[44:47], s64 offen lds
    s_add_u32 m0, s21, 22528
    s_add_u32 s64, s65, 0x122000
    buffer_load_dwordx4 v4, s[44:47], s64 offen lds
    s_add_u32 m0, s21, 23552
    s_add_u32 s64, s65, 0x127000
    buffer_load_dwordx4 v4, s[44:47], s64 offen lds
    s_waitcnt vmcnt(32)
    ds_read_b64_tr_b16 a[96:97], v2 offset:24576
    ds_read_b64_tr_b16 a[98:99], v2 offset:25600
    ds_read_b64_tr_b16 a[100:101], v3 offset:24576
    ds_read_b64_tr_b16 a[102:103], v3 offset:25600
    ds_read_b64_tr_b16 a[104:105], v2 offset:26624
    ds_read_b64_tr_b16 a[106:107], v2 offset:27648
    ds_read_b64_tr_b16 a[108:109], v3 offset:26624
    ds_read_b64_tr_b16 a[110:111], v3 offset:27648
    s_waitcnt lgkmcnt(0)
    s_add_u32 m0, s21, 24576
    s_add_u32 s64, s65, 0x12c000
    buffer_load_dwordx4 v4, s[44:47], s64 offen lds
    s_add_u32 m0, s21, 25600
    s_add_u32 s64, s65, 0x131000
    buffer_load_dwordx4 v4, s[44:47], s64 offen lds
    s_add_u32 m0, s21, 26624
    s_add_u32 s64, s65, 0x136000
    buffer_load_dwordx4 v4, s[44:47], s64 offen lds
    s_add_u32 m0, s21, 27648
    s_add_u32 s64, s65, 0x13b000
    buffer_load_dwordx4 v4, s[44:47], s64 offen lds
    s_waitcnt vmcnt(32)
    ds_read_b64_tr_b16 a[112:113], v2 offset:28672
    ds_read_b64_tr_b16 a[114:115], v2 offset:29696
    ds_read_b64_tr_b16 a[116:117], v3 offset:28672
    ds_read_b64_tr_b16 a[118:119], v3 offset:29696
    ds_read_b64_tr_b16 a[120:121], v2 offset:30720
    ds_read_b64_tr_b16 a[122:123], v2 offset:31744
    ds_read_b64_tr_b16 a[124:125], v3 offset:30720
    ds_read_b64_tr_b16 a[126:127], v3 offset:31744
    s_waitcnt lgkmcnt(0)
    s_waitcnt vmcnt(28)
    ds_read_b64_tr_b16 a[128:129], v2 offset:32768
    ds_read_b64_tr_b16 a[130:131], v2 offset:33792
    ds_read_b64_tr_b16 a[132:133], v3 offset:32768
    ds_read_b64_tr_b16 a[134:135], v3 offset:33792
    ds_read_b64_tr_b16 a[136:137], v2 offset:34816
    ds_read_b64_tr_b16 a[138:139], v2 offset:35840
    ds_read_b64_tr_b16 a[140:141], v3 offset:34816
    ds_read_b64_tr_b16 a[142:143], v3 offset:35840
    s_waitcnt lgkmcnt(0)
    s_waitcnt vmcnt(24)
    ds_read_b64_tr_b16 a[144:145], v2 offset:0
    ds_read_b64_tr_b16 a[146:147], v2 offset:1024
    ds_read_b64_tr_b16 a[148:149], v3 offset:0
    ds_read_b64_tr_b16 a[150:151], v3 offset:1024
    ds_read_b64_tr_b16 a[152:153], v2 offset:2048
    ds_read_b64_tr_b16 a[154:155], v2 offset:3072
    ds_read_b64_tr_b16 a[156:157], v3 offset:2048
    ds_read_b64_tr_b16 a[158:159], v3 offset:3072
    s_waitcnt lgkmcnt(0)
    s_waitcnt vmcnt(20)
    ds_read_b64_tr_b16 a[160:161], v2 offset:4096
    ds_read_b64_tr_b16 a[162:163], v2 offset:5120
    ds_read_b64_tr_b16 a[164:165], v3 offset:4096
    ds_read_b64_tr_b16 a[166:167], v3 offset:5120
    ds_read_b64_tr_b16 a[168:169], v2 offset:6144
    ds_read_b64_tr_b16 a[170:171], v2 offset:7168
    ds_read_b64_tr_b16 a[172:173], v3 offset:6144
    ds_read_b64_tr_b16 a[174:175], v3 offset:7168
    s_waitcnt lgkmcnt(0)
    s_waitcnt vmcnt(16)
    ds_read_b64_tr_b16 a[176:177], v2 offset:8192
    ds_read_b64_tr_b16 a[178:179], v2 offset:9216
    ds_read_b64_tr_b16 a[180:181], v3 offset:8192
    ds_read_b64_tr_b16 a[182:183], v3 offset:9216
    ds_read_b64_tr_b16 a[184:185], v2 offset:10240
    ds_read_b64_tr_b16 a[186:187], v2 offset:11264
    ds_read_b64_tr_b16 a[188:189], v3 offset:10240
    ds_read_b64_tr_b16 a[190:191], v3 offset:11264
    s_waitcnt lgkmcnt(0)
    s_waitcnt vmcnt(12)
    ds_read_b64_tr_b16 a[192:193], v2 offset:12288
    ds_read_b64_tr_b16 a[194:195], v2 offset:13312
    ds_read_b64_tr_b16 a[196:197], v3 offset:12288
    ds_read_b64_tr_b16 a[198:199], v3 offset:13312
    ds_read_b64_tr_b16 a[200:201], v2 offset:14336
    ds_read_b64_tr_b16 a[202:203], v2 offset:15360
    ds_read_b64_tr_b16 a[204:205], v3 offset:14336
    ds_read_b64_tr_b16 a[206:207], v3 offset:15360
    s_waitcnt lgkmcnt(0)
    s_waitcnt vmcnt(8)
    ds_read_b64_tr_b16 a[208:209], v2 offset:16384
    ds_read_b64_tr_b16 a[210:211], v2 offset:17408
    ds_read_b64_tr_b16 a[212:213], v3 offset:16384
    ds_read_b64_tr_b16 a[214:215], v3 offset:17408
    ds_read_b64_tr_b16 a[216:217], v2 offset:18432
    ds_read_b64_tr_b16 a[218:219], v2 offset:19456
    ds_read_b64_tr_b16 a[220:221], v3 offset:18432
    ds_read_b64_tr_b16 a[222:223], v3 offset:19456
    s_waitcnt lgkmcnt(0)
    s_waitcnt vmcnt(4)
    ds_read_b64_tr_b16 a[224:225], v2 offset:20480
    ds_read_b64_tr_b16 a[226:227], v2 offset:21504
    ds_read_b64_tr_b16 a[228:229], v3 offset:20480
    ds_read_b64_tr_b16 a[230:231], v3 offset:21504
    ds_read_b64_tr_b16 a[232:233], v2 offset:22528
    ds_read_b64_tr_b16 a[234:235], v2 offset:23552
    ds_read_b64_tr_b16 a[236:237], v3 offset:22528
    ds_read_b64_tr_b16 a[238:239], v3 offset:23552
    s_waitcnt lgkmcnt(0)
    s_waitcnt vmcnt(0)
    ds_read_b64_tr_b16 a[240:241], v2 offset:24576
    ds_read_b64_tr_b16 a[242:243], v2 offset:25600
    ds_read_b64_tr_b16 a[244:245], v3 offset:24576
    ds_read_b64_tr_b16 a[246:247], v3 offset:25600
    ds_read_b64_tr_b16 a[248:249], v2 offset:26624
    ds_read_b64_tr_b16 a[250:251], v2 offset:27648
    ds_read_b64_tr_b16 a[252:253], v3 offset:26624
    ds_read_b64_tr_b16 a[254:255], v3 offset:27648
    s_waitcnt lgkmcnt(0)
    s_barrier
    s_mov_b32 s29, 0
    v_lshlrev_b32 v1, 4, v0
    v_mov_b32 v8, 0
    s_mov_b32 s64, 0x298000
OUS_161:
    buffer_load_dword v7, v8, s[4:7], s64 offen sc1
    s_add_u32 s29, s29, 1
    s_waitcnt vmcnt(0)
    v_cmp_gt_u32 vcc, 1, v7
    s_cbranch_vccz OUSD_162
    s_cmp_gt_u32 s29, 262144
    s_cbranch_scc1 OUSD_162
    s_sleep 8
    s_branch OUS_161
OUSD_162:
    v_lshlrev_b32 v6, 2, v0
    s_mov_b32 s64, 0x5400000
    buffer_load_dword v7, v6, s[4:7], s64 offen sc1
    s_waitcnt vmcnt(0)
    v_readlane_b32 s72, v7, 0
    v_readlane_b32 s73, v7, 1
    v_readlane_b32 s74, v7, 2
    v_readlane_b32 s75, v7, 3
    v_readlane_b32 s76, v7, 4
    v_readlane_b32 s77, v7, 5
    v_readlane_b32 s78, v7, 6
    v_readlane_b32 s79, v7, 7
    s_and_b32 s64, s14, 1
    s_lshl_b32 s64, s64, 4
    v_and_b32 v6, 15, v0
    v_add_u32 v6, s64, v6
    v_mov_b32 v9, v6
    v_mul_u32_u24 v5, 1280, v6
    v_lshrrev_b32 v6, 4, v0
    v_lshl_add_u32 v5, v6, 3, v5
    s_lshr_b32 s64, s14, 1
    s_lshl_b32 s64, s64, 5
    s_lshl_b32 s65, s13, 6
    s_add_u32 s64, s64, s65
    v_add_u32 v5, s64, v5
    v_lshlrev_b32 v6, 2, v0
    s_mov_b32 s80, 0x49249249
    s_mov_b32 s81, 0x92492492
    s_lshl_b64 s[80:81], s[80:81], s12
    s_bitset0_b64 s[80:81], 63
    s_bitset0_b64 s[80:81], 62
    s_mov_b64 s[82:83], 0
    s_lshr_b32 s64, s72, 5
    s_bitset1_b64 s[82:83], s64
    s_lshr_b32 s64, s73, 5
    s_bitset1_b64 s[82:83], s64
    s_lshr_b32 s64, s74, 5
    s_bitset1_b64 s[82:83], s64
    s_lshr_b32 s64, s75, 5
    s_bitset1_b64 s[82:83], s64
    s_lshr_b32 s64, s76, 5
    s_bitset1_b64 s[82:83], s64
    s_lshr_b32 s64, s77, 5
    s_bitset1_b64 s[82:83], s64
    s_lshr_b32 s64, s78, 5
    s_bitset1_b64 s[82:83], s64
    s_lshr_b32 s64, s79, 5
    s_bitset1_b64 s[82:83], s64
OU_LOOP:
    s_cmp_eq_u64 s[80:81], 0
    s_cbranch_scc1 OU_END
    s_andn2_b64 s[84:85], s[80:81], s[82:83]
    s_cbranch_scc0 OU_WM
    s_ff1_i32_b64 s24, s[84:85]
    s_branch OU_GO
OU_WM:
    v_mov_b32 v8, 0
    s_mov_b32 s64, 0x298100
OUW_163:
    buffer_load_dword v7, v8, s[4:7], s64 offen sc1
    s_add_u32 s29, s29, 1
    s_waitcnt vmcnt(0)
    v_cmp_gt_u32 vcc, 40, v7
    s_cbranch_vccz OUWD_164
    s_cmp_gt_u32 s29, 262144
    s_cbranch_scc1 OUWD_164
    s_sleep 8
    s_branch OUW_163
OUWD_164:
    s_mov_b64 s[82:83], 0
    s_branch OU_LOOP
OU_GO:
    s_bitset0_b64 s[80:81], s24
    s_lshr_b32 s86, s14, 1
    s_mul_i32 s67, s24, 40960
    buffer_load_dwordx2 v[160:161], v5, s[48:51], s67 offen
    s_add_u32 s64, s67, 0x0
    buffer_load_dwordx2 v[162:163], v5, s[4:7], s64 offen
    s_mov_b32 s64, 0x298100
    buffer_load_dword v12, off, s[4:7], s64 sc1
    s_lshl_b32 s64, s24, 7
    s_add_u32 s64, s64, 0x296000
    s_mov_b64 exec, s[36:37]
OU_F_165:
    buffer_load_dword v7, v6, s[4:7], s64 offen sc1
    s_add_u32 s29, s29, 1
    s_waitcnt vmcnt(0)
    v_cmp_eq_u32 vcc, 0, v7
    s_cbranch_vccz OU_FD_166
    s_cmp_gt_u32 s29, 262144
    s_cbranch_scc1 OU_FD_166
    s_sleep 1
    s_branch OU_F_165
OU_FD_166:
    s_mov_b64 exec, -1
    s_lshl_b32 s25, s24, 18
    s_lshl_b32 s64, s14, 15
    s_add_u32 s25, s25, s64
    s_add_u32 s25, s25, 0x4400000
    s_add_u32 s64, s25, 0x0
    buffer_load_dwordx4 v[16:19], v1, s[4:7], s64 offen
    s_add_u32 s64, s25, 0x20000
    buffer_load_dwordx4 v[20:23], v1, s[4:7], s64 offen
    s_add_u32 s64, s25, 0x400
    buffer_load_dwordx4 v[24:27], v1, s[4:7], s64 offen
    s_add_u32 s64, s25, 0x20400
    buffer_load_dwordx4 v[28:31], v1, s[4:7], s64 offen
    s_add_u32 s64, s25, 0x800
    buffer_load_dwordx4 v[32:35], v1, s[4:7], s64 offen
    s_add_u32 s64, s25, 0x20800
    buffer_load_dwordx4 v[36:39], v1, s[4:7], s64 offen
    s_add_u32 s64, s25, 0xc00
    buffer_load_dwordx4 v[40:43], v1, s[4:7], s64 offen
    s_add_u32 s64, s25, 0x20c00
    buffer_load_dwordx4 v[44:47], v1, s[4:7], s64 offen
    s_add_u32 s64, s25, 0x1000
    buffer_load_dwordx4 v[48:51], v1, s[4:7], s64 offen
    s_add_u32 s64, s25, 0x21000
    buffer_load_dwordx4 v[52:55], v1, s[4:7], s64 offen
    s_add_u32 s64, s25, 0x1400
    buffer_load_dwordx4 v[56:59], v1, s[4:7], s64 offen
    s_add_u32 s64, s25, 0x21400
    buffer_load_dwordx4 v[60:63], v1, s[4:7], s64 offen
    s_add_u32 s64, s25, 0x1800
    buffer_load_dwordx4 v[64:67], v1, s[4:7], s64 offen
    s_add_u32 s64, s25, 0x21800
    buffer_load_dwordx4 v[68:71], v1, s[4:7], s64 offen
    s_add_u32 s64, s25, 0x1c00
    buffer_load_dwordx4 v[72:75], v1, s[4:7], s64 offen
    s_add_u32 s64, s25, 0x21c00
    buffer_load_dwordx4 v[76:79], v1, s[4:7], s64 offen
    s_add_u32 s64, s25, 0x2000
    buffer_load_dwordx4 v[80:83], v1, s[4:7], s64 offen
    s_add_u32 s64, s25, 0x22000
    buffer_load_dwordx4 v[84:87], v1, s[4:7], s64 offen
    s_add_u32 s64, s25, 0x2400
    buffer_load_dwordx4 v[88:91], v1, s[4:7], s64 offen
    s_add_u32 s64, s25, 0x22400
    buffer_load_dwordx4 v[92:95], v1, s[4:7], s64 offen
    s_add_u32 s64, s25, 0x2800
    buffer_load_dwordx4 v[96:99], v1, s[4:7], s64 offen
    s_add_u32 s64, s25, 0x22800
    buffer_load_dwordx4 v[100:103], v1, s[4:7], s64 offen
    s_add_u32 s64, s25, 0x2c00
    buffer_load_dwordx4 v[104:107], v1, s[4:7], s64 offen
    s_add_u32 s64, s25, 0x22c00
    buffer_load_dwordx4 v[108:111], v1, s[4:7], s64 offen
    s_add_u32 s64, s25, 0x3000
    buffer_load_dwordx4 v[112:115], v1, s[4:7], s64 offen
    s_add_u32 s64, s25, 0x23000
    buffer_load_dwordx4 v[116:119], v1, s[4:7], s64 offen
    s_add_u32 s64, s25, 0x3400
    buffer_load_dwordx4 v[120:123], v1, s[4:7], s64 offen
    s_add_u32 s64, s25, 0x23400
    buffer_load_dwordx4 v[124:127], v1, s[4:7], s64 offen
    s_add_u32 s64, s25, 0x3800
    buffer_load_dwordx4 v[128:131], v1, s[4:7], s64 offen
    s_add_u32 s64, s25, 0x23800
    buffer_load_dwordx4 v[132:135], v1, s[4:7], s64 offen
    s_add_u32 s64, s25, 0x3c00
    buffer_load_dwordx4 v[136:139], v1, s[4:7], s64 offen
    s_add_u32 s64, s25, 0x23c00
    buffer_load_dwordx4 v[140:143], v1, s[4:7], s64 offen
    s_waitcnt vmcnt(30)
    v_mfma_f32_16x16x32_bf16 v[144:147], a[0:3], v[16:19], 0
    v_mfma_f32_16x16x32_bf16 v[148:151], a[0:3], v[20:23], 0
    v_mfma_f32_16x16x32_bf16 v[152:155], a[4:7], v[16:19], 0
    v_mfma_f32_16x16x32_bf16 v[156:159], a[4:7], v[20:23], 0
    s_add_u32 s64, s25, 0x4000
    buffer_load_dwordx4 v[16:19], v1, s[4:7], s64 offen
    s_add_u32 s64, s25, 0x24000
    buffer_load_dwordx4 v[20:23], v1, s[4:7], s64 offen
    s_waitcnt vmcnt(30)
    v_mfma_f32_16x16x32_bf16 v[144:147], a[8:11], v[24:27], v[144:147]
    v_mfma_f32_16x16x32_bf16 v[148:151], a[8:11], v[28:31], v[148:151]
    v_mfma_f32_16x16x32_bf16 v[152:155], a[12:15], v[24:27], v[152:155]
    v_mfma_f32_16x16x32_bf16 v[156:159], a[12:15], v[28:31], v[156:159]
    s_add_u32 s64, s25, 0x4400
    buffer_load_dwordx4 v[24:27], v1, s[4:7], s64 offen
    s_add_u32 s64, s25, 0x24400
    buffer_load_dwordx4 v[28:31], v1, s[4:7], s64 offen
    s_waitcnt vmcnt(30)
    v_mfma_f32_16x16x32_bf16 v[144:147], a[16:19], v[32:35], v[144:147]
    v_mfma_f32_16x16x32_bf16 v[148:151], a[16:19], v[36:39], v[148:151]
    v_mfma_f32_16x16x32_bf16 v[152:155], a[20:23], v[32:35], v[152:155]
    v_mfma_f32_16x16x32_bf16 v[156:159], a[20:23], v[36:39], v[156:159]
    s_add_u32 s64, s25, 0x4800
    buffer_load_dwordx4 v[32:35], v1, s[4:7], s64 offen
    s_add_u32 s64, s25, 0x24800
    buffer_load_dwordx4 v[36:39], v1, s[4:7], s64 offen
    s_waitcnt vmcnt(30)
    v_mfma_f32_16x16x32_bf16 v[144:147], a[24:27], v[40:43], v[144:147]
    v_mfma_f32_16x16x32_bf16 v[148:151], a[24:27], v[44:47], v[148:151]
    v_mfma_f32_16x16x32_bf16 v[152:155], a[28:31], v[40:43], v[152:155]
    v_mfma_f32_16x16x32_bf16 v[156:159], a[28:31], v[44:47], v[156:159]
    s_add_u32 s64, s25, 0x4c00
    buffer_load_dwordx4 v[40:43], v1, s[4:7], s64 offen
    s_add_u32 s64, s25, 0x24c00
    buffer_load_dwordx4 v[44:47], v1, s[4:7], s64 offen
    s_waitcnt vmcnt(30)
    v_mfma_f32_16x16x32_bf16 v[144:147], a[32:35], v[48:51], v[144:147]
    v_mfma_f32_16x16x32_bf16 v[148:151], a[32:35], v[52:55], v[148:151]
    v_mfma_f32_16x16x32_bf16 v[152:155], a[36:39], v[48:51], v[152:155]
    v_mfma_f32_16x16x32_bf16 v[156:159], a[36:39], v[52:55], v[156:159]
    s_add_u32 s64, s25, 0x5000
    buffer_load_dwordx4 v[48:51], v1, s[4:7], s64 offen
    s_add_u32 s64, s25, 0x25000
    buffer_load_dwordx4 v[52:55], v1, s[4:7], s64 offen
    s_waitcnt vmcnt(30)
    v_mfma_f32_16x16x32_bf16 v[144:147], a[40:43], v[56:59], v[144:147]
    v_mfma_f32_16x16x32_bf16 v[148:151], a[40:43], v[60:63], v[148:151]
    v_mfma_f32_16x16x32_bf16 v[152:155], a[44:47], v[56:59], v[152:155]
    v_mfma_f32_16x16x32_bf16 v[156:159], a[44:47], v[60:63], v[156:159]
    s_add_u32 s64, s25, 0x5400
    buffer_load_dwordx4 v[56:59], v1, s[4:7], s64 offen
    s_add_u32 s64, s25, 0x25400
    buffer_load_dwordx4 v[60:63], v1, s[4:7], s64 offen
    s_waitcnt vmcnt(30)
    v_mfma_f32_16x16x32_bf16 v[144:147], a[48:51], v[64:67], v[144:147]
    v_mfma_f32_16x16x32_bf16 v[148:151], a[48:51], v[68:71], v[148:151]
    v_mfma_f32_16x16x32_bf16 v[152:155], a[52:55], v[64:67], v[152:155]
    v_mfma_f32_16x16x32_bf16 v[156:159], a[52:55], v[68:71], v[156:159]
    s_add_u32 s64, s25, 0x5800
    buffer_load_dwordx4 v[64:67], v1, s[4:7], s64 offen
    s_add_u32 s64, s25, 0x25800
    buffer_load_dwordx4 v[68:71], v1, s[4:7], s64 offen
    s_waitcnt vmcnt(30)
    v_mfma_f32_16x16x32_bf16 v[144:147], a[56:59], v[72:75], v[144:147]
    v_mfma_f32_16x16x32_bf16 v[148:151], a[56:59], v[76:79], v[148:151]
    v_mfma_f32_16x16x32_bf16 v[152:155], a[60:63], v[72:75], v[152:155]
    v_mfma_f32_16x16x32_bf16 v[156:159], a[60:63], v[76:79], v[156:159]
    s_add_u32 s64, s25, 0x5c00
    buffer_load_dwordx4 v[72:75], v1, s[4:7], s64 offen
    s_add_u32 s64, s25, 0x25c00
    buffer_load_dwordx4 v[76:79], v1, s[4:7], s64 offen
    s_waitcnt vmcnt(30)
    v_mfma_f32_16x16x32_bf16 v[144:147], a[64:67], v[80:83], v[144:147]
    v_mfma_f32_16x16x32_bf16 v[148:151], a[64:67], v[84:87], v[148:151]
    v_mfma_f32_16x16x32_bf16 v[152:155], a[68:71], v[80:83], v[152:155]
    v_mfma_f32_16x16x32_bf16 v[156:159], a[68:71], v[84:87], v[156:159]
    s_add_u32 s64, s25, 0x6000
    buffer_load_dwordx4 v[80:83], v1, s[4:7], s64 offen
    s_add_u32 s64, s25, 0x26000
    buffer_load_dwordx4 v[84:87], v1, s[4:7], s64 offen
    s_waitcnt vmcnt(30)
    v_mfma_f32_16x16x32_bf16 v[144:147], a[72:75], v[88:91], v[144:147]
    v_mfma_f32_16x16x32_bf16 v[148:151], a[72:75], v[92:95], v[148:151]
    v_mfma_f32_16x16x32_bf16 v[152:155], a[76:79], v[88:91], v[152:155]
    v_mfma_f32_16x16x32_bf16 v[156:159], a[76:79], v[92:95], v[156:159]
    s_add_u32 s64, s25, 0x6400
    buffer_load_dwordx4 v[88:91], v1, s[4:7], s64 offen
    s_add_u32 s64, s25, 0x26400
    buffer_load_dwordx4 v[92:95], v1, s[4:7], s64 offen
    s_waitcnt vmcnt(30)
    v_mfma_f32_16x16x32_bf16 v[144:147], a[80:83], v[96:99], v[144:147]
    v_mfma_f32_16x16x32_bf16 v[148:151], a[80:83], v[100:103], v[148:151]
    v_mfma_f32_16x16x32_bf16 v[152:155], a[84:87], v[96:99], v[152:155]
    v_mfma_f32_16x16x32_bf16 v[156:159], a[84:87], v[100:103], v[156:159]
    s_add_u32 s64, s25, 0x6800
    buffer_load_dwordx4 v[96:99], v1, s[4:7], s64 offen
    s_add_u32 s64, s25, 0x26800
    buffer_load_dwordx4 v[100:103], v1, s[4:7], s64 offen
    s_waitcnt vmcnt(30)
    v_mfma_f32_16x16x32_bf16 v[144:147], a[88:91], v[104:107], v[144:147]
    v_mfma_f32_16x16x32_bf16 v[148:151], a[88:91], v[108:111], v[148:151]
    v_mfma_f32_16x16x32_bf16 v[152:155], a[92:95], v[104:107], v[152:155]
    v_mfma_f32_16x16x32_bf16 v[156:159], a[92:95], v[108:111], v[156:159]
    s_add_u32 s64, s25, 0x6c00
    buffer_load_dwordx4 v[104:107], v1, s[4:7], s64 offen
    s_add_u32 s64, s25, 0x26c00
    buffer_load_dwordx4 v[108:111], v1, s[4:7], s64 offen
    s_waitcnt vmcnt(30)
    v_mfma_f32_16x16x32_bf16 v[144:147], a[96:99], v[112:115], v[144:147]
    v_mfma_f32_16x16x32_bf16 v[148:151], a[96:99], v[116:119], v[148:151]
    v_mfma_f32_16x16x32_bf16 v[152:155], a[100:103], v[112:115], v[152:155]
    v_mfma_f32_16x16x32_bf16 v[156:159], a[100:103], v[116:119], v[156:159]
    s_add_u32 s64, s25, 0x7000
    buffer_load_dwordx4 v[112:115], v1, s[4:7], s64 offen
    s_add_u32 s64, s25, 0x27000
    buffer_load_dwordx4 v[116:119], v1, s[4:7], s64 offen
    s_waitcnt vmcnt(30)
    v_mfma_f32_16x16x32_bf16 v[144:147], a[104:107], v[120:123], v[144:147]
    v_mfma_f32_16x16x32_bf16 v[148:151], a[104:107], v[124:127], v[148:151]
    v_mfma_f32_16x16x32_bf16 v[152:155], a[108:111], v[120:123], v[152:155]
    v_mfma_f32_16x16x32_bf16 v[156:159], a[108:111], v[124:127], v[156:159]
    s_add_u32 s64, s25, 0x7400
    buffer_load_dwordx4 v[120:123], v1, s[4:7], s64 offen
    s_add_u32 s64, s25, 0x27400
    buffer_load_dwordx4 v[124:127], v1, s[4:7], s64 offen
    s_waitcnt vmcnt(30)
    v_mfma_f32_16x16x32_bf16 v[144:147], a[112:115], v[128:131], v[144:147]
    v_mfma_f32_16x16x32_bf16 v[148:151], a[112:115], v[132:135], v[148:151]
    v_mfma_f32_16x16x32_bf16 v[152:155], a[116:119], v[128:131], v[152:155]
    v_mfma_f32_16x16x32_bf16 v[156:159], a[116:119], v[132:135], v[156:159]
    s_add_u32 s64, s25, 0x7800
    buffer_load_dwordx4 v[128:131], v1, s[4:7], s64 offen
    s_add_u32 s64, s25, 0x27800
    buffer_load_dwordx4 v[132:135], v1, s[4:7], s64 offen
    s_waitcnt vmcnt(30)
    v_mfma_f32_16x16x32_bf16 v[144:147], a[120:123], v[136:139], v[144:147]
    v_mfma_f32_16x16x32_bf16 v[148:151], a[120:123], v[140:143], v[148:151]
    v_mfma_f32_16x16x32_bf16 v[152:155], a[124:127], v[136:139], v[152:155]
    v_mfma_f32_16x16x32_bf16 v[156:159], a[124:127], v[140:143], v[156:159]
    s_add_u32 s64, s25, 0x7c00
    buffer_load_dwordx4 v[136:139], v1, s[4:7], s64 offen
    s_add_u32 s64, s25, 0x27c00
    buffer_load_dwordx4 v[140:143], v1, s[4:7], s64 offen
    s_waitcnt vmcnt(30)
    v_mfma_f32_16x16x32_bf16 v[144:147], a[128:131], v[16:19], v[144:147]
    v_mfma_f32_16x16x32_bf16 v[148:151], a[128:131], v[20:23], v[148:151]
    v_mfma_f32_16x16x32_bf16 v[152:155], a[132:135], v[16:19], v[152:155]
    v_mfma_f32_16x16x32_bf16 v[156:159], a[132:135], v[20:23], v[156:159]
    s_waitcnt vmcnt(28)
    v_mfma_f32_16x16x32_bf16 v[144:147], a[136:139], v[24:27], v[144:147]
    v_mfma_f32_16x16x32_bf16 v[148:151], a[136:139], v[28:31], v[148:151]
    v_mfma_f32_16x16x32_bf16 v[152:155], a[140:143], v[24:27], v[152:155]
    v_mfma_f32_16x16x32_bf16 v[156:159], a[140:143], v[28:31], v[156:159]
    s_waitcnt vmcnt(26)
    v_mfma_f32_16x16x32_bf16 v[144:147], a[144:147], v[32:35], v[144:147]
    v_mfma_f32_16x16x32_bf16 v[148:151], a[144:147], v[36:39], v[148:151]
    v_mfma_f32_16x16x32_bf16 v[152:155], a[148:151], v[32:35], v[152:155]
    v_mfma_f32_16x16x32_bf16 v[156:159], a[148:151], v[36:39], v[156:159]
    s_waitcnt vmcnt(24)
    v_mfma_f32_16x16x32_bf16 v[144:147], a[152:155], v[40:43], v[144:147]
    v_mfma_f32_16x16x32_bf16 v[148:151], a[152:155], v[44:47], v[148:151]
    v_mfma_f32_16x16x32_bf16 v[152:155], a[156:159], v[40:43], v[152:155]
    v_mfma_f32_16x16x32_bf16 v[156:159], a[156:159], v[44:47], v[156:159]
    s_waitcnt vmcnt(22)
    v_mfma_f32_16x16x32_bf16 v[144:147], a[160:163], v[48:51], v[144:147]
    v_mfma_f32_16x16x32_bf16 v[148:151], a[160:163], v[52:55], v[148:151]
    v_mfma_f32_16x16x32_bf16 v[152:155], a[164:167], v[48:51], v[152:155]
    v_mfma_f32_16x16x32_bf16 v[156:159], a[164:167], v[52:55], v[156:159]
    s_waitcnt vmcnt(20)
    v_mfma_f32_16x16x32_bf16 v[144:147], a[168:171], v[56:59], v[144:147]
    v_mfma_f32_16x16x32_bf16 v[148:151], a[168:171], v[60:63], v[148:151]
    v_mfma_f32_16x16x32_bf16 v[152:155], a[172:175], v[56:59], v[152:155]
    v_mfma_f32_16x16x32_bf16 v[156:159], a[172:175], v[60:63], v[156:159]
    s_waitcnt vmcnt(18)
    v_mfma_f32_16x16x32_bf16 v[144:147], a[176:179], v[64:67], v[144:147]
    v_mfma_f32_16x16x32_bf16 v[148:151], a[176:179], v[68:71], v[148:151]
    v_mfma_f32_16x16x32_bf16 v[152:155], a[180:183], v[64:67], v[152:155]
    v_mfma_f32_16x16x32_bf16 v[156:159], a[180:183], v[68:71], v[156:159]
    s_waitcnt vmcnt(16)
    v_mfma_f32_16x16x32_bf16 v[144:147], a[184:187], v[72:75], v[144:147]
    v_mfma_f32_16x16x32_bf16 v[148:151], a[184:187], v[76:79], v[148:151]
    v_mfma_f32_16x16x32_bf16 v[152:155], a[188:191], v[72:75], v[152:155]
    v_mfma_f32_16x16x32_bf16 v[156:159], a[188:191], v[76:79], v[156:159]
    s_waitcnt vmcnt(14)
    v_mfma_f32_16x16x32_bf16 v[144:147], a[192:195], v[80:83], v[144:147]
    v_mfma_f32_16x16x32_bf16 v[148:151], a[192:195], v[84:87], v[148:151]
    v_mfma_f32_16x16x32_bf16 v[152:155], a[196:199], v[80:83], v[152:155]
    v_mfma_f32_16x16x32_bf16 v[156:159], a[196:199], v[84:87], v[156:159]
    s_waitcnt vmcnt(12)
    v_mfma_f32_16x16x32_bf16 v[144:147], a[200:203], v[88:91], v[144:147]
    v_mfma_f32_16x16x32_bf16 v[148:151], a[200:203], v[92:95], v[148:151]
    v_mfma_f32_16x16x32_bf16 v[152:155], a[204:207], v[88:91], v[152:155]
    v_mfma_f32_16x16x32_bf16 v[156:159], a[204:207], v[92:95], v[156:159]
    s_waitcnt vmcnt(10)
    v_mfma_f32_16x16x32_bf16 v[144:147], a[208:211], v[96:99], v[144:147]
    v_mfma_f32_16x16x32_bf16 v[148:151], a[208:211], v[100:103], v[148:151]
    v_mfma_f32_16x16x32_bf16 v[152:155], a[212:215], v[96:99], v[152:155]
    v_mfma_f32_16x16x32_bf16 v[156:159], a[212:215], v[100:103], v[156:159]
    s_waitcnt vmcnt(8)
    v_mfma_f32_16x16x32_bf16 v[144:147], a[216:219], v[104:107], v[144:147]
    v_mfma_f32_16x16x32_bf16 v[148:151], a[216:219], v[108:111], v[148:151]
    v_mfma_f32_16x16x32_bf16 v[152:155], a[220:223], v[104:107], v[152:155]
    v_mfma_f32_16x16x32_bf16 v[156:159], a[220:223], v[108:111], v[156:159]
    s_waitcnt vmcnt(6)
    v_mfma_f32_16x16x32_bf16 v[144:147], a[224:227], v[112:115], v[144:147]
    v_mfma_f32_16x16x32_bf16 v[148:151], a[224:227], v[116:119], v[148:151]
    v_mfma_f32_16x16x32_bf16 v[152:155], a[228:231], v[112:115], v[152:155]
    v_mfma_f32_16x16x32_bf16 v[156:159], a[228:231], v[116:119], v[156:159]
    s_waitcnt vmcnt(4)
    v_mfma_f32_16x16x32_bf16 v[144:147], a[232:235], v[120:123], v[144:147]
    v_mfma_f32_16x16x32_bf16 v[148:151], a[232:235], v[124:127], v[148:151]
    v_mfma_f32_16x16x32_bf16 v[152:155], a[236:239], v[120:123], v[152:155]
    v_mfma_f32_16x16x32_bf16 v[156:159], a[236:239], v[124:127], v[156:159]
    s_waitcnt vmcnt(2)
    v_mfma_f32_16x16x32_bf16 v[144:147], a[240:243], v[128:131], v[144:147]
    v_mfma_f32_16x16x32_bf16 v[148:151], a[240:243], v[132:135], v[148:151]
    v_mfma_f32_16x16x32_bf16 v[152:155], a[244:247], v[128:131], v[152:155]
    v_mfma_f32_16x16x32_bf16 v[156:159], a[244:247], v[132:135], v[156:159]
    s_waitcnt vmcnt(0)
    v_mfma_f32_16x16x32_bf16 v[144:147], a[248:251], v[136:139], v[144:147]
    v_mfma_f32_16x16x32_bf16 v[148:151], a[248:251], v[140:143], v[148:151]
    v_mfma_f32_16x16x32_bf16 v[152:155], a[252:255], v[136:139], v[152:155]
    v_mfma_f32_16x16x32_bf16 v[156:159], a[252:255], v[140:143], v[156:159]
    s_lshl_b32 s64, s14, 12
    v_add_u32 v7, s64, v1
    s_barrier
    s_nop 3
    ds_write_b128 v7, v[144:147] offset:0
    ds_write_b128 v7, v[148:151] offset:1024
    ds_write_b128 v7, v[152:155] offset:2048
    ds_write_b128 v7, v[156:159] offset:3072
    v_mov_b32 v13, 16384
    s_cmp_lg_u32 s14, 0
    s_cbranch_scc1 OW0_167
    ds_write_b32 v13, v12
OW0_167:
    s_waitcnt lgkmcnt(0)
    s_barrier
    ds_read_b32 v12, v13
    s_waitcnt lgkmcnt(0)
    v_readfirstlane_b32 s64, v12
    s_cmp_lt_u32 s64, 40
    s_cselect_b64 s[82:83], s[82:83], 0
    s_lshl_b32 s64, s14, 10
    v_add_u32 v7, s64, v1
    ds_read_b128 v[16:19], v7 offset:0
    ds_read_b128 v[20:23], v7 offset:4096
    ds_read_b128 v[24:27], v7 offset:8192
    ds_read_b128 v[28:31], v7 offset:12288
    s_waitcnt lgkmcnt(0)
    v_add_f32 v16, v16, v20
    v_add_f32 v24, v24, v28
    v_add_f32 v16, v16, v24
    v_add_f32 v17, v17, v21
    v_add_f32 v25, v25, v29
    v_add_f32 v17, v17, v25
    v_add_f32 v18, v18, v22
    v_add_f32 v26, v26, v30
    v_add_f32 v18, v18, v26
    v_add_f32 v19, v19, v23
    v_add_f32 v27, v27, v31
    v_add_f32 v19, v19, v27
    v_cvt_pk_bf16_f32 v16, v16, v16
    v_lshlrev_b32 v16, 16, v16
    v_cvt_pk_bf16_f32 v17, v17, v17
    v_lshlrev_b32 v17, 16, v17
    v_cvt_pk_bf16_f32 v18, v18, v18
    v_lshlrev_b32 v18, 16, v18
    v_cvt_pk_bf16_f32 v19, v19, v19
    v_lshlrev_b32 v19, 16, v19
    v_lshlrev_b32 v20, 16, v162
    v_and_b32 v21, 0xffff0000, v162
    v_lshlrev_b32 v24, 16, v160
    v_and_b32 v25, 0xffff0000, v160
    v_lshlrev_b32 v22, 16, v163
    v_and_b32 v23, 0xffff0000, v163
    v_lshlrev_b32 v26, 16, v161
    v_and_b32 v27, 0xffff0000, v161
    s_lshl_b32 s64, s24, 5
    v_add_u32 v8, s64, v9
    v_mov_b32 v10, -1
    v_cmp_eq_u32 vcc, s72, v8
    s_nop 1
    v_cndmask_b32 v10, v10, 0, vcc
    v_cmp_eq_u32 vcc, s73, v8
    s_nop 1
    v_cndmask_b32 v10, v10, 1, vcc
    v_cmp_eq_u32 vcc, s74, v8
    s_nop 1
    v_cndmask_b32 v10, v10, 2, vcc
    v_cmp_eq_u32 vcc, s75, v8
    s_nop 1
    v_cndmask_b32 v10, v10, 3, vcc
    v_cmp_eq_u32 vcc, s76, v8
    s_nop 1
    v_cndmask_b32 v10, v10, 4, vcc
    v_cmp_eq_u32 vcc, s77, v8
    s_nop 1
    v_cndmask_b32 v10, v10, 5, vcc
    v_cmp_eq_u32 vcc, s78, v8
    s_nop 1
    v_cndmask_b32 v10, v10, 6, vcc
    v_cmp_eq_u32 vcc, s79, v8
    s_nop 1
    v_cndmask_b32 v10, v10, 7, vcc
    v_cmp_le_i32 vcc, 0, v10
    s_and_saveexec_b64 s[68:69], vcc
    s_cbranch_execz NOUPD_169
    v_mul_u32_u24 v10, 2560, v10
    v_lshrrev_b32 v11, 4, v0
    v_lshl_add_u32 v10, v11, 4, v10
    s_lshl_b32 s64, s86, 6
    s_lshl_b32 s65, s13, 7
    s_add_u32 s64, s64, s65
    s_add_u32 s64, s64, 0x5410000
    buffer_load_dwordx4 v[164:167], v10, s[4:7], s64 offen sc1
    s_waitcnt vmcnt(0)
    v_add_f32 v20, v20, v164
    v_cvt_pk_bf16_f32 v20, v20, v20
    v_lshlrev_b32 v20, 16, v20
    v_add_f32 v21, v21, v165
    v_cvt_pk_bf16_f32 v21, v21, v21
    v_lshlrev_b32 v21, 16, v21
    v_add_f32 v22, v22, v166
    v_cvt_pk_bf16_f32 v22, v22, v22
    v_lshlrev_b32 v22, 16, v22
    v_add_f32 v23, v23, v167
    v_cvt_pk_bf16_f32 v23, v23, v23
    v_lshlrev_b32 v23, 16, v23
NOUPD_169:
    s_mov_b64 exec, -1
    v_mul_f32 v28, 0xbfb8aa3b, v20
    v_exp_f32 v28, v28
    s_nop 0
    v_add_f32 v28, 1.0, v28
    v_rcp_f32 v28, v28
    s_nop 0
    v_mul_f32 v28, v28, v20
    v_cvt_pk_bf16_f32 v28, v28, v28
    v_lshlrev_b32 v28, 16, v28
    v_mul_f32 v28, v28, v16
    v_cvt_pk_bf16_f32 v28, v28, v28
    v_lshlrev_b32 v28, 16, v28
    v_add_f32 v28, v28, v24
    v_mul_f32 v29, 0xbfb8aa3b, v21
    v_exp_f32 v29, v29
    s_nop 0
    v_add_f32 v29, 1.0, v29
    v_rcp_f32 v29, v29
    s_nop 0
    v_mul_f32 v29, v29, v21
    v_cvt_pk_bf16_f32 v29, v29, v29
    v_lshlrev_b32 v29, 16, v29
    v_mul_f32 v29, v29, v17
    v_cvt_pk_bf16_f32 v29, v29, v29
    v_lshlrev_b32 v29, 16, v29
    v_add_f32 v29, v29, v25
    v_mul_f32 v30, 0xbfb8aa3b, v22
    v_exp_f32 v30, v30
    s_nop 0
    v_add_f32 v30, 1.0, v30
    v_rcp_f32 v30, v30
    s_nop 0
    v_mul_f32 v30, v30, v22
    v_cvt_pk_bf16_f32 v30, v30, v30
    v_lshlrev_b32 v30, 16, v30
    v_mul_f32 v30, v30, v18
    v_cvt_pk_bf16_f32 v30, v30, v30
    v_lshlrev_b32 v30, 16, v30
    v_add_f32 v30, v30, v26
    v_mul_f32 v31, 0xbfb8aa3b, v23
    v_exp_f32 v31, v31
    s_nop 0
    v_add_f32 v31, 1.0, v31
    v_rcp_f32 v31, v31
    s_nop 0
    v_mul_f32 v31, v31, v23
    v_cvt_pk_bf16_f32 v31, v31, v31
    v_lshlrev_b32 v31, 16, v31
    v_mul_f32 v31, v31, v19
    v_cvt_pk_bf16_f32 v31, v31, v31
    v_lshlrev_b32 v31, 16, v31
    v_add_f32 v31, v31, v27
    v_cvt_pk_bf16_f32 v164, v28, v29
    v_cvt_pk_bf16_f32 v165, v30, v31
    buffer_store_dwordx2 v[164:165], v5, s[52:55], s67 offen
OTD_168:
    s_branch OU_LOOP
OU_END:
    s_cmp_lg_u32 s12, 2
    s_cbranch_scc1 OU_X
    v_mov_b32 v8, 0
    s_mov_b32 s64, 0x298100
OUW_170:
    buffer_load_dword v7, v8, s[4:7], s64 offen sc1
    s_add_u32 s29, s29, 1
    s_waitcnt vmcnt(0)
    v_cmp_gt_u32 vcc, 40, v7
    s_cbranch_vccz OUWD_171
    s_cmp_gt_u32 s29, 262144
    s_cbranch_scc1 OUWD_171
    s_sleep 8
    s_branch OUW_170
OUWD_171:
    s_mov_b32 s24, 62
    s_mov_b32 s87, 0
    s_and_b32 s86, s14, 1
    s_lshl_b32 s64, s87, 4
    v_and_b32 v6, 15, v0
    v_add_u32 v6, s64, v6
    v_mov_b32 v9, v6
    v_mul_u32_u24 v5, 1280, v6
    v_lshrrev_b32 v6, 4, v0
    v_lshl_add_u32 v5, v6, 3, v5
    s_and_b32 s64, s14, 1
    s_lshl_b32 s64, s64, 5
    s_lshl_b32 s65, s13, 6
    s_add_u32 s64, s64, s65
    v_add_u32 v5, s64, v5
    v_lshlrev_b32 v6, 2, v0
    s_mul_i32 s67, s24, 40960
    buffer_load_dwordx2 v[160:161], v5, s[48:51], s67 offen
    s_add_u32 s64, s67, 0x0
    buffer_load_dwordx2 v[162:163], v5, s[4:7], s64 offen
    s_lshl_b32 s64, s24, 7
    s_add_u32 s64, s64, 0x296000
    s_mov_b64 exec, s[36:37]
OUH_F_172:
    buffer_load_dword v7, v6, s[4:7], s64 offen sc1
    s_add_u32 s29, s29, 1
    s_waitcnt vmcnt(0)
    v_cmp_eq_u32 vcc, 0, v7
    s_cbranch_vccz OUH_FD_173
    s_cmp_gt_u32 s29, 262144
    s_cbranch_scc1 OUH_FD_173
    s_sleep 1
    s_branch OUH_F_172
OUH_FD_173:
    s_mov_b64 exec, -1
    s_lshl_b32 s25, s24, 18
    s_lshl_b32 s64, s14, 15
    s_add_u32 s25, s25, s64
    s_add_u32 s25, s25, 0x4400000
    s_lshl_b32 s64, s87, 17
    s_add_u32 s25, s25, s64
    s_add_u32 s64, s25, 0x0
    buffer_load_dwordx4 v[16:19], v1, s[4:7], s64 offen
    s_add_u32 s64, s25, 0x400
    buffer_load_dwordx4 v[20:23], v1, s[4:7], s64 offen
    s_add_u32 s64, s25, 0x800
    buffer_load_dwordx4 v[24:27], v1, s[4:7], s64 offen
    s_add_u32 s64, s25, 0xc00
    buffer_load_dwordx4 v[28:31], v1, s[4:7], s64 offen
    s_add_u32 s64, s25, 0x1000
    buffer_load_dwordx4 v[32:35], v1, s[4:7], s64 offen
    s_add_u32 s64, s25, 0x1400
    buffer_load_dwordx4 v[36:39], v1, s[4:7], s64 offen
    s_add_u32 s64, s25, 0x1800
    buffer_load_dwordx4 v[40:43], v1, s[4:7], s64 offen
    s_add_u32 s64, s25, 0x1c00
    buffer_load_dwordx4 v[44:47], v1, s[4:7], s64 offen
    s_add_u32 s64, s25, 0x2000
    buffer_load_dwordx4 v[48:51], v1, s[4:7], s64 offen
    s_add_u32 s64, s25, 0x2400
    buffer_load_dwordx4 v[52:55], v1, s[4:7], s64 offen
    s_add_u32 s64, s25, 0x2800
    buffer_load_dwordx4 v[56:59], v1, s[4:7], s64 offen
    s_add_u32 s64, s25, 0x2c00
    buffer_load_dwordx4 v[60:63], v1, s[4:7], s64 offen
    s_add_u32 s64, s25, 0x3000
    buffer_load_dwordx4 v[64:67], v1, s[4:7], s64 offen
    s_add_u32 s64, s25, 0x3400
    buffer_load_dwordx4 v[68:71], v1, s[4:7], s64 offen
    s_add_u32 s64, s25, 0x3800
    buffer_load_dwordx4 v[72:75], v1, s[4:7], s64 offen
    s_add_u32 s64, s25, 0x3c00
    buffer_load_dwordx4 v[76:79], v1, s[4:7], s64 offen
    s_add_u32 s64, s25, 0x4000
    buffer_load_dwordx4 v[80:83], v1, s[4:7], s64 offen
    s_add_u32 s64, s25, 0x4400
    buffer_load_dwordx4 v[84:87], v1, s[4:7], s64 offen
    s_add_u32 s64, s25, 0x4800
    buffer_load_dwordx4 v[88:91], v1, s[4:7], s64 offen
    s_add_u32 s64, s25, 0x4c00
    buffer_load_dwordx4 v[92:95], v1, s[4:7], s64 offen
    s_add_u32 s64, s25, 0x5000
    buffer_load_dwordx4 v[96:99], v1, s[4:7], s64 offen
    s_add_u32 s64, s25, 0x5400
    buffer_load_dwordx4 v[100:103], v1, s[4:7], s64 offen
    s_add_u32 s64, s25, 0x5800
    buffer_load_dwordx4 v[104:107], v1, s[4:7], s64 offen
    s_add_u32 s64, s25, 0x5c00
    buffer_load_dwordx4 v[108:111], v1, s[4:7], s64 offen
    s_add_u32 s64, s25, 0x6000
    buffer_load_dwordx4 v[112:115], v1, s[4:7], s64 offen
    s_add_u32 s64, s25, 0x6400
    buffer_load_dwordx4 v[116:119], v1, s[4:7], s64 offen
    s_add_u32 s64, s25, 0x6800
    buffer_load_dwordx4 v[120:123], v1, s[4:7], s64 offen
    s_add_u32 s64, s25, 0x6c00
    buffer_load_dwordx4 v[124:127], v1, s[4:7], s64 offen
    s_add_u32 s64, s25, 0x7000
    buffer_load_dwordx4 v[128:131], v1, s[4:7], s64 offen
    s_add_u32 s64, s25, 0x7400
    buffer_load_dwordx4 v[132:135], v1, s[4:7], s64 offen
    s_add_u32 s64, s25, 0x7800
    buffer_load_dwordx4 v[136:139], v1, s[4:7], s64 offen
    s_add_u32 s64, s25, 0x7c00
    buffer_load_dwordx4 v[140:143], v1, s[4:7], s64 offen
    s_waitcnt vmcnt(31)
    v_mfma_f32_16x16x32_bf16 v[144:147], a[0:3], v[16:19], 0
    v_mfma_f32_16x16x32_bf16 v[148:151], a[4:7], v[16:19], 0
    s_waitcnt vmcnt(30)
    v_mfma_f32_16x16x32_bf16 v[144:147], a[8:11], v[20:23], v[144:147]
    v_mfma_f32_16x16x32_bf16 v[148:151], a[12:15], v[20:23], v[148:151]
    s_waitcnt vmcnt(29)
    v_mfma_f32_16x16x32_bf16 v[144:147], a[16:19], v[24:27], v[144:147]
    v_mfma_f32_16x16x32_bf16 v[148:151], a[20:23], v[24:27], v[148:151]
    s_waitcnt vmcnt(28)
    v_mfma_f32_16x16x32_bf16 v[144:147], a[24:27], v[28:31], v[144:147]
    v_mfma_f32_16x16x32_bf16 v[148:151], a[28:31], v[28:31], v[148:151]
    s_waitcnt vmcnt(27)
    v_mfma_f32_16x16x32_bf16 v[144:147], a[32:35], v[32:35], v[144:147]
    v_mfma_f32_16x16x32_bf16 v[148:151], a[36:39], v[32:35], v[148:151]
    s_waitcnt vmcnt(26)
    v_mfma_f32_16x16x32_bf16 v[144:147], a[40:43], v[36:39], v[144:147]
    v_mfma_f32_16x16x32_bf16 v[148:151], a[44:47], v[36:39], v[148:151]
    s_waitcnt vmcnt(25)
    v_mfma_f32_16x16x32_bf16 v[144:147], a[48:51], v[40:43], v[144:147]
    v_mfma_f32_16x16x32_bf16 v[148:151], a[52:55], v[40:43], v[148:151]
    s_waitcnt vmcnt(24)
    v_mfma_f32_16x16x32_bf16 v[144:147], a[56:59], v[44:47], v[144:147]
    v_mfma_f32_16x16x32_bf16 v[148:151], a[60:63], v[44:47], v[148:151]
    s_waitcnt vmcnt(23)
    v_mfma_f32_16x16x32_bf16 v[144:147], a[64:67], v[48:51], v[144:147]
    v_mfma_f32_16x16x32_bf16 v[148:151], a[68:71], v[48:51], v[148:151]
    s_waitcnt vmcnt(22)
    v_mfma_f32_16x16x32_bf16 v[144:147], a[72:75], v[52:55], v[144:147]
    v_mfma_f32_16x16x32_bf16 v[148:151], a[76:79], v[52:55], v[148:151]
    s_waitcnt vmcnt(21)
    v_mfma_f32_16x16x32_bf16 v[144:147], a[80:83], v[56:59], v[144:147]
    v_mfma_f32_16x16x32_bf16 v[148:151], a[84:87], v[56:59], v[148:151]
    s_waitcnt vmcnt(20)
    v_mfma_f32_16x16x32_bf16 v[144:147], a[88:91], v[60:63], v[144:147]
    v_mfma_f32_16x16x32_bf16 v[148:151], a[92:95], v[60:63], v[148:151]
    s_waitcnt vmcnt(19)
    v_mfma_f32_16x16x32_bf16 v[144:147], a[96:99], v[64:67], v[144:147]
    v_mfma_f32_16x16x32_bf16 v[148:151], a[100:103], v[64:67], v[148:151]
    s_waitcnt vmcnt(18)
    v_mfma_f32_16x16x32_bf16 v[144:147], a[104:107], v[68:71], v[144:147]
    v_mfma_f32_16x16x32_bf16 v[148:151], a[108:111], v[68:71], v[148:151]
    s_waitcnt vmcnt(17)
    v_mfma_f32_16x16x32_bf16 v[144:147], a[112:115], v[72:75], v[144:147]
    v_mfma_f32_16x16x32_bf16 v[148:151], a[116:119], v[72:75], v[148:151]
    s_waitcnt vmcnt(16)
    v_mfma_f32_16x16x32_bf16 v[144:147], a[120:123], v[76:79], v[144:147]
    v_mfma_f32_16x16x32_bf16 v[148:151], a[124:127], v[76:79], v[148:151]
    s_waitcnt vmcnt(15)
    v_mfma_f32_16x16x32_bf16 v[144:147], a[128:131], v[80:83], v[144:147]
    v_mfma_f32_16x16x32_bf16 v[148:151], a[132:135], v[80:83], v[148:151]
    s_waitcnt vmcnt(14)
    v_mfma_f32_16x16x32_bf16 v[144:147], a[136:139], v[84:87], v[144:147]
    v_mfma_f32_16x16x32_bf16 v[148:151], a[140:143], v[84:87], v[148:151]
    s_waitcnt vmcnt(13)
    v_mfma_f32_16x16x32_bf16 v[144:147], a[144:147], v[88:91], v[144:147]
    v_mfma_f32_16x16x32_bf16 v[148:151], a[148:151], v[88:91], v[148:151]
    s_waitcnt vmcnt(12)
    v_mfma_f32_16x16x32_bf16 v[144:147], a[152:155], v[92:95], v[144:147]
    v_mfma_f32_16x16x32_bf16 v[148:151], a[156:159], v[92:95], v[148:151]
    s_waitcnt vmcnt(11)
    v_mfma_f32_16x16x32_bf16 v[144:147], a[160:163], v[96:99], v[144:147]
    v_mfma_f32_16x16x32_bf16 v[148:151], a[164:167], v[96:99], v[148:151]
    s_waitcnt vmcnt(10)
    v_mfma_f32_16x16x32_bf16 v[144:147], a[168:171], v[100:103], v[144:147]
    v_mfma_f32_16x16x32_bf16 v[148:151], a[172:175], v[100:103], v[148:151]
    s_waitcnt vmcnt(9)
    v_mfma_f32_16x16x32_bf16 v[144:147], a[176:179], v[104:107], v[144:147]
    v_mfma_f32_16x16x32_bf16 v[148:151], a[180:183], v[104:107], v[148:151]
    s_waitcnt vmcnt(8)
    v_mfma_f32_16x16x32_bf16 v[144:147], a[184:187], v[108:111], v[144:147]
    v_mfma_f32_16x16x32_bf16 v[148:151], a[188:191], v[108:111], v[148:151]
    s_waitcnt vmcnt(7)
    v_mfma_f32_16x16x32_bf16 v[144:147], a[192:195], v[112:115], v[144:147]
    v_mfma_f32_16x16x32_bf16 v[148:151], a[196:199], v[112:115], v[148:151]
    s_waitcnt vmcnt(6)
    v_mfma_f32_16x16x32_bf16 v[144:147], a[200:203], v[116:119], v[144:147]
    v_mfma_f32_16x16x32_bf16 v[148:151], a[204:207], v[116:119], v[148:151]
    s_waitcnt vmcnt(5)
    v_mfma_f32_16x16x32_bf16 v[144:147], a[208:211], v[120:123], v[144:147]
    v_mfma_f32_16x16x32_bf16 v[148:151], a[212:215], v[120:123], v[148:151]
    s_waitcnt vmcnt(4)
    v_mfma_f32_16x16x32_bf16 v[144:147], a[216:219], v[124:127], v[144:147]
    v_mfma_f32_16x16x32_bf16 v[148:151], a[220:223], v[124:127], v[148:151]
    s_waitcnt vmcnt(3)
    v_mfma_f32_16x16x32_bf16 v[144:147], a[224:227], v[128:131], v[144:147]
    v_mfma_f32_16x16x32_bf16 v[148:151], a[228:231], v[128:131], v[148:151]
    s_waitcnt vmcnt(2)
    v_mfma_f32_16x16x32_bf16 v[144:147], a[232:235], v[132:135], v[144:147]
    v_mfma_f32_16x16x32_bf16 v[148:151], a[236:239], v[132:135], v[148:151]
    s_waitcnt vmcnt(1)
    v_mfma_f32_16x16x32_bf16 v[144:147], a[240:243], v[136:139], v[144:147]
    v_mfma_f32_16x16x32_bf16 v[148:151], a[244:247], v[136:139], v[148:151]
    s_waitcnt vmcnt(0)
    v_mfma_f32_16x16x32_bf16 v[144:147], a[248:251], v[140:143], v[144:147]
    v_mfma_f32_16x16x32_bf16 v[148:151], a[252:255], v[140:143], v[148:151]
    s_lshl_b32 s64, s14, 12
    v_add_u32 v7, s64, v1
    s_barrier
    s_nop 3
    ds_write_b128 v7, v[144:147] offset:0
    ds_write_b128 v7, v[148:151] offset:1024
    s_waitcnt lgkmcnt(0)
    s_barrier
    s_cmp_ge_u32 s14, 2
    s_cbranch_scc1 OTD_174
    s_lshl_b32 s64, s14, 10
    v_add_u32 v7, s64, v1
    ds_read_b128 v[16:19], v7 offset:0
    ds_read_b128 v[20:23], v7 offset:4096
    ds_read_b128 v[24:27], v7 offset:8192
    ds_read_b128 v[28:31], v7 offset:12288
    s_waitcnt lgkmcnt(0)
    v_add_f32 v16, v16, v20
    v_add_f32 v24, v24, v28
    v_add_f32 v16, v16, v24
    v_add_f32 v17, v17, v21
    v_add_f32 v25, v25, v29
    v_add_f32 v17, v17, v25
    v_add_f32 v18, v18, v22
    v_add_f32 v26, v26, v30
    v_add_f32 v18, v18, v26
    v_add_f32 v19, v19, v23
    v_add_f32 v27, v27, v31
    v_add_f32 v19, v19, v27
    v_cvt_pk_bf16_f32 v16, v16, v16
    v_lshlrev_b32 v16, 16, v16
    v_cvt_pk_bf16_f32 v17, v17, v17
    v_lshlrev_b32 v17, 16, v17
    v_cvt_pk_bf16_f32 v18, v18, v18
    v_lshlrev_b32 v18, 16, v18
    v_cvt_pk_bf16_f32 v19, v19, v19
    v_lshlrev_b32 v19, 16, v19
    v_lshlrev_b32 v20, 16, v162
    v_and_b32 v21, 0xffff0000, v162
    v_lshlrev_b32 v24, 16, v160
    v_and_b32 v25, 0xffff0000, v160
    v_lshlrev_b32 v22, 16, v163
    v_and_b32 v23, 0xffff0000, v163
    v_lshlrev_b32 v26, 16, v161
    v_and_b32 v27, 0xffff0000, v161
    s_lshl_b32 s64, s24, 5
    v_add_u32 v8, s64, v9
    v_mov_b32 v10, -1
    v_cmp_eq_u32 vcc, s72, v8
    s_nop 1
    v_cndmask_b32 v10, v10, 0, vcc
    v_cmp_eq_u32 vcc, s73, v8
    s_nop 1
    v_cndmask_b32 v10, v10, 1, vcc
    v_cmp_eq_u32 vcc, s74, v8
    s_nop 1
    v_cndmask_b32 v10, v10, 2, vcc
    v_cmp_eq_u32 vcc, s75, v8
    s_nop 1
    v_cndmask_b32 v10, v10, 3, vcc
    v_cmp_eq_u32 vcc, s76, v8
    s_nop 1
    v_cndmask_b32 v10, v10, 4, vcc
    v_cmp_eq_u32 vcc, s77, v8
    s_nop 1
    v_cndmask_b32 v10, v10, 5, vcc
    v_cmp_eq_u32 vcc, s78, v8
    s_nop 1
    v_cndmask_b32 v10, v10, 6, vcc
    v_cmp_eq_u32 vcc, s79, v8
    s_nop 1
    v_cndmask_b32 v10, v10, 7, vcc
    v_cmp_le_i32 vcc, 0, v10
    s_and_saveexec_b64 s[68:69], vcc
    s_cbranch_execz NOUPD_175
    v_mul_u32_u24 v10, 2560, v10
    v_lshrrev_b32 v11, 4, v0
    v_lshl_add_u32 v10, v11, 4, v10
    s_lshl_b32 s64, s86, 6
    s_lshl_b32 s65, s13, 7
    s_add_u32 s64, s64, s65
    s_add_u32 s64, s64, 0x5410000
    buffer_load_dwordx4 v[164:167], v10, s[4:7], s64 offen sc1
    s_waitcnt vmcnt(0)
    v_add_f32 v20, v20, v164
    v_cvt_pk_bf16_f32 v20, v20, v20
    v_lshlrev_b32 v20, 16, v20
    v_add_f32 v21, v21, v165
    v_cvt_pk_bf16_f32 v21, v21, v21
    v_lshlrev_b32 v21, 16, v21
    v_add_f32 v22, v22, v166
    v_cvt_pk_bf16_f32 v22, v22, v22
    v_lshlrev_b32 v22, 16, v22
    v_add_f32 v23, v23, v167
    v_cvt_pk_bf16_f32 v23, v23, v23
    v_lshlrev_b32 v23, 16, v23
NOUPD_175:
    s_mov_b64 exec, -1
    v_mul_f32 v28, 0xbfb8aa3b, v20
    v_exp_f32 v28, v28
    s_nop 0
    v_add_f32 v28, 1.0, v28
    v_rcp_f32 v28, v28
    s_nop 0
    v_mul_f32 v28, v28, v20
    v_cvt_pk_bf16_f32 v28, v28, v28
    v_lshlrev_b32 v28, 16, v28
    v_mul_f32 v28, v28, v16
    v_cvt_pk_bf16_f32 v28, v28, v28
    v_lshlrev_b32 v28, 16, v28
    v_add_f32 v28, v28, v24
    v_mul_f32 v29, 0xbfb8aa3b, v21
    v_exp_f32 v29, v29
    s_nop 0
    v_add_f32 v29, 1.0, v29
    v_rcp_f32 v29, v29
    s_nop 0
    v_mul_f32 v29, v29, v21
    v_cvt_pk_bf16_f32 v29, v29, v29
    v_lshlrev_b32 v29, 16, v29
    v_mul_f32 v29, v29, v17
    v_cvt_pk_bf16_f32 v29, v29, v29
    v_lshlrev_b32 v29, 16, v29
    v_add_f32 v29, v29, v25
    v_mul_f32 v30, 0xbfb8aa3b, v22
    v_exp_f32 v30, v30
    s_nop 0
    v_add_f32 v30, 1.0, v30
    v_rcp_f32 v30, v30
    s_nop 0
    v_mul_f32 v30, v30, v22
    v_cvt_pk_bf16_f32 v30, v30, v30
    v_lshlrev_b32 v30, 16, v30
    v_mul_f32 v30, v30, v18
    v_cvt_pk_bf16_f32 v30, v30, v30
    v_lshlrev_b32 v30, 16, v30
    v_add_f32 v30, v30, v26
    v_mul_f32 v31, 0xbfb8aa3b, v23
    v_exp_f32 v31, v31
    s_nop 0
    v_add_f32 v31, 1.0, v31
    v_rcp_f32 v31, v31
    s_nop 0
    v_mul_f32 v31, v31, v23
    v_cvt_pk_bf16_f32 v31, v31, v31
    v_lshlrev_b32 v31, 16, v31
    v_mul_f32 v31, v31, v19
    v_cvt_pk_bf16_f32 v31, v31, v31
    v_lshlrev_b32 v31, 16, v31
    v_add_f32 v31, v31, v27
    v_cvt_pk_bf16_f32 v164, v28, v29
    v_cvt_pk_bf16_f32 v165, v30, v31
    buffer_store_dwordx2 v[164:165], v5, s[52:55], s67 offen
OTD_174:
OU_X:
    s_branch M_EXIT
H_EXTRA:
    s_mul_hi_u32 s12, s88, 0xccccccd
    s_mul_i32 s65, s12, 20
    s_sub_u32 s13, s88, s65
    s_add_u32 s12, s12, 3
    s_load_dwordx2 s[48:49], s[0:1], 0
    s_mov_b32 s50, 0x280000
    s_mov_b32 s51, 0x00020000
    s_load_dwordx2 s[52:53], s[0:1], 96
    s_mov_b32 s54, 0x280000
    s_mov_b32 s55, 0x00020000
    s_mov_b32 s36, -1
    s_mov_b32 s37, 0
    s_waitcnt lgkmcnt(0)
    v_mbcnt_lo_u32_b32 v0, -1, 0
    v_mbcnt_hi_u32_b32 v0, -1, v0
    s_mov_b32 s29, 0
    v_lshlrev_b32 v1, 4, v0
    v_lshlrev_b32 v6, 2, v0
    v_mov_b32 v8, 0
    s_mov_b32 s64, 0x298100
OXW_176:
    buffer_load_dword v7, v8, s[4:7], s64 offen sc1
    s_add_u32 s29, s29, 1
    s_waitcnt vmcnt(0)
    v_cmp_gt_u32 vcc, 40, v7
    s_cbranch_vccz OXWD_177
    s_cmp_gt_u32 s29, 262144
    s_cbranch_scc1 OXWD_177
    s_sleep 8
    s_branch OXW_176
OXWD_177:
    v_lshlrev_b32 v6, 2, v0
    s_mov_b32 s64, 0x5400000
    buffer_load_dword v7, v6, s[4:7], s64 offen sc1
    s_waitcnt vmcnt(0)
    v_readlane_b32 s72, v7, 0
    v_readlane_b32 s73, v7, 1
    v_readlane_b32 s74, v7, 2
    v_readlane_b32 s75, v7, 3
    v_readlane_b32 s76, v7, 4
    v_readlane_b32 s77, v7, 5
    v_readlane_b32 s78, v7, 6
    v_readlane_b32 s79, v7, 7
    s_cmp_eq_u32 s12, 3
    s_cselect_b32 s24, 62, 63
    s_cmp_eq_u32 s12, 4
    s_cselect_b32 s87, 0, 1
    s_and_b32 s86, s14, 1
    s_lshl_b32 s64, s87, 4
    v_and_b32 v6, 15, v0
    v_add_u32 v6, s64, v6
    v_mov_b32 v9, v6
    v_mul_u32_u24 v5, 1280, v6
    v_lshrrev_b32 v6, 4, v0
    v_lshl_add_u32 v5, v6, 3, v5
    s_and_b32 s64, s14, 1
    s_lshl_b32 s64, s64, 5
    s_lshl_b32 s65, s13, 6
    s_add_u32 s64, s64, s65
    v_add_u32 v5, s64, v5
    v_lshlrev_b32 v6, 2, v0
    s_mul_i32 s67, s24, 40960
    buffer_load_dwordx2 v[160:161], v5, s[48:51], s67 offen
    s_add_u32 s64, s67, 0x0
    buffer_load_dwordx2 v[162:163], v5, s[4:7], s64 offen
    s_lshl_b32 s64, s24, 7
    s_add_u32 s64, s64, 0x296000
    s_mov_b64 exec, s[36:37]
OX_F_178:
    buffer_load_dword v7, v6, s[4:7], s64 offen sc1
    s_add_u32 s29, s29, 1
    s_waitcnt vmcnt(0)
    v_cmp_eq_u32 vcc, 0, v7
    s_cbranch_vccz OX_FD_179
    s_cmp_gt_u32 s29, 262144
    s_cbranch_scc1 OX_FD_179
    s_sleep 1
    s_branch OX_F_178
OX_FD_179:
    s_mov_b64 exec, -1
    s_lshl_b32 s25, s24, 18
    s_lshl_b32 s64, s14, 15
    s_add_u32 s25, s25, s64
    s_add_u32 s25, s25, 0x4400000
    s_lshl_b32 s64, s87, 17
    s_add_u32 s25, s25, s64
    s_add_u32 s64, s25, 0x0
    buffer_load_dwordx4 v[16:19], v1, s[4:7], s64 offen
    s_add_u32 s64, s25, 0x400
    buffer_load_dwordx4 v[20:23], v1, s[4:7], s64 offen
    s_add_u32 s64, s25, 0x800
    buffer_load_dwordx4 v[24:27], v1, s[4:7], s64 offen
    s_add_u32 s64, s25, 0xc00
    buffer_load_dwordx4 v[28:31], v1, s[4:7], s64 offen
    s_add_u32 s64, s25, 0x1000
    buffer_load_dwordx4 v[32:35], v1, s[4:7], s64 offen
    s_add_u32 s64, s25, 0x1400
    buffer_load_dwordx4 v[36:39], v1, s[4:7], s64 offen
    s_add_u32 s64, s25, 0x1800
    buffer_load_dwordx4 v[40:43], v1, s[4:7], s64 offen
    s_add_u32 s64, s25, 0x1c00
    buffer_load_dwordx4 v[44:47], v1, s[4:7], s64 offen
    s_add_u32 s64, s25, 0x2000
    buffer_load_dwordx4 v[48:51], v1, s[4:7], s64 offen
    s_add_u32 s64, s25, 0x2400
    buffer_load_dwordx4 v[52:55], v1, s[4:7], s64 offen
    s_add_u32 s64, s25, 0x2800
    buffer_load_dwordx4 v[56:59], v1, s[4:7], s64 offen
    s_add_u32 s64, s25, 0x2c00
    buffer_load_dwordx4 v[60:63], v1, s[4:7], s64 offen
    s_add_u32 s64, s25, 0x3000
    buffer_load_dwordx4 v[64:67], v1, s[4:7], s64 offen
    s_add_u32 s64, s25, 0x3400
    buffer_load_dwordx4 v[68:71], v1, s[4:7], s64 offen
    s_add_u32 s64, s25, 0x3800
    buffer_load_dwordx4 v[72:75], v1, s[4:7], s64 offen
    s_add_u32 s64, s25, 0x3c00
    buffer_load_dwordx4 v[76:79], v1, s[4:7], s64 offen
    s_add_u32 s64, s25, 0x4000
    buffer_load_dwordx4 v[80:83], v1, s[4:7], s64 offen
    s_add_u32 s64, s25, 0x4400
    buffer_load_dwordx4 v[84:87], v1, s[4:7], s64 offen
    s_add_u32 s64, s25, 0x4800
    buffer_load_dwordx4 v[88:91], v1, s[4:7], s64 offen
    s_add_u32 s64, s25, 0x4c00
    buffer_load_dwordx4 v[92:95], v1, s[4:7], s64 offen
    s_add_u32 s64, s25, 0x5000
    buffer_load_dwordx4 v[96:99], v1, s[4:7], s64 offen
    s_add_u32 s64, s25, 0x5400
    buffer_load_dwordx4 v[100:103], v1, s[4:7], s64 offen
    s_add_u32 s64, s25, 0x5800
    buffer_load_dwordx4 v[104:107], v1, s[4:7], s64 offen
    s_add_u32 s64, s25, 0x5c00
    buffer_load_dwordx4 v[108:111], v1, s[4:7], s64 offen
    s_add_u32 s64, s25, 0x6000
    buffer_load_dwordx4 v[112:115], v1, s[4:7], s64 offen
    s_add_u32 s64, s25, 0x6400
    buffer_load_dwordx4 v[116:119], v1, s[4:7], s64 offen
    s_add_u32 s64, s25, 0x6800
    buffer_load_dwordx4 v[120:123], v1, s[4:7], s64 offen
    s_add_u32 s64, s25, 0x6c00
    buffer_load_dwordx4 v[124:127], v1, s[4:7], s64 offen
    s_add_u32 s64, s25, 0x7000
    buffer_load_dwordx4 v[128:131], v1, s[4:7], s64 offen
    s_add_u32 s64, s25, 0x7400
    buffer_load_dwordx4 v[132:135], v1, s[4:7], s64 offen
    s_add_u32 s64, s25, 0x7800
    buffer_load_dwordx4 v[136:139], v1, s[4:7], s64 offen
    s_add_u32 s64, s25, 0x7c00
    buffer_load_dwordx4 v[140:143], v1, s[4:7], s64 offen
    s_waitcnt vmcnt(31)
    v_mfma_f32_16x16x32_bf16 v[144:147], a[0:3], v[16:19], 0
    v_mfma_f32_16x16x32_bf16 v[148:151], a[4:7], v[16:19], 0
    s_waitcnt vmcnt(30)
    v_mfma_f32_16x16x32_bf16 v[144:147], a[8:11], v[20:23], v[144:147]
    v_mfma_f32_16x16x32_bf16 v[148:151], a[12:15], v[20:23], v[148:151]
    s_waitcnt vmcnt(29)
    v_mfma_f32_16x16x32_bf16 v[144:147], a[16:19], v[24:27], v[144:147]
    v_mfma_f32_16x16x32_bf16 v[148:151], a[20:23], v[24:27], v[148:151]
    s_waitcnt vmcnt(28)
    v_mfma_f32_16x16x32_bf16 v[144:147], a[24:27], v[28:31], v[144:147]
    v_mfma_f32_16x16x32_bf16 v[148:151], a[28:31], v[28:31], v[148:151]
    s_waitcnt vmcnt(27)
    v_mfma_f32_16x16x32_bf16 v[144:147], a[32:35], v[32:35], v[144:147]
    v_mfma_f32_16x16x32_bf16 v[148:151], a[36:39], v[32:35], v[148:151]
    s_waitcnt vmcnt(26)
    v_mfma_f32_16x16x32_bf16 v[144:147], a[40:43], v[36:39], v[144:147]
    v_mfma_f32_16x16x32_bf16 v[148:151], a[44:47], v[36:39], v[148:151]
    s_waitcnt vmcnt(25)
    v_mfma_f32_16x16x32_bf16 v[144:147], a[48:51], v[40:43], v[144:147]
    v_mfma_f32_16x16x32_bf16 v[148:151], a[52:55], v[40:43], v[148:151]
    s_waitcnt vmcnt(24)
    v_mfma_f32_16x16x32_bf16 v[144:147], a[56:59], v[44:47], v[144:147]
    v_mfma_f32_16x16x32_bf16 v[148:151], a[60:63], v[44:47], v[148:151]
    s_waitcnt vmcnt(23)
    v_mfma_f32_16x16x32_bf16 v[144:147], a[64:67], v[48:51], v[144:147]
    v_mfma_f32_16x16x32_bf16 v[148:151], a[68:71], v[48:51], v[148:151]
    s_waitcnt vmcnt(22)
    v_mfma_f32_16x16x32_bf16 v[144:147], a[72:75], v[52:55], v[144:147]
    v_mfma_f32_16x16x32_bf16 v[148:151], a[76:79], v[52:55], v[148:151]
    s_waitcnt vmcnt(21)
    v_mfma_f32_16x16x32_bf16 v[144:147], a[80:83], v[56:59], v[144:147]
    v_mfma_f32_16x16x32_bf16 v[148:151], a[84:87], v[56:59], v[148:151]
    s_waitcnt vmcnt(20)
    v_mfma_f32_16x16x32_bf16 v[144:147], a[88:91], v[60:63], v[144:147]
    v_mfma_f32_16x16x32_bf16 v[148:151], a[92:95], v[60:63], v[148:151]
    s_waitcnt vmcnt(19)
    v_mfma_f32_16x16x32_bf16 v[144:147], a[96:99], v[64:67], v[144:147]
    v_mfma_f32_16x16x32_bf16 v[148:151], a[100:103], v[64:67], v[148:151]
    s_waitcnt vmcnt(18)
    v_mfma_f32_16x16x32_bf16 v[144:147], a[104:107], v[68:71], v[144:147]
    v_mfma_f32_16x16x32_bf16 v[148:151], a[108:111], v[68:71], v[148:151]
    s_waitcnt vmcnt(17)
    v_mfma_f32_16x16x32_bf16 v[144:147], a[112:115], v[72:75], v[144:147]
    v_mfma_f32_16x16x32_bf16 v[148:151], a[116:119], v[72:75], v[148:151]
    s_waitcnt vmcnt(16)
    v_mfma_f32_16x16x32_bf16 v[144:147], a[120:123], v[76:79], v[144:147]
    v_mfma_f32_16x16x32_bf16 v[148:151], a[124:127], v[76:79], v[148:151]
    s_waitcnt vmcnt(15)
    v_mfma_f32_16x16x32_bf16 v[144:147], a[128:131], v[80:83], v[144:147]
    v_mfma_f32_16x16x32_bf16 v[148:151], a[132:135], v[80:83], v[148:151]
    s_waitcnt vmcnt(14)
    v_mfma_f32_16x16x32_bf16 v[144:147], a[136:139], v[84:87], v[144:147]
    v_mfma_f32_16x16x32_bf16 v[148:151], a[140:143], v[84:87], v[148:151]
    s_waitcnt vmcnt(13)
    v_mfma_f32_16x16x32_bf16 v[144:147], a[144:147], v[88:91], v[144:147]
    v_mfma_f32_16x16x32_bf16 v[148:151], a[148:151], v[88:91], v[148:151]
    s_waitcnt vmcnt(12)
    v_mfma_f32_16x16x32_bf16 v[144:147], a[152:155], v[92:95], v[144:147]
    v_mfma_f32_16x16x32_bf16 v[148:151], a[156:159], v[92:95], v[148:151]
    s_waitcnt vmcnt(11)
    v_mfma_f32_16x16x32_bf16 v[144:147], a[160:163], v[96:99], v[144:147]
    v_mfma_f32_16x16x32_bf16 v[148:151], a[164:167], v[96:99], v[148:151]
    s_waitcnt vmcnt(10)
    v_mfma_f32_16x16x32_bf16 v[144:147], a[168:171], v[100:103], v[144:147]
    v_mfma_f32_16x16x32_bf16 v[148:151], a[172:175], v[100:103], v[148:151]
    s_waitcnt vmcnt(9)
    v_mfma_f32_16x16x32_bf16 v[144:147], a[176:179], v[104:107], v[144:147]
    v_mfma_f32_16x16x32_bf16 v[148:151], a[180:183], v[104:107], v[148:151]
    s_waitcnt vmcnt(8)
    v_mfma_f32_16x16x32_bf16 v[144:147], a[184:187], v[108:111], v[144:147]
    v_mfma_f32_16x16x32_bf16 v[148:151], a[188:191], v[108:111], v[148:151]
    s_waitcnt vmcnt(7)
    v_mfma_f32_16x16x32_bf16 v[144:147], a[192:195], v[112:115], v[144:147]
    v_mfma_f32_16x16x32_bf16 v[148:151], a[196:199], v[112:115], v[148:151]
    s_waitcnt vmcnt(6)
    v_mfma_f32_16x16x32_bf16 v[144:147], a[200:203], v[116:119], v[144:147]
    v_mfma_f32_16x16x32_bf16 v[148:151], a[204:207], v[116:119], v[148:151]
    s_waitcnt vmcnt(5)
    v_mfma_f32_16x16x32_bf16 v[144:147], a[208:211], v[120:123], v[144:147]
    v_mfma_f32_16x16x32_bf16 v[148:151], a[212:215], v[120:123], v[148:151]
    s_waitcnt vmcnt(4)
    v_mfma_f32_16x16x32_bf16 v[144:147], a[216:219], v[124:127], v[144:147]
    v_mfma_f32_16x16x32_bf16 v[148:151], a[220:223], v[124:127], v[148:151]
    s_waitcnt vmcnt(3)
    v_mfma_f32_16x16x32_bf16 v[144:147], a[224:227], v[128:131], v[144:147]
    v_mfma_f32_16x16x32_bf16 v[148:151], a[228:231], v[128:131], v[148:151]
    s_waitcnt vmcnt(2)
    v_mfma_f32_16x16x32_bf16 v[144:147], a[232:235], v[132:135], v[144:147]
    v_mfma_f32_16x16x32_bf16 v[148:151], a[236:239], v[132:135], v[148:151]
    s_waitcnt vmcnt(1)
    v_mfma_f32_16x16x32_bf16 v[144:147], a[240:243], v[136:139], v[144:147]
    v_mfma_f32_16x16x32_bf16 v[148:151], a[244:247], v[136:139], v[148:151]
    s_waitcnt vmcnt(0)
    v_mfma_f32_16x16x32_bf16 v[144:147], a[248:251], v[140:143], v[144:147]
    v_mfma_f32_16x16x32_bf16 v[148:151], a[252:255], v[140:143], v[148:151]
    s_lshl_b32 s64, s14, 12
    v_add_u32 v7, s64, v1
    s_barrier
    s_nop 3
    ds_write_b128 v7, v[144:147] offset:0
    ds_write_b128 v7, v[148:151] offset:1024
    s_waitcnt lgkmcnt(0)
    s_barrier
    s_cmp_ge_u32 s14, 2
    s_cbranch_scc1 OTD_180
    s_lshl_b32 s64, s14, 10
    v_add_u32 v7, s64, v1
    ds_read_b128 v[16:19], v7 offset:0
    ds_read_b128 v[20:23], v7 offset:4096
    ds_read_b128 v[24:27], v7 offset:8192
    ds_read_b128 v[28:31], v7 offset:12288
    s_waitcnt lgkmcnt(0)
    v_add_f32 v16, v16, v20
    v_add_f32 v24, v24, v28
    v_add_f32 v16, v16, v24
    v_add_f32 v17, v17, v21
    v_add_f32 v25, v25, v29
    v_add_f32 v17, v17, v25
    v_add_f32 v18, v18, v22
    v_add_f32 v26, v26, v30
    v_add_f32 v18, v18, v26
    v_add_f32 v19, v19, v23
    v_add_f32 v27, v27, v31
    v_add_f32 v19, v19, v27
    v_cvt_pk_bf16_f32 v16, v16, v16
    v_lshlrev_b32 v16, 16, v16
    v_cvt_pk_bf16_f32 v17, v17, v17
    v_lshlrev_b32 v17, 16, v17
    v_cvt_pk_bf16_f32 v18, v18, v18
    v_lshlrev_b32 v18, 16, v18
    v_cvt_pk_bf16_f32 v19, v19, v19
    v_lshlrev_b32 v19, 16, v19
    v_lshlrev_b32 v20, 16, v162
    v_and_b32 v21, 0xffff0000, v162
    v_lshlrev_b32 v24, 16, v160
    v_and_b32 v25, 0xffff0000, v160
    v_lshlrev_b32 v22, 16, v163
    v_and_b32 v23, 0xffff0000, v163
    v_lshlrev_b32 v26, 16, v161
    v_and_b32 v27, 0xffff0000, v161
    s_lshl_b32 s64, s24, 5
    v_add_u32 v8, s64, v9
    v_mov_b32 v10, -1
    v_cmp_eq_u32 vcc, s72, v8
    s_nop 1
    v_cndmask_b32 v10, v10, 0, vcc
    v_cmp_eq_u32 vcc, s73, v8
    s_nop 1
    v_cndmask_b32 v10, v10, 1, vcc
    v_cmp_eq_u32 vcc, s74, v8
    s_nop 1
    v_cndmask_b32 v10, v10, 2, vcc
    v_cmp_eq_u32 vcc, s75, v8
    s_nop 1
    v_cndmask_b32 v10, v10, 3, vcc
    v_cmp_eq_u32 vcc, s76, v8
    s_nop 1
    v_cndmask_b32 v10, v10, 4, vcc
    v_cmp_eq_u32 vcc, s77, v8
    s_nop 1
    v_cndmask_b32 v10, v10, 5, vcc
    v_cmp_eq_u32 vcc, s78, v8
    s_nop 1
    v_cndmask_b32 v10, v10, 6, vcc
    v_cmp_eq_u32 vcc, s79, v8
    s_nop 1
    v_cndmask_b32 v10, v10, 7, vcc
    v_cmp_le_i32 vcc, 0, v10
    s_and_saveexec_b64 s[68:69], vcc
    s_cbranch_execz NOUPD_181
    v_mul_u32_u24 v10, 2560, v10
    v_lshrrev_b32 v11, 4, v0
    v_lshl_add_u32 v10, v11, 4, v10
    s_lshl_b32 s64, s86, 6
    s_lshl_b32 s65, s13, 7
    s_add_u32 s64, s64, s65
    s_add_u32 s64, s64, 0x5410000
    buffer_load_dwordx4 v[164:167], v10, s[4:7], s64 offen sc1
    s_waitcnt vmcnt(0)
    v_add_f32 v20, v20, v164
    v_cvt_pk_bf16_f32 v20, v20, v20
    v_lshlrev_b32 v20, 16, v20
    v_add_f32 v21, v21, v165
    v_cvt_pk_bf16_f32 v21, v21, v21
    v_lshlrev_b32 v21, 16, v21
    v_add_f32 v22, v22, v166
    v_cvt_pk_bf16_f32 v22, v22, v22
    v_lshlrev_b32 v22, 16, v22
    v_add_f32 v23, v23, v167
    v_cvt_pk_bf16_f32 v23, v23, v23
    v_lshlrev_b32 v23, 16, v23
NOUPD_181:
    s_mov_b64 exec, -1
    v_mul_f32 v28, 0xbfb8aa3b, v20
    v_exp_f32 v28, v28
    s_nop 0
    v_add_f32 v28, 1.0, v28
    v_rcp_f32 v28, v28
    s_nop 0
    v_mul_f32 v28, v28, v20
    v_cvt_pk_bf16_f32 v28, v28, v28
    v_lshlrev_b32 v28, 16, v28
    v_mul_f32 v28, v28, v16
    v_cvt_pk_bf16_f32 v28, v28, v28
    v_lshlrev_b32 v28, 16, v28
    v_add_f32 v28, v28, v24
    v_mul_f32 v29, 0xbfb8aa3b, v21
    v_exp_f32 v29, v29
    s_nop 0
    v_add_f32 v29, 1.0, v29
    v_rcp_f32 v29, v29
    s_nop 0
    v_mul_f32 v29, v29, v21
    v_cvt_pk_bf16_f32 v29, v29, v29
    v_lshlrev_b32 v29, 16, v29
    v_mul_f32 v29, v29, v17
    v_cvt_pk_bf16_f32 v29, v29, v29
    v_lshlrev_b32 v29, 16, v29
    v_add_f32 v29, v29, v25
    v_mul_f32 v30, 0xbfb8aa3b, v22
    v_exp_f32 v30, v30
    s_nop 0
    v_add_f32 v30, 1.0, v30
    v_rcp_f32 v30, v30
    s_nop 0
    v_mul_f32 v30, v30, v22
    v_cvt_pk_bf16_f32 v30, v30, v30
    v_lshlrev_b32 v30, 16, v30
    v_mul_f32 v30, v30, v18
    v_cvt_pk_bf16_f32 v30, v30, v30
    v_lshlrev_b32 v30, 16, v30
    v_add_f32 v30, v30, v26
    v_mul_f32 v31, 0xbfb8aa3b, v23
    v_exp_f32 v31, v31
    s_nop 0
    v_add_f32 v31, 1.0, v31
    v_rcp_f32 v31, v31
    s_nop 0
    v_mul_f32 v31, v31, v23
    v_cvt_pk_bf16_f32 v31, v31, v31
    v_lshlrev_b32 v31, 16, v31
    v_mul_f32 v31, v31, v19
    v_cvt_pk_bf16_f32 v31, v31, v31
    v_lshlrev_b32 v31, 16, v31
    v_add_f32 v31, v31, v27
    v_cvt_pk_bf16_f32 v164, v28, v29
    v_cvt_pk_bf16_f32 v165, v30, v31
    buffer_store_dwordx2 v[164:165], v5, s[52:55], s67 offen
OTD_180:
    s_branch M_EXIT
H_Q:
    s_mov_b32 s29, 0
    v_lshlrev_b32 v1, 4, v0
    v_lshrrev_b32 v5, 4, v0
    v_lshlrev_b32 v2, 7, v5
    v_and_b32 v5, 7, v0
    v_lshl_add_u32 v2, v5, 4, v2
    v_bfe_u32 v5, v0, 4, 1
    v_lshlrev_b32 v3, 7, v5
    v_and_b32 v5, 15, v0
    v_lshl_add_u32 v3, v5, 3, v3
    s_mov_b32 s34, 0x3e0293ee
    s_mov_b32 s35, 0x3e0293ee
    s_mov_b32 s36, -1
    s_mov_b32 s37, 0
    v_lshrrev_b32 v5, 4, v0
    v_lshlrev_b32 v5, 2, v5
    v_and_b32 v6, 15, v0
    v_add_u32 v7, 0, v5
    v_cmp_le_u32 s[38:39], v7, v6
    v_add_u32 v7, 1, v5
    v_cmp_le_u32 s[40:41], v7, v6
    v_add_u32 v7, 2, v5
    v_cmp_le_u32 s[42:43], v7, v6
    v_add_u32 v7, 3, v5
    v_cmp_le_u32 s[44:45], v7, v6
    v_mov_b32 v248, 0x3f803f80
    v_mov_b32 v249, 0x3f803f80
    v_mov_b32 v250, 0x3f803f80
    v_mov_b32 v251, 0x3f803f80
    s_lshl_b32 s24, s12, 2
    s_add_u32 s24, s24, s14
    s_mov_b32 s25, 0
AT0_LOOP:
    s_cmp_eq_u32 s24, 63
    s_cbranch_scc1 AT0_END
    s_lshl_b32 s64, s24, 5
    s_add_u32 s64, s64, s13
    s_lshl_b32 s26, s64, 13
    s_add_u32 s26, s26, 0x3400000
    s_lshl_b32 s27, s64, 14
    s_add_u32 s27, s27, 0x1400000
    s_lshl_b32 s65, s64, 11
    s_add_u32 s30, s65, 0x640000
    s_add_u32 s31, s65, 0xa40000
    s_lshl_b32 s33, s64, 2
    s_add_u32 s33, s33, 0x296000
    s_lshl_b32 s32, s24, 18
    s_lshl_b32 s65, s13, 12
    s_add_u32 s32, s32, s65
    s_add_u32 s32, s32, 0x4400000
    s_lshr_b32 s65, s24, 2
    s_lshl_b32 s65, s65, 9
    s_lshl_b32 s66, s13, 4
    s_add_u32 s65, s65, s66
    s_add_u32 s65, s65, 0x291000
    s_lshr_b32 s66, s24, 1
    s_lshl_b32 s66, s66, 8
    s_lshl_b32 s64, s13, 3
    s_add_u32 s66, s66, s64
    s_add_u32 s66, s66, 0x293ff4
    v_lshlrev_b32 v5, 2, v0
    v_mov_b32 v6, s65
    v_mov_b32 v7, s66
    v_cmp_gt_u32 vcc, 3, v0
    s_nop 1
    v_cndmask_b32 v6, v7, v6, vcc
    v_add_u32 v4, v5, v6
    s_mov_b32 s64, 0
    s_mov_b64 exec, 7
AT0_F_182:
    buffer_load_dword v5, v4, s[4:7], s64 offen sc1
    s_add_u32 s29, s29, 1
    s_waitcnt vmcnt(0)
    v_cmp_eq_u32 vcc, 0, v5
    s_cbranch_vccz AT0_FD_183
    s_cmp_gt_u32 s29, 262144
    s_cbranch_scc1 AT0_FD_183
    s_sleep 1
    s_branch AT0_F_182
AT0_FD_183:
    s_mov_b64 exec, -1
    buffer_load_dwordx4 v[16:19], v1, s[4:7], s26 offen offset:0
    buffer_load_dwordx4 v[20:23], v1, s[4:7], s26 offen offset:1024
    buffer_load_dwordx4 v[24:27], v1, s[4:7], s26 offen offset:2048
    buffer_load_dwordx4 v[28:31], v1, s[4:7], s26 offen offset:3072
    s_add_u32 s26, s26, 4096
    buffer_load_dwordx4 v[32:35], v1, s[4:7], s26 offen offset:0
    buffer_load_dwordx4 v[36:39], v1, s[4:7], s26 offen offset:1024
    buffer_load_dwordx4 v[40:43], v1, s[4:7], s26 offen offset:2048
    buffer_load_dwordx4 v[44:47], v1, s[4:7], s26 offen offset:3072
    buffer_load_dwordx4 v[48:51], v1, s[4:7], s27 offen offset:0
    buffer_load_dwordx4 v[52:55], v1, s[4:7], s27 offen offset:1024
    buffer_load_dwordx4 v[56:59], v1, s[4:7], s27 offen offset:2048
    buffer_load_dwordx4 v[60:63], v1, s[4:7], s27 offen offset:3072
    s_add_u32 s27, s27, 4096
    buffer_load_dwordx4 v[64:67], v1, s[4:7], s27 offen offset:0
    buffer_load_dwordx4 v[68:71], v1, s[4:7], s27 offen offset:1024
    buffer_load_dwordx4 v[72:75], v1, s[4:7], s27 offen offset:2048
    buffer_load_dwordx4 v[76:79], v1, s[4:7], s27 offen offset:3072
    s_add_u32 s27, s27, 4096
    buffer_load_dwordx4 v[80:83], v1, s[4:7], s27 offen offset:0
    buffer_load_dwordx4 v[84:87], v1, s[4:7], s27 offen offset:1024
    buffer_load_dwordx4 v[88:91], v1, s[4:7], s27 offen offset:2048
    buffer_load_dwordx4 v[92:95], v1, s[4:7], s27 offen offset:3072
    s_add_u32 s27, s27, 4096
    buffer_load_dwordx4 v[96:99], v1, s[4:7], s27 offen offset:0
    buffer_load_dwordx4 v[100:103], v1, s[4:7], s27 offen offset:1024
    buffer_load_dwordx4 v[104:107], v1, s[4:7], s27 offen offset:2048
    buffer_load_dwordx4 v[108:111], v1, s[4:7], s27 offen offset:3072
    s_mov_b64 exec, 0x18
AT0_G_184:
    buffer_load_dword v5, v4, s[4:7], s64 offen sc1
    s_add_u32 s29, s29, 1
    s_waitcnt vmcnt(0)
    v_cmp_eq_u32 vcc, 0, v5
    s_cbranch_vccz AT0_GD_185
    s_cmp_gt_u32 s29, 262144
    s_cbranch_scc1 AT0_GD_185
    s_sleep 1
    s_branch AT0_G_184
AT0_GD_185:
    s_mov_b64 exec, -1
    buffer_load_dwordx4 v[112:115], v2, s[4:7], s30 offen offset:0
    buffer_load_dwordx4 v[116:119], v2, s[4:7], s30 offen offset:512
    buffer_load_dwordx4 v[120:123], v2, s[4:7], s30 offen offset:1024
    buffer_load_dwordx4 v[124:127], v2, s[4:7], s30 offen offset:1536
    buffer_load_dwordx2 v[128:129], v3, s[4:7], s31 offen offset:0
    buffer_load_dwordx2 v[130:131], v3, s[4:7], s31 offen offset:256
    buffer_load_dwordx2 v[132:133], v3, s[4:7], s31 offen offset:512
    buffer_load_dwordx2 v[134:135], v3, s[4:7], s31 offen offset:768
    buffer_load_dwordx2 v[136:137], v3, s[4:7], s31 offen offset:1024
    buffer_load_dwordx2 v[138:139], v3, s[4:7], s31 offen offset:1280
    buffer_load_dwordx2 v[140:141], v3, s[4:7], s31 offen offset:1536
    buffer_load_dwordx2 v[142:143], v3, s[4:7], s31 offen offset:1792
    v_mfma_f32_16x16x32_bf16 v[148:151], v[48:51], v[16:19], 0
    v_mfma_f32_16x16x32_bf16 v[156:159], v[48:51], v[32:35], 0
    v_mfma_f32_16x16x32_bf16 v[160:163], v[64:67], v[32:35], 0
    v_mfma_f32_16x16x32_bf16 v[148:151], v[52:55], v[20:23], v[148:151]
    v_mfma_f32_16x16x32_bf16 v[156:159], v[52:55], v[36:39], v[156:159]
    v_mfma_f32_16x16x32_bf16 v[160:163], v[68:71], v[36:39], v[160:163]
    v_mfma_f32_16x16x32_bf16 v[148:151], v[56:59], v[24:27], v[148:151]
    v_mfma_f32_16x16x32_bf16 v[156:159], v[56:59], v[40:43], v[156:159]
    v_mfma_f32_16x16x32_bf16 v[160:163], v[72:75], v[40:43], v[160:163]
    v_mfma_f32_16x16x32_bf16 v[148:151], v[60:63], v[28:31], v[148:151]
    v_mfma_f32_16x16x32_bf16 v[156:159], v[60:63], v[44:47], v[156:159]
    v_mfma_f32_16x16x32_bf16 v[160:163], v[76:79], v[44:47], v[160:163]
    s_waitcnt vmcnt(8)
    v_mfma_f32_16x16x32_bf16 v[144:147], v[112:115], v[16:19], 0
    v_mfma_f32_16x16x32_bf16 v[152:155], v[112:115], v[32:35], 0
    v_mfma_f32_16x16x32_bf16 v[144:147], v[116:119], v[20:23], v[144:147]
    v_mfma_f32_16x16x32_bf16 v[152:155], v[116:119], v[36:39], v[152:155]
    v_mfma_f32_16x16x32_bf16 v[144:147], v[120:123], v[24:27], v[144:147]
    v_mfma_f32_16x16x32_bf16 v[152:155], v[120:123], v[40:43], v[152:155]
    v_mfma_f32_16x16x32_bf16 v[144:147], v[124:127], v[28:31], v[144:147]
    v_mfma_f32_16x16x32_bf16 v[152:155], v[124:127], v[44:47], v[152:155]
    v_mov_b32 v11, 0xff800000
    s_nop 7
    v_cndmask_b32 v148, v11, v148, s[38:39]
    v_cndmask_b32 v160, v11, v160, s[38:39]
    v_cndmask_b32 v144, v11, v144, s[36:37]
    v_cndmask_b32 v152, v11, v152, s[36:37]
    v_cndmask_b32 v149, v11, v149, s[40:41]
    v_cndmask_b32 v161, v11, v161, s[40:41]
    v_cndmask_b32 v145, v11, v145, s[36:37]
    v_cndmask_b32 v153, v11, v153, s[36:37]
    v_cndmask_b32 v150, v11, v150, s[42:43]
    v_cndmask_b32 v162, v11, v162, s[42:43]
    v_cndmask_b32 v146, v11, v146, s[36:37]
    v_cndmask_b32 v154, v11, v154, s[36:37]
    v_cndmask_b32 v151, v11, v151, s[44:45]
    v_cndmask_b32 v163, v11, v163, s[44:45]
    v_cndmask_b32 v147, v11, v147, s[36:37]
    v_cndmask_b32 v155, v11, v155, s[36:37]
    v_max3_f32 v8, v144, v145, v146
    v_max3_f32 v8, v8, v147, v148
    v_max3_f32 v8, v8, v149, v150
    v_max_f32 v8, v8, v151
    v_mov_b32 v9, v8
    s_nop 1
    v_permlane16_swap_b32 v8, v9
    v_max_f32 v8, v8, v9
    v_mov_b32 v9, v8
    s_nop 1
    v_permlane32_swap_b32 v8, v9
    v_max_f32 v8, v8, v9
    v_mul_f32 v8, s34, v8
    v_fma_f32 v144, v144, s34, -v8
    v_fma_f32 v145, v145, s34, -v8
    v_fma_f32 v146, v146, s34, -v8
    v_fma_f32 v147, v147, s34, -v8
    v_fma_f32 v148, v148, s34, -v8
    v_fma_f32 v149, v149, s34, -v8
    v_fma_f32 v150, v150, s34, -v8
    v_fma_f32 v151, v151, s34, -v8
    v_exp_f32 v144, v144
    v_exp_f32 v145, v145
    v_exp_f32 v146, v146
    v_exp_f32 v147, v147
    v_exp_f32 v148, v148
    v_exp_f32 v149, v149
    v_exp_f32 v150, v150
    v_exp_f32 v151, v151
    s_nop 0
    v_cvt_pk_bf16_f32 v164, v148, v149
    v_cvt_pk_bf16_f32 v165, v150, v151
    v_mov_b32 v166, 0
    v_mov_b32 v167, 0
    v_cvt_pk_bf16_f32 v168, v144, v145
    v_cvt_pk_bf16_f32 v169, v146, v147
    v_max3_f32 v8, v152, v153, v154
    v_max3_f32 v8, v8, v155, v156
    v_max3_f32 v8, v8, v157, v158
    v_max3_f32 v8, v8, v159, v160
    v_max3_f32 v8, v8, v161, v162
    v_max_f32 v8, v8, v163
    v_mov_b32 v9, v8
    s_nop 1
    v_permlane16_swap_b32 v8, v9
    v_max_f32 v8, v8, v9
    v_mov_b32 v9, v8
    s_nop 1
    v_permlane32_swap_b32 v8, v9
    v_max_f32 v8, v8, v9
    v_mul_f32 v8, s34, v8
    v_fma_f32 v152, v152, s34, -v8
    v_fma_f32 v153, v153, s34, -v8
    v_fma_f32 v154, v154, s34, -v8
    v_fma_f32 v155, v155, s34, -v8
    v_fma_f32 v156, v156, s34, -v8
    v_fma_f32 v157, v157, s34, -v8
    v_fma_f32 v158, v158, s34, -v8
    v_fma_f32 v159, v159, s34, -v8
    v_fma_f32 v160, v160, s34, -v8
    v_fma_f32 v161, v161, s34, -v8
    v_fma_f32 v162, v162, s34, -v8
    v_fma_f32 v163, v163, s34, -v8
    v_exp_f32 v152, v152
    v_exp_f32 v153, v153
    v_exp_f32 v154, v154
    v_exp_f32 v155, v155
    v_exp_f32 v156, v156
    v_exp_f32 v157, v157
    v_exp_f32 v158, v158
    v_exp_f32 v159, v159
    v_exp_f32 v160, v160
    v_exp_f32 v161, v161
    v_exp_f32 v162, v162
    v_exp_f32 v163, v163
    s_nop 0
    v_cvt_pk_bf16_f32 v170, v156, v157
    v_cvt_pk_bf16_f32 v171, v158, v159
    v_cvt_pk_bf16_f32 v172, v160, v161
    v_cvt_pk_bf16_f32 v173, v162, v163
    v_cvt_pk_bf16_f32 v174, v152, v153
    v_cvt_pk_bf16_f32 v175, v154, v155
    s_waitcnt vmcnt(0)
    v_mfma_f32_16x16x32_bf16 v[240:243], v[248:251], v[164:167], 0
    v_mfma_f32_16x16x32_bf16 v[244:247], v[248:251], v[170:173], 0
    v_mfma_f32_16x16x32_bf16 v[176:179], v[80:83], v[164:167], 0
    v_mfma_f32_16x16x32_bf16 v[180:183], v[80:83], v[170:173], 0
    v_mfma_f32_16x16x32_bf16 v[184:187], v[84:87], v[164:167], 0
    v_mfma_f32_16x16x32_bf16 v[188:191], v[84:87], v[170:173], 0
    v_mfma_f32_16x16x32_bf16 v[192:195], v[88:91], v[164:167], 0
    v_mfma_f32_16x16x32_bf16 v[196:199], v[88:91], v[170:173], 0
    v_mfma_f32_16x16x32_bf16 v[200:203], v[92:95], v[164:167], 0
    v_mfma_f32_16x16x32_bf16 v[204:207], v[92:95], v[170:173], 0
    v_mfma_f32_16x16x32_bf16 v[208:211], v[96:99], v[164:167], 0
    v_mfma_f32_16x16x32_bf16 v[212:215], v[96:99], v[170:173], 0
    v_mfma_f32_16x16x32_bf16 v[216:219], v[100:103], v[164:167], 0
    v_mfma_f32_16x16x32_bf16 v[220:223], v[100:103], v[170:173], 0
    v_mfma_f32_16x16x32_bf16 v[224:227], v[104:107], v[164:167], 0
    v_mfma_f32_16x16x32_bf16 v[228:231], v[104:107], v[170:173], 0
    v_mfma_f32_16x16x32_bf16 v[232:235], v[108:111], v[164:167], 0
    v_mfma_f32_16x16x32_bf16 v[236:239], v[108:111], v[170:173], 0
    v_mfma_f32_16x16x16_bf16 v[240:243], v[248:249], v[168:169], v[240:243]
    v_mfma_f32_16x16x16_bf16 v[244:247], v[248:249], v[174:175], v[244:247]
    v_mfma_f32_16x16x16_bf16 v[176:179], v[128:129], v[168:169], v[176:179]
    v_mfma_f32_16x16x16_bf16 v[180:183], v[128:129], v[174:175], v[180:183]
    v_mfma_f32_16x16x16_bf16 v[184:187], v[130:131], v[168:169], v[184:187]
    v_mfma_f32_16x16x16_bf16 v[188:191], v[130:131], v[174:175], v[188:191]
    v_mfma_f32_16x16x16_bf16 v[192:195], v[132:133], v[168:169], v[192:195]
    v_mfma_f32_16x16x16_bf16 v[196:199], v[132:133], v[174:175], v[196:199]
    v_mfma_f32_16x16x16_bf16 v[200:203], v[134:135], v[168:169], v[200:203]
    v_mfma_f32_16x16x16_bf16 v[204:207], v[134:135], v[174:175], v[204:207]
    v_mfma_f32_16x16x16_bf16 v[208:211], v[136:137], v[168:169], v[208:211]
    v_mfma_f32_16x16x16_bf16 v[212:215], v[136:137], v[174:175], v[212:215]
    v_mfma_f32_16x16x16_bf16 v[216:219], v[138:139], v[168:169], v[216:219]
    v_mfma_f32_16x16x16_bf16 v[220:223], v[138:139], v[174:175], v[220:223]
    v_mfma_f32_16x16x16_bf16 v[224:227], v[140:141], v[168:169], v[224:227]
    v_mfma_f32_16x16x16_bf16 v[228:231], v[140:141], v[174:175], v[228:231]
    v_mfma_f32_16x16x16_bf16 v[232:235], v[142:143], v[168:169], v[232:235]
    v_mfma_f32_16x16x16_bf16 v[236:239], v[142:143], v[174:175], v[236:239]
    v_rcp_f32 v8, v240
    v_rcp_f32 v9, v244
    s_nop 7
    v_mul_f32 v176, v176, v8
    v_mul_f32 v177, v177, v8
    v_mul_f32 v178, v178, v8
    v_mul_f32 v179, v179, v8
    v_cvt_pk_bf16_f32 v16, v176, v177
    v_cvt_pk_bf16_f32 v17, v178, v179
    v_mul_f32 v184, v184, v8
    v_mul_f32 v185, v185, v8
    v_mul_f32 v186, v186, v8
    v_mul_f32 v187, v187, v8
    v_cvt_pk_bf16_f32 v18, v184, v185
    v_cvt_pk_bf16_f32 v19, v186, v187
    s_add_u32 s64, s32, 0x0
    buffer_store_dwordx4 v[16:19], v1, s[4:7], s64 offen offset:0 sc1
    v_mul_f32 v192, v192, v8
    v_mul_f32 v193, v193, v8
    v_mul_f32 v194, v194, v8
    v_mul_f32 v195, v195, v8
    v_cvt_pk_bf16_f32 v20, v192, v193
    v_cvt_pk_bf16_f32 v21, v194, v195
    v_mul_f32 v200, v200, v8
    v_mul_f32 v201, v201, v8
    v_mul_f32 v202, v202, v8
    v_mul_f32 v203, v203, v8
    v_cvt_pk_bf16_f32 v22, v200, v201
    v_cvt_pk_bf16_f32 v23, v202, v203
    s_add_u32 s64, s32, 0x0
    buffer_store_dwordx4 v[20:23], v1, s[4:7], s64 offen offset:1024 sc1
    v_mul_f32 v208, v208, v8
    v_mul_f32 v209, v209, v8
    v_mul_f32 v210, v210, v8
    v_mul_f32 v211, v211, v8
    v_cvt_pk_bf16_f32 v24, v208, v209
    v_cvt_pk_bf16_f32 v25, v210, v211
    v_mul_f32 v216, v216, v8
    v_mul_f32 v217, v217, v8
    v_mul_f32 v218, v218, v8
    v_mul_f32 v219, v219, v8
    v_cvt_pk_bf16_f32 v26, v216, v217
    v_cvt_pk_bf16_f32 v27, v218, v219
    s_add_u32 s64, s32, 0x0
    buffer_store_dwordx4 v[24:27], v1, s[4:7], s64 offen offset:2048 sc1
    v_mul_f32 v224, v224, v8
    v_mul_f32 v225, v225, v8
    v_mul_f32 v226, v226, v8
    v_mul_f32 v227, v227, v8
    v_cvt_pk_bf16_f32 v28, v224, v225
    v_cvt_pk_bf16_f32 v29, v226, v227
    v_mul_f32 v232, v232, v8
    v_mul_f32 v233, v233, v8
    v_mul_f32 v234, v234, v8
    v_mul_f32 v235, v235, v8
    v_cvt_pk_bf16_f32 v30, v232, v233
    v_cvt_pk_bf16_f32 v31, v234, v235
    s_add_u32 s64, s32, 0x0
    buffer_store_dwordx4 v[28:31], v1, s[4:7], s64 offen offset:3072 sc1
    v_mul_f32 v180, v180, v9
    v_mul_f32 v181, v181, v9
    v_mul_f32 v182, v182, v9
    v_mul_f32 v183, v183, v9
    v_cvt_pk_bf16_f32 v32, v180, v181
    v_cvt_pk_bf16_f32 v33, v182, v183
    v_mul_f32 v188, v188, v9
    v_mul_f32 v189, v189, v9
    v_mul_f32 v190, v190, v9
    v_mul_f32 v191, v191, v9
    v_cvt_pk_bf16_f32 v34, v188, v189
    v_cvt_pk_bf16_f32 v35, v190, v191
    s_add_u32 s64, s32, 0x20000
    buffer_store_dwordx4 v[32:35], v1, s[4:7], s64 offen offset:0 sc1
    v_mul_f32 v196, v196, v9
    v_mul_f32 v197, v197, v9
    v_mul_f32 v198, v198, v9
    v_mul_f32 v199, v199, v9
    v_cvt_pk_bf16_f32 v36, v196, v197
    v_cvt_pk_bf16_f32 v37, v198, v199
    v_mul_f32 v204, v204, v9
    v_mul_f32 v205, v205, v9
    v_mul_f32 v206, v206, v9
    v_mul_f32 v207, v207, v9
    v_cvt_pk_bf16_f32 v38, v204, v205
    v_cvt_pk_bf16_f32 v39, v206, v207
    s_add_u32 s64, s32, 0x20000
    buffer_store_dwordx4 v[36:39], v1, s[4:7], s64 offen offset:1024 sc1
    v_mul_f32 v212, v212, v9
    v_mul_f32 v213, v213, v9
    v_mul_f32 v214, v214, v9
    v_mul_f32 v215, v215, v9
    v_cvt_pk_bf16_f32 v40, v212, v213
    v_cvt_pk_bf16_f32 v41, v214, v215
    v_mul_f32 v220, v220, v9
    v_mul_f32 v221, v221, v9
    v_mul_f32 v222, v222, v9
    v_mul_f32 v223, v223, v9
    v_cvt_pk_bf16_f32 v42, v220, v221
    v_cvt_pk_bf16_f32 v43, v222, v223
    s_add_u32 s64, s32, 0x20000
    buffer_store_dwordx4 v[40:43], v1, s[4:7], s64 offen offset:2048 sc1
    v_mul_f32 v228, v228, v9
    v_mul_f32 v229, v229, v9
    v_mul_f32 v230, v230, v9
    v_mul_f32 v231, v231, v9
    v_cvt_pk_bf16_f32 v44, v228, v229
    v_cvt_pk_bf16_f32 v45, v230, v231
    v_mul_f32 v236, v236, v9
    v_mul_f32 v237, v237, v9
    v_mul_f32 v238, v238, v9
    v_mul_f32 v239, v239, v9
    v_cvt_pk_bf16_f32 v46, v236, v237
    v_cvt_pk_bf16_f32 v47, v238, v239
    s_add_u32 s64, s32, 0x20000
    buffer_store_dwordx4 v[44:47], v1, s[4:7], s64 offen offset:3072 sc1
    s_waitcnt vmcnt(0)
    v_mov_b32 v7, 1
    v_mov_b32 v8, 0
    s_mov_b64 exec, 1
    buffer_store_dword v7, v8, s[4:7], s33 offen sc1
    s_mov_b64 exec, -1
    s_add_u32 s24, s24, 8
    s_add_u32 s25, s25, 1
    s_cmp_lt_u32 s25, 1
    s_cbranch_scc1 AT0_LOOP
AT0_END:
    s_lshl_b32 s70, s13, 1
    s_add_u32 s70, s70, s12
    s_load_dwordx2 s[44:45], s[0:1], 72
    s_mov_b32 s46, 0x21c000
    s_mov_b32 s47, 0x00020000
    s_load_dwordx2 s[48:49], s[0:1], 80
    s_mov_b32 s50, 0x21c000
    s_mov_b32 s51, 0x00020000
    s_load_dwordx2 s[52:53], s[0:1], 88
    s_mov_b32 s54, 0x21c000
    s_mov_b32 s55, 0x00020000
    s_mov_b32 s29, 0
    s_waitcnt lgkmcnt(0)
    v_mbcnt_lo_u32_b32 v0, -1, 0
    v_mbcnt_hi_u32_b32 v0, -1, v0
    s_lshl_b32 s24, s70, 2
    s_add_u32 s24, s24, s14
    s_cmp_ge_u32 s24, 108
    s_cbranch_scc1 H_A1
    v_mov_b32 v8, 0
    s_mov_b32 s64, 0x298000
F1W_186:
    buffer_load_dword v7, v8, s[4:7], s64 offen sc1
    s_add_u32 s29, s29, 1
    s_waitcnt vmcnt(0)
    v_cmp_gt_u32 vcc, 1, v7
    s_cbranch_vccz F1WD_187
    s_cmp_gt_u32 s29, 262144
    s_cbranch_scc1 F1WD_187
    s_sleep 8
    s_branch F1W_186
F1WD_187:
    s_mul_i32 s25, s14, 40960
    v_lshrrev_b32 v7, 1, v0
    v_mul_u32_u24 v2, 3456, v7
    v_and_b32 v7, 1, v0
    v_lshl_add_u32 v2, v7, 4, v2
    v_lshrrev_b32 v7, 4, v0
    v_lshlrev_b32 v3, 8, v7
    v_bfe_u32 v7, v0, 2, 2
    v_lshl_add_u32 v3, v7, 5, v3
    v_and_b32 v7, 3, v0
    v_lshl_add_u32 v3, v7, 3, v3
    v_add_u32 v3, s25, v3
    v_and_b32 v7, 7, v0
    v_lshlrev_b32 v7, 2, v7
    s_mov_b32 s64, 0x5400000
    buffer_load_dword v4, v7, s[4:7], s64 offen sc1
    s_waitcnt vmcnt(0)
    v_mul_u32_u24 v4, 1280, v4
    v_lshrrev_b32 v7, 4, v0
    v_lshl_add_u32 v4, v7, 4, v4
    s_mov_b32 s65, 0x0
    buffer_load_dwordx4 v[16:19], v4, s[4:7], s65 offen offset:0 sc1
    buffer_load_dwordx4 v[20:23], v4, s[4:7], s65 offen offset:64 sc1
    buffer_load_dwordx4 v[24:27], v4, s[4:7], s65 offen offset:128 sc1
    buffer_load_dwordx4 v[28:31], v4, s[4:7], s65 offen offset:192 sc1
    buffer_load_dwordx4 v[32:35], v4, s[4:7], s65 offen offset:256 sc1
    buffer_load_dwordx4 v[36:39], v4, s[4:7], s65 offen offset:320 sc1
    buffer_load_dwordx4 v[40:43], v4, s[4:7], s65 offen offset:384 sc1
    buffer_load_dwordx4 v[44:47], v4, s[4:7], s65 offen offset:448 sc1
    buffer_load_dwordx4 v[48:51], v4, s[4:7], s65 offen offset:512 sc1
    buffer_load_dwordx4 v[52:55], v4, s[4:7], s65 offen offset:576 sc1
    buffer_load_dwordx4 v[56:59], v4, s[4:7], s65 offen offset:640 sc1
    buffer_load_dwordx4 v[60:63], v4, s[4:7], s65 offen offset:704 sc1
    buffer_load_dwordx4 v[64:67], v4, s[4:7], s65 offen offset:768 sc1
    buffer_load_dwordx4 v[68:71], v4, s[4:7], s65 offen offset:832 sc1
    buffer_load_dwordx4 v[72:75], v4, s[4:7], s65 offen offset:896 sc1
    buffer_load_dwordx4 v[76:79], v4, s[4:7], s65 offen offset:960 sc1
    buffer_load_dwordx4 v[80:83], v4, s[4:7], s65 offen offset:1024 sc1
    buffer_load_dwordx4 v[84:87], v4, s[4:7], s65 offen offset:1088 sc1
    buffer_load_dwordx4 v[88:91], v4, s[4:7], s65 offen offset:1152 sc1
    buffer_load_dwordx4 v[92:95], v4, s[4:7], s65 offen offset:1216 sc1
    s_lshl_b32 s26, s24, 5
    s_add_u32 m0, s25, 0
    s_add_u32 s64, s26, 0x0
    buffer_load_dwordx4 v2, s[44:47], s64 offen lds
    s_add_u32 m0, s25, 1024
    s_add_u32 s64, s26, 0x1b000
    buffer_load_dwordx4 v2, s[44:47], s64 offen lds
    s_add_u32 m0, s25, 2048
    s_add_u32 s64, s26, 0x36000
    buffer_load_dwordx4 v2, s[44:47], s64 offen lds
    s_add_u32 m0, s25, 3072
    s_add_u32 s64, s26, 0x51000
    buffer_load_dwordx4 v2, s[44:47], s64 offen lds
    s_add_u32 m0, s25, 4096
    s_add_u32 s64, s26, 0x6c000
    buffer_load_dwordx4 v2, s[44:47], s64 offen lds
    s_add_u32 m0, s25, 5120
    s_add_u32 s64, s26, 0x87000
    buffer_load_dwordx4 v2, s[44:47], s64 offen lds
    s_add_u32 m0, s25, 6144
    s_add_u32 s64, s26, 0xa2000
    buffer_load_dwordx4 v2, s[44:47], s64 offen lds
    s_add_u32 m0, s25, 7168
    s_add_u32 s64, s26, 0xbd000
    buffer_load_dwordx4 v2, s[44:47], s64 offen lds
    s_add_u32 m0, s25, 8192
    s_add_u32 s64, s26, 0xd8000
    buffer_load_dwordx4 v2, s[44:47], s64 offen lds
    s_add_u32 m0, s25, 9216
    s_add_u32 s64, s26, 0xf3000
    buffer_load_dwordx4 v2, s[44:47], s64 offen lds
    s_add_u32 m0, s25, 10240
    s_add_u32 s64, s26, 0x10e000
    buffer_load_dwordx4 v2, s[44:47], s64 offen lds
    s_add_u32 m0, s25, 11264
    s_add_u32 s64, s26, 0x129000
    buffer_load_dwordx4 v2, s[44:47], s64 offen lds
    s_add_u32 m0, s25, 12288
    s_add_u32 s64, s26, 0x144000
    buffer_load_dwordx4 v2, s[44:47], s64 offen lds
    s_add_u32 m0, s25, 13312
    s_add_u32 s64, s26, 0x15f000
    buffer_load_dwordx4 v2, s[44:47], s64 offen lds
    s_add_u32 m0, s25, 14336
    s_add_u32 s64, s26, 0x17a000
    buffer_load_dwordx4 v2, s[44:47], s64 offen lds
    s_add_u32 m0, s25, 15360
    s_add_u32 s64, s26, 0x195000
    buffer_load_dwordx4 v2, s[44:47], s64 offen lds
    s_add_u32 m0, s25, 16384
    s_add_u32 s64, s26, 0x1b0000
    buffer_load_dwordx4 v2, s[44:47], s64 offen lds
    s_add_u32 m0, s25, 17408
    s_add_u32 s64, s26, 0x1cb000
    buffer_load_dwordx4 v2, s[44:47], s64 offen lds
    s_add_u32 m0, s25, 18432
    s_add_u32 s64, s26, 0x1e6000
    buffer_load_dwordx4 v2, s[44:47], s64 offen lds
    s_add_u32 m0, s25, 19456
    s_add_u32 s64, s26, 0x201000
    buffer_load_dwordx4 v2, s[44:47], s64 offen lds
    s_waitcnt vmcnt(0)
    ds_read_b64_tr_b16 v[96:97], v3 offset:0
    ds_read_b64_tr_b16 v[98:99], v3 offset:128
    ds_read_b64_tr_b16 v[100:101], v3 offset:1024
    ds_read_b64_tr_b16 v[102:103], v3 offset:1152
    ds_read_b64_tr_b16 v[104:105], v3 offset:2048
    ds_read_b64_tr_b16 v[106:107], v3 offset:2176
    ds_read_b64_tr_b16 v[108:109], v3 offset:3072
    ds_read_b64_tr_b16 v[110:111], v3 offset:3200
    ds_read_b64_tr_b16 v[112:113], v3 offset:4096
    ds_read_b64_tr_b16 v[114:115], v3 offset:4224
    ds_read_b64_tr_b16 v[116:117], v3 offset:5120
    ds_read_b64_tr_b16 v[118:119], v3 offset:5248
    s_waitcnt lgkmcnt(4)
    ds_read_b64_tr_b16 v[120:121], v3 offset:6144
    ds_read_b64_tr_b16 v[122:123], v3 offset:6272
    ds_read_b64_tr_b16 v[124:125], v3 offset:7168
    ds_read_b64_tr_b16 v[126:127], v3 offset:7296
    ds_read_b64_tr_b16 v[128:129], v3 offset:8192
    ds_read_b64_tr_b16 v[130:131], v3 offset:8320
    ds_read_b64_tr_b16 v[132:133], v3 offset:9216
    ds_read_b64_tr_b16 v[134:135], v3 offset:9344
    ds_read_b64_tr_b16 v[136:137], v3 offset:10240
    ds_read_b64_tr_b16 v[138:139], v3 offset:10368
    ds_read_b64_tr_b16 v[140:141], v3 offset:11264
    ds_read_b64_tr_b16 v[142:143], v3 offset:11392
    s_waitcnt lgkmcnt(4)
    ds_read_b64_tr_b16 v[144:145], v3 offset:12288
    ds_read_b64_tr_b16 v[146:147], v3 offset:12416
    ds_read_b64_tr_b16 v[148:149], v3 offset:13312
    ds_read_b64_tr_b16 v[150:151], v3 offset:13440
    ds_read_b64_tr_b16 v[152:153], v3 offset:14336
    ds_read_b64_tr_b16 v[154:155], v3 offset:14464
    ds_read_b64_tr_b16 v[156:157], v3 offset:15360
    ds_read_b64_tr_b16 v[158:159], v3 offset:15488
    ds_read_b64_tr_b16 v[160:161], v3 offset:16384
    ds_read_b64_tr_b16 v[162:163], v3 offset:16512
    ds_read_b64_tr_b16 v[164:165], v3 offset:17408
    ds_read_b64_tr_b16 v[166:167], v3 offset:17536
    s_waitcnt lgkmcnt(4)
    ds_read_b64_tr_b16 v[168:169], v3 offset:18432
    ds_read_b64_tr_b16 v[170:171], v3 offset:18560
    ds_read_b64_tr_b16 v[172:173], v3 offset:19456
    ds_read_b64_tr_b16 v[174:175], v3 offset:19584
    s_waitcnt lgkmcnt(0)
    s_add_u32 s25, s25, 20480
    v_add_u32 v3, 20480, v3
    s_add_u32 m0, s25, 0
    s_add_u32 s64, s26, 0x0
    buffer_load_dwordx4 v2, s[48:51], s64 offen lds
    s_add_u32 m0, s25, 1024
    s_add_u32 s64, s26, 0x1b000
    buffer_load_dwordx4 v2, s[48:51], s64 offen lds
    s_add_u32 m0, s25, 2048
    s_add_u32 s64, s26, 0x36000
    buffer_load_dwordx4 v2, s[48:51], s64 offen lds
    s_add_u32 m0, s25, 3072
    s_add_u32 s64, s26, 0x51000
    buffer_load_dwordx4 v2, s[48:51], s64 offen lds
    s_add_u32 m0, s25, 4096
    s_add_u32 s64, s26, 0x6c000
    buffer_load_dwordx4 v2, s[48:51], s64 offen lds
    s_add_u32 m0, s25, 5120
    s_add_u32 s64, s26, 0x87000
    buffer_load_dwordx4 v2, s[48:51], s64 offen lds
    s_add_u32 m0, s25, 6144
    s_add_u32 s64, s26, 0xa2000
    buffer_load_dwordx4 v2, s[48:51], s64 offen lds
    s_add_u32 m0, s25, 7168
    s_add_u32 s64, s26, 0xbd000
    buffer_load_dwordx4 v2, s[48:51], s64 offen lds
    s_add_u32 m0, s25, 8192
    s_add_u32 s64, s26, 0xd8000
    buffer_load_dwordx4 v2, s[48:51], s64 offen lds
    s_add_u32 m0, s25, 9216
    s_add_u32 s64, s26, 0xf3000
    buffer_load_dwordx4 v2, s[48:51], s64 offen lds
    s_add_u32 m0, s25, 10240
    s_add_u32 s64, s26, 0x10e000
    buffer_load_dwordx4 v2, s[48:51], s64 offen lds
    s_add_u32 m0, s25, 11264
    s_add_u32 s64, s26, 0x129000
    buffer_load_dwordx4 v2, s[48:51], s64 offen lds
    s_add_u32 m0, s25, 12288
    s_add_u32 s64, s26, 0x144000
    buffer_load_dwordx4 v2, s[48:51], s64 offen lds
    s_add_u32 m0, s25, 13312
    s_add_u32 s64, s26, 0x15f000
    buffer_load_dwordx4 v2, s[48:51], s64 offen lds
    s_add_u32 m0, s25, 14336
    s_add_u32 s64, s26, 0x17a000
    buffer_load_dwordx4 v2, s[48:51], s64 offen lds
    s_add_u32 m0, s25, 15360
    s_add_u32 s64, s26, 0x195000
    buffer_load_dwordx4 v2, s[48:51], s64 offen lds
    s_add_u32 m0, s25, 16384
    s_add_u32 s64, s26, 0x1b0000
    buffer_load_dwordx4 v2, s[48:51], s64 offen lds
    s_add_u32 m0, s25, 17408
    s_add_u32 s64, s26, 0x1cb000
    buffer_load_dwordx4 v2, s[48:51], s64 offen lds
    s_add_u32 m0, s25, 18432
    s_add_u32 s64, s26, 0x1e6000
    buffer_load_dwordx4 v2, s[48:51], s64 offen lds
    s_add_u32 m0, s25, 19456
    s_add_u32 s64, s26, 0x201000
    buffer_load_dwordx4 v2, s[48:51], s64 offen lds
    s_waitcnt vmcnt(0)
    ds_read_b64_tr_b16 v[176:177], v3 offset:0
    ds_read_b64_tr_b16 v[178:179], v3 offset:128
    ds_read_b64_tr_b16 v[180:181], v3 offset:1024
    ds_read_b64_tr_b16 v[182:183], v3 offset:1152
    ds_read_b64_tr_b16 v[184:185], v3 offset:2048
    ds_read_b64_tr_b16 v[186:187], v3 offset:2176
    ds_read_b64_tr_b16 v[188:189], v3 offset:3072
    ds_read_b64_tr_b16 v[190:191], v3 offset:3200
    ds_read_b64_tr_b16 v[192:193], v3 offset:4096
    ds_read_b64_tr_b16 v[194:195], v3 offset:4224
    ds_read_b64_tr_b16 v[196:197], v3 offset:5120
    ds_read_b64_tr_b16 v[198:199], v3 offset:5248
    s_waitcnt lgkmcnt(4)
    ds_read_b64_tr_b16 v[200:201], v3 offset:6144
    ds_read_b64_tr_b16 v[202:203], v3 offset:6272
    ds_read_b64_tr_b16 v[204:205], v3 offset:7168
    ds_read_b64_tr_b16 v[206:207], v3 offset:7296
    ds_read_b64_tr_b16 v[208:209], v3 offset:8192
    ds_read_b64_tr_b16 v[210:211], v3 offset:8320
    ds_read_b64_tr_b16 v[212:213], v3 offset:9216
    ds_read_b64_tr_b16 v[214:215], v3 offset:9344
    ds_read_b64_tr_b16 v[216:217], v3 offset:10240
    ds_read_b64_tr_b16 v[218:219], v3 offset:10368
    ds_read_b64_tr_b16 v[220:221], v3 offset:11264
    ds_read_b64_tr_b16 v[222:223], v3 offset:11392
    s_waitcnt lgkmcnt(4)
    ds_read_b64_tr_b16 v[224:225], v3 offset:12288
    ds_read_b64_tr_b16 v[226:227], v3 offset:12416
    ds_read_b64_tr_b16 v[228:229], v3 offset:13312
    ds_read_b64_tr_b16 v[230:231], v3 offset:13440
    ds_read_b64_tr_b16 v[232:233], v3 offset:14336
    ds_read_b64_tr_b16 v[234:235], v3 offset:14464
    ds_read_b64_tr_b16 v[236:237], v3 offset:15360
    ds_read_b64_tr_b16 v[238:239], v3 offset:15488
    ds_read_b64_tr_b16 v[240:241], v3 offset:16384
    ds_read_b64_tr_b16 v[242:243], v3 offset:16512
    ds_read_b64_tr_b16 v[244:245], v3 offset:17408
    ds_read_b64_tr_b16 v[246:247], v3 offset:17536
    s_waitcnt lgkmcnt(4)
    ds_read_b64_tr_b16 v[248:249], v3 offset:18432
    ds_read_b64_tr_b16 v[250:251], v3 offset:18560
    ds_read_b64_tr_b16 v[252:253], v3 offset:19456
    ds_read_b64_tr_b16 v[254:255], v3 offset:19584
    s_waitcnt lgkmcnt(0)
    v_mfma_f32_16x16x32_bf16 v[8:11], v[96:99], v[16:19], 0
    v_mfma_f32_16x16x32_bf16 v[12:15], v[176:179], v[16:19], 0
    v_mfma_f32_16x16x32_bf16 v[8:11], v[100:103], v[20:23], v[8:11]
    v_mfma_f32_16x16x32_bf16 v[12:15], v[180:183], v[20:23], v[12:15]
    v_mfma_f32_16x16x32_bf16 v[8:11], v[104:107], v[24:27], v[8:11]
    v_mfma_f32_16x16x32_bf16 v[12:15], v[184:187], v[24:27], v[12:15]
    v_mfma_f32_16x16x32_bf16 v[8:11], v[108:111], v[28:31], v[8:11]
    v_mfma_f32_16x16x32_bf16 v[12:15], v[188:191], v[28:31], v[12:15]
    v_mfma_f32_16x16x32_bf16 v[8:11], v[112:115], v[32:35], v[8:11]
    v_mfma_f32_16x16x32_bf16 v[12:15], v[192:195], v[32:35], v[12:15]
    v_mfma_f32_16x16x32_bf16 v[8:11], v[116:119], v[36:39], v[8:11]
    v_mfma_f32_16x16x32_bf16 v[12:15], v[196:199], v[36:39], v[12:15]
    v_mfma_f32_16x16x32_bf16 v[8:11], v[120:123], v[40:43], v[8:11]
    v_mfma_f32_16x16x32_bf16 v[12:15], v[200:203], v[40:43], v[12:15]
    v_mfma_f32_16x16x32_bf16 v[8:11], v[124:127], v[44:47], v[8:11]
    v_mfma_f32_16x16x32_bf16 v[12:15], v[204:207], v[44:47], v[12:15]
    v_mfma_f32_16x16x32_bf16 v[8:11], v[128:131], v[48:51], v[8:11]
    v_mfma_f32_16x16x32_bf16 v[12:15], v[208:211], v[48:51], v[12:15]
    v_mfma_f32_16x16x32_bf16 v[8:11], v[132:135], v[52:55], v[8:11]
    v_mfma_f32_16x16x32_bf16 v[12:15], v[212:215], v[52:55], v[12:15]
    v_mfma_f32_16x16x32_bf16 v[8:11], v[136:139], v[56:59], v[8:11]
    v_mfma_f32_16x16x32_bf16 v[12:15], v[216:219], v[56:59], v[12:15]
    v_mfma_f32_16x16x32_bf16 v[8:11], v[140:143], v[60:63], v[8:11]
    v_mfma_f32_16x16x32_bf16 v[12:15], v[220:223], v[60:63], v[12:15]
    v_mfma_f32_16x16x32_bf16 v[8:11], v[144:147], v[64:67], v[8:11]
    v_mfma_f32_16x16x32_bf16 v[12:15], v[224:227], v[64:67], v[12:15]
    v_mfma_f32_16x16x32_bf16 v[8:11], v[148:151], v[68:71], v[8:11]
    v_mfma_f32_16x16x32_bf16 v[12:15], v[228:231], v[68:71], v[12:15]
    v_mfma_f32_16x16x32_bf16 v[8:11], v[152:155], v[72:75], v[8:11]
    v_mfma_f32_16x16x32_bf16 v[12:15], v[232:235], v[72:75], v[12:15]
    v_mfma_f32_16x16x32_bf16 v[8:11], v[156:159], v[76:79], v[8:11]
    v_mfma_f32_16x16x32_bf16 v[12:15], v[236:239], v[76:79], v[12:15]
    v_mfma_f32_16x16x32_bf16 v[8:11], v[160:163], v[80:83], v[8:11]
    v_mfma_f32_16x16x32_bf16 v[12:15], v[240:243], v[80:83], v[12:15]
    v_mfma_f32_16x16x32_bf16 v[8:11], v[164:167], v[84:87], v[8:11]
    v_mfma_f32_16x16x32_bf16 v[12:15], v[244:247], v[84:87], v[12:15]
    v_mfma_f32_16x16x32_bf16 v[8:11], v[168:171], v[88:91], v[8:11]
    v_mfma_f32_16x16x32_bf16 v[12:15], v[248:251], v[88:91], v[12:15]
    v_mfma_f32_16x16x32_bf16 v[8:11], v[172:175], v[92:95], v[8:11]
    v_mfma_f32_16x16x32_bf16 v[12:15], v[252:255], v[92:95], v[12:15]
    s_nop 7
    v_cvt_pk_bf16_f32 v8, v8, v8
    v_lshlrev_b32 v8, 16, v8
    v_cvt_pk_bf16_f32 v12, v12, v12
    v_lshlrev_b32 v12, 16, v12
    v_mul_f32 v16, 0xbfb8aa3b, v8
    v_exp_f32 v16, v16
    s_nop 0
    v_add_f32 v16, 1.0, v16
    v_rcp_f32 v16, v16
    s_nop 0
    v_mul_f32 v8, v8, v16
    v_cvt_pk_bf16_f32 v8, v8, v8
    v_lshlrev_b32 v8, 16, v8
    v_mul_f32 v8, v8, v12
    v_cvt_pk_bf16_f32 v9, v9, v9
    v_lshlrev_b32 v9, 16, v9
    v_cvt_pk_bf16_f32 v13, v13, v13
    v_lshlrev_b32 v13, 16, v13
    v_mul_f32 v17, 0xbfb8aa3b, v9
    v_exp_f32 v17, v17
    s_nop 0
    v_add_f32 v17, 1.0, v17
    v_rcp_f32 v17, v17
    s_nop 0
    v_mul_f32 v9, v9, v17
    v_cvt_pk_bf16_f32 v9, v9, v9
    v_lshlrev_b32 v9, 16, v9
    v_mul_f32 v9, v9, v13
    v_cvt_pk_bf16_f32 v10, v10, v10
    v_lshlrev_b32 v10, 16, v10
    v_cvt_pk_bf16_f32 v14, v14, v14
    v_lshlrev_b32 v14, 16, v14
    v_mul_f32 v18, 0xbfb8aa3b, v10
    v_exp_f32 v18, v18
    s_nop 0
    v_add_f32 v18, 1.0, v18
    v_rcp_f32 v18, v18
    s_nop 0
    v_mul_f32 v10, v10, v18
    v_cvt_pk_bf16_f32 v10, v10, v10
    v_lshlrev_b32 v10, 16, v10
    v_mul_f32 v10, v10, v14
    v_cvt_pk_bf16_f32 v11, v11, v11
    v_lshlrev_b32 v11, 16, v11
    v_cvt_pk_bf16_f32 v15, v15, v15
    v_lshlrev_b32 v15, 16, v15
    v_mul_f32 v19, 0xbfb8aa3b, v11
    v_exp_f32 v19, v19
    s_nop 0
    v_add_f32 v19, 1.0, v19
    v_rcp_f32 v19, v19
    s_nop 0
    v_mul_f32 v11, v11, v19
    v_cvt_pk_bf16_f32 v11, v11, v11
    v_lshlrev_b32 v11, 16, v11
    v_mul_f32 v11, v11, v15
    v_cvt_pk_bf16_f32 v16, v8, v9
    v_cvt_pk_bf16_f32 v17, v10, v11
    s_lshr_b32 s65, s24, 1
    s_lshl_b32 s65, s65, 10
    s_and_b32 s66, s24, 1
    s_lshl_b32 s66, s66, 3
    s_add_u32 s65, s65, s66
    s_add_u32 s65, s65, 0x5401000
    v_lshlrev_b32 v4, 4, v0
    buffer_store_dwordx2 v[16:17], v4, s[4:7], s65 offen sc1
    s_waitcnt vmcnt(0)
    v_mov_b32 v7, 1
    v_mov_b32 v8, 0
    s_mov_b32 s64, 0x298080
    s_mov_b64 exec, 1
    buffer_atomic_add v7, v8, s[4:7], s64 offen sc1
    s_mov_b64 exec, -1
H_A1:
    v_mbcnt_lo_u32_b32 v0, -1, 0
    v_mbcnt_hi_u32_b32 v0, -1, v0
    s_mov_b32 s29, 0
    v_lshlrev_b32 v1, 4, v0
    v_lshrrev_b32 v5, 4, v0
    v_lshlrev_b32 v2, 7, v5
    v_and_b32 v5, 7, v0
    v_lshl_add_u32 v2, v5, 4, v2
    v_bfe_u32 v5, v0, 4, 1
    v_lshlrev_b32 v3, 7, v5
    v_and_b32 v5, 15, v0
    v_lshl_add_u32 v3, v5, 3, v3
    s_mov_b32 s34, 0x3e0293ee
    s_mov_b32 s35, 0x3e0293ee
    s_mov_b32 s36, -1
    s_mov_b32 s37, 0
    v_lshrrev_b32 v5, 4, v0
    v_lshlrev_b32 v5, 2, v5
    v_and_b32 v6, 15, v0
    v_add_u32 v7, 0, v5
    v_cmp_le_u32 s[38:39], v7, v6
    v_add_u32 v7, 1, v5
    v_cmp_le_u32 s[40:41], v7, v6
    v_add_u32 v7, 2, v5
    v_cmp_le_u32 s[42:43], v7, v6
    v_add_u32 v7, 3, v5
    v_cmp_le_u32 s[44:45], v7, v6
    v_mov_b32 v248, 0x3f803f80
    v_mov_b32 v249, 0x3f803f80
    v_mov_b32 v250, 0x3f803f80
    v_mov_b32 v251, 0x3f803f80
    s_lshl_b32 s24, s12, 2
    s_add_u32 s24, s24, s14
    s_add_u32 s24, s24, 8
    s_mov_b32 s25, 1
AT1_LOOP:
    s_cmp_eq_u32 s24, 63
    s_cbranch_scc1 AT1_END
    s_lshl_b32 s64, s24, 5
    s_add_u32 s64, s64, s13
    s_lshl_b32 s26, s64, 13
    s_add_u32 s26, s26, 0x3400000
    s_lshl_b32 s27, s64, 14
    s_add_u32 s27, s27, 0x1400000
    s_lshl_b32 s65, s64, 11
    s_add_u32 s30, s65, 0x640000
    s_add_u32 s31, s65, 0xa40000
    s_lshl_b32 s33, s64, 2
    s_add_u32 s33, s33, 0x296000
    s_lshl_b32 s32, s24, 18
    s_lshl_b32 s65, s13, 12
    s_add_u32 s32, s32, s65
    s_add_u32 s32, s32, 0x4400000
    s_lshr_b32 s65, s24, 2
    s_lshl_b32 s65, s65, 9
    s_lshl_b32 s66, s13, 4
    s_add_u32 s65, s65, s66
    s_add_u32 s65, s65, 0x291000
    s_lshr_b32 s66, s24, 1
    s_lshl_b32 s66, s66, 8
    s_lshl_b32 s64, s13, 3
    s_add_u32 s66, s66, s64
    s_add_u32 s66, s66, 0x293ff4
    v_lshlrev_b32 v5, 2, v0
    v_mov_b32 v6, s65
    v_mov_b32 v7, s66
    v_cmp_gt_u32 vcc, 3, v0
    s_nop 1
    v_cndmask_b32 v6, v7, v6, vcc
    v_add_u32 v4, v5, v6
    s_mov_b32 s64, 0
    s_mov_b64 exec, 7
AT1_F_188:
    buffer_load_dword v5, v4, s[4:7], s64 offen sc1
    s_add_u32 s29, s29, 1
    s_waitcnt vmcnt(0)
    v_cmp_eq_u32 vcc, 0, v5
    s_cbranch_vccz AT1_FD_189
    s_cmp_gt_u32 s29, 262144
    s_cbranch_scc1 AT1_FD_189
    s_sleep 1
    s_branch AT1_F_188
AT1_FD_189:
    s_mov_b64 exec, -1
    buffer_load_dwordx4 v[16:19], v1, s[4:7], s26 offen offset:0
    buffer_load_dwordx4 v[20:23], v1, s[4:7], s26 offen offset:1024
    buffer_load_dwordx4 v[24:27], v1, s[4:7], s26 offen offset:2048
    buffer_load_dwordx4 v[28:31], v1, s[4:7], s26 offen offset:3072
    s_add_u32 s26, s26, 4096
    buffer_load_dwordx4 v[32:35], v1, s[4:7], s26 offen offset:0
    buffer_load_dwordx4 v[36:39], v1, s[4:7], s26 offen offset:1024
    buffer_load_dwordx4 v[40:43], v1, s[4:7], s26 offen offset:2048
    buffer_load_dwordx4 v[44:47], v1, s[4:7], s26 offen offset:3072
    buffer_load_dwordx4 v[48:51], v1, s[4:7], s27 offen offset:0
    buffer_load_dwordx4 v[52:55], v1, s[4:7], s27 offen offset:1024
    buffer_load_dwordx4 v[56:59], v1, s[4:7], s27 offen offset:2048
    buffer_load_dwordx4 v[60:63], v1, s[4:7], s27 offen offset:3072
    s_add_u32 s27, s27, 4096
    buffer_load_dwordx4 v[64:67], v1, s[4:7], s27 offen offset:0
    buffer_load_dwordx4 v[68:71], v1, s[4:7], s27 offen offset:1024
    buffer_load_dwordx4 v[72:75], v1, s[4:7], s27 offen offset:2048
    buffer_load_dwordx4 v[76:79], v1, s[4:7], s27 offen offset:3072
    s_add_u32 s27, s27, 4096
    buffer_load_dwordx4 v[80:83], v1, s[4:7], s27 offen offset:0
    buffer_load_dwordx4 v[84:87], v1, s[4:7], s27 offen offset:1024
    buffer_load_dwordx4 v[88:91], v1, s[4:7], s27 offen offset:2048
    buffer_load_dwordx4 v[92:95], v1, s[4:7], s27 offen offset:3072
    s_add_u32 s27, s27, 4096
    buffer_load_dwordx4 v[96:99], v1, s[4:7], s27 offen offset:0
    buffer_load_dwordx4 v[100:103], v1, s[4:7], s27 offen offset:1024
    buffer_load_dwordx4 v[104:107], v1, s[4:7], s27 offen offset:2048
    buffer_load_dwordx4 v[108:111], v1, s[4:7], s27 offen offset:3072
    s_mov_b64 exec, 0x18
AT1_G_190:
    buffer_load_dword v5, v4, s[4:7], s64 offen sc1
    s_add_u32 s29, s29, 1
    s_waitcnt vmcnt(0)
    v_cmp_eq_u32 vcc, 0, v5
    s_cbranch_vccz AT1_GD_191
    s_cmp_gt_u32 s29, 262144
    s_cbranch_scc1 AT1_GD_191
    s_sleep 1
    s_branch AT1_G_190
AT1_GD_191:
    s_mov_b64 exec, -1
    buffer_load_dwordx4 v[112:115], v2, s[4:7], s30 offen offset:0
    buffer_load_dwordx4 v[116:119], v2, s[4:7], s30 offen offset:512
    buffer_load_dwordx4 v[120:123], v2, s[4:7], s30 offen offset:1024
    buffer_load_dwordx4 v[124:127], v2, s[4:7], s30 offen offset:1536
    buffer_load_dwordx2 v[128:129], v3, s[4:7], s31 offen offset:0
    buffer_load_dwordx2 v[130:131], v3, s[4:7], s31 offen offset:256
    buffer_load_dwordx2 v[132:133], v3, s[4:7], s31 offen offset:512
    buffer_load_dwordx2 v[134:135], v3, s[4:7], s31 offen offset:768
    buffer_load_dwordx2 v[136:137], v3, s[4:7], s31 offen offset:1024
    buffer_load_dwordx2 v[138:139], v3, s[4:7], s31 offen offset:1280
    buffer_load_dwordx2 v[140:141], v3, s[4:7], s31 offen offset:1536
    buffer_load_dwordx2 v[142:143], v3, s[4:7], s31 offen offset:1792
    v_mfma_f32_16x16x32_bf16 v[148:151], v[48:51], v[16:19], 0
    v_mfma_f32_16x16x32_bf16 v[156:159], v[48:51], v[32:35], 0
    v_mfma_f32_16x16x32_bf16 v[160:163], v[64:67], v[32:35], 0
    v_mfma_f32_16x16x32_bf16 v[148:151], v[52:55], v[20:23], v[148:151]
    v_mfma_f32_16x16x32_bf16 v[156:159], v[52:55], v[36:39], v[156:159]
    v_mfma_f32_16x16x32_bf16 v[160:163], v[68:71], v[36:39], v[160:163]
    v_mfma_f32_16x16x32_bf16 v[148:151], v[56:59], v[24:27], v[148:151]
    v_mfma_f32_16x16x32_bf16 v[156:159], v[56:59], v[40:43], v[156:159]
    v_mfma_f32_16x16x32_bf16 v[160:163], v[72:75], v[40:43], v[160:163]
    v_mfma_f32_16x16x32_bf16 v[148:151], v[60:63], v[28:31], v[148:151]
    v_mfma_f32_16x16x32_bf16 v[156:159], v[60:63], v[44:47], v[156:159]
    v_mfma_f32_16x16x32_bf16 v[160:163], v[76:79], v[44:47], v[160:163]
    s_waitcnt vmcnt(8)
    v_mfma_f32_16x16x32_bf16 v[144:147], v[112:115], v[16:19], 0
    v_mfma_f32_16x16x32_bf16 v[152:155], v[112:115], v[32:35], 0
    v_mfma_f32_16x16x32_bf16 v[144:147], v[116:119], v[20:23], v[144:147]
    v_mfma_f32_16x16x32_bf16 v[152:155], v[116:119], v[36:39], v[152:155]
    v_mfma_f32_16x16x32_bf16 v[144:147], v[120:123], v[24:27], v[144:147]
    v_mfma_f32_16x16x32_bf16 v[152:155], v[120:123], v[40:43], v[152:155]
    v_mfma_f32_16x16x32_bf16 v[144:147], v[124:127], v[28:31], v[144:147]
    v_mfma_f32_16x16x32_bf16 v[152:155], v[124:127], v[44:47], v[152:155]
    v_mov_b32 v11, 0xff800000
    s_nop 7
    v_cndmask_b32 v148, v11, v148, s[38:39]
    v_cndmask_b32 v160, v11, v160, s[38:39]
    v_cndmask_b32 v144, v11, v144, s[36:37]
    v_cndmask_b32 v152, v11, v152, s[36:37]
    v_cndmask_b32 v149, v11, v149, s[40:41]
    v_cndmask_b32 v161, v11, v161, s[40:41]
    v_cndmask_b32 v145, v11, v145, s[36:37]
    v_cndmask_b32 v153, v11, v153, s[36:37]
    v_cndmask_b32 v150, v11, v150, s[42:43]
    v_cndmask_b32 v162, v11, v162, s[42:43]
    v_cndmask_b32 v146, v11, v146, s[36:37]
    v_cndmask_b32 v154, v11, v154, s[36:37]
    v_cndmask_b32 v151, v11, v151, s[44:45]
    v_cndmask_b32 v163, v11, v163, s[44:45]
    v_cndmask_b32 v147, v11, v147, s[36:37]
    v_cndmask_b32 v155, v11, v155, s[36:37]
    v_max3_f32 v8, v144, v145, v146
    v_max3_f32 v8, v8, v147, v148
    v_max3_f32 v8, v8, v149, v150
    v_max_f32 v8, v8, v151
    v_mov_b32 v9, v8
    s_nop 1
    v_permlane16_swap_b32 v8, v9
    v_max_f32 v8, v8, v9
    v_mov_b32 v9, v8
    s_nop 1
    v_permlane32_swap_b32 v8, v9
    v_max_f32 v8, v8, v9
    v_mul_f32 v8, s34, v8
    v_fma_f32 v144, v144, s34, -v8
    v_fma_f32 v145, v145, s34, -v8
    v_fma_f32 v146, v146, s34, -v8
    v_fma_f32 v147, v147, s34, -v8
    v_fma_f32 v148, v148, s34, -v8
    v_fma_f32 v149, v149, s34, -v8
    v_fma_f32 v150, v150, s34, -v8
    v_fma_f32 v151, v151, s34, -v8
    v_exp_f32 v144, v144
    v_exp_f32 v145, v145
    v_exp_f32 v146, v146
    v_exp_f32 v147, v147
    v_exp_f32 v148, v148
    v_exp_f32 v149, v149
    v_exp_f32 v150, v150
    v_exp_f32 v151, v151
    s_nop 0
    v_cvt_pk_bf16_f32 v164, v148, v149
    v_cvt_pk_bf16_f32 v165, v150, v151
    v_mov_b32 v166, 0
    v_mov_b32 v167, 0
    v_cvt_pk_bf16_f32 v168, v144, v145
    v_cvt_pk_bf16_f32 v169, v146, v147
    v_max3_f32 v8, v152, v153, v154
    v_max3_f32 v8, v8, v155, v156
    v_max3_f32 v8, v8, v157, v158
    v_max3_f32 v8, v8, v159, v160
    v_max3_f32 v8, v8, v161, v162
    v_max_f32 v8, v8, v163
    v_mov_b32 v9, v8
    s_nop 1
    v_permlane16_swap_b32 v8, v9
    v_max_f32 v8, v8, v9
    v_mov_b32 v9, v8
    s_nop 1
    v_permlane32_swap_b32 v8, v9
    v_max_f32 v8, v8, v9
    v_mul_f32 v8, s34, v8
    v_fma_f32 v152, v152, s34, -v8
    v_fma_f32 v153, v153, s34, -v8
    v_fma_f32 v154, v154, s34, -v8
    v_fma_f32 v155, v155, s34, -v8
    v_fma_f32 v156, v156, s34, -v8
    v_fma_f32 v157, v157, s34, -v8
    v_fma_f32 v158, v158, s34, -v8
    v_fma_f32 v159, v159, s34, -v8
    v_fma_f32 v160, v160, s34, -v8
    v_fma_f32 v161, v161, s34, -v8
    v_fma_f32 v162, v162, s34, -v8
    v_fma_f32 v163, v163, s34, -v8
    v_exp_f32 v152, v152
    v_exp_f32 v153, v153
    v_exp_f32 v154, v154
    v_exp_f32 v155, v155
    v_exp_f32 v156, v156
    v_exp_f32 v157, v157
    v_exp_f32 v158, v158
    v_exp_f32 v159, v159
    v_exp_f32 v160, v160
    v_exp_f32 v161, v161
    v_exp_f32 v162, v162
    v_exp_f32 v163, v163
    s_nop 0
    v_cvt_pk_bf16_f32 v170, v156, v157
    v_cvt_pk_bf16_f32 v171, v158, v159
    v_cvt_pk_bf16_f32 v172, v160, v161
    v_cvt_pk_bf16_f32 v173, v162, v163
    v_cvt_pk_bf16_f32 v174, v152, v153
    v_cvt_pk_bf16_f32 v175, v154, v155
    s_waitcnt vmcnt(0)
    v_mfma_f32_16x16x32_bf16 v[240:243], v[248:251], v[164:167], 0
    v_mfma_f32_16x16x32_bf16 v[244:247], v[248:251], v[170:173], 0
    v_mfma_f32_16x16x32_bf16 v[176:179], v[80:83], v[164:167], 0
    v_mfma_f32_16x16x32_bf16 v[180:183], v[80:83], v[170:173], 0
    v_mfma_f32_16x16x32_bf16 v[184:187], v[84:87], v[164:167], 0
    v_mfma_f32_16x16x32_bf16 v[188:191], v[84:87], v[170:173], 0
    v_mfma_f32_16x16x32_bf16 v[192:195], v[88:91], v[164:167], 0
    v_mfma_f32_16x16x32_bf16 v[196:199], v[88:91], v[170:173], 0
    v_mfma_f32_16x16x32_bf16 v[200:203], v[92:95], v[164:167], 0
    v_mfma_f32_16x16x32_bf16 v[204:207], v[92:95], v[170:173], 0
    v_mfma_f32_16x16x32_bf16 v[208:211], v[96:99], v[164:167], 0
    v_mfma_f32_16x16x32_bf16 v[212:215], v[96:99], v[170:173], 0
    v_mfma_f32_16x16x32_bf16 v[216:219], v[100:103], v[164:167], 0
    v_mfma_f32_16x16x32_bf16 v[220:223], v[100:103], v[170:173], 0
    v_mfma_f32_16x16x32_bf16 v[224:227], v[104:107], v[164:167], 0
    v_mfma_f32_16x16x32_bf16 v[228:231], v[104:107], v[170:173], 0
    v_mfma_f32_16x16x32_bf16 v[232:235], v[108:111], v[164:167], 0
    v_mfma_f32_16x16x32_bf16 v[236:239], v[108:111], v[170:173], 0
    v_mfma_f32_16x16x16_bf16 v[240:243], v[248:249], v[168:169], v[240:243]
    v_mfma_f32_16x16x16_bf16 v[244:247], v[248:249], v[174:175], v[244:247]
    v_mfma_f32_16x16x16_bf16 v[176:179], v[128:129], v[168:169], v[176:179]
    v_mfma_f32_16x16x16_bf16 v[180:183], v[128:129], v[174:175], v[180:183]
    v_mfma_f32_16x16x16_bf16 v[184:187], v[130:131], v[168:169], v[184:187]
    v_mfma_f32_16x16x16_bf16 v[188:191], v[130:131], v[174:175], v[188:191]
    v_mfma_f32_16x16x16_bf16 v[192:195], v[132:133], v[168:169], v[192:195]
    v_mfma_f32_16x16x16_bf16 v[196:199], v[132:133], v[174:175], v[196:199]
    v_mfma_f32_16x16x16_bf16 v[200:203], v[134:135], v[168:169], v[200:203]
    v_mfma_f32_16x16x16_bf16 v[204:207], v[134:135], v[174:175], v[204:207]
    v_mfma_f32_16x16x16_bf16 v[208:211], v[136:137], v[168:169], v[208:211]
    v_mfma_f32_16x16x16_bf16 v[212:215], v[136:137], v[174:175], v[212:215]
    v_mfma_f32_16x16x16_bf16 v[216:219], v[138:139], v[168:169], v[216:219]
    v_mfma_f32_16x16x16_bf16 v[220:223], v[138:139], v[174:175], v[220:223]
    v_mfma_f32_16x16x16_bf16 v[224:227], v[140:141], v[168:169], v[224:227]
    v_mfma_f32_16x16x16_bf16 v[228:231], v[140:141], v[174:175], v[228:231]
    v_mfma_f32_16x16x16_bf16 v[232:235], v[142:143], v[168:169], v[232:235]
    v_mfma_f32_16x16x16_bf16 v[236:239], v[142:143], v[174:175], v[236:239]
    v_rcp_f32 v8, v240
    v_rcp_f32 v9, v244
    s_nop 7
    v_mul_f32 v176, v176, v8
    v_mul_f32 v177, v177, v8
    v_mul_f32 v178, v178, v8
    v_mul_f32 v179, v179, v8
    v_cvt_pk_bf16_f32 v16, v176, v177
    v_cvt_pk_bf16_f32 v17, v178, v179
    v_mul_f32 v184, v184, v8
    v_mul_f32 v185, v185, v8
    v_mul_f32 v186, v186, v8
    v_mul_f32 v187, v187, v8
    v_cvt_pk_bf16_f32 v18, v184, v185
    v_cvt_pk_bf16_f32 v19, v186, v187
    s_add_u32 s64, s32, 0x0
    buffer_store_dwordx4 v[16:19], v1, s[4:7], s64 offen offset:0 sc1
    v_mul_f32 v192, v192, v8
    v_mul_f32 v193, v193, v8
    v_mul_f32 v194, v194, v8
    v_mul_f32 v195, v195, v8
    v_cvt_pk_bf16_f32 v20, v192, v193
    v_cvt_pk_bf16_f32 v21, v194, v195
    v_mul_f32 v200, v200, v8
    v_mul_f32 v201, v201, v8
    v_mul_f32 v202, v202, v8
    v_mul_f32 v203, v203, v8
    v_cvt_pk_bf16_f32 v22, v200, v201
    v_cvt_pk_bf16_f32 v23, v202, v203
    s_add_u32 s64, s32, 0x0
    buffer_store_dwordx4 v[20:23], v1, s[4:7], s64 offen offset:1024 sc1
    v_mul_f32 v208, v208, v8
    v_mul_f32 v209, v209, v8
    v_mul_f32 v210, v210, v8
    v_mul_f32 v211, v211, v8
    v_cvt_pk_bf16_f32 v24, v208, v209
    v_cvt_pk_bf16_f32 v25, v210, v211
    v_mul_f32 v216, v216, v8
    v_mul_f32 v217, v217, v8
    v_mul_f32 v218, v218, v8
    v_mul_f32 v219, v219, v8
    v_cvt_pk_bf16_f32 v26, v216, v217
    v_cvt_pk_bf16_f32 v27, v218, v219
    s_add_u32 s64, s32, 0x0
    buffer_store_dwordx4 v[24:27], v1, s[4:7], s64 offen offset:2048 sc1
    v_mul_f32 v224, v224, v8
    v_mul_f32 v225, v225, v8
    v_mul_f32 v226, v226, v8
    v_mul_f32 v227, v227, v8
    v_cvt_pk_bf16_f32 v28, v224, v225
    v_cvt_pk_bf16_f32 v29, v226, v227
    v_mul_f32 v232, v232, v8
    v_mul_f32 v233, v233, v8
    v_mul_f32 v234, v234, v8
    v_mul_f32 v235, v235, v8
    v_cvt_pk_bf16_f32 v30, v232, v233
    v_cvt_pk_bf16_f32 v31, v234, v235
    s_add_u32 s64, s32, 0x0
    buffer_store_dwordx4 v[28:31], v1, s[4:7], s64 offen offset:3072 sc1
    v_mul_f32 v180, v180, v9
    v_mul_f32 v181, v181, v9
    v_mul_f32 v182, v182, v9
    v_mul_f32 v183, v183, v9
    v_cvt_pk_bf16_f32 v32, v180, v181
    v_cvt_pk_bf16_f32 v33, v182, v183
    v_mul_f32 v188, v188, v9
    v_mul_f32 v189, v189, v9
    v_mul_f32 v190, v190, v9
    v_mul_f32 v191, v191, v9
    v_cvt_pk_bf16_f32 v34, v188, v189
    v_cvt_pk_bf16_f32 v35, v190, v191
    s_add_u32 s64, s32, 0x20000
    buffer_store_dwordx4 v[32:35], v1, s[4:7], s64 offen offset:0 sc1
    v_mul_f32 v196, v196, v9
    v_mul_f32 v197, v197, v9
    v_mul_f32 v198, v198, v9
    v_mul_f32 v199, v199, v9
    v_cvt_pk_bf16_f32 v36, v196, v197
    v_cvt_pk_bf16_f32 v37, v198, v199
    v_mul_f32 v204, v204, v9
    v_mul_f32 v205, v205, v9
    v_mul_f32 v206, v206, v9
    v_mul_f32 v207, v207, v9
    v_cvt_pk_bf16_f32 v38, v204, v205
    v_cvt_pk_bf16_f32 v39, v206, v207
    s_add_u32 s64, s32, 0x20000
    buffer_store_dwordx4 v[36:39], v1, s[4:7], s64 offen offset:1024 sc1
    v_mul_f32 v212, v212, v9
    v_mul_f32 v213, v213, v9
    v_mul_f32 v214, v214, v9
    v_mul_f32 v215, v215, v9
    v_cvt_pk_bf16_f32 v40, v212, v213
    v_cvt_pk_bf16_f32 v41, v214, v215
    v_mul_f32 v220, v220, v9
    v_mul_f32 v221, v221, v9
    v_mul_f32 v222, v222, v9
    v_mul_f32 v223, v223, v9
    v_cvt_pk_bf16_f32 v42, v220, v221
    v_cvt_pk_bf16_f32 v43, v222, v223
    s_add_u32 s64, s32, 0x20000
    buffer_store_dwordx4 v[40:43], v1, s[4:7], s64 offen offset:2048 sc1
    v_mul_f32 v228, v228, v9
    v_mul_f32 v229, v229, v9
    v_mul_f32 v230, v230, v9
    v_mul_f32 v231, v231, v9
    v_cvt_pk_bf16_f32 v44, v228, v229
    v_cvt_pk_bf16_f32 v45, v230, v231
    v_mul_f32 v236, v236, v9
    v_mul_f32 v237, v237, v9
    v_mul_f32 v238, v238, v9
    v_mul_f32 v239, v239, v9
    v_cvt_pk_bf16_f32 v46, v236, v237
    v_cvt_pk_bf16_f32 v47, v238, v239
    s_add_u32 s64, s32, 0x20000
    buffer_store_dwordx4 v[44:47], v1, s[4:7], s64 offen offset:3072 sc1
    s_waitcnt vmcnt(0)
    v_mov_b32 v7, 1
    v_mov_b32 v8, 0
    s_mov_b64 exec, 1
    buffer_store_dword v7, v8, s[4:7], s33 offen sc1
    s_mov_b64 exec, -1
    s_add_u32 s24, s24, 8
    s_add_u32 s25, s25, 1
    s_cmp_lt_u32 s25, 2
    s_cbranch_scc1 AT1_LOOP
AT1_END:
    s_lshl_b32 s70, s13, 1
    s_add_u32 s70, s70, s12
    s_load_dwordx2 s[44:45], s[0:1], 72
    s_mov_b32 s46, 0x21c000
    s_mov_b32 s47, 0x00020000
    s_load_dwordx2 s[48:49], s[0:1], 80
    s_mov_b32 s50, 0x21c000
    s_mov_b32 s51, 0x00020000
    s_load_dwordx2 s[52:53], s[0:1], 88
    s_mov_b32 s54, 0x21c000
    s_mov_b32 s55, 0x00020000
    s_mov_b32 s29, 0
    s_waitcnt lgkmcnt(0)
    v_mbcnt_lo_u32_b32 v0, -1, 0
    v_mbcnt_hi_u32_b32 v0, -1, v0
    s_cmp_lg_u32 s14, 0
    s_cbranch_scc1 H_ATT
    s_cmp_ge_u32 s70, 40
    s_cbranch_scc1 H_ATT
    s_mov_b32 s24, s70
    v_mov_b32 v8, 0
    s_mov_b32 s64, 0x298080
F2W_192:
    buffer_load_dword v7, v8, s[4:7], s64 offen sc1
    s_add_u32 s29, s29, 1
    s_waitcnt vmcnt(0)
    v_mov_b32 v9, 108
    v_cmp_gt_u32 vcc, v9, v7
    s_cbranch_vccz F2WD_193
    s_cmp_gt_u32 s29, 262144
    s_cbranch_scc1 F2WD_193
    s_sleep 8
    s_branch F2W_192
F2WD_193:
    s_mov_b32 s25, 0
    v_lshrrev_b32 v7, 1, v0
    v_mul_u32_u24 v2, 1280, v7
    v_and_b32 v7, 1, v0
    v_lshl_add_u32 v2, v7, 4, v2
    v_lshrrev_b32 v7, 4, v0
    v_lshlrev_b32 v3, 7, v7
    v_bfe_u32 v7, v0, 2, 2
    v_lshl_add_u32 v3, v7, 5, v3
    v_and_b32 v7, 3, v0
    v_lshl_add_u32 v3, v7, 3, v3
    v_add_u32 v3, s25, v3
    v_lshlrev_b32 v4, 4, v0
    s_mov_b32 s65, 0x5401000
    buffer_load_dwordx4 v[16:19], v4, s[4:7], s65 offen offset:0 sc1
    buffer_load_dwordx4 v[20:23], v4, s[4:7], s65 offen offset:1024 sc1
    buffer_load_dwordx4 v[24:27], v4, s[4:7], s65 offen offset:2048 sc1
    buffer_load_dwordx4 v[28:31], v4, s[4:7], s65 offen offset:3072 sc1
    s_add_u32 s65, s65, 4096
    buffer_load_dwordx4 v[32:35], v4, s[4:7], s65 offen offset:0 sc1
    buffer_load_dwordx4 v[36:39], v4, s[4:7], s65 offen offset:1024 sc1
    buffer_load_dwordx4 v[40:43], v4, s[4:7], s65 offen offset:2048 sc1
    buffer_load_dwordx4 v[44:47], v4, s[4:7], s65 offen offset:3072 sc1
    s_add_u32 s65, s65, 4096
    buffer_load_dwordx4 v[48:51], v4, s[4:7], s65 offen offset:0 sc1
    buffer_load_dwordx4 v[52:55], v4, s[4:7], s65 offen offset:1024 sc1
    buffer_load_dwordx4 v[56:59], v4, s[4:7], s65 offen offset:2048 sc1
    buffer_load_dwordx4 v[60:63], v4, s[4:7], s65 offen offset:3072 sc1
    s_add_u32 s65, s65, 4096
    buffer_load_dwordx4 v[64:67], v4, s[4:7], s65 offen offset:0 sc1
    buffer_load_dwordx4 v[68:71], v4, s[4:7], s65 offen offset:1024 sc1
    buffer_load_dwordx4 v[72:75], v4, s[4:7], s65 offen offset:2048 sc1
    buffer_load_dwordx4 v[76:79], v4, s[4:7], s65 offen offset:3072 sc1
    s_add_u32 s65, s65, 4096
    buffer_load_dwordx4 v[80:83], v4, s[4:7], s65 offen offset:0 sc1
    buffer_load_dwordx4 v[84:87], v4, s[4:7], s65 offen offset:1024 sc1
    buffer_load_dwordx4 v[88:91], v4, s[4:7], s65 offen offset:2048 sc1
    buffer_load_dwordx4 v[92:95], v4, s[4:7], s65 offen offset:3072 sc1
    s_add_u32 s65, s65, 4096
    buffer_load_dwordx4 v[96:99], v4, s[4:7], s65 offen offset:0 sc1
    buffer_load_dwordx4 v[100:103], v4, s[4:7], s65 offen offset:1024 sc1
    buffer_load_dwordx4 v[104:107], v4, s[4:7], s65 offen offset:2048 sc1
    buffer_load_dwordx4 v[108:111], v4, s[4:7], s65 offen offset:3072 sc1
    s_add_u32 s65, s65, 4096
    buffer_load_dwordx4 v[112:115], v4, s[4:7], s65 offen offset:0 sc1
    buffer_load_dwordx4 v[116:119], v4, s[4:7], s65 offen offset:1024 sc1
    buffer_load_dwordx4 v[120:123], v4, s[4:7], s65 offen offset:2048 sc1
    buffer_load_dwordx4 v[124:127], v4, s[4:7], s65 offen offset:3072 sc1
    s_add_u32 s65, s65, 4096
    buffer_load_dwordx4 v[128:131], v4, s[4:7], s65 offen offset:0 sc1
    buffer_load_dwordx4 v[132:135], v4, s[4:7], s65 offen offset:1024 sc1
    buffer_load_dwordx4 v[136:139], v4, s[4:7], s65 offen offset:2048 sc1
    buffer_load_dwordx4 v[140:143], v4, s[4:7], s65 offen offset:3072 sc1
    s_add_u32 s65, s65, 4096
    buffer_load_dwordx4 v[144:147], v4, s[4:7], s65 offen offset:0 sc1
    buffer_load_dwordx4 v[148:151], v4, s[4:7], s65 offen offset:1024 sc1
    buffer_load_dwordx4 v[152:155], v4, s[4:7], s65 offen offset:2048 sc1
    buffer_load_dwordx4 v[156:159], v4, s[4:7], s65 offen offset:3072 sc1
    s_add_u32 s65, s65, 4096
    buffer_load_dwordx4 v[160:163], v4, s[4:7], s65 offen offset:0 sc1
    buffer_load_dwordx4 v[164:167], v4, s[4:7], s65 offen offset:1024 sc1
    buffer_load_dwordx4 v[168:171], v4, s[4:7], s65 offen offset:2048 sc1
    buffer_load_dwordx4 v[172:175], v4, s[4:7], s65 offen offset:3072 sc1
    s_add_u32 s65, s65, 4096
    buffer_load_dwordx4 v[176:179], v4, s[4:7], s65 offen offset:0 sc1
    s_waitcnt vmcnt(20)
    buffer_load_dwordx4 v[180:183], v4, s[4:7], s65 offen offset:1024 sc1
    buffer_load_dwordx4 v[184:187], v4, s[4:7], s65 offen offset:2048 sc1
    buffer_load_dwordx4 v[188:191], v4, s[4:7], s65 offen offset:3072 sc1
    s_add_u32 s65, s65, 4096
    buffer_load_dwordx4 v[192:195], v4, s[4:7], s65 offen offset:0 sc1
    buffer_load_dwordx4 v[196:199], v4, s[4:7], s65 offen offset:1024 sc1
    buffer_load_dwordx4 v[200:203], v4, s[4:7], s65 offen offset:2048 sc1
    buffer_load_dwordx4 v[204:207], v4, s[4:7], s65 offen offset:3072 sc1
    s_add_u32 s65, s65, 4096
    buffer_load_dwordx4 v[208:211], v4, s[4:7], s65 offen offset:0 sc1
    buffer_load_dwordx4 v[212:215], v4, s[4:7], s65 offen offset:1024 sc1
    buffer_load_dwordx4 v[216:219], v4, s[4:7], s65 offen offset:2048 sc1
    buffer_load_dwordx4 v[220:223], v4, s[4:7], s65 offen offset:3072 sc1
    s_add_u32 s65, s65, 4096
    buffer_load_dwordx4 v[224:227], v4, s[4:7], s65 offen offset:0 sc1
    buffer_load_dwordx4 v[228:231], v4, s[4:7], s65 offen offset:1024 sc1
    s_waitcnt vmcnt(0)
    s_lshl_b32 s26, s24, 5
    s_add_u32 m0, s25, 0
    s_add_u32 s64, s26, 0x0
    buffer_load_dwordx4 v2, s[52:55], s64 offen lds
    s_add_u32 m0, s25, 1024
    s_add_u32 s64, s26, 0xa000
    buffer_load_dwordx4 v2, s[52:55], s64 offen lds
    s_add_u32 m0, s25, 2048
    s_add_u32 s64, s26, 0x14000
    buffer_load_dwordx4 v2, s[52:55], s64 offen lds
    s_add_u32 m0, s25, 3072
    s_add_u32 s64, s26, 0x1e000
    buffer_load_dwordx4 v2, s[52:55], s64 offen lds
    s_add_u32 m0, s25, 4096
    s_add_u32 s64, s26, 0x28000
    buffer_load_dwordx4 v2, s[52:55], s64 offen lds
    s_add_u32 m0, s25, 5120
    s_add_u32 s64, s26, 0x32000
    buffer_load_dwordx4 v2, s[52:55], s64 offen lds
    s_add_u32 m0, s25, 6144
    s_add_u32 s64, s26, 0x3c000
    buffer_load_dwordx4 v2, s[52:55], s64 offen lds
    s_add_u32 m0, s25, 7168
    s_add_u32 s64, s26, 0x46000
    buffer_load_dwordx4 v2, s[52:55], s64 offen lds
    s_add_u32 m0, s25, 8192
    s_add_u32 s64, s26, 0x50000
    buffer_load_dwordx4 v2, s[52:55], s64 offen lds
    s_add_u32 m0, s25, 9216
    s_add_u32 s64, s26, 0x5a000
    buffer_load_dwordx4 v2, s[52:55], s64 offen lds
    s_add_u32 m0, s25, 10240
    s_add_u32 s64, s26, 0x64000
    buffer_load_dwordx4 v2, s[52:55], s64 offen lds
    s_add_u32 m0, s25, 11264
    s_add_u32 s64, s26, 0x6e000
    buffer_load_dwordx4 v2, s[52:55], s64 offen lds
    s_add_u32 m0, s25, 12288
    s_add_u32 s64, s26, 0x78000
    buffer_load_dwordx4 v2, s[52:55], s64 offen lds
    s_add_u32 m0, s25, 13312
    s_add_u32 s64, s26, 0x82000
    buffer_load_dwordx4 v2, s[52:55], s64 offen lds
    s_add_u32 m0, s25, 14336
    s_add_u32 s64, s26, 0x8c000
    buffer_load_dwordx4 v2, s[52:55], s64 offen lds
    s_add_u32 m0, s25, 15360
    s_add_u32 s64, s26, 0x96000
    buffer_load_dwordx4 v2, s[52:55], s64 offen lds
    s_add_u32 m0, s25, 16384
    s_add_u32 s64, s26, 0xa0000
    buffer_load_dwordx4 v2, s[52:55], s64 offen lds
    s_add_u32 m0, s25, 17408
    s_add_u32 s64, s26, 0xaa000
    buffer_load_dwordx4 v2, s[52:55], s64 offen lds
    s_add_u32 m0, s25, 18432
    s_add_u32 s64, s26, 0xb4000
    buffer_load_dwordx4 v2, s[52:55], s64 offen lds
    s_add_u32 m0, s25, 19456
    s_add_u32 s64, s26, 0xbe000
    buffer_load_dwordx4 v2, s[52:55], s64 offen lds
    s_add_u32 m0, s25, 20480
    s_add_u32 s64, s26, 0xc8000
    buffer_load_dwordx4 v2, s[52:55], s64 offen lds
    s_add_u32 m0, s25, 21504
    s_add_u32 s64, s26, 0xd2000
    buffer_load_dwordx4 v2, s[52:55], s64 offen lds
    s_add_u32 m0, s25, 22528
    s_add_u32 s64, s26, 0xdc000
    buffer_load_dwordx4 v2, s[52:55], s64 offen lds
    s_add_u32 m0, s25, 23552
    s_add_u32 s64, s26, 0xe6000
    buffer_load_dwordx4 v2, s[52:55], s64 offen lds
    s_add_u32 m0, s25, 24576
    s_add_u32 s64, s26, 0xf0000
    buffer_load_dwordx4 v2, s[52:55], s64 offen lds
    s_add_u32 m0, s25, 25600
    s_add_u32 s64, s26, 0xfa000
    buffer_load_dwordx4 v2, s[52:55], s64 offen lds
    s_add_u32 m0, s25, 26624
    s_add_u32 s64, s26, 0x104000
    buffer_load_dwordx4 v2, s[52:55], s64 offen lds
    s_add_u32 m0, s25, 27648
    s_add_u32 s64, s26, 0x10e000
    buffer_load_dwordx4 v2, s[52:55], s64 offen lds
    s_add_u32 m0, s25, 28672
    s_add_u32 s64, s26, 0x118000
    buffer_load_dwordx4 v2, s[52:55], s64 offen lds
    s_add_u32 m0, s25, 29696
    s_add_u32 s64, s26, 0x122000
    buffer_load_dwordx4 v2, s[52:55], s64 offen lds
    s_add_u32 m0, s25, 30720
    s_add_u32 s64, s26, 0x12c000
    buffer_load_dwordx4 v2, s[52:55], s64 offen lds
    s_add_u32 m0, s25, 31744
    s_add_u32 s64, s26, 0x136000
    buffer_load_dwordx4 v2, s[52:55], s64 offen lds
    s_add_u32 m0, s25, 32768
    s_add_u32 s64, s26, 0x140000
    buffer_load_dwordx4 v2, s[52:55], s64 offen lds
    s_add_u32 m0, s25, 33792
    s_add_u32 s64, s26, 0x14a000
    buffer_load_dwordx4 v2, s[52:55], s64 offen lds
    s_add_u32 m0, s25, 34816
    s_add_u32 s64, s26, 0x154000
    buffer_load_dwordx4 v2, s[52:55], s64 offen lds
    s_add_u32 m0, s25, 35840
    s_add_u32 s64, s26, 0x15e000
    buffer_load_dwordx4 v2, s[52:55], s64 offen lds
    s_add_u32 m0, s25, 36864
    s_add_u32 s64, s26, 0x168000
    buffer_load_dwordx4 v2, s[52:55], s64 offen lds
    s_add_u32 m0, s25, 37888
    s_add_u32 s64, s26, 0x172000
    buffer_load_dwordx4 v2, s[52:55], s64 offen lds
    s_add_u32 m0, s25, 38912
    s_add_u32 s64, s26, 0x17c000
    buffer_load_dwordx4 v2, s[52:55], s64 offen lds
    s_add_u32 m0, s25, 39936
    s_add_u32 s64, s26, 0x186000
    buffer_load_dwordx4 v2, s[52:55], s64 offen lds
    s_add_u32 m0, s25, 40960
    s_add_u32 s64, s26, 0x190000
    buffer_load_dwordx4 v2, s[52:55], s64 offen lds
    s_waitcnt vmcnt(20)
    s_add_u32 m0, s25, 41984
    s_add_u32 s64, s26, 0x19a000
    buffer_load_dwordx4 v2, s[52:55], s64 offen lds
    s_add_u32 m0, s25, 43008
    s_add_u32 s64, s26, 0x1a4000
    buffer_load_dwordx4 v2, s[52:55], s64 offen lds
    s_add_u32 m0, s25, 44032
    s_add_u32 s64, s26, 0x1ae000
    buffer_load_dwordx4 v2, s[52:55], s64 offen lds
    s_add_u32 m0, s25, 45056
    s_add_u32 s64, s26, 0x1b8000
    buffer_load_dwordx4 v2, s[52:55], s64 offen lds
    s_add_u32 m0, s25, 46080
    s_add_u32 s64, s26, 0x1c2000
    buffer_load_dwordx4 v2, s[52:55], s64 offen lds
    s_add_u32 m0, s25, 47104
    s_add_u32 s64, s26, 0x1cc000
    buffer_load_dwordx4 v2, s[52:55], s64 offen lds
    s_add_u32 m0, s25, 48128
    s_add_u32 s64, s26, 0x1d6000
    buffer_load_dwordx4 v2, s[52:55], s64 offen lds
    s_add_u32 m0, s25, 49152
    s_add_u32 s64, s26, 0x1e0000
    buffer_load_dwordx4 v2, s[52:55], s64 offen lds
    s_add_u32 m0, s25, 50176
    s_add_u32 s64, s26, 0x1ea000
    buffer_load_dwordx4 v2, s[52:55], s64 offen lds
    s_add_u32 m0, s25, 51200
    s_add_u32 s64, s26, 0x1f4000
    buffer_load_dwordx4 v2, s[52:55], s64 offen lds
    s_add_u32 m0, s25, 52224
    s_add_u32 s64, s26, 0x1fe000
    buffer_load_dwordx4 v2, s[52:55], s64 offen lds
    s_add_u32 m0, s25, 53248
    s_add_u32 s64, s26, 0x208000
    buffer_load_dwordx4 v2, s[52:55], s64 offen lds
    s_add_u32 m0, s25, 54272
    s_add_u32 s64, s26, 0x212000
    buffer_load_dwordx4 v2, s[52:55], s64 offen lds
    s_waitcnt vmcnt(0)
    ds_read_b64_tr_b16 v[232:233], v3 offset:0
    ds_read_b64_tr_b16 v[234:235], v3 offset:512
    s_waitcnt lgkmcnt(0)
    v_mfma_f32_16x16x32_bf16 v[8:11], v[232:235], v[16:19], 0
    ds_read_b64_tr_b16 v[236:237], v3 offset:1024
    ds_read_b64_tr_b16 v[238:239], v3 offset:1536
    s_waitcnt lgkmcnt(0)
    v_mfma_f32_16x16x32_bf16 v[8:11], v[236:239], v[20:23], v[8:11]
    ds_read_b64_tr_b16 v[240:241], v3 offset:2048
    ds_read_b64_tr_b16 v[242:243], v3 offset:2560
    s_waitcnt lgkmcnt(0)
    v_mfma_f32_16x16x32_bf16 v[8:11], v[240:243], v[24:27], v[8:11]
    ds_read_b64_tr_b16 v[244:245], v3 offset:3072
    ds_read_b64_tr_b16 v[246:247], v3 offset:3584
    s_waitcnt lgkmcnt(0)
    v_mfma_f32_16x16x32_bf16 v[8:11], v[244:247], v[28:31], v[8:11]
    ds_read_b64_tr_b16 v[232:233], v3 offset:4096
    ds_read_b64_tr_b16 v[234:235], v3 offset:4608
    s_waitcnt lgkmcnt(0)
    v_mfma_f32_16x16x32_bf16 v[8:11], v[232:235], v[32:35], v[8:11]
    ds_read_b64_tr_b16 v[236:237], v3 offset:5120
    ds_read_b64_tr_b16 v[238:239], v3 offset:5632
    s_waitcnt lgkmcnt(0)
    v_mfma_f32_16x16x32_bf16 v[8:11], v[236:239], v[36:39], v[8:11]
    ds_read_b64_tr_b16 v[240:241], v3 offset:6144
    ds_read_b64_tr_b16 v[242:243], v3 offset:6656
    s_waitcnt lgkmcnt(0)
    v_mfma_f32_16x16x32_bf16 v[8:11], v[240:243], v[40:43], v[8:11]
    ds_read_b64_tr_b16 v[244:245], v3 offset:7168
    ds_read_b64_tr_b16 v[246:247], v3 offset:7680
    s_waitcnt lgkmcnt(0)
    v_mfma_f32_16x16x32_bf16 v[8:11], v[244:247], v[44:47], v[8:11]
    ds_read_b64_tr_b16 v[232:233], v3 offset:8192
    ds_read_b64_tr_b16 v[234:235], v3 offset:8704
    s_waitcnt lgkmcnt(0)
    v_mfma_f32_16x16x32_bf16 v[8:11], v[232:235], v[48:51], v[8:11]
    ds_read_b64_tr_b16 v[236:237], v3 offset:9216
    ds_read_b64_tr_b16 v[238:239], v3 offset:9728
    s_waitcnt lgkmcnt(0)
    v_mfma_f32_16x16x32_bf16 v[8:11], v[236:239], v[52:55], v[8:11]
    ds_read_b64_tr_b16 v[240:241], v3 offset:10240
    ds_read_b64_tr_b16 v[242:243], v3 offset:10752
    s_waitcnt lgkmcnt(0)
    v_mfma_f32_16x16x32_bf16 v[8:11], v[240:243], v[56:59], v[8:11]
    ds_read_b64_tr_b16 v[244:245], v3 offset:11264
    ds_read_b64_tr_b16 v[246:247], v3 offset:11776
    s_waitcnt lgkmcnt(0)
    v_mfma_f32_16x16x32_bf16 v[8:11], v[244:247], v[60:63], v[8:11]
    ds_read_b64_tr_b16 v[232:233], v3 offset:12288
    ds_read_b64_tr_b16 v[234:235], v3 offset:12800
    s_waitcnt lgkmcnt(0)
    v_mfma_f32_16x16x32_bf16 v[8:11], v[232:235], v[64:67], v[8:11]
    ds_read_b64_tr_b16 v[236:237], v3 offset:13312
    ds_read_b64_tr_b16 v[238:239], v3 offset:13824
    s_waitcnt lgkmcnt(0)
    v_mfma_f32_16x16x32_bf16 v[8:11], v[236:239], v[68:71], v[8:11]
    ds_read_b64_tr_b16 v[240:241], v3 offset:14336
    ds_read_b64_tr_b16 v[242:243], v3 offset:14848
    s_waitcnt lgkmcnt(0)
    v_mfma_f32_16x16x32_bf16 v[8:11], v[240:243], v[72:75], v[8:11]
    ds_read_b64_tr_b16 v[244:245], v3 offset:15360
    ds_read_b64_tr_b16 v[246:247], v3 offset:15872
    s_waitcnt lgkmcnt(0)
    v_mfma_f32_16x16x32_bf16 v[8:11], v[244:247], v[76:79], v[8:11]
    ds_read_b64_tr_b16 v[232:233], v3 offset:16384
    ds_read_b64_tr_b16 v[234:235], v3 offset:16896
    s_waitcnt lgkmcnt(0)
    v_mfma_f32_16x16x32_bf16 v[8:11], v[232:235], v[80:83], v[8:11]
    ds_read_b64_tr_b16 v[236:237], v3 offset:17408
    ds_read_b64_tr_b16 v[238:239], v3 offset:17920
    s_waitcnt lgkmcnt(0)
    v_mfma_f32_16x16x32_bf16 v[8:11], v[236:239], v[84:87], v[8:11]
    ds_read_b64_tr_b16 v[240:241], v3 offset:18432
    ds_read_b64_tr_b16 v[242:243], v3 offset:18944
    s_waitcnt lgkmcnt(0)
    v_mfma_f32_16x16x32_bf16 v[8:11], v[240:243], v[88:91], v[8:11]
    ds_read_b64_tr_b16 v[244:245], v3 offset:19456
    ds_read_b64_tr_b16 v[246:247], v3 offset:19968
    s_waitcnt lgkmcnt(0)
    v_mfma_f32_16x16x32_bf16 v[8:11], v[244:247], v[92:95], v[8:11]
    ds_read_b64_tr_b16 v[232:233], v3 offset:20480
    ds_read_b64_tr_b16 v[234:235], v3 offset:20992
    s_waitcnt lgkmcnt(0)
    v_mfma_f32_16x16x32_bf16 v[8:11], v[232:235], v[96:99], v[8:11]
    ds_read_b64_tr_b16 v[236:237], v3 offset:21504
    ds_read_b64_tr_b16 v[238:239], v3 offset:22016
    s_waitcnt lgkmcnt(0)
    v_mfma_f32_16x16x32_bf16 v[8:11], v[236:239], v[100:103], v[8:11]
    ds_read_b64_tr_b16 v[240:241], v3 offset:22528
    ds_read_b64_tr_b16 v[242:243], v3 offset:23040
    s_waitcnt lgkmcnt(0)
    v_mfma_f32_16x16x32_bf16 v[8:11], v[240:243], v[104:107], v[8:11]
    ds_read_b64_tr_b16 v[244:245], v3 offset:23552
    ds_read_b64_tr_b16 v[246:247], v3 offset:24064
    s_waitcnt lgkmcnt(0)
    v_mfma_f32_16x16x32_bf16 v[8:11], v[244:247], v[108:111], v[8:11]
    ds_read_b64_tr_b16 v[232:233], v3 offset:24576
    ds_read_b64_tr_b16 v[234:235], v3 offset:25088
    s_waitcnt lgkmcnt(0)
    v_mfma_f32_16x16x32_bf16 v[8:11], v[232:235], v[112:115], v[8:11]
    ds_read_b64_tr_b16 v[236:237], v3 offset:25600
    ds_read_b64_tr_b16 v[238:239], v3 offset:26112
    s_waitcnt lgkmcnt(0)
    v_mfma_f32_16x16x32_bf16 v[8:11], v[236:239], v[116:119], v[8:11]
    ds_read_b64_tr_b16 v[240:241], v3 offset:26624
    ds_read_b64_tr_b16 v[242:243], v3 offset:27136
    s_waitcnt lgkmcnt(0)
    v_mfma_f32_16x16x32_bf16 v[8:11], v[240:243], v[120:123], v[8:11]
    ds_read_b64_tr_b16 v[244:245], v3 offset:27648
    ds_read_b64_tr_b16 v[246:247], v3 offset:28160
    s_waitcnt lgkmcnt(0)
    v_mfma_f32_16x16x32_bf16 v[8:11], v[244:247], v[124:127], v[8:11]
    ds_read_b64_tr_b16 v[232:233], v3 offset:28672
    ds_read_b64_tr_b16 v[234:235], v3 offset:29184
    s_waitcnt lgkmcnt(0)
    v_mfma_f32_16x16x32_bf16 v[8:11], v[232:235], v[128:131], v[8:11]
    ds_read_b64_tr_b16 v[236:237], v3 offset:29696
    ds_read_b64_tr_b16 v[238:239], v3 offset:30208
    s_waitcnt lgkmcnt(0)
    v_mfma_f32_16x16x32_bf16 v[8:11], v[236:239], v[132:135], v[8:11]
    ds_read_b64_tr_b16 v[240:241], v3 offset:30720
    ds_read_b64_tr_b16 v[242:243], v3 offset:31232
    s_waitcnt lgkmcnt(0)
    v_mfma_f32_16x16x32_bf16 v[8:11], v[240:243], v[136:139], v[8:11]
    ds_read_b64_tr_b16 v[244:245], v3 offset:31744
    ds_read_b64_tr_b16 v[246:247], v3 offset:32256
    s_waitcnt lgkmcnt(0)
    v_mfma_f32_16x16x32_bf16 v[8:11], v[244:247], v[140:143], v[8:11]
    ds_read_b64_tr_b16 v[232:233], v3 offset:32768
    ds_read_b64_tr_b16 v[234:235], v3 offset:33280
    s_waitcnt lgkmcnt(0)
    v_mfma_f32_16x16x32_bf16 v[8:11], v[232:235], v[144:147], v[8:11]
    ds_read_b64_tr_b16 v[236:237], v3 offset:33792
    ds_read_b64_tr_b16 v[238:239], v3 offset:34304
    s_waitcnt lgkmcnt(0)
    v_mfma_f32_16x16x32_bf16 v[8:11], v[236:239], v[148:151], v[8:11]
    ds_read_b64_tr_b16 v[240:241], v3 offset:34816
    ds_read_b64_tr_b16 v[242:243], v3 offset:35328
    s_waitcnt lgkmcnt(0)
    v_mfma_f32_16x16x32_bf16 v[8:11], v[240:243], v[152:155], v[8:11]
    ds_read_b64_tr_b16 v[244:245], v3 offset:35840
    ds_read_b64_tr_b16 v[246:247], v3 offset:36352
    s_waitcnt lgkmcnt(0)
    v_mfma_f32_16x16x32_bf16 v[8:11], v[244:247], v[156:159], v[8:11]
    ds_read_b64_tr_b16 v[232:233], v3 offset:36864
    ds_read_b64_tr_b16 v[234:235], v3 offset:37376
    s_waitcnt lgkmcnt(0)
    v_mfma_f32_16x16x32_bf16 v[8:11], v[232:235], v[160:163], v[8:11]
    ds_read_b64_tr_b16 v[236:237], v3 offset:37888
    ds_read_b64_tr_b16 v[238:239], v3 offset:38400
    s_waitcnt lgkmcnt(0)
    v_mfma_f32_16x16x32_bf16 v[8:11], v[236:239], v[164:167], v[8:11]
    ds_read_b64_tr_b16 v[240:241], v3 offset:38912
    ds_read_b64_tr_b16 v[242:243], v3 offset:39424
    s_waitcnt lgkmcnt(0)
    v_mfma_f32_16x16x32_bf16 v[8:11], v[240:243], v[168:171], v[8:11]
    ds_read_b64_tr_b16 v[244:245], v3 offset:39936
    ds_read_b64_tr_b16 v[246:247], v3 offset:40448
    s_waitcnt lgkmcnt(0)
    v_mfma_f32_16x16x32_bf16 v[8:11], v[244:247], v[172:175], v[8:11]
    ds_read_b64_tr_b16 v[232:233], v3 offset:40960
    ds_read_b64_tr_b16 v[234:235], v3 offset:41472
    s_waitcnt lgkmcnt(0)
    v_mfma_f32_16x16x32_bf16 v[8:11], v[232:235], v[176:179], v[8:11]
    ds_read_b64_tr_b16 v[236:237], v3 offset:41984
    ds_read_b64_tr_b16 v[238:239], v3 offset:42496
    s_waitcnt lgkmcnt(0)
    v_mfma_f32_16x16x32_bf16 v[8:11], v[236:239], v[180:183], v[8:11]
    ds_read_b64_tr_b16 v[240:241], v3 offset:43008
    ds_read_b64_tr_b16 v[242:243], v3 offset:43520
    s_waitcnt lgkmcnt(0)
    v_mfma_f32_16x16x32_bf16 v[8:11], v[240:243], v[184:187], v[8:11]
    ds_read_b64_tr_b16 v[244:245], v3 offset:44032
    ds_read_b64_tr_b16 v[246:247], v3 offset:44544
    s_waitcnt lgkmcnt(0)
    v_mfma_f32_16x16x32_bf16 v[8:11], v[244:247], v[188:191], v[8:11]
    ds_read_b64_tr_b16 v[232:233], v3 offset:45056
    ds_read_b64_tr_b16 v[234:235], v3 offset:45568
    s_waitcnt lgkmcnt(0)
    v_mfma_f32_16x16x32_bf16 v[8:11], v[232:235], v[192:195], v[8:11]
    ds_read_b64_tr_b16 v[236:237], v3 offset:46080
    ds_read_b64_tr_b16 v[238:239], v3 offset:46592
    s_waitcnt lgkmcnt(0)
    v_mfma_f32_16x16x32_bf16 v[8:11], v[236:239], v[196:199], v[8:11]
    ds_read_b64_tr_b16 v[240:241], v3 offset:47104
    ds_read_b64_tr_b16 v[242:243], v3 offset:47616
    s_waitcnt lgkmcnt(0)
    v_mfma_f32_16x16x32_bf16 v[8:11], v[240:243], v[200:203], v[8:11]
    ds_read_b64_tr_b16 v[244:245], v3 offset:48128
    ds_read_b64_tr_b16 v[246:247], v3 offset:48640
    s_waitcnt lgkmcnt(0)
    v_mfma_f32_16x16x32_bf16 v[8:11], v[244:247], v[204:207], v[8:11]
    ds_read_b64_tr_b16 v[232:233], v3 offset:49152
    ds_read_b64_tr_b16 v[234:235], v3 offset:49664
    s_waitcnt lgkmcnt(0)
    v_mfma_f32_16x16x32_bf16 v[8:11], v[232:235], v[208:211], v[8:11]
    ds_read_b64_tr_b16 v[236:237], v3 offset:50176
    ds_read_b64_tr_b16 v[238:239], v3 offset:50688
    s_waitcnt lgkmcnt(0)
    v_mfma_f32_16x16x32_bf16 v[8:11], v[236:239], v[212:215], v[8:11]
    ds_read_b64_tr_b16 v[240:241], v3 offset:51200
    ds_read_b64_tr_b16 v[242:243], v3 offset:51712
    s_waitcnt lgkmcnt(0)
    v_mfma_f32_16x16x32_bf16 v[8:11], v[240:243], v[216:219], v[8:11]
    ds_read_b64_tr_b16 v[244:245], v3 offset:52224
    ds_read_b64_tr_b16 v[246:247], v3 offset:52736
    s_waitcnt lgkmcnt(0)
    v_mfma_f32_16x16x32_bf16 v[8:11], v[244:247], v[220:223], v[8:11]
    ds_read_b64_tr_b16 v[232:233], v3 offset:53248
    ds_read_b64_tr_b16 v[234:235], v3 offset:53760
    s_waitcnt lgkmcnt(0)
    v_mfma_f32_16x16x32_bf16 v[8:11], v[232:235], v[224:227], v[8:11]
    ds_read_b64_tr_b16 v[236:237], v3 offset:54272
    ds_read_b64_tr_b16 v[238:239], v3 offset:54784
    s_waitcnt lgkmcnt(0)
    v_mfma_f32_16x16x32_bf16 v[8:11], v[236:239], v[228:231], v[8:11]
    v_and_b32 v7, 7, v0
    v_lshlrev_b32 v7, 2, v7
    s_mov_b32 s64, 0x5400020
    buffer_load_dword v12, v7, s[4:7], s64 offen sc1
    s_waitcnt vmcnt(0)
    s_nop 7
    v_cvt_pk_bf16_f32 v8, v8, v8
    v_lshlrev_b32 v8, 16, v8
    v_mul_f32 v8, v8, v12
    v_cvt_pk_bf16_f32 v8, v8, v8
    v_lshlrev_b32 v8, 16, v8
    v_cvt_pk_bf16_f32 v9, v9, v9
    v_lshlrev_b32 v9, 16, v9
    v_mul_f32 v9, v9, v12
    v_cvt_pk_bf16_f32 v9, v9, v9
    v_lshlrev_b32 v9, 16, v9
    v_cvt_pk_bf16_f32 v10, v10, v10
    v_lshlrev_b32 v10, 16, v10
    v_mul_f32 v10, v10, v12
    v_cvt_pk_bf16_f32 v10, v10, v10
    v_lshlrev_b32 v10, 16, v10
    v_cvt_pk_bf16_f32 v11, v11, v11
    v_lshlrev_b32 v11, 16, v11
    v_mul_f32 v11, v11, v12
    v_cvt_pk_bf16_f32 v11, v11, v11
    v_lshlrev_b32 v11, 16, v11
    v_and_b32 v7, 7, v0
    v_mul_u32_u24 v7, 2560, v7
    v_lshrrev_b32 v13, 4, v0
    v_lshl_add_u32 v7, v13, 4, v7
    s_lshl_b32 s64, s24, 6
    s_add_u32 s64, s64, 0x5410000
    s_mov_b32 s68, 0x00ff00ff
    s_mov_b32 s69, 0x00ff00ff
    s_mov_b64 exec, s[68:69]
    buffer_store_dwordx4 v[8:11], v7, s[4:7], s64 offen sc1
    s_mov_b64 exec, -1
    s_waitcnt vmcnt(0)
    v_mov_b32 v7, 1
    v_mov_b32 v8, 0
    s_mov_b32 s64, 0x298100
    s_mov_b64 exec, 1
    buffer_atomic_add v7, v8, s[4:7], s64 offen sc1
    s_mov_b64 exec, -1
H_ATT:
    v_mbcnt_lo_u32_b32 v0, -1, 0
    v_mbcnt_hi_u32_b32 v0, -1, v0
    s_mov_b32 s29, 0
    v_lshlrev_b32 v1, 4, v0
    v_lshrrev_b32 v5, 4, v0
    v_lshlrev_b32 v2, 7, v5
    v_and_b32 v5, 7, v0
    v_lshl_add_u32 v2, v5, 4, v2
    v_bfe_u32 v5, v0, 4, 1
    v_lshlrev_b32 v3, 7, v5
    v_and_b32 v5, 15, v0
    v_lshl_add_u32 v3, v5, 3, v3
    s_mov_b32 s34, 0x3e0293ee
    s_mov_b32 s35, 0x3e0293ee
    s_mov_b32 s36, -1
    s_mov_b32 s37, 0
    v_lshrrev_b32 v5, 4, v0
    v_lshlrev_b32 v5, 2, v5
    v_and_b32 v6, 15, v0
    v_add_u32 v7, 0, v5
    v_cmp_le_u32 s[38:39], v7, v6
    v_add_u32 v7, 1, v5
    v_cmp_le_u32 s[40:41], v7, v6
    v_add_u32 v7, 2, v5
    v_cmp_le_u32 s[42:43], v7, v6
    v_add_u32 v7, 3, v5
    v_cmp_le_u32 s[44:45], v7, v6
    v_mov_b32 v248, 0x3f803f80
    v_mov_b32 v249, 0x3f803f80
    v_mov_b32 v250, 0x3f803f80
    v_mov_b32 v251, 0x3f803f80
    s_lshl_b32 s24, s12, 2
    s_add_u32 s24, s24, s14
    s_add_u32 s24, s24, 16
    s_mov_b32 s25, 2
AT2_LOOP:
    s_cmp_eq_u32 s24, 63
    s_cbranch_scc1 AT2_END
    s_lshl_b32 s64, s24, 5
    s_add_u32 s64, s64, s13
    s_lshl_b32 s26, s64, 13
    s_add_u32 s26, s26, 0x3400000
    s_lshl_b32 s27, s64, 14
    s_add_u32 s27, s27, 0x1400000
    s_lshl_b32 s65, s64, 11
    s_add_u32 s30, s65, 0x640000
    s_add_u32 s31, s65, 0xa40000
    s_lshl_b32 s33, s64, 2
    s_add_u32 s33, s33, 0x296000
    s_lshl_b32 s32, s24, 18
    s_lshl_b32 s65, s13, 12
    s_add_u32 s32, s32, s65
    s_add_u32 s32, s32, 0x4400000
    s_lshr_b32 s65, s24, 2
    s_lshl_b32 s65, s65, 9
    s_lshl_b32 s66, s13, 4
    s_add_u32 s65, s65, s66
    s_add_u32 s65, s65, 0x291000
    s_lshr_b32 s66, s24, 1
    s_lshl_b32 s66, s66, 8
    s_lshl_b32 s64, s13, 3
    s_add_u32 s66, s66, s64
    s_add_u32 s66, s66, 0x293ff4
    v_lshlrev_b32 v5, 2, v0
    v_mov_b32 v6, s65
    v_mov_b32 v7, s66
    v_cmp_gt_u32 vcc, 3, v0
    s_nop 1
    v_cndmask_b32 v6, v7, v6, vcc
    v_add_u32 v4, v5, v6
    s_mov_b32 s64, 0
    s_mov_b64 exec, 7
AT2_F_194:
    buffer_load_dword v5, v4, s[4:7], s64 offen sc1
    s_add_u32 s29, s29, 1
    s_waitcnt vmcnt(0)
    v_cmp_eq_u32 vcc, 0, v5
    s_cbranch_vccz AT2_FD_195
    s_cmp_gt_u32 s29, 262144
    s_cbranch_scc1 AT2_FD_195
    s_sleep 1
    s_branch AT2_F_194
AT2_FD_195:
    s_mov_b64 exec, -1
    buffer_load_dwordx4 v[16:19], v1, s[4:7], s26 offen offset:0
    buffer_load_dwordx4 v[20:23], v1, s[4:7], s26 offen offset:1024
    buffer_load_dwordx4 v[24:27], v1, s[4:7], s26 offen offset:2048
    buffer_load_dwordx4 v[28:31], v1, s[4:7], s26 offen offset:3072
    s_add_u32 s26, s26, 4096
    buffer_load_dwordx4 v[32:35], v1, s[4:7], s26 offen offset:0
    buffer_load_dwordx4 v[36:39], v1, s[4:7], s26 offen offset:1024
    buffer_load_dwordx4 v[40:43], v1, s[4:7], s26 offen offset:2048
    buffer_load_dwordx4 v[44:47], v1, s[4:7], s26 offen offset:3072
    buffer_load_dwordx4 v[48:51], v1, s[4:7], s27 offen offset:0
    buffer_load_dwordx4 v[52:55], v1, s[4:7], s27 offen offset:1024
    buffer_load_dwordx4 v[56:59], v1, s[4:7], s27 offen offset:2048
    buffer_load_dwordx4 v[60:63], v1, s[4:7], s27 offen offset:3072
    s_add_u32 s27, s27, 4096
    buffer_load_dwordx4 v[64:67], v1, s[4:7], s27 offen offset:0
    buffer_load_dwordx4 v[68:71], v1, s[4:7], s27 offen offset:1024
    buffer_load_dwordx4 v[72:75], v1, s[4:7], s27 offen offset:2048
    buffer_load_dwordx4 v[76:79], v1, s[4:7], s27 offen offset:3072
    s_add_u32 s27, s27, 4096
    buffer_load_dwordx4 v[80:83], v1, s[4:7], s27 offen offset:0
    buffer_load_dwordx4 v[84:87], v1, s[4:7], s27 offen offset:1024
    buffer_load_dwordx4 v[88:91], v1, s[4:7], s27 offen offset:2048
    buffer_load_dwordx4 v[92:95], v1, s[4:7], s27 offen offset:3072
    s_add_u32 s27, s27, 4096
    buffer_load_dwordx4 v[96:99], v1, s[4:7], s27 offen offset:0
    buffer_load_dwordx4 v[100:103], v1, s[4:7], s27 offen offset:1024
    buffer_load_dwordx4 v[104:107], v1, s[4:7], s27 offen offset:2048
    buffer_load_dwordx4 v[108:111], v1, s[4:7], s27 offen offset:3072
    s_mov_b64 exec, 0x18
AT2_G_196:
    buffer_load_dword v5, v4, s[4:7], s64 offen sc1
    s_add_u32 s29, s29, 1
    s_waitcnt vmcnt(0)
    v_cmp_eq_u32 vcc, 0, v5
    s_cbranch_vccz AT2_GD_197
    s_cmp_gt_u32 s29, 262144
    s_cbranch_scc1 AT2_GD_197
    s_sleep 1
    s_branch AT2_G_196
AT2_GD_197:
    s_mov_b64 exec, -1
    buffer_load_dwordx4 v[112:115], v2, s[4:7], s30 offen offset:0
    buffer_load_dwordx4 v[116:119], v2, s[4:7], s30 offen offset:512
    buffer_load_dwordx4 v[120:123], v2, s[4:7], s30 offen offset:1024
    buffer_load_dwordx4 v[124:127], v2, s[4:7], s30 offen offset:1536
    buffer_load_dwordx2 v[128:129], v3, s[4:7], s31 offen offset:0
    buffer_load_dwordx2 v[130:131], v3, s[4:7], s31 offen offset:256
    buffer_load_dwordx2 v[132:133], v3, s[4:7], s31 offen offset:512
    buffer_load_dwordx2 v[134:135], v3, s[4:7], s31 offen offset:768
    buffer_load_dwordx2 v[136:137], v3, s[4:7], s31 offen offset:1024
    buffer_load_dwordx2 v[138:139], v3, s[4:7], s31 offen offset:1280
    buffer_load_dwordx2 v[140:141], v3, s[4:7], s31 offen offset:1536
    buffer_load_dwordx2 v[142:143], v3, s[4:7], s31 offen offset:1792
    v_mfma_f32_16x16x32_bf16 v[148:151], v[48:51], v[16:19], 0
    v_mfma_f32_16x16x32_bf16 v[156:159], v[48:51], v[32:35], 0
    v_mfma_f32_16x16x32_bf16 v[160:163], v[64:67], v[32:35], 0
    v_mfma_f32_16x16x32_bf16 v[148:151], v[52:55], v[20:23], v[148:151]
    v_mfma_f32_16x16x32_bf16 v[156:159], v[52:55], v[36:39], v[156:159]
    v_mfma_f32_16x16x32_bf16 v[160:163], v[68:71], v[36:39], v[160:163]
    v_mfma_f32_16x16x32_bf16 v[148:151], v[56:59], v[24:27], v[148:151]
    v_mfma_f32_16x16x32_bf16 v[156:159], v[56:59], v[40:43], v[156:159]
    v_mfma_f32_16x16x32_bf16 v[160:163], v[72:75], v[40:43], v[160:163]
    v_mfma_f32_16x16x32_bf16 v[148:151], v[60:63], v[28:31], v[148:151]
    v_mfma_f32_16x16x32_bf16 v[156:159], v[60:63], v[44:47], v[156:159]
    v_mfma_f32_16x16x32_bf16 v[160:163], v[76:79], v[44:47], v[160:163]
    s_waitcnt vmcnt(8)
    v_mfma_f32_16x16x32_bf16 v[144:147], v[112:115], v[16:19], 0
    v_mfma_f32_16x16x32_bf16 v[152:155], v[112:115], v[32:35], 0
    v_mfma_f32_16x16x32_bf16 v[144:147], v[116:119], v[20:23], v[144:147]
    v_mfma_f32_16x16x32_bf16 v[152:155], v[116:119], v[36:39], v[152:155]
    v_mfma_f32_16x16x32_bf16 v[144:147], v[120:123], v[24:27], v[144:147]
    v_mfma_f32_16x16x32_bf16 v[152:155], v[120:123], v[40:43], v[152:155]
    v_mfma_f32_16x16x32_bf16 v[144:147], v[124:127], v[28:31], v[144:147]
    v_mfma_f32_16x16x32_bf16 v[152:155], v[124:127], v[44:47], v[152:155]
    v_mov_b32 v11, 0xff800000
    s_nop 7
    v_cndmask_b32 v148, v11, v148, s[38:39]
    v_cndmask_b32 v160, v11, v160, s[38:39]
    v_cndmask_b32 v144, v11, v144, s[36:37]
    v_cndmask_b32 v152, v11, v152, s[36:37]
    v_cndmask_b32 v149, v11, v149, s[40:41]
    v_cndmask_b32 v161, v11, v161, s[40:41]
    v_cndmask_b32 v145, v11, v145, s[36:37]
    v_cndmask_b32 v153, v11, v153, s[36:37]
    v_cndmask_b32 v150, v11, v150, s[42:43]
    v_cndmask_b32 v162, v11, v162, s[42:43]
    v_cndmask_b32 v146, v11, v146, s[36:37]
    v_cndmask_b32 v154, v11, v154, s[36:37]
    v_cndmask_b32 v151, v11, v151, s[44:45]
    v_cndmask_b32 v163, v11, v163, s[44:45]
    v_cndmask_b32 v147, v11, v147, s[36:37]
    v_cndmask_b32 v155, v11, v155, s[36:37]
    v_max3_f32 v8, v144, v145, v146
    v_max3_f32 v8, v8, v147, v148
    v_max3_f32 v8, v8, v149, v150
    v_max_f32 v8, v8, v151
    v_mov_b32 v9, v8
    s_nop 1
    v_permlane16_swap_b32 v8, v9
    v_max_f32 v8, v8, v9
    v_mov_b32 v9, v8
    s_nop 1
    v_permlane32_swap_b32 v8, v9
    v_max_f32 v8, v8, v9
    v_mul_f32 v8, s34, v8
    v_fma_f32 v144, v144, s34, -v8
    v_fma_f32 v145, v145, s34, -v8
    v_fma_f32 v146, v146, s34, -v8
    v_fma_f32 v147, v147, s34, -v8
    v_fma_f32 v148, v148, s34, -v8
    v_fma_f32 v149, v149, s34, -v8
    v_fma_f32 v150, v150, s34, -v8
    v_fma_f32 v151, v151, s34, -v8
    v_exp_f32 v144, v144
    v_exp_f32 v145, v145
    v_exp_f32 v146, v146
    v_exp_f32 v147, v147
    v_exp_f32 v148, v148
    v_exp_f32 v149, v149
    v_exp_f32 v150, v150
    v_exp_f32 v151, v151
    s_nop 0
    v_cvt_pk_bf16_f32 v164, v148, v149
    v_cvt_pk_bf16_f32 v165, v150, v151
    v_mov_b32 v166, 0
    v_mov_b32 v167, 0
    v_cvt_pk_bf16_f32 v168, v144, v145
    v_cvt_pk_bf16_f32 v169, v146, v147
    v_max3_f32 v8, v152, v153, v154
    v_max3_f32 v8, v8, v155, v156
    v_max3_f32 v8, v8, v157, v158
    v_max3_f32 v8, v8, v159, v160
    v_max3_f32 v8, v8, v161, v162
    v_max_f32 v8, v8, v163
    v_mov_b32 v9, v8
    s_nop 1
    v_permlane16_swap_b32 v8, v9
    v_max_f32 v8, v8, v9
    v_mov_b32 v9, v8
    s_nop 1
    v_permlane32_swap_b32 v8, v9
    v_max_f32 v8, v8, v9
    v_mul_f32 v8, s34, v8
    v_fma_f32 v152, v152, s34, -v8
    v_fma_f32 v153, v153, s34, -v8
    v_fma_f32 v154, v154, s34, -v8
    v_fma_f32 v155, v155, s34, -v8
    v_fma_f32 v156, v156, s34, -v8
    v_fma_f32 v157, v157, s34, -v8
    v_fma_f32 v158, v158, s34, -v8
    v_fma_f32 v159, v159, s34, -v8
    v_fma_f32 v160, v160, s34, -v8
    v_fma_f32 v161, v161, s34, -v8
    v_fma_f32 v162, v162, s34, -v8
    v_fma_f32 v163, v163, s34, -v8
    v_exp_f32 v152, v152
    v_exp_f32 v153, v153
    v_exp_f32 v154, v154
    v_exp_f32 v155, v155
    v_exp_f32 v156, v156
    v_exp_f32 v157, v157
    v_exp_f32 v158, v158
    v_exp_f32 v159, v159
    v_exp_f32 v160, v160
    v_exp_f32 v161, v161
    v_exp_f32 v162, v162
    v_exp_f32 v163, v163
    s_nop 0
    v_cvt_pk_bf16_f32 v170, v156, v157
    v_cvt_pk_bf16_f32 v171, v158, v159
    v_cvt_pk_bf16_f32 v172, v160, v161
    v_cvt_pk_bf16_f32 v173, v162, v163
    v_cvt_pk_bf16_f32 v174, v152, v153
    v_cvt_pk_bf16_f32 v175, v154, v155
    s_waitcnt vmcnt(0)
    v_mfma_f32_16x16x32_bf16 v[240:243], v[248:251], v[164:167], 0
    v_mfma_f32_16x16x32_bf16 v[244:247], v[248:251], v[170:173], 0
    v_mfma_f32_16x16x32_bf16 v[176:179], v[80:83], v[164:167], 0
    v_mfma_f32_16x16x32_bf16 v[180:183], v[80:83], v[170:173], 0
    v_mfma_f32_16x16x32_bf16 v[184:187], v[84:87], v[164:167], 0
    v_mfma_f32_16x16x32_bf16 v[188:191], v[84:87], v[170:173], 0
    v_mfma_f32_16x16x32_bf16 v[192:195], v[88:91], v[164:167], 0
    v_mfma_f32_16x16x32_bf16 v[196:199], v[88:91], v[170:173], 0
    v_mfma_f32_16x16x32_bf16 v[200:203], v[92:95], v[164:167], 0
    v_mfma_f32_16x16x32_bf16 v[204:207], v[92:95], v[170:173], 0
    v_mfma_f32_16x16x32_bf16 v[208:211], v[96:99], v[164:167], 0
    v_mfma_f32_16x16x32_bf16 v[212:215], v[96:99], v[170:173], 0
    v_mfma_f32_16x16x32_bf16 v[216:219], v[100:103], v[164:167], 0
    v_mfma_f32_16x16x32_bf16 v[220:223], v[100:103], v[170:173], 0
    v_mfma_f32_16x16x32_bf16 v[224:227], v[104:107], v[164:167], 0
    v_mfma_f32_16x16x32_bf16 v[228:231], v[104:107], v[170:173], 0
    v_mfma_f32_16x16x32_bf16 v[232:235], v[108:111], v[164:167], 0
    v_mfma_f32_16x16x32_bf16 v[236:239], v[108:111], v[170:173], 0
    v_mfma_f32_16x16x16_bf16 v[240:243], v[248:249], v[168:169], v[240:243]
    v_mfma_f32_16x16x16_bf16 v[244:247], v[248:249], v[174:175], v[244:247]
    v_mfma_f32_16x16x16_bf16 v[176:179], v[128:129], v[168:169], v[176:179]
    v_mfma_f32_16x16x16_bf16 v[180:183], v[128:129], v[174:175], v[180:183]
    v_mfma_f32_16x16x16_bf16 v[184:187], v[130:131], v[168:169], v[184:187]
    v_mfma_f32_16x16x16_bf16 v[188:191], v[130:131], v[174:175], v[188:191]
    v_mfma_f32_16x16x16_bf16 v[192:195], v[132:133], v[168:169], v[192:195]
    v_mfma_f32_16x16x16_bf16 v[196:199], v[132:133], v[174:175], v[196:199]
    v_mfma_f32_16x16x16_bf16 v[200:203], v[134:135], v[168:169], v[200:203]
    v_mfma_f32_16x16x16_bf16 v[204:207], v[134:135], v[174:175], v[204:207]
    v_mfma_f32_16x16x16_bf16 v[208:211], v[136:137], v[168:169], v[208:211]
    v_mfma_f32_16x16x16_bf16 v[212:215], v[136:137], v[174:175], v[212:215]
    v_mfma_f32_16x16x16_bf16 v[216:219], v[138:139], v[168:169], v[216:219]
    v_mfma_f32_16x16x16_bf16 v[220:223], v[138:139], v[174:175], v[220:223]
    v_mfma_f32_16x16x16_bf16 v[224:227], v[140:141], v[168:169], v[224:227]
    v_mfma_f32_16x16x16_bf16 v[228:231], v[140:141], v[174:175], v[228:231]
    v_mfma_f32_16x16x16_bf16 v[232:235], v[142:143], v[168:169], v[232:235]
    v_mfma_f32_16x16x16_bf16 v[236:239], v[142:143], v[174:175], v[236:239]
    v_rcp_f32 v8, v240
    v_rcp_f32 v9, v244
    s_nop 7
    v_mul_f32 v176, v176, v8
    v_mul_f32 v177, v177, v8
    v_mul_f32 v178, v178, v8
    v_mul_f32 v179, v179, v8
    v_cvt_pk_bf16_f32 v16, v176, v177
    v_cvt_pk_bf16_f32 v17, v178, v179
    v_mul_f32 v184, v184, v8
    v_mul_f32 v185, v185, v8
    v_mul_f32 v186, v186, v8
    v_mul_f32 v187, v187, v8
    v_cvt_pk_bf16_f32 v18, v184, v185
    v_cvt_pk_bf16_f32 v19, v186, v187
    s_add_u32 s64, s32, 0x0
    buffer_store_dwordx4 v[16:19], v1, s[4:7], s64 offen offset:0 sc1
    v_mul_f32 v192, v192, v8
    v_mul_f32 v193, v193, v8
    v_mul_f32 v194, v194, v8
    v_mul_f32 v195, v195, v8
    v_cvt_pk_bf16_f32 v20, v192, v193
    v_cvt_pk_bf16_f32 v21, v194, v195
    v_mul_f32 v200, v200, v8
    v_mul_f32 v201, v201, v8
    v_mul_f32 v202, v202, v8
    v_mul_f32 v203, v203, v8
    v_cvt_pk_bf16_f32 v22, v200, v201
    v_cvt_pk_bf16_f32 v23, v202, v203
    s_add_u32 s64, s32, 0x0
    buffer_store_dwordx4 v[20:23], v1, s[4:7], s64 offen offset:1024 sc1
    v_mul_f32 v208, v208, v8
    v_mul_f32 v209, v209, v8
    v_mul_f32 v210, v210, v8
    v_mul_f32 v211, v211, v8
    v_cvt_pk_bf16_f32 v24, v208, v209
    v_cvt_pk_bf16_f32 v25, v210, v211
    v_mul_f32 v216, v216, v8
    v_mul_f32 v217, v217, v8
    v_mul_f32 v218, v218, v8
    v_mul_f32 v219, v219, v8
    v_cvt_pk_bf16_f32 v26, v216, v217
    v_cvt_pk_bf16_f32 v27, v218, v219
    s_add_u32 s64, s32, 0x0
    buffer_store_dwordx4 v[24:27], v1, s[4:7], s64 offen offset:2048 sc1
    v_mul_f32 v224, v224, v8
    v_mul_f32 v225, v225, v8
    v_mul_f32 v226, v226, v8
    v_mul_f32 v227, v227, v8
    v_cvt_pk_bf16_f32 v28, v224, v225
    v_cvt_pk_bf16_f32 v29, v226, v227
    v_mul_f32 v232, v232, v8
    v_mul_f32 v233, v233, v8
    v_mul_f32 v234, v234, v8
    v_mul_f32 v235, v235, v8
    v_cvt_pk_bf16_f32 v30, v232, v233
    v_cvt_pk_bf16_f32 v31, v234, v235
    s_add_u32 s64, s32, 0x0
    buffer_store_dwordx4 v[28:31], v1, s[4:7], s64 offen offset:3072 sc1
    v_mul_f32 v180, v180, v9
    v_mul_f32 v181, v181, v9
    v_mul_f32 v182, v182, v9
    v_mul_f32 v183, v183, v9
    v_cvt_pk_bf16_f32 v32, v180, v181
    v_cvt_pk_bf16_f32 v33, v182, v183
    v_mul_f32 v188, v188, v9
    v_mul_f32 v189, v189, v9
    v_mul_f32 v190, v190, v9
    v_mul_f32 v191, v191, v9
    v_cvt_pk_bf16_f32 v34, v188, v189
    v_cvt_pk_bf16_f32 v35, v190, v191
    s_add_u32 s64, s32, 0x20000
    buffer_store_dwordx4 v[32:35], v1, s[4:7], s64 offen offset:0 sc1
    v_mul_f32 v196, v196, v9
    v_mul_f32 v197, v197, v9
    v_mul_f32 v198, v198, v9
    v_mul_f32 v199, v199, v9
    v_cvt_pk_bf16_f32 v36, v196, v197
    v_cvt_pk_bf16_f32 v37, v198, v199
    v_mul_f32 v204, v204, v9
    v_mul_f32 v205, v205, v9
    v_mul_f32 v206, v206, v9
    v_mul_f32 v207, v207, v9
    v_cvt_pk_bf16_f32 v38, v204, v205
    v_cvt_pk_bf16_f32 v39, v206, v207
    s_add_u32 s64, s32, 0x20000
    buffer_store_dwordx4 v[36:39], v1, s[4:7], s64 offen offset:1024 sc1
    v_mul_f32 v212, v212, v9
    v_mul_f32 v213, v213, v9
    v_mul_f32 v214, v214, v9
    v_mul_f32 v215, v215, v9
    v_cvt_pk_bf16_f32 v40, v212, v213
    v_cvt_pk_bf16_f32 v41, v214, v215
    v_mul_f32 v220, v220, v9
    v_mul_f32 v221, v221, v9
    v_mul_f32 v222, v222, v9
    v_mul_f32 v223, v223, v9
    v_cvt_pk_bf16_f32 v42, v220, v221
    v_cvt_pk_bf16_f32 v43, v222, v223
    s_add_u32 s64, s32, 0x20000
    buffer_store_dwordx4 v[40:43], v1, s[4:7], s64 offen offset:2048 sc1
    v_mul_f32 v228, v228, v9
    v_mul_f32 v229, v229, v9
    v_mul_f32 v230, v230, v9
    v_mul_f32 v231, v231, v9
    v_cvt_pk_bf16_f32 v44, v228, v229
    v_cvt_pk_bf16_f32 v45, v230, v231
    v_mul_f32 v236, v236, v9
    v_mul_f32 v237, v237, v9
    v_mul_f32 v238, v238, v9
    v_mul_f32 v239, v239, v9
    v_cvt_pk_bf16_f32 v46, v236, v237
    v_cvt_pk_bf16_f32 v47, v238, v239
    s_add_u32 s64, s32, 0x20000
    buffer_store_dwordx4 v[44:47], v1, s[4:7], s64 offen offset:3072 sc1
    s_waitcnt vmcnt(0)
    v_mov_b32 v7, 1
    v_mov_b32 v8, 0
    s_mov_b64 exec, 1
    buffer_store_dword v7, v8, s[4:7], s33 offen sc1
    s_mov_b64 exec, -1
    s_add_u32 s24, s24, 8
    s_add_u32 s25, s25, 1
    s_cmp_lt_u32 s25, 8
    s_cbranch_scc1 AT2_LOOP
AT2_END:
M_EXIT:
    s_endpgm
.section .rodata,"a"
.p2align 6
.amdhsa_kernel recurrent_scan__memory_aug_recurrent_mem_tr__moe_arch_mod__prompt_kernel
  .amdhsa_next_free_vgpr 512
  .amdhsa_next_free_sgpr 102
  .amdhsa_accum_offset 256
  .amdhsa_group_segment_fixed_size 0
  .amdhsa_kernarg_size 120
  .amdhsa_user_sgpr_count 2
  .amdhsa_user_sgpr_kernarg_segment_ptr 1
  .amdhsa_system_sgpr_workgroup_id_x 1
.end_amdhsa_kernel
```

```asm
; @launch grid=(256,1,1) block=(256,1,1) lds=163840
.amdgcn_target "amdgcn-amd-amdhsa--gfx950"
.text
.globl recurrent_scan__memory_aug_recurrent_mem_tr__moe_arch_mod__prompt_kernel
.p2align 8
.type recurrent_scan__memory_aug_recurrent_mem_tr__moe_arch_mod__prompt_kernel,@function
recurrent_scan__memory_aug_recurrent_mem_tr__moe_arch_mod__prompt_kernel:
    s_cmp_ge_u32 s2, 256
    s_cbranch_scc1 M_EXIT
    s_load_dwordx2 s[4:5], s[0:1], 112
    s_mov_b32 s6, 0x10000000
    s_mov_b32 s7, 0x00020000
    s_load_dwordx2 s[60:61], s[0:1], 104
    s_mov_b32 s62, 256
    s_mov_b32 s63, 0x00020000
    s_load_dwordx2 s[44:45], s[0:1], 16
    s_mov_b32 s46, 0x500000
    s_mov_b32 s47, 0x00020000
    s_load_dwordx2 s[48:49], s[0:1], 24
    s_mov_b32 s50, 0x500000
    s_mov_b32 s51, 0x00020000
    s_load_dwordx2 s[52:53], s[0:1], 32
    s_mov_b32 s54, 0x500000
    s_mov_b32 s55, 0x00020000
    s_load_dwordx2 s[56:57], s[0:1], 40
    s_mov_b32 s58, 0x500000
    s_mov_b32 s59, 0x00020000
    v_lshrrev_b32 v1, 6, v0
    v_and_b32 v0, 63, v0
    s_nop 0
    v_readfirstlane_b32 s14, v1
    s_getreg_b32 s98, hwreg(HW_REG_XCC_ID)
    s_and_b32 s98, s98, 7
    s_mov_b32 s97, 0
    s_mov_b32 s95, 4
    s_waitcnt lgkmcnt(0)
    s_cmp_lg_u32 s14, 0
    s_cbranch_scc1 NOMEAS_1
    s_and_b32 s64, s2, 0xfffffffd
    s_cmp_lg_u32 s64, 1
    s_cbranch_scc1 NOMEAS_1
    s_lshr_b32 s70, s2, 1
    s_mov_b32 s72, s60
    s_mov_b32 s73, s61
    s_mov_b32 s74, s62
    s_mov_b32 s75, s63
    s_lshl_b32 s60, s70, 21
    s_add_u32 s60, s60, 0x6001800
    v_mov_b32 v60, 0
    v_mov_b32 v61, -1
    s_mov_b32 s66, 0x7fffffff
    s_mov_b32 s67, 0x7fffffff
    s_mov_b32 s68, 0x7fffffff
    s_mov_b32 s69, 0x7fffffff
    s_mov_b64 exec, 1
    s_add_u32 s61, s60, 0
    s_memtime s[62:63]
    s_waitcnt lgkmcnt(0)
    buffer_store_dword v61, v60, s[4:7], s61 offen offset:0 sc1
    s_waitcnt vmcnt(0)
    s_memtime s[64:65]
    s_waitcnt lgkmcnt(0)
    s_sub_u32 s62, s64, s62
    s_min_u32 s66, s66, s62
    s_add_u32 s61, s60, 8192
    s_memtime s[62:63]
    s_waitcnt lgkmcnt(0)
    buffer_store_dword v61, v60, s[4:7], s61 offen offset:0 sc1
    s_waitcnt vmcnt(0)
    s_memtime s[64:65]
    s_waitcnt lgkmcnt(0)
    s_sub_u32 s62, s64, s62
    s_min_u32 s67, s67, s62
    s_add_u32 s61, s60, 16384
    s_memtime s[62:63]
    s_waitcnt lgkmcnt(0)
    buffer_store_dword v61, v60, s[4:7], s61 offen offset:0 sc1
    s_waitcnt vmcnt(0)
    s_memtime s[64:65]
    s_waitcnt lgkmcnt(0)
    s_sub_u32 s62, s64, s62
    s_min_u32 s68, s68, s62
    s_add_u32 s61, s60, 24576
    s_memtime s[62:63]
    s_waitcnt lgkmcnt(0)
    buffer_store_dword v61, v60, s[4:7], s61 offen offset:0 sc1
    s_waitcnt vmcnt(0)
    s_memtime s[64:65]
    s_waitcnt lgkmcnt(0)
    s_sub_u32 s62, s64, s62
    s_min_u32 s69, s69, s62
    s_add_u32 s61, s60, 0
    s_memtime s[62:63]
    s_waitcnt lgkmcnt(0)
    buffer_store_dword v61, v60, s[4:7], s61 offen offset:128 sc1
    s_waitcnt vmcnt(0)
    s_memtime s[64:65]
    s_waitcnt lgkmcnt(0)
    s_sub_u32 s62, s64, s62
    s_min_u32 s66, s66, s62
    s_add_u32 s61, s60, 8192
    s_memtime s[62:63]
    s_waitcnt lgkmcnt(0)
    buffer_store_dword v61, v60, s[4:7], s61 offen offset:128 sc1
    s_waitcnt vmcnt(0)
    s_memtime s[64:65]
    s_waitcnt lgkmcnt(0)
    s_sub_u32 s62, s64, s62
    s_min_u32 s67, s67, s62
    s_add_u32 s61, s60, 16384
    s_memtime s[62:63]
    s_waitcnt lgkmcnt(0)
    buffer_store_dword v61, v60, s[4:7], s61 offen offset:128 sc1
    s_waitcnt vmcnt(0)
    s_memtime s[64:65]
    s_waitcnt lgkmcnt(0)
    s_sub_u32 s62, s64, s62
    s_min_u32 s68, s68, s62
    s_add_u32 s61, s60, 24576
    s_memtime s[62:63]
    s_waitcnt lgkmcnt(0)
    buffer_store_dword v61, v60, s[4:7], s61 offen offset:128 sc1
    s_waitcnt vmcnt(0)
    s_memtime s[64:65]
    s_waitcnt lgkmcnt(0)
    s_sub_u32 s62, s64, s62
    s_min_u32 s69, s69, s62
    s_mov_b64 exec, -1
    s_mov_b32 s60, 0
    s_mov_b32 s61, s66
    s_cmp_lt_u32 s67, s61
    s_cselect_b32 s60, 1, s60
    s_min_u32 s61, s61, s67
    s_cmp_lt_u32 s68, s61
    s_cselect_b32 s60, 2, s60
    s_min_u32 s61, s61, s68
    s_cmp_lt_u32 s69, s61
    s_cselect_b32 s60, 3, s60
    s_min_u32 s61, s61, s69
    s_and_b32 s61, s98, 1
    s_lshl_b32 s61, s61, 1
    s_lshr_b32 s62, s98, 2
    s_add_u32 s61, s61, s62
    s_xor_b32 s60, s60, s61
    s_add_u32 s71, s60, 1
    s_mov_b32 s60, s72
    s_mov_b32 s61, s73
    s_mov_b32 s62, s74
    s_mov_b32 s63, s75
    s_lshl_b32 s70, s70, 2
    s_add_u32 s70, s70, 132
    v_mov_b32 v61, s71
    s_mov_b64 exec, 1
    buffer_store_dword v61, off, s[60:63], s70 sc1
    s_mov_b64 exec, -1
NOMEAS_1:
    s_cmp_eq_u32 s98, 0
    s_cselect_b32 s80, 1, 0
    s_cmp_eq_u32 s98, 2
    s_cselect_b32 s80, 1, s80
    s_mov_b32 s94, 0
    s_lshr_b32 s13, s2, 3
    s_and_b32 s13, s13, 31
    s_cmp_eq_u32 s14, 0
    s_cbranch_scc1 M_TICK0
    s_cmp_eq_u32 s80, 1
    s_cbranch_scc1 M_GUESS
    s_branch M_TICKW
M_TICK0:
    s_mul_i32 s64, s98, 32
    s_add_u32 s64, s64, 0x0
    v_mov_b32 v1, 0
    v_mov_b32 v70, 1
    s_mov_b64 exec, 1
    s_cmp_eq_u32 s98, 0
    s_cselect_b32 s65, 24, 28
    s_cmp_eq_u32 s80, 1
    s_cselect_b32 s65, s65, 0x1000
    s_lshl_b32 s66, 1, s13
    v_mov_b32 v4, s66
    buffer_atomic_or v4, off, s[60:63], s65 sc1
    buffer_atomic_add v70, v1, s[60:63], s64 offen sc0
    s_mov_b64 exec, -1
    s_getpc_b64 s[76:77]
M_PCREF:
    s_cmp_eq_u32 s80, 1
    s_mov_b32 s82, M_REC-M_PCREF
    s_mov_b32 s83, M_HELP-M_PCREF
    s_cselect_b32 s81, s82, s83
    s_mov_b32 s82, M_HELP-M_REC
    s_mov_b32 s83, M_EXIT-M_HELP
    s_cselect_b32 s78, s82, s83
    s_add_u32 s76, s76, s81
    s_addc_u32 s77, s77, 0
    s_and_b32 s77, s77, 0xffff
    s_mov_b32 s79, 0x00020000
    s_lshr_b32 s81, s2, 3
    s_and_b32 s81, s81, 3
    s_lshl_b32 s81, s81, 12
    v_mbcnt_lo_u32_b32 v3, -1, 0
    v_mbcnt_hi_u32_b32 v3, -1, v3
    v_lshlrev_b32 v3, 6, v3
    s_mov_b32 m0, 1024
    s_nop 0
    buffer_load_dword v3, s[76:79], s81 offen lds
    s_add_u32 s81, s81, 16384
    buffer_load_dword v3, s[76:79], s81 offen lds
    s_add_u32 s81, s81, 16384
    buffer_load_dword v3, s[76:79], s81 offen lds
    s_add_u32 s81, s81, 16384
    buffer_load_dword v3, s[76:79], s81 offen lds
    s_add_u32 s81, s81, 16384
    buffer_load_dword v3, s[76:79], s81 offen lds
    s_add_u32 s81, s81, 16384
    s_cmp_eq_u32 s80, 1
    s_cbranch_scc1 M_GUESS
    s_mov_b64 exec, 1
    s_waitcnt vmcnt(5)
    ds_write_b32 v1, v70
    s_waitcnt lgkmcnt(0)
    s_mov_b64 exec, -1
M_TICKW:
    s_barrier
    v_mov_b32 v1, 0
    ds_read_b32 v2, v1
    s_waitcnt lgkmcnt(0)
    v_readfirstlane_b32 s99, v2
    s_barrier
    s_cmp_ge_u32 s99, 32
    s_cbranch_scc1 M_SLOW0
    s_mov_b32 s12, s98
    s_cmp_eq_u32 s12, 0
    s_cbranch_scc1 XOK_2
    s_cmp_eq_u32 s12, 2
    s_cbranch_scc0 M_FH
    s_mov_b32 s12, 1
XOK_2:
    s_mov_b32 s13, s99
    s_branch M_REC
M_FH:
    s_sub_u32 s96, s98, 1
    s_cmp_gt_u32 s98, 2
    s_cselect_b32 s64, 1, 0
    s_sub_u32 s96, s96, s64
    s_lshl_b32 s96, s96, 5
    s_add_u32 s96, s96, s99
    s_branch M_HELP
M_GUESS:
    s_mov_b32 s94, 1
    s_cmp_eq_u32 s98, 0
    s_cselect_b32 s12, 0, 1
    s_branch M_REC
M_GFAIL:
    s_waitcnt vmcnt(0) lgkmcnt(0)
    s_barrier
    s_cmp_lg_u32 s14, 0
    s_cbranch_scc1 M_GF1
    v_mov_b32 v1, 0
    s_mov_b64 exec, 1
    ds_write_b32 v1, v70
    s_waitcnt lgkmcnt(0)
    s_mov_b64 exec, -1
M_GF1:
    s_barrier
    v_mov_b32 v1, 0
    ds_read_b32 v2, v1
    s_waitcnt lgkmcnt(0)
    v_readfirstlane_b32 s99, v2
    s_barrier
    s_mov_b32 s94, 0
    s_cmp_ge_u32 s99, 32
    s_cbranch_scc1 M_SLOW0
    s_mov_b32 s13, s99
    v_mbcnt_lo_u32_b32 v0, -1, 0
    v_mbcnt_hi_u32_b32 v0, -1, v0
    s_branch M_REC
M_SLOW0:
    v_mbcnt_lo_u32_b32 v0, -1, 0
    v_mbcnt_hi_u32_b32 v0, -1, v0
    v_mul_u32_u24 v8, 32, v0
    s_mov_b32 s64, 0x0
    s_mov_b32 s65, 0
    s_mov_b64 exec, 0xff
TK_3:
    buffer_load_dword v9, v8, s[60:63], s64 offen sc1
    s_add_u32 s65, s65, 1
    s_waitcnt vmcnt(0)
    s_mov_b32 s66, 0
    v_readlane_b32 s67, v9, 0
    s_add_u32 s66, s66, s67
    v_readlane_b32 s67, v9, 1
    s_add_u32 s66, s66, s67
    v_readlane_b32 s67, v9, 2
    s_add_u32 s66, s66, s67
    v_readlane_b32 s67, v9, 3
    s_add_u32 s66, s66, s67
    v_readlane_b32 s67, v9, 4
    s_add_u32 s66, s66, s67
    v_readlane_b32 s67, v9, 5
    s_add_u32 s66, s66, s67
    v_readlane_b32 s67, v9, 6
    s_add_u32 s66, s66, s67
    v_readlane_b32 s67, v9, 7
    s_add_u32 s66, s66, s67
    s_cmp_ge_u32 s66, 256
    s_cbranch_scc1 TKD_4
    s_cmp_gt_u32 s65, 262144
    s_cbranch_scc0 TK_3
TKD_4:
    v_cmp_ne_u32 vcc, 32, v9
    s_mov_b64 exec, -1
M_SLOW:
    s_waitcnt vmcnt(0) lgkmcnt(0)
    s_barrier
    s_cmp_lg_u32 s14, 0
    s_cbranch_scc1 M_SLOWB
    v_mov_b32 v8, 1
    s_mov_b64 exec, 1
    buffer_atomic_add v8, off, s[60:63], 12 sc1
    s_mov_b64 exec, -1
M_SLOWB:
    s_mov_b32 s95, 12
    s_mov_b32 s65, 0
SB_5:
    buffer_load_dword v8, off, s[60:63], s95 sc1
    s_add_u32 s65, s65, 1
    s_waitcnt vmcnt(0)
    v_readfirstlane_b32 s64, v8
    s_cmp_ge_u32 s64, 256
    s_cbranch_scc1 SBD_6
    s_cmp_gt_u32 s65, 65536
    s_cbranch_scc1 SBD_6
    s_sleep 4
    s_branch SB_5
SBD_6:
    s_mov_b32 s95, 8
    s_mov_b32 s97, 1
    s_mov_b32 s94, 0
    s_cmp_lt_u32 s2, 64
    s_cbranch_scc0 M_SH
    s_load_dwordx2 s[44:45], s[0:1], 16
    s_mov_b32 s46, 0x500000
    s_mov_b32 s47, 0x00020000
    s_load_dwordx2 s[48:49], s[0:1], 24
    s_mov_b32 s50, 0x500000
    s_mov_b32 s51, 0x00020000
    s_load_dwordx2 s[52:53], s[0:1], 32
    s_mov_b32 s54, 0x500000
    s_mov_b32 s55, 0x00020000
    s_load_dwordx2 s[56:57], s[0:1], 40
    s_mov_b32 s58, 0x500000
    s_mov_b32 s59, 0x00020000
    s_waitcnt lgkmcnt(0)
    s_lshr_b32 s12, s2, 5
    s_and_b32 s13, s2, 31
    s_branch M_REC
M_SH:
    s_sub_u32 s96, s2, 64
    s_branch M_HELP
M_REC:
    v_mbcnt_lo_u32_b32 v0, -1, 0
    v_mbcnt_hi_u32_b32 v0, -1, v0
    v_and_b32 v0, 63, v0
    s_mul_i32 s40, s14, 36864
    s_add_u32 s40, s40, 16384
    v_lshrrev_b32 v95, 4, v0
    v_lshlrev_b32 v8, 13, v95
    v_and_b32 v95, 1, v95
    v_lshlrev_b32 v95, 1, v95
    v_and_b32 v9, 15, v0
    v_xor_b32 v9, v9, v95
    v_xor_b32 v95, 0, v9
    v_lshl_add_u32 v76, v95, 4, v8
    v_xor_b32 v95, 4, v9
    v_lshl_add_u32 v77, v95, 4, v8
    v_xor_b32 v95, 8, v9
    v_lshl_add_u32 v78, v95, 4, v8
    v_xor_b32 v95, 12, v9
    v_lshl_add_u32 v79, v95, 4, v8
    s_lshl_b32 s64, s13, 8
    s_lshl_b32 s65, s14, 17
    s_add_u32 s64, s64, s65
    s_mul_i32 s65, s12, 2621440
    s_add_u32 s71, s64, s65
    s_sub_u32 s65, 2621440, s65
    s_add_u32 s72, s64, s65
    s_add_u32 m0, s40, 0
    s_add_u32 s64, s71, 0x0
    buffer_load_dwordx4 v76, s[44:47], s64 offen lds
    s_add_u32 m0, s40, 1024
    s_add_u32 s64, s71, 0x8000
    buffer_load_dwordx4 v77, s[44:47], s64 offen lds
    s_add_u32 m0, s40, 2048
    s_add_u32 s64, s71, 0x10000
    buffer_load_dwordx4 v78, s[44:47], s64 offen lds
    s_add_u32 m0, s40, 3072
    s_add_u32 s64, s71, 0x18000
    buffer_load_dwordx4 v79, s[44:47], s64 offen lds
    s_add_u32 m0, s40, 4096
    s_add_u32 s64, s71, 0x80000
    buffer_load_dwordx4 v76, s[44:47], s64 offen lds
    s_add_u32 m0, s40, 5120
    s_add_u32 s64, s71, 0x88000
    buffer_load_dwordx4 v77, s[44:47], s64 offen lds
    s_add_u32 m0, s40, 6144
    s_add_u32 s64, s71, 0x90000
    buffer_load_dwordx4 v78, s[44:47], s64 offen lds
    s_add_u32 m0, s40, 7168
    s_add_u32 s64, s71, 0x98000
    buffer_load_dwordx4 v79, s[44:47], s64 offen lds
    s_add_u32 m0, s40, 8192
    s_add_u32 s64, s71, 0x100000
    buffer_load_dwordx4 v76, s[44:47], s64 offen lds
    s_add_u32 m0, s40, 9216
    s_add_u32 s64, s71, 0x108000
    buffer_load_dwordx4 v77, s[44:47], s64 offen lds
    s_add_u32 m0, s40, 10240
    s_add_u32 s64, s71, 0x110000
    buffer_load_dwordx4 v78, s[44:47], s64 offen lds
    s_add_u32 m0, s40, 11264
    s_add_u32 s64, s71, 0x118000
    buffer_load_dwordx4 v79, s[44:47], s64 offen lds
    s_add_u32 m0, s40, 12288
    s_add_u32 s64, s71, 0x180000
    buffer_load_dwordx4 v76, s[44:47], s64 offen lds
    s_add_u32 m0, s40, 13312
    s_add_u32 s64, s71, 0x188000
    buffer_load_dwordx4 v77, s[44:47], s64 offen lds
    s_add_u32 m0, s40, 14336
    s_add_u32 s64, s71, 0x190000
    buffer_load_dwordx4 v78, s[44:47], s64 offen lds
    s_add_u32 m0, s40, 15360
    s_add_u32 s64, s71, 0x198000
    buffer_load_dwordx4 v79, s[44:47], s64 offen lds
    s_add_u32 m0, s40, 16384
    s_add_u32 s64, s71, 0x200000
    buffer_load_dwordx4 v76, s[44:47], s64 offen lds
    s_add_u32 m0, s40, 17408
    s_add_u32 s64, s71, 0x208000
    buffer_load_dwordx4 v77, s[44:47], s64 offen lds
    s_add_u32 m0, s40, 18432
    s_add_u32 s64, s71, 0x210000
    buffer_load_dwordx4 v78, s[44:47], s64 offen lds
    s_add_u32 m0, s40, 19456
    s_add_u32 s64, s71, 0x218000
    buffer_load_dwordx4 v79, s[44:47], s64 offen lds
    s_add_u32 m0, s40, 20480
    s_add_u32 s64, s72, 0x0
    buffer_load_dwordx4 v76, s[44:47], s64 offen lds
    s_add_u32 m0, s40, 21504
    s_add_u32 s64, s72, 0x8000
    buffer_load_dwordx4 v77, s[44:47], s64 offen lds
    s_add_u32 m0, s40, 22528
    s_add_u32 s64, s72, 0x10000
    buffer_load_dwordx4 v78, s[44:47], s64 offen lds
    s_add_u32 m0, s40, 23552
    s_add_u32 s64, s72, 0x18000
    buffer_load_dwordx4 v79, s[44:47], s64 offen lds
    s_add_u32 m0, s40, 24576
    s_add_u32 s64, s72, 0x80000
    buffer_load_dwordx4 v76, s[44:47], s64 offen lds
    s_add_u32 m0, s40, 25600
    s_add_u32 s64, s72, 0x88000
    buffer_load_dwordx4 v77, s[44:47], s64 offen lds
    s_add_u32 m0, s40, 26624
    s_add_u32 s64, s72, 0x90000
    buffer_load_dwordx4 v78, s[44:47], s64 offen lds
    s_add_u32 m0, s40, 27648
    s_add_u32 s64, s72, 0x98000
    buffer_load_dwordx4 v79, s[44:47], s64 offen lds
    s_add_u32 m0, s40, 28672
    s_add_u32 s64, s72, 0x100000
    buffer_load_dwordx4 v76, s[44:47], s64 offen lds
    s_add_u32 m0, s40, 29696
    s_add_u32 s64, s72, 0x108000
    buffer_load_dwordx4 v77, s[44:47], s64 offen lds
    s_add_u32 m0, s40, 30720
    s_add_u32 s64, s72, 0x110000
    buffer_load_dwordx4 v78, s[44:47], s64 offen lds
    s_add_u32 m0, s40, 31744
    s_add_u32 s64, s72, 0x118000
    buffer_load_dwordx4 v79, s[44:47], s64 offen lds
    v_lshrrev_b32 v95, 5, v0
    v_mul_u32_u24 v8, 36864, v95
    v_bfe_u32 v95, v0, 3, 1
    v_lshl_add_u32 v8, v95, 11, v8
    v_lshlrev_b32 v9, 3, v95
    v_bfe_u32 v95, v0, 4, 1
    v_lshl_add_u32 v8, v95, 10, v8
    v_lshl_add_u32 v9, v95, 2, v9
    v_bfe_u32 v95, v0, 2, 1
    v_lshl_add_u32 v8, v95, 8, v8
    v_lshl_add_u32 v9, v95, 1, v9
    v_and_b32 v95, 1, v0
    v_lshl_add_u32 v8, v95, 3, v8
    v_add_u32 v8, 16384, v8
    v_bfe_u32 v95, v0, 1, 1
    s_lshl_b32 s64, s14, 2
    v_add_u32 v10, s64, v95
    v_add_u32 v95, 0, v10
    v_xor_b32 v95, v95, v9
    v_lshl_add_u32 v72, v95, 4, v8
    v_add_u32 v73, 73728, v72
    v_add_u32 v95, 2, v10
    v_xor_b32 v95, v95, v9
    v_lshl_add_u32 v74, v95, 4, v8
    v_add_u32 v75, 73728, v74
    v_bfe_u32 v95, v0, 2, 1
    v_mov_b32 v8, v95
    v_bfe_u32 v95, v0, 3, 1
    v_lshl_add_u32 v8, v95, 2, v8
    v_bfe_u32 v95, v0, 4, 1
    v_lshl_add_u32 v8, v95, 1, v8
    v_bfe_u32 v95, v0, 5, 1
    v_lshl_add_u32 v8, v95, 3, v8
    v_mul_u32_u24 v8, 1280, v8
    v_and_b32 v95, 3, v0
    v_lshl_add_u32 v89, v95, 4, v8
    v_lshrrev_b32 v95, 1, v0
    v_mul_u32_u24 v8, 1280, v95
    v_and_b32 v95, 1, v0
    v_lshl_add_u32 v90, v95, 4, v8
    v_lshrrev_b32 v95, 5, v0
    v_lshlrev_b32 v93, 9, v95
    v_bfe_u32 v95, v0, 4, 1
    v_lshl_add_u32 v93, v95, 7, v93
    v_bfe_u32 v95, v0, 2, 1
    v_lshl_add_u32 v93, v95, 6, v93
    v_bfe_u32 v95, v0, 3, 1
    v_lshl_add_u32 v93, v95, 5, v93
    v_and_b32 v95, 3, v0
    v_lshl_add_u32 v93, v95, 3, v93
    v_add_u32 v93, s40, v93
    v_lshrrev_b32 v95, 4, v0
    v_lshlrev_b32 v94, 8, v95
    v_bfe_u32 v95, v0, 2, 2
    v_lshl_add_u32 v94, v95, 5, v94
    v_and_b32 v95, 3, v0
    v_lshl_add_u32 v94, v95, 3, v94
    v_add_u32 v94, s40, v94
    s_mul_i32 s39, s13, 163840
    s_mul_i32 s64, s12, 640
    s_add_u32 s39, s39, s64
    s_lshl_b32 s64, s14, 5
    s_add_u32 s41, s39, s64
    s_add_u32 s41, s41, 0x200
    s_lshl_b32 s64, s14, 6
    s_add_u32 s39, s39, s64
    v_and_b32 v0, 63, v0
    v_lshlrev_b32 v1, 4, v0
    s_mul_i32 s64, s14, 36864
    s_add_u32 s64, s64, 16384
    v_add_u32 v2, s64, v1
    v_bfe_u32 v8, v0, 4, 1
    v_mul_u32_u24 v8, 1152, v8
    v_lshrrev_b32 v9, 5, v0
    v_lshlrev_b32 v9, 4, v9
    v_and_b32 v10, 15, v0
    v_add_u32 v9, v9, v10
    s_lshl_b32 s64, s14, 5
    v_add_u32 v9, s64, v9
    v_lshl_add_u32 v8, v9, 3, v8
    v_add_u32 v3, 8192, v8
    v_and_b32 v8, 1, v0
    v_mul_u32_u24 v8, 1152, v8
    v_lshrrev_b32 v9, 4, v0
    v_lshlrev_b32 v9, 2, v9
    v_bfe_u32 v10, v0, 2, 2
    v_add_u32 v9, v9, v10
    v_lshl_add_u32 v8, v9, 3, v8
    v_add_u32 v4, 8192, v8
    v_and_b32 v8, 7, v0
    v_mul_u32_u24 v8, 288, v8
    v_bfe_u32 v9, v0, 3, 1
    v_lshl_add_u32 v8, v9, 5, v8
    v_lshrrev_b32 v9, 4, v0
    v_lshl_add_u32 v8, v9, 3, v8
    s_lshl_b32 s64, s14, 6
    s_add_u32 s64, s64, 12800
    v_add_u32 v5, s64, v8
    s_mov_b32 s32, 0x00ff00ff
    s_mov_b32 s33, 0x00ff00ff
    s_mov_b32 s34, -1
    s_mov_b32 s35, 0
    s_mov_b32 s36, 0x00010001
    s_mov_b32 s37, 0x00010001
    v_mov_b32 v8, 0xeeee
    v_mov_b32 v9, 0x4444
    v_cndmask_b32 v6, v8, v9, s[32:33]
    v_lshrrev_b32 v8, 5, v0
    v_lshlrev_b32 v8, 13, v8
    v_bfe_u32 v9, v0, 3, 1
    v_lshl_add_u32 v8, v9, 12, v8
    v_and_b32 v9, 7, v0
    v_lshl_add_u32 v8, v9, 4, v8
    v_bfe_u32 v9, v0, 4, 1
    v_lshl_add_u32 v7, v9, 3, v8
    s_mov_b32 s10, 0x3e0293ee
    s_mov_b32 s11, 0x3e0293ee
    s_cmp_eq_u32 s14, 0
    s_cselect_b32 s42, 1, 0
    s_cmp_ge_u32 s13, 24
    s_cselect_b32 s65, 1, 0
    s_cmp_eq_u32 s14, 1
    s_cselect_b32 s65, s65, 0
    s_or_b32 s42, s42, s65
    s_lshl_b32 s65, s65, 3
    s_add_u32 s64, s13, s65
    s_cmp_eq_u32 s64, 39
    s_cselect_b32 s22, s42, 0
    s_mul_i32 s24, s12, 163840
    s_add_u32 s24, s24, 0x300000
    s_lshl_b32 s67, s13, 7
    s_add_u32 s26, s24, s67
    s_lshl_b32 s67, s14, 14
    s_add_u32 s23, s26, s67
    s_add_u32 s25, s23, 0x10000
    s_lshl_b32 s67, s14, 13
    s_add_u32 s26, s26, s67
    s_add_u32 s26, s26, 0x20000
    s_lshl_b32 s67, s64, 12
    s_add_u32 s24, s24, s67
    s_lshl_b32 s64, s64, 7
    s_lshl_b32 s65, s12, 13
    s_add_u32 s17, s65, 0x5900000
    s_add_u32 s18, s17, s64
    s_lshl_b32 s65, s12, 21
    s_add_u32 s66, s65, 0x6000000
    s_add_u32 s21, s66, s64
    s_xor_b32 s65, s65, 0x200000
    s_add_u32 s20, s65, 0x5ff8000
    s_and_b32 s64, s13, 1
    s_cmp_eq_u32 s64, s12
    s_cselect_b32 s43, 1, 0
    s_mov_b32 s43, 0
    s_lshl_b32 s64, s13, 4
    s_add_u32 s69, s64, 0x291000
    s_lshl_b32 s64, s13, 2
    s_add_u32 s70, s64, 0x294000
    s_lshl_b32 s64, s13, 14
    s_lshl_b32 s73, s14, 11
    s_lshl_b32 s65, s14, 12
    s_add_u32 s65, s65, s64
    s_add_u32 s3, s65, 0x1500000
    s_add_u32 s64, s64, s73
    s_add_u32 s28, s64, 0x1400000
    s_add_u32 s29, s64, 0x1402000
    s_lshl_b32 s64, s13, 11
    s_add_u32 s30, s64, 0x640000
    s_lshl_b32 s64, s13, 12
    s_lshl_b32 s65, s14, 10
    s_add_u32 s64, s64, s65
    s_add_u32 s31, s64, 0xa40000
    s_waitcnt vmcnt(28)
    s_barrier
    s_add_u32 m0, s40, 32768
    s_add_u32 s64, s72, 0x180000
    buffer_load_dwordx4 v76, s[44:47], s64 offen lds
    s_add_u32 m0, s40, 33792
    s_add_u32 s64, s72, 0x188000
    buffer_load_dwordx4 v77, s[44:47], s64 offen lds
    s_add_u32 m0, s40, 34816
    s_add_u32 s64, s72, 0x190000
    buffer_load_dwordx4 v78, s[44:47], s64 offen lds
    s_add_u32 m0, s40, 35840
    s_add_u32 s64, s72, 0x198000
    buffer_load_dwordx4 v79, s[44:47], s64 offen lds
    ds_read_b64_tr_b16 v[96:97], v72 offset:0
    ds_read_b64_tr_b16 v[98:99], v72 offset:512
    ds_read_b64_tr_b16 v[100:101], v73 offset:0
    ds_read_b64_tr_b16 v[102:103], v73 offset:512
    ds_read_b64_tr_b16 v[104:105], v74 offset:0
    ds_read_b64_tr_b16 v[106:107], v74 offset:512
    ds_read_b64_tr_b16 v[108:109], v75 offset:0
    ds_read_b64_tr_b16 v[110:111], v75 offset:512
    s_waitcnt lgkmcnt(0)
    s_waitcnt vmcnt(28)
    s_barrier
    s_add_u32 m0, s40, 0
    s_add_u32 s64, s72, 0x200000
    buffer_load_dwordx4 v76, s[44:47], s64 offen lds
    s_add_u32 m0, s40, 1024
    s_add_u32 s64, s72, 0x208000
    buffer_load_dwordx4 v77, s[44:47], s64 offen lds
    s_add_u32 m0, s40, 2048
    s_add_u32 s64, s72, 0x210000
    buffer_load_dwordx4 v78, s[44:47], s64 offen lds
    s_add_u32 m0, s40, 3072
    s_add_u32 s64, s72, 0x218000
    buffer_load_dwordx4 v79, s[44:47], s64 offen lds
    ds_read_b64_tr_b16 v[112:113], v72 offset:4096
    ds_read_b64_tr_b16 v[114:115], v72 offset:4608
    ds_read_b64_tr_b16 v[116:117], v73 offset:4096
    ds_read_b64_tr_b16 v[118:119], v73 offset:4608
    ds_read_b64_tr_b16 v[120:121], v74 offset:4096
    ds_read_b64_tr_b16 v[122:123], v74 offset:4608
    ds_read_b64_tr_b16 v[124:125], v75 offset:4096
    ds_read_b64_tr_b16 v[126:127], v75 offset:4608
    s_waitcnt lgkmcnt(0)
    s_waitcnt vmcnt(28)
    s_barrier
    s_add_u32 m0, s40, 4096
    s_add_u32 s64, s72, 0x200000
    buffer_load_dwordx4 v76, s[48:51], s64 offen lds
    s_add_u32 m0, s40, 5120
    s_add_u32 s64, s72, 0x208000
    buffer_load_dwordx4 v77, s[48:51], s64 offen lds
    s_add_u32 m0, s40, 6144
    s_add_u32 s64, s72, 0x210000
    buffer_load_dwordx4 v78, s[48:51], s64 offen lds
    s_add_u32 m0, s40, 7168
    s_add_u32 s64, s72, 0x218000
    buffer_load_dwordx4 v79, s[48:51], s64 offen lds
    ds_read_b64_tr_b16 v[128:129], v72 offset:8192
    ds_read_b64_tr_b16 v[130:131], v72 offset:8704
    ds_read_b64_tr_b16 v[132:133], v73 offset:8192
    ds_read_b64_tr_b16 v[134:135], v73 offset:8704
    ds_read_b64_tr_b16 v[136:137], v74 offset:8192
    ds_read_b64_tr_b16 v[138:139], v74 offset:8704
    ds_read_b64_tr_b16 v[140:141], v75 offset:8192
    ds_read_b64_tr_b16 v[142:143], v75 offset:8704
    s_waitcnt lgkmcnt(0)
    s_waitcnt vmcnt(28)
    s_barrier
    s_add_u32 m0, s40, 8192
    s_add_u32 s64, s71, 0x0
    buffer_load_dwordx4 v76, s[52:55], s64 offen lds
    s_add_u32 m0, s40, 9216
    s_add_u32 s64, s71, 0x8000
    buffer_load_dwordx4 v77, s[52:55], s64 offen lds
    s_add_u32 m0, s40, 10240
    s_add_u32 s64, s71, 0x10000
    buffer_load_dwordx4 v78, s[52:55], s64 offen lds
    s_add_u32 m0, s40, 11264
    s_add_u32 s64, s71, 0x18000
    buffer_load_dwordx4 v79, s[52:55], s64 offen lds
    ds_read_b64_tr_b16 v[144:145], v72 offset:12288
    ds_read_b64_tr_b16 v[146:147], v72 offset:12800
    ds_read_b64_tr_b16 v[148:149], v73 offset:12288
    ds_read_b64_tr_b16 v[150:151], v73 offset:12800
    ds_read_b64_tr_b16 v[152:153], v74 offset:12288
    ds_read_b64_tr_b16 v[154:155], v74 offset:12800
    ds_read_b64_tr_b16 v[156:157], v75 offset:12288
    ds_read_b64_tr_b16 v[158:159], v75 offset:12800
    s_waitcnt lgkmcnt(0)
    s_waitcnt vmcnt(28)
    s_barrier
    s_add_u32 m0, s40, 12288
    s_add_u32 s64, s71, 0x80000
    buffer_load_dwordx4 v76, s[52:55], s64 offen lds
    s_add_u32 m0, s40, 13312
    s_add_u32 s64, s71, 0x88000
    buffer_load_dwordx4 v77, s[52:55], s64 offen lds
    s_add_u32 m0, s40, 14336
    s_add_u32 s64, s71, 0x90000
    buffer_load_dwordx4 v78, s[52:55], s64 offen lds
    s_add_u32 m0, s40, 15360
    s_add_u32 s64, s71, 0x98000
    buffer_load_dwordx4 v79, s[52:55], s64 offen lds
    ds_read_b64_tr_b16 v[160:161], v72 offset:16384
    ds_read_b64_tr_b16 v[162:163], v72 offset:16896
    ds_read_b64_tr_b16 v[164:165], v73 offset:16384
    ds_read_b64_tr_b16 v[166:167], v73 offset:16896
    ds_read_b64_tr_b16 v[168:169], v74 offset:16384
    ds_read_b64_tr_b16 v[170:171], v74 offset:16896
    ds_read_b64_tr_b16 v[172:173], v75 offset:16384
    ds_read_b64_tr_b16 v[174:175], v75 offset:16896
    s_waitcnt lgkmcnt(0)
    s_waitcnt vmcnt(28)
    s_barrier
    s_add_u32 m0, s40, 16384
    s_add_u32 s64, s71, 0x100000
    buffer_load_dwordx4 v76, s[52:55], s64 offen lds
    s_add_u32 m0, s40, 17408
    s_add_u32 s64, s71, 0x108000
    buffer_load_dwordx4 v77, s[52:55], s64 offen lds
    s_add_u32 m0, s40, 18432
    s_add_u32 s64, s71, 0x110000
    buffer_load_dwordx4 v78, s[52:55], s64 offen lds
    s_add_u32 m0, s40, 19456
    s_add_u32 s64, s71, 0x118000
    buffer_load_dwordx4 v79, s[52:55], s64 offen lds
    ds_read_b64_tr_b16 v[176:177], v72 offset:20480
    ds_read_b64_tr_b16 v[178:179], v72 offset:20992
    ds_read_b64_tr_b16 v[180:181], v73 offset:20480
    ds_read_b64_tr_b16 v[182:183], v73 offset:20992
    ds_read_b64_tr_b16 v[184:185], v74 offset:20480
    ds_read_b64_tr_b16 v[186:187], v74 offset:20992
    ds_read_b64_tr_b16 v[188:189], v75 offset:20480
    ds_read_b64_tr_b16 v[190:191], v75 offset:20992
    s_waitcnt lgkmcnt(0)
    s_waitcnt vmcnt(28)
    s_barrier
    s_add_u32 m0, s40, 20480
    s_add_u32 s64, s71, 0x180000
    buffer_load_dwordx4 v76, s[52:55], s64 offen lds
    s_add_u32 m0, s40, 21504
    s_add_u32 s64, s71, 0x188000
    buffer_load_dwordx4 v77, s[52:55], s64 offen lds
    s_add_u32 m0, s40, 22528
    s_add_u32 s64, s71, 0x190000
    buffer_load_dwordx4 v78, s[52:55], s64 offen lds
    s_add_u32 m0, s40, 23552
    s_add_u32 s64, s71, 0x198000
    buffer_load_dwordx4 v79, s[52:55], s64 offen lds
    ds_read_b64_tr_b16 v[192:193], v72 offset:24576
    ds_read_b64_tr_b16 v[194:195], v72 offset:25088
    ds_read_b64_tr_b16 v[196:197], v73 offset:24576
    ds_read_b64_tr_b16 v[198:199], v73 offset:25088
    ds_read_b64_tr_b16 v[200:201], v74 offset:24576
    ds_read_b64_tr_b16 v[202:203], v74 offset:25088
    ds_read_b64_tr_b16 v[204:205], v75 offset:24576
    ds_read_b64_tr_b16 v[206:207], v75 offset:25088
    s_waitcnt lgkmcnt(0)
    s_waitcnt vmcnt(28)
    s_barrier
    s_add_u32 m0, s40, 24576
    s_add_u32 s64, s71, 0x200000
    buffer_load_dwordx4 v76, s[52:55], s64 offen lds
    s_add_u32 m0, s40, 25600
    s_add_u32 s64, s71, 0x208000
    buffer_load_dwordx4 v77, s[52:55], s64 offen lds
    s_add_u32 m0, s40, 26624
    s_add_u32 s64, s71, 0x210000
    buffer_load_dwordx4 v78, s[52:55], s64 offen lds
    s_add_u32 m0, s40, 27648
    s_add_u32 s64, s71, 0x218000
    buffer_load_dwordx4 v79, s[52:55], s64 offen lds
    ds_read_b64_tr_b16 v[208:209], v72 offset:28672
    ds_read_b64_tr_b16 v[210:211], v72 offset:29184
    ds_read_b64_tr_b16 v[212:213], v73 offset:28672
    ds_read_b64_tr_b16 v[214:215], v73 offset:29184
    ds_read_b64_tr_b16 v[216:217], v74 offset:28672
    ds_read_b64_tr_b16 v[218:219], v74 offset:29184
    ds_read_b64_tr_b16 v[220:221], v75 offset:28672
    ds_read_b64_tr_b16 v[222:223], v75 offset:29184
    s_waitcnt lgkmcnt(0)
    s_waitcnt vmcnt(28)
    s_barrier
    s_add_u32 m0, s40, 28672
    s_add_u32 s64, s72, 0x0
    buffer_load_dwordx4 v76, s[52:55], s64 offen lds
    s_add_u32 m0, s40, 29696
    s_add_u32 s64, s72, 0x8000
    buffer_load_dwordx4 v77, s[52:55], s64 offen lds
    s_add_u32 m0, s40, 30720
    s_add_u32 s64, s72, 0x10000
    buffer_load_dwordx4 v78, s[52:55], s64 offen lds
    s_add_u32 m0, s40, 31744
    s_add_u32 s64, s72, 0x18000
    buffer_load_dwordx4 v79, s[52:55], s64 offen lds
    ds_read_b64_tr_b16 v[224:225], v72 offset:32768
    ds_read_b64_tr_b16 v[226:227], v72 offset:33280
    ds_read_b64_tr_b16 v[228:229], v73 offset:32768
    ds_read_b64_tr_b16 v[230:231], v73 offset:33280
    ds_read_b64_tr_b16 v[232:233], v74 offset:32768
    ds_read_b64_tr_b16 v[234:235], v74 offset:33280
    ds_read_b64_tr_b16 v[236:237], v75 offset:32768
    ds_read_b64_tr_b16 v[238:239], v75 offset:33280
    s_waitcnt lgkmcnt(0)
    s_waitcnt vmcnt(28)
    s_barrier
    s_add_u32 m0, s40, 32768
    s_add_u32 s64, s72, 0x80000
    buffer_load_dwordx4 v76, s[52:55], s64 offen lds
    s_add_u32 m0, s40, 33792
    s_add_u32 s64, s72, 0x88000
    buffer_load_dwordx4 v77, s[52:55], s64 offen lds
    s_add_u32 m0, s40, 34816
    s_add_u32 s64, s72, 0x90000
    buffer_load_dwordx4 v78, s[52:55], s64 offen lds
    s_add_u32 m0, s40, 35840
    s_add_u32 s64, s72, 0x98000
    buffer_load_dwordx4 v79, s[52:55], s64 offen lds
    ds_read_b64_tr_b16 v[240:241], v72 offset:0
    ds_read_b64_tr_b16 v[242:243], v72 offset:512
    ds_read_b64_tr_b16 v[244:245], v73 offset:0
    ds_read_b64_tr_b16 v[246:247], v73 offset:512
    ds_read_b64_tr_b16 v[248:249], v74 offset:0
    ds_read_b64_tr_b16 v[250:251], v74 offset:512
    ds_read_b64_tr_b16 v[252:253], v75 offset:0
    ds_read_b64_tr_b16 v[254:255], v75 offset:512
    s_waitcnt lgkmcnt(0)
    s_waitcnt vmcnt(28)
    s_barrier
    s_add_u32 m0, s40, 0
    s_add_u32 s64, s72, 0x100000
    buffer_load_dwordx4 v76, s[52:55], s64 offen lds
    s_add_u32 m0, s40, 1024
    s_add_u32 s64, s72, 0x108000
    buffer_load_dwordx4 v77, s[52:55], s64 offen lds
    s_add_u32 m0, s40, 2048
    s_add_u32 s64, s72, 0x110000
    buffer_load_dwordx4 v78, s[52:55], s64 offen lds
    s_add_u32 m0, s40, 3072
    s_add_u32 s64, s72, 0x118000
    buffer_load_dwordx4 v79, s[52:55], s64 offen lds
    ds_read_b64_tr_b16 a[240:241], v72 offset:4096
    ds_read_b64_tr_b16 a[242:243], v72 offset:4608
    ds_read_b64_tr_b16 a[244:245], v73 offset:4096
    ds_read_b64_tr_b16 a[246:247], v73 offset:4608
    ds_read_b64_tr_b16 a[248:249], v74 offset:4096
    ds_read_b64_tr_b16 a[250:251], v74 offset:4608
    ds_read_b64_tr_b16 a[252:253], v75 offset:4096
    ds_read_b64_tr_b16 a[254:255], v75 offset:4608
    s_waitcnt lgkmcnt(0)
    s_waitcnt vmcnt(28)
    s_barrier
    s_add_u32 m0, s40, 4096
    s_add_u32 s64, s72, 0x180000
    buffer_load_dwordx4 v76, s[52:55], s64 offen lds
    s_add_u32 m0, s40, 5120
    s_add_u32 s64, s72, 0x188000
    buffer_load_dwordx4 v77, s[52:55], s64 offen lds
    s_add_u32 m0, s40, 6144
    s_add_u32 s64, s72, 0x190000
    buffer_load_dwordx4 v78, s[52:55], s64 offen lds
    s_add_u32 m0, s40, 7168
    s_add_u32 s64, s72, 0x198000
    buffer_load_dwordx4 v79, s[52:55], s64 offen lds
    ds_read_b64_tr_b16 a[0:1], v72 offset:8192
    ds_read_b64_tr_b16 a[2:3], v72 offset:8704
    ds_read_b64_tr_b16 a[4:5], v73 offset:8192
    ds_read_b64_tr_b16 a[6:7], v73 offset:8704
    ds_read_b64_tr_b16 a[8:9], v74 offset:8192
    ds_read_b64_tr_b16 a[10:11], v74 offset:8704
    ds_read_b64_tr_b16 a[12:13], v75 offset:8192
    ds_read_b64_tr_b16 a[14:15], v75 offset:8704
    s_waitcnt lgkmcnt(0)
    s_waitcnt vmcnt(28)
    s_barrier
    s_add_u32 m0, s40, 8192
    s_add_u32 s64, s72, 0x200000
    buffer_load_dwordx4 v76, s[52:55], s64 offen lds
    s_add_u32 m0, s40, 9216
    s_add_u32 s64, s72, 0x208000
    buffer_load_dwordx4 v77, s[52:55], s64 offen lds
    s_add_u32 m0, s40, 10240
    s_add_u32 s64, s72, 0x210000
    buffer_load_dwordx4 v78, s[52:55], s64 offen lds
    s_add_u32 m0, s40, 11264
    s_add_u32 s64, s72, 0x218000
    buffer_load_dwordx4 v79, s[52:55], s64 offen lds
    ds_read_b64_tr_b16 a[16:17], v72 offset:12288
    ds_read_b64_tr_b16 a[18:19], v72 offset:12800
    ds_read_b64_tr_b16 a[20:21], v73 offset:12288
    ds_read_b64_tr_b16 a[22:23], v73 offset:12800
    ds_read_b64_tr_b16 a[24:25], v74 offset:12288
    ds_read_b64_tr_b16 a[26:27], v74 offset:12800
    ds_read_b64_tr_b16 a[28:29], v75 offset:12288
    ds_read_b64_tr_b16 a[30:31], v75 offset:12800
    s_waitcnt lgkmcnt(0)
    s_waitcnt vmcnt(28)
    s_barrier
    s_add_u32 m0, s40, 12288
    s_add_u32 s64, s39, 0x0
    buffer_load_dwordx4 v89, s[56:59], s64 offen lds
    s_add_u32 m0, s40, 13312
    s_add_u32 s64, s39, 0x5000
    buffer_load_dwordx4 v89, s[56:59], s64 offen lds
    s_add_u32 m0, s40, 14336
    s_add_u32 s64, s39, 0xa000
    buffer_load_dwordx4 v89, s[56:59], s64 offen lds
    s_add_u32 m0, s40, 15360
    s_add_u32 s64, s39, 0xf000
    buffer_load_dwordx4 v89, s[56:59], s64 offen lds
    ds_read_b64_tr_b16 a[32:33], v72 offset:16384
    ds_read_b64_tr_b16 a[34:35], v72 offset:16896
    ds_read_b64_tr_b16 a[36:37], v73 offset:16384
    ds_read_b64_tr_b16 a[38:39], v73 offset:16896
    ds_read_b64_tr_b16 a[40:41], v74 offset:16384
    ds_read_b64_tr_b16 a[42:43], v74 offset:16896
    ds_read_b64_tr_b16 a[44:45], v75 offset:16384
    ds_read_b64_tr_b16 a[46:47], v75 offset:16896
    s_waitcnt lgkmcnt(0)
    s_waitcnt vmcnt(28)
    s_barrier
    s_add_u32 m0, s40, 16384
    s_add_u32 s64, s39, 0x14000
    buffer_load_dwordx4 v89, s[56:59], s64 offen lds
    s_add_u32 m0, s40, 17408
    s_add_u32 s64, s39, 0x19000
    buffer_load_dwordx4 v89, s[56:59], s64 offen lds
    s_add_u32 m0, s40, 18432
    s_add_u32 s64, s39, 0x1e000
    buffer_load_dwordx4 v89, s[56:59], s64 offen lds
    s_add_u32 m0, s40, 19456
    s_add_u32 s64, s39, 0x23000
    buffer_load_dwordx4 v89, s[56:59], s64 offen lds
    ds_read_b64_tr_b16 a[48:49], v72 offset:20480
    ds_read_b64_tr_b16 a[50:51], v72 offset:20992
    ds_read_b64_tr_b16 a[52:53], v73 offset:20480
    ds_read_b64_tr_b16 a[54:55], v73 offset:20992
    ds_read_b64_tr_b16 a[56:57], v74 offset:20480
    ds_read_b64_tr_b16 a[58:59], v74 offset:20992
    ds_read_b64_tr_b16 a[60:61], v75 offset:20480
    ds_read_b64_tr_b16 a[62:63], v75 offset:20992
    s_waitcnt lgkmcnt(0)
    s_waitcnt vmcnt(28)
    s_barrier
    s_add_u32 m0, s40, 20480
    s_add_u32 s64, s39, 0x100
    buffer_load_dwordx4 v89, s[56:59], s64 offen lds
    s_add_u32 m0, s40, 21504
    s_add_u32 s64, s39, 0x5100
    buffer_load_dwordx4 v89, s[56:59], s64 offen lds
    s_add_u32 m0, s40, 22528
    s_add_u32 s64, s39, 0xa100
    buffer_load_dwordx4 v89, s[56:59], s64 offen lds
    s_add_u32 m0, s40, 23552
    s_add_u32 s64, s39, 0xf100
    buffer_load_dwordx4 v89, s[56:59], s64 offen lds
    ds_read_b64_tr_b16 a[64:65], v72 offset:24576
    ds_read_b64_tr_b16 a[66:67], v72 offset:25088
    ds_read_b64_tr_b16 a[68:69], v73 offset:24576
    ds_read_b64_tr_b16 a[70:71], v73 offset:25088
    ds_read_b64_tr_b16 a[72:73], v74 offset:24576
    ds_read_b64_tr_b16 a[74:75], v74 offset:25088
    ds_read_b64_tr_b16 a[76:77], v75 offset:24576
    ds_read_b64_tr_b16 a[78:79], v75 offset:25088
    s_waitcnt lgkmcnt(0)
    s_waitcnt vmcnt(28)
    s_barrier
    s_add_u32 m0, s40, 24576
    s_add_u32 s64, s39, 0x14100
    buffer_load_dwordx4 v89, s[56:59], s64 offen lds
    s_add_u32 m0, s40, 25600
    s_add_u32 s64, s39, 0x19100
    buffer_load_dwordx4 v89, s[56:59], s64 offen lds
    s_add_u32 m0, s40, 26624
    s_add_u32 s64, s39, 0x1e100
    buffer_load_dwordx4 v89, s[56:59], s64 offen lds
    s_add_u32 m0, s40, 27648
    s_add_u32 s64, s39, 0x23100
    buffer_load_dwordx4 v89, s[56:59], s64 offen lds
    ds_read_b64_tr_b16 a[80:81], v72 offset:28672
    ds_read_b64_tr_b16 a[82:83], v72 offset:29184
    ds_read_b64_tr_b16 a[84:85], v73 offset:28672
    ds_read_b64_tr_b16 a[86:87], v73 offset:29184
    ds_read_b64_tr_b16 a[88:89], v74 offset:28672
    ds_read_b64_tr_b16 a[90:91], v74 offset:29184
    ds_read_b64_tr_b16 a[92:93], v75 offset:28672
    ds_read_b64_tr_b16 a[94:95], v75 offset:29184
    s_waitcnt lgkmcnt(0)
    s_waitcnt vmcnt(28)
    s_barrier
    s_add_u32 m0, s40, 28672
    s_add_u32 s64, s41, 0x0
    buffer_load_dwordx4 v90, s[56:59], s64 offen lds
    s_add_u32 m0, s40, 29696
    s_add_u32 s64, s41, 0xa000
    buffer_load_dwordx4 v90, s[56:59], s64 offen lds
    s_add_u32 m0, s40, 30720
    s_add_u32 s64, s41, 0x14000
    buffer_load_dwordx4 v90, s[56:59], s64 offen lds
    s_add_u32 m0, s40, 31744
    s_add_u32 s64, s41, 0x1e000
    buffer_load_dwordx4 v90, s[56:59], s64 offen lds
    ds_read_b64_tr_b16 a[96:97], v72 offset:32768
    ds_read_b64_tr_b16 a[98:99], v72 offset:33280
    ds_read_b64_tr_b16 a[100:101], v73 offset:32768
    ds_read_b64_tr_b16 a[102:103], v73 offset:33280
    ds_read_b64_tr_b16 a[104:105], v74 offset:32768
    ds_read_b64_tr_b16 a[106:107], v74 offset:33280
    ds_read_b64_tr_b16 a[108:109], v75 offset:32768
    ds_read_b64_tr_b16 a[110:111], v75 offset:33280
    s_waitcnt lgkmcnt(0)
    s_waitcnt vmcnt(28)
    s_barrier
    s_add_u32 m0, s40, 32768
    s_add_u32 s64, s72, 0x180000
    buffer_load_dwordx4 v76, s[48:51], s64 offen lds
    s_add_u32 m0, s40, 33792
    s_add_u32 s64, s72, 0x188000
    buffer_load_dwordx4 v77, s[48:51], s64 offen lds
    s_add_u32 m0, s40, 34816
    s_add_u32 s64, s72, 0x190000
    buffer_load_dwordx4 v78, s[48:51], s64 offen lds
    s_add_u32 m0, s40, 35840
    s_add_u32 s64, s72, 0x198000
    buffer_load_dwordx4 v79, s[48:51], s64 offen lds
    v_lshlrev_b32 v80, 2, v0
    buffer_load_dword v81, v80, s[60:63], 0 offen sc1
    ds_read_b64_tr_b16 a[112:113], v72 offset:0
    ds_read_b64_tr_b16 a[114:115], v72 offset:512
    ds_read_b64_tr_b16 a[116:117], v73 offset:0
    ds_read_b64_tr_b16 a[118:119], v73 offset:512
    ds_read_b64_tr_b16 a[120:121], v74 offset:0
    ds_read_b64_tr_b16 a[122:123], v74 offset:512
    ds_read_b64_tr_b16 a[124:125], v75 offset:0
    ds_read_b64_tr_b16 a[126:127], v75 offset:512
    s_waitcnt lgkmcnt(0)
    s_waitcnt vmcnt(29)
    s_barrier
    s_add_u32 m0, s40, 0
    s_add_u32 s64, s71, 0x0
    buffer_load_dwordx4 v76, s[48:51], s64 offen lds
    s_add_u32 m0, s40, 1024
    s_add_u32 s64, s71, 0x8000
    buffer_load_dwordx4 v77, s[48:51], s64 offen lds
    s_add_u32 m0, s40, 2048
    s_add_u32 s64, s71, 0x10000
    buffer_load_dwordx4 v78, s[48:51], s64 offen lds
    s_add_u32 m0, s40, 3072
    s_add_u32 s64, s71, 0x18000
    buffer_load_dwordx4 v79, s[48:51], s64 offen lds
    ds_read_b64_tr_b16 a[128:129], v72 offset:4096
    ds_read_b64_tr_b16 a[130:131], v72 offset:4608
    ds_read_b64_tr_b16 a[132:133], v73 offset:4096
    ds_read_b64_tr_b16 a[134:135], v73 offset:4608
    ds_read_b64_tr_b16 a[136:137], v74 offset:4096
    ds_read_b64_tr_b16 a[138:139], v74 offset:4608
    ds_read_b64_tr_b16 a[140:141], v75 offset:4096
    ds_read_b64_tr_b16 a[142:143], v75 offset:4608
    s_waitcnt lgkmcnt(0)
    s_waitcnt vmcnt(29)
    s_barrier
    s_add_u32 m0, s40, 4096
    s_add_u32 s64, s71, 0x80000
    buffer_load_dwordx4 v76, s[48:51], s64 offen lds
    s_add_u32 m0, s40, 5120
    s_add_u32 s64, s71, 0x88000
    buffer_load_dwordx4 v77, s[48:51], s64 offen lds
    s_add_u32 m0, s40, 6144
    s_add_u32 s64, s71, 0x90000
    buffer_load_dwordx4 v78, s[48:51], s64 offen lds
    s_add_u32 m0, s40, 7168
    s_add_u32 s64, s71, 0x98000
    buffer_load_dwordx4 v79, s[48:51], s64 offen lds
    ds_read_b64_tr_b16 a[144:145], v72 offset:8192
    ds_read_b64_tr_b16 a[146:147], v72 offset:8704
    ds_read_b64_tr_b16 a[148:149], v73 offset:8192
    ds_read_b64_tr_b16 a[150:151], v73 offset:8704
    ds_read_b64_tr_b16 a[152:153], v74 offset:8192
    ds_read_b64_tr_b16 a[154:155], v74 offset:8704
    ds_read_b64_tr_b16 a[156:157], v75 offset:8192
    ds_read_b64_tr_b16 a[158:159], v75 offset:8704
    s_waitcnt lgkmcnt(0)
    s_waitcnt vmcnt(29)
    s_barrier
    s_add_u32 m0, s40, 8192
    s_add_u32 s64, s71, 0x100000
    buffer_load_dwordx4 v76, s[48:51], s64 offen lds
    s_add_u32 m0, s40, 9216
    s_add_u32 s64, s71, 0x108000
    buffer_load_dwordx4 v77, s[48:51], s64 offen lds
    s_add_u32 m0, s40, 10240
    s_add_u32 s64, s71, 0x110000
    buffer_load_dwordx4 v78, s[48:51], s64 offen lds
    s_add_u32 m0, s40, 11264
    s_add_u32 s64, s71, 0x118000
    buffer_load_dwordx4 v79, s[48:51], s64 offen lds
    ds_read_b64_tr_b16 a[160:161], v93 offset:12288
    ds_read_b64_tr_b16 a[162:163], v93 offset:12544
    ds_read_b64_tr_b16 a[164:165], v93 offset:13312
    ds_read_b64_tr_b16 a[166:167], v93 offset:13568
    ds_read_b64_tr_b16 a[168:169], v93 offset:14336
    ds_read_b64_tr_b16 a[170:171], v93 offset:14592
    ds_read_b64_tr_b16 a[172:173], v93 offset:15360
    ds_read_b64_tr_b16 a[174:175], v93 offset:15616
    s_waitcnt lgkmcnt(0)
    s_waitcnt vmcnt(29)
    s_barrier
    s_add_u32 m0, s40, 12288
    s_add_u32 s64, s71, 0x180000
    buffer_load_dwordx4 v76, s[48:51], s64 offen lds
    s_add_u32 m0, s40, 13312
    s_add_u32 s64, s71, 0x188000
    buffer_load_dwordx4 v77, s[48:51], s64 offen lds
    s_add_u32 m0, s40, 14336
    s_add_u32 s64, s71, 0x190000
    buffer_load_dwordx4 v78, s[48:51], s64 offen lds
    s_add_u32 m0, s40, 15360
    s_add_u32 s64, s71, 0x198000
    buffer_load_dwordx4 v79, s[48:51], s64 offen lds
    ds_read_b64_tr_b16 a[176:177], v93 offset:16384
    ds_read_b64_tr_b16 a[178:179], v93 offset:16640
    ds_read_b64_tr_b16 a[180:181], v93 offset:17408
    ds_read_b64_tr_b16 a[182:183], v93 offset:17664
    ds_read_b64_tr_b16 a[184:185], v93 offset:18432
    ds_read_b64_tr_b16 a[186:187], v93 offset:18688
    ds_read_b64_tr_b16 a[188:189], v93 offset:19456
    ds_read_b64_tr_b16 a[190:191], v93 offset:19712
    s_waitcnt lgkmcnt(0)
    s_waitcnt vmcnt(29)
    s_barrier
    s_add_u32 m0, s40, 16384
    s_add_u32 s64, s71, 0x200000
    buffer_load_dwordx4 v76, s[48:51], s64 offen lds
    s_add_u32 m0, s40, 17408
    s_add_u32 s64, s71, 0x208000
    buffer_load_dwordx4 v77, s[48:51], s64 offen lds
    s_add_u32 m0, s40, 18432
    s_add_u32 s64, s71, 0x210000
    buffer_load_dwordx4 v78, s[48:51], s64 offen lds
    s_add_u32 m0, s40, 19456
    s_add_u32 s64, s71, 0x218000
    buffer_load_dwordx4 v79, s[48:51], s64 offen lds
    ds_read_b64_tr_b16 a[192:193], v93 offset:20480
    ds_read_b64_tr_b16 a[194:195], v93 offset:20736
    ds_read_b64_tr_b16 a[196:197], v93 offset:21504
    ds_read_b64_tr_b16 a[198:199], v93 offset:21760
    ds_read_b64_tr_b16 a[200:201], v93 offset:22528
    ds_read_b64_tr_b16 a[202:203], v93 offset:22784
    ds_read_b64_tr_b16 a[204:205], v93 offset:23552
    ds_read_b64_tr_b16 a[206:207], v93 offset:23808
    s_waitcnt lgkmcnt(0)
    s_waitcnt vmcnt(29)
    s_barrier
    s_add_u32 m0, s40, 20480
    s_add_u32 s64, s72, 0x0
    buffer_load_dwordx4 v76, s[48:51], s64 offen lds
    s_add_u32 m0, s40, 21504
    s_add_u32 s64, s72, 0x8000
    buffer_load_dwordx4 v77, s[48:51], s64 offen lds
    s_add_u32 m0, s40, 22528
    s_add_u32 s64, s72, 0x10000
    buffer_load_dwordx4 v78, s[48:51], s64 offen lds
    s_add_u32 m0, s40, 23552
    s_add_u32 s64, s72, 0x18000
    buffer_load_dwordx4 v79, s[48:51], s64 offen lds
    ds_read_b64_tr_b16 a[208:209], v93 offset:24576
    ds_read_b64_tr_b16 a[210:211], v93 offset:24832
    ds_read_b64_tr_b16 a[212:213], v93 offset:25600
    ds_read_b64_tr_b16 a[214:215], v93 offset:25856
    ds_read_b64_tr_b16 a[216:217], v93 offset:26624
    ds_read_b64_tr_b16 a[218:219], v93 offset:26880
    ds_read_b64_tr_b16 a[220:221], v93 offset:27648
    ds_read_b64_tr_b16 a[222:223], v93 offset:27904
    s_waitcnt lgkmcnt(0)
    s_waitcnt vmcnt(29)
    s_barrier
    s_add_u32 m0, s40, 24576
    s_add_u32 s64, s72, 0x80000
    buffer_load_dwordx4 v76, s[48:51], s64 offen lds
    s_add_u32 m0, s40, 25600
    s_add_u32 s64, s72, 0x88000
    buffer_load_dwordx4 v77, s[48:51], s64 offen lds
    s_add_u32 m0, s40, 26624
    s_add_u32 s64, s72, 0x90000
    buffer_load_dwordx4 v78, s[48:51], s64 offen lds
    s_add_u32 m0, s40, 27648
    s_add_u32 s64, s72, 0x98000
    buffer_load_dwordx4 v79, s[48:51], s64 offen lds
    ds_read_b64_tr_b16 a[224:225], v94 offset:28672
    ds_read_b64_tr_b16 a[226:227], v94 offset:28800
    ds_read_b64_tr_b16 a[228:229], v94 offset:29696
    ds_read_b64_tr_b16 a[230:231], v94 offset:29824
    ds_read_b64_tr_b16 a[232:233], v94 offset:30720
    ds_read_b64_tr_b16 a[234:235], v94 offset:30848
    ds_read_b64_tr_b16 a[236:237], v94 offset:31744
    ds_read_b64_tr_b16 a[238:239], v94 offset:31872
    s_waitcnt lgkmcnt(0)
    s_waitcnt vmcnt(29)
    s_barrier
    s_add_u32 m0, s40, 28672
    s_add_u32 s64, s72, 0x100000
    buffer_load_dwordx4 v76, s[48:51], s64 offen lds
    s_add_u32 m0, s40, 29696
    s_add_u32 s64, s72, 0x108000
    buffer_load_dwordx4 v77, s[48:51], s64 offen lds
    s_add_u32 m0, s40, 30720
    s_add_u32 s64, s72, 0x110000
    buffer_load_dwordx4 v78, s[48:51], s64 offen lds
    s_add_u32 m0, s40, 31744
    s_add_u32 s64, s72, 0x118000
    buffer_load_dwordx4 v79, s[48:51], s64 offen lds
    s_mov_b32 s65, 0x290800
    buffer_load_dword v84, off, s[4:7], s65 sc1
    buffer_load_dwordx2 v[82:83], off, s[4:7], s69 sc1
    ds_read_b64_tr_b16 v[12:13], v72 offset:32768
    ds_read_b64_tr_b16 v[14:15], v72 offset:33280
    ds_read_b64_tr_b16 v[16:17], v73 offset:32768
    ds_read_b64_tr_b16 v[18:19], v73 offset:33280
    ds_read_b64_tr_b16 v[20:21], v74 offset:32768
    ds_read_b64_tr_b16 v[22:23], v74 offset:33280
    ds_read_b64_tr_b16 v[24:25], v75 offset:32768
    ds_read_b64_tr_b16 v[26:27], v75 offset:33280
    s_waitcnt lgkmcnt(0)
    s_barrier
    ds_write_b128 v2, v[12:15] offset:32768
    ds_write_b128 v2, v[16:19] offset:33792
    ds_write_b128 v2, v[20:23] offset:34816
    ds_write_b128 v2, v[24:27] offset:35840
    s_waitcnt lgkmcnt(0)
    s_waitcnt vmcnt(30)
    s_barrier
    ds_read_b64_tr_b16 v[12:13], v72 offset:0
    ds_read_b64_tr_b16 v[14:15], v72 offset:512
    ds_read_b64_tr_b16 v[16:17], v73 offset:0
    ds_read_b64_tr_b16 v[18:19], v73 offset:512
    ds_read_b64_tr_b16 v[20:21], v74 offset:0
    ds_read_b64_tr_b16 v[22:23], v74 offset:512
    ds_read_b64_tr_b16 v[24:25], v75 offset:0
    ds_read_b64_tr_b16 v[26:27], v75 offset:512
    s_waitcnt lgkmcnt(0)
    s_barrier
    ds_write_b128 v2, v[12:15] offset:0
    ds_write_b128 v2, v[16:19] offset:1024
    ds_write_b128 v2, v[20:23] offset:2048
    ds_write_b128 v2, v[24:27] offset:3072
    s_waitcnt lgkmcnt(0)
    s_waitcnt vmcnt(26)
    s_barrier
    ds_read_b64_tr_b16 v[12:13], v72 offset:4096
    ds_read_b64_tr_b16 v[14:15], v72 offset:4608
    ds_read_b64_tr_b16 v[16:17], v73 offset:4096
    ds_read_b64_tr_b16 v[18:19], v73 offset:4608
    ds_read_b64_tr_b16 v[20:21], v74 offset:4096
    ds_read_b64_tr_b16 v[22:23], v74 offset:4608
    ds_read_b64_tr_b16 v[24:25], v75 offset:4096
    ds_read_b64_tr_b16 v[26:27], v75 offset:4608
    s_waitcnt lgkmcnt(0)
    s_barrier
    ds_write_b128 v2, v[12:15] offset:4096
    ds_write_b128 v2, v[16:19] offset:5120
    ds_write_b128 v2, v[20:23] offset:6144
    ds_write_b128 v2, v[24:27] offset:7168
    s_waitcnt lgkmcnt(0)
    s_waitcnt vmcnt(22)
    s_barrier
    ds_read_b64_tr_b16 v[12:13], v72 offset:8192
    ds_read_b64_tr_b16 v[14:15], v72 offset:8704
    ds_read_b64_tr_b16 v[16:17], v73 offset:8192
    ds_read_b64_tr_b16 v[18:19], v73 offset:8704
    ds_read_b64_tr_b16 v[20:21], v74 offset:8192
    ds_read_b64_tr_b16 v[22:23], v74 offset:8704
    ds_read_b64_tr_b16 v[24:25], v75 offset:8192
    ds_read_b64_tr_b16 v[26:27], v75 offset:8704
    s_waitcnt lgkmcnt(0)
    s_barrier
    ds_write_b128 v2, v[12:15] offset:8192
    ds_write_b128 v2, v[16:19] offset:9216
    ds_write_b128 v2, v[20:23] offset:10240
    ds_write_b128 v2, v[24:27] offset:11264
    s_waitcnt lgkmcnt(0)
    s_waitcnt vmcnt(18)
    s_barrier
    ds_read_b64_tr_b16 v[12:13], v72 offset:12288
    ds_read_b64_tr_b16 v[14:15], v72 offset:12800
    ds_read_b64_tr_b16 v[16:17], v73 offset:12288
    ds_read_b64_tr_b16 v[18:19], v73 offset:12800
    ds_read_b64_tr_b16 v[20:21], v74 offset:12288
    ds_read_b64_tr_b16 v[22:23], v74 offset:12800
    ds_read_b64_tr_b16 v[24:25], v75 offset:12288
    ds_read_b64_tr_b16 v[26:27], v75 offset:12800
    s_waitcnt lgkmcnt(0)
    s_barrier
    ds_write_b128 v2, v[12:15] offset:12288
    ds_write_b128 v2, v[16:19] offset:13312
    ds_write_b128 v2, v[20:23] offset:14336
    ds_write_b128 v2, v[24:27] offset:15360
    s_waitcnt lgkmcnt(0)
    s_waitcnt vmcnt(14)
    s_barrier
    ds_read_b64_tr_b16 v[12:13], v72 offset:16384
    ds_read_b64_tr_b16 v[14:15], v72 offset:16896
    ds_read_b64_tr_b16 v[16:17], v73 offset:16384
    ds_read_b64_tr_b16 v[18:19], v73 offset:16896
    ds_read_b64_tr_b16 v[20:21], v74 offset:16384
    ds_read_b64_tr_b16 v[22:23], v74 offset:16896
    ds_read_b64_tr_b16 v[24:25], v75 offset:16384
    ds_read_b64_tr_b16 v[26:27], v75 offset:16896
    s_waitcnt lgkmcnt(0)
    s_barrier
    ds_write_b128 v2, v[12:15] offset:16384
    ds_write_b128 v2, v[16:19] offset:17408
    ds_write_b128 v2, v[20:23] offset:18432
    ds_write_b128 v2, v[24:27] offset:19456
    s_waitcnt lgkmcnt(0)
    s_waitcnt vmcnt(10)
    s_barrier
    ds_read_b64_tr_b16 v[12:13], v72 offset:20480
    ds_read_b64_tr_b16 v[14:15], v72 offset:20992
    ds_read_b64_tr_b16 v[16:17], v73 offset:20480
    ds_read_b64_tr_b16 v[18:19], v73 offset:20992
    ds_read_b64_tr_b16 v[20:21], v74 offset:20480
    ds_read_b64_tr_b16 v[22:23], v74 offset:20992
    ds_read_b64_tr_b16 v[24:25], v75 offset:20480
    ds_read_b64_tr_b16 v[26:27], v75 offset:20992
    s_waitcnt lgkmcnt(0)
    s_barrier
    ds_write_b128 v2, v[12:15] offset:20480
    ds_write_b128 v2, v[16:19] offset:21504
    ds_write_b128 v2, v[20:23] offset:22528
    ds_write_b128 v2, v[24:27] offset:23552
    s_waitcnt lgkmcnt(0)
    s_waitcnt vmcnt(6)
    s_barrier
    ds_read_b64_tr_b16 v[12:13], v72 offset:24576
    ds_read_b64_tr_b16 v[14:15], v72 offset:25088
    ds_read_b64_tr_b16 v[16:17], v73 offset:24576
    ds_read_b64_tr_b16 v[18:19], v73 offset:25088
    ds_read_b64_tr_b16 v[20:21], v74 offset:24576
    ds_read_b64_tr_b16 v[22:23], v74 offset:25088
    ds_read_b64_tr_b16 v[24:25], v75 offset:24576
    ds_read_b64_tr_b16 v[26:27], v75 offset:25088
    s_waitcnt lgkmcnt(0)
    s_barrier
    ds_write_b128 v2, v[12:15] offset:24576
    ds_write_b128 v2, v[16:19] offset:25600
    ds_write_b128 v2, v[20:23] offset:26624
    ds_write_b128 v2, v[24:27] offset:27648
    s_waitcnt lgkmcnt(0)
    s_waitcnt vmcnt(2)
    s_barrier
    ds_read_b64_tr_b16 v[12:13], v72 offset:28672
    ds_read_b64_tr_b16 v[14:15], v72 offset:29184
    ds_read_b64_tr_b16 v[16:17], v73 offset:28672
    ds_read_b64_tr_b16 v[18:19], v73 offset:29184
    ds_read_b64_tr_b16 v[20:21], v74 offset:28672
    ds_read_b64_tr_b16 v[22:23], v74 offset:29184
    ds_read_b64_tr_b16 v[24:25], v75 offset:28672
    ds_read_b64_tr_b16 v[26:27], v75 offset:29184
    s_waitcnt lgkmcnt(0)
    s_barrier
    ds_write_b128 v2, v[12:15] offset:28672
    ds_write_b128 v2, v[16:19] offset:29696
    ds_write_b128 v2, v[20:23] offset:30720
    ds_write_b128 v2, v[24:27] offset:31744
    s_waitcnt lgkmcnt(0)
    s_waitcnt vmcnt(0)
    s_cmp_lg_u32 s97, 0
    s_cbranch_scc1 NOTEARLY_8
    v_cmp_ne_u32 vcc, 32, v81
    v_readlane_b32 s64, v81, 1
    v_readlane_b32 s66, v81, 33
    v_readlane_b32 s67, v81, 34
    s_and_b32 s65, vcc_lo, 0x01010101
    s_cbranch_scc1 NOTEARLY_8
    s_and_b32 s65, vcc_hi, 0x01010101
    s_cbranch_scc1 NOTEARLY_8
    s_cmp_lt_u32 s64, 186
    s_cbranch_scc1 NOTEARLY_8
    v_readfirstlane_b32 s64, v84
    s_cmp_lt_u32 s64, 192
    s_cbranch_scc1 NOTEARLY_8
    s_min_u32 s65, s66, s67
    s_cmp_eq_u32 s65, 0
    s_cbranch_scc1 NOTEARLY_8
    v_readlane_b32 s64, v81, 6
    v_readlane_b32 s65, v81, 7
    s_and_b32 s64, s64, s65
    s_cmp_eq_u32 s64, -1
    s_cselect_b32 s64, 0, s94
    s_cmp_lg_u32 s64, 0
    s_cbranch_scc1 M_GFAIL
    s_sub_u32 s66, s66, 1
    s_sub_u32 s67, s67, 1
    s_branch EARLY_7
NOTEARLY_8:
    s_cmp_lg_u32 s97, 0
    s_cbranch_scc1 CM_9
    v_mbcnt_lo_u32_b32 v0, -1, 0
    v_mbcnt_hi_u32_b32 v0, -1, v0
    v_mul_u32_u24 v8, 32, v0
    s_mov_b32 s64, 0x0
    s_mov_b32 s65, 0
    s_mov_b64 exec, 0xff
TK_10:
    buffer_load_dword v9, v8, s[60:63], s64 offen sc1
    s_add_u32 s65, s65, 1
    s_waitcnt vmcnt(0)
    s_mov_b32 s66, 0
    v_readlane_b32 s67, v9, 0
    s_add_u32 s66, s66, s67
    v_readlane_b32 s67, v9, 1
    s_add_u32 s66, s66, s67
    v_readlane_b32 s67, v9, 2
    s_add_u32 s66, s66, s67
    v_readlane_b32 s67, v9, 3
    s_add_u32 s66, s66, s67
    v_readlane_b32 s67, v9, 4
    s_add_u32 s66, s66, s67
    v_readlane_b32 s67, v9, 5
    s_add_u32 s66, s66, s67
    v_readlane_b32 s67, v9, 6
    s_add_u32 s66, s66, s67
    v_readlane_b32 s67, v9, 7
    s_add_u32 s66, s66, s67
    s_cmp_ge_u32 s66, 256
    s_cbranch_scc1 TKD_11
    s_cmp_gt_u32 s65, 262144
    s_cbranch_scc0 TK_10
TKD_11:
    v_cmp_ne_u32 vcc, 32, v9
    s_mov_b64 exec, -1
    s_cbranch_vccnz M_SLOW
CM_9:
    s_mov_b32 s65, 0
RI_12:
    buffer_load_dword v8, off, s[60:63], s95 sc1
    s_add_u32 s65, s65, 1
    s_waitcnt vmcnt(0)
    v_readfirstlane_b32 s64, v8
    s_cmp_ge_u32 s64, 186
    s_cbranch_scc1 RID_13
    s_cmp_gt_u32 s65, 65536
    s_cbranch_scc1 RID_13
    s_sleep 4
    s_branch RI_12
RID_13:
    s_mov_b32 s65, 0
    s_mov_b32 s66, 0x290800
RB_14:
    buffer_load_dword v8, off, s[4:7], s66 sc1
    s_add_u32 s65, s65, 1
    s_waitcnt vmcnt(0)
    v_readfirstlane_b32 s64, v8
    s_cmp_ge_u32 s64, 192
    s_cbranch_scc1 RBD_15
    s_cmp_gt_u32 s65, 65536
    s_cbranch_scc1 RBD_15
    s_sleep 8
    s_branch RB_14
RBD_15:
    s_cmp_eq_u32 s94, 0
    s_cbranch_scc1 GOK_16
    buffer_load_dwordx2 v[8:9], off, s[60:63], 0 offset:24 sc1
    s_waitcnt vmcnt(0)
    v_and_b32 v8, v8, v9
    s_nop 0
    v_readfirstlane_b32 s64, v8
    s_cmp_lg_u32 s64, -1
    s_cbranch_scc1 M_GFAIL
GOK_16:
    s_mov_b32 s65, 0
CW_17:
    buffer_load_dwordx2 v[8:9], off, s[60:63], 0 offset:132 sc1
    s_add_u32 s65, s65, 1
    s_waitcnt vmcnt(0)
    v_readfirstlane_b32 s66, v8
    v_readfirstlane_b32 s67, v9
    s_min_u32 s64, s66, s67
    s_cmp_lg_u32 s64, 0
    s_cbranch_scc1 CWD_18
    s_cmp_gt_u32 s65, 65536
    s_cbranch_scc1 CWD_18
    s_sleep 4
    s_branch CW_17
CWD_18:
    s_sub_u32 s66, s66, 1
    s_and_b32 s66, s66, 3
    s_sub_u32 s67, s67, 1
    s_and_b32 s67, s67, 3
EARLY_7:
    s_mov_b32 s56, s66
    s_mov_b32 s57, s67
    s_mov_b32 s38, 0x3f80
    s_mov_b32 s53, 0
    s_cmp_eq_u32 s14, 2
    s_cselect_b32 s52, 1024, 0
    s_cmp_eq_u32 s14, 3
    s_cselect_b32 s58, 0, 1
    s_mov_b32 s59, 0
    s_cmp_eq_u32 s12, 0
    s_cselect_b32 s55, 2, 0
    s_mov_b32 s44, 0x3030303
    s_mov_b32 s45, 0x3030303
    s_mov_b32 s46, 0xc0c0c0c
    s_mov_b32 s47, 0xc0c0c0c
    s_mov_b32 s48, 0x30303030
    s_mov_b32 s49, 0x30303030
    s_mov_b32 s50, 0xc0c0c0c0
    s_mov_b32 s51, 0xc0c0c0c0
    v_and_b32 v8, 7, v0
    v_mul_u32_u24 v8, 288, v8
    v_lshrrev_b32 v9, 4, v0
    v_lshl_add_u32 v8, v9, 4, v8
    v_add_u32 v0, 12800, v8
    s_mov_b32 s68, 0
    s_mov_b32 s40, 0
    s_mov_b32 s64, s56
    s_mov_b32 s65, s57
    s_cmp_eq_u32 s12, 0
    s_cselect_b32 s66, s65, s64
    s_cselect_b32 s64, s64, s65
    s_and_b32 s64, s64, 3
    s_lshl_b32 s64, s64, 13
    s_and_b32 s66, s66, 3
    s_lshl_b32 s66, s66, 13
    s_add_u32 s21, s21, s64
    s_add_u32 s20, s20, s66
    s_cmp_eq_u32 s42, 0
    s_cselect_b32 s18, 0x40000000, s18
    s_cselect_b32 s21, 0x40000000, s21
    s_lshl_b32 s65, s12, 7
    s_add_u32 s65, s65, 0x29a000
    s_cmp_eq_u32 s22, 0
    s_cselect_b32 s22, 0x40000000, s65
    s_lshl_b32 s64, s13, 2
    s_add_u32 s64, s64, s14
    s_cmp_ge_u32 s64, 40
    s_cselect_b32 s65, 40, 0
    s_sub_u32 s64, s64, s65
    s_cmp_ge_u32 s64, 40
    s_cselect_b32 s65, 40, 0
    s_sub_u32 s64, s64, s65
    s_cmp_ge_u32 s64, 40
    s_cselect_b32 s65, 40, 0
    s_sub_u32 s64, s64, s65
    s_lshl_b32 s27, s64, 7
    s_add_u32 s19, s27, 0x4000
    v_and_b32 v82, v82, v83
    v_cmp_eq_u32 vcc, 0, v82
    s_cmp_lg_u32 s97, 0
    s_cselect_b64 vcc, -1, vcc
    s_cbranch_vccz KVOK_19
    v_mov_b32 v29, 0
FSPIN_20:
    buffer_load_dwordx2 v[12:13], v29, s[4:7], s69 offen sc1
    s_add_u32 s68, s68, 1
    s_waitcnt vmcnt(0)
    v_and_b32 v12, v12, v13
    v_cmp_eq_u32 vcc, 0, v12
    s_cbranch_vccz FDONE_21
    s_cmp_gt_u32 s68, 262144
    s_cbranch_scc0 FSPIN_20
FDONE_21:
KVOK_19:
    s_barrier
    s_mov_b32 m0, s73
    s_nop 0
    buffer_load_dwordx4 v1, s[4:7], s28 offen lds
    buffer_load_dwordx4 v1, s[4:7], s28 offen offset:1024 lds
    s_mov_b32 m0, 16128
    v_lshlrev_b32 v12, 2, v1
    s_add_u32 s65, s3, 0xfff80000
    buffer_load_dword v12, s[4:7], s65 offen lds
    s_mov_b32 s15, 0
    s_mov_b32 s16, 0
    s_add_u32 s66, s17, s52
    buffer_load_dwordx4 v[12:15], v1, s[4:7], s66 offen sc1
    buffer_load_dwordx4 v[16:19], v1, s[4:7], s17 offen offset:2048 sc1
    v_add_u32 v29, s52, v1
    s_waitcnt vmcnt(0)
    ds_write_b128 v29, v[12:15] offset:12800
    ds_write_b128 v1, v[16:19] offset:15104
    s_waitcnt lgkmcnt(0)
    v_mov_b64 v[32:33], 0
    v_mov_b64 v[34:35], 0
    v_mov_b64 v[36:37], 0
    v_mov_b64 v[38:39], 0
    v_mov_b64 v[40:41], 0
    v_mov_b64 v[42:43], 0
    v_mov_b64 v[44:45], 0
    v_mov_b64 v[46:47], 0
    v_mov_b64 v[48:49], 0
    v_mov_b64 v[50:51], 0
    v_mov_b64 v[52:53], 0
    v_mov_b64 v[54:55], 0
    v_mov_b32 v9, 0x40000000
    ds_read_b128 v[56:59], v2 offset:0
    ds_read_b128 v[60:63], v2 offset:1024
    ds_read_b128 v[64:67], v2 offset:2048
    ds_read_b128 v[68:71], v2 offset:3072
    s_cmp_eq_u32 s97, 0
    s_cbranch_scc1 REC_LOOP
    s_branch REC_LOOP_S
REC_POLL_S:
    s_cmp_eq_u32 s59, 0
    s_cbranch_scc1 NOFLG_22
    s_waitcnt vmcnt(0)
    v_lshrrev_b32 v29, 2, v1
    ds_read_b32 v12, v29 offset:15104
    s_add_u32 s64, s15, 2
    s_lshr_b32 s65, s64, 1
    s_add_u32 s67, s65, 1
    s_waitcnt lgkmcnt(0)
    v_cmp_ne_u32 vcc, 0, v12
    v_readlane_b32 s65, v12, s65
    v_readlane_b32 s67, v12, s67
    s_cmp_eq_u32 vcc_lo, -1
    s_cselect_b32 s58, 1, 0
    s_and_b32 s65, s65, s67
    s_cbranch_scc1 NOFLG_22
    s_lshl_b32 s64, s64, 7
    s_add_u32 s64, s64, s69
    v_mov_b32 v29, 0
FSPIN_24:
    buffer_load_dwordx2 v[12:13], v29, s[4:7], s64 offen sc1
    s_add_u32 s68, s68, 1
    s_waitcnt vmcnt(0)
    v_and_b32 v12, v12, v13
    v_cmp_eq_u32 vcc, 0, v12
    s_cbranch_vccz FDONE_25
    s_cmp_gt_u32 s68, 262144
    s_cbranch_scc0 FSPIN_24
FDONE_25:
NOFLG_22:
    s_add_u32 s64, s15, 3
    s_and_b32 s64, s64, 0x43
    s_or_b32 s64, s64, s58
    s_cmp_eq_u32 s64, 0
    s_cselect_b32 s59, 1, 0
    s_cmp_eq_u32 s15, 63
    s_cselect_b32 s59, s55, s59
    s_add_u32 s66, s17, s52
    v_add_u32 v10, s52, v1
    s_xor_b32 s16, s16, 1
    v_mov_b64 v[32:33], 0
    v_mov_b64 v[34:35], 0
    v_mov_b64 v[36:37], 0
    v_mov_b64 v[38:39], 0
    v_mov_b64 v[40:41], 0
    v_mov_b64 v[42:43], 0
    v_mov_b64 v[44:45], 0
    v_mov_b64 v[46:47], 0
    v_mov_b64 v[48:49], 0
    v_mov_b64 v[50:51], 0
    v_mov_b64 v[52:53], 0
    v_mov_b64 v[54:55], 0
    ds_read_b128 v[56:59], v2 offset:0
    ds_read_b128 v[60:63], v2 offset:1024
    ds_read_b128 v[64:67], v2 offset:2048
    ds_read_b128 v[68:71], v2 offset:3072
    s_barrier
    s_nop 14
    buffer_load_dwordx4 v[20:23], v1, s[4:7], s66 offen offset:0 sc1
    s_nop 7
    buffer_load_dwordx4 v[24:27], v1, s[4:7], s66 offen offset:0 sc1
    s_nop 7
    buffer_load_dwordx4 v[28:31], v1, s[4:7], s66 offen offset:0 sc1
IPOLL_27:
    s_waitcnt vmcnt(2)
    ds_write_b128 v10, v[20:23] offset:12800
    v_max3_u32 v11, v20, v21, v22
    v_max_u32 v11, v11, v23
    v_cmp_eq_u32 vcc, -1, v11
    s_cbranch_vccz IOK_26
    buffer_load_dwordx4 v[20:23], v1, s[4:7], s66 offen offset:0 sc1
    s_waitcnt vmcnt(2)
    ds_write_b128 v10, v[24:27] offset:12800
    v_max3_u32 v11, v24, v25, v26
    v_max_u32 v11, v11, v27
    v_cmp_eq_u32 vcc, -1, v11
    s_cbranch_vccz IOK_26
    buffer_load_dwordx4 v[24:27], v1, s[4:7], s66 offen offset:0 sc1
    s_waitcnt vmcnt(2)
    ds_write_b128 v10, v[28:31] offset:12800
    v_max3_u32 v11, v28, v29, v30
    v_max_u32 v11, v11, v31
    v_cmp_eq_u32 vcc, -1, v11
    s_add_u32 s68, s68, 1
    s_add_u32 s53, s53, 1
    s_cmp_gt_u32 s68, 262144
    s_cbranch_scc1 IOK_26
    s_cbranch_vccz IOK_26
    buffer_load_dwordx4 v[28:31], v1, s[4:7], s66 offen offset:0 sc1
    s_branch IPOLL_27
IOK_26:
    s_waitcnt lgkmcnt(0)
REC_LOOP_S:
    s_barrier
    ds_read_b128 v[12:15], v1 offset:12800
    ds_read_b128 v[16:19], v1 offset:13824
    buffer_load_dwordx4 v[20:23], v1, s[4:7], s17 offen offset:2048
    ds_read_b128 v[72:75], v2 offset:4096
    ds_read_b128 v[76:79], v2 offset:5120
    ds_read_b128 v[80:83], v2 offset:6144
    ds_read_b128 v[84:87], v2 offset:7168
    s_add_u32 s74, s17, 0x1000
    s_add_u32 s20, s20, 0x8000
    s_add_u32 s75, s20, 0x1000
    s_mov_b32 m0, 16128
    s_add_u32 s65, s20, s27
    s_waitcnt lgkmcnt(5)
    v_smfmac_f32_16x16x64_bf16 v[32:35], v[12:15], v[96:103], v6
    buffer_load_dwordx4 v[24:27], v1, s[4:7], s17 offen offset:3072
    v_smfmac_f32_16x16x64_bf16 v[36:39], v[12:15], v[104:111], v6
    v_smfmac_f32_16x16x64_bf16 v[40:43], v[12:15], v[56:63], v6
    buffer_load_dwordx4 v[28:31], v1, s[4:7], s74 offen offset:0
    ds_read_b128 v[56:59], v2 offset:8192
    ds_read_b128 v[60:63], v2 offset:9216
    v_smfmac_f32_16x16x64_bf16 v[44:47], v[12:15], v[64:71], v6
    ds_read_b128 v[64:67], v2 offset:10240
    ds_read_b128 v[68:71], v2 offset:11264
    s_waitcnt lgkmcnt(8)
    v_smfmac_f32_16x16x64_bf16 v[48:51], v[12:15], a[0:7], v6
    v_smfmac_f32_16x16x64_bf16 v[52:55], v[12:15], a[8:15], v6
    buffer_load_dwordx4 v[12:15], v1, s[4:7], s20 offen offset:0
    buffer_load_dword off, s[4:7], s65 lds
    v_smfmac_f32_16x16x64_bf16 v[32:35], v[16:19], v[112:119], v6
    v_smfmac_f32_16x16x64_bf16 v[36:39], v[16:19], v[120:127], v6
    s_waitcnt lgkmcnt(4)
    v_smfmac_f32_16x16x64_bf16 v[40:43], v[16:19], v[72:79], v6
    ds_read_b128 v[72:75], v2 offset:12288
    ds_read_b128 v[76:79], v2 offset:13312
    v_smfmac_f32_16x16x64_bf16 v[44:47], v[16:19], v[80:87], v6
    ds_read_b128 v[80:83], v2 offset:14336
    ds_read_b128 v[84:87], v2 offset:15360
    s_waitcnt vmcnt(4)
    v_cmp_eq_u32 vcc, -1, v23
    v_smfmac_f32_16x16x64_bf16 v[48:51], v[16:19], a[16:23], v6
    v_smfmac_f32_16x16x64_bf16 v[52:55], v[16:19], a[24:31], v6
    s_cbranch_vccnz RETRY_28
BACK_29:
    buffer_load_dwordx4 v[16:19], v1, s[4:7], s20 offen offset:1024
    v_smfmac_f32_16x16x64_bf16 v[32:35], v[20:23], v[128:135], v6
    v_smfmac_f32_16x16x64_bf16 v[36:39], v[20:23], v[136:143], v6
    s_waitcnt lgkmcnt(4)
    v_smfmac_f32_16x16x64_bf16 v[40:43], v[20:23], v[56:63], v6
    ds_read_b128 v[56:59], v2 offset:16384
    ds_read_b128 v[60:63], v2 offset:17408
    v_smfmac_f32_16x16x64_bf16 v[44:47], v[20:23], v[64:71], v6
    ds_read_b128 v[64:67], v2 offset:18432
    ds_read_b128 v[68:71], v2 offset:19456
    s_waitcnt vmcnt(4)
    v_cmp_eq_u32 vcc, -1, v27
    v_smfmac_f32_16x16x64_bf16 v[48:51], v[20:23], a[32:39], v6
    v_smfmac_f32_16x16x64_bf16 v[52:55], v[20:23], a[40:47], v6
    s_cbranch_vccnz RETRY_30
BACK_31:
    buffer_load_dwordx4 v[20:23], v1, s[4:7], s20 offen offset:2048
    v_smfmac_f32_16x16x64_bf16 v[32:35], v[24:27], v[144:151], v6
    v_smfmac_f32_16x16x64_bf16 v[36:39], v[24:27], v[152:159], v6
    s_waitcnt lgkmcnt(4)
    v_smfmac_f32_16x16x64_bf16 v[40:43], v[24:27], v[72:79], v6
    ds_read_b128 v[72:75], v2 offset:20480
    ds_read_b128 v[76:79], v2 offset:21504
    v_smfmac_f32_16x16x64_bf16 v[44:47], v[24:27], v[80:87], v6
    ds_read_b128 v[80:83], v2 offset:22528
    ds_read_b128 v[84:87], v2 offset:23552
    s_waitcnt vmcnt(4)
    v_cmp_eq_u32 vcc, -1, v31
    v_smfmac_f32_16x16x64_bf16 v[48:51], v[24:27], a[48:55], v6
    v_smfmac_f32_16x16x64_bf16 v[52:55], v[24:27], a[56:63], v6
    s_cbranch_vccnz RETRY_32
BACK_33:
    buffer_load_dwordx4 v[24:27], v1, s[4:7], s20 offen offset:3072
    v_smfmac_f32_16x16x64_bf16 v[32:35], v[28:31], v[160:167], v6
    v_smfmac_f32_16x16x64_bf16 v[36:39], v[28:31], v[168:175], v6
    s_waitcnt lgkmcnt(4)
    v_smfmac_f32_16x16x64_bf16 v[40:43], v[28:31], v[56:63], v6
    ds_read_b128 v[56:59], v2 offset:24576
    ds_read_b128 v[60:63], v2 offset:25600
    v_smfmac_f32_16x16x64_bf16 v[44:47], v[28:31], v[64:71], v6
    ds_read_b128 v[64:67], v2 offset:26624
    ds_read_b128 v[68:71], v2 offset:27648
    s_waitcnt vmcnt(4)
    v_cmp_eq_u32 vcc, -1, v15
    v_smfmac_f32_16x16x64_bf16 v[48:51], v[28:31], a[64:71], v6
    v_smfmac_f32_16x16x64_bf16 v[52:55], v[28:31], a[72:79], v6
    s_cbranch_vccnz RETRY_34
BACK_35:
    buffer_load_dwordx4 v[28:31], v1, s[4:7], s75 offen offset:0
    v_smfmac_f32_16x16x64_bf16 v[32:35], v[12:15], v[176:183], v6
    s_waitcnt vmcnt(3)
    v_cmp_eq_u32 vcc, -1, v19
    v_smfmac_f32_16x16x64_bf16 v[36:39], v[12:15], v[184:191], v6
    s_waitcnt lgkmcnt(4)
    v_smfmac_f32_16x16x64_bf16 v[40:43], v[12:15], v[72:79], v6
    ds_read_b128 v[72:75], v2 offset:28672
    ds_read_b128 v[76:79], v2 offset:29696
    v_smfmac_f32_16x16x64_bf16 v[44:47], v[12:15], v[80:87], v6
    ds_read_b128 v[80:83], v2 offset:30720
    ds_read_b128 v[84:87], v2 offset:31744
    buffer_load_dwordx4 v[88:91], v1, s[4:7], s29 offen offset:0
    s_cbranch_vccnz RETRY_36
BACK_37:
    v_smfmac_f32_16x16x64_bf16 v[32:35], v[16:19], v[192:199], v6
    s_waitcnt vmcnt(3)
    v_cmp_eq_u32 vcc, -1, v23
    v_smfmac_f32_16x16x64_bf16 v[36:39], v[16:19], v[200:207], v6
    s_waitcnt lgkmcnt(4)
    v_smfmac_f32_16x16x64_bf16 v[40:43], v[16:19], v[56:63], v6
    ds_read_b128 v[56:59], v2 offset:32768
    ds_read_b128 v[60:63], v2 offset:33792
    v_smfmac_f32_16x16x64_bf16 v[44:47], v[16:19], v[64:71], v6
    ds_read_b128 v[64:67], v2 offset:34816
    ds_read_b128 v[68:71], v2 offset:35840
    s_cbranch_vccnz RETRY_38
BACK_39:
    v_smfmac_f32_16x16x64_bf16 v[32:35], v[20:23], v[208:215], v6
    s_waitcnt vmcnt(2)
    v_cmp_eq_u32 vcc, -1, v27
    v_smfmac_f32_16x16x64_bf16 v[36:39], v[20:23], v[216:223], v6
    s_waitcnt lgkmcnt(4)
    v_smfmac_f32_16x16x64_bf16 v[40:43], v[20:23], v[72:79], v6
    ds_read_b128 v[72:75], v1 offset:0
    ds_read_b128 v[76:79], v1 offset:4096
    v_smfmac_f32_16x16x64_bf16 v[44:47], v[20:23], v[80:87], v6
    ds_read_b128 v[80:83], v1 offset:1024
    ds_read_b128 v[84:87], v1 offset:5120
    buffer_load_dwordx4 v[92:95], v1, s[4:7], s29 offen offset:1024
    s_cbranch_vccnz RETRY_40
BACK_41:
    v_smfmac_f32_16x16x64_bf16 v[32:35], v[24:27], v[224:231], v6
    s_waitcnt vmcnt(2)
    v_cmp_eq_u32 vcc, -1, v31
    v_smfmac_f32_16x16x64_bf16 v[36:39], v[24:27], v[232:239], v6
    s_waitcnt lgkmcnt(4)
    v_smfmac_f32_16x16x64_bf16 v[40:43], v[24:27], v[56:63], v6
    ds_read_b128 v[56:59], v1 offset:2048
    ds_read_b128 v[60:63], v1 offset:6144
    v_smfmac_f32_16x16x64_bf16 v[44:47], v[24:27], v[64:71], v6
    ds_read_b128 v[64:67], v1 offset:3072
    ds_read_b128 v[68:71], v1 offset:7168
    s_cbranch_vccnz RETRY_42
BACK_43:
    v_smfmac_f32_16x16x64_bf16 v[32:35], v[28:31], v[240:247], v6
    v_lshlrev_b32 v8, 2, v1
    v_smfmac_f32_16x16x64_bf16 v[36:39], v[28:31], v[248:255], v6
    s_add_u32 s65, s17, s19
    v_smfmac_f32_16x16x64_bf16 v[40:43], v[28:31], a[240:247], v6
    buffer_load_dword v8, s[4:7], s3 offen lds
    v_smfmac_f32_16x16x64_bf16 v[44:47], v[28:31], a[248:255], v6
    buffer_load_dword off, s[4:7], s65 sc1 lds
    buffer_store_dword v6, off, s[4:7], s22 sc1
    s_add_u32 s22, s22, 256
    s_cmp_lg_u32 s59, 0
    s_cbranch_scc1 KVOUT_45
KVLOOK_44:
    v_permlane32_swap_b32 v32, v36
    v_permlane32_swap_b32 v33, v37
    v_permlane32_swap_b32 v34, v38
    v_permlane32_swap_b32 v35, v39
    v_pk_add_f32 v[32:33], v[32:33], v[36:37]
    v_pk_add_f32 v[34:35], v[34:35], v[38:39]
    v_cvt_pk_bf16_f32 v36, v32, v33
    v_cvt_pk_bf16_f32 v37, v34, v35
    ds_write_b64 v3, v[36:37] offset:0
    v_permlane32_swap_b32 v40, v44
    v_permlane32_swap_b32 v41, v45
    v_permlane32_swap_b32 v42, v46
    v_permlane32_swap_b32 v43, v47
    v_pk_add_f32 v[40:41], v[40:41], v[44:45]
    v_pk_add_f32 v[42:43], v[42:43], v[46:47]
    v_cvt_pk_bf16_f32 v44, v40, v41
    v_cvt_pk_bf16_f32 v45, v42, v43
    ds_write_b64 v3, v[44:45] offset:2304
    v_smfmac_f32_16x16x64_bf16 v[48:51], v[12:15], a[80:87], v6
    v_smfmac_f32_16x16x64_bf16 v[52:55], v[12:15], a[88:95], v6
    v_smfmac_f32_16x16x64_bf16 v[48:51], v[16:19], a[96:103], v6
    v_smfmac_f32_16x16x64_bf16 v[52:55], v[16:19], a[104:111], v6
    s_waitcnt lgkmcnt(0)
    s_barrier
    ds_read_b64_tr_b16 v[32:33], v4 offset:0
    ds_read_b64_tr_b16 v[34:35], v4 offset:128
    ds_read_b64_tr_b16 v[36:37], v4 offset:256
    ds_read_b64_tr_b16 v[38:39], v4 offset:384
    s_cmp_eq_u32 s15, 63
    s_cbranch_scc1 REC_FINAL
    v_smfmac_f32_16x16x64_bf16 v[48:51], v[20:23], a[112:119], v6
    v_smfmac_f32_16x16x64_bf16 v[52:55], v[20:23], a[120:127], v6
    ds_read_b64_tr_b16 v[40:41], v4 offset:512
    ds_read_b64_tr_b16 v[42:43], v4 offset:640
    ds_read_b64_tr_b16 v[44:45], v4 offset:768
    ds_read_b64_tr_b16 v[46:47], v4 offset:896
    v_smfmac_f32_16x16x64_bf16 v[48:51], v[24:27], a[128:135], v6
    v_smfmac_f32_16x16x64_bf16 v[52:55], v[24:27], a[136:143], v6
    s_waitcnt lgkmcnt(4)
    v_mfma_f32_16x16x32_bf16 v[8:11], v[72:75], v[32:35], 0
    ds_read_b64_tr_b16 v[12:13], v4 offset:2304
    ds_read_b64_tr_b16 v[14:15], v4 offset:2432
    v_mfma_f32_16x16x32_bf16 v[8:11], v[80:83], v[36:39], v[8:11]
    ds_read_b64_tr_b16 v[16:17], v4 offset:2560
    ds_read_b64_tr_b16 v[18:19], v4 offset:2688
    s_waitcnt lgkmcnt(4)
    v_mfma_f32_16x16x32_bf16 v[8:11], v[56:59], v[40:43], v[8:11]
    ds_read_b64_tr_b16 v[56:57], v4 offset:2816
    ds_read_b64_tr_b16 v[58:59], v4 offset:2944
    v_mfma_f32_16x16x32_bf16 v[8:11], v[64:67], v[44:47], v[8:11]
    ds_read_b64_tr_b16 v[64:65], v4 offset:3072
    ds_read_b64_tr_b16 v[66:67], v4 offset:3200
    v_mfma_f32_16x16x32_bf16 v[72:75], v[76:79], v[32:35], 0
    v_mfma_f32_16x16x32_bf16 v[72:75], v[84:87], v[36:39], v[72:75]
    v_mfma_f32_16x16x32_bf16 v[72:75], v[60:63], v[40:43], v[72:75]
    v_mfma_f32_16x16x32_bf16 v[72:75], v[68:71], v[44:47], v[72:75]
    s_waitcnt lgkmcnt(4)
    v_mfma_f32_16x16x32_bf16 v[80:83], v[12:15], v[32:35], 0
    v_mov_b32 v84, 0x3f803f80
    v_mfma_f32_16x16x32_bf16 v[80:83], v[16:19], v[36:39], v[80:83]
    v_mov_b32 v85, 0x3f803f80
    s_waitcnt lgkmcnt(0)
    v_mfma_f32_16x16x32_bf16 v[80:83], v[56:59], v[40:43], v[80:83]
    v_mov_b32 v86, 0x3f803f80
    v_mfma_f32_16x16x32_bf16 v[80:83], v[64:67], v[44:47], v[80:83]
    v_mov_b32 v87, 0x3f803f80
    v_smfmac_f32_16x16x64_bf16 v[48:51], v[28:31], a[144:151], v6
    v_cndmask_b32 v60, 0, v84, s[34:35]
    v_smfmac_f32_16x16x64_bf16 v[52:55], v[28:31], a[152:159], v6
    v_cndmask_b32 v61, 0, v84, s[34:35]
    v_max3_f32 v20, v8, v9, v10
    v_max3_f32 v21, v11, v72, v73
    v_max3_f32 v20, v20, v21, v74
    v_max3_f32 v21, v80, v81, v82
    v_max3_f32 v20, v20, v75, v83
    v_max_f32 v20, v20, v21
    v_mov_b32 v21, v20
    v_cvt_pk_bf16_f32 v48, v48, v49
    v_cvt_pk_bf16_f32 v49, v50, v51
    v_permlane16_swap_b32 v20, v21
    v_max_f32 v20, v20, v21
    v_mov_b32 v21, v20
    v_cvt_pk_bf16_f32 v50, v52, v53
    v_cvt_pk_bf16_f32 v51, v54, v55
    v_permlane32_swap_b32 v20, v21
    v_max_f32 v20, v20, v21
    v_mul_f32 v22, s10, v20
    v_pk_fma_f32 v[8:9], v[8:9], s[10:11], v[22:23] op_sel_hi:[1,1,0] neg_lo:[0,0,1] neg_hi:[0,0,1]
    v_pk_fma_f32 v[10:11], v[10:11], s[10:11], v[22:23] op_sel_hi:[1,1,0] neg_lo:[0,0,1] neg_hi:[0,0,1]
    v_pk_fma_f32 v[72:73], v[72:73], s[10:11], v[22:23] op_sel_hi:[1,1,0] neg_lo:[0,0,1] neg_hi:[0,0,1]
    v_pk_fma_f32 v[74:75], v[74:75], s[10:11], v[22:23] op_sel_hi:[1,1,0] neg_lo:[0,0,1] neg_hi:[0,0,1]
    v_pk_fma_f32 v[80:81], v[80:81], s[10:11], v[22:23] op_sel_hi:[1,1,0] neg_lo:[0,0,1] neg_hi:[0,0,1]
    v_pk_fma_f32 v[82:83], v[82:83], s[10:11], v[22:23] op_sel_hi:[1,1,0] neg_lo:[0,0,1] neg_hi:[0,0,1]
    v_exp_f32 v8, v8
    v_exp_f32 v9, v9
    v_exp_f32 v10, v10
    v_exp_f32 v11, v11
    v_exp_f32 v72, v72
    v_exp_f32 v73, v73
    v_exp_f32 v74, v74
    v_exp_f32 v75, v75
    v_cvt_pk_bf16_f32 v32, v8, v9
    v_cvt_pk_bf16_f32 v33, v10, v11
    v_exp_f32 v80, v80
    v_exp_f32 v81, v81
    v_exp_f32 v82, v82
    v_exp_f32 v83, v83
    v_cvt_pk_bf16_f32 v34, v72, v73
    v_cvt_pk_bf16_f32 v35, v74, v75
    v_cvt_pk_bf16_f32 v36, v80, v81
    s_waitcnt vmcnt(3)
    v_mfma_f32_16x16x32_bf16 v[8:11], v[84:87], v[32:35], 0
    v_mfma_f32_16x16x32_bf16 v[40:43], v[88:91], v[32:35], 0
    v_cvt_pk_bf16_f32 v37, v82, v83
    v_mfma_f32_16x16x32_bf16 v[44:47], v[92:95], v[32:35], 0
    v_mfma_f32_16x16x16_bf16 v[8:11], v[60:61], v[36:37], v[8:11]
    v_mov_b64 v[72:73], 0
    v_mfma_f32_16x16x16_bf16 v[40:43], v[48:49], v[36:37], v[40:43]
    v_mov_b64 v[74:75], 0
    v_mfma_f32_16x16x16_bf16 v[44:47], v[50:51], v[36:37], v[44:47]
    v_mov_b64 v[76:77], 0
    v_mov_b64 v[78:79], 0
    v_mov_b64 v[80:81], 0
    v_mov_b64 v[82:83], 0
    v_rcp_f32 v22, v8
    s_nop 2
    v_cndmask_b32 v40, v44, v40, s[32:33]
    v_cndmask_b32 v41, v45, v41, s[32:33]
    v_cndmask_b32 v42, v46, v42, s[32:33]
    v_cndmask_b32 v43, v47, v43, s[32:33]
    v_pk_mul_f32 v[40:41], v[40:41], v[22:23] op_sel_hi:[1,0]
    v_pk_mul_f32 v[42:43], v[42:43], v[22:23] op_sel_hi:[1,0]
    v_cvt_pk_bf16_f32 v44, v40, v41
    v_cvt_pk_bf16_f32 v45, v42, v43
    ds_write_b64 v5, v[44:45]
    s_mov_b32 m0, s73
    s_add_u32 s28, s28, 0x80000
    buffer_load_dwordx4 v1, s[4:7], s28 offen lds
    buffer_load_dwordx4 v1, s[4:7], s28 offen offset:1024 lds
    v_and_b32 v9, 0x70, v1
    v_bfe_u32 v29, v1, 8, 1
    v_lshl_add_u32 v9, v29, 3, v9
    v_bfe_u32 v29, v1, 9, 1
    v_lshl_add_u32 v9, v29, 2, v9
    v_mov_b32 v29, 0x40000000
    s_waitcnt lgkmcnt(0)
    s_barrier
    ds_read_b128 v[12:15], v0 offset:0
    ds_read_b128 v[16:19], v0 offset:64
    ds_read_b128 v[20:23], v0 offset:128
    ds_read_b128 v[24:27], v0 offset:192
    v_cndmask_b32 v9, v29, v9, s[32:33]
    v_and_b32 v29, 16, v1
    v_lshlrev_b32 v29, v29, s38
    v_cndmask_b32 v88, 0, v29, s[44:45]
    v_cndmask_b32 v89, 0, v29, s[46:47]
    v_cndmask_b32 v90, 0, v29, s[48:49]
    v_cndmask_b32 v91, 0, v29, s[50:51]
    s_waitcnt lgkmcnt(3)
    v_smfmac_f32_16x16x64_bf16 v[72:75], v[12:15], a[160:167], v6
    s_waitcnt lgkmcnt(2)
    v_smfmac_f32_16x16x64_bf16 v[72:75], v[16:19], a[168:175], v6
    s_waitcnt lgkmcnt(1)
    v_smfmac_f32_16x16x64_bf16 v[72:75], v[20:23], a[176:183], v6
    s_waitcnt lgkmcnt(0)
    v_smfmac_f32_16x16x64_bf16 v[72:75], v[24:27], a[184:191], v6
    v_smfmac_f32_16x16x64_bf16 v[76:79], v[12:15], a[192:199], v6
    v_smfmac_f32_16x16x64_bf16 v[76:79], v[16:19], a[200:207], v6
    v_cvt_pk_bf16_f32 v72, v72, v73
    v_smfmac_f32_16x16x64_bf16 v[76:79], v[20:23], a[208:215], v6
    v_cvt_pk_bf16_f32 v73, v74, v75
    v_smfmac_f32_16x16x64_bf16 v[76:79], v[24:27], a[216:223], v6
    v_and_or_b32 v72, v72, -2, s16
    v_mfma_f32_16x16x32_bf16 v[80:83], v[12:15], a[224:227], 0
    buffer_store_dwordx2 v[72:73], v7, s[4:7], s23 offen sc1
    v_mfma_f32_16x16x32_bf16 v[80:83], v[16:19], a[228:231], v[80:83]
    v_mfma_f32_16x16x32_bf16 v[80:83], v[20:23], a[232:235], v[80:83]
    v_cvt_pk_bf16_f32 v76, v76, v77
    v_cvt_pk_bf16_f32 v77, v78, v79
    v_mfma_f32_16x16x32_bf16 v[80:83], v[24:27], a[236:239], v[80:83]
    v_and_or_b32 v76, v76, -2, s16
    buffer_store_dwordx2 v[76:77], v7, s[4:7], s25 offen sc1
    s_add_u32 s17, s17, 0x4000
    s_add_u32 s3, s3, 0x80000
    s_add_u32 s29, s29, 0x80000
    s_add_u32 s18, s18, 0x4000
    s_add_u32 s21, s21, 0x8000
    s_add_u32 s15, s15, 1
    s_nop 0
    v_cvt_pk_bf16_f32 v80, v80, v81
    v_cvt_pk_bf16_f32 v81, v82, v83
    v_and_or_b32 v80, v80, -2, s16
    s_mov_b64 exec, s[34:35]
    buffer_store_dwordx2 v[80:81], v7, s[4:7], s26 offen sc1
    s_mov_b64 exec, -1
    s_cmp_lg_u32 s42, 0
    s_cbranch_scc1 OWN_47
    s_cmp_lt_u32 s14, 2
    s_cbranch_scc1 IDLE_46
    s_branch REC_POLL_S
OWN_47:
    s_nop 15
    s_nop 13
    buffer_load_dwordx4 v[12:15], v1, s[4:7], s24 offen offset:0 sc1
    buffer_load_dwordx4 v[16:19], v1, s[4:7], s24 offen offset:1024 sc1
    buffer_load_dwordx4 v[20:23], v1, s[4:7], s24 offen offset:2048 sc1
    buffer_load_dwordx4 v[24:27], v1, s[4:7], s24 offen offset:3072 sc1
    ds_read_b128 v[56:59], v2 offset:0
    ds_read_b128 v[60:63], v2 offset:1024
    ds_read_b128 v[64:67], v2 offset:2048
    ds_read_b128 v[68:71], v2 offset:3072
    v_mov_b64 v[32:33], 0
    v_mov_b64 v[34:35], 0
    v_mov_b64 v[36:37], 0
    v_mov_b64 v[38:39], 0
    v_mov_b64 v[40:41], 0
    v_mov_b64 v[42:43], 0
    v_mov_b64 v[44:45], 0
    v_mov_b64 v[46:47], 0
    buffer_load_dwordx4 v[72:75], v1, s[4:7], s24 offen offset:0 sc1
    buffer_load_dwordx4 v[76:79], v1, s[4:7], s24 offen offset:1024 sc1
    buffer_load_dwordx4 v[80:83], v1, s[4:7], s24 offen offset:2048 sc1
    buffer_load_dwordx4 v[84:87], v1, s[4:7], s24 offen offset:3072 sc1
    v_mov_b64 v[48:49], 0
    v_mov_b64 v[50:51], 0
    v_mov_b64 v[52:53], 0
    v_mov_b64 v[54:55], 0
OPOLL_49:
    s_waitcnt vmcnt(7)
    v_mfma_f32_16x16x32_bf16 v[92:95], v[12:15], v[88:91], 0
    v_bitop3_b32 v10, v12, v14, s16 bitop3:0x7e
    s_waitcnt vmcnt(6)
    v_mfma_f32_16x16x32_bf16 v[92:95], v[16:19], v[88:91], v[92:95]
    v_bitop3_b32 v11, v16, v18, s16 bitop3:0x7e
    s_waitcnt vmcnt(5)
    v_mfma_f32_16x16x32_bf16 v[92:95], v[20:23], v[88:91], v[92:95]
    v_bitop3_b32 v30, v20, v22, s16 bitop3:0x7e
    s_waitcnt vmcnt(4)
    v_mfma_f32_16x16x32_bf16 v[92:95], v[24:27], v[88:91], v[92:95]
    v_bitop3_b32 v31, v24, v26, s16 bitop3:0x7e
    v_or3_b32 v10, v10, v11, v30
    v_bitop3_b32 v10, v10, v31, 1 bitop3:0xa8
    v_cmp_ne_u32 vcc, 0, v10
    s_nop 3
    s_cbranch_vccz ODONE_48
    s_add_u32 s40, s40, 1
    buffer_load_dwordx4 v[12:15], v1, s[4:7], s24 offen offset:0 sc1
    buffer_load_dwordx4 v[16:19], v1, s[4:7], s24 offen offset:1024 sc1
    buffer_load_dwordx4 v[20:23], v1, s[4:7], s24 offen offset:2048 sc1
    buffer_load_dwordx4 v[24:27], v1, s[4:7], s24 offen offset:3072 sc1
    s_waitcnt vmcnt(7)
    v_mfma_f32_16x16x32_bf16 v[92:95], v[72:75], v[88:91], 0
    v_bitop3_b32 v10, v72, v74, s16 bitop3:0x7e
    s_waitcnt vmcnt(6)
    v_mfma_f32_16x16x32_bf16 v[92:95], v[76:79], v[88:91], v[92:95]
    v_bitop3_b32 v11, v76, v78, s16 bitop3:0x7e
    s_waitcnt vmcnt(5)
    v_mfma_f32_16x16x32_bf16 v[92:95], v[80:83], v[88:91], v[92:95]
    v_bitop3_b32 v30, v80, v82, s16 bitop3:0x7e
    s_waitcnt vmcnt(4)
    v_mfma_f32_16x16x32_bf16 v[92:95], v[84:87], v[88:91], v[92:95]
    v_bitop3_b32 v31, v84, v86, s16 bitop3:0x7e
    v_or3_b32 v10, v10, v11, v30
    v_bitop3_b32 v10, v10, v31, 1 bitop3:0xa8
    v_cmp_ne_u32 vcc, 0, v10
    s_add_u32 s68, s68, 1
    s_cmp_gt_u32 s68, 262144
    s_cbranch_scc1 ODONE_48
    s_nop 0
    s_cbranch_vccz ODONE_48
    s_add_u32 s40, s40, 1
    buffer_load_dwordx4 v[72:75], v1, s[4:7], s24 offen offset:0 sc1
    buffer_load_dwordx4 v[76:79], v1, s[4:7], s24 offen offset:1024 sc1
    buffer_load_dwordx4 v[80:83], v1, s[4:7], s24 offen offset:2048 sc1
    buffer_load_dwordx4 v[84:87], v1, s[4:7], s24 offen offset:3072 sc1
    s_branch OPOLL_49
ODONE_48:
    v_permlane32_swap_b32 v92, v94
    v_permlane32_swap_b32 v93, v95
    v_add_f32 v92, v92, v94
    v_add_f32 v93, v93, v95
    v_cvt_pk_bf16_f32 v8, v92, v93
    buffer_store_dword v8, v9, s[4:7], s18 offen sc1
    s_cmp_eq_u32 s15, 63
    s_cselect_b32 s59, s55, 0
    s_barrier
    s_nop 15
    s_nop 15
    s_nop 12
    buffer_store_dword v8, v9, s[4:7], s21 offen sc1
    s_cmp_lt_u32 s15, 61
    s_cbranch_scc1 EFLG_50
    buffer_store_dword v6, off, s[4:7], s22 sc1
EFLG_50:
    s_xor_b32 s16, s16, 1
    s_waitcnt vmcnt(2) lgkmcnt(0)
    s_branch REC_LOOP_S
IDLE_46:
    s_barrier
    s_cmp_eq_u32 s15, 63
    s_cselect_b32 s59, s55, 0
    v_mov_b64 v[32:33], 0
    v_mov_b64 v[34:35], 0
    v_mov_b64 v[36:37], 0
    v_mov_b64 v[38:39], 0
    v_mov_b64 v[40:41], 0
    v_mov_b64 v[42:43], 0
    v_mov_b64 v[44:45], 0
    v_mov_b64 v[46:47], 0
    v_mov_b64 v[48:49], 0
    v_mov_b64 v[50:51], 0
    v_mov_b64 v[52:53], 0
    v_mov_b64 v[54:55], 0
    ds_read_b128 v[56:59], v2 offset:0
    ds_read_b128 v[60:63], v2 offset:1024
    ds_read_b128 v[64:67], v2 offset:2048
    ds_read_b128 v[68:71], v2 offset:3072
    s_xor_b32 s16, s16, 1
    s_waitcnt vmcnt(0)
    s_branch REC_LOOP_S
REC_TAIL_S:
KVOUT_45:
    s_cmp_eq_u32 s59, 1
    s_cbranch_scc1 KVL1_51
    s_lshl_b32 s64, s13, 13
    s_add_u32 s64, s64, 0x43c0000
    buffer_load_dwordx4 v[96:99], v1, s[4:7], s64 offen offset:0
    buffer_load_dwordx4 v[100:103], v1, s[4:7], s64 offen offset:1024
    buffer_load_dwordx4 v[104:107], v1, s[4:7], s64 offen offset:2048
    buffer_load_dwordx4 v[108:111], v1, s[4:7], s64 offen offset:3072
    s_add_u32 s64, s64, 0x1000
    buffer_load_dwordx4 v[112:115], v1, s[4:7], s64 offen offset:0
    buffer_load_dwordx4 v[116:119], v1, s[4:7], s64 offen offset:1024
    buffer_load_dwordx4 v[120:123], v1, s[4:7], s64 offen offset:2048
    buffer_load_dwordx4 v[124:127], v1, s[4:7], s64 offen offset:3072
    s_branch KVLOOK_44
KVL1_51:
    v_lshrrev_b32 v9, 5, v1
    v_lshlrev_b32 v9, 9, v9
    v_bfe_u32 v10, v1, 4, 1
    v_lshl_add_u32 v9, v10, 2, v9
    s_mov_b32 m0, 15104
    s_mov_b64 exec, s[34:35]
    buffer_load_dword v9, s[4:7], s69 offen sc1 lds
    s_mov_b64 exec, -1
    s_mov_b32 m0, 16128
    s_branch KVLOOK_44
RETRY_28:
SPIN_53:
    buffer_load_dwordx4 v[20:23], v1, s[4:7], s17 offen offset:2048 sc1
    buffer_load_dwordx4 v[24:27], v1, s[4:7], s17 offen offset:3072 sc1
    buffer_load_dwordx4 v[28:31], v1, s[4:7], s74 offen offset:0 sc1
    s_add_u32 s68, s68, 1
    s_add_u32 s40, s40, 1024
    s_cmp_gt_u32 s68, 262144
    s_waitcnt vmcnt(0)
    s_cbranch_scc1 BACK_29
    v_cmp_eq_u32 vcc, -1, v23
    s_cbranch_vccnz SPIN_53
    s_branch BACK_29
RETRY_30:
SPIN_54:
    buffer_load_dwordx4 v[24:27], v1, s[4:7], s17 offen offset:3072 sc1
    buffer_load_dwordx4 v[28:31], v1, s[4:7], s74 offen offset:0 sc1
    s_add_u32 s68, s68, 1
    s_add_u32 s40, s40, 1024
    s_cmp_gt_u32 s68, 262144
    s_waitcnt vmcnt(0)
    s_cbranch_scc1 BACK_31
    v_cmp_eq_u32 vcc, -1, v27
    s_cbranch_vccnz SPIN_54
    s_branch BACK_31
RETRY_32:
SPIN_55:
    buffer_load_dwordx4 v[28:31], v1, s[4:7], s74 offen offset:0 sc1
    s_add_u32 s68, s68, 1
    s_add_u32 s40, s40, 1024
    s_cmp_gt_u32 s68, 262144
    s_waitcnt vmcnt(0)
    s_cbranch_scc1 BACK_33
    v_cmp_eq_u32 vcc, -1, v31
    s_cbranch_vccnz SPIN_55
    s_branch BACK_33
RETRY_34:
SPIN_56:
    buffer_load_dwordx4 v[12:15], v1, s[4:7], s20 offen offset:0 sc1
    buffer_load_dwordx4 v[16:19], v1, s[4:7], s20 offen offset:1024 sc1
    buffer_load_dwordx4 v[20:23], v1, s[4:7], s20 offen offset:2048 sc1
    buffer_load_dwordx4 v[24:27], v1, s[4:7], s20 offen offset:3072 sc1
    s_add_u32 s68, s68, 1
    s_add_u32 s40, s40, 1048576
    s_cmp_gt_u32 s68, 262144
    s_waitcnt vmcnt(0)
    s_cbranch_scc1 BACK_35
    v_cmp_eq_u32 vcc, -1, v15
    s_cbranch_vccnz SPIN_56
    s_branch BACK_35
RETRY_36:
SPIN_57:
    buffer_load_dwordx4 v[16:19], v1, s[4:7], s20 offen offset:1024 sc1
    buffer_load_dwordx4 v[20:23], v1, s[4:7], s20 offen offset:2048 sc1
    buffer_load_dwordx4 v[24:27], v1, s[4:7], s20 offen offset:3072 sc1
    buffer_load_dwordx4 v[28:31], v1, s[4:7], s75 offen offset:0 sc1
    s_add_u32 s68, s68, 1
    s_add_u32 s40, s40, 1048576
    s_cmp_gt_u32 s68, 262144
    s_waitcnt vmcnt(0)
    s_cbranch_scc1 BACK_37
    v_cmp_eq_u32 vcc, -1, v19
    s_cbranch_vccnz SPIN_57
    s_branch BACK_37
RETRY_38:
SPIN_58:
    buffer_load_dwordx4 v[20:23], v1, s[4:7], s20 offen offset:2048 sc1
    buffer_load_dwordx4 v[24:27], v1, s[4:7], s20 offen offset:3072 sc1
    buffer_load_dwordx4 v[28:31], v1, s[4:7], s75 offen offset:0 sc1
    s_add_u32 s68, s68, 1
    s_add_u32 s40, s40, 1048576
    s_cmp_gt_u32 s68, 262144
    s_waitcnt vmcnt(0)
    s_cbranch_scc1 BACK_39
    v_cmp_eq_u32 vcc, -1, v23
    s_cbranch_vccnz SPIN_58
    s_branch BACK_39
RETRY_40:
SPIN_59:
    buffer_load_dwordx4 v[24:27], v1, s[4:7], s20 offen offset:3072 sc1
    buffer_load_dwordx4 v[28:31], v1, s[4:7], s75 offen offset:0 sc1
    s_add_u32 s68, s68, 1
    s_add_u32 s40, s40, 1048576
    s_cmp_gt_u32 s68, 262144
    s_waitcnt vmcnt(0)
    s_cbranch_scc1 BACK_41
    v_cmp_eq_u32 vcc, -1, v27
    s_cbranch_vccnz SPIN_59
    s_branch BACK_41
RETRY_42:
SPIN_60:
    buffer_load_dwordx4 v[28:31], v1, s[4:7], s75 offen offset:0 sc1
    s_add_u32 s68, s68, 1
    s_add_u32 s40, s40, 1048576
    s_cmp_gt_u32 s68, 262144
    s_waitcnt vmcnt(0)
    s_cbranch_scc1 BACK_43
    v_cmp_eq_u32 vcc, -1, v31
    s_cbranch_vccnz SPIN_60
    s_branch BACK_43
REC_POLL:
    s_cmp_eq_u32 s59, 0
    s_cbranch_scc1 NOFLG_61
    s_waitcnt vmcnt(0)
    v_lshrrev_b32 v29, 2, v1
    ds_read_b32 v12, v29 offset:15104
    s_add_u32 s64, s15, 2
    s_lshr_b32 s65, s64, 1
    s_add_u32 s67, s65, 1
    s_waitcnt lgkmcnt(0)
    v_cmp_ne_u32 vcc, 0, v12
    v_readlane_b32 s65, v12, s65
    v_readlane_b32 s67, v12, s67
    s_cmp_eq_u32 vcc_lo, -1
    s_cselect_b32 s58, 1, 0
    s_and_b32 s65, s65, s67
    s_cbranch_scc1 NOFLG_61
    s_lshl_b32 s64, s64, 7
    s_add_u32 s64, s64, s69
    v_mov_b32 v29, 0
FSPIN_63:
    buffer_load_dwordx2 v[12:13], v29, s[4:7], s64 offen sc1
    s_add_u32 s68, s68, 1
    s_waitcnt vmcnt(0)
    v_and_b32 v12, v12, v13
    v_cmp_eq_u32 vcc, 0, v12
    s_cbranch_vccz FDONE_64
    s_cmp_gt_u32 s68, 262144
    s_cbranch_scc0 FSPIN_63
FDONE_64:
NOFLG_61:
    s_add_u32 s64, s15, 3
    s_and_b32 s64, s64, 0x43
    s_or_b32 s64, s64, s58
    s_cmp_eq_u32 s64, 0
    s_cselect_b32 s59, 1, 0
    s_cmp_eq_u32 s15, 63
    s_cselect_b32 s59, s55, s59
    s_add_u32 s66, s17, s52
    v_add_u32 v10, s52, v1
    s_xor_b32 s16, s16, 1
    v_mov_b64 v[32:33], 0
    v_mov_b64 v[34:35], 0
    v_mov_b64 v[36:37], 0
    v_mov_b64 v[38:39], 0
    v_mov_b64 v[40:41], 0
    v_mov_b64 v[42:43], 0
    v_mov_b64 v[44:45], 0
    v_mov_b64 v[46:47], 0
    v_mov_b64 v[48:49], 0
    v_mov_b64 v[50:51], 0
    v_mov_b64 v[52:53], 0
    v_mov_b64 v[54:55], 0
    ds_read_b128 v[56:59], v2 offset:0
    ds_read_b128 v[60:63], v2 offset:1024
    ds_read_b128 v[64:67], v2 offset:2048
    ds_read_b128 v[68:71], v2 offset:3072
    s_barrier
    s_nop 14
    buffer_load_dwordx4 v[20:23], v1, s[4:7], s66 offen offset:0 sc1
    s_nop 7
    buffer_load_dwordx4 v[24:27], v1, s[4:7], s66 offen offset:0 sc1
    s_nop 7
    buffer_load_dwordx4 v[28:31], v1, s[4:7], s66 offen offset:0 sc1
IPOLL_66:
    s_waitcnt vmcnt(2)
    ds_write_b128 v10, v[20:23] offset:12800
    v_max3_u32 v11, v20, v21, v22
    v_max_u32 v11, v11, v23
    v_cmp_eq_u32 vcc, -1, v11
    s_cbranch_vccz IOK_65
    buffer_load_dwordx4 v[20:23], v1, s[4:7], s66 offen offset:0 sc1
    s_waitcnt vmcnt(2)
    ds_write_b128 v10, v[24:27] offset:12800
    v_max3_u32 v11, v24, v25, v26
    v_max_u32 v11, v11, v27
    v_cmp_eq_u32 vcc, -1, v11
    s_cbranch_vccz IOK_65
    buffer_load_dwordx4 v[24:27], v1, s[4:7], s66 offen offset:0 sc1
    s_waitcnt vmcnt(2)
    ds_write_b128 v10, v[28:31] offset:12800
    v_max3_u32 v11, v28, v29, v30
    v_max_u32 v11, v11, v31
    v_cmp_eq_u32 vcc, -1, v11
    s_add_u32 s68, s68, 1
    s_add_u32 s53, s53, 1
    s_cmp_gt_u32 s68, 262144
    s_cbranch_scc1 IOK_65
    s_cbranch_vccz IOK_65
    buffer_load_dwordx4 v[28:31], v1, s[4:7], s66 offen offset:0 sc1
    s_branch IPOLL_66
IOK_65:
    s_waitcnt lgkmcnt(0)
REC_LOOP:
    s_barrier
    ds_read_b128 v[12:15], v1 offset:12800
    ds_read_b128 v[16:19], v1 offset:13824
    buffer_load_dwordx4 v[20:23], v1, s[4:7], s17 offen offset:2048
    ds_read_b128 v[72:75], v2 offset:4096
    ds_read_b128 v[76:79], v2 offset:5120
    ds_read_b128 v[80:83], v2 offset:6144
    ds_read_b128 v[84:87], v2 offset:7168
    s_add_u32 s74, s17, 0x1000
    s_add_u32 s20, s20, 0x8000
    s_add_u32 s75, s20, 0x1000
    s_mov_b32 m0, 16128
    s_add_u32 s65, s20, s27
    s_waitcnt lgkmcnt(5)
    v_smfmac_f32_16x16x64_bf16 v[32:35], v[12:15], v[96:103], v6
    buffer_load_dwordx4 v[24:27], v1, s[4:7], s17 offen offset:3072
    v_smfmac_f32_16x16x64_bf16 v[36:39], v[12:15], v[104:111], v6
    v_smfmac_f32_16x16x64_bf16 v[40:43], v[12:15], v[56:63], v6
    buffer_load_dwordx4 v[28:31], v1, s[4:7], s74 offen offset:0
    ds_read_b128 v[56:59], v2 offset:8192
    ds_read_b128 v[60:63], v2 offset:9216
    v_smfmac_f32_16x16x64_bf16 v[44:47], v[12:15], v[64:71], v6
    ds_read_b128 v[64:67], v2 offset:10240
    ds_read_b128 v[68:71], v2 offset:11264
    s_waitcnt lgkmcnt(8)
    v_smfmac_f32_16x16x64_bf16 v[48:51], v[12:15], a[0:7], v6
    v_smfmac_f32_16x16x64_bf16 v[52:55], v[12:15], a[8:15], v6
    buffer_load_dwordx4 v[12:15], v1, s[4:7], s20 offen offset:0
    buffer_load_dword off, s[4:7], s65 lds
    v_smfmac_f32_16x16x64_bf16 v[32:35], v[16:19], v[112:119], v6
    v_smfmac_f32_16x16x64_bf16 v[36:39], v[16:19], v[120:127], v6
    s_waitcnt lgkmcnt(4)
    v_smfmac_f32_16x16x64_bf16 v[40:43], v[16:19], v[72:79], v6
    ds_read_b128 v[72:75], v2 offset:12288
    ds_read_b128 v[76:79], v2 offset:13312
    v_smfmac_f32_16x16x64_bf16 v[44:47], v[16:19], v[80:87], v6
    ds_read_b128 v[80:83], v2 offset:14336
    ds_read_b128 v[84:87], v2 offset:15360
    s_waitcnt vmcnt(4)
    v_cmp_eq_u32 vcc, -1, v23
    v_smfmac_f32_16x16x64_bf16 v[48:51], v[16:19], a[16:23], v6
    v_smfmac_f32_16x16x64_bf16 v[52:55], v[16:19], a[24:31], v6
    s_cbranch_vccnz RETRY_67
BACK_68:
    buffer_load_dwordx4 v[16:19], v1, s[4:7], s20 offen offset:1024
    v_smfmac_f32_16x16x64_bf16 v[32:35], v[20:23], v[128:135], v6
    v_smfmac_f32_16x16x64_bf16 v[36:39], v[20:23], v[136:143], v6
    s_waitcnt lgkmcnt(4)
    v_smfmac_f32_16x16x64_bf16 v[40:43], v[20:23], v[56:63], v6
    ds_read_b128 v[56:59], v2 offset:16384
    ds_read_b128 v[60:63], v2 offset:17408
    v_smfmac_f32_16x16x64_bf16 v[44:47], v[20:23], v[64:71], v6
    ds_read_b128 v[64:67], v2 offset:18432
    ds_read_b128 v[68:71], v2 offset:19456
    s_waitcnt vmcnt(4)
    v_cmp_eq_u32 vcc, -1, v27
    v_smfmac_f32_16x16x64_bf16 v[48:51], v[20:23], a[32:39], v6
    v_smfmac_f32_16x16x64_bf16 v[52:55], v[20:23], a[40:47], v6
    s_cbranch_vccnz RETRY_69
BACK_70:
    buffer_load_dwordx4 v[20:23], v1, s[4:7], s20 offen offset:2048
    v_smfmac_f32_16x16x64_bf16 v[32:35], v[24:27], v[144:151], v6
    v_smfmac_f32_16x16x64_bf16 v[36:39], v[24:27], v[152:159], v6
    s_waitcnt lgkmcnt(4)
    v_smfmac_f32_16x16x64_bf16 v[40:43], v[24:27], v[72:79], v6
    ds_read_b128 v[72:75], v2 offset:20480
    ds_read_b128 v[76:79], v2 offset:21504
    v_smfmac_f32_16x16x64_bf16 v[44:47], v[24:27], v[80:87], v6
    ds_read_b128 v[80:83], v2 offset:22528
    ds_read_b128 v[84:87], v2 offset:23552
    s_waitcnt vmcnt(4)
    v_cmp_eq_u32 vcc, -1, v31
    v_smfmac_f32_16x16x64_bf16 v[48:51], v[24:27], a[48:55], v6
    v_smfmac_f32_16x16x64_bf16 v[52:55], v[24:27], a[56:63], v6
    s_cbranch_vccnz RETRY_71
BACK_72:
    buffer_load_dwordx4 v[24:27], v1, s[4:7], s20 offen offset:3072
    v_smfmac_f32_16x16x64_bf16 v[32:35], v[28:31], v[160:167], v6
    v_smfmac_f32_16x16x64_bf16 v[36:39], v[28:31], v[168:175], v6
    s_waitcnt lgkmcnt(4)
    v_smfmac_f32_16x16x64_bf16 v[40:43], v[28:31], v[56:63], v6
    ds_read_b128 v[56:59], v2 offset:24576
    ds_read_b128 v[60:63], v2 offset:25600
    v_smfmac_f32_16x16x64_bf16 v[44:47], v[28:31], v[64:71], v6
    ds_read_b128 v[64:67], v2 offset:26624
    ds_read_b128 v[68:71], v2 offset:27648
    s_waitcnt vmcnt(4)
    v_cmp_eq_u32 vcc, -1, v15
    v_smfmac_f32_16x16x64_bf16 v[48:51], v[28:31], a[64:71], v6
    v_smfmac_f32_16x16x64_bf16 v[52:55], v[28:31], a[72:79], v6
    s_cbranch_vccnz RETRY_73
BACK_74:
    buffer_load_dwordx4 v[28:31], v1, s[4:7], s75 offen offset:0
    v_smfmac_f32_16x16x64_bf16 v[32:35], v[12:15], v[176:183], v6
    s_waitcnt vmcnt(3)
    v_cmp_eq_u32 vcc, -1, v19
    v_smfmac_f32_16x16x64_bf16 v[36:39], v[12:15], v[184:191], v6
    s_waitcnt lgkmcnt(4)
    v_smfmac_f32_16x16x64_bf16 v[40:43], v[12:15], v[72:79], v6
    ds_read_b128 v[72:75], v2 offset:28672
    ds_read_b128 v[76:79], v2 offset:29696
    v_smfmac_f32_16x16x64_bf16 v[44:47], v[12:15], v[80:87], v6
    ds_read_b128 v[80:83], v2 offset:30720
    ds_read_b128 v[84:87], v2 offset:31744
    buffer_load_dwordx4 v[88:91], v1, s[4:7], s29 offen offset:0
    s_cbranch_vccnz RETRY_75
BACK_76:
    v_smfmac_f32_16x16x64_bf16 v[32:35], v[16:19], v[192:199], v6
    s_waitcnt vmcnt(3)
    v_cmp_eq_u32 vcc, -1, v23
    v_smfmac_f32_16x16x64_bf16 v[36:39], v[16:19], v[200:207], v6
    s_waitcnt lgkmcnt(4)
    v_smfmac_f32_16x16x64_bf16 v[40:43], v[16:19], v[56:63], v6
    ds_read_b128 v[56:59], v2 offset:32768
    ds_read_b128 v[60:63], v2 offset:33792
    v_smfmac_f32_16x16x64_bf16 v[44:47], v[16:19], v[64:71], v6
    ds_read_b128 v[64:67], v2 offset:34816
    ds_read_b128 v[68:71], v2 offset:35840
    s_cbranch_vccnz RETRY_77
BACK_78:
    v_smfmac_f32_16x16x64_bf16 v[32:35], v[20:23], v[208:215], v6
    s_waitcnt vmcnt(2)
    v_cmp_eq_u32 vcc, -1, v27
    v_smfmac_f32_16x16x64_bf16 v[36:39], v[20:23], v[216:223], v6
    s_waitcnt lgkmcnt(4)
    v_smfmac_f32_16x16x64_bf16 v[40:43], v[20:23], v[72:79], v6
    ds_read_b128 v[72:75], v1 offset:0
    ds_read_b128 v[76:79], v1 offset:4096
    v_smfmac_f32_16x16x64_bf16 v[44:47], v[20:23], v[80:87], v6
    ds_read_b128 v[80:83], v1 offset:1024
    ds_read_b128 v[84:87], v1 offset:5120
    buffer_load_dwordx4 v[92:95], v1, s[4:7], s29 offen offset:1024
    s_cbranch_vccnz RETRY_79
BACK_80:
    v_smfmac_f32_16x16x64_bf16 v[32:35], v[24:27], v[224:231], v6
    s_waitcnt vmcnt(2)
    v_cmp_eq_u32 vcc, -1, v31
    v_smfmac_f32_16x16x64_bf16 v[36:39], v[24:27], v[232:239], v6
    s_waitcnt lgkmcnt(4)
    v_smfmac_f32_16x16x64_bf16 v[40:43], v[24:27], v[56:63], v6
    ds_read_b128 v[56:59], v1 offset:2048
    ds_read_b128 v[60:63], v1 offset:6144
    v_smfmac_f32_16x16x64_bf16 v[44:47], v[24:27], v[64:71], v6
    ds_read_b128 v[64:67], v1 offset:3072
    ds_read_b128 v[68:71], v1 offset:7168
    s_cbranch_vccnz RETRY_81
BACK_82:
    v_smfmac_f32_16x16x64_bf16 v[32:35], v[28:31], v[240:247], v6
    v_lshlrev_b32 v8, 2, v1
    v_smfmac_f32_16x16x64_bf16 v[36:39], v[28:31], v[248:255], v6
    s_add_u32 s65, s17, s19
    v_smfmac_f32_16x16x64_bf16 v[40:43], v[28:31], a[240:247], v6
    buffer_load_dword v8, s[4:7], s3 offen lds
    v_smfmac_f32_16x16x64_bf16 v[44:47], v[28:31], a[248:255], v6
    buffer_load_dword off, s[4:7], s65 sc1 lds
    buffer_store_dword v6, off, s[4:7], s22 sc1
    s_add_u32 s22, s22, 256
    s_cmp_lg_u32 s59, 0
    s_cbranch_scc1 KVOUT_84
KVLOOK_83:
    v_permlane32_swap_b32 v32, v36
    v_permlane32_swap_b32 v33, v37
    v_permlane32_swap_b32 v34, v38
    v_permlane32_swap_b32 v35, v39
    v_pk_add_f32 v[32:33], v[32:33], v[36:37]
    v_pk_add_f32 v[34:35], v[34:35], v[38:39]
    v_cvt_pk_bf16_f32 v36, v32, v33
    v_cvt_pk_bf16_f32 v37, v34, v35
    ds_write_b64 v3, v[36:37] offset:0
    v_permlane32_swap_b32 v40, v44
    v_permlane32_swap_b32 v41, v45
    v_permlane32_swap_b32 v42, v46
    v_permlane32_swap_b32 v43, v47
    v_pk_add_f32 v[40:41], v[40:41], v[44:45]
    v_pk_add_f32 v[42:43], v[42:43], v[46:47]
    v_cvt_pk_bf16_f32 v44, v40, v41
    v_cvt_pk_bf16_f32 v45, v42, v43
    ds_write_b64 v3, v[44:45] offset:2304
    v_smfmac_f32_16x16x64_bf16 v[48:51], v[12:15], a[80:87], v6
    v_smfmac_f32_16x16x64_bf16 v[52:55], v[12:15], a[88:95], v6
    v_smfmac_f32_16x16x64_bf16 v[48:51], v[16:19], a[96:103], v6
    v_smfmac_f32_16x16x64_bf16 v[52:55], v[16:19], a[104:111], v6
    s_waitcnt lgkmcnt(0)
    s_barrier
    ds_read_b64_tr_b16 v[32:33], v4 offset:0
    ds_read_b64_tr_b16 v[34:35], v4 offset:128
    ds_read_b64_tr_b16 v[36:37], v4 offset:256
    ds_read_b64_tr_b16 v[38:39], v4 offset:384
    s_cmp_eq_u32 s15, 63
    s_cbranch_scc1 REC_FINAL
    v_smfmac_f32_16x16x64_bf16 v[48:51], v[20:23], a[112:119], v6
    v_smfmac_f32_16x16x64_bf16 v[52:55], v[20:23], a[120:127], v6
    ds_read_b64_tr_b16 v[40:41], v4 offset:512
    ds_read_b64_tr_b16 v[42:43], v4 offset:640
    ds_read_b64_tr_b16 v[44:45], v4 offset:768
    ds_read_b64_tr_b16 v[46:47], v4 offset:896
    v_smfmac_f32_16x16x64_bf16 v[48:51], v[24:27], a[128:135], v6
    v_smfmac_f32_16x16x64_bf16 v[52:55], v[24:27], a[136:143], v6
    s_waitcnt lgkmcnt(4)
    v_mfma_f32_16x16x32_bf16 v[8:11], v[72:75], v[32:35], 0
    ds_read_b64_tr_b16 v[12:13], v4 offset:2304
    ds_read_b64_tr_b16 v[14:15], v4 offset:2432
    v_mfma_f32_16x16x32_bf16 v[8:11], v[80:83], v[36:39], v[8:11]
    ds_read_b64_tr_b16 v[16:17], v4 offset:2560
    ds_read_b64_tr_b16 v[18:19], v4 offset:2688
    s_waitcnt lgkmcnt(4)
    v_mfma_f32_16x16x32_bf16 v[8:11], v[56:59], v[40:43], v[8:11]
    ds_read_b64_tr_b16 v[56:57], v4 offset:2816
    ds_read_b64_tr_b16 v[58:59], v4 offset:2944
    v_mfma_f32_16x16x32_bf16 v[8:11], v[64:67], v[44:47], v[8:11]
    ds_read_b64_tr_b16 v[64:65], v4 offset:3072
    ds_read_b64_tr_b16 v[66:67], v4 offset:3200
    v_mfma_f32_16x16x32_bf16 v[72:75], v[76:79], v[32:35], 0
    v_mfma_f32_16x16x32_bf16 v[72:75], v[84:87], v[36:39], v[72:75]
    v_mfma_f32_16x16x32_bf16 v[72:75], v[60:63], v[40:43], v[72:75]
    v_mfma_f32_16x16x32_bf16 v[72:75], v[68:71], v[44:47], v[72:75]
    s_waitcnt lgkmcnt(4)
    v_mfma_f32_16x16x32_bf16 v[80:83], v[12:15], v[32:35], 0
    v_mov_b32 v84, 0x3f803f80
    v_mfma_f32_16x16x32_bf16 v[80:83], v[16:19], v[36:39], v[80:83]
    v_mov_b32 v85, 0x3f803f80
    s_waitcnt lgkmcnt(0)
    v_mfma_f32_16x16x32_bf16 v[80:83], v[56:59], v[40:43], v[80:83]
    v_mov_b32 v86, 0x3f803f80
    v_mfma_f32_16x16x32_bf16 v[80:83], v[64:67], v[44:47], v[80:83]
    v_mov_b32 v87, 0x3f803f80
    v_smfmac_f32_16x16x64_bf16 v[48:51], v[28:31], a[144:151], v6
    v_cndmask_b32 v60, 0, v84, s[34:35]
    v_smfmac_f32_16x16x64_bf16 v[52:55], v[28:31], a[152:159], v6
    v_cndmask_b32 v61, 0, v84, s[34:35]
    v_max3_f32 v20, v8, v9, v10
    v_max3_f32 v21, v11, v72, v73
    v_max3_f32 v20, v20, v21, v74
    v_max3_f32 v21, v80, v81, v82
    v_max3_f32 v20, v20, v75, v83
    v_max_f32 v20, v20, v21
    v_mov_b32 v21, v20
    v_cvt_pk_bf16_f32 v48, v48, v49
    v_cvt_pk_bf16_f32 v49, v50, v51
    v_permlane16_swap_b32 v20, v21
    v_max_f32 v20, v20, v21
    v_mov_b32 v21, v20
    v_cvt_pk_bf16_f32 v50, v52, v53
    v_cvt_pk_bf16_f32 v51, v54, v55
    v_permlane32_swap_b32 v20, v21
    v_max_f32 v20, v20, v21
    v_mul_f32 v22, s10, v20
    v_pk_fma_f32 v[8:9], v[8:9], s[10:11], v[22:23] op_sel_hi:[1,1,0] neg_lo:[0,0,1] neg_hi:[0,0,1]
    v_pk_fma_f32 v[10:11], v[10:11], s[10:11], v[22:23] op_sel_hi:[1,1,0] neg_lo:[0,0,1] neg_hi:[0,0,1]
    v_pk_fma_f32 v[72:73], v[72:73], s[10:11], v[22:23] op_sel_hi:[1,1,0] neg_lo:[0,0,1] neg_hi:[0,0,1]
    v_pk_fma_f32 v[74:75], v[74:75], s[10:11], v[22:23] op_sel_hi:[1,1,0] neg_lo:[0,0,1] neg_hi:[0,0,1]
    v_pk_fma_f32 v[80:81], v[80:81], s[10:11], v[22:23] op_sel_hi:[1,1,0] neg_lo:[0,0,1] neg_hi:[0,0,1]
    v_pk_fma_f32 v[82:83], v[82:83], s[10:11], v[22:23] op_sel_hi:[1,1,0] neg_lo:[0,0,1] neg_hi:[0,0,1]
    v_exp_f32 v8, v8
    v_exp_f32 v9, v9
    v_exp_f32 v10, v10
    v_exp_f32 v11, v11
    v_exp_f32 v72, v72
    v_exp_f32 v73, v73
    v_exp_f32 v74, v74
    v_exp_f32 v75, v75
    v_cvt_pk_bf16_f32 v32, v8, v9
    v_cvt_pk_bf16_f32 v33, v10, v11
    v_exp_f32 v80, v80
    v_exp_f32 v81, v81
    v_exp_f32 v82, v82
    v_exp_f32 v83, v83
    v_cvt_pk_bf16_f32 v34, v72, v73
    v_cvt_pk_bf16_f32 v35, v74, v75
    v_cvt_pk_bf16_f32 v36, v80, v81
    s_waitcnt vmcnt(3)
    v_mfma_f32_16x16x32_bf16 v[8:11], v[84:87], v[32:35], 0
    v_mfma_f32_16x16x32_bf16 v[40:43], v[88:91], v[32:35], 0
    v_cvt_pk_bf16_f32 v37, v82, v83
    v_mfma_f32_16x16x32_bf16 v[44:47], v[92:95], v[32:35], 0
    v_mfma_f32_16x16x16_bf16 v[8:11], v[60:61], v[36:37], v[8:11]
    v_mov_b64 v[72:73], 0
    v_mfma_f32_16x16x16_bf16 v[40:43], v[48:49], v[36:37], v[40:43]
    v_mov_b64 v[74:75], 0
    v_mfma_f32_16x16x16_bf16 v[44:47], v[50:51], v[36:37], v[44:47]
    v_mov_b64 v[76:77], 0
    v_mov_b64 v[78:79], 0
    v_mov_b64 v[80:81], 0
    v_mov_b64 v[82:83], 0
    v_rcp_f32 v22, v8
    s_nop 2
    v_cndmask_b32 v40, v44, v40, s[32:33]
    v_cndmask_b32 v41, v45, v41, s[32:33]
    v_cndmask_b32 v42, v46, v42, s[32:33]
    v_cndmask_b32 v43, v47, v43, s[32:33]
    v_pk_mul_f32 v[40:41], v[40:41], v[22:23] op_sel_hi:[1,0]
    v_pk_mul_f32 v[42:43], v[42:43], v[22:23] op_sel_hi:[1,0]
    v_cvt_pk_bf16_f32 v44, v40, v41
    v_cvt_pk_bf16_f32 v45, v42, v43
    ds_write_b64 v5, v[44:45]
    s_mov_b32 m0, s73
    s_add_u32 s28, s28, 0x80000
    buffer_load_dwordx4 v1, s[4:7], s28 offen lds
    buffer_load_dwordx4 v1, s[4:7], s28 offen offset:1024 lds
    v_and_b32 v9, 0x70, v1
    v_bfe_u32 v29, v1, 8, 1
    v_lshl_add_u32 v9, v29, 3, v9
    v_bfe_u32 v29, v1, 9, 1
    v_lshl_add_u32 v9, v29, 2, v9
    v_mov_b32 v29, 0x40000000
    s_waitcnt lgkmcnt(0)
    s_barrier
    ds_read_b128 v[12:15], v0 offset:0
    ds_read_b128 v[16:19], v0 offset:64
    ds_read_b128 v[20:23], v0 offset:128
    ds_read_b128 v[24:27], v0 offset:192
    v_cndmask_b32 v9, v29, v9, s[32:33]
    v_and_b32 v29, 16, v1
    v_lshlrev_b32 v29, v29, s38
    v_cndmask_b32 v88, 0, v29, s[44:45]
    v_cndmask_b32 v89, 0, v29, s[46:47]
    v_cndmask_b32 v90, 0, v29, s[48:49]
    v_cndmask_b32 v91, 0, v29, s[50:51]
    s_waitcnt lgkmcnt(3)
    v_smfmac_f32_16x16x64_bf16 v[72:75], v[12:15], a[160:167], v6
    s_waitcnt lgkmcnt(2)
    v_smfmac_f32_16x16x64_bf16 v[72:75], v[16:19], a[168:175], v6
    s_waitcnt lgkmcnt(1)
    v_smfmac_f32_16x16x64_bf16 v[72:75], v[20:23], a[176:183], v6
    s_waitcnt lgkmcnt(0)
    v_smfmac_f32_16x16x64_bf16 v[72:75], v[24:27], a[184:191], v6
    v_smfmac_f32_16x16x64_bf16 v[76:79], v[12:15], a[192:199], v6
    v_smfmac_f32_16x16x64_bf16 v[76:79], v[16:19], a[200:207], v6
    v_cvt_pk_bf16_f32 v72, v72, v73
    v_smfmac_f32_16x16x64_bf16 v[76:79], v[20:23], a[208:215], v6
    v_cvt_pk_bf16_f32 v73, v74, v75
    v_smfmac_f32_16x16x64_bf16 v[76:79], v[24:27], a[216:223], v6
    v_and_or_b32 v72, v72, -2, s16
    v_mfma_f32_16x16x32_bf16 v[80:83], v[12:15], a[224:227], 0
    buffer_store_dwordx2 v[72:73], v7, s[4:7], s23 offen
    v_mfma_f32_16x16x32_bf16 v[80:83], v[16:19], a[228:231], v[80:83]
    v_mfma_f32_16x16x32_bf16 v[80:83], v[20:23], a[232:235], v[80:83]
    v_cvt_pk_bf16_f32 v76, v76, v77
    v_cvt_pk_bf16_f32 v77, v78, v79
    v_mfma_f32_16x16x32_bf16 v[80:83], v[24:27], a[236:239], v[80:83]
    v_and_or_b32 v76, v76, -2, s16
    buffer_store_dwordx2 v[76:77], v7, s[4:7], s25 offen
    s_add_u32 s17, s17, 0x4000
    s_add_u32 s3, s3, 0x80000
    s_add_u32 s29, s29, 0x80000
    s_add_u32 s18, s18, 0x4000
    s_add_u32 s21, s21, 0x8000
    s_add_u32 s15, s15, 1
    s_nop 0
    v_cvt_pk_bf16_f32 v80, v80, v81
    v_cvt_pk_bf16_f32 v81, v82, v83
    v_and_or_b32 v80, v80, -2, s16
    s_mov_b64 exec, s[34:35]
    buffer_store_dwordx2 v[80:81], v7, s[4:7], s26 offen
    s_mov_b64 exec, -1
    s_cmp_lg_u32 s42, 0
    s_cbranch_scc1 OWN_86
    s_cmp_lt_u32 s14, 2
    s_cbranch_scc1 IDLE_85
    s_branch REC_POLL
OWN_86:
    s_nop 15
    s_nop 13
    buffer_load_dwordx4 v[12:15], v1, s[4:7], s24 offen offset:0 sc1
    buffer_load_dwordx4 v[16:19], v1, s[4:7], s24 offen offset:1024 sc1
    buffer_load_dwordx4 v[20:23], v1, s[4:7], s24 offen offset:2048 sc1
    buffer_load_dwordx4 v[24:27], v1, s[4:7], s24 offen offset:3072 sc1
    ds_read_b128 v[56:59], v2 offset:0
    ds_read_b128 v[60:63], v2 offset:1024
    ds_read_b128 v[64:67], v2 offset:2048
    ds_read_b128 v[68:71], v2 offset:3072
    v_mov_b64 v[32:33], 0
    v_mov_b64 v[34:35], 0
    v_mov_b64 v[36:37], 0
    v_mov_b64 v[38:39], 0
    v_mov_b64 v[40:41], 0
    v_mov_b64 v[42:43], 0
    v_mov_b64 v[44:45], 0
    v_mov_b64 v[46:47], 0
    buffer_load_dwordx4 v[72:75], v1, s[4:7], s24 offen offset:0 sc1
    buffer_load_dwordx4 v[76:79], v1, s[4:7], s24 offen offset:1024 sc1
    buffer_load_dwordx4 v[80:83], v1, s[4:7], s24 offen offset:2048 sc1
    buffer_load_dwordx4 v[84:87], v1, s[4:7], s24 offen offset:3072 sc1
    v_mov_b64 v[48:49], 0
    v_mov_b64 v[50:51], 0
    v_mov_b64 v[52:53], 0
    v_mov_b64 v[54:55], 0
OPOLL_88:
    s_waitcnt vmcnt(7)
    v_mfma_f32_16x16x32_bf16 v[92:95], v[12:15], v[88:91], 0
    v_bitop3_b32 v10, v12, v14, s16 bitop3:0x7e
    s_waitcnt vmcnt(6)
    v_mfma_f32_16x16x32_bf16 v[92:95], v[16:19], v[88:91], v[92:95]
    v_bitop3_b32 v11, v16, v18, s16 bitop3:0x7e
    s_waitcnt vmcnt(5)
    v_mfma_f32_16x16x32_bf16 v[92:95], v[20:23], v[88:91], v[92:95]
    v_bitop3_b32 v30, v20, v22, s16 bitop3:0x7e
    s_waitcnt vmcnt(4)
    v_mfma_f32_16x16x32_bf16 v[92:95], v[24:27], v[88:91], v[92:95]
    v_bitop3_b32 v31, v24, v26, s16 bitop3:0x7e
    v_or3_b32 v10, v10, v11, v30
    v_bitop3_b32 v10, v10, v31, 1 bitop3:0xa8
    v_cmp_ne_u32 vcc, 0, v10
    s_nop 3
    s_cbranch_vccz ODONE_87
    s_add_u32 s40, s40, 1
    buffer_load_dwordx4 v[12:15], v1, s[4:7], s24 offen offset:0 sc1
    buffer_load_dwordx4 v[16:19], v1, s[4:7], s24 offen offset:1024 sc1
    buffer_load_dwordx4 v[20:23], v1, s[4:7], s24 offen offset:2048 sc1
    buffer_load_dwordx4 v[24:27], v1, s[4:7], s24 offen offset:3072 sc1
    s_waitcnt vmcnt(7)
    v_mfma_f32_16x16x32_bf16 v[92:95], v[72:75], v[88:91], 0
    v_bitop3_b32 v10, v72, v74, s16 bitop3:0x7e
    s_waitcnt vmcnt(6)
    v_mfma_f32_16x16x32_bf16 v[92:95], v[76:79], v[88:91], v[92:95]
    v_bitop3_b32 v11, v76, v78, s16 bitop3:0x7e
    s_waitcnt vmcnt(5)
    v_mfma_f32_16x16x32_bf16 v[92:95], v[80:83], v[88:91], v[92:95]
    v_bitop3_b32 v30, v80, v82, s16 bitop3:0x7e
    s_waitcnt vmcnt(4)
    v_mfma_f32_16x16x32_bf16 v[92:95], v[84:87], v[88:91], v[92:95]
    v_bitop3_b32 v31, v84, v86, s16 bitop3:0x7e
    v_or3_b32 v10, v10, v11, v30
    v_bitop3_b32 v10, v10, v31, 1 bitop3:0xa8
    v_cmp_ne_u32 vcc, 0, v10
    s_add_u32 s68, s68, 1
    s_cmp_gt_u32 s68, 262144
    s_cbranch_scc1 ODONE_87
    s_nop 0
    s_cbranch_vccz ODONE_87
    s_add_u32 s40, s40, 1
    buffer_load_dwordx4 v[72:75], v1, s[4:7], s24 offen offset:0 sc1
    buffer_load_dwordx4 v[76:79], v1, s[4:7], s24 offen offset:1024 sc1
    buffer_load_dwordx4 v[80:83], v1, s[4:7], s24 offen offset:2048 sc1
    buffer_load_dwordx4 v[84:87], v1, s[4:7], s24 offen offset:3072 sc1
    s_branch OPOLL_88
ODONE_87:
    v_permlane32_swap_b32 v92, v94
    v_permlane32_swap_b32 v93, v95
    v_add_f32 v92, v92, v94
    v_add_f32 v93, v93, v95
    v_cvt_pk_bf16_f32 v8, v92, v93
    buffer_store_dword v8, v9, s[4:7], s18 offen
    s_cmp_eq_u32 s15, 63
    s_cselect_b32 s59, s55, 0
    s_barrier
    s_nop 15
    s_nop 15
    s_nop 12
    buffer_store_dword v8, v9, s[4:7], s21 offen sc1
    s_cmp_lt_u32 s15, 61
    s_cbranch_scc1 EFLG_89
    buffer_store_dword v6, off, s[4:7], s22 sc1
EFLG_89:
    s_xor_b32 s16, s16, 1
    s_waitcnt vmcnt(2) lgkmcnt(0)
    s_branch REC_LOOP
IDLE_85:
    s_barrier
    s_cmp_eq_u32 s15, 63
    s_cselect_b32 s59, s55, 0
    v_mov_b64 v[32:33], 0
    v_mov_b64 v[34:35], 0
    v_mov_b64 v[36:37], 0
    v_mov_b64 v[38:39], 0
    v_mov_b64 v[40:41], 0
    v_mov_b64 v[42:43], 0
    v_mov_b64 v[44:45], 0
    v_mov_b64 v[46:47], 0
    v_mov_b64 v[48:49], 0
    v_mov_b64 v[50:51], 0
    v_mov_b64 v[52:53], 0
    v_mov_b64 v[54:55], 0
    ds_read_b128 v[56:59], v2 offset:0
    ds_read_b128 v[60:63], v2 offset:1024
    ds_read_b128 v[64:67], v2 offset:2048
    ds_read_b128 v[68:71], v2 offset:3072
    s_xor_b32 s16, s16, 1
    s_waitcnt vmcnt(0)
    s_branch REC_LOOP
REC_TAIL:
KVOUT_84:
    s_cmp_eq_u32 s59, 1
    s_cbranch_scc1 KVL1_90
    s_lshl_b32 s64, s13, 13
    s_add_u32 s64, s64, 0x43c0000
    buffer_load_dwordx4 v[96:99], v1, s[4:7], s64 offen offset:0
    buffer_load_dwordx4 v[100:103], v1, s[4:7], s64 offen offset:1024
    buffer_load_dwordx4 v[104:107], v1, s[4:7], s64 offen offset:2048
    buffer_load_dwordx4 v[108:111], v1, s[4:7], s64 offen offset:3072
    s_add_u32 s64, s64, 0x1000
    buffer_load_dwordx4 v[112:115], v1, s[4:7], s64 offen offset:0
    buffer_load_dwordx4 v[116:119], v1, s[4:7], s64 offen offset:1024
    buffer_load_dwordx4 v[120:123], v1, s[4:7], s64 offen offset:2048
    buffer_load_dwordx4 v[124:127], v1, s[4:7], s64 offen offset:3072
    s_branch KVLOOK_83
KVL1_90:
    v_lshrrev_b32 v9, 5, v1
    v_lshlrev_b32 v9, 9, v9
    v_bfe_u32 v10, v1, 4, 1
    v_lshl_add_u32 v9, v10, 2, v9
    s_mov_b32 m0, 15104
    s_mov_b64 exec, s[34:35]
    buffer_load_dword v9, s[4:7], s69 offen sc1 lds
    s_mov_b64 exec, -1
    s_mov_b32 m0, 16128
    s_branch KVLOOK_83
RETRY_67:
SPIN_92:
    buffer_load_dwordx4 v[20:23], v1, s[4:7], s17 offen offset:2048 sc1
    buffer_load_dwordx4 v[24:27], v1, s[4:7], s17 offen offset:3072 sc1
    buffer_load_dwordx4 v[28:31], v1, s[4:7], s74 offen offset:0 sc1
    s_add_u32 s68, s68, 1
    s_add_u32 s40, s40, 1024
    s_cmp_gt_u32 s68, 262144
    s_waitcnt vmcnt(0)
    s_cbranch_scc1 BACK_68
    v_cmp_eq_u32 vcc, -1, v23
    s_cbranch_vccnz SPIN_92
    s_branch BACK_68
RETRY_69:
SPIN_93:
    buffer_load_dwordx4 v[24:27], v1, s[4:7], s17 offen offset:3072 sc1
    buffer_load_dwordx4 v[28:31], v1, s[4:7], s74 offen offset:0 sc1
    s_add_u32 s68, s68, 1
    s_add_u32 s40, s40, 1024
    s_cmp_gt_u32 s68, 262144
    s_waitcnt vmcnt(0)
    s_cbranch_scc1 BACK_70
    v_cmp_eq_u32 vcc, -1, v27
    s_cbranch_vccnz SPIN_93
    s_branch BACK_70
RETRY_71:
SPIN_94:
    buffer_load_dwordx4 v[28:31], v1, s[4:7], s74 offen offset:0 sc1
    s_add_u32 s68, s68, 1
    s_add_u32 s40, s40, 1024
    s_cmp_gt_u32 s68, 262144
    s_waitcnt vmcnt(0)
    s_cbranch_scc1 BACK_72
    v_cmp_eq_u32 vcc, -1, v31
    s_cbranch_vccnz SPIN_94
    s_branch BACK_72
RETRY_73:
SPIN_95:
    buffer_load_dwordx4 v[12:15], v1, s[4:7], s20 offen offset:0 sc1
    buffer_load_dwordx4 v[16:19], v1, s[4:7], s20 offen offset:1024 sc1
    buffer_load_dwordx4 v[20:23], v1, s[4:7], s20 offen offset:2048 sc1
    buffer_load_dwordx4 v[24:27], v1, s[4:7], s20 offen offset:3072 sc1
    s_add_u32 s68, s68, 1
    s_add_u32 s40, s40, 1048576
    s_cmp_gt_u32 s68, 262144
    s_waitcnt vmcnt(0)
    s_cbranch_scc1 BACK_74
    v_cmp_eq_u32 vcc, -1, v15
    s_cbranch_vccnz SPIN_95
    s_branch BACK_74
RETRY_75:
SPIN_96:
    buffer_load_dwordx4 v[16:19], v1, s[4:7], s20 offen offset:1024 sc1
    buffer_load_dwordx4 v[20:23], v1, s[4:7], s20 offen offset:2048 sc1
    buffer_load_dwordx4 v[24:27], v1, s[4:7], s20 offen offset:3072 sc1
    buffer_load_dwordx4 v[28:31], v1, s[4:7], s75 offen offset:0 sc1
    s_add_u32 s68, s68, 1
    s_add_u32 s40, s40, 1048576
    s_cmp_gt_u32 s68, 262144
    s_waitcnt vmcnt(0)
    s_cbranch_scc1 BACK_76
    v_cmp_eq_u32 vcc, -1, v19
    s_cbranch_vccnz SPIN_96
    s_branch BACK_76
RETRY_77:
SPIN_97:
    buffer_load_dwordx4 v[20:23], v1, s[4:7], s20 offen offset:2048 sc1
    buffer_load_dwordx4 v[24:27], v1, s[4:7], s20 offen offset:3072 sc1
    buffer_load_dwordx4 v[28:31], v1, s[4:7], s75 offen offset:0 sc1
    s_add_u32 s68, s68, 1
    s_add_u32 s40, s40, 1048576
    s_cmp_gt_u32 s68, 262144
    s_waitcnt vmcnt(0)
    s_cbranch_scc1 BACK_78
    v_cmp_eq_u32 vcc, -1, v23
    s_cbranch_vccnz SPIN_97
    s_branch BACK_78
RETRY_79:
SPIN_98:
    buffer_load_dwordx4 v[24:27], v1, s[4:7], s20 offen offset:3072 sc1
    buffer_load_dwordx4 v[28:31], v1, s[4:7], s75 offen offset:0 sc1
    s_add_u32 s68, s68, 1
    s_add_u32 s40, s40, 1048576
    s_cmp_gt_u32 s68, 262144
    s_waitcnt vmcnt(0)
    s_cbranch_scc1 BACK_80
    v_cmp_eq_u32 vcc, -1, v27
    s_cbranch_vccnz SPIN_98
    s_branch BACK_80
RETRY_81:
SPIN_99:
    buffer_load_dwordx4 v[28:31], v1, s[4:7], s75 offen offset:0 sc1
    s_add_u32 s68, s68, 1
    s_add_u32 s40, s40, 1048576
    s_cmp_gt_u32 s68, 262144
    s_waitcnt vmcnt(0)
    s_cbranch_scc1 BACK_82
    v_cmp_eq_u32 vcc, -1, v31
    s_cbranch_vccnz SPIN_99
    s_branch BACK_82
REC_FINAL:
    s_cmp_lg_u32 s12, 0
    s_cbranch_scc1 REC_END
    s_waitcnt lgkmcnt(0)
    v_smfmac_f32_16x16x64_bf16 v[48:51], v[20:23], a[112:119], v6
    v_smfmac_f32_16x16x64_bf16 v[52:55], v[20:23], a[120:127], v6
    v_smfmac_f32_16x16x64_bf16 v[48:51], v[24:27], a[128:135], v6
    v_smfmac_f32_16x16x64_bf16 v[52:55], v[24:27], a[136:143], v6
    v_smfmac_f32_16x16x64_bf16 v[48:51], v[28:31], a[144:151], v6
    v_smfmac_f32_16x16x64_bf16 v[52:55], v[28:31], a[152:159], v6
    ds_read_b64_tr_b16 v[192:193], v4 offset:2304
    ds_read_b64_tr_b16 v[194:195], v4 offset:2432
    ds_read_b64_tr_b16 v[196:197], v4 offset:2560
    ds_read_b64_tr_b16 v[198:199], v4 offset:2688
    ds_read_b64_tr_b16 v[200:201], v4 offset:2816
    ds_read_b64_tr_b16 v[202:203], v4 offset:2944
    ds_read_b64_tr_b16 v[204:205], v4 offset:3072
    ds_read_b64_tr_b16 v[206:207], v4 offset:3200
    ds_read_b128 v[160:163], v1 offset:0
    ds_read_b128 v[164:167], v1 offset:1024
    ds_read_b128 v[168:171], v1 offset:2048
    ds_read_b128 v[172:175], v1 offset:3072
    ds_read_b128 v[176:179], v1 offset:4096
    ds_read_b128 v[180:183], v1 offset:5120
    ds_read_b128 v[184:187], v1 offset:6144
    ds_read_b128 v[188:191], v1 offset:7168
    v_mbcnt_lo_u32_b32 v0, -1, 0
    v_mbcnt_hi_u32_b32 v0, -1, v0
    s_mov_b32 s34, 0x3e0293ee
    s_mov_b32 s35, 0x3e0293ee
    s_mov_b32 s36, -1
    s_mov_b32 s37, 0
    v_lshrrev_b32 v5, 4, v0
    v_lshlrev_b32 v5, 2, v5
    v_and_b32 v6, 15, v0
    v_add_u32 v7, 0, v5
    v_cmp_le_u32 s[38:39], v7, v6
    v_add_u32 v7, 1, v5
    v_cmp_le_u32 s[40:41], v7, v6
    v_add_u32 v7, 2, v5
    v_cmp_le_u32 s[42:43], v7, v6
    v_add_u32 v7, 3, v5
    v_cmp_le_u32 s[44:45], v7, v6
    v_mov_b32 v252, 0x3f803f80
    v_mov_b32 v253, 0x3f803f80
    v_mov_b32 v254, 0x3f803f80
    v_mov_b32 v255, 0x3f803f80
    v_permlane32_swap_b32 v48, v52
    v_permlane32_swap_b32 v49, v53
    v_permlane32_swap_b32 v50, v54
    v_permlane32_swap_b32 v51, v55
    v_pk_add_f32 v[48:49], v[48:49], v[52:53]
    v_pk_add_f32 v[50:51], v[50:51], v[54:55]
    v_cvt_pk_bf16_f32 v208, v48, v49
    v_cvt_pk_bf16_f32 v209, v50, v51
    v_mov_b32 v210, v208
    v_mov_b32 v211, v209
    s_nop 1
    v_permlane32_swap_b32 v208, v210
    v_permlane32_swap_b32 v209, v211
    s_mov_b32 s24, 63
    s_lshl_b32 s64, s24, 5
    s_add_u32 s64, s64, s13
    s_lshl_b32 s33, s64, 2
    s_add_u32 s33, s33, 0x296000
    s_lshl_b32 s32, s24, 18
    s_lshl_b32 s65, s13, 12
    s_add_u32 s32, s32, s65
    s_add_u32 s32, s32, 0x4400000
    s_lshl_b32 s64, s14, 10
    s_add_u32 s32, s32, s64
    s_waitcnt vmcnt(0) lgkmcnt(0)
    v_mfma_f32_16x16x32_bf16 v[228:231], v[160:163], v[96:99], 0
    v_mfma_f32_16x16x32_bf16 v[236:239], v[160:163], v[112:115], 0
    v_mfma_f32_16x16x32_bf16 v[240:243], v[176:179], v[112:115], 0
    v_mfma_f32_16x16x32_bf16 v[228:231], v[164:167], v[100:103], v[228:231]
    v_mfma_f32_16x16x32_bf16 v[236:239], v[164:167], v[116:119], v[236:239]
    v_mfma_f32_16x16x32_bf16 v[240:243], v[180:183], v[116:119], v[240:243]
    v_mfma_f32_16x16x32_bf16 v[228:231], v[168:171], v[104:107], v[228:231]
    v_mfma_f32_16x16x32_bf16 v[236:239], v[168:171], v[120:123], v[236:239]
    v_mfma_f32_16x16x32_bf16 v[240:243], v[184:187], v[120:123], v[240:243]
    v_mfma_f32_16x16x32_bf16 v[228:231], v[172:175], v[108:111], v[228:231]
    v_mfma_f32_16x16x32_bf16 v[236:239], v[172:175], v[124:127], v[236:239]
    v_mfma_f32_16x16x32_bf16 v[240:243], v[188:191], v[124:127], v[240:243]
    v_mfma_f32_16x16x32_bf16 v[224:227], v[192:195], v[96:99], 0
    v_mfma_f32_16x16x32_bf16 v[232:235], v[192:195], v[112:115], 0
    v_mfma_f32_16x16x32_bf16 v[224:227], v[196:199], v[100:103], v[224:227]
    v_mfma_f32_16x16x32_bf16 v[232:235], v[196:199], v[116:119], v[232:235]
    v_mfma_f32_16x16x32_bf16 v[224:227], v[200:203], v[104:107], v[224:227]
    v_mfma_f32_16x16x32_bf16 v[232:235], v[200:203], v[120:123], v[232:235]
    v_mfma_f32_16x16x32_bf16 v[224:227], v[204:207], v[108:111], v[224:227]
    v_mfma_f32_16x16x32_bf16 v[232:235], v[204:207], v[124:127], v[232:235]
    v_mov_b32 v11, 0xff800000
    s_nop 7
    v_cndmask_b32 v228, v11, v228, s[38:39]
    v_cndmask_b32 v240, v11, v240, s[38:39]
    v_cndmask_b32 v224, v11, v224, s[36:37]
    v_cndmask_b32 v232, v11, v232, s[36:37]
    v_cndmask_b32 v229, v11, v229, s[40:41]
    v_cndmask_b32 v241, v11, v241, s[40:41]
    v_cndmask_b32 v225, v11, v225, s[36:37]
    v_cndmask_b32 v233, v11, v233, s[36:37]
    v_cndmask_b32 v230, v11, v230, s[42:43]
    v_cndmask_b32 v242, v11, v242, s[42:43]
    v_cndmask_b32 v226, v11, v226, s[36:37]
    v_cndmask_b32 v234, v11, v234, s[36:37]
    v_cndmask_b32 v231, v11, v231, s[44:45]
    v_cndmask_b32 v243, v11, v243, s[44:45]
    v_cndmask_b32 v227, v11, v227, s[36:37]
    v_cndmask_b32 v235, v11, v235, s[36:37]
    v_max3_f32 v8, v224, v225, v226
    v_max3_f32 v8, v8, v227, v228
    v_max3_f32 v8, v8, v229, v230
    v_max_f32 v8, v8, v231
    v_mov_b32 v9, v8
    s_nop 1
    v_permlane16_swap_b32 v8, v9
    v_max_f32 v8, v8, v9
    v_mov_b32 v9, v8
    s_nop 1
    v_permlane32_swap_b32 v8, v9
    v_max_f32 v8, v8, v9
    v_mul_f32 v8, s34, v8
    v_fma_f32 v224, v224, s34, -v8
    v_fma_f32 v225, v225, s34, -v8
    v_fma_f32 v226, v226, s34, -v8
    v_fma_f32 v227, v227, s34, -v8
    v_fma_f32 v228, v228, s34, -v8
    v_fma_f32 v229, v229, s34, -v8
    v_fma_f32 v230, v230, s34, -v8
    v_fma_f32 v231, v231, s34, -v8
    v_exp_f32 v224, v224
    v_exp_f32 v225, v225
    v_exp_f32 v226, v226
    v_exp_f32 v227, v227
    v_exp_f32 v228, v228
    v_exp_f32 v229, v229
    v_exp_f32 v230, v230
    v_exp_f32 v231, v231
    s_nop 0
    v_cvt_pk_bf16_f32 v16, v228, v229
    v_cvt_pk_bf16_f32 v17, v230, v231
    v_mov_b32 v18, 0
    v_mov_b32 v19, 0
    v_cvt_pk_bf16_f32 v20, v224, v225
    v_cvt_pk_bf16_f32 v21, v226, v227
    v_max3_f32 v8, v232, v233, v234
    v_max3_f32 v8, v8, v235, v236
    v_max3_f32 v8, v8, v237, v238
    v_max3_f32 v8, v8, v239, v240
    v_max3_f32 v8, v8, v241, v242
    v_max_f32 v8, v8, v243
    v_mov_b32 v9, v8
    s_nop 1
    v_permlane16_swap_b32 v8, v9
    v_max_f32 v8, v8, v9
    v_mov_b32 v9, v8
    s_nop 1
    v_permlane32_swap_b32 v8, v9
    v_max_f32 v8, v8, v9
    v_mul_f32 v8, s34, v8
    v_fma_f32 v232, v232, s34, -v8
    v_fma_f32 v233, v233, s34, -v8
    v_fma_f32 v234, v234, s34, -v8
    v_fma_f32 v235, v235, s34, -v8
    v_fma_f32 v236, v236, s34, -v8
    v_fma_f32 v237, v237, s34, -v8
    v_fma_f32 v238, v238, s34, -v8
    v_fma_f32 v239, v239, s34, -v8
    v_fma_f32 v240, v240, s34, -v8
    v_fma_f32 v241, v241, s34, -v8
    v_fma_f32 v242, v242, s34, -v8
    v_fma_f32 v243, v243, s34, -v8
    v_exp_f32 v232, v232
    v_exp_f32 v233, v233
    v_exp_f32 v234, v234
    v_exp_f32 v235, v235
    v_exp_f32 v236, v236
    v_exp_f32 v237, v237
    v_exp_f32 v238, v238
    v_exp_f32 v239, v239
    v_exp_f32 v240, v240
    v_exp_f32 v241, v241
    v_exp_f32 v242, v242
    v_exp_f32 v243, v243
    s_nop 0
    v_cvt_pk_bf16_f32 v22, v236, v237
    v_cvt_pk_bf16_f32 v23, v238, v239
    v_cvt_pk_bf16_f32 v24, v240, v241
    v_cvt_pk_bf16_f32 v25, v242, v243
    v_cvt_pk_bf16_f32 v26, v232, v233
    v_cvt_pk_bf16_f32 v27, v234, v235
    v_mfma_f32_16x16x32_bf16 v[244:247], v[252:255], v[16:19], 0
    v_mfma_f32_16x16x32_bf16 v[248:251], v[252:255], v[22:25], 0
    v_mfma_f32_16x16x32_bf16 v[32:35], v[88:91], v[16:19], 0
    v_mfma_f32_16x16x32_bf16 v[36:39], v[88:91], v[22:25], 0
    v_mfma_f32_16x16x32_bf16 v[40:43], v[92:95], v[16:19], 0
    v_mfma_f32_16x16x32_bf16 v[44:47], v[92:95], v[22:25], 0
    v_mfma_f32_16x16x16_bf16 v[244:247], v[252:253], v[20:21], v[244:247]
    v_mfma_f32_16x16x16_bf16 v[248:251], v[252:253], v[26:27], v[248:251]
    v_mfma_f32_16x16x16_bf16 v[32:35], v[208:209], v[20:21], v[32:35]
    v_mfma_f32_16x16x16_bf16 v[36:39], v[208:209], v[26:27], v[36:39]
    v_mfma_f32_16x16x16_bf16 v[40:43], v[210:211], v[20:21], v[40:43]
    v_mfma_f32_16x16x16_bf16 v[44:47], v[210:211], v[26:27], v[44:47]
    v_rcp_f32 v8, v244
    v_rcp_f32 v9, v248
    s_nop 7
    v_mul_f32 v32, v32, v8
    v_mul_f32 v33, v33, v8
    v_mul_f32 v34, v34, v8
    v_mul_f32 v35, v35, v8
    v_cvt_pk_bf16_f32 v96, v32, v33
    v_cvt_pk_bf16_f32 v97, v34, v35
    v_mul_f32 v40, v40, v8
    v_mul_f32 v41, v41, v8
    v_mul_f32 v42, v42, v8
    v_mul_f32 v43, v43, v8
    v_cvt_pk_bf16_f32 v98, v40, v41
    v_cvt_pk_bf16_f32 v99, v42, v43
    s_add_u32 s64, s32, 0x0
    buffer_store_dwordx4 v[96:99], v1, s[4:7], s64 offen offset:0 sc1
    v_mul_f32 v36, v36, v9
    v_mul_f32 v37, v37, v9
    v_mul_f32 v38, v38, v9
    v_mul_f32 v39, v39, v9
    v_cvt_pk_bf16_f32 v100, v36, v37
    v_cvt_pk_bf16_f32 v101, v38, v39
    v_mul_f32 v44, v44, v9
    v_mul_f32 v45, v45, v9
    v_mul_f32 v46, v46, v9
    v_mul_f32 v47, v47, v9
    v_cvt_pk_bf16_f32 v102, v44, v45
    v_cvt_pk_bf16_f32 v103, v46, v47
    s_add_u32 s64, s32, 0x20000
    buffer_store_dwordx4 v[100:103], v1, s[4:7], s64 offen offset:0 sc1
    s_waitcnt vmcnt(0)
    s_barrier
    s_cmp_lg_u32 s14, 0
    s_cbranch_scc1 REC_END
    v_mov_b32 v7, 1
    v_mov_b32 v8, 0
    s_mov_b64 exec, 1
    buffer_store_dword v7, v8, s[4:7], s33 offen sc1
    s_mov_b64 exec, -1
    s_branch REC_END
REC_END:
    s_branch M_EXIT
M_HELP:
    v_mbcnt_lo_u32_b32 v0, -1, 0
    v_mbcnt_hi_u32_b32 v0, -1, v0
    s_and_b32 s12, s96, 1
    s_lshr_b32 s3, s96, 1
    s_and_b32 s13, s3, 31
    s_lshr_b32 s3, s3, 5
    s_load_dwordx4 s[48:51], s[0:1], 16
    s_load_dwordx2 s[52:53], s[0:1], 32
    s_waitcnt lgkmcnt(0)
    s_mov_b32 s46, 5242880
    s_mov_b32 s47, 0x00020000
    s_cmp_eq_u32 s3, 1
    s_cselect_b32 s44, s52, s50
    s_cselect_b32 s45, s53, s51
    s_cmp_eq_u32 s3, 2
    s_cselect_b32 s44, s48, s44
    s_cselect_b32 s45, s49, s45
    s_load_dwordx2 s[16:17], s[0:1], 0
    s_mov_b32 s18, 2621440
    s_mov_b32 s19, 0x00020000
    s_load_dwordx2 s[20:21], s[0:1], 64
    s_mov_b32 s22, 1280
    s_mov_b32 s23, 0x00020000
    s_load_dwordx2 s[24:25], s[0:1], 8
    s_mov_b32 s26, 10240
    s_mov_b32 s27, 0x00020000
    s_lshr_b32 s29, s96, 5
    s_sub_u32 s28, s96, s29
    s_lshl_b32 s28, s28, 2
    s_add_u32 s28, s28, s14
    s_mul_i32 s28, s28, 3
    v_lshlrev_b32 v3, 4, v0
    v_lshlrev_b32 v4, 2, v0
    s_waitcnt lgkmcnt(0)
    s_and_b32 s29, s96, 31
    s_cmp_eq_u32 s29, 31
    s_cbranch_scc1 INP2_100
    s_add_u32 s29, s28, 0
    s_mul_i32 s33, s29, 1280
    buffer_load_dwordx4 v[10:13], v3, s[16:19], s33 offen
    buffer_load_dword v14, v4, s[16:19], s33 offen offset:1024
    s_add_u32 s29, s28, 1
    s_mul_i32 s34, s29, 1280
    buffer_load_dwordx4 v[16:19], v3, s[16:19], s34 offen
    buffer_load_dword v20, v4, s[16:19], s34 offen offset:1024
    s_add_u32 s29, s28, 2
    s_mul_i32 s35, s29, 1280
    buffer_load_dwordx4 v[22:25], v3, s[16:19], s35 offen
    buffer_load_dword v26, v4, s[16:19], s35 offen offset:1024
    buffer_load_dwordx4 v[28:31], v3, s[20:23], 0 offen
    buffer_load_dword v32, v4, s[20:23], 0 offen offset:1024
    s_cmp_ge_u32 s96, 10
    s_cbranch_scc1 INM0_101
    v_and_b32 v5, 7, v0
    v_mul_u32_u24 v5, 1280, v5
    v_lshrrev_b32 v6, 4, v0
    v_lshl_add_u32 v5, v6, 5, v5
    v_bfe_u32 v6, v0, 3, 1
    v_lshl_add_u32 v5, v6, 4, v5
    s_lshl_b32 s29, s96, 7
    buffer_load_dwordx4 v[34:37], v5, s[24:27], s29 offen
INM0_101:
    s_waitcnt vmcnt(0)
    s_add_u32 s29, s28, 0
    s_cmp_ge_u32 s29, 2048
    s_cbranch_scc1 INR_102
    v_lshlrev_b32 v50, 16, v10
    v_and_b32 v60, 0xffff0000, v10
    v_lshlrev_b32 v51, 16, v11
    v_and_b32 v61, 0xffff0000, v11
    v_lshlrev_b32 v52, 16, v12
    v_and_b32 v62, 0xffff0000, v12
    v_lshlrev_b32 v53, 16, v13
    v_and_b32 v63, 0xffff0000, v13
    v_lshlrev_b32 v54, 16, v14
    v_and_b32 v64, 0xffff0000, v14
    v_add_f32 v70, v50, v60
    v_add_f32 v70, v70, v51
    v_add_f32 v70, v70, v61
    v_add_f32 v70, v70, v52
    v_add_f32 v70, v70, v62
    v_add_f32 v70, v70, v53
    v_add_f32 v70, v70, v63
    v_add_f32 v70, v70, v54
    v_add_f32 v70, v70, v64
    s_nop 1
    v_add_f32_dpp v70, v70, v70 quad_perm:[1,0,3,2] row_mask:0xf bank_mask:0xf
    s_nop 1
    v_add_f32_dpp v70, v70, v70 quad_perm:[2,3,0,1] row_mask:0xf bank_mask:0xf
    s_nop 1
    v_add_f32_dpp v70, v70, v70 row_half_mirror row_mask:0xf bank_mask:0xf
    s_nop 1
    v_add_f32_dpp v70, v70, v70 row_mirror row_mask:0xf bank_mask:0xf
    v_mov_b32 v71, v70
    s_nop 1
    v_permlane16_swap_b32 v70, v71
    v_add_f32 v70, v70, v71
    v_mov_b32 v71, v70
    s_nop 1
    v_permlane32_swap_b32 v70, v71
    v_add_f32 v70, v70, v71
    v_mul_f32 v72, 0x3acccccd, v70
    v_mov_b32 v73, 0
    v_sub_f32 v74, v50, v72
    v_fmac_f32 v73, v74, v74
    v_sub_f32 v74, v60, v72
    v_fmac_f32 v73, v74, v74
    v_sub_f32 v74, v51, v72
    v_fmac_f32 v73, v74, v74
    v_sub_f32 v74, v61, v72
    v_fmac_f32 v73, v74, v74
    v_sub_f32 v74, v52, v72
    v_fmac_f32 v73, v74, v74
    v_sub_f32 v74, v62, v72
    v_fmac_f32 v73, v74, v74
    v_sub_f32 v74, v53, v72
    v_fmac_f32 v73, v74, v74
    v_sub_f32 v74, v63, v72
    v_fmac_f32 v73, v74, v74
    v_sub_f32 v74, v54, v72
    v_fmac_f32 v73, v74, v74
    v_sub_f32 v74, v64, v72
    v_fmac_f32 v73, v74, v74
    s_nop 1
    v_add_f32_dpp v73, v73, v73 quad_perm:[1,0,3,2] row_mask:0xf bank_mask:0xf
    s_nop 1
    v_add_f32_dpp v73, v73, v73 quad_perm:[2,3,0,1] row_mask:0xf bank_mask:0xf
    s_nop 1
    v_add_f32_dpp v73, v73, v73 row_half_mirror row_mask:0xf bank_mask:0xf
    s_nop 1
    v_add_f32_dpp v73, v73, v73 row_mirror row_mask:0xf bank_mask:0xf
    v_mov_b32 v71, v73
    s_nop 1
    v_permlane16_swap_b32 v73, v71
    v_add_f32 v73, v73, v71
    v_mov_b32 v71, v73
    s_nop 1
    v_permlane32_swap_b32 v73, v71
    v_add_f32 v73, v73, v71
    v_mul_f32 v73, 0x3acccccd, v73
    v_cvt_pk_bf16_f32 v72, v72, v72
    v_lshlrev_b32 v72, 16, v72
    v_cvt_pk_bf16_f32 v73, v73, v73
    v_lshlrev_b32 v73, 16, v73
    v_add_f32 v73, 0x3727c5ac, v73
    v_cvt_pk_bf16_f32 v73, v73, v73
    v_lshlrev_b32 v73, 16, v73
    v_sqrt_f32 v73, v73
    s_nop 0
    v_cvt_pk_bf16_f32 v73, v73, v73
    v_lshlrev_b32 v73, 16, v73
    v_rcp_f32 v75, v73
    s_nop 0
    v_mov_b32 v76, 0
    v_sub_f32 v50, v50, v72
    v_cvt_pk_bf16_f32 v50, v50, v50
    v_lshlrev_b32 v50, 16, v50
    v_mul_f32 v74, v50, v75
    v_fma_f32 v77, -v74, v73, v50
    v_fma_f32 v50, v77, v75, v74
    v_sub_f32 v60, v60, v72
    v_cvt_pk_bf16_f32 v60, v60, v60
    v_lshlrev_b32 v60, 16, v60
    v_mul_f32 v74, v60, v75
    v_fma_f32 v77, -v74, v73, v60
    v_fma_f32 v60, v77, v75, v74
    v_cvt_pk_bf16_f32 v10, v50, v60
    v_lshlrev_b32 v74, 16, v10
    v_lshlrev_b32 v77, 16, v28
    v_fmac_f32 v76, v74, v77
    v_and_b32 v74, 0xffff0000, v10
    v_and_b32 v77, 0xffff0000, v28
    v_fmac_f32 v76, v74, v77
    v_sub_f32 v51, v51, v72
    v_cvt_pk_bf16_f32 v51, v51, v51
    v_lshlrev_b32 v51, 16, v51
    v_mul_f32 v74, v51, v75
    v_fma_f32 v77, -v74, v73, v51
    v_fma_f32 v51, v77, v75, v74
    v_sub_f32 v61, v61, v72
    v_cvt_pk_bf16_f32 v61, v61, v61
    v_lshlrev_b32 v61, 16, v61
    v_mul_f32 v74, v61, v75
    v_fma_f32 v77, -v74, v73, v61
    v_fma_f32 v61, v77, v75, v74
    v_cvt_pk_bf16_f32 v11, v51, v61
    v_lshlrev_b32 v74, 16, v11
    v_lshlrev_b32 v77, 16, v29
    v_fmac_f32 v76, v74, v77
    v_and_b32 v74, 0xffff0000, v11
    v_and_b32 v77, 0xffff0000, v29
    v_fmac_f32 v76, v74, v77
    v_sub_f32 v52, v52, v72
    v_cvt_pk_bf16_f32 v52, v52, v52
    v_lshlrev_b32 v52, 16, v52
    v_mul_f32 v74, v52, v75
    v_fma_f32 v77, -v74, v73, v52
    v_fma_f32 v52, v77, v75, v74
    v_sub_f32 v62, v62, v72
    v_cvt_pk_bf16_f32 v62, v62, v62
    v_lshlrev_b32 v62, 16, v62
    v_mul_f32 v74, v62, v75
    v_fma_f32 v77, -v74, v73, v62
    v_fma_f32 v62, v77, v75, v74
    v_cvt_pk_bf16_f32 v12, v52, v62
    v_lshlrev_b32 v74, 16, v12
    v_lshlrev_b32 v77, 16, v30
    v_fmac_f32 v76, v74, v77
    v_and_b32 v74, 0xffff0000, v12
    v_and_b32 v77, 0xffff0000, v30
    v_fmac_f32 v76, v74, v77
    v_sub_f32 v53, v53, v72
    v_cvt_pk_bf16_f32 v53, v53, v53
    v_lshlrev_b32 v53, 16, v53
    v_mul_f32 v74, v53, v75
    v_fma_f32 v77, -v74, v73, v53
    v_fma_f32 v53, v77, v75, v74
    v_sub_f32 v63, v63, v72
    v_cvt_pk_bf16_f32 v63, v63, v63
    v_lshlrev_b32 v63, 16, v63
    v_mul_f32 v74, v63, v75
    v_fma_f32 v77, -v74, v73, v63
    v_fma_f32 v63, v77, v75, v74
    v_cvt_pk_bf16_f32 v13, v53, v63
    v_lshlrev_b32 v74, 16, v13
    v_lshlrev_b32 v77, 16, v31
    v_fmac_f32 v76, v74, v77
    v_and_b32 v74, 0xffff0000, v13
    v_and_b32 v77, 0xffff0000, v31
    v_fmac_f32 v76, v74, v77
    v_sub_f32 v54, v54, v72
    v_cvt_pk_bf16_f32 v54, v54, v54
    v_lshlrev_b32 v54, 16, v54
    v_mul_f32 v74, v54, v75
    v_fma_f32 v77, -v74, v73, v54
    v_fma_f32 v54, v77, v75, v74
    v_sub_f32 v64, v64, v72
    v_cvt_pk_bf16_f32 v64, v64, v64
    v_lshlrev_b32 v64, 16, v64
    v_mul_f32 v74, v64, v75
    v_fma_f32 v77, -v74, v73, v64
    v_fma_f32 v64, v77, v75, v74
    v_cvt_pk_bf16_f32 v14, v54, v64
    v_lshlrev_b32 v74, 16, v14
    v_lshlrev_b32 v77, 16, v32
    v_fmac_f32 v76, v74, v77
    v_and_b32 v74, 0xffff0000, v14
    v_and_b32 v77, 0xffff0000, v32
    v_fmac_f32 v76, v74, v77
    s_add_u32 s30, s33, 0x0
    buffer_store_dwordx4 v[10:13], v3, s[4:7], s30 offen sc1
    buffer_store_dword v14, v4, s[4:7], s30 offen offset:1024 sc1
    s_nop 1
    v_add_f32_dpp v76, v76, v76 quad_perm:[1,0,3,2] row_mask:0xf bank_mask:0xf
    s_nop 1
    v_add_f32_dpp v76, v76, v76 quad_perm:[2,3,0,1] row_mask:0xf bank_mask:0xf
    s_nop 1
    v_add_f32_dpp v76, v76, v76 row_half_mirror row_mask:0xf bank_mask:0xf
    s_nop 1
    v_add_f32_dpp v76, v76, v76 row_mirror row_mask:0xf bank_mask:0xf
    v_mov_b32 v71, v76
    s_nop 1
    v_permlane16_swap_b32 v76, v71
    v_add_f32 v76, v76, v71
    v_mov_b32 v71, v76
    s_nop 1
    v_permlane32_swap_b32 v76, v71
    v_add_f32 v76, v76, v71
    v_cvt_pk_bf16_f32 v76, v76, v76
    v_lshlrev_b32 v76, 16, v76
    s_lshl_b32 s30, s29, 2
    s_add_u32 s30, s30, 0x280000
    s_mov_b64 exec, 1
    buffer_store_dword v76, off, s[4:7], s30 sc1
    s_mov_b64 exec, -1
INR_102:
    s_add_u32 s29, s28, 1
    s_cmp_ge_u32 s29, 2048
    s_cbranch_scc1 INR_103
    v_lshlrev_b32 v50, 16, v16
    v_and_b32 v60, 0xffff0000, v16
    v_lshlrev_b32 v51, 16, v17
    v_and_b32 v61, 0xffff0000, v17
    v_lshlrev_b32 v52, 16, v18
    v_and_b32 v62, 0xffff0000, v18
    v_lshlrev_b32 v53, 16, v19
    v_and_b32 v63, 0xffff0000, v19
    v_lshlrev_b32 v54, 16, v20
    v_and_b32 v64, 0xffff0000, v20
    v_add_f32 v70, v50, v60
    v_add_f32 v70, v70, v51
    v_add_f32 v70, v70, v61
    v_add_f32 v70, v70, v52
    v_add_f32 v70, v70, v62
    v_add_f32 v70, v70, v53
    v_add_f32 v70, v70, v63
    v_add_f32 v70, v70, v54
    v_add_f32 v70, v70, v64
    s_nop 1
    v_add_f32_dpp v70, v70, v70 quad_perm:[1,0,3,2] row_mask:0xf bank_mask:0xf
    s_nop 1
    v_add_f32_dpp v70, v70, v70 quad_perm:[2,3,0,1] row_mask:0xf bank_mask:0xf
    s_nop 1
    v_add_f32_dpp v70, v70, v70 row_half_mirror row_mask:0xf bank_mask:0xf
    s_nop 1
    v_add_f32_dpp v70, v70, v70 row_mirror row_mask:0xf bank_mask:0xf
    v_mov_b32 v71, v70
    s_nop 1
    v_permlane16_swap_b32 v70, v71
    v_add_f32 v70, v70, v71
    v_mov_b32 v71, v70
    s_nop 1
    v_permlane32_swap_b32 v70, v71
    v_add_f32 v70, v70, v71
    v_mul_f32 v72, 0x3acccccd, v70
    v_mov_b32 v73, 0
    v_sub_f32 v74, v50, v72
    v_fmac_f32 v73, v74, v74
    v_sub_f32 v74, v60, v72
    v_fmac_f32 v73, v74, v74
    v_sub_f32 v74, v51, v72
    v_fmac_f32 v73, v74, v74
    v_sub_f32 v74, v61, v72
    v_fmac_f32 v73, v74, v74
    v_sub_f32 v74, v52, v72
    v_fmac_f32 v73, v74, v74
    v_sub_f32 v74, v62, v72
    v_fmac_f32 v73, v74, v74
    v_sub_f32 v74, v53, v72
    v_fmac_f32 v73, v74, v74
    v_sub_f32 v74, v63, v72
    v_fmac_f32 v73, v74, v74
    v_sub_f32 v74, v54, v72
    v_fmac_f32 v73, v74, v74
    v_sub_f32 v74, v64, v72
    v_fmac_f32 v73, v74, v74
    s_nop 1
    v_add_f32_dpp v73, v73, v73 quad_perm:[1,0,3,2] row_mask:0xf bank_mask:0xf
    s_nop 1
    v_add_f32_dpp v73, v73, v73 quad_perm:[2,3,0,1] row_mask:0xf bank_mask:0xf
    s_nop 1
    v_add_f32_dpp v73, v73, v73 row_half_mirror row_mask:0xf bank_mask:0xf
    s_nop 1
    v_add_f32_dpp v73, v73, v73 row_mirror row_mask:0xf bank_mask:0xf
    v_mov_b32 v71, v73
    s_nop 1
    v_permlane16_swap_b32 v73, v71
    v_add_f32 v73, v73, v71
    v_mov_b32 v71, v73
    s_nop 1
    v_permlane32_swap_b32 v73, v71
    v_add_f32 v73, v73, v71
    v_mul_f32 v73, 0x3acccccd, v73
    v_cvt_pk_bf16_f32 v72, v72, v72
    v_lshlrev_b32 v72, 16, v72
    v_cvt_pk_bf16_f32 v73, v73, v73
    v_lshlrev_b32 v73, 16, v73
    v_add_f32 v73, 0x3727c5ac, v73
    v_cvt_pk_bf16_f32 v73, v73, v73
    v_lshlrev_b32 v73, 16, v73
    v_sqrt_f32 v73, v73
    s_nop 0
    v_cvt_pk_bf16_f32 v73, v73, v73
    v_lshlrev_b32 v73, 16, v73
    v_rcp_f32 v75, v73
    s_nop 0
    v_mov_b32 v76, 0
    v_sub_f32 v50, v50, v72
    v_cvt_pk_bf16_f32 v50, v50, v50
    v_lshlrev_b32 v50, 16, v50
    v_mul_f32 v74, v50, v75
    v_fma_f32 v77, -v74, v73, v50
    v_fma_f32 v50, v77, v75, v74
    v_sub_f32 v60, v60, v72
    v_cvt_pk_bf16_f32 v60, v60, v60
    v_lshlrev_b32 v60, 16, v60
    v_mul_f32 v74, v60, v75
    v_fma_f32 v77, -v74, v73, v60
    v_fma_f32 v60, v77, v75, v74
    v_cvt_pk_bf16_f32 v16, v50, v60
    v_lshlrev_b32 v74, 16, v16
    v_lshlrev_b32 v77, 16, v28
    v_fmac_f32 v76, v74, v77
    v_and_b32 v74, 0xffff0000, v16
    v_and_b32 v77, 0xffff0000, v28
    v_fmac_f32 v76, v74, v77
    v_sub_f32 v51, v51, v72
    v_cvt_pk_bf16_f32 v51, v51, v51
    v_lshlrev_b32 v51, 16, v51
    v_mul_f32 v74, v51, v75
    v_fma_f32 v77, -v74, v73, v51
    v_fma_f32 v51, v77, v75, v74
    v_sub_f32 v61, v61, v72
    v_cvt_pk_bf16_f32 v61, v61, v61
    v_lshlrev_b32 v61, 16, v61
    v_mul_f32 v74, v61, v75
    v_fma_f32 v77, -v74, v73, v61
    v_fma_f32 v61, v77, v75, v74
    v_cvt_pk_bf16_f32 v17, v51, v61
    v_lshlrev_b32 v74, 16, v17
    v_lshlrev_b32 v77, 16, v29
    v_fmac_f32 v76, v74, v77
    v_and_b32 v74, 0xffff0000, v17
    v_and_b32 v77, 0xffff0000, v29
    v_fmac_f32 v76, v74, v77
    v_sub_f32 v52, v52, v72
    v_cvt_pk_bf16_f32 v52, v52, v52
    v_lshlrev_b32 v52, 16, v52
    v_mul_f32 v74, v52, v75
    v_fma_f32 v77, -v74, v73, v52
    v_fma_f32 v52, v77, v75, v74
    v_sub_f32 v62, v62, v72
    v_cvt_pk_bf16_f32 v62, v62, v62
    v_lshlrev_b32 v62, 16, v62
    v_mul_f32 v74, v62, v75
    v_fma_f32 v77, -v74, v73, v62
    v_fma_f32 v62, v77, v75, v74
    v_cvt_pk_bf16_f32 v18, v52, v62
    v_lshlrev_b32 v74, 16, v18
    v_lshlrev_b32 v77, 16, v30
    v_fmac_f32 v76, v74, v77
    v_and_b32 v74, 0xffff0000, v18
    v_and_b32 v77, 0xffff0000, v30
    v_fmac_f32 v76, v74, v77
    v_sub_f32 v53, v53, v72
    v_cvt_pk_bf16_f32 v53, v53, v53
    v_lshlrev_b32 v53, 16, v53
    v_mul_f32 v74, v53, v75
    v_fma_f32 v77, -v74, v73, v53
    v_fma_f32 v53, v77, v75, v74
    v_sub_f32 v63, v63, v72
    v_cvt_pk_bf16_f32 v63, v63, v63
    v_lshlrev_b32 v63, 16, v63
    v_mul_f32 v74, v63, v75
    v_fma_f32 v77, -v74, v73, v63
    v_fma_f32 v63, v77, v75, v74
    v_cvt_pk_bf16_f32 v19, v53, v63
    v_lshlrev_b32 v74, 16, v19
    v_lshlrev_b32 v77, 16, v31
    v_fmac_f32 v76, v74, v77
    v_and_b32 v74, 0xffff0000, v19
    v_and_b32 v77, 0xffff0000, v31
    v_fmac_f32 v76, v74, v77
    v_sub_f32 v54, v54, v72
    v_cvt_pk_bf16_f32 v54, v54, v54
    v_lshlrev_b32 v54, 16, v54
    v_mul_f32 v74, v54, v75
    v_fma_f32 v77, -v74, v73, v54
    v_fma_f32 v54, v77, v75, v74
    v_sub_f32 v64, v64, v72
    v_cvt_pk_bf16_f32 v64, v64, v64
    v_lshlrev_b32 v64, 16, v64
    v_mul_f32 v74, v64, v75
    v_fma_f32 v77, -v74, v73, v64
    v_fma_f32 v64, v77, v75, v74
    v_cvt_pk_bf16_f32 v20, v54, v64
    v_lshlrev_b32 v74, 16, v20
    v_lshlrev_b32 v77, 16, v32
    v_fmac_f32 v76, v74, v77
    v_and_b32 v74, 0xffff0000, v20
    v_and_b32 v77, 0xffff0000, v32
    v_fmac_f32 v76, v74, v77
    s_add_u32 s30, s34, 0x0
    buffer_store_dwordx4 v[16:19], v3, s[4:7], s30 offen sc1
    buffer_store_dword v20, v4, s[4:7], s30 offen offset:1024 sc1
    s_nop 1
    v_add_f32_dpp v76, v76, v76 quad_perm:[1,0,3,2] row_mask:0xf bank_mask:0xf
    s_nop 1
    v_add_f32_dpp v76, v76, v76 quad_perm:[2,3,0,1] row_mask:0xf bank_mask:0xf
    s_nop 1
    v_add_f32_dpp v76, v76, v76 row_half_mirror row_mask:0xf bank_mask:0xf
    s_nop 1
    v_add_f32_dpp v76, v76, v76 row_mirror row_mask:0xf bank_mask:0xf
    v_mov_b32 v71, v76
    s_nop 1
    v_permlane16_swap_b32 v76, v71
    v_add_f32 v76, v76, v71
    v_mov_b32 v71, v76
    s_nop 1
    v_permlane32_swap_b32 v76, v71
    v_add_f32 v76, v76, v71
    v_cvt_pk_bf16_f32 v76, v76, v76
    v_lshlrev_b32 v76, 16, v76
    s_lshl_b32 s30, s29, 2
    s_add_u32 s30, s30, 0x280000
    s_mov_b64 exec, 1
    buffer_store_dword v76, off, s[4:7], s30 sc1
    s_mov_b64 exec, -1
INR_103:
    s_add_u32 s29, s28, 2
    s_cmp_ge_u32 s29, 2048
    s_cbranch_scc1 INR_104
    v_lshlrev_b32 v50, 16, v22
    v_and_b32 v60, 0xffff0000, v22
    v_lshlrev_b32 v51, 16, v23
    v_and_b32 v61, 0xffff0000, v23
    v_lshlrev_b32 v52, 16, v24
    v_and_b32 v62, 0xffff0000, v24
    v_lshlrev_b32 v53, 16, v25
    v_and_b32 v63, 0xffff0000, v25
    v_lshlrev_b32 v54, 16, v26
    v_and_b32 v64, 0xffff0000, v26
    v_add_f32 v70, v50, v60
    v_add_f32 v70, v70, v51
    v_add_f32 v70, v70, v61
    v_add_f32 v70, v70, v52
    v_add_f32 v70, v70, v62
    v_add_f32 v70, v70, v53
    v_add_f32 v70, v70, v63
    v_add_f32 v70, v70, v54
    v_add_f32 v70, v70, v64
    s_nop 1
    v_add_f32_dpp v70, v70, v70 quad_perm:[1,0,3,2] row_mask:0xf bank_mask:0xf
    s_nop 1
    v_add_f32_dpp v70, v70, v70 quad_perm:[2,3,0,1] row_mask:0xf bank_mask:0xf
    s_nop 1
    v_add_f32_dpp v70, v70, v70 row_half_mirror row_mask:0xf bank_mask:0xf
    s_nop 1
    v_add_f32_dpp v70, v70, v70 row_mirror row_mask:0xf bank_mask:0xf
    v_mov_b32 v71, v70
    s_nop 1
    v_permlane16_swap_b32 v70, v71
    v_add_f32 v70, v70, v71
    v_mov_b32 v71, v70
    s_nop 1
    v_permlane32_swap_b32 v70, v71
    v_add_f32 v70, v70, v71
    v_mul_f32 v72, 0x3acccccd, v70
    v_mov_b32 v73, 0
    v_sub_f32 v74, v50, v72
    v_fmac_f32 v73, v74, v74
    v_sub_f32 v74, v60, v72
    v_fmac_f32 v73, v74, v74
    v_sub_f32 v74, v51, v72
    v_fmac_f32 v73, v74, v74
    v_sub_f32 v74, v61, v72
    v_fmac_f32 v73, v74, v74
    v_sub_f32 v74, v52, v72
    v_fmac_f32 v73, v74, v74
    v_sub_f32 v74, v62, v72
    v_fmac_f32 v73, v74, v74
    v_sub_f32 v74, v53, v72
    v_fmac_f32 v73, v74, v74
    v_sub_f32 v74, v63, v72
    v_fmac_f32 v73, v74, v74
    v_sub_f32 v74, v54, v72
    v_fmac_f32 v73, v74, v74
    v_sub_f32 v74, v64, v72
    v_fmac_f32 v73, v74, v74
    s_nop 1
    v_add_f32_dpp v73, v73, v73 quad_perm:[1,0,3,2] row_mask:0xf bank_mask:0xf
    s_nop 1
    v_add_f32_dpp v73, v73, v73 quad_perm:[2,3,0,1] row_mask:0xf bank_mask:0xf
    s_nop 1
    v_add_f32_dpp v73, v73, v73 row_half_mirror row_mask:0xf bank_mask:0xf
    s_nop 1
    v_add_f32_dpp v73, v73, v73 row_mirror row_mask:0xf bank_mask:0xf
    v_mov_b32 v71, v73
    s_nop 1
    v_permlane16_swap_b32 v73, v71
    v_add_f32 v73, v73, v71
    v_mov_b32 v71, v73
    s_nop 1
    v_permlane32_swap_b32 v73, v71
    v_add_f32 v73, v73, v71
    v_mul_f32 v73, 0x3acccccd, v73
    v_cvt_pk_bf16_f32 v72, v72, v72
    v_lshlrev_b32 v72, 16, v72
    v_cvt_pk_bf16_f32 v73, v73, v73
    v_lshlrev_b32 v73, 16, v73
    v_add_f32 v73, 0x3727c5ac, v73
    v_cvt_pk_bf16_f32 v73, v73, v73
    v_lshlrev_b32 v73, 16, v73
    v_sqrt_f32 v73, v73
    s_nop 0
    v_cvt_pk_bf16_f32 v73, v73, v73
    v_lshlrev_b32 v73, 16, v73
    v_rcp_f32 v75, v73
    s_nop 0
    v_mov_b32 v76, 0
    v_sub_f32 v50, v50, v72
    v_cvt_pk_bf16_f32 v50, v50, v50
    v_lshlrev_b32 v50, 16, v50
    v_mul_f32 v74, v50, v75
    v_fma_f32 v77, -v74, v73, v50
    v_fma_f32 v50, v77, v75, v74
    v_sub_f32 v60, v60, v72
    v_cvt_pk_bf16_f32 v60, v60, v60
    v_lshlrev_b32 v60, 16, v60
    v_mul_f32 v74, v60, v75
    v_fma_f32 v77, -v74, v73, v60
    v_fma_f32 v60, v77, v75, v74
    v_cvt_pk_bf16_f32 v22, v50, v60
    v_lshlrev_b32 v74, 16, v22
    v_lshlrev_b32 v77, 16, v28
    v_fmac_f32 v76, v74, v77
    v_and_b32 v74, 0xffff0000, v22
    v_and_b32 v77, 0xffff0000, v28
    v_fmac_f32 v76, v74, v77
    v_sub_f32 v51, v51, v72
    v_cvt_pk_bf16_f32 v51, v51, v51
    v_lshlrev_b32 v51, 16, v51
    v_mul_f32 v74, v51, v75
    v_fma_f32 v77, -v74, v73, v51
    v_fma_f32 v51, v77, v75, v74
    v_sub_f32 v61, v61, v72
    v_cvt_pk_bf16_f32 v61, v61, v61
    v_lshlrev_b32 v61, 16, v61
    v_mul_f32 v74, v61, v75
    v_fma_f32 v77, -v74, v73, v61
    v_fma_f32 v61, v77, v75, v74
    v_cvt_pk_bf16_f32 v23, v51, v61
    v_lshlrev_b32 v74, 16, v23
    v_lshlrev_b32 v77, 16, v29
    v_fmac_f32 v76, v74, v77
    v_and_b32 v74, 0xffff0000, v23
    v_and_b32 v77, 0xffff0000, v29
    v_fmac_f32 v76, v74, v77
    v_sub_f32 v52, v52, v72
    v_cvt_pk_bf16_f32 v52, v52, v52
    v_lshlrev_b32 v52, 16, v52
    v_mul_f32 v74, v52, v75
    v_fma_f32 v77, -v74, v73, v52
    v_fma_f32 v52, v77, v75, v74
    v_sub_f32 v62, v62, v72
    v_cvt_pk_bf16_f32 v62, v62, v62
    v_lshlrev_b32 v62, 16, v62
    v_mul_f32 v74, v62, v75
    v_fma_f32 v77, -v74, v73, v62
    v_fma_f32 v62, v77, v75, v74
    v_cvt_pk_bf16_f32 v24, v52, v62
    v_lshlrev_b32 v74, 16, v24
    v_lshlrev_b32 v77, 16, v30
    v_fmac_f32 v76, v74, v77
    v_and_b32 v74, 0xffff0000, v24
    v_and_b32 v77, 0xffff0000, v30
    v_fmac_f32 v76, v74, v77
    v_sub_f32 v53, v53, v72
    v_cvt_pk_bf16_f32 v53, v53, v53
    v_lshlrev_b32 v53, 16, v53
    v_mul_f32 v74, v53, v75
    v_fma_f32 v77, -v74, v73, v53
    v_fma_f32 v53, v77, v75, v74
    v_sub_f32 v63, v63, v72
    v_cvt_pk_bf16_f32 v63, v63, v63
    v_lshlrev_b32 v63, 16, v63
    v_mul_f32 v74, v63, v75
    v_fma_f32 v77, -v74, v73, v63
    v_fma_f32 v63, v77, v75, v74
    v_cvt_pk_bf16_f32 v25, v53, v63
    v_lshlrev_b32 v74, 16, v25
    v_lshlrev_b32 v77, 16, v31
    v_fmac_f32 v76, v74, v77
    v_and_b32 v74, 0xffff0000, v25
    v_and_b32 v77, 0xffff0000, v31
    v_fmac_f32 v76, v74, v77
    v_sub_f32 v54, v54, v72
    v_cvt_pk_bf16_f32 v54, v54, v54
    v_lshlrev_b32 v54, 16, v54
    v_mul_f32 v74, v54, v75
    v_fma_f32 v77, -v74, v73, v54
    v_fma_f32 v54, v77, v75, v74
    v_sub_f32 v64, v64, v72
    v_cvt_pk_bf16_f32 v64, v64, v64
    v_lshlrev_b32 v64, 16, v64
    v_mul_f32 v74, v64, v75
    v_fma_f32 v77, -v74, v73, v64
    v_fma_f32 v64, v77, v75, v74
    v_cvt_pk_bf16_f32 v26, v54, v64
    v_lshlrev_b32 v74, 16, v26
    v_lshlrev_b32 v77, 16, v32
    v_fmac_f32 v76, v74, v77
    v_and_b32 v74, 0xffff0000, v26
    v_and_b32 v77, 0xffff0000, v32
    v_fmac_f32 v76, v74, v77
    s_add_u32 s30, s35, 0x0
    buffer_store_dwordx4 v[22:25], v3, s[4:7], s30 offen sc1
    buffer_store_dword v26, v4, s[4:7], s30 offen offset:1024 sc1
    s_nop 1
    v_add_f32_dpp v76, v76, v76 quad_perm:[1,0,3,2] row_mask:0xf bank_mask:0xf
    s_nop 1
    v_add_f32_dpp v76, v76, v76 quad_perm:[2,3,0,1] row_mask:0xf bank_mask:0xf
    s_nop 1
    v_add_f32_dpp v76, v76, v76 row_half_mirror row_mask:0xf bank_mask:0xf
    s_nop 1
    v_add_f32_dpp v76, v76, v76 row_mirror row_mask:0xf bank_mask:0xf
    v_mov_b32 v71, v76
    s_nop 1
    v_permlane16_swap_b32 v76, v71
    v_add_f32 v76, v76, v71
    v_mov_b32 v71, v76
    s_nop 1
    v_permlane32_swap_b32 v76, v71
    v_add_f32 v76, v76, v71
    v_cvt_pk_bf16_f32 v76, v76, v76
    v_lshlrev_b32 v76, 16, v76
    s_lshl_b32 s30, s29, 2
    s_add_u32 s30, s30, 0x280000
    s_mov_b64 exec, 1
    buffer_store_dword v76, off, s[4:7], s30 sc1
    s_mov_b64 exec, -1
INR_104:
    s_lshl_b32 s29, s96, 2
    s_add_u32 s29, s29, s14
    s_lshl_b32 s29, s29, 6
    v_add_u32 v5, s29, v0
    v_lshlrev_b32 v6, 4, v5
    v_mov_b32 v44, 0
    v_mov_b32 v45, 0
    v_mov_b32 v46, 0
    v_mov_b32 v47, 0
    v_cmp_gt_u32 vcc, 0x1000, v5
    s_nop 0
    s_and_saveexec_b64 s[38:39], vcc
    s_cbranch_execz INF_105
    s_mov_b32 s30, 0x290000
    buffer_store_dwordx4 v[44:47], v6, s[4:7], s30 offen sc1
INF_105:
    s_mov_b64 exec, s[38:39]
    s_waitcnt vmcnt(0)
    s_barrier
    s_cmp_lg_u32 s14, 0
    s_cbranch_scc1 INA_106
    v_mov_b32 v8, 1
    s_mov_b64 exec, 1
    buffer_atomic_add v8, off, s[60:63], s95 sc1
    s_mov_b64 exec, -1
INA_106:
INP2_100:
    s_lshl_b32 s29, s96, 2
    s_add_u32 s29, s29, s14
    s_lshl_b32 s29, s29, 6
    v_add_u32 v5, s29, v0
    v_lshlrev_b32 v6, 4, v5
    v_mov_b32 v40, -1
    v_mov_b32 v41, -1
    v_mov_b32 v42, -1
    v_mov_b32 v43, -1
    v_cmp_gt_u32 vcc, 0x5000, v5
    s_nop 0
    s_and_saveexec_b64 s[38:39], vcc
    s_cbranch_execz INF_107
    s_mov_b32 s30, 0x300000
    buffer_store_dwordx4 v[40:43], v6, s[4:7], s30 offen sc1
INF_107:
    s_mov_b64 exec, s[38:39]
    v_lshrrev_b32 v7, 6, v5
    v_mul_u32_u24 v7, 52429, v7
    v_lshrrev_b32 v7, 18, v7
    v_mul_u32_u24 v8, 320, v7
    v_sub_u32 v8, v5, v8
    v_lshlrev_b32 v48, 4, v8
    v_lshl_add_u32 v49, v7, 13, v48
    v_cmp_gt_u32 vcc, 0xa000, v5
    s_nop 0
    s_and_saveexec_b64 s[38:39], vcc
    s_cbranch_execz INF_108
    s_mov_b32 s30, 0x5904000
    buffer_store_dwordx4 v[40:43], v49, s[4:7], s30 offen sc1
INF_108:
    s_mov_b64 exec, s[38:39]
    s_cmp_ge_u32 s96, 10
    s_cbranch_scc1 INM1_109
    s_cmp_lg_u32 s14, 0
    s_cbranch_scc1 INM1_109
    s_cmp_ge_u32 s96, 5
    s_cselect_b32 s36, 1, 0
    s_mul_i32 s29, s36, 5
    s_sub_u32 s29, s96, s29
    s_lshl_b32 s29, s29, 10
    s_lshl_b32 s30, s36, 13
    s_add_u32 s30, s30, 0x5900000
    s_add_u32 s30, s30, s29
    buffer_store_dwordx4 v[34:37], v3, s[4:7], s30 offen sc1
INM1_109:
    s_lshl_b32 s40, s13, 8
    s_lshl_b32 s42, s14, 17
    s_add_u32 s40, s40, s42
    s_mul_i32 s41, s14, 40960
    v_lshrrev_b32 v81, 4, v0
    v_lshlrev_b32 v79, 13, v81
    v_lshlrev_b32 v81, 1, v81
    v_and_b32 v82, 15, v0
    v_xor_b32 v81, v81, v82
    v_xor_b32 v82, 8, v81
    v_lshl_add_u32 v80, v82, 4, v79
    v_lshl_add_u32 v79, v81, 4, v79
    s_add_u32 m0, s41, 0
    s_add_u32 s42, s40, 0x0
    buffer_load_dwordx4 v79, s[44:47], s42 offen lds
    s_add_u32 m0, s41, 1024
    s_add_u32 s42, s40, 0x8000
    buffer_load_dwordx4 v79, s[44:47], s42 offen lds
    s_add_u32 m0, s41, 2048
    s_add_u32 s42, s40, 0x10000
    buffer_load_dwordx4 v80, s[44:47], s42 offen lds
    s_add_u32 m0, s41, 3072
    s_add_u32 s42, s40, 0x18000
    buffer_load_dwordx4 v80, s[44:47], s42 offen lds
    s_add_u32 m0, s41, 4096
    s_add_u32 s42, s40, 0x80000
    buffer_load_dwordx4 v79, s[44:47], s42 offen lds
    s_add_u32 m0, s41, 5120
    s_add_u32 s42, s40, 0x88000
    buffer_load_dwordx4 v79, s[44:47], s42 offen lds
    s_add_u32 m0, s41, 6144
    s_add_u32 s42, s40, 0x90000
    buffer_load_dwordx4 v80, s[44:47], s42 offen lds
    s_add_u32 m0, s41, 7168
    s_add_u32 s42, s40, 0x98000
    buffer_load_dwordx4 v80, s[44:47], s42 offen lds
    s_add_u32 m0, s41, 8192
    s_add_u32 s42, s40, 0x100000
    buffer_load_dwordx4 v79, s[44:47], s42 offen lds
    s_add_u32 m0, s41, 9216
    s_add_u32 s42, s40, 0x108000
    buffer_load_dwordx4 v79, s[44:47], s42 offen lds
    s_add_u32 m0, s41, 10240
    s_add_u32 s42, s40, 0x110000
    buffer_load_dwordx4 v80, s[44:47], s42 offen lds
    s_add_u32 m0, s41, 11264
    s_add_u32 s42, s40, 0x118000
    buffer_load_dwordx4 v80, s[44:47], s42 offen lds
    s_add_u32 m0, s41, 12288
    s_add_u32 s42, s40, 0x180000
    buffer_load_dwordx4 v79, s[44:47], s42 offen lds
    s_add_u32 m0, s41, 13312
    s_add_u32 s42, s40, 0x188000
    buffer_load_dwordx4 v79, s[44:47], s42 offen lds
    s_add_u32 m0, s41, 14336
    s_add_u32 s42, s40, 0x190000
    buffer_load_dwordx4 v80, s[44:47], s42 offen lds
    s_add_u32 m0, s41, 15360
    s_add_u32 s42, s40, 0x198000
    buffer_load_dwordx4 v80, s[44:47], s42 offen lds
    s_add_u32 m0, s41, 16384
    s_add_u32 s42, s40, 0x200000
    buffer_load_dwordx4 v79, s[44:47], s42 offen lds
    s_add_u32 m0, s41, 17408
    s_add_u32 s42, s40, 0x208000
    buffer_load_dwordx4 v79, s[44:47], s42 offen lds
    s_add_u32 m0, s41, 18432
    s_add_u32 s42, s40, 0x210000
    buffer_load_dwordx4 v80, s[44:47], s42 offen lds
    s_add_u32 m0, s41, 19456
    s_add_u32 s42, s40, 0x218000
    buffer_load_dwordx4 v80, s[44:47], s42 offen lds
    s_add_u32 m0, s41, 20480
    s_add_u32 s42, s40, 0x280000
    buffer_load_dwordx4 v79, s[44:47], s42 offen lds
    s_add_u32 m0, s41, 21504
    s_add_u32 s42, s40, 0x288000
    buffer_load_dwordx4 v79, s[44:47], s42 offen lds
    s_add_u32 m0, s41, 22528
    s_add_u32 s42, s40, 0x290000
    buffer_load_dwordx4 v80, s[44:47], s42 offen lds
    s_add_u32 m0, s41, 23552
    s_add_u32 s42, s40, 0x298000
    buffer_load_dwordx4 v80, s[44:47], s42 offen lds
    s_add_u32 m0, s41, 24576
    s_add_u32 s42, s40, 0x300000
    buffer_load_dwordx4 v79, s[44:47], s42 offen lds
    s_add_u32 m0, s41, 25600
    s_add_u32 s42, s40, 0x308000
    buffer_load_dwordx4 v79, s[44:47], s42 offen lds
    s_add_u32 m0, s41, 26624
    s_add_u32 s42, s40, 0x310000
    buffer_load_dwordx4 v80, s[44:47], s42 offen lds
    s_add_u32 m0, s41, 27648
    s_add_u32 s42, s40, 0x318000
    buffer_load_dwordx4 v80, s[44:47], s42 offen lds
    s_add_u32 m0, s41, 28672
    s_add_u32 s42, s40, 0x380000
    buffer_load_dwordx4 v79, s[44:47], s42 offen lds
    s_add_u32 m0, s41, 29696
    s_add_u32 s42, s40, 0x388000
    buffer_load_dwordx4 v79, s[44:47], s42 offen lds
    s_add_u32 m0, s41, 30720
    s_add_u32 s42, s40, 0x390000
    buffer_load_dwordx4 v80, s[44:47], s42 offen lds
    s_add_u32 m0, s41, 31744
    s_add_u32 s42, s40, 0x398000
    buffer_load_dwordx4 v80, s[44:47], s42 offen lds
    s_add_u32 m0, s41, 32768
    s_add_u32 s42, s40, 0x400000
    buffer_load_dwordx4 v79, s[44:47], s42 offen lds
    s_add_u32 m0, s41, 33792
    s_add_u32 s42, s40, 0x408000
    buffer_load_dwordx4 v79, s[44:47], s42 offen lds
    s_add_u32 m0, s41, 34816
    s_add_u32 s42, s40, 0x410000
    buffer_load_dwordx4 v80, s[44:47], s42 offen lds
    s_add_u32 m0, s41, 35840
    s_add_u32 s42, s40, 0x418000
    buffer_load_dwordx4 v80, s[44:47], s42 offen lds
    s_add_u32 m0, s41, 36864
    s_add_u32 s42, s40, 0x480000
    buffer_load_dwordx4 v79, s[44:47], s42 offen lds
    s_add_u32 m0, s41, 37888
    s_add_u32 s42, s40, 0x488000
    buffer_load_dwordx4 v79, s[44:47], s42 offen lds
    s_add_u32 m0, s41, 38912
    s_add_u32 s42, s40, 0x490000
    buffer_load_dwordx4 v80, s[44:47], s42 offen lds
    s_add_u32 m0, s41, 39936
    s_add_u32 s42, s40, 0x498000
    buffer_load_dwordx4 v80, s[44:47], s42 offen lds
    v_mbcnt_lo_u32_b32 v0, -1, 0
    v_mbcnt_hi_u32_b32 v0, -1, v0
    s_cmp_eq_u32 s3, 0
    s_cbranch_scc1 H_E0
    s_cmp_eq_u32 s3, 1
    s_cbranch_scc1 H_E1
    s_cmp_eq_u32 s3, 2
    s_cbranch_scc1 H_E2
    s_branch M_EXIT
H_E0:
    s_lshl_b32 s16, s13, 14
    s_mov_b32 s17, 0x80000
    s_lshl_b32 s64, s14, 10
    s_add_u32 s16, s16, 0x1400000
    s_add_u32 s16, s16, s64
    s_mul_i32 s64, s12, s17
    s_lshl_b32 s64, s64, 2
    s_add_u32 s16, s16, s64
    s_lshl_b32 s18, s13, 4
    s_add_u32 s18, s18, 0x291000
    s_branch G_T
H_E1:
    s_lshl_b32 s16, s13, 14
    s_mov_b32 s17, 0x80000
    s_lshl_b32 s64, s14, 11
    s_add_u32 s16, s16, 0x1402000
    s_add_u32 s16, s16, s64
    s_mul_i32 s64, s12, s17
    s_lshl_b32 s64, s64, 2
    s_add_u32 s16, s16, s64
    s_lshl_b32 s18, s13, 4
    s_add_u32 s18, s18, 0x291004
    s_branch G_N
H_E2:
    s_lshl_b32 s16, s13, 13
    s_mov_b32 s17, 0x40000
    s_lshl_b32 s64, s14, 10
    s_add_u32 s16, s16, 0x3400000
    s_add_u32 s16, s16, s64
    s_mul_i32 s64, s12, s17
    s_lshl_b32 s64, s64, 2
    s_add_u32 s16, s16, s64
    s_lshl_b32 s18, s13, 4
    s_add_u32 s18, s18, 0x291008
    s_branch G_T
G_T:
    v_lshrrev_b32 v6, 5, v0
    v_mul_u32_u24 v7, 40960, v6
    v_bfe_u32 v6, v0, 4, 1
    v_lshl_add_u32 v7, v6, 11, v7
    v_lshlrev_b32 v8, 3, v6
    v_bfe_u32 v6, v0, 2, 2
    v_lshl_add_u32 v7, v6, 8, v7
    v_lshl_add_u32 v8, v6, 1, v8
    v_and_b32 v6, 1, v0
    v_lshl_add_u32 v7, v6, 3, v7
    v_bfe_u32 v6, v0, 1, 1
    s_lshl_b32 s64, s14, 2
    v_add_u32 v10, s64, v6
    v_add_u32 v6, 0, v10
    v_xor_b32 v6, v6, v8
    v_lshl_add_u32 v3, v6, 4, v7
    v_add_u32 v4, 81920, v3
    v_add_u32 v6, 2, v10
    v_xor_b32 v6, v6, v8
    v_lshl_add_u32 v5, v6, 4, v7
    v_add_u32 v9, 81920, v5
    s_waitcnt vmcnt(0)
    s_barrier
    ds_read_b64_tr_b16 v[96:97], v3 offset:0
    ds_read_b64_tr_b16 v[98:99], v3 offset:1024
    ds_read_b64_tr_b16 v[100:101], v5 offset:0
    ds_read_b64_tr_b16 v[102:103], v5 offset:1024
    ds_read_b64_tr_b16 v[104:105], v4 offset:0
    ds_read_b64_tr_b16 v[106:107], v4 offset:1024
    ds_read_b64_tr_b16 v[108:109], v9 offset:0
    ds_read_b64_tr_b16 v[110:111], v9 offset:1024
    ds_read_b64_tr_b16 v[112:113], v3 offset:4096
    ds_read_b64_tr_b16 v[114:115], v3 offset:5120
    ds_read_b64_tr_b16 v[116:117], v5 offset:4096
    ds_read_b64_tr_b16 v[118:119], v5 offset:5120
    ds_read_b64_tr_b16 v[120:121], v4 offset:4096
    ds_read_b64_tr_b16 v[122:123], v4 offset:5120
    ds_read_b64_tr_b16 v[124:125], v9 offset:4096
    ds_read_b64_tr_b16 v[126:127], v9 offset:5120
    s_waitcnt lgkmcnt(4)
    ds_read_b64_tr_b16 v[128:129], v3 offset:8192
    ds_read_b64_tr_b16 v[130:131], v3 offset:9216
    ds_read_b64_tr_b16 v[132:133], v5 offset:8192
    ds_read_b64_tr_b16 v[134:135], v5 offset:9216
    ds_read_b64_tr_b16 v[136:137], v4 offset:8192
    ds_read_b64_tr_b16 v[138:139], v4 offset:9216
    ds_read_b64_tr_b16 v[140:141], v9 offset:8192
    ds_read_b64_tr_b16 v[142:143], v9 offset:9216
    ds_read_b64_tr_b16 v[144:145], v3 offset:12288
    ds_read_b64_tr_b16 v[146:147], v3 offset:13312
    ds_read_b64_tr_b16 v[148:149], v5 offset:12288
    ds_read_b64_tr_b16 v[150:151], v5 offset:13312
    ds_read_b64_tr_b16 v[152:153], v4 offset:12288
    ds_read_b64_tr_b16 v[154:155], v4 offset:13312
    ds_read_b64_tr_b16 v[156:157], v9 offset:12288
    ds_read_b64_tr_b16 v[158:159], v9 offset:13312
    s_waitcnt lgkmcnt(4)
    ds_read_b64_tr_b16 v[160:161], v3 offset:16384
    ds_read_b64_tr_b16 v[162:163], v3 offset:17408
    ds_read_b64_tr_b16 v[164:165], v5 offset:16384
    ds_read_b64_tr_b16 v[166:167], v5 offset:17408
    ds_read_b64_tr_b16 v[168:169], v4 offset:16384
    ds_read_b64_tr_b16 v[170:171], v4 offset:17408
    ds_read_b64_tr_b16 v[172:173], v9 offset:16384
    ds_read_b64_tr_b16 v[174:175], v9 offset:17408
    ds_read_b64_tr_b16 v[176:177], v3 offset:20480
    ds_read_b64_tr_b16 v[178:179], v3 offset:21504
    ds_read_b64_tr_b16 v[180:181], v5 offset:20480
    ds_read_b64_tr_b16 v[182:183], v5 offset:21504
    ds_read_b64_tr_b16 v[184:185], v4 offset:20480
    ds_read_b64_tr_b16 v[186:187], v4 offset:21504
    ds_read_b64_tr_b16 v[188:189], v9 offset:20480
    ds_read_b64_tr_b16 v[190:191], v9 offset:21504
    s_waitcnt lgkmcnt(4)
    ds_read_b64_tr_b16 v[192:193], v3 offset:24576
    ds_read_b64_tr_b16 v[194:195], v3 offset:25600
    ds_read_b64_tr_b16 v[196:197], v5 offset:24576
    ds_read_b64_tr_b16 v[198:199], v5 offset:25600
    ds_read_b64_tr_b16 v[200:201], v4 offset:24576
    ds_read_b64_tr_b16 v[202:203], v4 offset:25600
    ds_read_b64_tr_b16 v[204:205], v9 offset:24576
    ds_read_b64_tr_b16 v[206:207], v9 offset:25600
    ds_read_b64_tr_b16 v[208:209], v3 offset:28672
    ds_read_b64_tr_b16 v[210:211], v3 offset:29696
    ds_read_b64_tr_b16 v[212:213], v5 offset:28672
    ds_read_b64_tr_b16 v[214:215], v5 offset:29696
    ds_read_b64_tr_b16 v[216:217], v4 offset:28672
    ds_read_b64_tr_b16 v[218:219], v4 offset:29696
    ds_read_b64_tr_b16 v[220:221], v9 offset:28672
    ds_read_b64_tr_b16 v[222:223], v9 offset:29696
    s_waitcnt lgkmcnt(4)
    ds_read_b64_tr_b16 v[224:225], v3 offset:32768
    ds_read_b64_tr_b16 v[226:227], v3 offset:33792
    ds_read_b64_tr_b16 v[228:229], v5 offset:32768
    ds_read_b64_tr_b16 v[230:231], v5 offset:33792
    ds_read_b64_tr_b16 v[232:233], v4 offset:32768
    ds_read_b64_tr_b16 v[234:235], v4 offset:33792
    ds_read_b64_tr_b16 v[236:237], v9 offset:32768
    ds_read_b64_tr_b16 v[238:239], v9 offset:33792
    ds_read_b64_tr_b16 v[240:241], v3 offset:36864
    ds_read_b64_tr_b16 v[242:243], v3 offset:37888
    ds_read_b64_tr_b16 v[244:245], v5 offset:36864
    ds_read_b64_tr_b16 v[246:247], v5 offset:37888
    ds_read_b64_tr_b16 v[248:249], v4 offset:36864
    ds_read_b64_tr_b16 v[250:251], v4 offset:37888
    ds_read_b64_tr_b16 v[252:253], v9 offset:36864
    ds_read_b64_tr_b16 v[254:255], v9 offset:37888
    s_waitcnt lgkmcnt(0)
    s_cmp_lg_u32 s97, 0
    s_cbranch_scc1 CM_110
    v_mbcnt_lo_u32_b32 v0, -1, 0
    v_mbcnt_hi_u32_b32 v0, -1, v0
    v_mul_u32_u24 v8, 32, v0
    s_mov_b32 s64, 0x0
    s_mov_b32 s65, 0
    s_mov_b64 exec, 0xff
TK_111:
    buffer_load_dword v9, v8, s[60:63], s64 offen sc1
    s_add_u32 s65, s65, 1
    s_waitcnt vmcnt(0)
    s_mov_b32 s66, 0
    v_readlane_b32 s67, v9, 0
    s_add_u32 s66, s66, s67
    v_readlane_b32 s67, v9, 1
    s_add_u32 s66, s66, s67
    v_readlane_b32 s67, v9, 2
    s_add_u32 s66, s66, s67
    v_readlane_b32 s67, v9, 3
    s_add_u32 s66, s66, s67
    v_readlane_b32 s67, v9, 4
    s_add_u32 s66, s66, s67
    v_readlane_b32 s67, v9, 5
    s_add_u32 s66, s66, s67
    v_readlane_b32 s67, v9, 6
    s_add_u32 s66, s66, s67
    v_readlane_b32 s67, v9, 7
    s_add_u32 s66, s66, s67
    s_cmp_ge_u32 s66, 256
    s_cbranch_scc1 TKD_112
    s_cmp_gt_u32 s65, 262144
    s_cbranch_scc0 TK_111
TKD_112:
    v_cmp_ne_u32 vcc, 32, v9
    s_mov_b64 exec, -1
    s_cbranch_vccnz M_SLOW
CM_110:
    s_mov_b32 s65, 0
GI_113:
    buffer_load_dword v8, off, s[60:63], s95 sc1
    s_add_u32 s65, s65, 1
    s_waitcnt vmcnt(0)
    v_readfirstlane_b32 s64, v8
    s_cmp_ge_u32 s64, 186
    s_cbranch_scc1 GID_114
    s_cmp_gt_u32 s65, 65536
    s_cbranch_scc1 GID_114
    s_sleep 4
    s_branch GI_113
GID_114:
    v_mbcnt_lo_u32_b32 v0, -1, 0
    v_mbcnt_hi_u32_b32 v0, -1, v0
    s_mov_b32 s65, 0
CW_115:
    buffer_load_dwordx2 v[8:9], off, s[60:63], 0 offset:132 sc1
    s_add_u32 s65, s65, 1
    s_waitcnt vmcnt(0)
    v_readfirstlane_b32 s30, v8
    v_readfirstlane_b32 s31, v9
    s_min_u32 s64, s30, s31
    s_cmp_lg_u32 s64, 0
    s_cbranch_scc1 CWD_116
    s_cmp_gt_u32 s65, 65536
    s_cbranch_scc1 CWD_116
    s_sleep 4
    s_branch CW_115
CWD_116:
    s_sub_u32 s30, s30, 1
    s_and_b32 s30, s30, 3
    s_sub_u32 s31, s31, 1
    s_and_b32 s31, s31, 3
    s_lshl_b32 s34, s96, 2
    s_add_u32 s34, s34, s14
    s_lshl_b32 s34, s34, 6
    v_add_u32 v5, s34, v0
    v_lshlrev_b32 v3, 4, v0
    v_mov_b32 v40, -1
    v_mov_b32 v41, -1
    v_mov_b32 v42, -1
    v_mov_b32 v43, -1
    v_lshrrev_b32 v7, 6, v5
    v_mul_u32_u24 v7, 52429, v7
    v_lshrrev_b32 v7, 18, v7
    v_mul_u32_u24 v8, 320, v7
    v_sub_u32 v8, v5, v8
    v_lshlrev_b32 v48, 4, v8
    s_lshl_b32 s30, s30, 13
    s_lshl_b32 s31, s31, 13
    s_add_u32 s31, s31, 0x200000
    v_and_b32 v8, 1, v7
    v_cmp_eq_u32 vcc, 1, v8
    v_mov_b32 v8, s30
    v_mov_b32 v9, s31
    v_cndmask_b32 v8, v8, v9, vcc
    v_lshrrev_b32 v9, 1, v7
    v_lshl_add_u32 v8, v9, 15, v8
    v_add_u32 v49, v8, v48
    v_cmp_le_u32 vcc, 640, v5
    v_mov_b32 v9, 0x40000000
    s_nop 0
    v_cndmask_b32 v49, v9, v49, vcc
    v_cmp_gt_u32 vcc, 0xa000, v5
    s_nop 0
    s_and_saveexec_b64 s[38:39], vcc
    s_cbranch_execz INF_117
    s_mov_b32 s35, 0x6000000
    buffer_store_dwordx4 v[40:43], v49, s[4:7], s35 offen sc1
INF_117:
    s_mov_b64 exec, s[38:39]
    s_cmp_ge_u32 s96, 10
    s_cbranch_scc1 INM2_118
    s_cmp_lg_u32 s14, 1
    s_cbranch_scc1 INM2_118
    s_cmp_ge_u32 s96, 5
    s_cselect_b32 s36, 1, 0
    s_mul_i32 s34, s36, 5
    s_sub_u32 s34, s96, s34
    s_lshl_b32 s34, s34, 10
    s_cmp_eq_u32 s36, 0
    s_cselect_b32 s37, s30, s31
    s_add_u32 s37, s37, 0x6000000
    s_add_u32 s37, s37, s34
    buffer_store_dwordx4 v[34:37], v3, s[4:7], s37 offen sc1
INM2_118:
    s_cmp_lg_u32 s3, 2
    s_cbranch_scc1 NOSEL_119
    s_or_b32 s64, s13, s12
    s_or_b32 s64, s64, s14
    s_cmp_lg_u32 s64, 0
    s_cbranch_scc1 NOSEL_119
    s_mov_b32 s29, 0
    v_lshlrev_b32 v1, 4, v0
    s_mov_b32 s64, 0x280000
    buffer_load_dwordx4 v[16:19], v1, s[4:7], s64 offen offset:0 sc1
    buffer_load_dwordx4 v[20:23], v1, s[4:7], s64 offen offset:1024 sc1
    buffer_load_dwordx4 v[24:27], v1, s[4:7], s64 offen offset:2048 sc1
    buffer_load_dwordx4 v[28:31], v1, s[4:7], s64 offen offset:3072 sc1
    s_add_u32 s64, s64, 4096
    buffer_load_dwordx4 v[32:35], v1, s[4:7], s64 offen offset:0 sc1
    buffer_load_dwordx4 v[36:39], v1, s[4:7], s64 offen offset:1024 sc1
    buffer_load_dwordx4 v[40:43], v1, s[4:7], s64 offen offset:2048 sc1
    buffer_load_dwordx4 v[44:47], v1, s[4:7], s64 offen offset:3072 sc1
    s_waitcnt vmcnt(0)
    v_lshlrev_b32 v2, 2, v0
    v_ashrrev_i32 v3, 31, v16
    v_or_b32 v3, 0x80000000, v3
    v_xor_b32 v16, v16, v3
    v_and_b32 v16, 0xffff0000, v16
    v_sub_u32 v3, 65535, v2
    v_or_b32 v16, v16, v3
    v_ashrrev_i32 v3, 31, v17
    v_or_b32 v3, 0x80000000, v3
    v_xor_b32 v17, v17, v3
    v_and_b32 v17, 0xffff0000, v17
    v_sub_u32 v3, 65534, v2
    v_or_b32 v17, v17, v3
    v_ashrrev_i32 v3, 31, v18
    v_or_b32 v3, 0x80000000, v3
    v_xor_b32 v18, v18, v3
    v_and_b32 v18, 0xffff0000, v18
    v_sub_u32 v3, 65533, v2
    v_or_b32 v18, v18, v3
    v_ashrrev_i32 v3, 31, v19
    v_or_b32 v3, 0x80000000, v3
    v_xor_b32 v19, v19, v3
    v_and_b32 v19, 0xffff0000, v19
    v_sub_u32 v3, 65532, v2
    v_or_b32 v19, v19, v3
    v_ashrrev_i32 v3, 31, v20
    v_or_b32 v3, 0x80000000, v3
    v_xor_b32 v20, v20, v3
    v_and_b32 v20, 0xffff0000, v20
    v_sub_u32 v3, 65279, v2
    v_or_b32 v20, v20, v3
    v_ashrrev_i32 v3, 31, v21
    v_or_b32 v3, 0x80000000, v3
    v_xor_b32 v21, v21, v3
    v_and_b32 v21, 0xffff0000, v21
    v_sub_u32 v3, 65278, v2
    v_or_b32 v21, v21, v3
    v_ashrrev_i32 v3, 31, v22
    v_or_b32 v3, 0x80000000, v3
    v_xor_b32 v22, v22, v3
    v_and_b32 v22, 0xffff0000, v22
    v_sub_u32 v3, 65277, v2
    v_or_b32 v22, v22, v3
    v_ashrrev_i32 v3, 31, v23
    v_or_b32 v3, 0x80000000, v3
    v_xor_b32 v23, v23, v3
    v_and_b32 v23, 0xffff0000, v23
    v_sub_u32 v3, 65276, v2
    v_or_b32 v23, v23, v3
    v_ashrrev_i32 v3, 31, v24
    v_or_b32 v3, 0x80000000, v3
    v_xor_b32 v24, v24, v3
    v_and_b32 v24, 0xffff0000, v24
    v_sub_u32 v3, 65023, v2
    v_or_b32 v24, v24, v3
    v_ashrrev_i32 v3, 31, v25
    v_or_b32 v3, 0x80000000, v3
    v_xor_b32 v25, v25, v3
    v_and_b32 v25, 0xffff0000, v25
    v_sub_u32 v3, 65022, v2
    v_or_b32 v25, v25, v3
    v_ashrrev_i32 v3, 31, v26
    v_or_b32 v3, 0x80000000, v3
    v_xor_b32 v26, v26, v3
    v_and_b32 v26, 0xffff0000, v26
    v_sub_u32 v3, 65021, v2
    v_or_b32 v26, v26, v3
    v_ashrrev_i32 v3, 31, v27
    v_or_b32 v3, 0x80000000, v3
    v_xor_b32 v27, v27, v3
    v_and_b32 v27, 0xffff0000, v27
    v_sub_u32 v3, 65020, v2
    v_or_b32 v27, v27, v3
    v_ashrrev_i32 v3, 31, v28
    v_or_b32 v3, 0x80000000, v3
    v_xor_b32 v28, v28, v3
    v_and_b32 v28, 0xffff0000, v28
    v_sub_u32 v3, 64767, v2
    v_or_b32 v28, v28, v3
    v_ashrrev_i32 v3, 31, v29
    v_or_b32 v3, 0x80000000, v3
    v_xor_b32 v29, v29, v3
    v_and_b32 v29, 0xffff0000, v29
    v_sub_u32 v3, 64766, v2
    v_or_b32 v29, v29, v3
    v_ashrrev_i32 v3, 31, v30
    v_or_b32 v3, 0x80000000, v3
    v_xor_b32 v30, v30, v3
    v_and_b32 v30, 0xffff0000, v30
    v_sub_u32 v3, 64765, v2
    v_or_b32 v30, v30, v3
    v_ashrrev_i32 v3, 31, v31
    v_or_b32 v3, 0x80000000, v3
    v_xor_b32 v31, v31, v3
    v_and_b32 v31, 0xffff0000, v31
    v_sub_u32 v3, 64764, v2
    v_or_b32 v31, v31, v3
    v_ashrrev_i32 v3, 31, v32
    v_or_b32 v3, 0x80000000, v3
    v_xor_b32 v32, v32, v3
    v_and_b32 v32, 0xffff0000, v32
    v_sub_u32 v3, 64511, v2
    v_or_b32 v32, v32, v3
    v_ashrrev_i32 v3, 31, v33
    v_or_b32 v3, 0x80000000, v3
    v_xor_b32 v33, v33, v3
    v_and_b32 v33, 0xffff0000, v33
    v_sub_u32 v3, 64510, v2
    v_or_b32 v33, v33, v3
    v_ashrrev_i32 v3, 31, v34
    v_or_b32 v3, 0x80000000, v3
    v_xor_b32 v34, v34, v3
    v_and_b32 v34, 0xffff0000, v34
    v_sub_u32 v3, 64509, v2
    v_or_b32 v34, v34, v3
    v_ashrrev_i32 v3, 31, v35
    v_or_b32 v3, 0x80000000, v3
    v_xor_b32 v35, v35, v3
    v_and_b32 v35, 0xffff0000, v35
    v_sub_u32 v3, 64508, v2
    v_or_b32 v35, v35, v3
    v_ashrrev_i32 v3, 31, v36
    v_or_b32 v3, 0x80000000, v3
    v_xor_b32 v36, v36, v3
    v_and_b32 v36, 0xffff0000, v36
    v_sub_u32 v3, 64255, v2
    v_or_b32 v36, v36, v3
    v_ashrrev_i32 v3, 31, v37
    v_or_b32 v3, 0x80000000, v3
    v_xor_b32 v37, v37, v3
    v_and_b32 v37, 0xffff0000, v37
    v_sub_u32 v3, 64254, v2
    v_or_b32 v37, v37, v3
    v_ashrrev_i32 v3, 31, v38
    v_or_b32 v3, 0x80000000, v3
    v_xor_b32 v38, v38, v3
    v_and_b32 v38, 0xffff0000, v38
    v_sub_u32 v3, 64253, v2
    v_or_b32 v38, v38, v3
    v_ashrrev_i32 v3, 31, v39
    v_or_b32 v3, 0x80000000, v3
    v_xor_b32 v39, v39, v3
    v_and_b32 v39, 0xffff0000, v39
    v_sub_u32 v3, 64252, v2
    v_or_b32 v39, v39, v3
    v_ashrrev_i32 v3, 31, v40
    v_or_b32 v3, 0x80000000, v3
    v_xor_b32 v40, v40, v3
    v_and_b32 v40, 0xffff0000, v40
    v_sub_u32 v3, 63999, v2
    v_or_b32 v40, v40, v3
    v_ashrrev_i32 v3, 31, v41
    v_or_b32 v3, 0x80000000, v3
    v_xor_b32 v41, v41, v3
    v_and_b32 v41, 0xffff0000, v41
    v_sub_u32 v3, 63998, v2
    v_or_b32 v41, v41, v3
    v_ashrrev_i32 v3, 31, v42
    v_or_b32 v3, 0x80000000, v3
    v_xor_b32 v42, v42, v3
    v_and_b32 v42, 0xffff0000, v42
    v_sub_u32 v3, 63997, v2
    v_or_b32 v42, v42, v3
    v_ashrrev_i32 v3, 31, v43
    v_or_b32 v3, 0x80000000, v3
    v_xor_b32 v43, v43, v3
    v_and_b32 v43, 0xffff0000, v43
    v_sub_u32 v3, 63996, v2
    v_or_b32 v43, v43, v3
    v_ashrrev_i32 v3, 31, v44
    v_or_b32 v3, 0x80000000, v3
    v_xor_b32 v44, v44, v3
    v_and_b32 v44, 0xffff0000, v44
    v_sub_u32 v3, 63743, v2
    v_or_b32 v44, v44, v3
    v_ashrrev_i32 v3, 31, v45
    v_or_b32 v3, 0x80000000, v3
    v_xor_b32 v45, v45, v3
    v_and_b32 v45, 0xffff0000, v45
    v_sub_u32 v3, 63742, v2
    v_or_b32 v45, v45, v3
    v_ashrrev_i32 v3, 31, v46
    v_or_b32 v3, 0x80000000, v3
    v_xor_b32 v46, v46, v3
    v_and_b32 v46, 0xffff0000, v46
    v_sub_u32 v3, 63741, v2
    v_or_b32 v46, v46, v3
    v_ashrrev_i32 v3, 31, v47
    v_or_b32 v3, 0x80000000, v3
    v_xor_b32 v47, v47, v3
    v_and_b32 v47, 0xffff0000, v47
    v_sub_u32 v3, 63740, v2
    v_or_b32 v47, v47, v3
    v_max3_u32 v4, v16, v17, v18
    v_max3_u32 v4, v4, v19, v20
    v_max3_u32 v4, v4, v21, v22
    v_max3_u32 v4, v4, v23, v24
    v_max3_u32 v4, v4, v25, v26
    v_max3_u32 v4, v4, v27, v28
    v_max3_u32 v4, v4, v29, v30
    v_max3_u32 v4, v4, v31, v32
    v_max3_u32 v4, v4, v33, v34
    v_max3_u32 v4, v4, v35, v36
    v_max3_u32 v4, v4, v37, v38
    v_max3_u32 v4, v4, v39, v40
    v_max3_u32 v4, v4, v41, v42
    v_max3_u32 v4, v4, v43, v44
    v_max3_u32 v4, v4, v45, v46
    v_max_u32 v4, v4, v47
    s_nop 1
    v_max_u32_dpp v4, v4, v4 quad_perm:[1,0,3,2] row_mask:0xf bank_mask:0xf
    s_nop 1
    v_max_u32_dpp v4, v4, v4 quad_perm:[2,3,0,1] row_mask:0xf bank_mask:0xf
    s_nop 1
    v_max_u32_dpp v4, v4, v4 row_half_mirror row_mask:0xf bank_mask:0xf
    s_nop 1
    v_max_u32_dpp v4, v4, v4 row_mirror row_mask:0xf bank_mask:0xf
    v_mov_b32 v5, v4
    s_nop 1
    v_permlane16_swap_b32 v4, v5
    v_max_u32 v4, v4, v5
    v_mov_b32 v5, v4
    s_nop 1
    v_permlane32_swap_b32 v4, v5
    v_max_u32 v4, v4, v5
    v_mov_b32 v56, v4
    v_cmp_eq_u32 vcc, v4, v16
    s_nop 1
    v_cndmask_b32 v16, v16, 0, vcc
    v_cmp_eq_u32 vcc, v4, v17
    s_nop 1
    v_cndmask_b32 v17, v17, 0, vcc
    v_cmp_eq_u32 vcc, v4, v18
    s_nop 1
    v_cndmask_b32 v18, v18, 0, vcc
    v_cmp_eq_u32 vcc, v4, v19
    s_nop 1
    v_cndmask_b32 v19, v19, 0, vcc
    v_cmp_eq_u32 vcc, v4, v20
    s_nop 1
    v_cndmask_b32 v20, v20, 0, vcc
    v_cmp_eq_u32 vcc, v4, v21
    s_nop 1
    v_cndmask_b32 v21, v21, 0, vcc
    v_cmp_eq_u32 vcc, v4, v22
    s_nop 1
    v_cndmask_b32 v22, v22, 0, vcc
    v_cmp_eq_u32 vcc, v4, v23
    s_nop 1
    v_cndmask_b32 v23, v23, 0, vcc
    v_cmp_eq_u32 vcc, v4, v24
    s_nop 1
    v_cndmask_b32 v24, v24, 0, vcc
    v_cmp_eq_u32 vcc, v4, v25
    s_nop 1
    v_cndmask_b32 v25, v25, 0, vcc
    v_cmp_eq_u32 vcc, v4, v26
    s_nop 1
    v_cndmask_b32 v26, v26, 0, vcc
    v_cmp_eq_u32 vcc, v4, v27
    s_nop 1
    v_cndmask_b32 v27, v27, 0, vcc
    v_cmp_eq_u32 vcc, v4, v28
    s_nop 1
    v_cndmask_b32 v28, v28, 0, vcc
    v_cmp_eq_u32 vcc, v4, v29
    s_nop 1
    v_cndmask_b32 v29, v29, 0, vcc
    v_cmp_eq_u32 vcc, v4, v30
    s_nop 1
    v_cndmask_b32 v30, v30, 0, vcc
    v_cmp_eq_u32 vcc, v4, v31
    s_nop 1
    v_cndmask_b32 v31, v31, 0, vcc
    v_cmp_eq_u32 vcc, v4, v32
    s_nop 1
    v_cndmask_b32 v32, v32, 0, vcc
    v_cmp_eq_u32 vcc, v4, v33
    s_nop 1
    v_cndmask_b32 v33, v33, 0, vcc
    v_cmp_eq_u32 vcc, v4, v34
    s_nop 1
    v_cndmask_b32 v34, v34, 0, vcc
    v_cmp_eq_u32 vcc, v4, v35
    s_nop 1
    v_cndmask_b32 v35, v35, 0, vcc
    v_cmp_eq_u32 vcc, v4, v36
    s_nop 1
    v_cndmask_b32 v36, v36, 0, vcc
    v_cmp_eq_u32 vcc, v4, v37
    s_nop 1
    v_cndmask_b32 v37, v37, 0, vcc
    v_cmp_eq_u32 vcc, v4, v38
    s_nop 1
    v_cndmask_b32 v38, v38, 0, vcc
    v_cmp_eq_u32 vcc, v4, v39
    s_nop 1
    v_cndmask_b32 v39, v39, 0, vcc
    v_cmp_eq_u32 vcc, v4, v40
    s_nop 1
    v_cndmask_b32 v40, v40, 0, vcc
    v_cmp_eq_u32 vcc, v4, v41
    s_nop 1
    v_cndmask_b32 v41, v41, 0, vcc
    v_cmp_eq_u32 vcc, v4, v42
    s_nop 1
    v_cndmask_b32 v42, v42, 0, vcc
    v_cmp_eq_u32 vcc, v4, v43
    s_nop 1
    v_cndmask_b32 v43, v43, 0, vcc
    v_cmp_eq_u32 vcc, v4, v44
    s_nop 1
    v_cndmask_b32 v44, v44, 0, vcc
    v_cmp_eq_u32 vcc, v4, v45
    s_nop 1
    v_cndmask_b32 v45, v45, 0, vcc
    v_cmp_eq_u32 vcc, v4, v46
    s_nop 1
    v_cndmask_b32 v46, v46, 0, vcc
    v_cmp_eq_u32 vcc, v4, v47
    s_nop 1
    v_cndmask_b32 v47, v47, 0, vcc
    v_max3_u32 v4, v16, v17, v18
    v_max3_u32 v4, v4, v19, v20
    v_max3_u32 v4, v4, v21, v22
    v_max3_u32 v4, v4, v23, v24
    v_max3_u32 v4, v4, v25, v26
    v_max3_u32 v4, v4, v27, v28
    v_max3_u32 v4, v4, v29, v30
    v_max3_u32 v4, v4, v31, v32
    v_max3_u32 v4, v4, v33, v34
    v_max3_u32 v4, v4, v35, v36
    v_max3_u32 v4, v4, v37, v38
    v_max3_u32 v4, v4, v39, v40
    v_max3_u32 v4, v4, v41, v42
    v_max3_u32 v4, v4, v43, v44
    v_max3_u32 v4, v4, v45, v46
    v_max_u32 v4, v4, v47
    s_nop 1
    v_max_u32_dpp v4, v4, v4 quad_perm:[1,0,3,2] row_mask:0xf bank_mask:0xf
    s_nop 1
    v_max_u32_dpp v4, v4, v4 quad_perm:[2,3,0,1] row_mask:0xf bank_mask:0xf
    s_nop 1
    v_max_u32_dpp v4, v4, v4 row_half_mirror row_mask:0xf bank_mask:0xf
    s_nop 1
    v_max_u32_dpp v4, v4, v4 row_mirror row_mask:0xf bank_mask:0xf
    v_mov_b32 v5, v4
    s_nop 1
    v_permlane16_swap_b32 v4, v5
    v_max_u32 v4, v4, v5
    v_mov_b32 v5, v4
    s_nop 1
    v_permlane32_swap_b32 v4, v5
    v_max_u32 v4, v4, v5
    v_mov_b32 v57, v4
    v_cmp_eq_u32 vcc, v4, v16
    s_nop 1
    v_cndmask_b32 v16, v16, 0, vcc
    v_cmp_eq_u32 vcc, v4, v17
    s_nop 1
    v_cndmask_b32 v17, v17, 0, vcc
    v_cmp_eq_u32 vcc, v4, v18
    s_nop 1
    v_cndmask_b32 v18, v18, 0, vcc
    v_cmp_eq_u32 vcc, v4, v19
    s_nop 1
    v_cndmask_b32 v19, v19, 0, vcc
    v_cmp_eq_u32 vcc, v4, v20
    s_nop 1
    v_cndmask_b32 v20, v20, 0, vcc
    v_cmp_eq_u32 vcc, v4, v21
    s_nop 1
    v_cndmask_b32 v21, v21, 0, vcc
    v_cmp_eq_u32 vcc, v4, v22
    s_nop 1
    v_cndmask_b32 v22, v22, 0, vcc
    v_cmp_eq_u32 vcc, v4, v23
    s_nop 1
    v_cndmask_b32 v23, v23, 0, vcc
    v_cmp_eq_u32 vcc, v4, v24
    s_nop 1
    v_cndmask_b32 v24, v24, 0, vcc
    v_cmp_eq_u32 vcc, v4, v25
    s_nop 1
    v_cndmask_b32 v25, v25, 0, vcc
    v_cmp_eq_u32 vcc, v4, v26
    s_nop 1
    v_cndmask_b32 v26, v26, 0, vcc
    v_cmp_eq_u32 vcc, v4, v27
    s_nop 1
    v_cndmask_b32 v27, v27, 0, vcc
    v_cmp_eq_u32 vcc, v4, v28
    s_nop 1
    v_cndmask_b32 v28, v28, 0, vcc
    v_cmp_eq_u32 vcc, v4, v29
    s_nop 1
    v_cndmask_b32 v29, v29, 0, vcc
    v_cmp_eq_u32 vcc, v4, v30
    s_nop 1
    v_cndmask_b32 v30, v30, 0, vcc
    v_cmp_eq_u32 vcc, v4, v31
    s_nop 1
    v_cndmask_b32 v31, v31, 0, vcc
    v_cmp_eq_u32 vcc, v4, v32
    s_nop 1
    v_cndmask_b32 v32, v32, 0, vcc
    v_cmp_eq_u32 vcc, v4, v33
    s_nop 1
    v_cndmask_b32 v33, v33, 0, vcc
    v_cmp_eq_u32 vcc, v4, v34
    s_nop 1
    v_cndmask_b32 v34, v34, 0, vcc
    v_cmp_eq_u32 vcc, v4, v35
    s_nop 1
    v_cndmask_b32 v35, v35, 0, vcc
    v_cmp_eq_u32 vcc, v4, v36
    s_nop 1
    v_cndmask_b32 v36, v36, 0, vcc
    v_cmp_eq_u32 vcc, v4, v37
    s_nop 1
    v_cndmask_b32 v37, v37, 0, vcc
    v_cmp_eq_u32 vcc, v4, v38
    s_nop 1
    v_cndmask_b32 v38, v38, 0, vcc
    v_cmp_eq_u32 vcc, v4, v39
    s_nop 1
    v_cndmask_b32 v39, v39, 0, vcc
    v_cmp_eq_u32 vcc, v4, v40
    s_nop 1
    v_cndmask_b32 v40, v40, 0, vcc
    v_cmp_eq_u32 vcc, v4, v41
    s_nop 1
    v_cndmask_b32 v41, v41, 0, vcc
    v_cmp_eq_u32 vcc, v4, v42
    s_nop 1
    v_cndmask_b32 v42, v42, 0, vcc
    v_cmp_eq_u32 vcc, v4, v43
    s_nop 1
    v_cndmask_b32 v43, v43, 0, vcc
    v_cmp_eq_u32 vcc, v4, v44
    s_nop 1
    v_cndmask_b32 v44, v44, 0, vcc
    v_cmp_eq_u32 vcc, v4, v45
    s_nop 1
    v_cndmask_b32 v45, v45, 0, vcc
    v_cmp_eq_u32 vcc, v4, v46
    s_nop 1
    v_cndmask_b32 v46, v46, 0, vcc
    v_cmp_eq_u32 vcc, v4, v47
    s_nop 1
    v_cndmask_b32 v47, v47, 0, vcc
    v_max3_u32 v4, v16, v17, v18
    v_max3_u32 v4, v4, v19, v20
    v_max3_u32 v4, v4, v21, v22
    v_max3_u32 v4, v4, v23, v24
    v_max3_u32 v4, v4, v25, v26
    v_max3_u32 v4, v4, v27, v28
    v_max3_u32 v4, v4, v29, v30
    v_max3_u32 v4, v4, v31, v32
    v_max3_u32 v4, v4, v33, v34
    v_max3_u32 v4, v4, v35, v36
    v_max3_u32 v4, v4, v37, v38
    v_max3_u32 v4, v4, v39, v40
    v_max3_u32 v4, v4, v41, v42
    v_max3_u32 v4, v4, v43, v44
    v_max3_u32 v4, v4, v45, v46
    v_max_u32 v4, v4, v47
    s_nop 1
    v_max_u32_dpp v4, v4, v4 quad_perm:[1,0,3,2] row_mask:0xf bank_mask:0xf
    s_nop 1
    v_max_u32_dpp v4, v4, v4 quad_perm:[2,3,0,1] row_mask:0xf bank_mask:0xf
    s_nop 1
    v_max_u32_dpp v4, v4, v4 row_half_mirror row_mask:0xf bank_mask:0xf
    s_nop 1
    v_max_u32_dpp v4, v4, v4 row_mirror row_mask:0xf bank_mask:0xf
    v_mov_b32 v5, v4
    s_nop 1
    v_permlane16_swap_b32 v4, v5
    v_max_u32 v4, v4, v5
    v_mov_b32 v5, v4
    s_nop 1
    v_permlane32_swap_b32 v4, v5
    v_max_u32 v4, v4, v5
    v_mov_b32 v58, v4
    v_cmp_eq_u32 vcc, v4, v16
    s_nop 1
    v_cndmask_b32 v16, v16, 0, vcc
    v_cmp_eq_u32 vcc, v4, v17
    s_nop 1
    v_cndmask_b32 v17, v17, 0, vcc
    v_cmp_eq_u32 vcc, v4, v18
    s_nop 1
    v_cndmask_b32 v18, v18, 0, vcc
    v_cmp_eq_u32 vcc, v4, v19
    s_nop 1
    v_cndmask_b32 v19, v19, 0, vcc
    v_cmp_eq_u32 vcc, v4, v20
    s_nop 1
    v_cndmask_b32 v20, v20, 0, vcc
    v_cmp_eq_u32 vcc, v4, v21
    s_nop 1
    v_cndmask_b32 v21, v21, 0, vcc
    v_cmp_eq_u32 vcc, v4, v22
    s_nop 1
    v_cndmask_b32 v22, v22, 0, vcc
    v_cmp_eq_u32 vcc, v4, v23
    s_nop 1
    v_cndmask_b32 v23, v23, 0, vcc
    v_cmp_eq_u32 vcc, v4, v24
    s_nop 1
    v_cndmask_b32 v24, v24, 0, vcc
    v_cmp_eq_u32 vcc, v4, v25
    s_nop 1
    v_cndmask_b32 v25, v25, 0, vcc
    v_cmp_eq_u32 vcc, v4, v26
    s_nop 1
    v_cndmask_b32 v26, v26, 0, vcc
    v_cmp_eq_u32 vcc, v4, v27
    s_nop 1
    v_cndmask_b32 v27, v27, 0, vcc
    v_cmp_eq_u32 vcc, v4, v28
    s_nop 1
    v_cndmask_b32 v28, v28, 0, vcc
    v_cmp_eq_u32 vcc, v4, v29
    s_nop 1
    v_cndmask_b32 v29, v29, 0, vcc
    v_cmp_eq_u32 vcc, v4, v30
    s_nop 1
    v_cndmask_b32 v30, v30, 0, vcc
    v_cmp_eq_u32 vcc, v4, v31
    s_nop 1
    v_cndmask_b32 v31, v31, 0, vcc
    v_cmp_eq_u32 vcc, v4, v32
    s_nop 1
    v_cndmask_b32 v32, v32, 0, vcc
    v_cmp_eq_u32 vcc, v4, v33
    s_nop 1
    v_cndmask_b32 v33, v33, 0, vcc
    v_cmp_eq_u32 vcc, v4, v34
    s_nop 1
    v_cndmask_b32 v34, v34, 0, vcc
    v_cmp_eq_u32 vcc, v4, v35
    s_nop 1
    v_cndmask_b32 v35, v35, 0, vcc
    v_cmp_eq_u32 vcc, v4, v36
    s_nop 1
    v_cndmask_b32 v36, v36, 0, vcc
    v_cmp_eq_u32 vcc, v4, v37
    s_nop 1
    v_cndmask_b32 v37, v37, 0, vcc
    v_cmp_eq_u32 vcc, v4, v38
    s_nop 1
    v_cndmask_b32 v38, v38, 0, vcc
    v_cmp_eq_u32 vcc, v4, v39
    s_nop 1
    v_cndmask_b32 v39, v39, 0, vcc
    v_cmp_eq_u32 vcc, v4, v40
    s_nop 1
    v_cndmask_b32 v40, v40, 0, vcc
    v_cmp_eq_u32 vcc, v4, v41
    s_nop 1
    v_cndmask_b32 v41, v41, 0, vcc
    v_cmp_eq_u32 vcc, v4, v42
    s_nop 1
    v_cndmask_b32 v42, v42, 0, vcc
    v_cmp_eq_u32 vcc, v4, v43
    s_nop 1
    v_cndmask_b32 v43, v43, 0, vcc
    v_cmp_eq_u32 vcc, v4, v44
    s_nop 1
    v_cndmask_b32 v44, v44, 0, vcc
    v_cmp_eq_u32 vcc, v4, v45
    s_nop 1
    v_cndmask_b32 v45, v45, 0, vcc
    v_cmp_eq_u32 vcc, v4, v46
    s_nop 1
    v_cndmask_b32 v46, v46, 0, vcc
    v_cmp_eq_u32 vcc, v4, v47
    s_nop 1
    v_cndmask_b32 v47, v47, 0, vcc
    v_max3_u32 v4, v16, v17, v18
    v_max3_u32 v4, v4, v19, v20
    v_max3_u32 v4, v4, v21, v22
    v_max3_u32 v4, v4, v23, v24
    v_max3_u32 v4, v4, v25, v26
    v_max3_u32 v4, v4, v27, v28
    v_max3_u32 v4, v4, v29, v30
    v_max3_u32 v4, v4, v31, v32
    v_max3_u32 v4, v4, v33, v34
    v_max3_u32 v4, v4, v35, v36
    v_max3_u32 v4, v4, v37, v38
    v_max3_u32 v4, v4, v39, v40
    v_max3_u32 v4, v4, v41, v42
    v_max3_u32 v4, v4, v43, v44
    v_max3_u32 v4, v4, v45, v46
    v_max_u32 v4, v4, v47
    s_nop 1
    v_max_u32_dpp v4, v4, v4 quad_perm:[1,0,3,2] row_mask:0xf bank_mask:0xf
    s_nop 1
    v_max_u32_dpp v4, v4, v4 quad_perm:[2,3,0,1] row_mask:0xf bank_mask:0xf
    s_nop 1
    v_max_u32_dpp v4, v4, v4 row_half_mirror row_mask:0xf bank_mask:0xf
    s_nop 1
    v_max_u32_dpp v4, v4, v4 row_mirror row_mask:0xf bank_mask:0xf
    v_mov_b32 v5, v4
    s_nop 1
    v_permlane16_swap_b32 v4, v5
    v_max_u32 v4, v4, v5
    v_mov_b32 v5, v4
    s_nop 1
    v_permlane32_swap_b32 v4, v5
    v_max_u32 v4, v4, v5
    v_mov_b32 v59, v4
    v_cmp_eq_u32 vcc, v4, v16
    s_nop 1
    v_cndmask_b32 v16, v16, 0, vcc
    v_cmp_eq_u32 vcc, v4, v17
    s_nop 1
    v_cndmask_b32 v17, v17, 0, vcc
    v_cmp_eq_u32 vcc, v4, v18
    s_nop 1
    v_cndmask_b32 v18, v18, 0, vcc
    v_cmp_eq_u32 vcc, v4, v19
    s_nop 1
    v_cndmask_b32 v19, v19, 0, vcc
    v_cmp_eq_u32 vcc, v4, v20
    s_nop 1
    v_cndmask_b32 v20, v20, 0, vcc
    v_cmp_eq_u32 vcc, v4, v21
    s_nop 1
    v_cndmask_b32 v21, v21, 0, vcc
    v_cmp_eq_u32 vcc, v4, v22
    s_nop 1
    v_cndmask_b32 v22, v22, 0, vcc
    v_cmp_eq_u32 vcc, v4, v23
    s_nop 1
    v_cndmask_b32 v23, v23, 0, vcc
    v_cmp_eq_u32 vcc, v4, v24
    s_nop 1
    v_cndmask_b32 v24, v24, 0, vcc
    v_cmp_eq_u32 vcc, v4, v25
    s_nop 1
    v_cndmask_b32 v25, v25, 0, vcc
    v_cmp_eq_u32 vcc, v4, v26
    s_nop 1
    v_cndmask_b32 v26, v26, 0, vcc
    v_cmp_eq_u32 vcc, v4, v27
    s_nop 1
    v_cndmask_b32 v27, v27, 0, vcc
    v_cmp_eq_u32 vcc, v4, v28
    s_nop 1
    v_cndmask_b32 v28, v28, 0, vcc
    v_cmp_eq_u32 vcc, v4, v29
    s_nop 1
    v_cndmask_b32 v29, v29, 0, vcc
    v_cmp_eq_u32 vcc, v4, v30
    s_nop 1
    v_cndmask_b32 v30, v30, 0, vcc
    v_cmp_eq_u32 vcc, v4, v31
    s_nop 1
    v_cndmask_b32 v31, v31, 0, vcc
    v_cmp_eq_u32 vcc, v4, v32
    s_nop 1
    v_cndmask_b32 v32, v32, 0, vcc
    v_cmp_eq_u32 vcc, v4, v33
    s_nop 1
    v_cndmask_b32 v33, v33, 0, vcc
    v_cmp_eq_u32 vcc, v4, v34
    s_nop 1
    v_cndmask_b32 v34, v34, 0, vcc
    v_cmp_eq_u32 vcc, v4, v35
    s_nop 1
    v_cndmask_b32 v35, v35, 0, vcc
    v_cmp_eq_u32 vcc, v4, v36
    s_nop 1
    v_cndmask_b32 v36, v36, 0, vcc
    v_cmp_eq_u32 vcc, v4, v37
    s_nop 1
    v_cndmask_b32 v37, v37, 0, vcc
    v_cmp_eq_u32 vcc, v4, v38
    s_nop 1
    v_cndmask_b32 v38, v38, 0, vcc
    v_cmp_eq_u32 vcc, v4, v39
    s_nop 1
    v_cndmask_b32 v39, v39, 0, vcc
    v_cmp_eq_u32 vcc, v4, v40
    s_nop 1
    v_cndmask_b32 v40, v40, 0, vcc
    v_cmp_eq_u32 vcc, v4, v41
    s_nop 1
    v_cndmask_b32 v41, v41, 0, vcc
    v_cmp_eq_u32 vcc, v4, v42
    s_nop 1
    v_cndmask_b32 v42, v42, 0, vcc
    v_cmp_eq_u32 vcc, v4, v43
    s_nop 1
    v_cndmask_b32 v43, v43, 0, vcc
    v_cmp_eq_u32 vcc, v4, v44
    s_nop 1
    v_cndmask_b32 v44, v44, 0, vcc
    v_cmp_eq_u32 vcc, v4, v45
    s_nop 1
    v_cndmask_b32 v45, v45, 0, vcc
    v_cmp_eq_u32 vcc, v4, v46
    s_nop 1
    v_cndmask_b32 v46, v46, 0, vcc
    v_cmp_eq_u32 vcc, v4, v47
    s_nop 1
    v_cndmask_b32 v47, v47, 0, vcc
    v_max3_u32 v4, v16, v17, v18
    v_max3_u32 v4, v4, v19, v20
    v_max3_u32 v4, v4, v21, v22
    v_max3_u32 v4, v4, v23, v24
    v_max3_u32 v4, v4, v25, v26
    v_max3_u32 v4, v4, v27, v28
    v_max3_u32 v4, v4, v29, v30
    v_max3_u32 v4, v4, v31, v32
    v_max3_u32 v4, v4, v33, v34
    v_max3_u32 v4, v4, v35, v36
    v_max3_u32 v4, v4, v37, v38
    v_max3_u32 v4, v4, v39, v40
    v_max3_u32 v4, v4, v41, v42
    v_max3_u32 v4, v4, v43, v44
    v_max3_u32 v4, v4, v45, v46
    v_max_u32 v4, v4, v47
    s_nop 1
    v_max_u32_dpp v4, v4, v4 quad_perm:[1,0,3,2] row_mask:0xf bank_mask:0xf
    s_nop 1
    v_max_u32_dpp v4, v4, v4 quad_perm:[2,3,0,1] row_mask:0xf bank_mask:0xf
    s_nop 1
    v_max_u32_dpp v4, v4, v4 row_half_mirror row_mask:0xf bank_mask:0xf
    s_nop 1
    v_max_u32_dpp v4, v4, v4 row_mirror row_mask:0xf bank_mask:0xf
    v_mov_b32 v5, v4
    s_nop 1
    v_permlane16_swap_b32 v4, v5
    v_max_u32 v4, v4, v5
    v_mov_b32 v5, v4
    s_nop 1
    v_permlane32_swap_b32 v4, v5
    v_max_u32 v4, v4, v5
    v_mov_b32 v60, v4
    v_cmp_eq_u32 vcc, v4, v16
    s_nop 1
    v_cndmask_b32 v16, v16, 0, vcc
    v_cmp_eq_u32 vcc, v4, v17
    s_nop 1
    v_cndmask_b32 v17, v17, 0, vcc
    v_cmp_eq_u32 vcc, v4, v18
    s_nop 1
    v_cndmask_b32 v18, v18, 0, vcc
    v_cmp_eq_u32 vcc, v4, v19
    s_nop 1
    v_cndmask_b32 v19, v19, 0, vcc
    v_cmp_eq_u32 vcc, v4, v20
    s_nop 1
    v_cndmask_b32 v20, v20, 0, vcc
    v_cmp_eq_u32 vcc, v4, v21
    s_nop 1
    v_cndmask_b32 v21, v21, 0, vcc
    v_cmp_eq_u32 vcc, v4, v22
    s_nop 1
    v_cndmask_b32 v22, v22, 0, vcc
    v_cmp_eq_u32 vcc, v4, v23
    s_nop 1
    v_cndmask_b32 v23, v23, 0, vcc
    v_cmp_eq_u32 vcc, v4, v24
    s_nop 1
    v_cndmask_b32 v24, v24, 0, vcc
    v_cmp_eq_u32 vcc, v4, v25
    s_nop 1
    v_cndmask_b32 v25, v25, 0, vcc
    v_cmp_eq_u32 vcc, v4, v26
    s_nop 1
    v_cndmask_b32 v26, v26, 0, vcc
    v_cmp_eq_u32 vcc, v4, v27
    s_nop 1
    v_cndmask_b32 v27, v27, 0, vcc
    v_cmp_eq_u32 vcc, v4, v28
    s_nop 1
    v_cndmask_b32 v28, v28, 0, vcc
    v_cmp_eq_u32 vcc, v4, v29
    s_nop 1
    v_cndmask_b32 v29, v29, 0, vcc
    v_cmp_eq_u32 vcc, v4, v30
    s_nop 1
    v_cndmask_b32 v30, v30, 0, vcc
    v_cmp_eq_u32 vcc, v4, v31
    s_nop 1
    v_cndmask_b32 v31, v31, 0, vcc
    v_cmp_eq_u32 vcc, v4, v32
    s_nop 1
    v_cndmask_b32 v32, v32, 0, vcc
    v_cmp_eq_u32 vcc, v4, v33
    s_nop 1
    v_cndmask_b32 v33, v33, 0, vcc
    v_cmp_eq_u32 vcc, v4, v34
    s_nop 1
    v_cndmask_b32 v34, v34, 0, vcc
    v_cmp_eq_u32 vcc, v4, v35
    s_nop 1
    v_cndmask_b32 v35, v35, 0, vcc
    v_cmp_eq_u32 vcc, v4, v36
    s_nop 1
    v_cndmask_b32 v36, v36, 0, vcc
    v_cmp_eq_u32 vcc, v4, v37
    s_nop 1
    v_cndmask_b32 v37, v37, 0, vcc
    v_cmp_eq_u32 vcc, v4, v38
    s_nop 1
    v_cndmask_b32 v38, v38, 0, vcc
    v_cmp_eq_u32 vcc, v4, v39
    s_nop 1
    v_cndmask_b32 v39, v39, 0, vcc
    v_cmp_eq_u32 vcc, v4, v40
    s_nop 1
    v_cndmask_b32 v40, v40, 0, vcc
    v_cmp_eq_u32 vcc, v4, v41
    s_nop 1
    v_cndmask_b32 v41, v41, 0, vcc
    v_cmp_eq_u32 vcc, v4, v42
    s_nop 1
    v_cndmask_b32 v42, v42, 0, vcc
    v_cmp_eq_u32 vcc, v4, v43
    s_nop 1
    v_cndmask_b32 v43, v43, 0, vcc
    v_cmp_eq_u32 vcc, v4, v44
    s_nop 1
    v_cndmask_b32 v44, v44, 0, vcc
    v_cmp_eq_u32 vcc, v4, v45
    s_nop 1
    v_cndmask_b32 v45, v45, 0, vcc
    v_cmp_eq_u32 vcc, v4, v46
    s_nop 1
    v_cndmask_b32 v46, v46, 0, vcc
    v_cmp_eq_u32 vcc, v4, v47
    s_nop 1
    v_cndmask_b32 v47, v47, 0, vcc
    v_max3_u32 v4, v16, v17, v18
    v_max3_u32 v4, v4, v19, v20
    v_max3_u32 v4, v4, v21, v22
    v_max3_u32 v4, v4, v23, v24
    v_max3_u32 v4, v4, v25, v26
    v_max3_u32 v4, v4, v27, v28
    v_max3_u32 v4, v4, v29, v30
    v_max3_u32 v4, v4, v31, v32
    v_max3_u32 v4, v4, v33, v34
    v_max3_u32 v4, v4, v35, v36
    v_max3_u32 v4, v4, v37, v38
    v_max3_u32 v4, v4, v39, v40
    v_max3_u32 v4, v4, v41, v42
    v_max3_u32 v4, v4, v43, v44
    v_max3_u32 v4, v4, v45, v46
    v_max_u32 v4, v4, v47
    s_nop 1
    v_max_u32_dpp v4, v4, v4 quad_perm:[1,0,3,2] row_mask:0xf bank_mask:0xf
    s_nop 1
    v_max_u32_dpp v4, v4, v4 quad_perm:[2,3,0,1] row_mask:0xf bank_mask:0xf
    s_nop 1
    v_max_u32_dpp v4, v4, v4 row_half_mirror row_mask:0xf bank_mask:0xf
    s_nop 1
    v_max_u32_dpp v4, v4, v4 row_mirror row_mask:0xf bank_mask:0xf
    v_mov_b32 v5, v4
    s_nop 1
    v_permlane16_swap_b32 v4, v5
    v_max_u32 v4, v4, v5
    v_mov_b32 v5, v4
    s_nop 1
    v_permlane32_swap_b32 v4, v5
    v_max_u32 v4, v4, v5
    v_mov_b32 v61, v4
    v_cmp_eq_u32 vcc, v4, v16
    s_nop 1
    v_cndmask_b32 v16, v16, 0, vcc
    v_cmp_eq_u32 vcc, v4, v17
    s_nop 1
    v_cndmask_b32 v17, v17, 0, vcc
    v_cmp_eq_u32 vcc, v4, v18
    s_nop 1
    v_cndmask_b32 v18, v18, 0, vcc
    v_cmp_eq_u32 vcc, v4, v19
    s_nop 1
    v_cndmask_b32 v19, v19, 0, vcc
    v_cmp_eq_u32 vcc, v4, v20
    s_nop 1
    v_cndmask_b32 v20, v20, 0, vcc
    v_cmp_eq_u32 vcc, v4, v21
    s_nop 1
    v_cndmask_b32 v21, v21, 0, vcc
    v_cmp_eq_u32 vcc, v4, v22
    s_nop 1
    v_cndmask_b32 v22, v22, 0, vcc
    v_cmp_eq_u32 vcc, v4, v23
    s_nop 1
    v_cndmask_b32 v23, v23, 0, vcc
    v_cmp_eq_u32 vcc, v4, v24
    s_nop 1
    v_cndmask_b32 v24, v24, 0, vcc
    v_cmp_eq_u32 vcc, v4, v25
    s_nop 1
    v_cndmask_b32 v25, v25, 0, vcc
    v_cmp_eq_u32 vcc, v4, v26
    s_nop 1
    v_cndmask_b32 v26, v26, 0, vcc
    v_cmp_eq_u32 vcc, v4, v27
    s_nop 1
    v_cndmask_b32 v27, v27, 0, vcc
    v_cmp_eq_u32 vcc, v4, v28
    s_nop 1
    v_cndmask_b32 v28, v28, 0, vcc
    v_cmp_eq_u32 vcc, v4, v29
    s_nop 1
    v_cndmask_b32 v29, v29, 0, vcc
    v_cmp_eq_u32 vcc, v4, v30
    s_nop 1
    v_cndmask_b32 v30, v30, 0, vcc
    v_cmp_eq_u32 vcc, v4, v31
    s_nop 1
    v_cndmask_b32 v31, v31, 0, vcc
    v_cmp_eq_u32 vcc, v4, v32
    s_nop 1
    v_cndmask_b32 v32, v32, 0, vcc
    v_cmp_eq_u32 vcc, v4, v33
    s_nop 1
    v_cndmask_b32 v33, v33, 0, vcc
    v_cmp_eq_u32 vcc, v4, v34
    s_nop 1
    v_cndmask_b32 v34, v34, 0, vcc
    v_cmp_eq_u32 vcc, v4, v35
    s_nop 1
    v_cndmask_b32 v35, v35, 0, vcc
    v_cmp_eq_u32 vcc, v4, v36
    s_nop 1
    v_cndmask_b32 v36, v36, 0, vcc
    v_cmp_eq_u32 vcc, v4, v37
    s_nop 1
    v_cndmask_b32 v37, v37, 0, vcc
    v_cmp_eq_u32 vcc, v4, v38
    s_nop 1
    v_cndmask_b32 v38, v38, 0, vcc
    v_cmp_eq_u32 vcc, v4, v39
    s_nop 1
    v_cndmask_b32 v39, v39, 0, vcc
    v_cmp_eq_u32 vcc, v4, v40
    s_nop 1
    v_cndmask_b32 v40, v40, 0, vcc
    v_cmp_eq_u32 vcc, v4, v41
    s_nop 1
    v_cndmask_b32 v41, v41, 0, vcc
    v_cmp_eq_u32 vcc, v4, v42
    s_nop 1
    v_cndmask_b32 v42, v42, 0, vcc
    v_cmp_eq_u32 vcc, v4, v43
    s_nop 1
    v_cndmask_b32 v43, v43, 0, vcc
    v_cmp_eq_u32 vcc, v4, v44
    s_nop 1
    v_cndmask_b32 v44, v44, 0, vcc
    v_cmp_eq_u32 vcc, v4, v45
    s_nop 1
    v_cndmask_b32 v45, v45, 0, vcc
    v_cmp_eq_u32 vcc, v4, v46
    s_nop 1
    v_cndmask_b32 v46, v46, 0, vcc
    v_cmp_eq_u32 vcc, v4, v47
    s_nop 1
    v_cndmask_b32 v47, v47, 0, vcc
    v_max3_u32 v4, v16, v17, v18
    v_max3_u32 v4, v4, v19, v20
    v_max3_u32 v4, v4, v21, v22
    v_max3_u32 v4, v4, v23, v24
    v_max3_u32 v4, v4, v25, v26
    v_max3_u32 v4, v4, v27, v28
    v_max3_u32 v4, v4, v29, v30
    v_max3_u32 v4, v4, v31, v32
    v_max3_u32 v4, v4, v33, v34
    v_max3_u32 v4, v4, v35, v36
    v_max3_u32 v4, v4, v37, v38
    v_max3_u32 v4, v4, v39, v40
    v_max3_u32 v4, v4, v41, v42
    v_max3_u32 v4, v4, v43, v44
    v_max3_u32 v4, v4, v45, v46
    v_max_u32 v4, v4, v47
    s_nop 1
    v_max_u32_dpp v4, v4, v4 quad_perm:[1,0,3,2] row_mask:0xf bank_mask:0xf
    s_nop 1
    v_max_u32_dpp v4, v4, v4 quad_perm:[2,3,0,1] row_mask:0xf bank_mask:0xf
    s_nop 1
    v_max_u32_dpp v4, v4, v4 row_half_mirror row_mask:0xf bank_mask:0xf
    s_nop 1
    v_max_u32_dpp v4, v4, v4 row_mirror row_mask:0xf bank_mask:0xf
    v_mov_b32 v5, v4
    s_nop 1
    v_permlane16_swap_b32 v4, v5
    v_max_u32 v4, v4, v5
    v_mov_b32 v5, v4
    s_nop 1
    v_permlane32_swap_b32 v4, v5
    v_max_u32 v4, v4, v5
    v_mov_b32 v62, v4
    v_cmp_eq_u32 vcc, v4, v16
    s_nop 1
    v_cndmask_b32 v16, v16, 0, vcc
    v_cmp_eq_u32 vcc, v4, v17
    s_nop 1
    v_cndmask_b32 v17, v17, 0, vcc
    v_cmp_eq_u32 vcc, v4, v18
    s_nop 1
    v_cndmask_b32 v18, v18, 0, vcc
    v_cmp_eq_u32 vcc, v4, v19
    s_nop 1
    v_cndmask_b32 v19, v19, 0, vcc
    v_cmp_eq_u32 vcc, v4, v20
    s_nop 1
    v_cndmask_b32 v20, v20, 0, vcc
    v_cmp_eq_u32 vcc, v4, v21
    s_nop 1
    v_cndmask_b32 v21, v21, 0, vcc
    v_cmp_eq_u32 vcc, v4, v22
    s_nop 1
    v_cndmask_b32 v22, v22, 0, vcc
    v_cmp_eq_u32 vcc, v4, v23
    s_nop 1
    v_cndmask_b32 v23, v23, 0, vcc
    v_cmp_eq_u32 vcc, v4, v24
    s_nop 1
    v_cndmask_b32 v24, v24, 0, vcc
    v_cmp_eq_u32 vcc, v4, v25
    s_nop 1
    v_cndmask_b32 v25, v25, 0, vcc
    v_cmp_eq_u32 vcc, v4, v26
    s_nop 1
    v_cndmask_b32 v26, v26, 0, vcc
    v_cmp_eq_u32 vcc, v4, v27
    s_nop 1
    v_cndmask_b32 v27, v27, 0, vcc
    v_cmp_eq_u32 vcc, v4, v28
    s_nop 1
    v_cndmask_b32 v28, v28, 0, vcc
    v_cmp_eq_u32 vcc, v4, v29
    s_nop 1
    v_cndmask_b32 v29, v29, 0, vcc
    v_cmp_eq_u32 vcc, v4, v30
    s_nop 1
    v_cndmask_b32 v30, v30, 0, vcc
    v_cmp_eq_u32 vcc, v4, v31
    s_nop 1
    v_cndmask_b32 v31, v31, 0, vcc
    v_cmp_eq_u32 vcc, v4, v32
    s_nop 1
    v_cndmask_b32 v32, v32, 0, vcc
    v_cmp_eq_u32 vcc, v4, v33
    s_nop 1
    v_cndmask_b32 v33, v33, 0, vcc
    v_cmp_eq_u32 vcc, v4, v34
    s_nop 1
    v_cndmask_b32 v34, v34, 0, vcc
    v_cmp_eq_u32 vcc, v4, v35
    s_nop 1
    v_cndmask_b32 v35, v35, 0, vcc
    v_cmp_eq_u32 vcc, v4, v36
    s_nop 1
    v_cndmask_b32 v36, v36, 0, vcc
    v_cmp_eq_u32 vcc, v4, v37
    s_nop 1
    v_cndmask_b32 v37, v37, 0, vcc
    v_cmp_eq_u32 vcc, v4, v38
    s_nop 1
    v_cndmask_b32 v38, v38, 0, vcc
    v_cmp_eq_u32 vcc, v4, v39
    s_nop 1
    v_cndmask_b32 v39, v39, 0, vcc
    v_cmp_eq_u32 vcc, v4, v40
    s_nop 1
    v_cndmask_b32 v40, v40, 0, vcc
    v_cmp_eq_u32 vcc, v4, v41
    s_nop 1
    v_cndmask_b32 v41, v41, 0, vcc
    v_cmp_eq_u32 vcc, v4, v42
    s_nop 1
    v_cndmask_b32 v42, v42, 0, vcc
    v_cmp_eq_u32 vcc, v4, v43
    s_nop 1
    v_cndmask_b32 v43, v43, 0, vcc
    v_cmp_eq_u32 vcc, v4, v44
    s_nop 1
    v_cndmask_b32 v44, v44, 0, vcc
    v_cmp_eq_u32 vcc, v4, v45
    s_nop 1
    v_cndmask_b32 v45, v45, 0, vcc
    v_cmp_eq_u32 vcc, v4, v46
    s_nop 1
    v_cndmask_b32 v46, v46, 0, vcc
    v_cmp_eq_u32 vcc, v4, v47
    s_nop 1
    v_cndmask_b32 v47, v47, 0, vcc
    v_max3_u32 v4, v16, v17, v18
    v_max3_u32 v4, v4, v19, v20
    v_max3_u32 v4, v4, v21, v22
    v_max3_u32 v4, v4, v23, v24
    v_max3_u32 v4, v4, v25, v26
    v_max3_u32 v4, v4, v27, v28
    v_max3_u32 v4, v4, v29, v30
    v_max3_u32 v4, v4, v31, v32
    v_max3_u32 v4, v4, v33, v34
    v_max3_u32 v4, v4, v35, v36
    v_max3_u32 v4, v4, v37, v38
    v_max3_u32 v4, v4, v39, v40
    v_max3_u32 v4, v4, v41, v42
    v_max3_u32 v4, v4, v43, v44
    v_max3_u32 v4, v4, v45, v46
    v_max_u32 v4, v4, v47
    s_nop 1
    v_max_u32_dpp v4, v4, v4 quad_perm:[1,0,3,2] row_mask:0xf bank_mask:0xf
    s_nop 1
    v_max_u32_dpp v4, v4, v4 quad_perm:[2,3,0,1] row_mask:0xf bank_mask:0xf
    s_nop 1
    v_max_u32_dpp v4, v4, v4 row_half_mirror row_mask:0xf bank_mask:0xf
    s_nop 1
    v_max_u32_dpp v4, v4, v4 row_mirror row_mask:0xf bank_mask:0xf
    v_mov_b32 v5, v4
    s_nop 1
    v_permlane16_swap_b32 v4, v5
    v_max_u32 v4, v4, v5
    v_mov_b32 v5, v4
    s_nop 1
    v_permlane32_swap_b32 v4, v5
    v_max_u32 v4, v4, v5
    v_mov_b32 v63, v4
    v_mov_b32 v4, v56
    v_cmp_eq_u32 vcc, 1, v0
    s_nop 1
    v_cndmask_b32 v4, v4, v57, vcc
    v_cmp_eq_u32 vcc, 2, v0
    s_nop 1
    v_cndmask_b32 v4, v4, v58, vcc
    v_cmp_eq_u32 vcc, 3, v0
    s_nop 1
    v_cndmask_b32 v4, v4, v59, vcc
    v_cmp_eq_u32 vcc, 4, v0
    s_nop 1
    v_cndmask_b32 v4, v4, v60, vcc
    v_cmp_eq_u32 vcc, 5, v0
    s_nop 1
    v_cndmask_b32 v4, v4, v61, vcc
    v_cmp_eq_u32 vcc, 6, v0
    s_nop 1
    v_cndmask_b32 v4, v4, v62, vcc
    v_cmp_eq_u32 vcc, 7, v0
    s_nop 1
    v_cndmask_b32 v4, v4, v63, vcc
    v_and_b32 v5, 0xffff, v4
    v_sub_u32 v5, 0xffff, v5
    v_and_b32 v4, 0xffff0000, v4
    v_ashrrev_i32 v3, 31, v4
    v_not_b32 v3, v3
    v_or_b32 v3, 0x80000000, v3
    v_xor_b32 v4, v4, v3
    v_and_b32 v4, 0xffff0000, v4
    v_mul_f32 v4, 0xbfb8aa3b, v4
    v_exp_f32 v4, v4
    s_nop 0
    v_add_f32 v4, 1.0, v4
    v_rcp_f32 v4, v4
    s_nop 0
    v_cvt_pk_bf16_f32 v4, v4, v4
    v_lshlrev_b32 v4, 16, v4
    v_lshlrev_b32 v6, 2, v0
    s_mov_b32 s64, 0x5400000
    s_mov_b64 exec, 0xff
    buffer_store_dword v5, v6, s[4:7], s64 offen sc1
    buffer_store_dword v4, v6, s[4:7], s64 offen offset:32 sc1
    s_mov_b64 exec, -1
    s_waitcnt vmcnt(0)
    v_mov_b32 v7, 1
    v_mov_b32 v8, 0
    s_mov_b32 s64, 0x298000
    s_mov_b64 exec, 1
    buffer_atomic_add v7, v8, s[4:7], s64 offen sc1
    s_mov_b64 exec, -1
    v_mbcnt_lo_u32_b32 v0, -1, 0
    v_mbcnt_hi_u32_b32 v0, -1, v0
NOSEL_119:
    v_lshlrev_b32 v1, 4, v0
    v_lshrrev_b32 v6, 3, v0
    v_mul_u32_u24 v2, 1280, v6
    v_and_b32 v7, 7, v0
    v_xor_b32 v7, v7, v6
    v_lshl_add_u32 v2, v7, 4, v2
    v_bfe_u32 v6, v0, 3, 1
    v_lshlrev_b32 v9, 10, v6
    v_and_b32 v6, 7, v0
    v_lshl_add_u32 v9, v6, 7, v9
    v_lshrrev_b32 v7, 4, v0
    v_xor_b32 v7, v7, v6
    v_lshl_add_u32 v3, v7, 4, v9
    v_xor_b32 v7, 4, v7
    v_lshl_add_u32 v4, v7, 4, v9
    v_add_u32 v6, 0x10000, v3
    v_add_u32 v9, 0x10000, v4
    s_barrier
    s_mul_i32 s20, s12, 163840
    s_mul_i32 s64, s14, 40960
    s_add_u32 s20, s20, s64
    s_add_u32 s20, s20, 0x0
    s_lshl_b32 s21, s14, 12
    s_add_u32 m0, s21, 0
    s_add_u32 s64, s20, 0x0
    buffer_load_dwordx4 v2, s[4:7], s64 offen lds
    s_add_u32 m0, s21, 1024
    s_add_u32 s64, s20, 0x2800
    buffer_load_dwordx4 v2, s[4:7], s64 offen lds
    s_add_u32 m0, s21, 2048
    s_add_u32 s64, s20, 0x5000
    buffer_load_dwordx4 v2, s[4:7], s64 offen lds
    s_add_u32 m0, s21, 3072
    s_add_u32 s64, s20, 0x7800
    buffer_load_dwordx4 v2, s[4:7], s64 offen lds
    s_add_u32 m0, s21, 16384
    s_add_u32 s64, s20, 0x80
    buffer_load_dwordx4 v2, s[4:7], s64 offen lds
    s_add_u32 m0, s21, 17408
    s_add_u32 s64, s20, 0x2880
    buffer_load_dwordx4 v2, s[4:7], s64 offen lds
    s_add_u32 m0, s21, 18432
    s_add_u32 s64, s20, 0x5080
    buffer_load_dwordx4 v2, s[4:7], s64 offen lds
    s_add_u32 m0, s21, 19456
    s_add_u32 s64, s20, 0x7880
    buffer_load_dwordx4 v2, s[4:7], s64 offen lds
    s_add_u32 m0, s21, 32768
    s_add_u32 s64, s20, 0x100
    buffer_load_dwordx4 v2, s[4:7], s64 offen lds
    s_add_u32 m0, s21, 33792
    s_add_u32 s64, s20, 0x2900
    buffer_load_dwordx4 v2, s[4:7], s64 offen lds
    s_add_u32 m0, s21, 34816
    s_add_u32 s64, s20, 0x5100
    buffer_load_dwordx4 v2, s[4:7], s64 offen lds
    s_add_u32 m0, s21, 35840
    s_add_u32 s64, s20, 0x7900
    buffer_load_dwordx4 v2, s[4:7], s64 offen lds
    s_add_u32 m0, s21, 49152
    s_add_u32 s64, s20, 0x180
    buffer_load_dwordx4 v2, s[4:7], s64 offen lds
    s_add_u32 m0, s21, 50176
    s_add_u32 s64, s20, 0x2980
    buffer_load_dwordx4 v2, s[4:7], s64 offen lds
    s_add_u32 m0, s21, 51200
    s_add_u32 s64, s20, 0x5180
    buffer_load_dwordx4 v2, s[4:7], s64 offen lds
    s_add_u32 m0, s21, 52224
    s_add_u32 s64, s20, 0x7980
    buffer_load_dwordx4 v2, s[4:7], s64 offen lds
    s_mov_b32 s64, 0x40000000
    buffer_store_dword v7, v1, s[4:7], s64 offen
    buffer_store_dword v7, v1, s[4:7], s64 offen
    buffer_store_dword v7, v1, s[4:7], s64 offen
    buffer_store_dword v7, v1, s[4:7], s64 offen
    buffer_store_dword v7, v1, s[4:7], s64 offen
    buffer_store_dword v7, v1, s[4:7], s64 offen
    buffer_store_dword v7, v1, s[4:7], s64 offen
    buffer_store_dword v7, v1, s[4:7], s64 offen
    s_waitcnt vmcnt(20)
    s_barrier
    ds_read_b128 a[0:3], v3 offset:0
    ds_read_b128 a[4:7], v3 offset:2048
    ds_read_b128 a[8:11], v3 offset:4096
    ds_read_b128 a[12:15], v3 offset:6144
    ds_read_b128 a[16:19], v3 offset:8192
    ds_read_b128 a[20:23], v3 offset:10240
    ds_read_b128 a[24:27], v3 offset:12288
    ds_read_b128 a[28:31], v3 offset:14336
    s_mov_b32 s19, 0
    s_mov_b32 s22, s16
    s_mov_b32 s23, 0x40000000
G_T_LOOP:
    s_waitcnt lgkmcnt(4)
    v_mfma_f32_16x16x32_bf16 v[16:19], v[96:99], a[0:3], 0
    v_mfma_f32_16x16x32_bf16 v[20:23], v[100:103], a[0:3], 0
    ds_read_b128 a[32:35], v4 offset:0
    v_mfma_f32_16x16x32_bf16 v[24:27], v[96:99], a[4:7], 0
    v_mfma_f32_16x16x32_bf16 v[28:31], v[100:103], a[4:7], 0
    ds_read_b128 a[36:39], v4 offset:2048
    v_mfma_f32_16x16x32_bf16 v[32:35], v[96:99], a[8:11], 0
    v_mfma_f32_16x16x32_bf16 v[36:39], v[100:103], a[8:11], 0
    ds_read_b128 a[40:43], v4 offset:4096
    v_mfma_f32_16x16x32_bf16 v[40:43], v[96:99], a[12:15], 0
    v_mfma_f32_16x16x32_bf16 v[44:47], v[100:103], a[12:15], 0
    ds_read_b128 a[44:47], v4 offset:6144
    s_waitcnt lgkmcnt(4)
    v_mfma_f32_16x16x32_bf16 v[48:51], v[96:99], a[16:19], 0
    v_mfma_f32_16x16x32_bf16 v[52:55], v[100:103], a[16:19], 0
    ds_read_b128 a[48:51], v4 offset:8192
    v_mfma_f32_16x16x32_bf16 v[56:59], v[96:99], a[20:23], 0
    v_mfma_f32_16x16x32_bf16 v[60:63], v[100:103], a[20:23], 0
    ds_read_b128 a[52:55], v4 offset:10240
    v_mfma_f32_16x16x32_bf16 v[64:67], v[96:99], a[24:27], 0
    v_mfma_f32_16x16x32_bf16 v[68:71], v[100:103], a[24:27], 0
    ds_read_b128 a[56:59], v4 offset:12288
    v_mfma_f32_16x16x32_bf16 v[72:75], v[96:99], a[28:31], 0
    v_mfma_f32_16x16x32_bf16 v[76:79], v[100:103], a[28:31], 0
    ds_read_b128 a[60:63], v4 offset:14336
    s_waitcnt vmcnt(16)
    s_barrier
    s_waitcnt lgkmcnt(4)
    v_mfma_f32_16x16x32_bf16 v[16:19], v[104:107], a[32:35], v[16:19]
    v_mfma_f32_16x16x32_bf16 v[20:23], v[108:111], a[32:35], v[20:23]
    ds_read_b128 a[0:3], v3 offset:16384
    s_add_u32 m0, s21, 65536
    v_mfma_f32_16x16x32_bf16 v[24:27], v[104:107], a[36:39], v[24:27]
    v_mfma_f32_16x16x32_bf16 v[28:31], v[108:111], a[36:39], v[28:31]
    ds_read_b128 a[4:7], v3 offset:18432
    s_add_u32 s64, s20, 0x200
    buffer_load_dwordx4 v2, s[4:7], s64 offen lds
    v_mfma_f32_16x16x32_bf16 v[32:35], v[104:107], a[40:43], v[32:35]
    v_mfma_f32_16x16x32_bf16 v[36:39], v[108:111], a[40:43], v[36:39]
    ds_read_b128 a[8:11], v3 offset:20480
    s_add_u32 m0, s21, 66560
    v_mfma_f32_16x16x32_bf16 v[40:43], v[104:107], a[44:47], v[40:43]
    v_mfma_f32_16x16x32_bf16 v[44:47], v[108:111], a[44:47], v[44:47]
    ds_read_b128 a[12:15], v3 offset:22528
    s_add_u32 s64, s20, 0x2a00
    buffer_load_dwordx4 v2, s[4:7], s64 offen lds
    s_waitcnt lgkmcnt(4)
    v_mfma_f32_16x16x32_bf16 v[48:51], v[104:107], a[48:51], v[48:51]
    v_mfma_f32_16x16x32_bf16 v[52:55], v[108:111], a[48:51], v[52:55]
    ds_read_b128 a[16:19], v3 offset:24576
    s_add_u32 m0, s21, 67584
    v_mfma_f32_16x16x32_bf16 v[56:59], v[104:107], a[52:55], v[56:59]
    v_mfma_f32_16x16x32_bf16 v[60:63], v[108:111], a[52:55], v[60:63]
    ds_read_b128 a[20:23], v3 offset:26624
    s_add_u32 s64, s20, 0x5200
    buffer_load_dwordx4 v2, s[4:7], s64 offen lds
    v_mfma_f32_16x16x32_bf16 v[64:67], v[104:107], a[56:59], v[64:67]
    v_mfma_f32_16x16x32_bf16 v[68:71], v[108:111], a[56:59], v[68:71]
    ds_read_b128 a[24:27], v3 offset:28672
    s_add_u32 m0, s21, 68608
    v_mfma_f32_16x16x32_bf16 v[72:75], v[104:107], a[60:63], v[72:75]
    v_mfma_f32_16x16x32_bf16 v[76:79], v[108:111], a[60:63], v[76:79]
    ds_read_b128 a[28:31], v3 offset:30720
    s_add_u32 s64, s20, 0x7a00
    buffer_load_dwordx4 v2, s[4:7], s64 offen lds
    s_waitcnt lgkmcnt(4)
    v_mfma_f32_16x16x32_bf16 v[16:19], v[112:115], a[0:3], v[16:19]
    v_mfma_f32_16x16x32_bf16 v[20:23], v[116:119], a[0:3], v[20:23]
    ds_read_b128 a[32:35], v4 offset:16384
    v_mfma_f32_16x16x32_bf16 v[24:27], v[112:115], a[4:7], v[24:27]
    v_mfma_f32_16x16x32_bf16 v[28:31], v[116:119], a[4:7], v[28:31]
    ds_read_b128 a[36:39], v4 offset:18432
    v_mfma_f32_16x16x32_bf16 v[32:35], v[112:115], a[8:11], v[32:35]
    v_mfma_f32_16x16x32_bf16 v[36:39], v[116:119], a[8:11], v[36:39]
    ds_read_b128 a[40:43], v4 offset:20480
    v_mfma_f32_16x16x32_bf16 v[40:43], v[112:115], a[12:15], v[40:43]
    v_mfma_f32_16x16x32_bf16 v[44:47], v[116:119], a[12:15], v[44:47]
    ds_read_b128 a[44:47], v4 offset:22528
    s_waitcnt lgkmcnt(4)
    v_mfma_f32_16x16x32_bf16 v[48:51], v[112:115], a[16:19], v[48:51]
    v_mfma_f32_16x16x32_bf16 v[52:55], v[116:119], a[16:19], v[52:55]
    ds_read_b128 a[48:51], v4 offset:24576
    v_mfma_f32_16x16x32_bf16 v[56:59], v[112:115], a[20:23], v[56:59]
    v_mfma_f32_16x16x32_bf16 v[60:63], v[116:119], a[20:23], v[60:63]
    ds_read_b128 a[52:55], v4 offset:26624
    v_mfma_f32_16x16x32_bf16 v[64:67], v[112:115], a[24:27], v[64:67]
    v_mfma_f32_16x16x32_bf16 v[68:71], v[116:119], a[24:27], v[68:71]
    ds_read_b128 a[56:59], v4 offset:28672
    v_mfma_f32_16x16x32_bf16 v[72:75], v[112:115], a[28:31], v[72:75]
    v_mfma_f32_16x16x32_bf16 v[76:79], v[116:119], a[28:31], v[76:79]
    ds_read_b128 a[60:63], v4 offset:30720
    s_waitcnt vmcnt(16)
    s_barrier
    s_cmp_lg_u32 s19, 0
    s_cbranch_scc1 GFD_120
    s_cmp_lg_u32 s14, 0
    s_cbranch_scc1 INE_121
    s_cmp_lg_u32 s96, 10
    s_cbranch_scc1 ING_122
    v_mov_b32 v7, 1
    v_lshlrev_b32 v8, 7, v0
    s_mov_b32 s65, 0x29a000
    s_mov_b64 exec, 3
    buffer_store_dword v7, v8, s[4:7], s65 offen sc1
    s_mov_b64 exec, -1
    s_waitcnt vmcnt(0)
ING_122:
    v_mov_b32 v8, 1
    s_mov_b32 s65, 0x290800
    s_mov_b64 exec, 1
    buffer_atomic_add v8, off, s[4:7], s65 sc1
    s_mov_b64 exec, -1
INE_121:
GFD_120:
    s_waitcnt lgkmcnt(4)
    v_mfma_f32_16x16x32_bf16 v[16:19], v[120:123], a[32:35], v[16:19]
    v_mfma_f32_16x16x32_bf16 v[20:23], v[124:127], a[32:35], v[20:23]
    ds_read_b128 a[0:3], v3 offset:32768
    s_add_u32 m0, s21, 0
    v_mfma_f32_16x16x32_bf16 v[24:27], v[120:123], a[36:39], v[24:27]
    v_mfma_f32_16x16x32_bf16 v[28:31], v[124:127], a[36:39], v[28:31]
    ds_read_b128 a[4:7], v3 offset:34816
    s_add_u32 s64, s20, 0x280
    buffer_load_dwordx4 v2, s[4:7], s64 offen lds
    v_mfma_f32_16x16x32_bf16 v[32:35], v[120:123], a[40:43], v[32:35]
    v_mfma_f32_16x16x32_bf16 v[36:39], v[124:127], a[40:43], v[36:39]
    ds_read_b128 a[8:11], v3 offset:36864
    s_add_u32 m0, s21, 1024
    v_mfma_f32_16x16x32_bf16 v[40:43], v[120:123], a[44:47], v[40:43]
    v_mfma_f32_16x16x32_bf16 v[44:47], v[124:127], a[44:47], v[44:47]
    ds_read_b128 a[12:15], v3 offset:38912
    s_add_u32 s64, s20, 0x2a80
    buffer_load_dwordx4 v2, s[4:7], s64 offen lds
    s_waitcnt lgkmcnt(4)
    v_mfma_f32_16x16x32_bf16 v[48:51], v[120:123], a[48:51], v[48:51]
    v_mfma_f32_16x16x32_bf16 v[52:55], v[124:127], a[48:51], v[52:55]
    ds_read_b128 a[16:19], v3 offset:40960
    s_add_u32 m0, s21, 2048
    v_mfma_f32_16x16x32_bf16 v[56:59], v[120:123], a[52:55], v[56:59]
    v_mfma_f32_16x16x32_bf16 v[60:63], v[124:127], a[52:55], v[60:63]
    ds_read_b128 a[20:23], v3 offset:43008
    s_add_u32 s64, s20, 0x5280
    buffer_load_dwordx4 v2, s[4:7], s64 offen lds
    v_mfma_f32_16x16x32_bf16 v[64:67], v[120:123], a[56:59], v[64:67]
    v_mfma_f32_16x16x32_bf16 v[68:71], v[124:127], a[56:59], v[68:71]
    ds_read_b128 a[24:27], v3 offset:45056
    s_add_u32 m0, s21, 3072
    v_mfma_f32_16x16x32_bf16 v[72:75], v[120:123], a[60:63], v[72:75]
    v_mfma_f32_16x16x32_bf16 v[76:79], v[124:127], a[60:63], v[76:79]
    ds_read_b128 a[28:31], v3 offset:47104
    s_add_u32 s64, s20, 0x7a80
    buffer_load_dwordx4 v2, s[4:7], s64 offen lds
    s_waitcnt lgkmcnt(4)
    v_mfma_f32_16x16x32_bf16 v[16:19], v[128:131], a[0:3], v[16:19]
    v_mfma_f32_16x16x32_bf16 v[20:23], v[132:135], a[0:3], v[20:23]
    ds_read_b128 a[32:35], v4 offset:32768
    v_mfma_f32_16x16x32_bf16 v[24:27], v[128:131], a[4:7], v[24:27]
    v_mfma_f32_16x16x32_bf16 v[28:31], v[132:135], a[4:7], v[28:31]
    ds_read_b128 a[36:39], v4 offset:34816
    v_mfma_f32_16x16x32_bf16 v[32:35], v[128:131], a[8:11], v[32:35]
    v_mfma_f32_16x16x32_bf16 v[36:39], v[132:135], a[8:11], v[36:39]
    ds_read_b128 a[40:43], v4 offset:36864
    v_mfma_f32_16x16x32_bf16 v[40:43], v[128:131], a[12:15], v[40:43]
    v_mfma_f32_16x16x32_bf16 v[44:47], v[132:135], a[12:15], v[44:47]
    ds_read_b128 a[44:47], v4 offset:38912
    s_waitcnt lgkmcnt(4)
    v_mfma_f32_16x16x32_bf16 v[48:51], v[128:131], a[16:19], v[48:51]
    v_mfma_f32_16x16x32_bf16 v[52:55], v[132:135], a[16:19], v[52:55]
    ds_read_b128 a[48:51], v4 offset:40960
    v_mfma_f32_16x16x32_bf16 v[56:59], v[128:131], a[20:23], v[56:59]
    v_mfma_f32_16x16x32_bf16 v[60:63], v[132:135], a[20:23], v[60:63]
    ds_read_b128 a[52:55], v4 offset:43008
    v_mfma_f32_16x16x32_bf16 v[64:67], v[128:131], a[24:27], v[64:67]
    v_mfma_f32_16x16x32_bf16 v[68:71], v[132:135], a[24:27], v[68:71]
    ds_read_b128 a[56:59], v4 offset:45056
    v_mfma_f32_16x16x32_bf16 v[72:75], v[128:131], a[28:31], v[72:75]
    v_mfma_f32_16x16x32_bf16 v[76:79], v[132:135], a[28:31], v[76:79]
    ds_read_b128 a[60:63], v4 offset:47104
    s_waitcnt vmcnt(16)
    s_barrier
    s_waitcnt lgkmcnt(4)
    v_mfma_f32_16x16x32_bf16 v[16:19], v[136:139], a[32:35], v[16:19]
    v_mfma_f32_16x16x32_bf16 v[20:23], v[140:143], a[32:35], v[20:23]
    ds_read_b128 a[0:3], v3 offset:49152
    s_add_u32 m0, s21, 16384
    v_mfma_f32_16x16x32_bf16 v[24:27], v[136:139], a[36:39], v[24:27]
    v_mfma_f32_16x16x32_bf16 v[28:31], v[140:143], a[36:39], v[28:31]
    ds_read_b128 a[4:7], v3 offset:51200
    s_add_u32 s64, s20, 0x300
    buffer_load_dwordx4 v2, s[4:7], s64 offen lds
    v_mfma_f32_16x16x32_bf16 v[32:35], v[136:139], a[40:43], v[32:35]
    v_mfma_f32_16x16x32_bf16 v[36:39], v[140:143], a[40:43], v[36:39]
    ds_read_b128 a[8:11], v3 offset:53248
    s_add_u32 m0, s21, 17408
    v_mfma_f32_16x16x32_bf16 v[40:43], v[136:139], a[44:47], v[40:43]
    v_mfma_f32_16x16x32_bf16 v[44:47], v[140:143], a[44:47], v[44:47]
    ds_read_b128 a[12:15], v3 offset:55296
    s_add_u32 s64, s20, 0x2b00
    buffer_load_dwordx4 v2, s[4:7], s64 offen lds
    s_waitcnt lgkmcnt(4)
    v_mfma_f32_16x16x32_bf16 v[48:51], v[136:139], a[48:51], v[48:51]
    v_mfma_f32_16x16x32_bf16 v[52:55], v[140:143], a[48:51], v[52:55]
    ds_read_b128 a[16:19], v3 offset:57344
    s_add_u32 m0, s21, 18432
    v_mfma_f32_16x16x32_bf16 v[56:59], v[136:139], a[52:55], v[56:59]
    v_mfma_f32_16x16x32_bf16 v[60:63], v[140:143], a[52:55], v[60:63]
    ds_read_b128 a[20:23], v3 offset:59392
    s_add_u32 s64, s20, 0x5300
    buffer_load_dwordx4 v2, s[4:7], s64 offen lds
    v_mfma_f32_16x16x32_bf16 v[64:67], v[136:139], a[56:59], v[64:67]
    v_mfma_f32_16x16x32_bf16 v[68:71], v[140:143], a[56:59], v[68:71]
    ds_read_b128 a[24:27], v3 offset:61440
    s_add_u32 m0, s21, 19456
    v_mfma_f32_16x16x32_bf16 v[72:75], v[136:139], a[60:63], v[72:75]
    v_mfma_f32_16x16x32_bf16 v[76:79], v[140:143], a[60:63], v[76:79]
    ds_read_b128 a[28:31], v3 offset:63488
    s_add_u32 s64, s20, 0x7b00
    buffer_load_dwordx4 v2, s[4:7], s64 offen lds
    s_waitcnt lgkmcnt(4)
    v_mfma_f32_16x16x32_bf16 v[16:19], v[144:147], a[0:3], v[16:19]
    v_mfma_f32_16x16x32_bf16 v[20:23], v[148:151], a[0:3], v[20:23]
    ds_read_b128 a[32:35], v4 offset:49152
    v_mfma_f32_16x16x32_bf16 v[24:27], v[144:147], a[4:7], v[24:27]
    v_mfma_f32_16x16x32_bf16 v[28:31], v[148:151], a[4:7], v[28:31]
    ds_read_b128 a[36:39], v4 offset:51200
    v_mfma_f32_16x16x32_bf16 v[32:35], v[144:147], a[8:11], v[32:35]
    v_mfma_f32_16x16x32_bf16 v[36:39], v[148:151], a[8:11], v[36:39]
    ds_read_b128 a[40:43], v4 offset:53248
    v_mfma_f32_16x16x32_bf16 v[40:43], v[144:147], a[12:15], v[40:43]
    v_mfma_f32_16x16x32_bf16 v[44:47], v[148:151], a[12:15], v[44:47]
    ds_read_b128 a[44:47], v4 offset:55296
    s_waitcnt lgkmcnt(4)
    v_mfma_f32_16x16x32_bf16 v[48:51], v[144:147], a[16:19], v[48:51]
    v_mfma_f32_16x16x32_bf16 v[52:55], v[148:151], a[16:19], v[52:55]
    ds_read_b128 a[48:51], v4 offset:57344
    v_mfma_f32_16x16x32_bf16 v[56:59], v[144:147], a[20:23], v[56:59]
    v_mfma_f32_16x16x32_bf16 v[60:63], v[148:151], a[20:23], v[60:63]
    ds_read_b128 a[52:55], v4 offset:59392
    v_mfma_f32_16x16x32_bf16 v[64:67], v[144:147], a[24:27], v[64:67]
    v_mfma_f32_16x16x32_bf16 v[68:71], v[148:151], a[24:27], v[68:71]
    ds_read_b128 a[56:59], v4 offset:61440
    v_mfma_f32_16x16x32_bf16 v[72:75], v[144:147], a[28:31], v[72:75]
    v_mfma_f32_16x16x32_bf16 v[76:79], v[148:151], a[28:31], v[76:79]
    ds_read_b128 a[60:63], v4 offset:63488
    s_waitcnt vmcnt(8)
    s_barrier
    s_cmp_lg_u32 s14, 0
    s_cbranch_scc1 GF_123
    v_mov_b32 v7, 1
    v_mov_b32 v8, 0
    s_mov_b64 exec, 1
    buffer_store_dword v7, v8, s[4:7], s23 offen sc1
    s_mov_b64 exec, -1
GF_123:
    s_waitcnt lgkmcnt(4)
    v_mfma_f32_16x16x32_bf16 v[16:19], v[152:155], a[32:35], v[16:19]
    v_mfma_f32_16x16x32_bf16 v[20:23], v[156:159], a[32:35], v[20:23]
    ds_read_b128 a[0:3], v6 offset:0
    s_add_u32 m0, s21, 32768
    v_mfma_f32_16x16x32_bf16 v[24:27], v[152:155], a[36:39], v[24:27]
    v_mfma_f32_16x16x32_bf16 v[28:31], v[156:159], a[36:39], v[28:31]
    ds_read_b128 a[4:7], v6 offset:2048
    s_add_u32 s64, s20, 0x380
    buffer_load_dwordx4 v2, s[4:7], s64 offen lds
    v_mfma_f32_16x16x32_bf16 v[32:35], v[152:155], a[40:43], v[32:35]
    v_mfma_f32_16x16x32_bf16 v[36:39], v[156:159], a[40:43], v[36:39]
    ds_read_b128 a[8:11], v6 offset:4096
    s_add_u32 m0, s21, 33792
    v_mfma_f32_16x16x32_bf16 v[40:43], v[152:155], a[44:47], v[40:43]
    v_mfma_f32_16x16x32_bf16 v[44:47], v[156:159], a[44:47], v[44:47]
    ds_read_b128 a[12:15], v6 offset:6144
    s_add_u32 s64, s20, 0x2b80
    buffer_load_dwordx4 v2, s[4:7], s64 offen lds
    s_waitcnt lgkmcnt(4)
    v_mfma_f32_16x16x32_bf16 v[48:51], v[152:155], a[48:51], v[48:51]
    v_mfma_f32_16x16x32_bf16 v[52:55], v[156:159], a[48:51], v[52:55]
    ds_read_b128 a[16:19], v6 offset:8192
    s_add_u32 m0, s21, 34816
    v_mfma_f32_16x16x32_bf16 v[56:59], v[152:155], a[52:55], v[56:59]
    v_mfma_f32_16x16x32_bf16 v[60:63], v[156:159], a[52:55], v[60:63]
    ds_read_b128 a[20:23], v6 offset:10240
    s_add_u32 s64, s20, 0x5380
    buffer_load_dwordx4 v2, s[4:7], s64 offen lds
    v_mfma_f32_16x16x32_bf16 v[64:67], v[152:155], a[56:59], v[64:67]
    v_mfma_f32_16x16x32_bf16 v[68:71], v[156:159], a[56:59], v[68:71]
    ds_read_b128 a[24:27], v6 offset:12288
    s_add_u32 m0, s21, 35840
    v_mfma_f32_16x16x32_bf16 v[72:75], v[152:155], a[60:63], v[72:75]
    v_mfma_f32_16x16x32_bf16 v[76:79], v[156:159], a[60:63], v[76:79]
    ds_read_b128 a[28:31], v6 offset:14336
    s_add_u32 s64, s20, 0x7b80
    buffer_load_dwordx4 v2, s[4:7], s64 offen lds
    s_waitcnt lgkmcnt(4)
    v_mfma_f32_16x16x32_bf16 v[16:19], v[160:163], a[0:3], v[16:19]
    v_mfma_f32_16x16x32_bf16 v[20:23], v[164:167], a[0:3], v[20:23]
    ds_read_b128 a[32:35], v9 offset:0
    v_mfma_f32_16x16x32_bf16 v[24:27], v[160:163], a[4:7], v[24:27]
    v_mfma_f32_16x16x32_bf16 v[28:31], v[164:167], a[4:7], v[28:31]
    ds_read_b128 a[36:39], v9 offset:2048
    v_mfma_f32_16x16x32_bf16 v[32:35], v[160:163], a[8:11], v[32:35]
    v_mfma_f32_16x16x32_bf16 v[36:39], v[164:167], a[8:11], v[36:39]
    ds_read_b128 a[40:43], v9 offset:4096
    v_mfma_f32_16x16x32_bf16 v[40:43], v[160:163], a[12:15], v[40:43]
    v_mfma_f32_16x16x32_bf16 v[44:47], v[164:167], a[12:15], v[44:47]
    ds_read_b128 a[44:47], v9 offset:6144
    s_waitcnt lgkmcnt(4)
    v_mfma_f32_16x16x32_bf16 v[48:51], v[160:163], a[16:19], v[48:51]
    v_mfma_f32_16x16x32_bf16 v[52:55], v[164:167], a[16:19], v[52:55]
    ds_read_b128 a[48:51], v9 offset:8192
    v_mfma_f32_16x16x32_bf16 v[56:59], v[160:163], a[20:23], v[56:59]
    v_mfma_f32_16x16x32_bf16 v[60:63], v[164:167], a[20:23], v[60:63]
    ds_read_b128 a[52:55], v9 offset:10240
    v_mfma_f32_16x16x32_bf16 v[64:67], v[160:163], a[24:27], v[64:67]
    v_mfma_f32_16x16x32_bf16 v[68:71], v[164:167], a[24:27], v[68:71]
    ds_read_b128 a[56:59], v9 offset:12288
    v_mfma_f32_16x16x32_bf16 v[72:75], v[160:163], a[28:31], v[72:75]
    v_mfma_f32_16x16x32_bf16 v[76:79], v[164:167], a[28:31], v[76:79]
    ds_read_b128 a[60:63], v9 offset:14336
    s_waitcnt vmcnt(8)
    s_barrier
    s_waitcnt lgkmcnt(4)
    v_mfma_f32_16x16x32_bf16 v[16:19], v[168:171], a[32:35], v[16:19]
    v_mfma_f32_16x16x32_bf16 v[20:23], v[172:175], a[32:35], v[20:23]
    ds_read_b128 a[0:3], v3 offset:0
    s_add_u32 m0, s21, 49152
    v_mfma_f32_16x16x32_bf16 v[24:27], v[168:171], a[36:39], v[24:27]
    v_mfma_f32_16x16x32_bf16 v[28:31], v[172:175], a[36:39], v[28:31]
    ds_read_b128 a[4:7], v3 offset:2048
    s_add_u32 s64, s20, 0x400
    buffer_load_dwordx4 v2, s[4:7], s64 offen lds
    v_mfma_f32_16x16x32_bf16 v[32:35], v[168:171], a[40:43], v[32:35]
    v_mfma_f32_16x16x32_bf16 v[36:39], v[172:175], a[40:43], v[36:39]
    ds_read_b128 a[8:11], v3 offset:4096
    s_add_u32 m0, s21, 50176
    v_mfma_f32_16x16x32_bf16 v[40:43], v[168:171], a[44:47], v[40:43]
    v_mfma_f32_16x16x32_bf16 v[44:47], v[172:175], a[44:47], v[44:47]
    ds_read_b128 a[12:15], v3 offset:6144
    s_add_u32 s64, s20, 0x2c00
    buffer_load_dwordx4 v2, s[4:7], s64 offen lds
    s_waitcnt lgkmcnt(4)
    v_mfma_f32_16x16x32_bf16 v[48:51], v[168:171], a[48:51], v[48:51]
    v_mfma_f32_16x16x32_bf16 v[52:55], v[172:175], a[48:51], v[52:55]
    ds_read_b128 a[16:19], v3 offset:8192
    s_add_u32 m0, s21, 51200
    v_mfma_f32_16x16x32_bf16 v[56:59], v[168:171], a[52:55], v[56:59]
    v_mfma_f32_16x16x32_bf16 v[60:63], v[172:175], a[52:55], v[60:63]
    ds_read_b128 a[20:23], v3 offset:10240
    s_add_u32 s64, s20, 0x5400
    buffer_load_dwordx4 v2, s[4:7], s64 offen lds
    v_mfma_f32_16x16x32_bf16 v[64:67], v[168:171], a[56:59], v[64:67]
    v_mfma_f32_16x16x32_bf16 v[68:71], v[172:175], a[56:59], v[68:71]
    ds_read_b128 a[24:27], v3 offset:12288
    s_add_u32 m0, s21, 52224
    v_mfma_f32_16x16x32_bf16 v[72:75], v[168:171], a[60:63], v[72:75]
    v_mfma_f32_16x16x32_bf16 v[76:79], v[172:175], a[60:63], v[76:79]
    ds_read_b128 a[28:31], v3 offset:14336
    s_add_u32 s64, s20, 0x7c00
    buffer_load_dwordx4 v2, s[4:7], s64 offen lds
    s_waitcnt lgkmcnt(4)
    v_mfma_f32_16x16x32_bf16 v[16:19], v[176:179], a[0:3], v[16:19]
    v_mfma_f32_16x16x32_bf16 v[20:23], v[180:183], a[0:3], v[20:23]
    ds_read_b128 a[32:35], v4 offset:0
    v_mfma_f32_16x16x32_bf16 v[24:27], v[176:179], a[4:7], v[24:27]
    v_mfma_f32_16x16x32_bf16 v[28:31], v[180:183], a[4:7], v[28:31]
    ds_read_b128 a[36:39], v4 offset:2048
    v_mfma_f32_16x16x32_bf16 v[32:35], v[176:179], a[8:11], v[32:35]
    v_mfma_f32_16x16x32_bf16 v[36:39], v[180:183], a[8:11], v[36:39]
    ds_read_b128 a[40:43], v4 offset:4096
    v_mfma_f32_16x16x32_bf16 v[40:43], v[176:179], a[12:15], v[40:43]
    v_mfma_f32_16x16x32_bf16 v[44:47], v[180:183], a[12:15], v[44:47]
    ds_read_b128 a[44:47], v4 offset:6144
    s_waitcnt lgkmcnt(4)
    v_mfma_f32_16x16x32_bf16 v[48:51], v[176:179], a[16:19], v[48:51]
    v_mfma_f32_16x16x32_bf16 v[52:55], v[180:183], a[16:19], v[52:55]
    ds_read_b128 a[48:51], v4 offset:8192
    v_mfma_f32_16x16x32_bf16 v[56:59], v[176:179], a[20:23], v[56:59]
    v_mfma_f32_16x16x32_bf16 v[60:63], v[180:183], a[20:23], v[60:63]
    ds_read_b128 a[52:55], v4 offset:10240
    v_mfma_f32_16x16x32_bf16 v[64:67], v[176:179], a[24:27], v[64:67]
    v_mfma_f32_16x16x32_bf16 v[68:71], v[180:183], a[24:27], v[68:71]
    ds_read_b128 a[56:59], v4 offset:12288
    v_mfma_f32_16x16x32_bf16 v[72:75], v[176:179], a[28:31], v[72:75]
    v_mfma_f32_16x16x32_bf16 v[76:79], v[180:183], a[28:31], v[76:79]
    ds_read_b128 a[60:63], v4 offset:14336
    s_waitcnt vmcnt(8)
    s_barrier
    s_waitcnt lgkmcnt(4)
    v_mfma_f32_16x16x32_bf16 v[16:19], v[184:187], a[32:35], v[16:19]
    v_mfma_f32_16x16x32_bf16 v[20:23], v[188:191], a[32:35], v[20:23]
    ds_read_b128 a[0:3], v3 offset:16384
    s_add_u32 m0, s21, 65536
    v_mfma_f32_16x16x32_bf16 v[24:27], v[184:187], a[36:39], v[24:27]
    v_mfma_f32_16x16x32_bf16 v[28:31], v[188:191], a[36:39], v[28:31]
    ds_read_b128 a[4:7], v3 offset:18432
    s_add_u32 s64, s20, 0x480
    buffer_load_dwordx4 v2, s[4:7], s64 offen lds
    v_mfma_f32_16x16x32_bf16 v[32:35], v[184:187], a[40:43], v[32:35]
    v_mfma_f32_16x16x32_bf16 v[36:39], v[188:191], a[40:43], v[36:39]
    ds_read_b128 a[8:11], v3 offset:20480
    s_add_u32 m0, s21, 66560
    v_mfma_f32_16x16x32_bf16 v[40:43], v[184:187], a[44:47], v[40:43]
    v_mfma_f32_16x16x32_bf16 v[44:47], v[188:191], a[44:47], v[44:47]
    ds_read_b128 a[12:15], v3 offset:22528
    s_add_u32 s64, s20, 0x2c80
    buffer_load_dwordx4 v2, s[4:7], s64 offen lds
    s_waitcnt lgkmcnt(4)
    v_mfma_f32_16x16x32_bf16 v[48:51], v[184:187], a[48:51], v[48:51]
    v_mfma_f32_16x16x32_bf16 v[52:55], v[188:191], a[48:51], v[52:55]
    ds_read_b128 a[16:19], v3 offset:24576
    s_add_u32 m0, s21, 67584
    v_mfma_f32_16x16x32_bf16 v[56:59], v[184:187], a[52:55], v[56:59]
    v_mfma_f32_16x16x32_bf16 v[60:63], v[188:191], a[52:55], v[60:63]
    ds_read_b128 a[20:23], v3 offset:26624
    s_add_u32 s64, s20, 0x5480
    buffer_load_dwordx4 v2, s[4:7], s64 offen lds
    v_mfma_f32_16x16x32_bf16 v[64:67], v[184:187], a[56:59], v[64:67]
    v_mfma_f32_16x16x32_bf16 v[68:71], v[188:191], a[56:59], v[68:71]
    ds_read_b128 a[24:27], v3 offset:28672
    s_add_u32 m0, s21, 68608
    v_mfma_f32_16x16x32_bf16 v[72:75], v[184:187], a[60:63], v[72:75]
    v_mfma_f32_16x16x32_bf16 v[76:79], v[188:191], a[60:63], v[76:79]
    ds_read_b128 a[28:31], v3 offset:30720
    s_add_u32 s64, s20, 0x7c80
    buffer_load_dwordx4 v2, s[4:7], s64 offen lds
    s_waitcnt lgkmcnt(4)
    v_mfma_f32_16x16x32_bf16 v[16:19], v[192:195], a[0:3], v[16:19]
    v_mfma_f32_16x16x32_bf16 v[20:23], v[196:199], a[0:3], v[20:23]
    ds_read_b128 a[32:35], v4 offset:16384
    v_mfma_f32_16x16x32_bf16 v[24:27], v[192:195], a[4:7], v[24:27]
    v_mfma_f32_16x16x32_bf16 v[28:31], v[196:199], a[4:7], v[28:31]
    ds_read_b128 a[36:39], v4 offset:18432
    v_mfma_f32_16x16x32_bf16 v[32:35], v[192:195], a[8:11], v[32:35]
    v_mfma_f32_16x16x32_bf16 v[36:39], v[196:199], a[8:11], v[36:39]
    ds_read_b128 a[40:43], v4 offset:20480
    v_mfma_f32_16x16x32_bf16 v[40:43], v[192:195], a[12:15], v[40:43]
    v_mfma_f32_16x16x32_bf16 v[44:47], v[196:199], a[12:15], v[44:47]
    ds_read_b128 a[44:47], v4 offset:22528
    s_waitcnt lgkmcnt(4)
    v_mfma_f32_16x16x32_bf16 v[48:51], v[192:195], a[16:19], v[48:51]
    v_mfma_f32_16x16x32_bf16 v[52:55], v[196:199], a[16:19], v[52:55]
    ds_read_b128 a[48:51], v4 offset:24576
    v_mfma_f32_16x16x32_bf16 v[56:59], v[192:195], a[20:23], v[56:59]
    v_mfma_f32_16x16x32_bf16 v[60:63], v[196:199], a[20:23], v[60:63]
    ds_read_b128 a[52:55], v4 offset:26624
    v_mfma_f32_16x16x32_bf16 v[64:67], v[192:195], a[24:27], v[64:67]
    v_mfma_f32_16x16x32_bf16 v[68:71], v[196:199], a[24:27], v[68:71]
    ds_read_b128 a[56:59], v4 offset:28672
    v_mfma_f32_16x16x32_bf16 v[72:75], v[192:195], a[28:31], v[72:75]
    v_mfma_f32_16x16x32_bf16 v[76:79], v[196:199], a[28:31], v[76:79]
    ds_read_b128 a[60:63], v4 offset:30720
    s_waitcnt vmcnt(8)
    s_barrier
    s_waitcnt lgkmcnt(4)
    v_mfma_f32_16x16x32_bf16 v[16:19], v[200:203], a[32:35], v[16:19]
    v_mfma_f32_16x16x32_bf16 v[20:23], v[204:207], a[32:35], v[20:23]
    ds_read_b128 a[0:3], v3 offset:32768
    s_add_u32 m0, s21, 0
    v_mfma_f32_16x16x32_bf16 v[24:27], v[200:203], a[36:39], v[24:27]
    v_mfma_f32_16x16x32_bf16 v[28:31], v[204:207], a[36:39], v[28:31]
    ds_read_b128 a[4:7], v3 offset:34816
    s_add_u32 s64, s20, 0x50000
    buffer_load_dwordx4 v2, s[4:7], s64 offen lds
    v_mfma_f32_16x16x32_bf16 v[32:35], v[200:203], a[40:43], v[32:35]
    v_mfma_f32_16x16x32_bf16 v[36:39], v[204:207], a[40:43], v[36:39]
    ds_read_b128 a[8:11], v3 offset:36864
    s_add_u32 m0, s21, 1024
    v_mfma_f32_16x16x32_bf16 v[40:43], v[200:203], a[44:47], v[40:43]
    v_mfma_f32_16x16x32_bf16 v[44:47], v[204:207], a[44:47], v[44:47]
    ds_read_b128 a[12:15], v3 offset:38912
    s_add_u32 s64, s20, 0x52800
    buffer_load_dwordx4 v2, s[4:7], s64 offen lds
    s_waitcnt lgkmcnt(4)
    v_mfma_f32_16x16x32_bf16 v[48:51], v[200:203], a[48:51], v[48:51]
    v_mfma_f32_16x16x32_bf16 v[52:55], v[204:207], a[48:51], v[52:55]
    ds_read_b128 a[16:19], v3 offset:40960
    s_add_u32 m0, s21, 2048
    v_mfma_f32_16x16x32_bf16 v[56:59], v[200:203], a[52:55], v[56:59]
    v_mfma_f32_16x16x32_bf16 v[60:63], v[204:207], a[52:55], v[60:63]
    ds_read_b128 a[20:23], v3 offset:43008
    s_add_u32 s64, s20, 0x55000
    buffer_load_dwordx4 v2, s[4:7], s64 offen lds
    v_mfma_f32_16x16x32_bf16 v[64:67], v[200:203], a[56:59], v[64:67]
    v_mfma_f32_16x16x32_bf16 v[68:71], v[204:207], a[56:59], v[68:71]
    ds_read_b128 a[24:27], v3 offset:45056
    s_add_u32 m0, s21, 3072
    v_mfma_f32_16x16x32_bf16 v[72:75], v[200:203], a[60:63], v[72:75]
    v_mfma_f32_16x16x32_bf16 v[76:79], v[204:207], a[60:63], v[76:79]
    ds_read_b128 a[28:31], v3 offset:47104
    s_add_u32 s64, s20, 0x57800
    buffer_load_dwordx4 v2, s[4:7], s64 offen lds
    s_waitcnt lgkmcnt(4)
    v_mfma_f32_16x16x32_bf16 v[16:19], v[208:211], a[0:3], v[16:19]
    v_mfma_f32_16x16x32_bf16 v[20:23], v[212:215], a[0:3], v[20:23]
    ds_read_b128 a[32:35], v4 offset:32768
    v_mfma_f32_16x16x32_bf16 v[24:27], v[208:211], a[4:7], v[24:27]
    v_mfma_f32_16x16x32_bf16 v[28:31], v[212:215], a[4:7], v[28:31]
    ds_read_b128 a[36:39], v4 offset:34816
    v_mfma_f32_16x16x32_bf16 v[32:35], v[208:211], a[8:11], v[32:35]
    v_mfma_f32_16x16x32_bf16 v[36:39], v[212:215], a[8:11], v[36:39]
    ds_read_b128 a[40:43], v4 offset:36864
    v_mfma_f32_16x16x32_bf16 v[40:43], v[208:211], a[12:15], v[40:43]
    v_mfma_f32_16x16x32_bf16 v[44:47], v[212:215], a[12:15], v[44:47]
    ds_read_b128 a[44:47], v4 offset:38912
    s_waitcnt lgkmcnt(4)
    v_mfma_f32_16x16x32_bf16 v[48:51], v[208:211], a[16:19], v[48:51]
    v_mfma_f32_16x16x32_bf16 v[52:55], v[212:215], a[16:19], v[52:55]
    ds_read_b128 a[48:51], v4 offset:40960
    v_mfma_f32_16x16x32_bf16 v[56:59], v[208:211], a[20:23], v[56:59]
    v_mfma_f32_16x16x32_bf16 v[60:63], v[212:215], a[20:23], v[60:63]
    ds_read_b128 a[52:55], v4 offset:43008
    v_mfma_f32_16x16x32_bf16 v[64:67], v[208:211], a[24:27], v[64:67]
    v_mfma_f32_16x16x32_bf16 v[68:71], v[212:215], a[24:27], v[68:71]
    ds_read_b128 a[56:59], v4 offset:45056
    v_mfma_f32_16x16x32_bf16 v[72:75], v[208:211], a[28:31], v[72:75]
    v_mfma_f32_16x16x32_bf16 v[76:79], v[212:215], a[28:31], v[76:79]
    ds_read_b128 a[60:63], v4 offset:47104
    s_waitcnt vmcnt(8)
    s_barrier
    s_waitcnt lgkmcnt(4)
    v_mfma_f32_16x16x32_bf16 v[16:19], v[216:219], a[32:35], v[16:19]
    v_mfma_f32_16x16x32_bf16 v[20:23], v[220:223], a[32:35], v[20:23]
    ds_read_b128 a[0:3], v3 offset:49152
    s_add_u32 m0, s21, 16384
    v_mfma_f32_16x16x32_bf16 v[24:27], v[216:219], a[36:39], v[24:27]
    v_mfma_f32_16x16x32_bf16 v[28:31], v[220:223], a[36:39], v[28:31]
    ds_read_b128 a[4:7], v3 offset:51200
    s_add_u32 s64, s20, 0x50080
    buffer_load_dwordx4 v2, s[4:7], s64 offen lds
    v_mfma_f32_16x16x32_bf16 v[32:35], v[216:219], a[40:43], v[32:35]
    v_mfma_f32_16x16x32_bf16 v[36:39], v[220:223], a[40:43], v[36:39]
    ds_read_b128 a[8:11], v3 offset:53248
    s_add_u32 m0, s21, 17408
    v_mfma_f32_16x16x32_bf16 v[40:43], v[216:219], a[44:47], v[40:43]
    v_mfma_f32_16x16x32_bf16 v[44:47], v[220:223], a[44:47], v[44:47]
    ds_read_b128 a[12:15], v3 offset:55296
    s_add_u32 s64, s20, 0x52880
    buffer_load_dwordx4 v2, s[4:7], s64 offen lds
    s_waitcnt lgkmcnt(4)
    v_mfma_f32_16x16x32_bf16 v[48:51], v[216:219], a[48:51], v[48:51]
    v_mfma_f32_16x16x32_bf16 v[52:55], v[220:223], a[48:51], v[52:55]
    ds_read_b128 a[16:19], v3 offset:57344
    s_add_u32 m0, s21, 18432
    v_mfma_f32_16x16x32_bf16 v[56:59], v[216:219], a[52:55], v[56:59]
    v_mfma_f32_16x16x32_bf16 v[60:63], v[220:223], a[52:55], v[60:63]
    ds_read_b128 a[20:23], v3 offset:59392
    s_add_u32 s64, s20, 0x55080
    buffer_load_dwordx4 v2, s[4:7], s64 offen lds
    v_mfma_f32_16x16x32_bf16 v[64:67], v[216:219], a[56:59], v[64:67]
    v_mfma_f32_16x16x32_bf16 v[68:71], v[220:223], a[56:59], v[68:71]
    ds_read_b128 a[24:27], v3 offset:61440
    s_add_u32 m0, s21, 19456
    v_mfma_f32_16x16x32_bf16 v[72:75], v[216:219], a[60:63], v[72:75]
    v_mfma_f32_16x16x32_bf16 v[76:79], v[220:223], a[60:63], v[76:79]
    ds_read_b128 a[28:31], v3 offset:63488
    s_add_u32 s64, s20, 0x57880
    buffer_load_dwordx4 v2, s[4:7], s64 offen lds
    s_waitcnt lgkmcnt(4)
    v_mfma_f32_16x16x32_bf16 v[16:19], v[224:227], a[0:3], v[16:19]
    v_mfma_f32_16x16x32_bf16 v[20:23], v[228:231], a[0:3], v[20:23]
    ds_read_b128 a[32:35], v4 offset:49152
    v_mfma_f32_16x16x32_bf16 v[24:27], v[224:227], a[4:7], v[24:27]
    v_mfma_f32_16x16x32_bf16 v[28:31], v[228:231], a[4:7], v[28:31]
    ds_read_b128 a[36:39], v4 offset:51200
    v_mfma_f32_16x16x32_bf16 v[32:35], v[224:227], a[8:11], v[32:35]
    v_mfma_f32_16x16x32_bf16 v[36:39], v[228:231], a[8:11], v[36:39]
    ds_read_b128 a[40:43], v4 offset:53248
    v_mfma_f32_16x16x32_bf16 v[40:43], v[224:227], a[12:15], v[40:43]
    v_mfma_f32_16x16x32_bf16 v[44:47], v[228:231], a[12:15], v[44:47]
    ds_read_b128 a[44:47], v4 offset:55296
    s_waitcnt lgkmcnt(4)
    v_mfma_f32_16x16x32_bf16 v[48:51], v[224:227], a[16:19], v[48:51]
    v_mfma_f32_16x16x32_bf16 v[52:55], v[228:231], a[16:19], v[52:55]
    ds_read_b128 a[48:51], v4 offset:57344
    v_mfma_f32_16x16x32_bf16 v[56:59], v[224:227], a[20:23], v[56:59]
    v_mfma_f32_16x16x32_bf16 v[60:63], v[228:231], a[20:23], v[60:63]
    ds_read_b128 a[52:55], v4 offset:59392
    v_mfma_f32_16x16x32_bf16 v[64:67], v[224:227], a[24:27], v[64:67]
    v_mfma_f32_16x16x32_bf16 v[68:71], v[228:231], a[24:27], v[68:71]
    ds_read_b128 a[56:59], v4 offset:61440
    v_mfma_f32_16x16x32_bf16 v[72:75], v[224:227], a[28:31], v[72:75]
    v_mfma_f32_16x16x32_bf16 v[76:79], v[228:231], a[28:31], v[76:79]
    ds_read_b128 a[60:63], v4 offset:63488
    s_waitcnt vmcnt(8)
    s_barrier
    s_waitcnt lgkmcnt(4)
    v_mfma_f32_16x16x32_bf16 v[16:19], v[232:235], a[32:35], v[16:19]
    v_mfma_f32_16x16x32_bf16 v[20:23], v[236:239], a[32:35], v[20:23]
    ds_read_b128 a[0:3], v6 offset:0
    s_add_u32 m0, s21, 32768
    v_mfma_f32_16x16x32_bf16 v[24:27], v[232:235], a[36:39], v[24:27]
    v_mfma_f32_16x16x32_bf16 v[28:31], v[236:239], a[36:39], v[28:31]
    ds_read_b128 a[4:7], v6 offset:2048
    s_add_u32 s64, s20, 0x50100
    buffer_load_dwordx4 v2, s[4:7], s64 offen lds
    v_mfma_f32_16x16x32_bf16 v[32:35], v[232:235], a[40:43], v[32:35]
    v_mfma_f32_16x16x32_bf16 v[36:39], v[236:239], a[40:43], v[36:39]
    ds_read_b128 a[8:11], v6 offset:4096
    s_add_u32 m0, s21, 33792
    v_mfma_f32_16x16x32_bf16 v[40:43], v[232:235], a[44:47], v[40:43]
    v_mfma_f32_16x16x32_bf16 v[44:47], v[236:239], a[44:47], v[44:47]
    ds_read_b128 a[12:15], v6 offset:6144
    s_add_u32 s64, s20, 0x52900
    buffer_load_dwordx4 v2, s[4:7], s64 offen lds
    s_waitcnt lgkmcnt(4)
    v_mfma_f32_16x16x32_bf16 v[48:51], v[232:235], a[48:51], v[48:51]
    v_mfma_f32_16x16x32_bf16 v[52:55], v[236:239], a[48:51], v[52:55]
    ds_read_b128 a[16:19], v6 offset:8192
    s_add_u32 m0, s21, 34816
    v_mfma_f32_16x16x32_bf16 v[56:59], v[232:235], a[52:55], v[56:59]
    v_mfma_f32_16x16x32_bf16 v[60:63], v[236:239], a[52:55], v[60:63]
    ds_read_b128 a[20:23], v6 offset:10240
    s_add_u32 s64, s20, 0x55100
    buffer_load_dwordx4 v2, s[4:7], s64 offen lds
    v_mfma_f32_16x16x32_bf16 v[64:67], v[232:235], a[56:59], v[64:67]
    v_mfma_f32_16x16x32_bf16 v[68:71], v[236:239], a[56:59], v[68:71]
    ds_read_b128 a[24:27], v6 offset:12288
    s_add_u32 m0, s21, 35840
    v_mfma_f32_16x16x32_bf16 v[72:75], v[232:235], a[60:63], v[72:75]
    v_mfma_f32_16x16x32_bf16 v[76:79], v[236:239], a[60:63], v[76:79]
    ds_read_b128 a[28:31], v6 offset:14336
    s_add_u32 s64, s20, 0x57900
    buffer_load_dwordx4 v2, s[4:7], s64 offen lds
    s_waitcnt lgkmcnt(4)
    v_mfma_f32_16x16x32_bf16 v[16:19], v[240:243], a[0:3], v[16:19]
    v_mfma_f32_16x16x32_bf16 v[20:23], v[244:247], a[0:3], v[20:23]
    ds_read_b128 a[32:35], v9 offset:0
    v_mfma_f32_16x16x32_bf16 v[24:27], v[240:243], a[4:7], v[24:27]
    v_mfma_f32_16x16x32_bf16 v[28:31], v[244:247], a[4:7], v[28:31]
    ds_read_b128 a[36:39], v9 offset:2048
    v_mfma_f32_16x16x32_bf16 v[32:35], v[240:243], a[8:11], v[32:35]
    v_mfma_f32_16x16x32_bf16 v[36:39], v[244:247], a[8:11], v[36:39]
    ds_read_b128 a[40:43], v9 offset:4096
    v_mfma_f32_16x16x32_bf16 v[40:43], v[240:243], a[12:15], v[40:43]
    v_mfma_f32_16x16x32_bf16 v[44:47], v[244:247], a[12:15], v[44:47]
    ds_read_b128 a[44:47], v9 offset:6144
    s_waitcnt lgkmcnt(4)
    v_mfma_f32_16x16x32_bf16 v[48:51], v[240:243], a[16:19], v[48:51]
    v_mfma_f32_16x16x32_bf16 v[52:55], v[244:247], a[16:19], v[52:55]
    ds_read_b128 a[48:51], v9 offset:8192
    v_mfma_f32_16x16x32_bf16 v[56:59], v[240:243], a[20:23], v[56:59]
    v_mfma_f32_16x16x32_bf16 v[60:63], v[244:247], a[20:23], v[60:63]
    ds_read_b128 a[52:55], v9 offset:10240
    v_mfma_f32_16x16x32_bf16 v[64:67], v[240:243], a[24:27], v[64:67]
    v_mfma_f32_16x16x32_bf16 v[68:71], v[244:247], a[24:27], v[68:71]
    ds_read_b128 a[56:59], v9 offset:12288
    v_mfma_f32_16x16x32_bf16 v[72:75], v[240:243], a[28:31], v[72:75]
    v_mfma_f32_16x16x32_bf16 v[76:79], v[244:247], a[28:31], v[76:79]
    ds_read_b128 a[60:63], v9 offset:14336
    s_waitcnt vmcnt(8)
    s_barrier
    s_waitcnt lgkmcnt(4)
    v_mfma_f32_16x16x32_bf16 v[16:19], v[248:251], a[32:35], v[16:19]
    v_mfma_f32_16x16x32_bf16 v[20:23], v[252:255], a[32:35], v[20:23]
    ds_read_b128 a[0:3], v3 offset:0
    s_add_u32 m0, s21, 49152
    v_mfma_f32_16x16x32_bf16 v[24:27], v[248:251], a[36:39], v[24:27]
    v_mfma_f32_16x16x32_bf16 v[28:31], v[252:255], a[36:39], v[28:31]
    ds_read_b128 a[4:7], v3 offset:2048
    s_add_u32 s64, s20, 0x50180
    buffer_load_dwordx4 v2, s[4:7], s64 offen lds
    v_mfma_f32_16x16x32_bf16 v[32:35], v[248:251], a[40:43], v[32:35]
    v_mfma_f32_16x16x32_bf16 v[36:39], v[252:255], a[40:43], v[36:39]
    ds_read_b128 a[8:11], v3 offset:4096
    s_add_u32 m0, s21, 50176
    v_mfma_f32_16x16x32_bf16 v[40:43], v[248:251], a[44:47], v[40:43]
    v_mfma_f32_16x16x32_bf16 v[44:47], v[252:255], a[44:47], v[44:47]
    ds_read_b128 a[12:15], v3 offset:6144
    s_add_u32 s64, s20, 0x52980
    buffer_load_dwordx4 v2, s[4:7], s64 offen lds
    s_waitcnt lgkmcnt(4)
    v_mfma_f32_16x16x32_bf16 v[48:51], v[248:251], a[48:51], v[48:51]
    v_mfma_f32_16x16x32_bf16 v[52:55], v[252:255], a[48:51], v[52:55]
    ds_read_b128 a[16:19], v3 offset:8192
    s_add_u32 m0, s21, 51200
    v_mfma_f32_16x16x32_bf16 v[56:59], v[248:251], a[52:55], v[56:59]
    v_mfma_f32_16x16x32_bf16 v[60:63], v[252:255], a[52:55], v[60:63]
    ds_read_b128 a[20:23], v3 offset:10240
    s_add_u32 s64, s20, 0x55180
    buffer_load_dwordx4 v2, s[4:7], s64 offen lds
    v_mfma_f32_16x16x32_bf16 v[64:67], v[248:251], a[56:59], v[64:67]
    v_mfma_f32_16x16x32_bf16 v[68:71], v[252:255], a[56:59], v[68:71]
    ds_read_b128 a[24:27], v3 offset:12288
    s_add_u32 m0, s21, 52224
    v_mfma_f32_16x16x32_bf16 v[72:75], v[248:251], a[60:63], v[72:75]
    v_mfma_f32_16x16x32_bf16 v[76:79], v[252:255], a[60:63], v[76:79]
    ds_read_b128 a[28:31], v3 offset:14336
    s_add_u32 s64, s20, 0x57980
    buffer_load_dwordx4 v2, s[4:7], s64 offen lds
    s_nop 5
    s_mul_i32 s65, s17, 0
    s_add_u32 s65, s65, s22
    s_add_u32 s64, s65, 0
    v_cvt_pk_bf16_f32 v80, v16, v17
    v_cvt_pk_bf16_f32 v81, v18, v19
    v_cvt_pk_bf16_f32 v82, v20, v21
    v_cvt_pk_bf16_f32 v83, v22, v23
    buffer_store_dwordx4 v[80:83], v1, s[4:7], s64 offen sc1
    s_add_u32 s64, s65, 4096
    v_cvt_pk_bf16_f32 v84, v24, v25
    v_cvt_pk_bf16_f32 v85, v26, v27
    v_cvt_pk_bf16_f32 v86, v28, v29
    v_cvt_pk_bf16_f32 v87, v30, v31
    buffer_store_dwordx4 v[84:87], v1, s[4:7], s64 offen sc1
    s_mul_i32 s65, s17, 1
    s_add_u32 s65, s65, s22
    s_add_u32 s64, s65, 0
    v_cvt_pk_bf16_f32 v88, v32, v33
    v_cvt_pk_bf16_f32 v89, v34, v35
    v_cvt_pk_bf16_f32 v90, v36, v37
    v_cvt_pk_bf16_f32 v91, v38, v39
    buffer_store_dwordx4 v[88:91], v1, s[4:7], s64 offen sc1
    s_add_u32 s64, s65, 4096
    v_cvt_pk_bf16_f32 v92, v40, v41
    v_cvt_pk_bf16_f32 v93, v42, v43
    v_cvt_pk_bf16_f32 v94, v44, v45
    v_cvt_pk_bf16_f32 v95, v46, v47
    buffer_store_dwordx4 v[92:95], v1, s[4:7], s64 offen sc1
    s_mul_i32 s65, s17, 2
    s_add_u32 s65, s65, s22
    s_add_u32 s64, s65, 0
    v_cvt_pk_bf16_f32 v80, v48, v49
    v_cvt_pk_bf16_f32 v81, v50, v51
    v_cvt_pk_bf16_f32 v82, v52, v53
    v_cvt_pk_bf16_f32 v83, v54, v55
    buffer_store_dwordx4 v[80:83], v1, s[4:7], s64 offen sc1
    s_add_u32 s64, s65, 4096
    v_cvt_pk_bf16_f32 v84, v56, v57
    v_cvt_pk_bf16_f32 v85, v58, v59
    v_cvt_pk_bf16_f32 v86, v60, v61
    v_cvt_pk_bf16_f32 v87, v62, v63
    buffer_store_dwordx4 v[84:87], v1, s[4:7], s64 offen sc1
    s_mul_i32 s65, s17, 3
    s_add_u32 s65, s65, s22
    s_add_u32 s64, s65, 0
    v_cvt_pk_bf16_f32 v88, v64, v65
    v_cvt_pk_bf16_f32 v89, v66, v67
    v_cvt_pk_bf16_f32 v90, v68, v69
    v_cvt_pk_bf16_f32 v91, v70, v71
    buffer_store_dwordx4 v[88:91], v1, s[4:7], s64 offen sc1
    s_add_u32 s64, s65, 4096
    v_cvt_pk_bf16_f32 v92, v72, v73
    v_cvt_pk_bf16_f32 v93, v74, v75
    v_cvt_pk_bf16_f32 v94, v76, v77
    v_cvt_pk_bf16_f32 v95, v78, v79
    buffer_store_dwordx4 v[92:95], v1, s[4:7], s64 offen sc1
    s_lshl_b32 s64, s19, 1
    s_add_u32 s64, s64, s12
    s_lshl_b32 s64, s64, 9
    s_add_u32 s23, s18, s64
    s_lshl_b32 s64, s17, 3
    s_add_u32 s22, s22, s64
    s_add_u32 s19, s19, 1
    s_add_u32 s20, s20, 0x50000
    s_cmp_lg_u32 s19, 1
    s_cbranch_scc1 GE0_124
    s_waitcnt vmcnt(0)
    s_barrier
    s_cmp_lg_u32 s14, 0
    s_cbranch_scc1 GF_125
    v_mov_b32 v7, 1
    v_mov_b32 v8, 0
    s_mov_b64 exec, 1
    buffer_store_dword v7, v8, s[4:7], s23 offen sc1
    s_mov_b64 exec, -1
GF_125:
GE0_124:
    s_cmp_lt_u32 s19, 8
    s_cbranch_scc1 G_T_LOOP
    s_waitcnt vmcnt(0) lgkmcnt(0)
    s_barrier
    s_cmp_lg_u32 s14, 0
    s_cbranch_scc1 GF_126
    v_mov_b32 v7, 1
    v_mov_b32 v8, 0
    s_mov_b64 exec, 1
    buffer_store_dword v7, v8, s[4:7], s23 offen sc1
    s_mov_b64 exec, -1
GF_126:
    s_cmp_eq_u32 s3, 2
    s_cbranch_scc1 H_Q
    s_cmp_eq_u32 s12, 1
    s_cbranch_scc1 H_OUT
    s_lshl_b32 s88, s3, 5
    s_add_u32 s88, s88, s13
    s_mov_b32 s29, 0
    v_lshlrev_b32 v1, 4, v0
    s_mov_b32 s65, 0
CW_127:
    buffer_load_dwordx2 v[8:9], off, s[60:63], 0 offset:132 sc1
    s_add_u32 s65, s65, 1
    s_waitcnt vmcnt(0)
    v_readfirstlane_b32 s66, v8
    v_readfirstlane_b32 s67, v9
    s_min_u32 s64, s66, s67
    s_cmp_lg_u32 s64, 0
    s_cbranch_scc1 CWD_128
    s_cmp_gt_u32 s65, 65536
    s_cbranch_scc1 CWD_128
    s_sleep 4
    s_branch CW_127
CWD_128:
    s_sub_u32 s66, s66, 1
    s_and_b32 s66, s66, 3
    s_sub_u32 s67, s67, 1
    s_and_b32 s67, s67, 3
    s_mov_b32 s64, s66
    s_mov_b32 s65, s67
    s_and_b32 s64, s64, 3
    s_lshl_b32 s64, s64, 13
    s_and_b32 s65, s65, 3
    s_lshl_b32 s65, s65, 13
    s_add_u32 s25, s64, 0x6000000
    s_add_u32 s30, s65, 0x6200000
    v_bfe_u32 v4, v0, 3, 1
    v_mul_u32_u24 v2, 0x8000, v4
    v_lshrrev_b32 v4, 5, v0
    v_lshl_add_u32 v2, v4, 8, v2
    v_bfe_u32 v4, v0, 4, 1
    v_lshl_add_u32 v2, v4, 7, v2
    v_and_b32 v4, 7, v0
    v_lshl_add_u32 v2, v4, 4, v2
    v_bfe_u32 v4, v0, 3, 1
    v_lshlrev_b32 v3, 16, v4
    v_lshrrev_b32 v4, 4, v0
    v_lshl_add_u32 v3, v4, 7, v3
    v_and_b32 v4, 7, v0
    v_lshl_add_u32 v3, v4, 4, v3
    s_lshl_b32 s26, s13, 11
    s_lshl_b32 s64, s14, 9
    s_add_u32 s26, s26, s64
    s_add_u32 s26, s26, 0x640000
    s_lshl_b32 s27, s13, 3
    s_add_u32 s27, s27, 0x294000
    s_mov_b32 s28, 0x29a000
    s_mov_b32 s24, 0
    v_lshlrev_b32 v6, 7, v0
MKT_LOOP:
    s_cmp_lg_u32 s24, 10
    s_cbranch_scc1 MKH_129
    v_mov_b32 v10, v2
    v_mov_b32 v11, v3
    s_cmp_ge_u32 s88, 60
    s_cbranch_scc1 NOWO_130
    s_mov_b32 s89, s13
    s_mul_hi_u32 s65, s88, 0xccccccd
    s_mul_i32 s65, s65, 20
    s_sub_u32 s13, s88, s65
    s_load_dwordx2 s[44:45], s[0:1], 40
    s_mov_b32 s46, 0x500000
    s_mov_b32 s47, 0x00020000
    s_waitcnt lgkmcnt(0)
    s_mul_i32 s21, s14, 36864
    v_lshrrev_b32 v7, 2, v0
    v_mul_u32_u24 v4, 1280, v7
    v_bfe_u32 v7, v0, 4, 1
    v_lshlrev_b32 v7, 1, v7
    v_and_b32 v8, 3, v0
    v_xor_b32 v7, v7, v8
    v_lshl_add_u32 v4, v7, 4, v4
    v_lshrrev_b32 v7, 4, v0
    v_lshlrev_b32 v2, 8, v7
    v_bfe_u32 v7, v0, 2, 2
    v_lshl_add_u32 v2, v7, 6, v2
    v_and_b32 v7, 3, v0
    v_lshl_add_u32 v2, v7, 3, v2
    v_add_u32 v2, s21, v2
    v_bfe_u32 v7, v0, 4, 1
    v_lshlrev_b32 v7, 5, v7
    v_sub_u32 v3, 32, v7
    v_add_u32 v3, v3, v2
    v_add_u32 v2, v2, v7
    s_mul_i32 s65, s14, 1310720
    s_lshl_b32 s66, s13, 6
    s_add_u32 s65, s65, s66
    s_add_u32 m0, s21, 0
    s_add_u32 s64, s65, 0x0
    buffer_load_dwordx4 v4, s[44:47], s64 offen lds
    s_add_u32 m0, s21, 1024
    s_add_u32 s64, s65, 0x5000
    buffer_load_dwordx4 v4, s[44:47], s64 offen lds
    s_add_u32 m0, s21, 2048
    s_add_u32 s64, s65, 0xa000
    buffer_load_dwordx4 v4, s[44:47], s64 offen lds
    s_add_u32 m0, s21, 3072
    s_add_u32 s64, s65, 0xf000
    buffer_load_dwordx4 v4, s[44:47], s64 offen lds
    s_add_u32 m0, s21, 4096
    s_add_u32 s64, s65, 0x14000
    buffer_load_dwordx4 v4, s[44:47], s64 offen lds
    s_add_u32 m0, s21, 5120
    s_add_u32 s64, s65, 0x19000
    buffer_load_dwordx4 v4, s[44:47], s64 offen lds
    s_add_u32 m0, s21, 6144
    s_add_u32 s64, s65, 0x1e000
    buffer_load_dwordx4 v4, s[44:47], s64 offen lds
    s_add_u32 m0, s21, 7168
    s_add_u32 s64, s65, 0x23000
    buffer_load_dwordx4 v4, s[44:47], s64 offen lds
    s_add_u32 m0, s21, 8192
    s_add_u32 s64, s65, 0x28000
    buffer_load_dwordx4 v4, s[44:47], s64 offen lds
    s_add_u32 m0, s21, 9216
    s_add_u32 s64, s65, 0x2d000
    buffer_load_dwordx4 v4, s[44:47], s64 offen lds
    s_add_u32 m0, s21, 10240
    s_add_u32 s64, s65, 0x32000
    buffer_load_dwordx4 v4, s[44:47], s64 offen lds
    s_add_u32 m0, s21, 11264
    s_add_u32 s64, s65, 0x37000
    buffer_load_dwordx4 v4, s[44:47], s64 offen lds
    s_add_u32 m0, s21, 12288
    s_add_u32 s64, s65, 0x3c000
    buffer_load_dwordx4 v4, s[44:47], s64 offen lds
    s_add_u32 m0, s21, 13312
    s_add_u32 s64, s65, 0x41000
    buffer_load_dwordx4 v4, s[44:47], s64 offen lds
    s_add_u32 m0, s21, 14336
    s_add_u32 s64, s65, 0x46000
    buffer_load_dwordx4 v4, s[44:47], s64 offen lds
    s_add_u32 m0, s21, 15360
    s_add_u32 s64, s65, 0x4b000
    buffer_load_dwordx4 v4, s[44:47], s64 offen lds
    s_add_u32 m0, s21, 16384
    s_add_u32 s64, s65, 0x50000
    buffer_load_dwordx4 v4, s[44:47], s64 offen lds
    s_add_u32 m0, s21, 17408
    s_add_u32 s64, s65, 0x55000
    buffer_load_dwordx4 v4, s[44:47], s64 offen lds
    s_add_u32 m0, s21, 18432
    s_add_u32 s64, s65, 0x5a000
    buffer_load_dwordx4 v4, s[44:47], s64 offen lds
    s_add_u32 m0, s21, 19456
    s_add_u32 s64, s65, 0x5f000
    buffer_load_dwordx4 v4, s[44:47], s64 offen lds
    s_add_u32 m0, s21, 20480
    s_add_u32 s64, s65, 0x64000
    buffer_load_dwordx4 v4, s[44:47], s64 offen lds
    s_add_u32 m0, s21, 21504
    s_add_u32 s64, s65, 0x69000
    buffer_load_dwordx4 v4, s[44:47], s64 offen lds
    s_add_u32 m0, s21, 22528
    s_add_u32 s64, s65, 0x6e000
    buffer_load_dwordx4 v4, s[44:47], s64 offen lds
    s_add_u32 m0, s21, 23552
    s_add_u32 s64, s65, 0x73000
    buffer_load_dwordx4 v4, s[44:47], s64 offen lds
    s_add_u32 m0, s21, 24576
    s_add_u32 s64, s65, 0x78000
    buffer_load_dwordx4 v4, s[44:47], s64 offen lds
    s_add_u32 m0, s21, 25600
    s_add_u32 s64, s65, 0x7d000
    buffer_load_dwordx4 v4, s[44:47], s64 offen lds
    s_add_u32 m0, s21, 26624
    s_add_u32 s64, s65, 0x82000
    buffer_load_dwordx4 v4, s[44:47], s64 offen lds
    s_add_u32 m0, s21, 27648
    s_add_u32 s64, s65, 0x87000
    buffer_load_dwordx4 v4, s[44:47], s64 offen lds
    s_add_u32 m0, s21, 28672
    s_add_u32 s64, s65, 0x8c000
    buffer_load_dwordx4 v4, s[44:47], s64 offen lds
    s_add_u32 m0, s21, 29696
    s_add_u32 s64, s65, 0x91000
    buffer_load_dwordx4 v4, s[44:47], s64 offen lds
    s_add_u32 m0, s21, 30720
    s_add_u32 s64, s65, 0x96000
    buffer_load_dwordx4 v4, s[44:47], s64 offen lds
    s_add_u32 m0, s21, 31744
    s_add_u32 s64, s65, 0x9b000
    buffer_load_dwordx4 v4, s[44:47], s64 offen lds
    s_add_u32 m0, s21, 32768
    s_add_u32 s64, s65, 0xa0000
    buffer_load_dwordx4 v4, s[44:47], s64 offen lds
    s_add_u32 m0, s21, 33792
    s_add_u32 s64, s65, 0xa5000
    buffer_load_dwordx4 v4, s[44:47], s64 offen lds
    s_add_u32 m0, s21, 34816
    s_add_u32 s64, s65, 0xaa000
    buffer_load_dwordx4 v4, s[44:47], s64 offen lds
    s_add_u32 m0, s21, 35840
    s_add_u32 s64, s65, 0xaf000
    buffer_load_dwordx4 v4, s[44:47], s64 offen lds
    s_waitcnt vmcnt(32)
    ds_read_b64_tr_b16 a[0:1], v2 offset:0
    ds_read_b64_tr_b16 a[2:3], v2 offset:1024
    ds_read_b64_tr_b16 a[4:5], v3 offset:0
    ds_read_b64_tr_b16 a[6:7], v3 offset:1024
    ds_read_b64_tr_b16 a[8:9], v2 offset:2048
    ds_read_b64_tr_b16 a[10:11], v2 offset:3072
    ds_read_b64_tr_b16 a[12:13], v3 offset:2048
    ds_read_b64_tr_b16 a[14:15], v3 offset:3072
    s_waitcnt lgkmcnt(0)
    s_add_u32 m0, s21, 0
    s_add_u32 s64, s65, 0xb4000
    buffer_load_dwordx4 v4, s[44:47], s64 offen lds
    s_add_u32 m0, s21, 1024
    s_add_u32 s64, s65, 0xb9000
    buffer_load_dwordx4 v4, s[44:47], s64 offen lds
    s_add_u32 m0, s21, 2048
    s_add_u32 s64, s65, 0xbe000
    buffer_load_dwordx4 v4, s[44:47], s64 offen lds
    s_add_u32 m0, s21, 3072
    s_add_u32 s64, s65, 0xc3000
    buffer_load_dwordx4 v4, s[44:47], s64 offen lds
    s_waitcnt vmcnt(32)
    ds_read_b64_tr_b16 a[16:17], v2 offset:4096
    ds_read_b64_tr_b16 a[18:19], v2 offset:5120
    ds_read_b64_tr_b16 a[20:21], v3 offset:4096
    ds_read_b64_tr_b16 a[22:23], v3 offset:5120
    ds_read_b64_tr_b16 a[24:25], v2 offset:6144
    ds_read_b64_tr_b16 a[26:27], v2 offset:7168
    ds_read_b64_tr_b16 a[28:29], v3 offset:6144
    ds_read_b64_tr_b16 a[30:31], v3 offset:7168
    s_waitcnt lgkmcnt(0)
    s_add_u32 m0, s21, 4096
    s_add_u32 s64, s65, 0xc8000
    buffer_load_dwordx4 v4, s[44:47], s64 offen lds
    s_add_u32 m0, s21, 5120
    s_add_u32 s64, s65, 0xcd000
    buffer_load_dwordx4 v4, s[44:47], s64 offen lds
    s_add_u32 m0, s21, 6144
    s_add_u32 s64, s65, 0xd2000
    buffer_load_dwordx4 v4, s[44:47], s64 offen lds
    s_add_u32 m0, s21, 7168
    s_add_u32 s64, s65, 0xd7000
    buffer_load_dwordx4 v4, s[44:47], s64 offen lds
    s_waitcnt vmcnt(32)
    ds_read_b64_tr_b16 a[32:33], v2 offset:8192
    ds_read_b64_tr_b16 a[34:35], v2 offset:9216
    ds_read_b64_tr_b16 a[36:37], v3 offset:8192
    ds_read_b64_tr_b16 a[38:39], v3 offset:9216
    ds_read_b64_tr_b16 a[40:41], v2 offset:10240
    ds_read_b64_tr_b16 a[42:43], v2 offset:11264
    ds_read_b64_tr_b16 a[44:45], v3 offset:10240
    ds_read_b64_tr_b16 a[46:47], v3 offset:11264
    s_waitcnt lgkmcnt(0)
    s_add_u32 m0, s21, 8192
    s_add_u32 s64, s65, 0xdc000
    buffer_load_dwordx4 v4, s[44:47], s64 offen lds
    s_add_u32 m0, s21, 9216
    s_add_u32 s64, s65, 0xe1000
    buffer_load_dwordx4 v4, s[44:47], s64 offen lds
    s_add_u32 m0, s21, 10240
    s_add_u32 s64, s65, 0xe6000
    buffer_load_dwordx4 v4, s[44:47], s64 offen lds
    s_add_u32 m0, s21, 11264
    s_add_u32 s64, s65, 0xeb000
    buffer_load_dwordx4 v4, s[44:47], s64 offen lds
    s_waitcnt vmcnt(32)
    ds_read_b64_tr_b16 a[48:49], v2 offset:12288
    ds_read_b64_tr_b16 a[50:51], v2 offset:13312
    ds_read_b64_tr_b16 a[52:53], v3 offset:12288
    ds_read_b64_tr_b16 a[54:55], v3 offset:13312
    ds_read_b64_tr_b16 a[56:57], v2 offset:14336
    ds_read_b64_tr_b16 a[58:59], v2 offset:15360
    ds_read_b64_tr_b16 a[60:61], v3 offset:14336
    ds_read_b64_tr_b16 a[62:63], v3 offset:15360
    s_waitcnt lgkmcnt(0)
    s_add_u32 m0, s21, 12288
    s_add_u32 s64, s65, 0xf0000
    buffer_load_dwordx4 v4, s[44:47], s64 offen lds
    s_add_u32 m0, s21, 13312
    s_add_u32 s64, s65, 0xf5000
    buffer_load_dwordx4 v4, s[44:47], s64 offen lds
    s_add_u32 m0, s21, 14336
    s_add_u32 s64, s65, 0xfa000
    buffer_load_dwordx4 v4, s[44:47], s64 offen lds
    s_add_u32 m0, s21, 15360
    s_add_u32 s64, s65, 0xff000
    buffer_load_dwordx4 v4, s[44:47], s64 offen lds
    s_waitcnt vmcnt(32)
    ds_read_b64_tr_b16 a[64:65], v2 offset:16384
    ds_read_b64_tr_b16 a[66:67], v2 offset:17408
    ds_read_b64_tr_b16 a[68:69], v3 offset:16384
    ds_read_b64_tr_b16 a[70:71], v3 offset:17408
    ds_read_b64_tr_b16 a[72:73], v2 offset:18432
    ds_read_b64_tr_b16 a[74:75], v2 offset:19456
    ds_read_b64_tr_b16 a[76:77], v3 offset:18432
    ds_read_b64_tr_b16 a[78:79], v3 offset:19456
    s_waitcnt lgkmcnt(0)
    s_add_u32 m0, s21, 16384
    s_add_u32 s64, s65, 0x104000
    buffer_load_dwordx4 v4, s[44:47], s64 offen lds
    s_add_u32 m0, s21, 17408
    s_add_u32 s64, s65, 0x109000
    buffer_load_dwordx4 v4, s[44:47], s64 offen lds
    s_add_u32 m0, s21, 18432
    s_add_u32 s64, s65, 0x10e000
    buffer_load_dwordx4 v4, s[44:47], s64 offen lds
    s_add_u32 m0, s21, 19456
    s_add_u32 s64, s65, 0x113000
    buffer_load_dwordx4 v4, s[44:47], s64 offen lds
    s_waitcnt vmcnt(32)
    ds_read_b64_tr_b16 a[80:81], v2 offset:20480
    ds_read_b64_tr_b16 a[82:83], v2 offset:21504
    ds_read_b64_tr_b16 a[84:85], v3 offset:20480
    ds_read_b64_tr_b16 a[86:87], v3 offset:21504
    ds_read_b64_tr_b16 a[88:89], v2 offset:22528
    ds_read_b64_tr_b16 a[90:91], v2 offset:23552
    ds_read_b64_tr_b16 a[92:93], v3 offset:22528
    ds_read_b64_tr_b16 a[94:95], v3 offset:23552
    s_waitcnt lgkmcnt(0)
    s_add_u32 m0, s21, 20480
    s_add_u32 s64, s65, 0x118000
    buffer_load_dwordx4 v4, s[44:47], s64 offen lds
    s_add_u32 m0, s21, 21504
    s_add_u32 s64, s65, 0x11d000
    buffer_load_dwordx4 v4, s[44:47], s64 offen lds
    s_add_u32 m0, s21, 22528
    s_add_u32 s64, s65, 0x122000
    buffer_load_dwordx4 v4, s[44:47], s64 offen lds
    s_add_u32 m0, s21, 23552
    s_add_u32 s64, s65, 0x127000
    buffer_load_dwordx4 v4, s[44:47], s64 offen lds
    s_waitcnt vmcnt(32)
    ds_read_b64_tr_b16 a[96:97], v2 offset:24576
    ds_read_b64_tr_b16 a[98:99], v2 offset:25600
    ds_read_b64_tr_b16 a[100:101], v3 offset:24576
    ds_read_b64_tr_b16 a[102:103], v3 offset:25600
    ds_read_b64_tr_b16 a[104:105], v2 offset:26624
    ds_read_b64_tr_b16 a[106:107], v2 offset:27648
    ds_read_b64_tr_b16 a[108:109], v3 offset:26624
    ds_read_b64_tr_b16 a[110:111], v3 offset:27648
    s_waitcnt lgkmcnt(0)
    s_add_u32 m0, s21, 24576
    s_add_u32 s64, s65, 0x12c000
    buffer_load_dwordx4 v4, s[44:47], s64 offen lds
    s_add_u32 m0, s21, 25600
    s_add_u32 s64, s65, 0x131000
    buffer_load_dwordx4 v4, s[44:47], s64 offen lds
    s_add_u32 m0, s21, 26624
    s_add_u32 s64, s65, 0x136000
    buffer_load_dwordx4 v4, s[44:47], s64 offen lds
    s_add_u32 m0, s21, 27648
    s_add_u32 s64, s65, 0x13b000
    buffer_load_dwordx4 v4, s[44:47], s64 offen lds
    s_waitcnt vmcnt(32)
    ds_read_b64_tr_b16 a[112:113], v2 offset:28672
    ds_read_b64_tr_b16 a[114:115], v2 offset:29696
    ds_read_b64_tr_b16 a[116:117], v3 offset:28672
    ds_read_b64_tr_b16 a[118:119], v3 offset:29696
    ds_read_b64_tr_b16 a[120:121], v2 offset:30720
    ds_read_b64_tr_b16 a[122:123], v2 offset:31744
    ds_read_b64_tr_b16 a[124:125], v3 offset:30720
    ds_read_b64_tr_b16 a[126:127], v3 offset:31744
    s_waitcnt lgkmcnt(0)
    s_waitcnt vmcnt(28)
    ds_read_b64_tr_b16 a[128:129], v2 offset:32768
    ds_read_b64_tr_b16 a[130:131], v2 offset:33792
    ds_read_b64_tr_b16 a[132:133], v3 offset:32768
    ds_read_b64_tr_b16 a[134:135], v3 offset:33792
    ds_read_b64_tr_b16 a[136:137], v2 offset:34816
    ds_read_b64_tr_b16 a[138:139], v2 offset:35840
    ds_read_b64_tr_b16 a[140:141], v3 offset:34816
    ds_read_b64_tr_b16 a[142:143], v3 offset:35840
    s_waitcnt lgkmcnt(0)
    s_waitcnt vmcnt(24)
    ds_read_b64_tr_b16 a[144:145], v2 offset:0
    ds_read_b64_tr_b16 a[146:147], v2 offset:1024
    ds_read_b64_tr_b16 a[148:149], v3 offset:0
    ds_read_b64_tr_b16 a[150:151], v3 offset:1024
    ds_read_b64_tr_b16 a[152:153], v2 offset:2048
    ds_read_b64_tr_b16 a[154:155], v2 offset:3072
    ds_read_b64_tr_b16 a[156:157], v3 offset:2048
    ds_read_b64_tr_b16 a[158:159], v3 offset:3072
    s_waitcnt lgkmcnt(0)
    s_waitcnt vmcnt(20)
    ds_read_b64_tr_b16 a[160:161], v2 offset:4096
    ds_read_b64_tr_b16 a[162:163], v2 offset:5120
    ds_read_b64_tr_b16 a[164:165], v3 offset:4096
    ds_read_b64_tr_b16 a[166:167], v3 offset:5120
    ds_read_b64_tr_b16 a[168:169], v2 offset:6144
    ds_read_b64_tr_b16 a[170:171], v2 offset:7168
    ds_read_b64_tr_b16 a[172:173], v3 offset:6144
    ds_read_b64_tr_b16 a[174:175], v3 offset:7168
    s_waitcnt lgkmcnt(0)
    s_waitcnt vmcnt(16)
    ds_read_b64_tr_b16 a[176:177], v2 offset:8192
    ds_read_b64_tr_b16 a[178:179], v2 offset:9216
    ds_read_b64_tr_b16 a[180:181], v3 offset:8192
    ds_read_b64_tr_b16 a[182:183], v3 offset:9216
    ds_read_b64_tr_b16 a[184:185], v2 offset:10240
    ds_read_b64_tr_b16 a[186:187], v2 offset:11264
    ds_read_b64_tr_b16 a[188:189], v3 offset:10240
    ds_read_b64_tr_b16 a[190:191], v3 offset:11264
    s_waitcnt lgkmcnt(0)
    s_waitcnt vmcnt(12)
    ds_read_b64_tr_b16 a[192:193], v2 offset:12288
    ds_read_b64_tr_b16 a[194:195], v2 offset:13312
    ds_read_b64_tr_b16 a[196:197], v3 offset:12288
    ds_read_b64_tr_b16 a[198:199], v3 offset:13312
    ds_read_b64_tr_b16 a[200:201], v2 offset:14336
    ds_read_b64_tr_b16 a[202:203], v2 offset:15360
    ds_read_b64_tr_b16 a[204:205], v3 offset:14336
    ds_read_b64_tr_b16 a[206:207], v3 offset:15360
    s_waitcnt lgkmcnt(0)
    s_waitcnt vmcnt(8)
    ds_read_b64_tr_b16 a[208:209], v2 offset:16384
    ds_read_b64_tr_b16 a[210:211], v2 offset:17408
    ds_read_b64_tr_b16 a[212:213], v3 offset:16384
    ds_read_b64_tr_b16 a[214:215], v3 offset:17408
    ds_read_b64_tr_b16 a[216:217], v2 offset:18432
    ds_read_b64_tr_b16 a[218:219], v2 offset:19456
    ds_read_b64_tr_b16 a[220:221], v3 offset:18432
    ds_read_b64_tr_b16 a[222:223], v3 offset:19456
    s_waitcnt lgkmcnt(0)
    s_waitcnt vmcnt(4)
    ds_read_b64_tr_b16 a[224:225], v2 offset:20480
    ds_read_b64_tr_b16 a[226:227], v2 offset:21504
    ds_read_b64_tr_b16 a[228:229], v3 offset:20480
    ds_read_b64_tr_b16 a[230:231], v3 offset:21504
    ds_read_b64_tr_b16 a[232:233], v2 offset:22528
    ds_read_b64_tr_b16 a[234:235], v2 offset:23552
    ds_read_b64_tr_b16 a[236:237], v3 offset:22528
    ds_read_b64_tr_b16 a[238:239], v3 offset:23552
    s_waitcnt lgkmcnt(0)
    s_waitcnt vmcnt(0)
    ds_read_b64_tr_b16 a[240:241], v2 offset:24576
    ds_read_b64_tr_b16 a[242:243], v2 offset:25600
    ds_read_b64_tr_b16 a[244:245], v3 offset:24576
    ds_read_b64_tr_b16 a[246:247], v3 offset:25600
    ds_read_b64_tr_b16 a[248:249], v2 offset:26624
    ds_read_b64_tr_b16 a[250:251], v2 offset:27648
    ds_read_b64_tr_b16 a[252:253], v3 offset:26624
    ds_read_b64_tr_b16 a[254:255], v3 offset:27648
    s_waitcnt lgkmcnt(0)
    s_mov_b32 s13, s89
NOWO_130:
    v_mov_b32 v2, v10
    v_mov_b32 v3, v11
MKH_129:
    s_cmp_lg_u32 s24, 31
    s_mov_b64 exec, 0xf
    s_cbranch_scc1 MKL_131
    s_mov_b64 exec, -1
    v_bfe_u32 v4, v0, 3, 1
    v_mul_u32_u24 v4, 0x8000, v4
    v_sub_u32 v2, v2, v4
    s_mov_b64 exec, 3
MKL_131:
MKT_M_132:
    buffer_load_dword v5, v6, s[4:7], s28 offen sc1
    s_add_u32 s29, s29, 1
    s_waitcnt vmcnt(0)
    v_cmp_eq_u32 vcc, 0, v5
    s_cbranch_vccz MKT_MD_133
    s_cmp_gt_u32 s29, 262144
    s_cbranch_scc1 MKT_MD_133
    s_sleep 1
    s_branch MKT_M_132
MKT_MD_133:
    s_mov_b64 exec, -1
MKR_134:
    s_add_u32 s64, s25, 0x0
    buffer_load_dwordx4 v[16:19], v2, s[4:7], s64 offen sc1
    s_add_u32 s64, s25, 0x200
    buffer_load_dwordx4 v[20:23], v2, s[4:7], s64 offen sc1
    s_add_u32 s64, s25, 0x400
    buffer_load_dwordx4 v[24:27], v2, s[4:7], s64 offen sc1
    s_add_u32 s64, s25, 0x600
    buffer_load_dwordx4 v[28:31], v2, s[4:7], s64 offen sc1
    s_add_u32 s64, s25, 0x800
    buffer_load_dwordx4 v[32:35], v2, s[4:7], s64 offen sc1
    s_add_u32 s64, s25, 0xa00
    buffer_load_dwordx4 v[36:39], v2, s[4:7], s64 offen sc1
    s_add_u32 s64, s25, 0xc00
    buffer_load_dwordx4 v[40:43], v2, s[4:7], s64 offen sc1
    s_add_u32 s64, s25, 0xe00
    buffer_load_dwordx4 v[44:47], v2, s[4:7], s64 offen sc1
    s_add_u32 s64, s25, 0x1000
    buffer_load_dwordx4 v[48:51], v2, s[4:7], s64 offen sc1
    s_add_u32 s64, s25, 0x1200
    buffer_load_dwordx4 v[52:55], v2, s[4:7], s64 offen sc1
    s_add_u32 s64, s30, 0x0
    buffer_load_dwordx4 v[56:59], v2, s[4:7], s64 offen sc1
    s_add_u32 s64, s30, 0x200
    buffer_load_dwordx4 v[60:63], v2, s[4:7], s64 offen sc1
    s_add_u32 s64, s30, 0x400
    buffer_load_dwordx4 v[64:67], v2, s[4:7], s64 offen sc1
    s_add_u32 s64, s30, 0x600
    buffer_load_dwordx4 v[68:71], v2, s[4:7], s64 offen sc1
    s_add_u32 s64, s30, 0x800
    buffer_load_dwordx4 v[72:75], v2, s[4:7], s64 offen sc1
    s_add_u32 s64, s30, 0xa00
    buffer_load_dwordx4 v[76:79], v2, s[4:7], s64 offen sc1
    s_add_u32 s64, s30, 0xc00
    buffer_load_dwordx4 v[80:83], v2, s[4:7], s64 offen sc1
    s_add_u32 s64, s30, 0xe00
    buffer_load_dwordx4 v[84:87], v2, s[4:7], s64 offen sc1
    s_add_u32 s64, s30, 0x1000
    buffer_load_dwordx4 v[88:91], v2, s[4:7], s64 offen sc1
    s_add_u32 s64, s30, 0x1200
    buffer_load_dwordx4 v[92:95], v2, s[4:7], s64 offen sc1
    s_add_u32 s29, s29, 1
    s_waitcnt vmcnt(0)
    v_max3_u32 v4, v19, v23, v27
    v_max3_u32 v4, v4, v31, v35
    v_max3_u32 v4, v4, v39, v43
    v_max3_u32 v4, v4, v47, v51
    v_max3_u32 v4, v4, v55, v59
    v_max3_u32 v4, v4, v63, v67
    v_max3_u32 v4, v4, v71, v75
    v_max3_u32 v4, v4, v79, v83
    v_max3_u32 v4, v4, v87, v91
    v_max_u32 v4, v4, v95
    v_cmp_eq_u32 vcc, -1, v4
    s_cbranch_vccz MKO_135
    s_cmp_gt_u32 s29, 262144
    s_cbranch_scc0 MKR_134
MKO_135:
    v_mfma_f32_16x16x32_bf16 v[8:11], v[96:99], v[16:19], 0
    v_mfma_f32_16x16x32_bf16 v[12:15], v[100:103], v[16:19], 0
    v_mfma_f32_16x16x32_bf16 v[8:11], v[104:107], v[20:23], v[8:11]
    v_mfma_f32_16x16x32_bf16 v[12:15], v[108:111], v[20:23], v[12:15]
    v_mfma_f32_16x16x32_bf16 v[8:11], v[112:115], v[24:27], v[8:11]
    v_mfma_f32_16x16x32_bf16 v[12:15], v[116:119], v[24:27], v[12:15]
    v_mfma_f32_16x16x32_bf16 v[8:11], v[120:123], v[28:31], v[8:11]
    v_mfma_f32_16x16x32_bf16 v[12:15], v[124:127], v[28:31], v[12:15]
    v_mfma_f32_16x16x32_bf16 v[8:11], v[128:131], v[32:35], v[8:11]
    v_mfma_f32_16x16x32_bf16 v[12:15], v[132:135], v[32:35], v[12:15]
    v_mfma_f32_16x16x32_bf16 v[8:11], v[136:139], v[36:39], v[8:11]
    v_mfma_f32_16x16x32_bf16 v[12:15], v[140:143], v[36:39], v[12:15]
    v_mfma_f32_16x16x32_bf16 v[8:11], v[144:147], v[40:43], v[8:11]
    v_mfma_f32_16x16x32_bf16 v[12:15], v[148:151], v[40:43], v[12:15]
    v_mfma_f32_16x16x32_bf16 v[8:11], v[152:155], v[44:47], v[8:11]
    v_mfma_f32_16x16x32_bf16 v[12:15], v[156:159], v[44:47], v[12:15]
    v_mfma_f32_16x16x32_bf16 v[8:11], v[160:163], v[48:51], v[8:11]
    v_mfma_f32_16x16x32_bf16 v[12:15], v[164:167], v[48:51], v[12:15]
    v_mfma_f32_16x16x32_bf16 v[8:11], v[168:171], v[52:55], v[8:11]
    v_mfma_f32_16x16x32_bf16 v[12:15], v[172:175], v[52:55], v[12:15]
    v_mfma_f32_16x16x32_bf16 v[8:11], v[176:179], v[56:59], v[8:11]
    v_mfma_f32_16x16x32_bf16 v[12:15], v[180:183], v[56:59], v[12:15]
    v_mfma_f32_16x16x32_bf16 v[8:11], v[184:187], v[60:63], v[8:11]
    v_mfma_f32_16x16x32_bf16 v[12:15], v[188:191], v[60:63], v[12:15]
    v_mfma_f32_16x16x32_bf16 v[8:11], v[192:195], v[64:67], v[8:11]
    v_mfma_f32_16x16x32_bf16 v[12:15], v[196:199], v[64:67], v[12:15]
    v_mfma_f32_16x16x32_bf16 v[8:11], v[200:203], v[68:71], v[8:11]
    v_mfma_f32_16x16x32_bf16 v[12:15], v[204:207], v[68:71], v[12:15]
    v_mfma_f32_16x16x32_bf16 v[8:11], v[208:211], v[72:75], v[8:11]
    v_mfma_f32_16x16x32_bf16 v[12:15], v[212:215], v[72:75], v[12:15]
    v_mfma_f32_16x16x32_bf16 v[8:11], v[216:219], v[76:79], v[8:11]
    v_mfma_f32_16x16x32_bf16 v[12:15], v[220:223], v[76:79], v[12:15]
    v_mfma_f32_16x16x32_bf16 v[8:11], v[224:227], v[80:83], v[8:11]
    v_mfma_f32_16x16x32_bf16 v[12:15], v[228:231], v[80:83], v[12:15]
    v_mfma_f32_16x16x32_bf16 v[8:11], v[232:235], v[84:87], v[8:11]
    v_mfma_f32_16x16x32_bf16 v[12:15], v[236:239], v[84:87], v[12:15]
    v_mfma_f32_16x16x32_bf16 v[8:11], v[240:243], v[88:91], v[8:11]
    v_mfma_f32_16x16x32_bf16 v[12:15], v[244:247], v[88:91], v[12:15]
    v_mfma_f32_16x16x32_bf16 v[8:11], v[248:251], v[92:95], v[8:11]
    v_mfma_f32_16x16x32_bf16 v[12:15], v[252:255], v[92:95], v[12:15]
    s_nop 7
    v_cvt_pk_bf16_f32 v16, v8, v9
    v_cvt_pk_bf16_f32 v17, v10, v11
    v_cvt_pk_bf16_f32 v18, v12, v13
    v_cvt_pk_bf16_f32 v19, v14, v15
    buffer_store_dwordx4 v[16:19], v3, s[4:7], s26 offen sc1
    s_waitcnt vmcnt(0)
    s_barrier
    s_cmp_lg_u32 s14, 0
    s_cbranch_scc1 GF_136
    v_mov_b32 v7, 1
    v_mov_b32 v8, 0
    s_mov_b64 exec, 1
    buffer_store_dword v7, v8, s[4:7], s27 offen sc1
    s_mov_b64 exec, -1
GF_136:
    s_add_u32 s25, s25, 0x10000
    s_add_u32 s30, s30, 0x10000
    s_add_u32 s26, s26, 0x20000
    s_add_u32 s27, s27, 256
    s_add_u32 s28, s28, 512
    s_add_u32 s24, s24, 1
    s_cmp_lt_u32 s24, 32
    s_cbranch_scc1 MKT_LOOP
    s_cmp_ge_u32 s88, 60
    s_cbranch_scc1 M_EXIT
    s_branch H_EXTRA
G_N:
    v_lshrrev_b32 v6, 5, v0
    v_mul_u32_u24 v7, 40960, v6
    v_bfe_u32 v6, v0, 4, 1
    v_lshl_add_u32 v7, v6, 11, v7
    v_lshlrev_b32 v8, 3, v6
    v_bfe_u32 v6, v0, 2, 2
    v_lshl_add_u32 v7, v6, 8, v7
    v_lshl_add_u32 v8, v6, 1, v8
    v_and_b32 v6, 1, v0
    v_lshl_add_u32 v7, v6, 3, v7
    v_bfe_u32 v6, v0, 1, 1
    s_lshl_b32 s64, s14, 2
    v_add_u32 v10, s64, v6
    v_add_u32 v6, 0, v10
    v_xor_b32 v6, v6, v8
    v_lshl_add_u32 v3, v6, 4, v7
    v_add_u32 v4, 81920, v3
    v_add_u32 v6, 2, v10
    v_xor_b32 v6, v6, v8
    v_lshl_add_u32 v5, v6, 4, v7
    v_add_u32 v9, 81920, v5
    s_waitcnt vmcnt(0)
    s_barrier
    ds_read_b64_tr_b16 v[96:97], v3 offset:0
    ds_read_b64_tr_b16 v[98:99], v3 offset:1024
    ds_read_b64_tr_b16 v[100:101], v5 offset:0
    ds_read_b64_tr_b16 v[102:103], v5 offset:1024
    ds_read_b64_tr_b16 v[104:105], v4 offset:0
    ds_read_b64_tr_b16 v[106:107], v4 offset:1024
    ds_read_b64_tr_b16 v[108:109], v9 offset:0
    ds_read_b64_tr_b16 v[110:111], v9 offset:1024
    ds_read_b64_tr_b16 v[112:113], v3 offset:4096
    ds_read_b64_tr_b16 v[114:115], v3 offset:5120
    ds_read_b64_tr_b16 v[116:117], v5 offset:4096
    ds_read_b64_tr_b16 v[118:119], v5 offset:5120
    ds_read_b64_tr_b16 v[120:121], v4 offset:4096
    ds_read_b64_tr_b16 v[122:123], v4 offset:5120
    ds_read_b64_tr_b16 v[124:125], v9 offset:4096
    ds_read_b64_tr_b16 v[126:127], v9 offset:5120
    s_waitcnt lgkmcnt(4)
    ds_read_b64_tr_b16 v[128:129], v3 offset:8192
    ds_read_b64_tr_b16 v[130:131], v3 offset:9216
    ds_read_b64_tr_b16 v[132:133], v5 offset:8192
    ds_read_b64_tr_b16 v[134:135], v5 offset:9216
    ds_read_b64_tr_b16 v[136:137], v4 offset:8192
    ds_read_b64_tr_b16 v[138:139], v4 offset:9216
    ds_read_b64_tr_b16 v[140:141], v9 offset:8192
    ds_read_b64_tr_b16 v[142:143], v9 offset:9216
    ds_read_b64_tr_b16 v[144:145], v3 offset:12288
    ds_read_b64_tr_b16 v[146:147], v3 offset:13312
    ds_read_b64_tr_b16 v[148:149], v5 offset:12288
    ds_read_b64_tr_b16 v[150:151], v5 offset:13312
    ds_read_b64_tr_b16 v[152:153], v4 offset:12288
    ds_read_b64_tr_b16 v[154:155], v4 offset:13312
    ds_read_b64_tr_b16 v[156:157], v9 offset:12288
    ds_read_b64_tr_b16 v[158:159], v9 offset:13312
    s_waitcnt lgkmcnt(4)
    ds_read_b64_tr_b16 v[160:161], v3 offset:16384
    ds_read_b64_tr_b16 v[162:163], v3 offset:17408
    ds_read_b64_tr_b16 v[164:165], v5 offset:16384
    ds_read_b64_tr_b16 v[166:167], v5 offset:17408
    ds_read_b64_tr_b16 v[168:169], v4 offset:16384
    ds_read_b64_tr_b16 v[170:171], v4 offset:17408
    ds_read_b64_tr_b16 v[172:173], v9 offset:16384
    ds_read_b64_tr_b16 v[174:175], v9 offset:17408
    ds_read_b64_tr_b16 v[176:177], v3 offset:20480
    ds_read_b64_tr_b16 v[178:179], v3 offset:21504
    ds_read_b64_tr_b16 v[180:181], v5 offset:20480
    ds_read_b64_tr_b16 v[182:183], v5 offset:21504
    ds_read_b64_tr_b16 v[184:185], v4 offset:20480
    ds_read_b64_tr_b16 v[186:187], v4 offset:21504
    ds_read_b64_tr_b16 v[188:189], v9 offset:20480
    ds_read_b64_tr_b16 v[190:191], v9 offset:21504
    s_waitcnt lgkmcnt(4)
    ds_read_b64_tr_b16 v[192:193], v3 offset:24576
    ds_read_b64_tr_b16 v[194:195], v3 offset:25600
    ds_read_b64_tr_b16 v[196:197], v5 offset:24576
    ds_read_b64_tr_b16 v[198:199], v5 offset:25600
    ds_read_b64_tr_b16 v[200:201], v4 offset:24576
    ds_read_b64_tr_b16 v[202:203], v4 offset:25600
    ds_read_b64_tr_b16 v[204:205], v9 offset:24576
    ds_read_b64_tr_b16 v[206:207], v9 offset:25600
    ds_read_b64_tr_b16 v[208:209], v3 offset:28672
    ds_read_b64_tr_b16 v[210:211], v3 offset:29696
    ds_read_b64_tr_b16 v[212:213], v5 offset:28672
    ds_read_b64_tr_b16 v[214:215], v5 offset:29696
    ds_read_b64_tr_b16 v[216:217], v4 offset:28672
    ds_read_b64_tr_b16 v[218:219], v4 offset:29696
    ds_read_b64_tr_b16 v[220:221], v9 offset:28672
    ds_read_b64_tr_b16 v[222:223], v9 offset:29696
    s_waitcnt lgkmcnt(4)
    ds_read_b64_tr_b16 v[224:225], v3 offset:32768
    ds_read_b64_tr_b16 v[226:227], v3 offset:33792
    ds_read_b64_tr_b16 v[228:229], v5 offset:32768
    ds_read_b64_tr_b16 v[230:231], v5 offset:33792
    ds_read_b64_tr_b16 v[232:233], v4 offset:32768
    ds_read_b64_tr_b16 v[234:235], v4 offset:33792
    ds_read_b64_tr_b16 v[236:237], v9 offset:32768
    ds_read_b64_tr_b16 v[238:239], v9 offset:33792
    ds_read_b64_tr_b16 v[240:241], v3 offset:36864
    ds_read_b64_tr_b16 v[242:243], v3 offset:37888
    ds_read_b64_tr_b16 v[244:245], v5 offset:36864
    ds_read_b64_tr_b16 v[246:247], v5 offset:37888
    ds_read_b64_tr_b16 v[248:249], v4 offset:36864
    ds_read_b64_tr_b16 v[250:251], v4 offset:37888
    ds_read_b64_tr_b16 v[252:253], v9 offset:36864
    ds_read_b64_tr_b16 v[254:255], v9 offset:37888
    s_waitcnt lgkmcnt(0)
    s_cmp_lg_u32 s97, 0
    s_cbranch_scc1 CM_137
    v_mbcnt_lo_u32_b32 v0, -1, 0
    v_mbcnt_hi_u32_b32 v0, -1, v0
    v_mul_u32_u24 v8, 32, v0
    s_mov_b32 s64, 0x0
    s_mov_b32 s65, 0
    s_mov_b64 exec, 0xff
TK_138:
    buffer_load_dword v9, v8, s[60:63], s64 offen sc1
    s_add_u32 s65, s65, 1
    s_waitcnt vmcnt(0)
    s_mov_b32 s66, 0
    v_readlane_b32 s67, v9, 0
    s_add_u32 s66, s66, s67
    v_readlane_b32 s67, v9, 1
    s_add_u32 s66, s66, s67
    v_readlane_b32 s67, v9, 2
    s_add_u32 s66, s66, s67
    v_readlane_b32 s67, v9, 3
    s_add_u32 s66, s66, s67
    v_readlane_b32 s67, v9, 4
    s_add_u32 s66, s66, s67
    v_readlane_b32 s67, v9, 5
    s_add_u32 s66, s66, s67
    v_readlane_b32 s67, v9, 6
    s_add_u32 s66, s66, s67
    v_readlane_b32 s67, v9, 7
    s_add_u32 s66, s66, s67
    s_cmp_ge_u32 s66, 256
    s_cbranch_scc1 TKD_139
    s_cmp_gt_u32 s65, 262144
    s_cbranch_scc0 TK_138
TKD_139:
    v_cmp_ne_u32 vcc, 32, v9
    s_mov_b64 exec, -1
    s_cbranch_vccnz M_SLOW
CM_137:
    s_mov_b32 s65, 0
GI_140:
    buffer_load_dword v8, off, s[60:63], s95 sc1
    s_add_u32 s65, s65, 1
    s_waitcnt vmcnt(0)
    v_readfirstlane_b32 s64, v8
    s_cmp_ge_u32 s64, 186
    s_cbranch_scc1 GID_141
    s_cmp_gt_u32 s65, 65536
    s_cbranch_scc1 GID_141
    s_sleep 4
    s_branch GI_140
GID_141:
    v_mbcnt_lo_u32_b32 v0, -1, 0
    v_mbcnt_hi_u32_b32 v0, -1, v0
    s_mov_b32 s65, 0
CW_142:
    buffer_load_dwordx2 v[8:9], off, s[60:63], 0 offset:132 sc1
    s_add_u32 s65, s65, 1
    s_waitcnt vmcnt(0)
    v_readfirstlane_b32 s30, v8
    v_readfirstlane_b32 s31, v9
    s_min_u32 s64, s30, s31
    s_cmp_lg_u32 s64, 0
    s_cbranch_scc1 CWD_143
    s_cmp_gt_u32 s65, 65536
    s_cbranch_scc1 CWD_143
    s_sleep 4
    s_branch CW_142
CWD_143:
    s_sub_u32 s30, s30, 1
    s_and_b32 s30, s30, 3
    s_sub_u32 s31, s31, 1
    s_and_b32 s31, s31, 3
    s_lshl_b32 s34, s96, 2
    s_add_u32 s34, s34, s14
    s_lshl_b32 s34, s34, 6
    v_add_u32 v5, s34, v0
    v_lshlrev_b32 v3, 4, v0
    v_mov_b32 v40, -1
    v_mov_b32 v41, -1
    v_mov_b32 v42, -1
    v_mov_b32 v43, -1
    v_lshrrev_b32 v7, 6, v5
    v_mul_u32_u24 v7, 52429, v7
    v_lshrrev_b32 v7, 18, v7
    v_mul_u32_u24 v8, 320, v7
    v_sub_u32 v8, v5, v8
    v_lshlrev_b32 v48, 4, v8
    s_lshl_b32 s30, s30, 13
    s_lshl_b32 s31, s31, 13
    s_add_u32 s31, s31, 0x200000
    v_and_b32 v8, 1, v7
    v_cmp_eq_u32 vcc, 1, v8
    v_mov_b32 v8, s30
    v_mov_b32 v9, s31
    v_cndmask_b32 v8, v8, v9, vcc
    v_lshrrev_b32 v9, 1, v7
    v_lshl_add_u32 v8, v9, 15, v8
    v_add_u32 v49, v8, v48
    v_cmp_le_u32 vcc, 640, v5
    v_mov_b32 v9, 0x40000000
    s_nop 0
    v_cndmask_b32 v49, v9, v49, vcc
    v_cmp_gt_u32 vcc, 0xa000, v5
    s_nop 0
    s_and_saveexec_b64 s[38:39], vcc
    s_cbranch_execz INF_144
    s_mov_b32 s35, 0x6000000
    buffer_store_dwordx4 v[40:43], v49, s[4:7], s35 offen sc1
INF_144:
    s_mov_b64 exec, s[38:39]
    s_cmp_ge_u32 s96, 10
    s_cbranch_scc1 INM2_145
    s_cmp_lg_u32 s14, 1
    s_cbranch_scc1 INM2_145
    s_cmp_ge_u32 s96, 5
    s_cselect_b32 s36, 1, 0
    s_mul_i32 s34, s36, 5
    s_sub_u32 s34, s96, s34
    s_lshl_b32 s34, s34, 10
    s_cmp_eq_u32 s36, 0
    s_cselect_b32 s37, s30, s31
    s_add_u32 s37, s37, 0x6000000
    s_add_u32 s37, s37, s34
    buffer_store_dwordx4 v[34:37], v3, s[4:7], s37 offen sc1
INM2_145:
    v_lshlrev_b32 v1, 4, v0
    v_lshrrev_b32 v6, 3, v0
    v_mul_u32_u24 v2, 1280, v6
    v_and_b32 v7, 7, v0
    v_xor_b32 v7, v7, v6
    v_lshl_add_u32 v2, v7, 4, v2
    v_bfe_u32 v6, v0, 3, 1
    v_lshlrev_b32 v9, 10, v6
    v_and_b32 v6, 7, v0
    v_lshl_add_u32 v9, v6, 7, v9
    v_lshrrev_b32 v7, 4, v0
    v_xor_b32 v7, v7, v6
    v_lshl_add_u32 v3, v7, 4, v9
    v_xor_b32 v7, 4, v7
    v_lshl_add_u32 v4, v7, 4, v9
    v_add_u32 v6, 0x10000, v3
    v_add_u32 v9, 0x10000, v4
    s_barrier
    s_mul_i32 s20, s12, 163840
    s_mul_i32 s64, s14, 40960
    s_add_u32 s20, s20, s64
    s_add_u32 s20, s20, 0x0
    s_lshl_b32 s21, s14, 12
    s_add_u32 m0, s21, 0
    s_add_u32 s64, s20, 0x0
    buffer_load_dwordx4 v2, s[4:7], s64 offen lds
    s_add_u32 m0, s21, 1024
    s_add_u32 s64, s20, 0x2800
    buffer_load_dwordx4 v2, s[4:7], s64 offen lds
    s_add_u32 m0, s21, 2048
    s_add_u32 s64, s20, 0x5000
    buffer_load_dwordx4 v2, s[4:7], s64 offen lds
    s_add_u32 m0, s21, 3072
    s_add_u32 s64, s20, 0x7800
    buffer_load_dwordx4 v2, s[4:7], s64 offen lds
    s_add_u32 m0, s21, 16384
    s_add_u32 s64, s20, 0x80
    buffer_load_dwordx4 v2, s[4:7], s64 offen lds
    s_add_u32 m0, s21, 17408
    s_add_u32 s64, s20, 0x2880
    buffer_load_dwordx4 v2, s[4:7], s64 offen lds
    s_add_u32 m0, s21, 18432
    s_add_u32 s64, s20, 0x5080
    buffer_load_dwordx4 v2, s[4:7], s64 offen lds
    s_add_u32 m0, s21, 19456
    s_add_u32 s64, s20, 0x7880
    buffer_load_dwordx4 v2, s[4:7], s64 offen lds
    s_add_u32 m0, s21, 32768
    s_add_u32 s64, s20, 0x100
    buffer_load_dwordx4 v2, s[4:7], s64 offen lds
    s_add_u32 m0, s21, 33792
    s_add_u32 s64, s20, 0x2900
    buffer_load_dwordx4 v2, s[4:7], s64 offen lds
    s_add_u32 m0, s21, 34816
    s_add_u32 s64, s20, 0x5100
    buffer_load_dwordx4 v2, s[4:7], s64 offen lds
    s_add_u32 m0, s21, 35840
    s_add_u32 s64, s20, 0x7900
    buffer_load_dwordx4 v2, s[4:7], s64 offen lds
    s_add_u32 m0, s21, 49152
    s_add_u32 s64, s20, 0x180
    buffer_load_dwordx4 v2, s[4:7], s64 offen lds
    s_add_u32 m0, s21, 50176
    s_add_u32 s64, s20, 0x2980
    buffer_load_dwordx4 v2, s[4:7], s64 offen lds
    s_add_u32 m0, s21, 51200
    s_add_u32 s64, s20, 0x5180
    buffer_load_dwordx4 v2, s[4:7], s64 offen lds
    s_add_u32 m0, s21, 52224
    s_add_u32 s64, s20, 0x7980
    buffer_load_dwordx4 v2, s[4:7], s64 offen lds
    s_mov_b32 s64, 0x40000000
    buffer_store_dword v7, v1, s[4:7], s64 offen
    buffer_store_dword v7, v1, s[4:7], s64 offen
    buffer_store_dword v7, v1, s[4:7], s64 offen
    buffer_store_dword v7, v1, s[4:7], s64 offen
    buffer_store_dword v7, v1, s[4:7], s64 offen
    buffer_store_dword v7, v1, s[4:7], s64 offen
    buffer_store_dword v7, v1, s[4:7], s64 offen
    buffer_store_dword v7, v1, s[4:7], s64 offen
    s_waitcnt vmcnt(20)
    s_barrier
    ds_read_b128 a[0:3], v3 offset:0
    ds_read_b128 a[4:7], v3 offset:2048
    ds_read_b128 a[8:11], v3 offset:4096
    ds_read_b128 a[12:15], v3 offset:6144
    ds_read_b128 a[16:19], v3 offset:8192
    ds_read_b128 a[20:23], v3 offset:10240
    ds_read_b128 a[24:27], v3 offset:12288
    ds_read_b128 a[28:31], v3 offset:14336
    s_mov_b32 s19, 0
    s_mov_b32 s22, s16
    s_mov_b32 s23, 0x40000000
G_N_LOOP:
    s_waitcnt lgkmcnt(4)
    v_mfma_f32_16x16x32_bf16 v[16:19], a[0:3], v[96:99], 0
    v_mfma_f32_16x16x32_bf16 v[20:23], a[0:3], v[100:103], 0
    ds_read_b128 a[32:35], v4 offset:0
    v_mfma_f32_16x16x32_bf16 v[24:27], a[4:7], v[96:99], 0
    v_mfma_f32_16x16x32_bf16 v[28:31], a[4:7], v[100:103], 0
    ds_read_b128 a[36:39], v4 offset:2048
    v_mfma_f32_16x16x32_bf16 v[32:35], a[8:11], v[96:99], 0
    v_mfma_f32_16x16x32_bf16 v[36:39], a[8:11], v[100:103], 0
    ds_read_b128 a[40:43], v4 offset:4096
    v_mfma_f32_16x16x32_bf16 v[40:43], a[12:15], v[96:99], 0
    v_mfma_f32_16x16x32_bf16 v[44:47], a[12:15], v[100:103], 0
    ds_read_b128 a[44:47], v4 offset:6144
    s_waitcnt lgkmcnt(4)
    v_mfma_f32_16x16x32_bf16 v[48:51], a[16:19], v[96:99], 0
    v_mfma_f32_16x16x32_bf16 v[52:55], a[16:19], v[100:103], 0
    ds_read_b128 a[48:51], v4 offset:8192
    v_mfma_f32_16x16x32_bf16 v[56:59], a[20:23], v[96:99], 0
    v_mfma_f32_16x16x32_bf16 v[60:63], a[20:23], v[100:103], 0
    ds_read_b128 a[52:55], v4 offset:10240
    v_mfma_f32_16x16x32_bf16 v[64:67], a[24:27], v[96:99], 0
    v_mfma_f32_16x16x32_bf16 v[68:71], a[24:27], v[100:103], 0
    ds_read_b128 a[56:59], v4 offset:12288
    v_mfma_f32_16x16x32_bf16 v[72:75], a[28:31], v[96:99], 0
    v_mfma_f32_16x16x32_bf16 v[76:79], a[28:31], v[100:103], 0
    ds_read_b128 a[60:63], v4 offset:14336
    s_waitcnt vmcnt(16)
    s_barrier
    s_waitcnt lgkmcnt(4)
    v_mfma_f32_16x16x32_bf16 v[16:19], a[32:35], v[104:107], v[16:19]
    v_mfma_f32_16x16x32_bf16 v[20:23], a[32:35], v[108:111], v[20:23]
    ds_read_b128 a[0:3], v3 offset:16384
    s_add_u32 m0, s21, 65536
    v_mfma_f32_16x16x32_bf16 v[24:27], a[36:39], v[104:107], v[24:27]
    v_mfma_f32_16x16x32_bf16 v[28:31], a[36:39], v[108:111], v[28:31]
    ds_read_b128 a[4:7], v3 offset:18432
    s_add_u32 s64, s20, 0x200
    buffer_load_dwordx4 v2, s[4:7], s64 offen lds
    v_mfma_f32_16x16x32_bf16 v[32:35], a[40:43], v[104:107], v[32:35]
    v_mfma_f32_16x16x32_bf16 v[36:39], a[40:43], v[108:111], v[36:39]
    ds_read_b128 a[8:11], v3 offset:20480
    s_add_u32 m0, s21, 66560
    v_mfma_f32_16x16x32_bf16 v[40:43], a[44:47], v[104:107], v[40:43]
    v_mfma_f32_16x16x32_bf16 v[44:47], a[44:47], v[108:111], v[44:47]
    ds_read_b128 a[12:15], v3 offset:22528
    s_add_u32 s64, s20, 0x2a00
    buffer_load_dwordx4 v2, s[4:7], s64 offen lds
    s_waitcnt lgkmcnt(4)
    v_mfma_f32_16x16x32_bf16 v[48:51], a[48:51], v[104:107], v[48:51]
    v_mfma_f32_16x16x32_bf16 v[52:55], a[48:51], v[108:111], v[52:55]
    ds_read_b128 a[16:19], v3 offset:24576
    s_add_u32 m0, s21, 67584
    v_mfma_f32_16x16x32_bf16 v[56:59], a[52:55], v[104:107], v[56:59]
    v_mfma_f32_16x16x32_bf16 v[60:63], a[52:55], v[108:111], v[60:63]
    ds_read_b128 a[20:23], v3 offset:26624
    s_add_u32 s64, s20, 0x5200
    buffer_load_dwordx4 v2, s[4:7], s64 offen lds
    v_mfma_f32_16x16x32_bf16 v[64:67], a[56:59], v[104:107], v[64:67]
    v_mfma_f32_16x16x32_bf16 v[68:71], a[56:59], v[108:111], v[68:71]
    ds_read_b128 a[24:27], v3 offset:28672
    s_add_u32 m0, s21, 68608
    v_mfma_f32_16x16x32_bf16 v[72:75], a[60:63], v[104:107], v[72:75]
    v_mfma_f32_16x16x32_bf16 v[76:79], a[60:63], v[108:111], v[76:79]
    ds_read_b128 a[28:31], v3 offset:30720
    s_add_u32 s64, s20, 0x7a00
    buffer_load_dwordx4 v2, s[4:7], s64 offen lds
    s_waitcnt lgkmcnt(4)
    v_mfma_f32_16x16x32_bf16 v[16:19], a[0:3], v[112:115], v[16:19]
    v_mfma_f32_16x16x32_bf16 v[20:23], a[0:3], v[116:119], v[20:23]
    ds_read_b128 a[32:35], v4 offset:16384
    v_mfma_f32_16x16x32_bf16 v[24:27], a[4:7], v[112:115], v[24:27]
    v_mfma_f32_16x16x32_bf16 v[28:31], a[4:7], v[116:119], v[28:31]
    ds_read_b128 a[36:39], v4 offset:18432
    v_mfma_f32_16x16x32_bf16 v[32:35], a[8:11], v[112:115], v[32:35]
    v_mfma_f32_16x16x32_bf16 v[36:39], a[8:11], v[116:119], v[36:39]
    ds_read_b128 a[40:43], v4 offset:20480
    v_mfma_f32_16x16x32_bf16 v[40:43], a[12:15], v[112:115], v[40:43]
    v_mfma_f32_16x16x32_bf16 v[44:47], a[12:15], v[116:119], v[44:47]
    ds_read_b128 a[44:47], v4 offset:22528
    s_waitcnt lgkmcnt(4)
    v_mfma_f32_16x16x32_bf16 v[48:51], a[16:19], v[112:115], v[48:51]
    v_mfma_f32_16x16x32_bf16 v[52:55], a[16:19], v[116:119], v[52:55]
    ds_read_b128 a[48:51], v4 offset:24576
    v_mfma_f32_16x16x32_bf16 v[56:59], a[20:23], v[112:115], v[56:59]
    v_mfma_f32_16x16x32_bf16 v[60:63], a[20:23], v[116:119], v[60:63]
    ds_read_b128 a[52:55], v4 offset:26624
    v_mfma_f32_16x16x32_bf16 v[64:67], a[24:27], v[112:115], v[64:67]
    v_mfma_f32_16x16x32_bf16 v[68:71], a[24:27], v[116:119], v[68:71]
    ds_read_b128 a[56:59], v4 offset:28672
    v_mfma_f32_16x16x32_bf16 v[72:75], a[28:31], v[112:115], v[72:75]
    v_mfma_f32_16x16x32_bf16 v[76:79], a[28:31], v[116:119], v[76:79]
    ds_read_b128 a[60:63], v4 offset:30720
    s_waitcnt vmcnt(16)
    s_barrier
    s_cmp_lg_u32 s19, 0
    s_cbranch_scc1 GFD_146
    s_cmp_lg_u32 s14, 0
    s_cbranch_scc1 INE_147
    s_cmp_lg_u32 s96, 10
    s_cbranch_scc1 ING_148
    v_mov_b32 v7, 1
    v_lshlrev_b32 v8, 7, v0
    s_mov_b32 s65, 0x29a000
    s_mov_b64 exec, 3
    buffer_store_dword v7, v8, s[4:7], s65 offen sc1
    s_mov_b64 exec, -1
    s_waitcnt vmcnt(0)
ING_148:
    v_mov_b32 v8, 1
    s_mov_b32 s65, 0x290800
    s_mov_b64 exec, 1
    buffer_atomic_add v8, off, s[4:7], s65 sc1
    s_mov_b64 exec, -1
INE_147:
GFD_146:
    s_waitcnt lgkmcnt(4)
    v_mfma_f32_16x16x32_bf16 v[16:19], a[32:35], v[120:123], v[16:19]
    v_mfma_f32_16x16x32_bf16 v[20:23], a[32:35], v[124:127], v[20:23]
    ds_read_b128 a[0:3], v3 offset:32768
    s_add_u32 m0, s21, 0
    v_mfma_f32_16x16x32_bf16 v[24:27], a[36:39], v[120:123], v[24:27]
    v_mfma_f32_16x16x32_bf16 v[28:31], a[36:39], v[124:127], v[28:31]
    ds_read_b128 a[4:7], v3 offset:34816
    s_add_u32 s64, s20, 0x280
    buffer_load_dwordx4 v2, s[4:7], s64 offen lds
    v_mfma_f32_16x16x32_bf16 v[32:35], a[40:43], v[120:123], v[32:35]
    v_mfma_f32_16x16x32_bf16 v[36:39], a[40:43], v[124:127], v[36:39]
    ds_read_b128 a[8:11], v3 offset:36864
    s_add_u32 m0, s21, 1024
    v_mfma_f32_16x16x32_bf16 v[40:43], a[44:47], v[120:123], v[40:43]
    v_mfma_f32_16x16x32_bf16 v[44:47], a[44:47], v[124:127], v[44:47]
    ds_read_b128 a[12:15], v3 offset:38912
    s_add_u32 s64, s20, 0x2a80
    buffer_load_dwordx4 v2, s[4:7], s64 offen lds
    s_waitcnt lgkmcnt(4)
    v_mfma_f32_16x16x32_bf16 v[48:51], a[48:51], v[120:123], v[48:51]
    v_mfma_f32_16x16x32_bf16 v[52:55], a[48:51], v[124:127], v[52:55]
    ds_read_b128 a[16:19], v3 offset:40960
    s_add_u32 m0, s21, 2048
    v_mfma_f32_16x16x32_bf16 v[56:59], a[52:55], v[120:123], v[56:59]
    v_mfma_f32_16x16x32_bf16 v[60:63], a[52:55], v[124:127], v[60:63]
    ds_read_b128 a[20:23], v3 offset:43008
    s_add_u32 s64, s20, 0x5280
    buffer_load_dwordx4 v2, s[4:7], s64 offen lds
    v_mfma_f32_16x16x32_bf16 v[64:67], a[56:59], v[120:123], v[64:67]
    v_mfma_f32_16x16x32_bf16 v[68:71], a[56:59], v[124:127], v[68:71]
    ds_read_b128 a[24:27], v3 offset:45056
    s_add_u32 m0, s21, 3072
    v_mfma_f32_16x16x32_bf16 v[72:75], a[60:63], v[120:123], v[72:75]
    v_mfma_f32_16x16x32_bf16 v[76:79], a[60:63], v[124:127], v[76:79]
    ds_read_b128 a[28:31], v3 offset:47104
    s_add_u32 s64, s20, 0x7a80
    buffer_load_dwordx4 v2, s[4:7], s64 offen lds
    s_waitcnt lgkmcnt(4)
    v_mfma_f32_16x16x32_bf16 v[16:19], a[0:3], v[128:131], v[16:19]
    v_mfma_f32_16x16x32_bf16 v[20:23], a[0:3], v[132:135], v[20:23]
    ds_read_b128 a[32:35], v4 offset:32768
    v_mfma_f32_16x16x32_bf16 v[24:27], a[4:7], v[128:131], v[24:27]
    v_mfma_f32_16x16x32_bf16 v[28:31], a[4:7], v[132:135], v[28:31]
    ds_read_b128 a[36:39], v4 offset:34816
    v_mfma_f32_16x16x32_bf16 v[32:35], a[8:11], v[128:131], v[32:35]
    v_mfma_f32_16x16x32_bf16 v[36:39], a[8:11], v[132:135], v[36:39]
    ds_read_b128 a[40:43], v4 offset:36864
    v_mfma_f32_16x16x32_bf16 v[40:43], a[12:15], v[128:131], v[40:43]
    v_mfma_f32_16x16x32_bf16 v[44:47], a[12:15], v[132:135], v[44:47]
    ds_read_b128 a[44:47], v4 offset:38912
    s_waitcnt lgkmcnt(4)
    v_mfma_f32_16x16x32_bf16 v[48:51], a[16:19], v[128:131], v[48:51]
    v_mfma_f32_16x16x32_bf16 v[52:55], a[16:19], v[132:135], v[52:55]
    ds_read_b128 a[48:51], v4 offset:40960
    v_mfma_f32_16x16x32_bf16 v[56:59], a[20:23], v[128:131], v[56:59]
    v_mfma_f32_16x16x32_bf16 v[60:63], a[20:23], v[132:135], v[60:63]
    ds_read_b128 a[52:55], v4 offset:43008
    v_mfma_f32_16x16x32_bf16 v[64:67], a[24:27], v[128:131], v[64:67]
    v_mfma_f32_16x16x32_bf16 v[68:71], a[24:27], v[132:135], v[68:71]
    ds_read_b128 a[56:59], v4 offset:45056
    v_mfma_f32_16x16x32_bf16 v[72:75], a[28:31], v[128:131], v[72:75]
    v_mfma_f32_16x16x32_bf16 v[76:79], a[28:31], v[132:135], v[76:79]
    ds_read_b128 a[60:63], v4 offset:47104
    s_waitcnt vmcnt(16)
    s_barrier
    s_waitcnt lgkmcnt(4)
    v_mfma_f32_16x16x32_bf16 v[16:19], a[32:35], v[136:139], v[16:19]
    v_mfma_f32_16x16x32_bf16 v[20:23], a[32:35], v[140:143], v[20:23]
    ds_read_b128 a[0:3], v3 offset:49152
    s_add_u32 m0, s21, 16384
    v_mfma_f32_16x16x32_bf16 v[24:27], a[36:39], v[136:139], v[24:27]
    v_mfma_f32_16x16x32_bf16 v[28:31], a[36:39], v[140:143], v[28:31]
    ds_read_b128 a[4:7], v3 offset:51200
    s_add_u32 s64, s20, 0x300
    buffer_load_dwordx4 v2, s[4:7], s64 offen lds
    v_mfma_f32_16x16x32_bf16 v[32:35], a[40:43], v[136:139], v[32:35]
    v_mfma_f32_16x16x32_bf16 v[36:39], a[40:43], v[140:143], v[36:39]
    ds_read_b128 a[8:11], v3 offset:53248
    s_add_u32 m0, s21, 17408
    v_mfma_f32_16x16x32_bf16 v[40:43], a[44:47], v[136:139], v[40:43]
    v_mfma_f32_16x16x32_bf16 v[44:47], a[44:47], v[140:143], v[44:47]
    ds_read_b128 a[12:15], v3 offset:55296
    s_add_u32 s64, s20, 0x2b00
    buffer_load_dwordx4 v2, s[4:7], s64 offen lds
    s_waitcnt lgkmcnt(4)
    v_mfma_f32_16x16x32_bf16 v[48:51], a[48:51], v[136:139], v[48:51]
    v_mfma_f32_16x16x32_bf16 v[52:55], a[48:51], v[140:143], v[52:55]
    ds_read_b128 a[16:19], v3 offset:57344
    s_add_u32 m0, s21, 18432
    v_mfma_f32_16x16x32_bf16 v[56:59], a[52:55], v[136:139], v[56:59]
    v_mfma_f32_16x16x32_bf16 v[60:63], a[52:55], v[140:143], v[60:63]
    ds_read_b128 a[20:23], v3 offset:59392
    s_add_u32 s64, s20, 0x5300
    buffer_load_dwordx4 v2, s[4:7], s64 offen lds
    v_mfma_f32_16x16x32_bf16 v[64:67], a[56:59], v[136:139], v[64:67]
    v_mfma_f32_16x16x32_bf16 v[68:71], a[56:59], v[140:143], v[68:71]
    ds_read_b128 a[24:27], v3 offset:61440
    s_add_u32 m0, s21, 19456
    v_mfma_f32_16x16x32_bf16 v[72:75], a[60:63], v[136:139], v[72:75]
    v_mfma_f32_16x16x32_bf16 v[76:79], a[60:63], v[140:143], v[76:79]
    ds_read_b128 a[28:31], v3 offset:63488
    s_add_u32 s64, s20, 0x7b00
    buffer_load_dwordx4 v2, s[4:7], s64 offen lds
    s_waitcnt lgkmcnt(4)
    v_mfma_f32_16x16x32_bf16 v[16:19], a[0:3], v[144:147], v[16:19]
    v_mfma_f32_16x16x32_bf16 v[20:23], a[0:3], v[148:151], v[20:23]
    ds_read_b128 a[32:35], v4 offset:49152
    v_mfma_f32_16x16x32_bf16 v[24:27], a[4:7], v[144:147], v[24:27]
    v_mfma_f32_16x16x32_bf16 v[28:31], a[4:7], v[148:151], v[28:31]
    ds_read_b128 a[36:39], v4 offset:51200
    v_mfma_f32_16x16x32_bf16 v[32:35], a[8:11], v[144:147], v[32:35]
    v_mfma_f32_16x16x32_bf16 v[36:39], a[8:11], v[148:151], v[36:39]
    ds_read_b128 a[40:43], v4 offset:53248
    v_mfma_f32_16x16x32_bf16 v[40:43], a[12:15], v[144:147], v[40:43]
    v_mfma_f32_16x16x32_bf16 v[44:47], a[12:15], v[148:151], v[44:47]
    ds_read_b128 a[44:47], v4 offset:55296
    s_waitcnt lgkmcnt(4)
    v_mfma_f32_16x16x32_bf16 v[48:51], a[16:19], v[144:147], v[48:51]
    v_mfma_f32_16x16x32_bf16 v[52:55], a[16:19], v[148:151], v[52:55]
    ds_read_b128 a[48:51], v4 offset:57344
    v_mfma_f32_16x16x32_bf16 v[56:59], a[20:23], v[144:147], v[56:59]
    v_mfma_f32_16x16x32_bf16 v[60:63], a[20:23], v[148:151], v[60:63]
    ds_read_b128 a[52:55], v4 offset:59392
    v_mfma_f32_16x16x32_bf16 v[64:67], a[24:27], v[144:147], v[64:67]
    v_mfma_f32_16x16x32_bf16 v[68:71], a[24:27], v[148:151], v[68:71]
    ds_read_b128 a[56:59], v4 offset:61440
    v_mfma_f32_16x16x32_bf16 v[72:75], a[28:31], v[144:147], v[72:75]
    v_mfma_f32_16x16x32_bf16 v[76:79], a[28:31], v[148:151], v[76:79]
    ds_read_b128 a[60:63], v4 offset:63488
    s_waitcnt vmcnt(8)
    s_barrier
    s_cmp_lg_u32 s14, 0
    s_cbranch_scc1 GF_149
    v_mov_b32 v7, 1
    v_mov_b32 v8, 0
    s_mov_b64 exec, 1
    buffer_store_dword v7, v8, s[4:7], s23 offen sc1
    s_mov_b64 exec, -1
GF_149:
    s_waitcnt lgkmcnt(4)
    v_mfma_f32_16x16x32_bf16 v[16:19], a[32:35], v[152:155], v[16:19]
    v_mfma_f32_16x16x32_bf16 v[20:23], a[32:35], v[156:159], v[20:23]
    ds_read_b128 a[0:3], v6 offset:0
    s_add_u32 m0, s21, 32768
    v_mfma_f32_16x16x32_bf16 v[24:27], a[36:39], v[152:155], v[24:27]
    v_mfma_f32_16x16x32_bf16 v[28:31], a[36:39], v[156:159], v[28:31]
    ds_read_b128 a[4:7], v6 offset:2048
    s_add_u32 s64, s20, 0x380
    buffer_load_dwordx4 v2, s[4:7], s64 offen lds
    v_mfma_f32_16x16x32_bf16 v[32:35], a[40:43], v[152:155], v[32:35]
    v_mfma_f32_16x16x32_bf16 v[36:39], a[40:43], v[156:159], v[36:39]
    ds_read_b128 a[8:11], v6 offset:4096
    s_add_u32 m0, s21, 33792
    v_mfma_f32_16x16x32_bf16 v[40:43], a[44:47], v[152:155], v[40:43]
    v_mfma_f32_16x16x32_bf16 v[44:47], a[44:47], v[156:159], v[44:47]
    ds_read_b128 a[12:15], v6 offset:6144
    s_add_u32 s64, s20, 0x2b80
    buffer_load_dwordx4 v2, s[4:7], s64 offen lds
    s_waitcnt lgkmcnt(4)
    v_mfma_f32_16x16x32_bf16 v[48:51], a[48:51], v[152:155], v[48:51]
    v_mfma_f32_16x16x32_bf16 v[52:55], a[48:51], v[156:159], v[52:55]
    ds_read_b128 a[16:19], v6 offset:8192
    s_add_u32 m0, s21, 34816
    v_mfma_f32_16x16x32_bf16 v[56:59], a[52:55], v[152:155], v[56:59]
    v_mfma_f32_16x16x32_bf16 v[60:63], a[52:55], v[156:159], v[60:63]
    ds_read_b128 a[20:23], v6 offset:10240
    s_add_u32 s64, s20, 0x5380
    buffer_load_dwordx4 v2, s[4:7], s64 offen lds
    v_mfma_f32_16x16x32_bf16 v[64:67], a[56:59], v[152:155], v[64:67]
    v_mfma_f32_16x16x32_bf16 v[68:71], a[56:59], v[156:159], v[68:71]
    ds_read_b128 a[24:27], v6 offset:12288
    s_add_u32 m0, s21, 35840
    v_mfma_f32_16x16x32_bf16 v[72:75], a[60:63], v[152:155], v[72:75]
    v_mfma_f32_16x16x32_bf16 v[76:79], a[60:63], v[156:159], v[76:79]
    ds_read_b128 a[28:31], v6 offset:14336
    s_add_u32 s64, s20, 0x7b80
    buffer_load_dwordx4 v2, s[4:7], s64 offen lds
    s_waitcnt lgkmcnt(4)
    v_mfma_f32_16x16x32_bf16 v[16:19], a[0:3], v[160:163], v[16:19]
    v_mfma_f32_16x16x32_bf16 v[20:23], a[0:3], v[164:167], v[20:23]
    ds_read_b128 a[32:35], v9 offset:0
    v_mfma_f32_16x16x32_bf16 v[24:27], a[4:7], v[160:163], v[24:27]
    v_mfma_f32_16x16x32_bf16 v[28:31], a[4:7], v[164:167], v[28:31]
    ds_read_b128 a[36:39], v9 offset:2048
    v_mfma_f32_16x16x32_bf16 v[32:35], a[8:11], v[160:163], v[32:35]
    v_mfma_f32_16x16x32_bf16 v[36:39], a[8:11], v[164:167], v[36:39]
    ds_read_b128 a[40:43], v9 offset:4096
    v_mfma_f32_16x16x32_bf16 v[40:43], a[12:15], v[160:163], v[40:43]
    v_mfma_f32_16x16x32_bf16 v[44:47], a[12:15], v[164:167], v[44:47]
    ds_read_b128 a[44:47], v9 offset:6144
    s_waitcnt lgkmcnt(4)
    v_mfma_f32_16x16x32_bf16 v[48:51], a[16:19], v[160:163], v[48:51]
    v_mfma_f32_16x16x32_bf16 v[52:55], a[16:19], v[164:167], v[52:55]
    ds_read_b128 a[48:51], v9 offset:8192
    v_mfma_f32_16x16x32_bf16 v[56:59], a[20:23], v[160:163], v[56:59]
    v_mfma_f32_16x16x32_bf16 v[60:63], a[20:23], v[164:167], v[60:63]
    ds_read_b128 a[52:55], v9 offset:10240
    v_mfma_f32_16x16x32_bf16 v[64:67], a[24:27], v[160:163], v[64:67]
    v_mfma_f32_16x16x32_bf16 v[68:71], a[24:27], v[164:167], v[68:71]
    ds_read_b128 a[56:59], v9 offset:12288
    v_mfma_f32_16x16x32_bf16 v[72:75], a[28:31], v[160:163], v[72:75]
    v_mfma_f32_16x16x32_bf16 v[76:79], a[28:31], v[164:167], v[76:79]
    ds_read_b128 a[60:63], v9 offset:14336
    s_waitcnt vmcnt(8)
    s_barrier
    s_waitcnt lgkmcnt(4)
    v_mfma_f32_16x16x32_bf16 v[16:19], a[32:35], v[168:171], v[16:19]
    v_mfma_f32_16x16x32_bf16 v[20:23], a[32:35], v[172:175], v[20:23]
    ds_read_b128 a[0:3], v3 offset:0
    s_add_u32 m0, s21, 49152
    v_mfma_f32_16x16x32_bf16 v[24:27], a[36:39], v[168:171], v[24:27]
    v_mfma_f32_16x16x32_bf16 v[28:31], a[36:39], v[172:175], v[28:31]
    ds_read_b128 a[4:7], v3 offset:2048
    s_add_u32 s64, s20, 0x400
    buffer_load_dwordx4 v2, s[4:7], s64 offen lds
    v_mfma_f32_16x16x32_bf16 v[32:35], a[40:43], v[168:171], v[32:35]
    v_mfma_f32_16x16x32_bf16 v[36:39], a[40:43], v[172:175], v[36:39]
    ds_read_b128 a[8:11], v3 offset:4096
    s_add_u32 m0, s21, 50176
    v_mfma_f32_16x16x32_bf16 v[40:43], a[44:47], v[168:171], v[40:43]
    v_mfma_f32_16x16x32_bf16 v[44:47], a[44:47], v[172:175], v[44:47]
    ds_read_b128 a[12:15], v3 offset:6144
    s_add_u32 s64, s20, 0x2c00
    buffer_load_dwordx4 v2, s[4:7], s64 offen lds
    s_waitcnt lgkmcnt(4)
    v_mfma_f32_16x16x32_bf16 v[48:51], a[48:51], v[168:171], v[48:51]
    v_mfma_f32_16x16x32_bf16 v[52:55], a[48:51], v[172:175], v[52:55]
    ds_read_b128 a[16:19], v3 offset:8192
    s_add_u32 m0, s21, 51200
    v_mfma_f32_16x16x32_bf16 v[56:59], a[52:55], v[168:171], v[56:59]
    v_mfma_f32_16x16x32_bf16 v[60:63], a[52:55], v[172:175], v[60:63]
    ds_read_b128 a[20:23], v3 offset:10240
    s_add_u32 s64, s20, 0x5400
    buffer_load_dwordx4 v2, s[4:7], s64 offen lds
    v_mfma_f32_16x16x32_bf16 v[64:67], a[56:59], v[168:171], v[64:67]
    v_mfma_f32_16x16x32_bf16 v[68:71], a[56:59], v[172:175], v[68:71]
    ds_read_b128 a[24:27], v3 offset:12288
    s_add_u32 m0, s21, 52224
    v_mfma_f32_16x16x32_bf16 v[72:75], a[60:63], v[168:171], v[72:75]
    v_mfma_f32_16x16x32_bf16 v[76:79], a[60:63], v[172:175], v[76:79]
    ds_read_b128 a[28:31], v3 offset:14336
    s_add_u32 s64, s20, 0x7c00
    buffer_load_dwordx4 v2, s[4:7], s64 offen lds
    s_waitcnt lgkmcnt(4)
    v_mfma_f32_16x16x32_bf16 v[16:19], a[0:3], v[176:179], v[16:19]
    v_mfma_f32_16x16x32_bf16 v[20:23], a[0:3], v[180:183], v[20:23]
    ds_read_b128 a[32:35], v4 offset:0
    v_mfma_f32_16x16x32_bf16 v[24:27], a[4:7], v[176:179], v[24:27]
    v_mfma_f32_16x16x32_bf16 v[28:31], a[4:7], v[180:183], v[28:31]
    ds_read_b128 a[36:39], v4 offset:2048
    v_mfma_f32_16x16x32_bf16 v[32:35], a[8:11], v[176:179], v[32:35]
    v_mfma_f32_16x16x32_bf16 v[36:39], a[8:11], v[180:183], v[36:39]
    ds_read_b128 a[40:43], v4 offset:4096
    v_mfma_f32_16x16x32_bf16 v[40:43], a[12:15], v[176:179], v[40:43]
    v_mfma_f32_16x16x32_bf16 v[44:47], a[12:15], v[180:183], v[44:47]
    ds_read_b128 a[44:47], v4 offset:6144
    s_waitcnt lgkmcnt(4)
    v_mfma_f32_16x16x32_bf16 v[48:51], a[16:19], v[176:179], v[48:51]
    v_mfma_f32_16x16x32_bf16 v[52:55], a[16:19], v[180:183], v[52:55]
    ds_read_b128 a[48:51], v4 offset:8192
    v_mfma_f32_16x16x32_bf16 v[56:59], a[20:23], v[176:179], v[56:59]
    v_mfma_f32_16x16x32_bf16 v[60:63], a[20:23], v[180:183], v[60:63]
    ds_read_b128 a[52:55], v4 offset:10240
    v_mfma_f32_16x16x32_bf16 v[64:67], a[24:27], v[176:179], v[64:67]
    v_mfma_f32_16x16x32_bf16 v[68:71], a[24:27], v[180:183], v[68:71]
    ds_read_b128 a[56:59], v4 offset:12288
    v_mfma_f32_16x16x32_bf16 v[72:75], a[28:31], v[176:179], v[72:75]
    v_mfma_f32_16x16x32_bf16 v[76:79], a[28:31], v[180:183], v[76:79]
    ds_read_b128 a[60:63], v4 offset:14336
    s_waitcnt vmcnt(8)
    s_barrier
    s_waitcnt lgkmcnt(4)
    v_mfma_f32_16x16x32_bf16 v[16:19], a[32:35], v[184:187], v[16:19]
    v_mfma_f32_16x16x32_bf16 v[20:23], a[32:35], v[188:191], v[20:23]
    ds_read_b128 a[0:3], v3 offset:16384
    s_add_u32 m0, s21, 65536
    v_mfma_f32_16x16x32_bf16 v[24:27], a[36:39], v[184:187], v[24:27]
    v_mfma_f32_16x16x32_bf16 v[28:31], a[36:39], v[188:191], v[28:31]
    ds_read_b128 a[4:7], v3 offset:18432
    s_add_u32 s64, s20, 0x480
    buffer_load_dwordx4 v2, s[4:7], s64 offen lds
    v_mfma_f32_16x16x32_bf16 v[32:35], a[40:43], v[184:187], v[32:35]
    v_mfma_f32_16x16x32_bf16 v[36:39], a[40:43], v[188:191], v[36:39]
    ds_read_b128 a[8:11], v3 offset:20480
    s_add_u32 m0, s21, 66560
    v_mfma_f32_16x16x32_bf16 v[40:43], a[44:47], v[184:187], v[40:43]
    v_mfma_f32_16x16x32_bf16 v[44:47], a[44:47], v[188:191], v[44:47]
    ds_read_b128 a[12:15], v3 offset:22528
    s_add_u32 s64, s20, 0x2c80
    buffer_load_dwordx4 v2, s[4:7], s64 offen lds
    s_waitcnt lgkmcnt(4)
    v_mfma_f32_16x16x32_bf16 v[48:51], a[48:51], v[184:187], v[48:51]
    v_mfma_f32_16x16x32_bf16 v[52:55], a[48:51], v[188:191], v[52:55]
    ds_read_b128 a[16:19], v3 offset:24576
    s_add_u32 m0, s21, 67584
    v_mfma_f32_16x16x32_bf16 v[56:59], a[52:55], v[184:187], v[56:59]
    v_mfma_f32_16x16x32_bf16 v[60:63], a[52:55], v[188:191], v[60:63]
    ds_read_b128 a[20:23], v3 offset:26624
    s_add_u32 s64, s20, 0x5480
    buffer_load_dwordx4 v2, s[4:7], s64 offen lds
    v_mfma_f32_16x16x32_bf16 v[64:67], a[56:59], v[184:187], v[64:67]
    v_mfma_f32_16x16x32_bf16 v[68:71], a[56:59], v[188:191], v[68:71]
    ds_read_b128 a[24:27], v3 offset:28672
    s_add_u32 m0, s21, 68608
    v_mfma_f32_16x16x32_bf16 v[72:75], a[60:63], v[184:187], v[72:75]
    v_mfma_f32_16x16x32_bf16 v[76:79], a[60:63], v[188:191], v[76:79]
    ds_read_b128 a[28:31], v3 offset:30720
    s_add_u32 s64, s20, 0x7c80
    buffer_load_dwordx4 v2, s[4:7], s64 offen lds
    s_waitcnt lgkmcnt(4)
    v_mfma_f32_16x16x32_bf16 v[16:19], a[0:3], v[192:195], v[16:19]
    v_mfma_f32_16x16x32_bf16 v[20:23], a[0:3], v[196:199], v[20:23]
    ds_read_b128 a[32:35], v4 offset:16384
    v_mfma_f32_16x16x32_bf16 v[24:27], a[4:7], v[192:195], v[24:27]
    v_mfma_f32_16x16x32_bf16 v[28:31], a[4:7], v[196:199], v[28:31]
    ds_read_b128 a[36:39], v4 offset:18432
    v_mfma_f32_16x16x32_bf16 v[32:35], a[8:11], v[192:195], v[32:35]
    v_mfma_f32_16x16x32_bf16 v[36:39], a[8:11], v[196:199], v[36:39]
    ds_read_b128 a[40:43], v4 offset:20480
    v_mfma_f32_16x16x32_bf16 v[40:43], a[12:15], v[192:195], v[40:43]
    v_mfma_f32_16x16x32_bf16 v[44:47], a[12:15], v[196:199], v[44:47]
    ds_read_b128 a[44:47], v4 offset:22528
    s_waitcnt lgkmcnt(4)
    v_mfma_f32_16x16x32_bf16 v[48:51], a[16:19], v[192:195], v[48:51]
    v_mfma_f32_16x16x32_bf16 v[52:55], a[16:19], v[196:199], v[52:55]
    ds_read_b128 a[48:51], v4 offset:24576
    v_mfma_f32_16x16x32_bf16 v[56:59], a[20:23], v[192:195], v[56:59]
    v_mfma_f32_16x16x32_bf16 v[60:63], a[20:23], v[196:199], v[60:63]
    ds_read_b128 a[52:55], v4 offset:26624
    v_mfma_f32_16x16x32_bf16 v[64:67], a[24:27], v[192:195], v[64:67]
    v_mfma_f32_16x16x32_bf16 v[68:71], a[24:27], v[196:199], v[68:71]
    ds_read_b128 a[56:59], v4 offset:28672
    v_mfma_f32_16x16x32_bf16 v[72:75], a[28:31], v[192:195], v[72:75]
    v_mfma_f32_16x16x32_bf16 v[76:79], a[28:31], v[196:199], v[76:79]
    ds_read_b128 a[60:63], v4 offset:30720
    s_waitcnt vmcnt(8)
    s_barrier
    s_waitcnt lgkmcnt(4)
    v_mfma_f32_16x16x32_bf16 v[16:19], a[32:35], v[200:203], v[16:19]
    v_mfma_f32_16x16x32_bf16 v[20:23], a[32:35], v[204:207], v[20:23]
    ds_read_b128 a[0:3], v3 offset:32768
    s_add_u32 m0, s21, 0
    v_mfma_f32_16x16x32_bf16 v[24:27], a[36:39], v[200:203], v[24:27]
    v_mfma_f32_16x16x32_bf16 v[28:31], a[36:39], v[204:207], v[28:31]
    ds_read_b128 a[4:7], v3 offset:34816
    s_add_u32 s64, s20, 0x50000
    buffer_load_dwordx4 v2, s[4:7], s64 offen lds
    v_mfma_f32_16x16x32_bf16 v[32:35], a[40:43], v[200:203], v[32:35]
    v_mfma_f32_16x16x32_bf16 v[36:39], a[40:43], v[204:207], v[36:39]
    ds_read_b128 a[8:11], v3 offset:36864
    s_add_u32 m0, s21, 1024
    v_mfma_f32_16x16x32_bf16 v[40:43], a[44:47], v[200:203], v[40:43]
    v_mfma_f32_16x16x32_bf16 v[44:47], a[44:47], v[204:207], v[44:47]
    ds_read_b128 a[12:15], v3 offset:38912
    s_add_u32 s64, s20, 0x52800
    buffer_load_dwordx4 v2, s[4:7], s64 offen lds
    s_waitcnt lgkmcnt(4)
    v_mfma_f32_16x16x32_bf16 v[48:51], a[48:51], v[200:203], v[48:51]
    v_mfma_f32_16x16x32_bf16 v[52:55], a[48:51], v[204:207], v[52:55]
    ds_read_b128 a[16:19], v3 offset:40960
    s_add_u32 m0, s21, 2048
    v_mfma_f32_16x16x32_bf16 v[56:59], a[52:55], v[200:203], v[56:59]
    v_mfma_f32_16x16x32_bf16 v[60:63], a[52:55], v[204:207], v[60:63]
    ds_read_b128 a[20:23], v3 offset:43008
    s_add_u32 s64, s20, 0x55000
    buffer_load_dwordx4 v2, s[4:7], s64 offen lds
    v_mfma_f32_16x16x32_bf16 v[64:67], a[56:59], v[200:203], v[64:67]
    v_mfma_f32_16x16x32_bf16 v[68:71], a[56:59], v[204:207], v[68:71]
    ds_read_b128 a[24:27], v3 offset:45056
    s_add_u32 m0, s21, 3072
    v_mfma_f32_16x16x32_bf16 v[72:75], a[60:63], v[200:203], v[72:75]
    v_mfma_f32_16x16x32_bf16 v[76:79], a[60:63], v[204:207], v[76:79]
    ds_read_b128 a[28:31], v3 offset:47104
    s_add_u32 s64, s20, 0x57800
    buffer_load_dwordx4 v2, s[4:7], s64 offen lds
    s_waitcnt lgkmcnt(4)
    v_mfma_f32_16x16x32_bf16 v[16:19], a[0:3], v[208:211], v[16:19]
    v_mfma_f32_16x16x32_bf16 v[20:23], a[0:3], v[212:215], v[20:23]
    ds_read_b128 a[32:35], v4 offset:32768
    v_mfma_f32_16x16x32_bf16 v[24:27], a[4:7], v[208:211], v[24:27]
    v_mfma_f32_16x16x32_bf16 v[28:31], a[4:7], v[212:215], v[28:31]
    ds_read_b128 a[36:39], v4 offset:34816
    v_mfma_f32_16x16x32_bf16 v[32:35], a[8:11], v[208:211], v[32:35]
    v_mfma_f32_16x16x32_bf16 v[36:39], a[8:11], v[212:215], v[36:39]
    ds_read_b128 a[40:43], v4 offset:36864
    v_mfma_f32_16x16x32_bf16 v[40:43], a[12:15], v[208:211], v[40:43]
    v_mfma_f32_16x16x32_bf16 v[44:47], a[12:15], v[212:215], v[44:47]
    ds_read_b128 a[44:47], v4 offset:38912
    s_waitcnt lgkmcnt(4)
    v_mfma_f32_16x16x32_bf16 v[48:51], a[16:19], v[208:211], v[48:51]
    v_mfma_f32_16x16x32_bf16 v[52:55], a[16:19], v[212:215], v[52:55]
    ds_read_b128 a[48:51], v4 offset:40960
    v_mfma_f32_16x16x32_bf16 v[56:59], a[20:23], v[208:211], v[56:59]
    v_mfma_f32_16x16x32_bf16 v[60:63], a[20:23], v[212:215], v[60:63]
    ds_read_b128 a[52:55], v4 offset:43008
    v_mfma_f32_16x16x32_bf16 v[64:67], a[24:27], v[208:211], v[64:67]
    v_mfma_f32_16x16x32_bf16 v[68:71], a[24:27], v[212:215], v[68:71]
    ds_read_b128 a[56:59], v4 offset:45056
    v_mfma_f32_16x16x32_bf16 v[72:75], a[28:31], v[208:211], v[72:75]
    v_mfma_f32_16x16x32_bf16 v[76:79], a[28:31], v[212:215], v[76:79]
    ds_read_b128 a[60:63], v4 offset:47104
    s_waitcnt vmcnt(8)
    s_barrier
    s_waitcnt lgkmcnt(4)
    v_mfma_f32_16x16x32_bf16 v[16:19], a[32:35], v[216:219], v[16:19]
    v_mfma_f32_16x16x32_bf16 v[20:23], a[32:35], v[220:223], v[20:23]
    ds_read_b128 a[0:3], v3 offset:49152
    s_add_u32 m0, s21, 16384
    v_mfma_f32_16x16x32_bf16 v[24:27], a[36:39], v[216:219], v[24:27]
    v_mfma_f32_16x16x32_bf16 v[28:31], a[36:39], v[220:223], v[28:31]
    ds_read_b128 a[4:7], v3 offset:51200
    s_add_u32 s64, s20, 0x50080
    buffer_load_dwordx4 v2, s[4:7], s64 offen lds
    v_mfma_f32_16x16x32_bf16 v[32:35], a[40:43], v[216:219], v[32:35]
    v_mfma_f32_16x16x32_bf16 v[36:39], a[40:43], v[220:223], v[36:39]
    ds_read_b128 a[8:11], v3 offset:53248
    s_add_u32 m0, s21, 17408
    v_mfma_f32_16x16x32_bf16 v[40:43], a[44:47], v[216:219], v[40:43]
    v_mfma_f32_16x16x32_bf16 v[44:47], a[44:47], v[220:223], v[44:47]
    ds_read_b128 a[12:15], v3 offset:55296
    s_add_u32 s64, s20, 0x52880
    buffer_load_dwordx4 v2, s[4:7], s64 offen lds
    s_waitcnt lgkmcnt(4)
    v_mfma_f32_16x16x32_bf16 v[48:51], a[48:51], v[216:219], v[48:51]
    v_mfma_f32_16x16x32_bf16 v[52:55], a[48:51], v[220:223], v[52:55]
    ds_read_b128 a[16:19], v3 offset:57344
    s_add_u32 m0, s21, 18432
    v_mfma_f32_16x16x32_bf16 v[56:59], a[52:55], v[216:219], v[56:59]
    v_mfma_f32_16x16x32_bf16 v[60:63], a[52:55], v[220:223], v[60:63]
    ds_read_b128 a[20:23], v3 offset:59392
    s_add_u32 s64, s20, 0x55080
    buffer_load_dwordx4 v2, s[4:7], s64 offen lds
    v_mfma_f32_16x16x32_bf16 v[64:67], a[56:59], v[216:219], v[64:67]
    v_mfma_f32_16x16x32_bf16 v[68:71], a[56:59], v[220:223], v[68:71]
    ds_read_b128 a[24:27], v3 offset:61440
    s_add_u32 m0, s21, 19456
    v_mfma_f32_16x16x32_bf16 v[72:75], a[60:63], v[216:219], v[72:75]
    v_mfma_f32_16x16x32_bf16 v[76:79], a[60:63], v[220:223], v[76:79]
    ds_read_b128 a[28:31], v3 offset:63488
    s_add_u32 s64, s20, 0x57880
    buffer_load_dwordx4 v2, s[4:7], s64 offen lds
    s_waitcnt lgkmcnt(4)
    v_mfma_f32_16x16x32_bf16 v[16:19], a[0:3], v[224:227], v[16:19]
    v_mfma_f32_16x16x32_bf16 v[20:23], a[0:3], v[228:231], v[20:23]
    ds_read_b128 a[32:35], v4 offset:49152
    v_mfma_f32_16x16x32_bf16 v[24:27], a[4:7], v[224:227], v[24:27]
    v_mfma_f32_16x16x32_bf16 v[28:31], a[4:7], v[228:231], v[28:31]
    ds_read_b128 a[36:39], v4 offset:51200
    v_mfma_f32_16x16x32_bf16 v[32:35], a[8:11], v[224:227], v[32:35]
    v_mfma_f32_16x16x32_bf16 v[36:39], a[8:11], v[228:231], v[36:39]
    ds_read_b128 a[40:43], v4 offset:53248
    v_mfma_f32_16x16x32_bf16 v[40:43], a[12:15], v[224:227], v[40:43]
    v_mfma_f32_16x16x32_bf16 v[44:47], a[12:15], v[228:231], v[44:47]
    ds_read_b128 a[44:47], v4 offset:55296
    s_waitcnt lgkmcnt(4)
    v_mfma_f32_16x16x32_bf16 v[48:51], a[16:19], v[224:227], v[48:51]
    v_mfma_f32_16x16x32_bf16 v[52:55], a[16:19], v[228:231], v[52:55]
    ds_read_b128 a[48:51], v4 offset:57344
    v_mfma_f32_16x16x32_bf16 v[56:59], a[20:23], v[224:227], v[56:59]
    v_mfma_f32_16x16x32_bf16 v[60:63], a[20:23], v[228:231], v[60:63]
    ds_read_b128 a[52:55], v4 offset:59392
    v_mfma_f32_16x16x32_bf16 v[64:67], a[24:27], v[224:227], v[64:67]
    v_mfma_f32_16x16x32_bf16 v[68:71], a[24:27], v[228:231], v[68:71]
    ds_read_b128 a[56:59], v4 offset:61440
    v_mfma_f32_16x16x32_bf16 v[72:75], a[28:31], v[224:227], v[72:75]
    v_mfma_f32_16x16x32_bf16 v[76:79], a[28:31], v[228:231], v[76:79]
    ds_read_b128 a[60:63], v4 offset:63488
    s_waitcnt vmcnt(8)
    s_barrier
    s_waitcnt lgkmcnt(4)
    v_mfma_f32_16x16x32_bf16 v[16:19], a[32:35], v[232:235], v[16:19]
    v_mfma_f32_16x16x32_bf16 v[20:23], a[32:35], v[236:239], v[20:23]
    ds_read_b128 a[0:3], v6 offset:0
    s_add_u32 m0, s21, 32768
    v_mfma_f32_16x16x32_bf16 v[24:27], a[36:39], v[232:235], v[24:27]
    v_mfma_f32_16x16x32_bf16 v[28:31], a[36:39], v[236:239], v[28:31]
    ds_read_b128 a[4:7], v6 offset:2048
    s_add_u32 s64, s20, 0x50100
    buffer_load_dwordx4 v2, s[4:7], s64 offen lds
    v_mfma_f32_16x16x32_bf16 v[32:35], a[40:43], v[232:235], v[32:35]
    v_mfma_f32_16x16x32_bf16 v[36:39], a[40:43], v[236:239], v[36:39]
    ds_read_b128 a[8:11], v6 offset:4096
    s_add_u32 m0, s21, 33792
    v_mfma_f32_16x16x32_bf16 v[40:43], a[44:47], v[232:235], v[40:43]
    v_mfma_f32_16x16x32_bf16 v[44:47], a[44:47], v[236:239], v[44:47]
    ds_read_b128 a[12:15], v6 offset:6144
    s_add_u32 s64, s20, 0x52900
    buffer_load_dwordx4 v2, s[4:7], s64 offen lds
    s_waitcnt lgkmcnt(4)
    v_mfma_f32_16x16x32_bf16 v[48:51], a[48:51], v[232:235], v[48:51]
    v_mfma_f32_16x16x32_bf16 v[52:55], a[48:51], v[236:239], v[52:55]
    ds_read_b128 a[16:19], v6 offset:8192
    s_add_u32 m0, s21, 34816
    v_mfma_f32_16x16x32_bf16 v[56:59], a[52:55], v[232:235], v[56:59]
    v_mfma_f32_16x16x32_bf16 v[60:63], a[52:55], v[236:239], v[60:63]
    ds_read_b128 a[20:23], v6 offset:10240
    s_add_u32 s64, s20, 0x55100
    buffer_load_dwordx4 v2, s[4:7], s64 offen lds
    v_mfma_f32_16x16x32_bf16 v[64:67], a[56:59], v[232:235], v[64:67]
    v_mfma_f32_16x16x32_bf16 v[68:71], a[56:59], v[236:239], v[68:71]
    ds_read_b128 a[24:27], v6 offset:12288
    s_add_u32 m0, s21, 35840
    v_mfma_f32_16x16x32_bf16 v[72:75], a[60:63], v[232:235], v[72:75]
    v_mfma_f32_16x16x32_bf16 v[76:79], a[60:63], v[236:239], v[76:79]
    ds_read_b128 a[28:31], v6 offset:14336
    s_add_u32 s64, s20, 0x57900
    buffer_load_dwordx4 v2, s[4:7], s64 offen lds
    s_waitcnt lgkmcnt(4)
    v_mfma_f32_16x16x32_bf16 v[16:19], a[0:3], v[240:243], v[16:19]
    v_mfma_f32_16x16x32_bf16 v[20:23], a[0:3], v[244:247], v[20:23]
    ds_read_b128 a[32:35], v9 offset:0
    v_mfma_f32_16x16x32_bf16 v[24:27], a[4:7], v[240:243], v[24:27]
    v_mfma_f32_16x16x32_bf16 v[28:31], a[4:7], v[244:247], v[28:31]
    ds_read_b128 a[36:39], v9 offset:2048
    v_mfma_f32_16x16x32_bf16 v[32:35], a[8:11], v[240:243], v[32:35]
    v_mfma_f32_16x16x32_bf16 v[36:39], a[8:11], v[244:247], v[36:39]
    ds_read_b128 a[40:43], v9 offset:4096
    v_mfma_f32_16x16x32_bf16 v[40:43], a[12:15], v[240:243], v[40:43]
    v_mfma_f32_16x16x32_bf16 v[44:47], a[12:15], v[244:247], v[44:47]
    ds_read_b128 a[44:47], v9 offset:6144
    s_waitcnt lgkmcnt(4)
    v_mfma_f32_16x16x32_bf16 v[48:51], a[16:19], v[240:243], v[48:51]
    v_mfma_f32_16x16x32_bf16 v[52:55], a[16:19], v[244:247], v[52:55]
    ds_read_b128 a[48:51], v9 offset:8192
    v_mfma_f32_16x16x32_bf16 v[56:59], a[20:23], v[240:243], v[56:59]
    v_mfma_f32_16x16x32_bf16 v[60:63], a[20:23], v[244:247], v[60:63]
    ds_read_b128 a[52:55], v9 offset:10240
    v_mfma_f32_16x16x32_bf16 v[64:67], a[24:27], v[240:243], v[64:67]
    v_mfma_f32_16x16x32_bf16 v[68:71], a[24:27], v[244:247], v[68:71]
    ds_read_b128 a[56:59], v9 offset:12288
    v_mfma_f32_16x16x32_bf16 v[72:75], a[28:31], v[240:243], v[72:75]
    v_mfma_f32_16x16x32_bf16 v[76:79], a[28:31], v[244:247], v[76:79]
    ds_read_b128 a[60:63], v9 offset:14336
    s_waitcnt vmcnt(8)
    s_barrier
    s_waitcnt lgkmcnt(4)
    v_mfma_f32_16x16x32_bf16 v[16:19], a[32:35], v[248:251], v[16:19]
    v_mfma_f32_16x16x32_bf16 v[20:23], a[32:35], v[252:255], v[20:23]
    ds_read_b128 a[0:3], v3 offset:0
    s_add_u32 m0, s21, 49152
    v_mfma_f32_16x16x32_bf16 v[24:27], a[36:39], v[248:251], v[24:27]
    v_mfma_f32_16x16x32_bf16 v[28:31], a[36:39], v[252:255], v[28:31]
    ds_read_b128 a[4:7], v3 offset:2048
    s_add_u32 s64, s20, 0x50180
    buffer_load_dwordx4 v2, s[4:7], s64 offen lds
    v_mfma_f32_16x16x32_bf16 v[32:35], a[40:43], v[248:251], v[32:35]
    v_mfma_f32_16x16x32_bf16 v[36:39], a[40:43], v[252:255], v[36:39]
    ds_read_b128 a[8:11], v3 offset:4096
    s_add_u32 m0, s21, 50176
    v_mfma_f32_16x16x32_bf16 v[40:43], a[44:47], v[248:251], v[40:43]
    v_mfma_f32_16x16x32_bf16 v[44:47], a[44:47], v[252:255], v[44:47]
    ds_read_b128 a[12:15], v3 offset:6144
    s_add_u32 s64, s20, 0x52980
    buffer_load_dwordx4 v2, s[4:7], s64 offen lds
    s_waitcnt lgkmcnt(4)
    v_mfma_f32_16x16x32_bf16 v[48:51], a[48:51], v[248:251], v[48:51]
    v_mfma_f32_16x16x32_bf16 v[52:55], a[48:51], v[252:255], v[52:55]
    ds_read_b128 a[16:19], v3 offset:8192
    s_add_u32 m0, s21, 51200
    v_mfma_f32_16x16x32_bf16 v[56:59], a[52:55], v[248:251], v[56:59]
    v_mfma_f32_16x16x32_bf16 v[60:63], a[52:55], v[252:255], v[60:63]
    ds_read_b128 a[20:23], v3 offset:10240
    s_add_u32 s64, s20, 0x55180
    buffer_load_dwordx4 v2, s[4:7], s64 offen lds
    v_mfma_f32_16x16x32_bf16 v[64:67], a[56:59], v[248:251], v[64:67]
    v_mfma_f32_16x16x32_bf16 v[68:71], a[56:59], v[252:255], v[68:71]
    ds_read_b128 a[24:27], v3 offset:12288
    s_add_u32 m0, s21, 52224
    v_mfma_f32_16x16x32_bf16 v[72:75], a[60:63], v[248:251], v[72:75]
    v_mfma_f32_16x16x32_bf16 v[76:79], a[60:63], v[252:255], v[76:79]
    ds_read_b128 a[28:31], v3 offset:14336
    s_add_u32 s64, s20, 0x57980
    buffer_load_dwordx4 v2, s[4:7], s64 offen lds
    s_nop 5
    s_mul_i32 s65, s17, 0
    s_add_u32 s65, s65, s22
    s_add_u32 s64, s65, 0
    v_cvt_pk_bf16_f32 v80, v16, v17
    v_cvt_pk_bf16_f32 v81, v18, v19
    v_cvt_pk_bf16_f32 v82, v24, v25
    v_cvt_pk_bf16_f32 v83, v26, v27
    buffer_store_dwordx4 v[80:83], v1, s[4:7], s64 offen sc1
    s_add_u32 s64, s65, 1024
    v_cvt_pk_bf16_f32 v84, v20, v21
    v_cvt_pk_bf16_f32 v85, v22, v23
    v_cvt_pk_bf16_f32 v86, v28, v29
    v_cvt_pk_bf16_f32 v87, v30, v31
    buffer_store_dwordx4 v[84:87], v1, s[4:7], s64 offen sc1
    s_mul_i32 s65, s17, 1
    s_add_u32 s65, s65, s22
    s_add_u32 s64, s65, 0
    v_cvt_pk_bf16_f32 v88, v32, v33
    v_cvt_pk_bf16_f32 v89, v34, v35
    v_cvt_pk_bf16_f32 v90, v40, v41
    v_cvt_pk_bf16_f32 v91, v42, v43
    buffer_store_dwordx4 v[88:91], v1, s[4:7], s64 offen sc1
    s_add_u32 s64, s65, 1024
    v_cvt_pk_bf16_f32 v92, v36, v37
    v_cvt_pk_bf16_f32 v93, v38, v39
    v_cvt_pk_bf16_f32 v94, v44, v45
    v_cvt_pk_bf16_f32 v95, v46, v47
    buffer_store_dwordx4 v[92:95], v1, s[4:7], s64 offen sc1
    s_mul_i32 s65, s17, 2
    s_add_u32 s65, s65, s22
    s_add_u32 s64, s65, 0
    v_cvt_pk_bf16_f32 v80, v48, v49
    v_cvt_pk_bf16_f32 v81, v50, v51
    v_cvt_pk_bf16_f32 v82, v56, v57
    v_cvt_pk_bf16_f32 v83, v58, v59
    buffer_store_dwordx4 v[80:83], v1, s[4:7], s64 offen sc1
    s_add_u32 s64, s65, 1024
    v_cvt_pk_bf16_f32 v84, v52, v53
    v_cvt_pk_bf16_f32 v85, v54, v55
    v_cvt_pk_bf16_f32 v86, v60, v61
    v_cvt_pk_bf16_f32 v87, v62, v63
    buffer_store_dwordx4 v[84:87], v1, s[4:7], s64 offen sc1
    s_mul_i32 s65, s17, 3
    s_add_u32 s65, s65, s22
    s_add_u32 s64, s65, 0
    v_cvt_pk_bf16_f32 v88, v64, v65
    v_cvt_pk_bf16_f32 v89, v66, v67
    v_cvt_pk_bf16_f32 v90, v72, v73
    v_cvt_pk_bf16_f32 v91, v74, v75
    buffer_store_dwordx4 v[88:91], v1, s[4:7], s64 offen sc1
    s_add_u32 s64, s65, 1024
    v_cvt_pk_bf16_f32 v92, v68, v69
    v_cvt_pk_bf16_f32 v93, v70, v71
    v_cvt_pk_bf16_f32 v94, v76, v77
    v_cvt_pk_bf16_f32 v95, v78, v79
    buffer_store_dwordx4 v[92:95], v1, s[4:7], s64 offen sc1
    s_lshl_b32 s64, s19, 1
    s_add_u32 s64, s64, s12
    s_lshl_b32 s64, s64, 9
    s_add_u32 s23, s18, s64
    s_lshl_b32 s64, s17, 3
    s_add_u32 s22, s22, s64
    s_add_u32 s19, s19, 1
    s_add_u32 s20, s20, 0x50000
    s_cmp_lg_u32 s19, 1
    s_cbranch_scc1 GE0_150
    s_waitcnt vmcnt(0)
    s_barrier
    s_cmp_lg_u32 s14, 0
    s_cbranch_scc1 GF_151
    v_mov_b32 v7, 1
    v_mov_b32 v8, 0
    s_mov_b64 exec, 1
    buffer_store_dword v7, v8, s[4:7], s23 offen sc1
    s_mov_b64 exec, -1
GF_151:
GE0_150:
    s_cmp_lt_u32 s19, 8
    s_cbranch_scc1 G_N_LOOP
    s_waitcnt vmcnt(0) lgkmcnt(0)
    s_barrier
    s_cmp_lg_u32 s14, 0
    s_cbranch_scc1 GF_152
    v_mov_b32 v7, 1
    v_mov_b32 v8, 0
    s_mov_b64 exec, 1
    buffer_store_dword v7, v8, s[4:7], s23 offen sc1
    s_mov_b64 exec, -1
GF_152:
    s_cmp_eq_u32 s12, 1
    s_cbranch_scc1 H_OUT
    s_lshl_b32 s88, s3, 5
    s_add_u32 s88, s88, s13
    s_mov_b32 s29, 0
    v_lshlrev_b32 v1, 4, v0
    s_mov_b32 s65, 0
CW_153:
    buffer_load_dwordx2 v[8:9], off, s[60:63], 0 offset:132 sc1
    s_add_u32 s65, s65, 1
    s_waitcnt vmcnt(0)
    v_readfirstlane_b32 s66, v8
    v_readfirstlane_b32 s67, v9
    s_min_u32 s64, s66, s67
    s_cmp_lg_u32 s64, 0
    s_cbranch_scc1 CWD_154
    s_cmp_gt_u32 s65, 65536
    s_cbranch_scc1 CWD_154
    s_sleep 4
    s_branch CW_153
CWD_154:
    s_sub_u32 s66, s66, 1
    s_and_b32 s66, s66, 3
    s_sub_u32 s67, s67, 1
    s_and_b32 s67, s67, 3
    s_mov_b32 s64, s66
    s_mov_b32 s65, s67
    s_and_b32 s64, s64, 3
    s_lshl_b32 s64, s64, 13
    s_and_b32 s65, s65, 3
    s_lshl_b32 s65, s65, 13
    s_add_u32 s25, s64, 0x6000000
    s_add_u32 s30, s65, 0x6200000
    v_bfe_u32 v4, v0, 3, 1
    v_mul_u32_u24 v2, 0x8000, v4
    v_lshrrev_b32 v4, 5, v0
    v_lshl_add_u32 v2, v4, 8, v2
    v_bfe_u32 v4, v0, 4, 1
    v_lshl_add_u32 v2, v4, 7, v2
    v_and_b32 v4, 7, v0
    v_lshl_add_u32 v2, v4, 4, v2
    v_lshrrev_b32 v4, 5, v0
    v_lshlrev_b32 v3, 16, v4
    v_bfe_u32 v4, v0, 4, 1
    v_lshl_add_u32 v3, v4, 7, v3
    v_and_b32 v4, 15, v0
    v_lshl_add_u32 v3, v4, 3, v3
    s_lshl_b32 s26, s13, 11
    s_lshl_b32 s64, s14, 9
    s_add_u32 s26, s26, s64
    s_add_u32 s26, s26, 0xa40000
    s_lshl_b32 s27, s13, 3
    s_add_u32 s27, s27, 0x294004
    s_mov_b32 s28, 0x29a000
    s_mov_b32 s24, 0
    v_lshlrev_b32 v6, 7, v0
MKN_LOOP:
    s_cmp_lg_u32 s24, 10
    s_cbranch_scc1 MKH_155
    v_mov_b32 v10, v2
    v_mov_b32 v11, v3
    s_cmp_ge_u32 s88, 60
    s_cbranch_scc1 NOWO_156
    s_mov_b32 s89, s13
    s_mul_hi_u32 s65, s88, 0xccccccd
    s_mul_i32 s65, s65, 20
    s_sub_u32 s13, s88, s65
    s_load_dwordx2 s[44:45], s[0:1], 40
    s_mov_b32 s46, 0x500000
    s_mov_b32 s47, 0x00020000
    s_waitcnt lgkmcnt(0)
    s_mul_i32 s21, s14, 36864
    v_lshrrev_b32 v7, 2, v0
    v_mul_u32_u24 v4, 1280, v7
    v_bfe_u32 v7, v0, 4, 1
    v_lshlrev_b32 v7, 1, v7
    v_and_b32 v8, 3, v0
    v_xor_b32 v7, v7, v8
    v_lshl_add_u32 v4, v7, 4, v4
    v_lshrrev_b32 v7, 4, v0
    v_lshlrev_b32 v2, 8, v7
    v_bfe_u32 v7, v0, 2, 2
    v_lshl_add_u32 v2, v7, 6, v2
    v_and_b32 v7, 3, v0
    v_lshl_add_u32 v2, v7, 3, v2
    v_add_u32 v2, s21, v2
    v_bfe_u32 v7, v0, 4, 1
    v_lshlrev_b32 v7, 5, v7
    v_sub_u32 v3, 32, v7
    v_add_u32 v3, v3, v2
    v_add_u32 v2, v2, v7
    s_mul_i32 s65, s14, 1310720
    s_lshl_b32 s66, s13, 6
    s_add_u32 s65, s65, s66
    s_add_u32 m0, s21, 0
    s_add_u32 s64, s65, 0x0
    buffer_load_dwordx4 v4, s[44:47], s64 offen lds
    s_add_u32 m0, s21, 1024
    s_add_u32 s64, s65, 0x5000
    buffer_load_dwordx4 v4, s[44:47], s64 offen lds
    s_add_u32 m0, s21, 2048
    s_add_u32 s64, s65, 0xa000
    buffer_load_dwordx4 v4, s[44:47], s64 offen lds
    s_add_u32 m0, s21, 3072
    s_add_u32 s64, s65, 0xf000
    buffer_load_dwordx4 v4, s[44:47], s64 offen lds
    s_add_u32 m0, s21, 4096
    s_add_u32 s64, s65, 0x14000
    buffer_load_dwordx4 v4, s[44:47], s64 offen lds
    s_add_u32 m0, s21, 5120
    s_add_u32 s64, s65, 0x19000
    buffer_load_dwordx4 v4, s[44:47], s64 offen lds
    s_add_u32 m0, s21, 6144
    s_add_u32 s64, s65, 0x1e000
    buffer_load_dwordx4 v4, s[44:47], s64 offen lds
    s_add_u32 m0, s21, 7168
    s_add_u32 s64, s65, 0x23000
    buffer_load_dwordx4 v4, s[44:47], s64 offen lds
    s_add_u32 m0, s21, 8192
    s_add_u32 s64, s65, 0x28000
    buffer_load_dwordx4 v4, s[44:47], s64 offen lds
    s_add_u32 m0, s21, 9216
    s_add_u32 s64, s65, 0x2d000
    buffer_load_dwordx4 v4, s[44:47], s64 offen lds
    s_add_u32 m0, s21, 10240
    s_add_u32 s64, s65, 0x32000
    buffer_load_dwordx4 v4, s[44:47], s64 offen lds
    s_add_u32 m0, s21, 11264
    s_add_u32 s64, s65, 0x37000
    buffer_load_dwordx4 v4, s[44:47], s64 offen lds
    s_add_u32 m0, s21, 12288
    s_add_u32 s64, s65, 0x3c000
    buffer_load_dwordx4 v4, s[44:47], s64 offen lds
    s_add_u32 m0, s21, 13312
    s_add_u32 s64, s65, 0x41000
    buffer_load_dwordx4 v4, s[44:47], s64 offen lds
    s_add_u32 m0, s21, 14336
    s_add_u32 s64, s65, 0x46000
    buffer_load_dwordx4 v4, s[44:47], s64 offen lds
    s_add_u32 m0, s21, 15360
    s_add_u32 s64, s65, 0x4b000
    buffer_load_dwordx4 v4, s[44:47], s64 offen lds
    s_add_u32 m0, s21, 16384
    s_add_u32 s64, s65, 0x50000
    buffer_load_dwordx4 v4, s[44:47], s64 offen lds
    s_add_u32 m0, s21, 17408
    s_add_u32 s64, s65, 0x55000
    buffer_load_dwordx4 v4, s[44:47], s64 offen lds
    s_add_u32 m0, s21, 18432
    s_add_u32 s64, s65, 0x5a000
    buffer_load_dwordx4 v4, s[44:47], s64 offen lds
    s_add_u32 m0, s21, 19456
    s_add_u32 s64, s65, 0x5f000
    buffer_load_dwordx4 v4, s[44:47], s64 offen lds
    s_add_u32 m0, s21, 20480
    s_add_u32 s64, s65, 0x64000
    buffer_load_dwordx4 v4, s[44:47], s64 offen lds
    s_add_u32 m0, s21, 21504
    s_add_u32 s64, s65, 0x69000
    buffer_load_dwordx4 v4, s[44:47], s64 offen lds
    s_add_u32 m0, s21, 22528
    s_add_u32 s64, s65, 0x6e000
    buffer_load_dwordx4 v4, s[44:47], s64 offen lds
    s_add_u32 m0, s21, 23552
    s_add_u32 s64, s65, 0x73000
    buffer_load_dwordx4 v4, s[44:47], s64 offen lds
    s_add_u32 m0, s21, 24576
    s_add_u32 s64, s65, 0x78000
    buffer_load_dwordx4 v4, s[44:47], s64 offen lds
    s_add_u32 m0, s21, 25600
    s_add_u32 s64, s65, 0x7d000
    buffer_load_dwordx4 v4, s[44:47], s64 offen lds
    s_add_u32 m0, s21, 26624
    s_add_u32 s64, s65, 0x82000
    buffer_load_dwordx4 v4, s[44:47], s64 offen lds
    s_add_u32 m0, s21, 27648
    s_add_u32 s64, s65, 0x87000
    buffer_load_dwordx4 v4, s[44:47], s64 offen lds
    s_add_u32 m0, s21, 28672
    s_add_u32 s64, s65, 0x8c000
    buffer_load_dwordx4 v4, s[44:47], s64 offen lds
    s_add_u32 m0, s21, 29696
    s_add_u32 s64, s65, 0x91000
    buffer_load_dwordx4 v4, s[44:47], s64 offen lds
    s_add_u32 m0, s21, 30720
    s_add_u32 s64, s65, 0x96000
    buffer_load_dwordx4 v4, s[44:47], s64 offen lds
    s_add_u32 m0, s21, 31744
    s_add_u32 s64, s65, 0x9b000
    buffer_load_dwordx4 v4, s[44:47], s64 offen lds
    s_add_u32 m0, s21, 32768
    s_add_u32 s64, s65, 0xa0000
    buffer_load_dwordx4 v4, s[44:47], s64 offen lds
    s_add_u32 m0, s21, 33792
    s_add_u32 s64, s65, 0xa5000
    buffer_load_dwordx4 v4, s[44:47], s64 offen lds
    s_add_u32 m0, s21, 34816
    s_add_u32 s64, s65, 0xaa000
    buffer_load_dwordx4 v4, s[44:47], s64 offen lds
    s_add_u32 m0, s21, 35840
    s_add_u32 s64, s65, 0xaf000
    buffer_load_dwordx4 v4, s[44:47], s64 offen lds
    s_waitcnt vmcnt(32)
    ds_read_b64_tr_b16 a[0:1], v2 offset:0
    ds_read_b64_tr_b16 a[2:3], v2 offset:1024
    ds_read_b64_tr_b16 a[4:5], v3 offset:0
    ds_read_b64_tr_b16 a[6:7], v3 offset:1024
    ds_read_b64_tr_b16 a[8:9], v2 offset:2048
    ds_read_b64_tr_b16 a[10:11], v2 offset:3072
    ds_read_b64_tr_b16 a[12:13], v3 offset:2048
    ds_read_b64_tr_b16 a[14:15], v3 offset:3072
    s_waitcnt lgkmcnt(0)
    s_add_u32 m0, s21, 0
    s_add_u32 s64, s65, 0xb4000
    buffer_load_dwordx4 v4, s[44:47], s64 offen lds
    s_add_u32 m0, s21, 1024
    s_add_u32 s64, s65, 0xb9000
    buffer_load_dwordx4 v4, s[44:47], s64 offen lds
    s_add_u32 m0, s21, 2048
    s_add_u32 s64, s65, 0xbe000
    buffer_load_dwordx4 v4, s[44:47], s64 offen lds
    s_add_u32 m0, s21, 3072
    s_add_u32 s64, s65, 0xc3000
    buffer_load_dwordx4 v4, s[44:47], s64 offen lds
    s_waitcnt vmcnt(32)
    ds_read_b64_tr_b16 a[16:17], v2 offset:4096
    ds_read_b64_tr_b16 a[18:19], v2 offset:5120
    ds_read_b64_tr_b16 a[20:21], v3 offset:4096
    ds_read_b64_tr_b16 a[22:23], v3 offset:5120
    ds_read_b64_tr_b16 a[24:25], v2 offset:6144
    ds_read_b64_tr_b16 a[26:27], v2 offset:7168
    ds_read_b64_tr_b16 a[28:29], v3 offset:6144
    ds_read_b64_tr_b16 a[30:31], v3 offset:7168
    s_waitcnt lgkmcnt(0)
    s_add_u32 m0, s21, 4096
    s_add_u32 s64, s65, 0xc8000
    buffer_load_dwordx4 v4, s[44:47], s64 offen lds
    s_add_u32 m0, s21, 5120
    s_add_u32 s64, s65, 0xcd000
    buffer_load_dwordx4 v4, s[44:47], s64 offen lds
    s_add_u32 m0, s21, 6144
    s_add_u32 s64, s65, 0xd2000
    buffer_load_dwordx4 v4, s[44:47], s64 offen lds
    s_add_u32 m0, s21, 7168
    s_add_u32 s64, s65, 0xd7000
    buffer_load_dwordx4 v4, s[44:47], s64 offen lds
    s_waitcnt vmcnt(32)
    ds_read_b64_tr_b16 a[32:33], v2 offset:8192
    ds_read_b64_tr_b16 a[34:35], v2 offset:9216
    ds_read_b64_tr_b16 a[36:37], v3 offset:8192
    ds_read_b64_tr_b16 a[38:39], v3 offset:9216
    ds_read_b64_tr_b16 a[40:41], v2 offset:10240
    ds_read_b64_tr_b16 a[42:43], v2 offset:11264
    ds_read_b64_tr_b16 a[44:45], v3 offset:10240
    ds_read_b64_tr_b16 a[46:47], v3 offset:11264
    s_waitcnt lgkmcnt(0)
    s_add_u32 m0, s21, 8192
    s_add_u32 s64, s65, 0xdc000
    buffer_load_dwordx4 v4, s[44:47], s64 offen lds
    s_add_u32 m0, s21, 9216
    s_add_u32 s64, s65, 0xe1000
    buffer_load_dwordx4 v4, s[44:47], s64 offen lds
    s_add_u32 m0, s21, 10240
    s_add_u32 s64, s65, 0xe6000
    buffer_load_dwordx4 v4, s[44:47], s64 offen lds
    s_add_u32 m0, s21, 11264
    s_add_u32 s64, s65, 0xeb000
    buffer_load_dwordx4 v4, s[44:47], s64 offen lds
    s_waitcnt vmcnt(32)
    ds_read_b64_tr_b16 a[48:49], v2 offset:12288
    ds_read_b64_tr_b16 a[50:51], v2 offset:13312
    ds_read_b64_tr_b16 a[52:53], v3 offset:12288
    ds_read_b64_tr_b16 a[54:55], v3 offset:13312
    ds_read_b64_tr_b16 a[56:57], v2 offset:14336
    ds_read_b64_tr_b16 a[58:59], v2 offset:15360
    ds_read_b64_tr_b16 a[60:61], v3 offset:14336
    ds_read_b64_tr_b16 a[62:63], v3 offset:15360
    s_waitcnt lgkmcnt(0)
    s_add_u32 m0, s21, 12288
    s_add_u32 s64, s65, 0xf0000
    buffer_load_dwordx4 v4, s[44:47], s64 offen lds
    s_add_u32 m0, s21, 13312
    s_add_u32 s64, s65, 0xf5000
    buffer_load_dwordx4 v4, s[44:47], s64 offen lds
    s_add_u32 m0, s21, 14336
    s_add_u32 s64, s65, 0xfa000
    buffer_load_dwordx4 v4, s[44:47], s64 offen lds
    s_add_u32 m0, s21, 15360
    s_add_u32 s64, s65, 0xff000
    buffer_load_dwordx4 v4, s[44:47], s64 offen lds
    s_waitcnt vmcnt(32)
    ds_read_b64_tr_b16 a[64:65], v2 offset:16384
    ds_read_b64_tr_b16 a[66:67], v2 offset:17408
    ds_read_b64_tr_b16 a[68:69], v3 offset:16384
    ds_read_b64_tr_b16 a[70:71], v3 offset:17408
    ds_read_b64_tr_b16 a[72:73], v2 offset:18432
    ds_read_b64_tr_b16 a[74:75], v2 offset:19456
    ds_read_b64_tr_b16 a[76:77], v3 offset:18432
    ds_read_b64_tr_b16 a[78:79], v3 offset:19456
    s_waitcnt lgkmcnt(0)
    s_add_u32 m0, s21, 16384
    s_add_u32 s64, s65, 0x104000
    buffer_load_dwordx4 v4, s[44:47], s64 offen lds
    s_add_u32 m0, s21, 17408
    s_add_u32 s64, s65, 0x109000
    buffer_load_dwordx4 v4, s[44:47], s64 offen lds
    s_add_u32 m0, s21, 18432
    s_add_u32 s64, s65, 0x10e000
    buffer_load_dwordx4 v4, s[44:47], s64 offen lds
    s_add_u32 m0, s21, 19456
    s_add_u32 s64, s65, 0x113000
    buffer_load_dwordx4 v4, s[44:47], s64 offen lds
    s_waitcnt vmcnt(32)
    ds_read_b64_tr_b16 a[80:81], v2 offset:20480
    ds_read_b64_tr_b16 a[82:83], v2 offset:21504
    ds_read_b64_tr_b16 a[84:85], v3 offset:20480
    ds_read_b64_tr_b16 a[86:87], v3 offset:21504
    ds_read_b64_tr_b16 a[88:89], v2 offset:22528
    ds_read_b64_tr_b16 a[90:91], v2 offset:23552
    ds_read_b64_tr_b16 a[92:93], v3 offset:22528
    ds_read_b64_tr_b16 a[94:95], v3 offset:23552
    s_waitcnt lgkmcnt(0)
    s_add_u32 m0, s21, 20480
    s_add_u32 s64, s65, 0x118000
    buffer_load_dwordx4 v4, s[44:47], s64 offen lds
    s_add_u32 m0, s21, 21504
    s_add_u32 s64, s65, 0x11d000
    buffer_load_dwordx4 v4, s[44:47], s64 offen lds
    s_add_u32 m0, s21, 22528
    s_add_u32 s64, s65, 0x122000
    buffer_load_dwordx4 v4, s[44:47], s64 offen lds
    s_add_u32 m0, s21, 23552
    s_add_u32 s64, s65, 0x127000
    buffer_load_dwordx4 v4, s[44:47], s64 offen lds
    s_waitcnt vmcnt(32)
    ds_read_b64_tr_b16 a[96:97], v2 offset:24576
    ds_read_b64_tr_b16 a[98:99], v2 offset:25600
    ds_read_b64_tr_b16 a[100:101], v3 offset:24576
    ds_read_b64_tr_b16 a[102:103], v3 offset:25600
    ds_read_b64_tr_b16 a[104:105], v2 offset:26624
    ds_read_b64_tr_b16 a[106:107], v2 offset:27648
    ds_read_b64_tr_b16 a[108:109], v3 offset:26624
    ds_read_b64_tr_b16 a[110:111], v3 offset:27648
    s_waitcnt lgkmcnt(0)
    s_add_u32 m0, s21, 24576
    s_add_u32 s64, s65, 0x12c000
    buffer_load_dwordx4 v4, s[44:47], s64 offen lds
    s_add_u32 m0, s21, 25600
    s_add_u32 s64, s65, 0x131000
    buffer_load_dwordx4 v4, s[44:47], s64 offen lds
    s_add_u32 m0, s21, 26624
    s_add_u32 s64, s65, 0x136000
    buffer_load_dwordx4 v4, s[44:47], s64 offen lds
    s_add_u32 m0, s21, 27648
    s_add_u32 s64, s65, 0x13b000
    buffer_load_dwordx4 v4, s[44:47], s64 offen lds
    s_waitcnt vmcnt(32)
    ds_read_b64_tr_b16 a[112:113], v2 offset:28672
    ds_read_b64_tr_b16 a[114:115], v2 offset:29696
    ds_read_b64_tr_b16 a[116:117], v3 offset:28672
    ds_read_b64_tr_b16 a[118:119], v3 offset:29696
    ds_read_b64_tr_b16 a[120:121], v2 offset:30720
    ds_read_b64_tr_b16 a[122:123], v2 offset:31744
    ds_read_b64_tr_b16 a[124:125], v3 offset:30720
    ds_read_b64_tr_b16 a[126:127], v3 offset:31744
    s_waitcnt lgkmcnt(0)
    s_waitcnt vmcnt(28)
    ds_read_b64_tr_b16 a[128:129], v2 offset:32768
    ds_read_b64_tr_b16 a[130:131], v2 offset:33792
    ds_read_b64_tr_b16 a[132:133], v3 offset:32768
    ds_read_b64_tr_b16 a[134:135], v3 offset:33792
    ds_read_b64_tr_b16 a[136:137], v2 offset:34816
    ds_read_b64_tr_b16 a[138:139], v2 offset:35840
    ds_read_b64_tr_b16 a[140:141], v3 offset:34816
    ds_read_b64_tr_b16 a[142:143], v3 offset:35840
    s_waitcnt lgkmcnt(0)
    s_waitcnt vmcnt(24)
    ds_read_b64_tr_b16 a[144:145], v2 offset:0
    ds_read_b64_tr_b16 a[146:147], v2 offset:1024
    ds_read_b64_tr_b16 a[148:149], v3 offset:0
    ds_read_b64_tr_b16 a[150:151], v3 offset:1024
    ds_read_b64_tr_b16 a[152:153], v2 offset:2048
    ds_read_b64_tr_b16 a[154:155], v2 offset:3072
    ds_read_b64_tr_b16 a[156:157], v3 offset:2048
    ds_read_b64_tr_b16 a[158:159], v3 offset:3072
    s_waitcnt lgkmcnt(0)
    s_waitcnt vmcnt(20)
    ds_read_b64_tr_b16 a[160:161], v2 offset:4096
    ds_read_b64_tr_b16 a[162:163], v2 offset:5120
    ds_read_b64_tr_b16 a[164:165], v3 offset:4096
    ds_read_b64_tr_b16 a[166:167], v3 offset:5120
    ds_read_b64_tr_b16 a[168:169], v2 offset:6144
    ds_read_b64_tr_b16 a[170:171], v2 offset:7168
    ds_read_b64_tr_b16 a[172:173], v3 offset:6144
    ds_read_b64_tr_b16 a[174:175], v3 offset:7168
    s_waitcnt lgkmcnt(0)
    s_waitcnt vmcnt(16)
    ds_read_b64_tr_b16 a[176:177], v2 offset:8192
    ds_read_b64_tr_b16 a[178:179], v2 offset:9216
    ds_read_b64_tr_b16 a[180:181], v3 offset:8192
    ds_read_b64_tr_b16 a[182:183], v3 offset:9216
    ds_read_b64_tr_b16 a[184:185], v2 offset:10240
    ds_read_b64_tr_b16 a[186:187], v2 offset:11264
    ds_read_b64_tr_b16 a[188:189], v3 offset:10240
    ds_read_b64_tr_b16 a[190:191], v3 offset:11264
    s_waitcnt lgkmcnt(0)
    s_waitcnt vmcnt(12)
    ds_read_b64_tr_b16 a[192:193], v2 offset:12288
    ds_read_b64_tr_b16 a[194:195], v2 offset:13312
    ds_read_b64_tr_b16 a[196:197], v3 offset:12288
    ds_read_b64_tr_b16 a[198:199], v3 offset:13312
    ds_read_b64_tr_b16 a[200:201], v2 offset:14336
    ds_read_b64_tr_b16 a[202:203], v2 offset:15360
    ds_read_b64_tr_b16 a[204:205], v3 offset:14336
    ds_read_b64_tr_b16 a[206:207], v3 offset:15360
    s_waitcnt lgkmcnt(0)
    s_waitcnt vmcnt(8)
    ds_read_b64_tr_b16 a[208:209], v2 offset:16384
    ds_read_b64_tr_b16 a[210:211], v2 offset:17408
    ds_read_b64_tr_b16 a[212:213], v3 offset:16384
    ds_read_b64_tr_b16 a[214:215], v3 offset:17408
    ds_read_b64_tr_b16 a[216:217], v2 offset:18432
    ds_read_b64_tr_b16 a[218:219], v2 offset:19456
    ds_read_b64_tr_b16 a[220:221], v3 offset:18432
    ds_read_b64_tr_b16 a[222:223], v3 offset:19456
    s_waitcnt lgkmcnt(0)
    s_waitcnt vmcnt(4)
    ds_read_b64_tr_b16 a[224:225], v2 offset:20480
    ds_read_b64_tr_b16 a[226:227], v2 offset:21504
    ds_read_b64_tr_b16 a[228:229], v3 offset:20480
    ds_read_b64_tr_b16 a[230:231], v3 offset:21504
    ds_read_b64_tr_b16 a[232:233], v2 offset:22528
    ds_read_b64_tr_b16 a[234:235], v2 offset:23552
    ds_read_b64_tr_b16 a[236:237], v3 offset:22528
    ds_read_b64_tr_b16 a[238:239], v3 offset:23552
    s_waitcnt lgkmcnt(0)
    s_waitcnt vmcnt(0)
    ds_read_b64_tr_b16 a[240:241], v2 offset:24576
    ds_read_b64_tr_b16 a[242:243], v2 offset:25600
    ds_read_b64_tr_b16 a[244:245], v3 offset:24576
    ds_read_b64_tr_b16 a[246:247], v3 offset:25600
    ds_read_b64_tr_b16 a[248:249], v2 offset:26624
    ds_read_b64_tr_b16 a[250:251], v2 offset:27648
    ds_read_b64_tr_b16 a[252:253], v3 offset:26624
    ds_read_b64_tr_b16 a[254:255], v3 offset:27648
    s_waitcnt lgkmcnt(0)
    s_mov_b32 s13, s89
NOWO_156:
    v_mov_b32 v2, v10
    v_mov_b32 v3, v11
MKH_155:
    s_cmp_lg_u32 s24, 31
    s_mov_b64 exec, 0xf
    s_cbranch_scc1 MKL_157
    s_mov_b64 exec, -1
    v_bfe_u32 v4, v0, 3, 1
    v_mul_u32_u24 v4, 0x8000, v4
    v_sub_u32 v2, v2, v4
    s_mov_b64 exec, 3
MKL_157:
MKN_M_158:
    buffer_load_dword v5, v6, s[4:7], s28 offen sc1
    s_add_u32 s29, s29, 1
    s_waitcnt vmcnt(0)
    v_cmp_eq_u32 vcc, 0, v5
    s_cbranch_vccz MKN_MD_159
    s_cmp_gt_u32 s29, 262144
    s_cbranch_scc1 MKN_MD_159
    s_sleep 1
    s_branch MKN_M_158
MKN_MD_159:
    s_mov_b64 exec, -1
MKR_160:
    s_add_u32 s64, s25, 0x0
    buffer_load_dwordx4 v[16:19], v2, s[4:7], s64 offen sc1
    s_add_u32 s64, s25, 0x200
    buffer_load_dwordx4 v[20:23], v2, s[4:7], s64 offen sc1
    s_add_u32 s64, s25, 0x400
    buffer_load_dwordx4 v[24:27], v2, s[4:7], s64 offen sc1
    s_add_u32 s64, s25, 0x600
    buffer_load_dwordx4 v[28:31], v2, s[4:7], s64 offen sc1
    s_add_u32 s64, s25, 0x800
    buffer_load_dwordx4 v[32:35], v2, s[4:7], s64 offen sc1
    s_add_u32 s64, s25, 0xa00
    buffer_load_dwordx4 v[36:39], v2, s[4:7], s64 offen sc1
    s_add_u32 s64, s25, 0xc00
    buffer_load_dwordx4 v[40:43], v2, s[4:7], s64 offen sc1
    s_add_u32 s64, s25, 0xe00
    buffer_load_dwordx4 v[44:47], v2, s[4:7], s64 offen sc1
    s_add_u32 s64, s25, 0x1000
    buffer_load_dwordx4 v[48:51], v2, s[4:7], s64 offen sc1
    s_add_u32 s64, s25, 0x1200
    buffer_load_dwordx4 v[52:55], v2, s[4:7], s64 offen sc1
    s_add_u32 s64, s30, 0x0
    buffer_load_dwordx4 v[56:59], v2, s[4:7], s64 offen sc1
    s_add_u32 s64, s30, 0x200
    buffer_load_dwordx4 v[60:63], v2, s[4:7], s64 offen sc1
    s_add_u32 s64, s30, 0x400
    buffer_load_dwordx4 v[64:67], v2, s[4:7], s64 offen sc1
    s_add_u32 s64, s30, 0x600
    buffer_load_dwordx4 v[68:71], v2, s[4:7], s64 offen sc1
    s_add_u32 s64, s30, 0x800
    buffer_load_dwordx4 v[72:75], v2, s[4:7], s64 offen sc1
    s_add_u32 s64, s30, 0xa00
    buffer_load_dwordx4 v[76:79], v2, s[4:7], s64 offen sc1
    s_add_u32 s64, s30, 0xc00
    buffer_load_dwordx4 v[80:83], v2, s[4:7], s64 offen sc1
    s_add_u32 s64, s30, 0xe00
    buffer_load_dwordx4 v[84:87], v2, s[4:7], s64 offen sc1
    s_add_u32 s64, s30, 0x1000
    buffer_load_dwordx4 v[88:91], v2, s[4:7], s64 offen sc1
    s_add_u32 s64, s30, 0x1200
    buffer_load_dwordx4 v[92:95], v2, s[4:7], s64 offen sc1
    s_add_u32 s29, s29, 1
    s_waitcnt vmcnt(0)
    v_max3_u32 v4, v19, v23, v27
    v_max3_u32 v4, v4, v31, v35
    v_max3_u32 v4, v4, v39, v43
    v_max3_u32 v4, v4, v47, v51
    v_max3_u32 v4, v4, v55, v59
    v_max3_u32 v4, v4, v63, v67
    v_max3_u32 v4, v4, v71, v75
    v_max3_u32 v4, v4, v79, v83
    v_max3_u32 v4, v4, v87, v91
    v_max_u32 v4, v4, v95
    v_cmp_eq_u32 vcc, -1, v4
    s_cbranch_vccz MKO_161
    s_cmp_gt_u32 s29, 262144
    s_cbranch_scc0 MKR_160
MKO_161:
    v_mfma_f32_16x16x32_bf16 v[8:11], v[16:19], v[96:99], 0
    v_mfma_f32_16x16x32_bf16 v[12:15], v[16:19], v[100:103], 0
    v_mfma_f32_16x16x32_bf16 v[8:11], v[20:23], v[104:107], v[8:11]
    v_mfma_f32_16x16x32_bf16 v[12:15], v[20:23], v[108:111], v[12:15]
    v_mfma_f32_16x16x32_bf16 v[8:11], v[24:27], v[112:115], v[8:11]
    v_mfma_f32_16x16x32_bf16 v[12:15], v[24:27], v[116:119], v[12:15]
    v_mfma_f32_16x16x32_bf16 v[8:11], v[28:31], v[120:123], v[8:11]
    v_mfma_f32_16x16x32_bf16 v[12:15], v[28:31], v[124:127], v[12:15]
    v_mfma_f32_16x16x32_bf16 v[8:11], v[32:35], v[128:131], v[8:11]
    v_mfma_f32_16x16x32_bf16 v[12:15], v[32:35], v[132:135], v[12:15]
    v_mfma_f32_16x16x32_bf16 v[8:11], v[36:39], v[136:139], v[8:11]
    v_mfma_f32_16x16x32_bf16 v[12:15], v[36:39], v[140:143], v[12:15]
    v_mfma_f32_16x16x32_bf16 v[8:11], v[40:43], v[144:147], v[8:11]
    v_mfma_f32_16x16x32_bf16 v[12:15], v[40:43], v[148:151], v[12:15]
    v_mfma_f32_16x16x32_bf16 v[8:11], v[44:47], v[152:155], v[8:11]
    v_mfma_f32_16x16x32_bf16 v[12:15], v[44:47], v[156:159], v[12:15]
    v_mfma_f32_16x16x32_bf16 v[8:11], v[48:51], v[160:163], v[8:11]
    v_mfma_f32_16x16x32_bf16 v[12:15], v[48:51], v[164:167], v[12:15]
    v_mfma_f32_16x16x32_bf16 v[8:11], v[52:55], v[168:171], v[8:11]
    v_mfma_f32_16x16x32_bf16 v[12:15], v[52:55], v[172:175], v[12:15]
    v_mfma_f32_16x16x32_bf16 v[8:11], v[56:59], v[176:179], v[8:11]
    v_mfma_f32_16x16x32_bf16 v[12:15], v[56:59], v[180:183], v[12:15]
    v_mfma_f32_16x16x32_bf16 v[8:11], v[60:63], v[184:187], v[8:11]
    v_mfma_f32_16x16x32_bf16 v[12:15], v[60:63], v[188:191], v[12:15]
    v_mfma_f32_16x16x32_bf16 v[8:11], v[64:67], v[192:195], v[8:11]
    v_mfma_f32_16x16x32_bf16 v[12:15], v[64:67], v[196:199], v[12:15]
    v_mfma_f32_16x16x32_bf16 v[8:11], v[68:71], v[200:203], v[8:11]
    v_mfma_f32_16x16x32_bf16 v[12:15], v[68:71], v[204:207], v[12:15]
    v_mfma_f32_16x16x32_bf16 v[8:11], v[72:75], v[208:211], v[8:11]
    v_mfma_f32_16x16x32_bf16 v[12:15], v[72:75], v[212:215], v[12:15]
    v_mfma_f32_16x16x32_bf16 v[8:11], v[76:79], v[216:219], v[8:11]
    v_mfma_f32_16x16x32_bf16 v[12:15], v[76:79], v[220:223], v[12:15]
    v_mfma_f32_16x16x32_bf16 v[8:11], v[80:83], v[224:227], v[8:11]
    v_mfma_f32_16x16x32_bf16 v[12:15], v[80:83], v[228:231], v[12:15]
    v_mfma_f32_16x16x32_bf16 v[8:11], v[84:87], v[232:235], v[8:11]
    v_mfma_f32_16x16x32_bf16 v[12:15], v[84:87], v[236:239], v[12:15]
    v_mfma_f32_16x16x32_bf16 v[8:11], v[88:91], v[240:243], v[8:11]
    v_mfma_f32_16x16x32_bf16 v[12:15], v[88:91], v[244:247], v[12:15]
    v_mfma_f32_16x16x32_bf16 v[8:11], v[92:95], v[248:251], v[8:11]
    v_mfma_f32_16x16x32_bf16 v[12:15], v[92:95], v[252:255], v[12:15]
    s_nop 7
    v_cvt_pk_bf16_f32 v16, v8, v9
    v_cvt_pk_bf16_f32 v17, v10, v11
    v_cvt_pk_bf16_f32 v18, v12, v13
    v_cvt_pk_bf16_f32 v19, v14, v15
    buffer_store_dwordx2 v[16:17], v3, s[4:7], s26 offen sc1
    buffer_store_dwordx2 v[18:19], v3, s[4:7], s26 offen offset:256 sc1
    s_waitcnt vmcnt(0)
    s_barrier
    s_cmp_lg_u32 s14, 0
    s_cbranch_scc1 GF_162
    v_mov_b32 v7, 1
    v_mov_b32 v8, 0
    s_mov_b64 exec, 1
    buffer_store_dword v7, v8, s[4:7], s27 offen sc1
    s_mov_b64 exec, -1
GF_162:
    s_add_u32 s25, s25, 0x10000
    s_add_u32 s30, s30, 0x10000
    s_add_u32 s26, s26, 0x20000
    s_add_u32 s27, s27, 256
    s_add_u32 s28, s28, 512
    s_add_u32 s24, s24, 1
    s_cmp_lt_u32 s24, 32
    s_cbranch_scc1 MKN_LOOP
    s_cmp_ge_u32 s88, 60
    s_cbranch_scc1 M_EXIT
    s_branch H_EXTRA
H_OUT:
    s_lshl_b32 s64, s3, 5
    s_add_u32 s64, s64, s13
    s_cmp_ge_u32 s64, 60
    s_cbranch_scc1 M_EXIT
    s_mul_hi_u32 s12, s64, 0xccccccd
    s_mul_i32 s65, s12, 20
    s_sub_u32 s13, s64, s65
    s_load_dwordx2 s[44:45], s[0:1], 40
    s_mov_b32 s46, 0x500000
    s_mov_b32 s47, 0x00020000
    s_load_dwordx2 s[48:49], s[0:1], 0
    s_mov_b32 s50, 0x280000
    s_mov_b32 s51, 0x00020000
    s_load_dwordx2 s[52:53], s[0:1], 96
    s_mov_b32 s54, 0x280000
    s_mov_b32 s55, 0x00020000
    s_mov_b32 s36, -1
    s_mov_b32 s37, 0
    s_waitcnt lgkmcnt(0)
    s_mul_i32 s21, s14, 36864
    v_lshrrev_b32 v7, 2, v0
    v_mul_u32_u24 v4, 1280, v7
    v_bfe_u32 v7, v0, 4, 1
    v_lshlrev_b32 v7, 1, v7
    v_and_b32 v8, 3, v0
    v_xor_b32 v7, v7, v8
    v_lshl_add_u32 v4, v7, 4, v4
    v_lshrrev_b32 v7, 4, v0
    v_lshlrev_b32 v2, 8, v7
    v_bfe_u32 v7, v0, 2, 2
    v_lshl_add_u32 v2, v7, 6, v2
    v_and_b32 v7, 3, v0
    v_lshl_add_u32 v2, v7, 3, v2
    v_add_u32 v2, s21, v2
    v_bfe_u32 v7, v0, 4, 1
    v_lshlrev_b32 v7, 5, v7
    v_sub_u32 v3, 32, v7
    v_add_u32 v3, v3, v2
    v_add_u32 v2, v2, v7
    s_mul_i32 s65, s14, 1310720
    s_lshl_b32 s66, s13, 6
    s_add_u32 s65, s65, s66
    s_add_u32 m0, s21, 0
    s_add_u32 s64, s65, 0x0
    buffer_load_dwordx4 v4, s[44:47], s64 offen lds
    s_add_u32 m0, s21, 1024
    s_add_u32 s64, s65, 0x5000
    buffer_load_dwordx4 v4, s[44:47], s64 offen lds
    s_add_u32 m0, s21, 2048
    s_add_u32 s64, s65, 0xa000
    buffer_load_dwordx4 v4, s[44:47], s64 offen lds
    s_add_u32 m0, s21, 3072
    s_add_u32 s64, s65, 0xf000
    buffer_load_dwordx4 v4, s[44:47], s64 offen lds
    s_add_u32 m0, s21, 4096
    s_add_u32 s64, s65, 0x14000
    buffer_load_dwordx4 v4, s[44:47], s64 offen lds
    s_add_u32 m0, s21, 5120
    s_add_u32 s64, s65, 0x19000
    buffer_load_dwordx4 v4, s[44:47], s64 offen lds
    s_add_u32 m0, s21, 6144
    s_add_u32 s64, s65, 0x1e000
    buffer_load_dwordx4 v4, s[44:47], s64 offen lds
    s_add_u32 m0, s21, 7168
    s_add_u32 s64, s65, 0x23000
    buffer_load_dwordx4 v4, s[44:47], s64 offen lds
    s_add_u32 m0, s21, 8192
    s_add_u32 s64, s65, 0x28000
    buffer_load_dwordx4 v4, s[44:47], s64 offen lds
    s_add_u32 m0, s21, 9216
    s_add_u32 s64, s65, 0x2d000
    buffer_load_dwordx4 v4, s[44:47], s64 offen lds
    s_add_u32 m0, s21, 10240
    s_add_u32 s64, s65, 0x32000
    buffer_load_dwordx4 v4, s[44:47], s64 offen lds
    s_add_u32 m0, s21, 11264
    s_add_u32 s64, s65, 0x37000
    buffer_load_dwordx4 v4, s[44:47], s64 offen lds
    s_add_u32 m0, s21, 12288
    s_add_u32 s64, s65, 0x3c000
    buffer_load_dwordx4 v4, s[44:47], s64 offen lds
    s_add_u32 m0, s21, 13312
    s_add_u32 s64, s65, 0x41000
    buffer_load_dwordx4 v4, s[44:47], s64 offen lds
    s_add_u32 m0, s21, 14336
    s_add_u32 s64, s65, 0x46000
    buffer_load_dwordx4 v4, s[44:47], s64 offen lds
    s_add_u32 m0, s21, 15360
    s_add_u32 s64, s65, 0x4b000
    buffer_load_dwordx4 v4, s[44:47], s64 offen lds
    s_add_u32 m0, s21, 16384
    s_add_u32 s64, s65, 0x50000
    buffer_load_dwordx4 v4, s[44:47], s64 offen lds
    s_add_u32 m0, s21, 17408
    s_add_u32 s64, s65, 0x55000
    buffer_load_dwordx4 v4, s[44:47], s64 offen lds
    s_add_u32 m0, s21, 18432
    s_add_u32 s64, s65, 0x5a000
    buffer_load_dwordx4 v4, s[44:47], s64 offen lds
    s_add_u32 m0, s21, 19456
    s_add_u32 s64, s65, 0x5f000
    buffer_load_dwordx4 v4, s[44:47], s64 offen lds
    s_add_u32 m0, s21, 20480
    s_add_u32 s64, s65, 0x64000
    buffer_load_dwordx4 v4, s[44:47], s64 offen lds
    s_add_u32 m0, s21, 21504
    s_add_u32 s64, s65, 0x69000
    buffer_load_dwordx4 v4, s[44:47], s64 offen lds
    s_add_u32 m0, s21, 22528
    s_add_u32 s64, s65, 0x6e000
    buffer_load_dwordx4 v4, s[44:47], s64 offen lds
    s_add_u32 m0, s21, 23552
    s_add_u32 s64, s65, 0x73000
    buffer_load_dwordx4 v4, s[44:47], s64 offen lds
    s_add_u32 m0, s21, 24576
    s_add_u32 s64, s65, 0x78000
    buffer_load_dwordx4 v4, s[44:47], s64 offen lds
    s_add_u32 m0, s21, 25600
    s_add_u32 s64, s65, 0x7d000
    buffer_load_dwordx4 v4, s[44:47], s64 offen lds
    s_add_u32 m0, s21, 26624
    s_add_u32 s64, s65, 0x82000
    buffer_load_dwordx4 v4, s[44:47], s64 offen lds
    s_add_u32 m0, s21, 27648
    s_add_u32 s64, s65, 0x87000
    buffer_load_dwordx4 v4, s[44:47], s64 offen lds
    s_add_u32 m0, s21, 28672
    s_add_u32 s64, s65, 0x8c000
    buffer_load_dwordx4 v4, s[44:47], s64 offen lds
    s_add_u32 m0, s21, 29696
    s_add_u32 s64, s65, 0x91000
    buffer_load_dwordx4 v4, s[44:47], s64 offen lds
    s_add_u32 m0, s21, 30720
    s_add_u32 s64, s65, 0x96000
    buffer_load_dwordx4 v4, s[44:47], s64 offen lds
    s_add_u32 m0, s21, 31744
    s_add_u32 s64, s65, 0x9b000
    buffer_load_dwordx4 v4, s[44:47], s64 offen lds
    s_add_u32 m0, s21, 32768
    s_add_u32 s64, s65, 0xa0000
    buffer_load_dwordx4 v4, s[44:47], s64 offen lds
    s_add_u32 m0, s21, 33792
    s_add_u32 s64, s65, 0xa5000
    buffer_load_dwordx4 v4, s[44:47], s64 offen lds
    s_add_u32 m0, s21, 34816
    s_add_u32 s64, s65, 0xaa000
    buffer_load_dwordx4 v4, s[44:47], s64 offen lds
    s_add_u32 m0, s21, 35840
    s_add_u32 s64, s65, 0xaf000
    buffer_load_dwordx4 v4, s[44:47], s64 offen lds
    s_waitcnt vmcnt(32)
    ds_read_b64_tr_b16 a[0:1], v2 offset:0
    ds_read_b64_tr_b16 a[2:3], v2 offset:1024
    ds_read_b64_tr_b16 a[4:5], v3 offset:0
    ds_read_b64_tr_b16 a[6:7], v3 offset:1024
    ds_read_b64_tr_b16 a[8:9], v2 offset:2048
    ds_read_b64_tr_b16 a[10:11], v2 offset:3072
    ds_read_b64_tr_b16 a[12:13], v3 offset:2048
    ds_read_b64_tr_b16 a[14:15], v3 offset:3072
    s_waitcnt lgkmcnt(0)
    s_add_u32 m0, s21, 0
    s_add_u32 s64, s65, 0xb4000
    buffer_load_dwordx4 v4, s[44:47], s64 offen lds
    s_add_u32 m0, s21, 1024
    s_add_u32 s64, s65, 0xb9000
    buffer_load_dwordx4 v4, s[44:47], s64 offen lds
    s_add_u32 m0, s21, 2048
    s_add_u32 s64, s65, 0xbe000
    buffer_load_dwordx4 v4, s[44:47], s64 offen lds
    s_add_u32 m0, s21, 3072
    s_add_u32 s64, s65, 0xc3000
    buffer_load_dwordx4 v4, s[44:47], s64 offen lds
    s_waitcnt vmcnt(32)
    ds_read_b64_tr_b16 a[16:17], v2 offset:4096
    ds_read_b64_tr_b16 a[18:19], v2 offset:5120
    ds_read_b64_tr_b16 a[20:21], v3 offset:4096
    ds_read_b64_tr_b16 a[22:23], v3 offset:5120
    ds_read_b64_tr_b16 a[24:25], v2 offset:6144
    ds_read_b64_tr_b16 a[26:27], v2 offset:7168
    ds_read_b64_tr_b16 a[28:29], v3 offset:6144
    ds_read_b64_tr_b16 a[30:31], v3 offset:7168
    s_waitcnt lgkmcnt(0)
    s_add_u32 m0, s21, 4096
    s_add_u32 s64, s65, 0xc8000
    buffer_load_dwordx4 v4, s[44:47], s64 offen lds
    s_add_u32 m0, s21, 5120
    s_add_u32 s64, s65, 0xcd000
    buffer_load_dwordx4 v4, s[44:47], s64 offen lds
    s_add_u32 m0, s21, 6144
    s_add_u32 s64, s65, 0xd2000
    buffer_load_dwordx4 v4, s[44:47], s64 offen lds
    s_add_u32 m0, s21, 7168
    s_add_u32 s64, s65, 0xd7000
    buffer_load_dwordx4 v4, s[44:47], s64 offen lds
    s_waitcnt vmcnt(32)
    ds_read_b64_tr_b16 a[32:33], v2 offset:8192
    ds_read_b64_tr_b16 a[34:35], v2 offset:9216
    ds_read_b64_tr_b16 a[36:37], v3 offset:8192
    ds_read_b64_tr_b16 a[38:39], v3 offset:9216
    ds_read_b64_tr_b16 a[40:41], v2 offset:10240
    ds_read_b64_tr_b16 a[42:43], v2 offset:11264
    ds_read_b64_tr_b16 a[44:45], v3 offset:10240
    ds_read_b64_tr_b16 a[46:47], v3 offset:11264
    s_waitcnt lgkmcnt(0)
    s_add_u32 m0, s21, 8192
    s_add_u32 s64, s65, 0xdc000
    buffer_load_dwordx4 v4, s[44:47], s64 offen lds
    s_add_u32 m0, s21, 9216
    s_add_u32 s64, s65, 0xe1000
    buffer_load_dwordx4 v4, s[44:47], s64 offen lds
    s_add_u32 m0, s21, 10240
    s_add_u32 s64, s65, 0xe6000
    buffer_load_dwordx4 v4, s[44:47], s64 offen lds
    s_add_u32 m0, s21, 11264
    s_add_u32 s64, s65, 0xeb000
    buffer_load_dwordx4 v4, s[44:47], s64 offen lds
    s_waitcnt vmcnt(32)
    ds_read_b64_tr_b16 a[48:49], v2 offset:12288
    ds_read_b64_tr_b16 a[50:51], v2 offset:13312
    ds_read_b64_tr_b16 a[52:53], v3 offset:12288
    ds_read_b64_tr_b16 a[54:55], v3 offset:13312
    ds_read_b64_tr_b16 a[56:57], v2 offset:14336
    ds_read_b64_tr_b16 a[58:59], v2 offset:15360
    ds_read_b64_tr_b16 a[60:61], v3 offset:14336
    ds_read_b64_tr_b16 a[62:63], v3 offset:15360
    s_waitcnt lgkmcnt(0)
    s_add_u32 m0, s21, 12288
    s_add_u32 s64, s65, 0xf0000
    buffer_load_dwordx4 v4, s[44:47], s64 offen lds
    s_add_u32 m0, s21, 13312
    s_add_u32 s64, s65, 0xf5000
    buffer_load_dwordx4 v4, s[44:47], s64 offen lds
    s_add_u32 m0, s21, 14336
    s_add_u32 s64, s65, 0xfa000
    buffer_load_dwordx4 v4, s[44:47], s64 offen lds
    s_add_u32 m0, s21, 15360
    s_add_u32 s64, s65, 0xff000
    buffer_load_dwordx4 v4, s[44:47], s64 offen lds
    s_waitcnt vmcnt(32)
    ds_read_b64_tr_b16 a[64:65], v2 offset:16384
    ds_read_b64_tr_b16 a[66:67], v2 offset:17408
    ds_read_b64_tr_b16 a[68:69], v3 offset:16384
    ds_read_b64_tr_b16 a[70:71], v3 offset:17408
    ds_read_b64_tr_b16 a[72:73], v2 offset:18432
    ds_read_b64_tr_b16 a[74:75], v2 offset:19456
    ds_read_b64_tr_b16 a[76:77], v3 offset:18432
    ds_read_b64_tr_b16 a[78:79], v3 offset:19456
    s_waitcnt lgkmcnt(0)
    s_add_u32 m0, s21, 16384
    s_add_u32 s64, s65, 0x104000
    buffer_load_dwordx4 v4, s[44:47], s64 offen lds
    s_add_u32 m0, s21, 17408
    s_add_u32 s64, s65, 0x109000
    buffer_load_dwordx4 v4, s[44:47], s64 offen lds
    s_add_u32 m0, s21, 18432
    s_add_u32 s64, s65, 0x10e000
    buffer_load_dwordx4 v4, s[44:47], s64 offen lds
    s_add_u32 m0, s21, 19456
    s_add_u32 s64, s65, 0x113000
    buffer_load_dwordx4 v4, s[44:47], s64 offen lds
    s_waitcnt vmcnt(32)
    ds_read_b64_tr_b16 a[80:81], v2 offset:20480
    ds_read_b64_tr_b16 a[82:83], v2 offset:21504
    ds_read_b64_tr_b16 a[84:85], v3 offset:20480
    ds_read_b64_tr_b16 a[86:87], v3 offset:21504
    ds_read_b64_tr_b16 a[88:89], v2 offset:22528
    ds_read_b64_tr_b16 a[90:91], v2 offset:23552
    ds_read_b64_tr_b16 a[92:93], v3 offset:22528
    ds_read_b64_tr_b16 a[94:95], v3 offset:23552
    s_waitcnt lgkmcnt(0)
    s_add_u32 m0, s21, 20480
    s_add_u32 s64, s65, 0x118000
    buffer_load_dwordx4 v4, s[44:47], s64 offen lds
    s_add_u32 m0, s21, 21504
    s_add_u32 s64, s65, 0x11d000
    buffer_load_dwordx4 v4, s[44:47], s64 offen lds
    s_add_u32 m0, s21, 22528
    s_add_u32 s64, s65, 0x122000
    buffer_load_dwordx4 v4, s[44:47], s64 offen lds
    s_add_u32 m0, s21, 23552
    s_add_u32 s64, s65, 0x127000
    buffer_load_dwordx4 v4, s[44:47], s64 offen lds
    s_waitcnt vmcnt(32)
    ds_read_b64_tr_b16 a[96:97], v2 offset:24576
    ds_read_b64_tr_b16 a[98:99], v2 offset:25600
    ds_read_b64_tr_b16 a[100:101], v3 offset:24576
    ds_read_b64_tr_b16 a[102:103], v3 offset:25600
    ds_read_b64_tr_b16 a[104:105], v2 offset:26624
    ds_read_b64_tr_b16 a[106:107], v2 offset:27648
    ds_read_b64_tr_b16 a[108:109], v3 offset:26624
    ds_read_b64_tr_b16 a[110:111], v3 offset:27648
    s_waitcnt lgkmcnt(0)
    s_add_u32 m0, s21, 24576
    s_add_u32 s64, s65, 0x12c000
    buffer_load_dwordx4 v4, s[44:47], s64 offen lds
    s_add_u32 m0, s21, 25600
    s_add_u32 s64, s65, 0x131000
    buffer_load_dwordx4 v4, s[44:47], s64 offen lds
    s_add_u32 m0, s21, 26624
    s_add_u32 s64, s65, 0x136000
    buffer_load_dwordx4 v4, s[44:47], s64 offen lds
    s_add_u32 m0, s21, 27648
    s_add_u32 s64, s65, 0x13b000
    buffer_load_dwordx4 v4, s[44:47], s64 offen lds
    s_waitcnt vmcnt(32)
    ds_read_b64_tr_b16 a[112:113], v2 offset:28672
    ds_read_b64_tr_b16 a[114:115], v2 offset:29696
    ds_read_b64_tr_b16 a[116:117], v3 offset:28672
    ds_read_b64_tr_b16 a[118:119], v3 offset:29696
    ds_read_b64_tr_b16 a[120:121], v2 offset:30720
    ds_read_b64_tr_b16 a[122:123], v2 offset:31744
    ds_read_b64_tr_b16 a[124:125], v3 offset:30720
    ds_read_b64_tr_b16 a[126:127], v3 offset:31744
    s_waitcnt lgkmcnt(0)
    s_waitcnt vmcnt(28)
    ds_read_b64_tr_b16 a[128:129], v2 offset:32768
    ds_read_b64_tr_b16 a[130:131], v2 offset:33792
    ds_read_b64_tr_b16 a[132:133], v3 offset:32768
    ds_read_b64_tr_b16 a[134:135], v3 offset:33792
    ds_read_b64_tr_b16 a[136:137], v2 offset:34816
    ds_read_b64_tr_b16 a[138:139], v2 offset:35840
    ds_read_b64_tr_b16 a[140:141], v3 offset:34816
    ds_read_b64_tr_b16 a[142:143], v3 offset:35840
    s_waitcnt lgkmcnt(0)
    s_waitcnt vmcnt(24)
    ds_read_b64_tr_b16 a[144:145], v2 offset:0
    ds_read_b64_tr_b16 a[146:147], v2 offset:1024
    ds_read_b64_tr_b16 a[148:149], v3 offset:0
    ds_read_b64_tr_b16 a[150:151], v3 offset:1024
    ds_read_b64_tr_b16 a[152:153], v2 offset:2048
    ds_read_b64_tr_b16 a[154:155], v2 offset:3072
    ds_read_b64_tr_b16 a[156:157], v3 offset:2048
    ds_read_b64_tr_b16 a[158:159], v3 offset:3072
    s_waitcnt lgkmcnt(0)
    s_waitcnt vmcnt(20)
    ds_read_b64_tr_b16 a[160:161], v2 offset:4096
    ds_read_b64_tr_b16 a[162:163], v2 offset:5120
    ds_read_b64_tr_b16 a[164:165], v3 offset:4096
    ds_read_b64_tr_b16 a[166:167], v3 offset:5120
    ds_read_b64_tr_b16 a[168:169], v2 offset:6144
    ds_read_b64_tr_b16 a[170:171], v2 offset:7168
    ds_read_b64_tr_b16 a[172:173], v3 offset:6144
    ds_read_b64_tr_b16 a[174:175], v3 offset:7168
    s_waitcnt lgkmcnt(0)
    s_waitcnt vmcnt(16)
    ds_read_b64_tr_b16 a[176:177], v2 offset:8192
    ds_read_b64_tr_b16 a[178:179], v2 offset:9216
    ds_read_b64_tr_b16 a[180:181], v3 offset:8192
    ds_read_b64_tr_b16 a[182:183], v3 offset:9216
    ds_read_b64_tr_b16 a[184:185], v2 offset:10240
    ds_read_b64_tr_b16 a[186:187], v2 offset:11264
    ds_read_b64_tr_b16 a[188:189], v3 offset:10240
    ds_read_b64_tr_b16 a[190:191], v3 offset:11264
    s_waitcnt lgkmcnt(0)
    s_waitcnt vmcnt(12)
    ds_read_b64_tr_b16 a[192:193], v2 offset:12288
    ds_read_b64_tr_b16 a[194:195], v2 offset:13312
    ds_read_b64_tr_b16 a[196:197], v3 offset:12288
    ds_read_b64_tr_b16 a[198:199], v3 offset:13312
    ds_read_b64_tr_b16 a[200:201], v2 offset:14336
    ds_read_b64_tr_b16 a[202:203], v2 offset:15360
    ds_read_b64_tr_b16 a[204:205], v3 offset:14336
    ds_read_b64_tr_b16 a[206:207], v3 offset:15360
    s_waitcnt lgkmcnt(0)
    s_waitcnt vmcnt(8)
    ds_read_b64_tr_b16 a[208:209], v2 offset:16384
    ds_read_b64_tr_b16 a[210:211], v2 offset:17408
    ds_read_b64_tr_b16 a[212:213], v3 offset:16384
    ds_read_b64_tr_b16 a[214:215], v3 offset:17408
    ds_read_b64_tr_b16 a[216:217], v2 offset:18432
    ds_read_b64_tr_b16 a[218:219], v2 offset:19456
    ds_read_b64_tr_b16 a[220:221], v3 offset:18432
    ds_read_b64_tr_b16 a[222:223], v3 offset:19456
    s_waitcnt lgkmcnt(0)
    s_waitcnt vmcnt(4)
    ds_read_b64_tr_b16 a[224:225], v2 offset:20480
    ds_read_b64_tr_b16 a[226:227], v2 offset:21504
    ds_read_b64_tr_b16 a[228:229], v3 offset:20480
    ds_read_b64_tr_b16 a[230:231], v3 offset:21504
    ds_read_b64_tr_b16 a[232:233], v2 offset:22528
    ds_read_b64_tr_b16 a[234:235], v2 offset:23552
    ds_read_b64_tr_b16 a[236:237], v3 offset:22528
    ds_read_b64_tr_b16 a[238:239], v3 offset:23552
    s_waitcnt lgkmcnt(0)
    s_waitcnt vmcnt(0)
    ds_read_b64_tr_b16 a[240:241], v2 offset:24576
    ds_read_b64_tr_b16 a[242:243], v2 offset:25600
    ds_read_b64_tr_b16 a[244:245], v3 offset:24576
    ds_read_b64_tr_b16 a[246:247], v3 offset:25600
    ds_read_b64_tr_b16 a[248:249], v2 offset:26624
    ds_read_b64_tr_b16 a[250:251], v2 offset:27648
    ds_read_b64_tr_b16 a[252:253], v3 offset:26624
    ds_read_b64_tr_b16 a[254:255], v3 offset:27648
    s_waitcnt lgkmcnt(0)
    s_barrier
    s_mov_b32 s29, 0
    v_lshlrev_b32 v1, 4, v0
    v_mov_b32 v8, 0
    s_mov_b32 s64, 0x298000
OUS_163:
    buffer_load_dword v7, v8, s[4:7], s64 offen sc1
    s_add_u32 s29, s29, 1
    s_waitcnt vmcnt(0)
    v_cmp_gt_u32 vcc, 1, v7
    s_cbranch_vccz OUSD_164
    s_cmp_gt_u32 s29, 262144
    s_cbranch_scc1 OUSD_164
    s_sleep 8
    s_branch OUS_163
OUSD_164:
    v_lshlrev_b32 v6, 2, v0
    s_mov_b32 s64, 0x5400000
    buffer_load_dword v7, v6, s[4:7], s64 offen sc1
    s_waitcnt vmcnt(0)
    v_readlane_b32 s72, v7, 0
    v_readlane_b32 s73, v7, 1
    v_readlane_b32 s74, v7, 2
    v_readlane_b32 s75, v7, 3
    v_readlane_b32 s76, v7, 4
    v_readlane_b32 s77, v7, 5
    v_readlane_b32 s78, v7, 6
    v_readlane_b32 s79, v7, 7
    s_and_b32 s64, s14, 1
    s_lshl_b32 s64, s64, 4
    v_and_b32 v6, 15, v0
    v_add_u32 v6, s64, v6
    v_mov_b32 v9, v6
    v_mul_u32_u24 v5, 1280, v6
    v_lshrrev_b32 v6, 4, v0
    v_lshl_add_u32 v5, v6, 3, v5
    s_lshr_b32 s64, s14, 1
    s_lshl_b32 s64, s64, 5
    s_lshl_b32 s65, s13, 6
    s_add_u32 s64, s64, s65
    v_add_u32 v5, s64, v5
    v_lshlrev_b32 v6, 2, v0
    s_mov_b32 s80, 0x49249249
    s_mov_b32 s81, 0x92492492
    s_lshl_b64 s[80:81], s[80:81], s12
    s_bitset0_b64 s[80:81], 63
    s_bitset0_b64 s[80:81], 62
    s_mov_b64 s[82:83], 0
    s_lshr_b32 s64, s72, 5
    s_bitset1_b64 s[82:83], s64
    s_lshr_b32 s64, s73, 5
    s_bitset1_b64 s[82:83], s64
    s_lshr_b32 s64, s74, 5
    s_bitset1_b64 s[82:83], s64
    s_lshr_b32 s64, s75, 5
    s_bitset1_b64 s[82:83], s64
    s_lshr_b32 s64, s76, 5
    s_bitset1_b64 s[82:83], s64
    s_lshr_b32 s64, s77, 5
    s_bitset1_b64 s[82:83], s64
    s_lshr_b32 s64, s78, 5
    s_bitset1_b64 s[82:83], s64
    s_lshr_b32 s64, s79, 5
    s_bitset1_b64 s[82:83], s64
OU_LOOP:
    s_cmp_eq_u64 s[80:81], 0
    s_cbranch_scc1 OU_END
    s_andn2_b64 s[84:85], s[80:81], s[82:83]
    s_cbranch_scc0 OU_WM
    s_ff1_i32_b64 s24, s[84:85]
    s_branch OU_GO
OU_WM:
    v_mov_b32 v8, 0
    s_mov_b32 s64, 0x298100
OUW_165:
    buffer_load_dword v7, v8, s[4:7], s64 offen sc1
    s_add_u32 s29, s29, 1
    s_waitcnt vmcnt(0)
    v_cmp_gt_u32 vcc, 40, v7
    s_cbranch_vccz OUWD_166
    s_cmp_gt_u32 s29, 262144
    s_cbranch_scc1 OUWD_166
    s_sleep 8
    s_branch OUW_165
OUWD_166:
    s_mov_b64 s[82:83], 0
    s_branch OU_LOOP
OU_GO:
    s_bitset0_b64 s[80:81], s24
    s_lshr_b32 s86, s14, 1
    s_mul_i32 s67, s24, 40960
    s_lshl_b32 s64, s24, 7
    s_add_u32 s64, s64, 0x296000
    s_mov_b64 exec, s[36:37]
OU_F_167:
    buffer_load_dword v7, v6, s[4:7], s64 offen sc1
    s_add_u32 s29, s29, 1
    s_waitcnt vmcnt(0)
    v_cmp_eq_u32 vcc, 0, v7
    s_cbranch_vccz OU_FD_168
    s_cmp_gt_u32 s29, 262144
    s_cbranch_scc1 OU_FD_168
    s_sleep 1
    s_branch OU_F_167
OU_FD_168:
    s_mov_b64 exec, -1
    s_lshl_b32 s25, s24, 18
    s_lshl_b32 s64, s14, 15
    s_add_u32 s25, s25, s64
    s_add_u32 s25, s25, 0x4400000
    s_add_u32 s64, s25, 0x0
    buffer_load_dwordx4 v[16:19], v1, s[4:7], s64 offen
    s_add_u32 s64, s25, 0x20000
    buffer_load_dwordx4 v[20:23], v1, s[4:7], s64 offen
    s_add_u32 s64, s25, 0x400
    buffer_load_dwordx4 v[24:27], v1, s[4:7], s64 offen
    s_add_u32 s64, s25, 0x20400
    buffer_load_dwordx4 v[28:31], v1, s[4:7], s64 offen
    s_add_u32 s64, s25, 0x800
    buffer_load_dwordx4 v[32:35], v1, s[4:7], s64 offen
    s_add_u32 s64, s25, 0x20800
    buffer_load_dwordx4 v[36:39], v1, s[4:7], s64 offen
    s_add_u32 s64, s25, 0xc00
    buffer_load_dwordx4 v[40:43], v1, s[4:7], s64 offen
    s_add_u32 s64, s25, 0x20c00
    buffer_load_dwordx4 v[44:47], v1, s[4:7], s64 offen
    s_add_u32 s64, s25, 0x1000
    buffer_load_dwordx4 v[48:51], v1, s[4:7], s64 offen
    s_add_u32 s64, s25, 0x21000
    buffer_load_dwordx4 v[52:55], v1, s[4:7], s64 offen
    s_add_u32 s64, s25, 0x1400
    buffer_load_dwordx4 v[56:59], v1, s[4:7], s64 offen
    s_add_u32 s64, s25, 0x21400
    buffer_load_dwordx4 v[60:63], v1, s[4:7], s64 offen
    s_add_u32 s64, s25, 0x1800
    buffer_load_dwordx4 v[64:67], v1, s[4:7], s64 offen
    s_add_u32 s64, s25, 0x21800
    buffer_load_dwordx4 v[68:71], v1, s[4:7], s64 offen
    s_add_u32 s64, s25, 0x1c00
    buffer_load_dwordx4 v[72:75], v1, s[4:7], s64 offen
    s_add_u32 s64, s25, 0x21c00
    buffer_load_dwordx4 v[76:79], v1, s[4:7], s64 offen
    s_add_u32 s64, s25, 0x2000
    buffer_load_dwordx4 v[80:83], v1, s[4:7], s64 offen
    s_add_u32 s64, s25, 0x22000
    buffer_load_dwordx4 v[84:87], v1, s[4:7], s64 offen
    s_add_u32 s64, s25, 0x2400
    buffer_load_dwordx4 v[88:91], v1, s[4:7], s64 offen
    s_add_u32 s64, s25, 0x22400
    buffer_load_dwordx4 v[92:95], v1, s[4:7], s64 offen
    s_add_u32 s64, s25, 0x2800
    buffer_load_dwordx4 v[96:99], v1, s[4:7], s64 offen
    s_add_u32 s64, s25, 0x22800
    buffer_load_dwordx4 v[100:103], v1, s[4:7], s64 offen
    s_add_u32 s64, s25, 0x2c00
    buffer_load_dwordx4 v[104:107], v1, s[4:7], s64 offen
    s_add_u32 s64, s25, 0x22c00
    buffer_load_dwordx4 v[108:111], v1, s[4:7], s64 offen
    s_add_u32 s64, s25, 0x3000
    buffer_load_dwordx4 v[112:115], v1, s[4:7], s64 offen
    s_add_u32 s64, s25, 0x23000
    buffer_load_dwordx4 v[116:119], v1, s[4:7], s64 offen
    s_add_u32 s64, s25, 0x3400
    buffer_load_dwordx4 v[120:123], v1, s[4:7], s64 offen
    s_add_u32 s64, s25, 0x23400
    buffer_load_dwordx4 v[124:127], v1, s[4:7], s64 offen
    s_add_u32 s64, s25, 0x3800
    buffer_load_dwordx4 v[128:131], v1, s[4:7], s64 offen
    s_add_u32 s64, s25, 0x23800
    buffer_load_dwordx4 v[132:135], v1, s[4:7], s64 offen
    s_add_u32 s64, s25, 0x3c00
    buffer_load_dwordx4 v[136:139], v1, s[4:7], s64 offen
    s_add_u32 s64, s25, 0x23c00
    buffer_load_dwordx4 v[140:143], v1, s[4:7], s64 offen
    s_waitcnt vmcnt(30)
    v_mfma_f32_16x16x32_bf16 v[144:147], a[0:3], v[16:19], 0
    v_mfma_f32_16x16x32_bf16 v[148:151], a[0:3], v[20:23], 0
    v_mfma_f32_16x16x32_bf16 v[152:155], a[4:7], v[16:19], 0
    v_mfma_f32_16x16x32_bf16 v[156:159], a[4:7], v[20:23], 0
    s_add_u32 s64, s25, 0x4000
    buffer_load_dwordx4 v[16:19], v1, s[4:7], s64 offen
    s_add_u32 s64, s25, 0x24000
    buffer_load_dwordx4 v[20:23], v1, s[4:7], s64 offen
    s_waitcnt vmcnt(30)
    v_mfma_f32_16x16x32_bf16 v[144:147], a[8:11], v[24:27], v[144:147]
    v_mfma_f32_16x16x32_bf16 v[148:151], a[8:11], v[28:31], v[148:151]
    v_mfma_f32_16x16x32_bf16 v[152:155], a[12:15], v[24:27], v[152:155]
    v_mfma_f32_16x16x32_bf16 v[156:159], a[12:15], v[28:31], v[156:159]
    s_add_u32 s64, s25, 0x4400
    buffer_load_dwordx4 v[24:27], v1, s[4:7], s64 offen
    s_add_u32 s64, s25, 0x24400
    buffer_load_dwordx4 v[28:31], v1, s[4:7], s64 offen
    s_waitcnt vmcnt(30)
    v_mfma_f32_16x16x32_bf16 v[144:147], a[16:19], v[32:35], v[144:147]
    v_mfma_f32_16x16x32_bf16 v[148:151], a[16:19], v[36:39], v[148:151]
    v_mfma_f32_16x16x32_bf16 v[152:155], a[20:23], v[32:35], v[152:155]
    v_mfma_f32_16x16x32_bf16 v[156:159], a[20:23], v[36:39], v[156:159]
    s_add_u32 s64, s25, 0x4800
    buffer_load_dwordx4 v[32:35], v1, s[4:7], s64 offen
    s_add_u32 s64, s25, 0x24800
    buffer_load_dwordx4 v[36:39], v1, s[4:7], s64 offen
    s_waitcnt vmcnt(30)
    v_mfma_f32_16x16x32_bf16 v[144:147], a[24:27], v[40:43], v[144:147]
    v_mfma_f32_16x16x32_bf16 v[148:151], a[24:27], v[44:47], v[148:151]
    v_mfma_f32_16x16x32_bf16 v[152:155], a[28:31], v[40:43], v[152:155]
    v_mfma_f32_16x16x32_bf16 v[156:159], a[28:31], v[44:47], v[156:159]
    s_add_u32 s64, s25, 0x4c00
    buffer_load_dwordx4 v[40:43], v1, s[4:7], s64 offen
    s_add_u32 s64, s25, 0x24c00
    buffer_load_dwordx4 v[44:47], v1, s[4:7], s64 offen
    s_waitcnt vmcnt(30)
    v_mfma_f32_16x16x32_bf16 v[144:147], a[32:35], v[48:51], v[144:147]
    v_mfma_f32_16x16x32_bf16 v[148:151], a[32:35], v[52:55], v[148:151]
    v_mfma_f32_16x16x32_bf16 v[152:155], a[36:39], v[48:51], v[152:155]
    v_mfma_f32_16x16x32_bf16 v[156:159], a[36:39], v[52:55], v[156:159]
    s_add_u32 s64, s25, 0x5000
    buffer_load_dwordx4 v[48:51], v1, s[4:7], s64 offen
    s_add_u32 s64, s25, 0x25000
    buffer_load_dwordx4 v[52:55], v1, s[4:7], s64 offen
    s_waitcnt vmcnt(30)
    v_mfma_f32_16x16x32_bf16 v[144:147], a[40:43], v[56:59], v[144:147]
    v_mfma_f32_16x16x32_bf16 v[148:151], a[40:43], v[60:63], v[148:151]
    v_mfma_f32_16x16x32_bf16 v[152:155], a[44:47], v[56:59], v[152:155]
    v_mfma_f32_16x16x32_bf16 v[156:159], a[44:47], v[60:63], v[156:159]
    s_add_u32 s64, s25, 0x5400
    buffer_load_dwordx4 v[56:59], v1, s[4:7], s64 offen
    s_add_u32 s64, s25, 0x25400
    buffer_load_dwordx4 v[60:63], v1, s[4:7], s64 offen
    s_waitcnt vmcnt(30)
    v_mfma_f32_16x16x32_bf16 v[144:147], a[48:51], v[64:67], v[144:147]
    v_mfma_f32_16x16x32_bf16 v[148:151], a[48:51], v[68:71], v[148:151]
    v_mfma_f32_16x16x32_bf16 v[152:155], a[52:55], v[64:67], v[152:155]
    v_mfma_f32_16x16x32_bf16 v[156:159], a[52:55], v[68:71], v[156:159]
    s_add_u32 s64, s25, 0x5800
    buffer_load_dwordx4 v[64:67], v1, s[4:7], s64 offen
    s_add_u32 s64, s25, 0x25800
    buffer_load_dwordx4 v[68:71], v1, s[4:7], s64 offen
    s_waitcnt vmcnt(30)
    v_mfma_f32_16x16x32_bf16 v[144:147], a[56:59], v[72:75], v[144:147]
    v_mfma_f32_16x16x32_bf16 v[148:151], a[56:59], v[76:79], v[148:151]
    v_mfma_f32_16x16x32_bf16 v[152:155], a[60:63], v[72:75], v[152:155]
    v_mfma_f32_16x16x32_bf16 v[156:159], a[60:63], v[76:79], v[156:159]
    s_add_u32 s64, s25, 0x5c00
    buffer_load_dwordx4 v[72:75], v1, s[4:7], s64 offen
    s_add_u32 s64, s25, 0x25c00
    buffer_load_dwordx4 v[76:79], v1, s[4:7], s64 offen
    s_waitcnt vmcnt(30)
    v_mfma_f32_16x16x32_bf16 v[144:147], a[64:67], v[80:83], v[144:147]
    v_mfma_f32_16x16x32_bf16 v[148:151], a[64:67], v[84:87], v[148:151]
    v_mfma_f32_16x16x32_bf16 v[152:155], a[68:71], v[80:83], v[152:155]
    v_mfma_f32_16x16x32_bf16 v[156:159], a[68:71], v[84:87], v[156:159]
    s_add_u32 s64, s25, 0x6000
    buffer_load_dwordx4 v[80:83], v1, s[4:7], s64 offen
    s_add_u32 s64, s25, 0x26000
    buffer_load_dwordx4 v[84:87], v1, s[4:7], s64 offen
    buffer_load_dwordx2 v[160:161], v5, s[48:51], s67 offen
    s_add_u32 s65, s67, 0x0
    buffer_load_dwordx2 v[162:163], v5, s[4:7], s65 offen
    s_mov_b32 s65, 0x298100
    buffer_load_dword v12, off, s[4:7], s65 sc1
    s_waitcnt vmcnt(33)
    v_mfma_f32_16x16x32_bf16 v[144:147], a[72:75], v[88:91], v[144:147]
    v_mfma_f32_16x16x32_bf16 v[148:151], a[72:75], v[92:95], v[148:151]
    v_mfma_f32_16x16x32_bf16 v[152:155], a[76:79], v[88:91], v[152:155]
    v_mfma_f32_16x16x32_bf16 v[156:159], a[76:79], v[92:95], v[156:159]
    s_add_u32 s64, s25, 0x6400
    buffer_load_dwordx4 v[88:91], v1, s[4:7], s64 offen
    s_add_u32 s64, s25, 0x26400
    buffer_load_dwordx4 v[92:95], v1, s[4:7], s64 offen
    s_waitcnt vmcnt(33)
    v_mfma_f32_16x16x32_bf16 v[144:147], a[80:83], v[96:99], v[144:147]
    v_mfma_f32_16x16x32_bf16 v[148:151], a[80:83], v[100:103], v[148:151]
    v_mfma_f32_16x16x32_bf16 v[152:155], a[84:87], v[96:99], v[152:155]
    v_mfma_f32_16x16x32_bf16 v[156:159], a[84:87], v[100:103], v[156:159]
    s_add_u32 s64, s25, 0x6800
    buffer_load_dwordx4 v[96:99], v1, s[4:7], s64 offen
    s_add_u32 s64, s25, 0x26800
    buffer_load_dwordx4 v[100:103], v1, s[4:7], s64 offen
    s_waitcnt vmcnt(33)
    v_mfma_f32_16x16x32_bf16 v[144:147], a[88:91], v[104:107], v[144:147]
    v_mfma_f32_16x16x32_bf16 v[148:151], a[88:91], v[108:111], v[148:151]
    v_mfma_f32_16x16x32_bf16 v[152:155], a[92:95], v[104:107], v[152:155]
    v_mfma_f32_16x16x32_bf16 v[156:159], a[92:95], v[108:111], v[156:159]
    s_add_u32 s64, s25, 0x6c00
    buffer_load_dwordx4 v[104:107], v1, s[4:7], s64 offen
    s_add_u32 s64, s25, 0x26c00
    buffer_load_dwordx4 v[108:111], v1, s[4:7], s64 offen
    s_waitcnt vmcnt(33)
    v_mfma_f32_16x16x32_bf16 v[144:147], a[96:99], v[112:115], v[144:147]
    v_mfma_f32_16x16x32_bf16 v[148:151], a[96:99], v[116:119], v[148:151]
    v_mfma_f32_16x16x32_bf16 v[152:155], a[100:103], v[112:115], v[152:155]
    v_mfma_f32_16x16x32_bf16 v[156:159], a[100:103], v[116:119], v[156:159]
    s_add_u32 s64, s25, 0x7000
    buffer_load_dwordx4 v[112:115], v1, s[4:7], s64 offen
    s_add_u32 s64, s25, 0x27000
    buffer_load_dwordx4 v[116:119], v1, s[4:7], s64 offen
    s_waitcnt vmcnt(33)
    v_mfma_f32_16x16x32_bf16 v[144:147], a[104:107], v[120:123], v[144:147]
    v_mfma_f32_16x16x32_bf16 v[148:151], a[104:107], v[124:127], v[148:151]
    v_mfma_f32_16x16x32_bf16 v[152:155], a[108:111], v[120:123], v[152:155]
    v_mfma_f32_16x16x32_bf16 v[156:159], a[108:111], v[124:127], v[156:159]
    s_add_u32 s64, s25, 0x7400
    buffer_load_dwordx4 v[120:123], v1, s[4:7], s64 offen
    s_add_u32 s64, s25, 0x27400
    buffer_load_dwordx4 v[124:127], v1, s[4:7], s64 offen
    s_waitcnt vmcnt(33)
    v_mfma_f32_16x16x32_bf16 v[144:147], a[112:115], v[128:131], v[144:147]
    v_mfma_f32_16x16x32_bf16 v[148:151], a[112:115], v[132:135], v[148:151]
    v_mfma_f32_16x16x32_bf16 v[152:155], a[116:119], v[128:131], v[152:155]
    v_mfma_f32_16x16x32_bf16 v[156:159], a[116:119], v[132:135], v[156:159]
    s_add_u32 s64, s25, 0x7800
    buffer_load_dwordx4 v[128:131], v1, s[4:7], s64 offen
    s_add_u32 s64, s25, 0x27800
    buffer_load_dwordx4 v[132:135], v1, s[4:7], s64 offen
    s_waitcnt vmcnt(33)
    v_mfma_f32_16x16x32_bf16 v[144:147], a[120:123], v[136:139], v[144:147]
    v_mfma_f32_16x16x32_bf16 v[148:151], a[120:123], v[140:143], v[148:151]
    v_mfma_f32_16x16x32_bf16 v[152:155], a[124:127], v[136:139], v[152:155]
    v_mfma_f32_16x16x32_bf16 v[156:159], a[124:127], v[140:143], v[156:159]
    s_add_u32 s64, s25, 0x7c00
    buffer_load_dwordx4 v[136:139], v1, s[4:7], s64 offen
    s_add_u32 s64, s25, 0x27c00
    buffer_load_dwordx4 v[140:143], v1, s[4:7], s64 offen
    s_waitcnt vmcnt(33)
    v_mfma_f32_16x16x32_bf16 v[144:147], a[128:131], v[16:19], v[144:147]
    v_mfma_f32_16x16x32_bf16 v[148:151], a[128:131], v[20:23], v[148:151]
    v_mfma_f32_16x16x32_bf16 v[152:155], a[132:135], v[16:19], v[152:155]
    v_mfma_f32_16x16x32_bf16 v[156:159], a[132:135], v[20:23], v[156:159]
    s_waitcnt vmcnt(31)
    v_mfma_f32_16x16x32_bf16 v[144:147], a[136:139], v[24:27], v[144:147]
    v_mfma_f32_16x16x32_bf16 v[148:151], a[136:139], v[28:31], v[148:151]
    v_mfma_f32_16x16x32_bf16 v[152:155], a[140:143], v[24:27], v[152:155]
    v_mfma_f32_16x16x32_bf16 v[156:159], a[140:143], v[28:31], v[156:159]
    s_waitcnt vmcnt(29)
    v_mfma_f32_16x16x32_bf16 v[144:147], a[144:147], v[32:35], v[144:147]
    v_mfma_f32_16x16x32_bf16 v[148:151], a[144:147], v[36:39], v[148:151]
    v_mfma_f32_16x16x32_bf16 v[152:155], a[148:151], v[32:35], v[152:155]
    v_mfma_f32_16x16x32_bf16 v[156:159], a[148:151], v[36:39], v[156:159]
    s_waitcnt vmcnt(27)
    v_mfma_f32_16x16x32_bf16 v[144:147], a[152:155], v[40:43], v[144:147]
    v_mfma_f32_16x16x32_bf16 v[148:151], a[152:155], v[44:47], v[148:151]
    v_mfma_f32_16x16x32_bf16 v[152:155], a[156:159], v[40:43], v[152:155]
    v_mfma_f32_16x16x32_bf16 v[156:159], a[156:159], v[44:47], v[156:159]
    s_waitcnt vmcnt(25)
    v_mfma_f32_16x16x32_bf16 v[144:147], a[160:163], v[48:51], v[144:147]
    v_mfma_f32_16x16x32_bf16 v[148:151], a[160:163], v[52:55], v[148:151]
    v_mfma_f32_16x16x32_bf16 v[152:155], a[164:167], v[48:51], v[152:155]
    v_mfma_f32_16x16x32_bf16 v[156:159], a[164:167], v[52:55], v[156:159]
    s_waitcnt vmcnt(23)
    v_mfma_f32_16x16x32_bf16 v[144:147], a[168:171], v[56:59], v[144:147]
    v_mfma_f32_16x16x32_bf16 v[148:151], a[168:171], v[60:63], v[148:151]
    v_mfma_f32_16x16x32_bf16 v[152:155], a[172:175], v[56:59], v[152:155]
    v_mfma_f32_16x16x32_bf16 v[156:159], a[172:175], v[60:63], v[156:159]
    s_waitcnt vmcnt(21)
    v_mfma_f32_16x16x32_bf16 v[144:147], a[176:179], v[64:67], v[144:147]
    v_mfma_f32_16x16x32_bf16 v[148:151], a[176:179], v[68:71], v[148:151]
    v_mfma_f32_16x16x32_bf16 v[152:155], a[180:183], v[64:67], v[152:155]
    v_mfma_f32_16x16x32_bf16 v[156:159], a[180:183], v[68:71], v[156:159]
    s_waitcnt vmcnt(19)
    v_mfma_f32_16x16x32_bf16 v[144:147], a[184:187], v[72:75], v[144:147]
    v_mfma_f32_16x16x32_bf16 v[148:151], a[184:187], v[76:79], v[148:151]
    v_mfma_f32_16x16x32_bf16 v[152:155], a[188:191], v[72:75], v[152:155]
    v_mfma_f32_16x16x32_bf16 v[156:159], a[188:191], v[76:79], v[156:159]
    s_waitcnt vmcnt(17)
    v_mfma_f32_16x16x32_bf16 v[144:147], a[192:195], v[80:83], v[144:147]
    v_mfma_f32_16x16x32_bf16 v[148:151], a[192:195], v[84:87], v[148:151]
    v_mfma_f32_16x16x32_bf16 v[152:155], a[196:199], v[80:83], v[152:155]
    v_mfma_f32_16x16x32_bf16 v[156:159], a[196:199], v[84:87], v[156:159]
    s_waitcnt vmcnt(12)
    v_mfma_f32_16x16x32_bf16 v[144:147], a[200:203], v[88:91], v[144:147]
    v_mfma_f32_16x16x32_bf16 v[148:151], a[200:203], v[92:95], v[148:151]
    v_mfma_f32_16x16x32_bf16 v[152:155], a[204:207], v[88:91], v[152:155]
    v_mfma_f32_16x16x32_bf16 v[156:159], a[204:207], v[92:95], v[156:159]
    s_waitcnt vmcnt(10)
    v_mfma_f32_16x16x32_bf16 v[144:147], a[208:211], v[96:99], v[144:147]
    v_mfma_f32_16x16x32_bf16 v[148:151], a[208:211], v[100:103], v[148:151]
    v_mfma_f32_16x16x32_bf16 v[152:155], a[212:215], v[96:99], v[152:155]
    v_mfma_f32_16x16x32_bf16 v[156:159], a[212:215], v[100:103], v[156:159]
    s_waitcnt vmcnt(8)
    v_mfma_f32_16x16x32_bf16 v[144:147], a[216:219], v[104:107], v[144:147]
    v_mfma_f32_16x16x32_bf16 v[148:151], a[216:219], v[108:111], v[148:151]
    v_mfma_f32_16x16x32_bf16 v[152:155], a[220:223], v[104:107], v[152:155]
    v_mfma_f32_16x16x32_bf16 v[156:159], a[220:223], v[108:111], v[156:159]
    s_waitcnt vmcnt(6)
    v_mfma_f32_16x16x32_bf16 v[144:147], a[224:227], v[112:115], v[144:147]
    v_mfma_f32_16x16x32_bf16 v[148:151], a[224:227], v[116:119], v[148:151]
    v_mfma_f32_16x16x32_bf16 v[152:155], a[228:231], v[112:115], v[152:155]
    v_mfma_f32_16x16x32_bf16 v[156:159], a[228:231], v[116:119], v[156:159]
    s_waitcnt vmcnt(4)
    v_mfma_f32_16x16x32_bf16 v[144:147], a[232:235], v[120:123], v[144:147]
    v_mfma_f32_16x16x32_bf16 v[148:151], a[232:235], v[124:127], v[148:151]
    v_mfma_f32_16x16x32_bf16 v[152:155], a[236:239], v[120:123], v[152:155]
    v_mfma_f32_16x16x32_bf16 v[156:159], a[236:239], v[124:127], v[156:159]
    s_waitcnt vmcnt(2)
    v_mfma_f32_16x16x32_bf16 v[144:147], a[240:243], v[128:131], v[144:147]
    v_mfma_f32_16x16x32_bf16 v[148:151], a[240:243], v[132:135], v[148:151]
    v_mfma_f32_16x16x32_bf16 v[152:155], a[244:247], v[128:131], v[152:155]
    v_mfma_f32_16x16x32_bf16 v[156:159], a[244:247], v[132:135], v[156:159]
    s_waitcnt vmcnt(0)
    v_mfma_f32_16x16x32_bf16 v[144:147], a[248:251], v[136:139], v[144:147]
    v_mfma_f32_16x16x32_bf16 v[148:151], a[248:251], v[140:143], v[148:151]
    v_mfma_f32_16x16x32_bf16 v[152:155], a[252:255], v[136:139], v[152:155]
    v_mfma_f32_16x16x32_bf16 v[156:159], a[252:255], v[140:143], v[156:159]
    s_lshl_b32 s64, s14, 12
    v_add_u32 v7, s64, v1
    s_barrier
    s_nop 3
    ds_write_b128 v7, v[144:147] offset:0
    ds_write_b128 v7, v[148:151] offset:1024
    ds_write_b128 v7, v[152:155] offset:2048
    ds_write_b128 v7, v[156:159] offset:3072
    v_mov_b32 v13, 16384
    s_cmp_lg_u32 s14, 0
    s_cbranch_scc1 OW0_169
    ds_write_b32 v13, v12
OW0_169:
    s_waitcnt lgkmcnt(0)
    s_barrier
    ds_read_b32 v12, v13
    s_waitcnt lgkmcnt(0)
    v_readfirstlane_b32 s64, v12
    s_cmp_lt_u32 s64, 40
    s_cselect_b64 s[82:83], s[82:83], 0
    s_lshl_b32 s64, s14, 10
    v_add_u32 v7, s64, v1
    ds_read_b128 v[16:19], v7 offset:0
    ds_read_b128 v[20:23], v7 offset:4096
    ds_read_b128 v[24:27], v7 offset:8192
    ds_read_b128 v[28:31], v7 offset:12288
    s_waitcnt lgkmcnt(0)
    v_add_f32 v16, v16, v20
    v_add_f32 v24, v24, v28
    v_add_f32 v16, v16, v24
    v_add_f32 v17, v17, v21
    v_add_f32 v25, v25, v29
    v_add_f32 v17, v17, v25
    v_add_f32 v18, v18, v22
    v_add_f32 v26, v26, v30
    v_add_f32 v18, v18, v26
    v_add_f32 v19, v19, v23
    v_add_f32 v27, v27, v31
    v_add_f32 v19, v19, v27
    v_cvt_pk_bf16_f32 v16, v16, v16
    v_lshlrev_b32 v16, 16, v16
    v_cvt_pk_bf16_f32 v17, v17, v17
    v_lshlrev_b32 v17, 16, v17
    v_cvt_pk_bf16_f32 v18, v18, v18
    v_lshlrev_b32 v18, 16, v18
    v_cvt_pk_bf16_f32 v19, v19, v19
    v_lshlrev_b32 v19, 16, v19
    v_lshlrev_b32 v20, 16, v162
    v_and_b32 v21, 0xffff0000, v162
    v_lshlrev_b32 v24, 16, v160
    v_and_b32 v25, 0xffff0000, v160
    v_lshlrev_b32 v22, 16, v163
    v_and_b32 v23, 0xffff0000, v163
    v_lshlrev_b32 v26, 16, v161
    v_and_b32 v27, 0xffff0000, v161
    s_lshl_b32 s64, s24, 5
    v_add_u32 v8, s64, v9
    v_mov_b32 v10, -1
    v_cmp_eq_u32 vcc, s72, v8
    s_nop 1
    v_cndmask_b32 v10, v10, 0, vcc
    v_cmp_eq_u32 vcc, s73, v8
    s_nop 1
    v_cndmask_b32 v10, v10, 1, vcc
    v_cmp_eq_u32 vcc, s74, v8
    s_nop 1
    v_cndmask_b32 v10, v10, 2, vcc
    v_cmp_eq_u32 vcc, s75, v8
    s_nop 1
    v_cndmask_b32 v10, v10, 3, vcc
    v_cmp_eq_u32 vcc, s76, v8
    s_nop 1
    v_cndmask_b32 v10, v10, 4, vcc
    v_cmp_eq_u32 vcc, s77, v8
    s_nop 1
    v_cndmask_b32 v10, v10, 5, vcc
    v_cmp_eq_u32 vcc, s78, v8
    s_nop 1
    v_cndmask_b32 v10, v10, 6, vcc
    v_cmp_eq_u32 vcc, s79, v8
    s_nop 1
    v_cndmask_b32 v10, v10, 7, vcc
    v_cmp_le_i32 vcc, 0, v10
    s_and_saveexec_b64 s[68:69], vcc
    s_cbranch_execz NOUPD_171
    v_mul_u32_u24 v10, 2560, v10
    v_lshrrev_b32 v11, 4, v0
    v_lshl_add_u32 v10, v11, 4, v10
    s_lshl_b32 s64, s86, 6
    s_lshl_b32 s65, s13, 7
    s_add_u32 s64, s64, s65
    s_add_u32 s64, s64, 0x5410000
    buffer_load_dwordx4 v[164:167], v10, s[4:7], s64 offen sc1
    s_waitcnt vmcnt(0)
    v_add_f32 v20, v20, v164
    v_cvt_pk_bf16_f32 v20, v20, v20
    v_lshlrev_b32 v20, 16, v20
    v_add_f32 v21, v21, v165
    v_cvt_pk_bf16_f32 v21, v21, v21
    v_lshlrev_b32 v21, 16, v21
    v_add_f32 v22, v22, v166
    v_cvt_pk_bf16_f32 v22, v22, v22
    v_lshlrev_b32 v22, 16, v22
    v_add_f32 v23, v23, v167
    v_cvt_pk_bf16_f32 v23, v23, v23
    v_lshlrev_b32 v23, 16, v23
NOUPD_171:
    s_mov_b64 exec, -1
    v_mul_f32 v28, 0xbfb8aa3b, v20
    v_exp_f32 v28, v28
    s_nop 0
    v_add_f32 v28, 1.0, v28
    v_rcp_f32 v28, v28
    s_nop 0
    v_mul_f32 v28, v28, v20
    v_cvt_pk_bf16_f32 v28, v28, v28
    v_lshlrev_b32 v28, 16, v28
    v_mul_f32 v28, v28, v16
    v_cvt_pk_bf16_f32 v28, v28, v28
    v_lshlrev_b32 v28, 16, v28
    v_add_f32 v28, v28, v24
    v_mul_f32 v29, 0xbfb8aa3b, v21
    v_exp_f32 v29, v29
    s_nop 0
    v_add_f32 v29, 1.0, v29
    v_rcp_f32 v29, v29
    s_nop 0
    v_mul_f32 v29, v29, v21
    v_cvt_pk_bf16_f32 v29, v29, v29
    v_lshlrev_b32 v29, 16, v29
    v_mul_f32 v29, v29, v17
    v_cvt_pk_bf16_f32 v29, v29, v29
    v_lshlrev_b32 v29, 16, v29
    v_add_f32 v29, v29, v25
    v_mul_f32 v30, 0xbfb8aa3b, v22
    v_exp_f32 v30, v30
    s_nop 0
    v_add_f32 v30, 1.0, v30
    v_rcp_f32 v30, v30
    s_nop 0
    v_mul_f32 v30, v30, v22
    v_cvt_pk_bf16_f32 v30, v30, v30
    v_lshlrev_b32 v30, 16, v30
    v_mul_f32 v30, v30, v18
    v_cvt_pk_bf16_f32 v30, v30, v30
    v_lshlrev_b32 v30, 16, v30
    v_add_f32 v30, v30, v26
    v_mul_f32 v31, 0xbfb8aa3b, v23
    v_exp_f32 v31, v31
    s_nop 0
    v_add_f32 v31, 1.0, v31
    v_rcp_f32 v31, v31
    s_nop 0
    v_mul_f32 v31, v31, v23
    v_cvt_pk_bf16_f32 v31, v31, v31
    v_lshlrev_b32 v31, 16, v31
    v_mul_f32 v31, v31, v19
    v_cvt_pk_bf16_f32 v31, v31, v31
    v_lshlrev_b32 v31, 16, v31
    v_add_f32 v31, v31, v27
    v_cvt_pk_bf16_f32 v164, v28, v29
    v_cvt_pk_bf16_f32 v165, v30, v31
    buffer_store_dwordx2 v[164:165], v5, s[52:55], s67 offen
OTD_170:
    s_branch OU_LOOP
OU_END:
    s_cmp_lg_u32 s12, 2
    s_cbranch_scc1 OU_X
    v_mov_b32 v8, 0
    s_mov_b32 s64, 0x298100
OUW_172:
    buffer_load_dword v7, v8, s[4:7], s64 offen sc1
    s_add_u32 s29, s29, 1
    s_waitcnt vmcnt(0)
    v_cmp_gt_u32 vcc, 40, v7
    s_cbranch_vccz OUWD_173
    s_cmp_gt_u32 s29, 262144
    s_cbranch_scc1 OUWD_173
    s_sleep 8
    s_branch OUW_172
OUWD_173:
    s_mov_b32 s24, 62
    s_mov_b32 s87, 0
    s_and_b32 s86, s14, 1
    s_lshl_b32 s64, s87, 4
    v_and_b32 v6, 15, v0
    v_add_u32 v6, s64, v6
    v_mov_b32 v9, v6
    v_mul_u32_u24 v5, 1280, v6
    v_lshrrev_b32 v6, 4, v0
    v_lshl_add_u32 v5, v6, 3, v5
    s_and_b32 s64, s14, 1
    s_lshl_b32 s64, s64, 5
    s_lshl_b32 s65, s13, 6
    s_add_u32 s64, s64, s65
    v_add_u32 v5, s64, v5
    v_lshlrev_b32 v6, 2, v0
    s_mul_i32 s67, s24, 40960
    s_lshl_b32 s64, s24, 7
    s_add_u32 s64, s64, 0x296000
    s_mov_b64 exec, s[36:37]
OUH_F_174:
    buffer_load_dword v7, v6, s[4:7], s64 offen sc1
    s_add_u32 s29, s29, 1
    s_waitcnt vmcnt(0)
    v_cmp_eq_u32 vcc, 0, v7
    s_cbranch_vccz OUH_FD_175
    s_cmp_gt_u32 s29, 262144
    s_cbranch_scc1 OUH_FD_175
    s_sleep 1
    s_branch OUH_F_174
OUH_FD_175:
    s_mov_b64 exec, -1
    s_lshl_b32 s25, s24, 18
    s_lshl_b32 s64, s14, 15
    s_add_u32 s25, s25, s64
    s_add_u32 s25, s25, 0x4400000
    s_lshl_b32 s64, s87, 17
    s_add_u32 s25, s25, s64
    s_add_u32 s64, s25, 0x0
    buffer_load_dwordx4 v[16:19], v1, s[4:7], s64 offen
    s_add_u32 s64, s25, 0x400
    buffer_load_dwordx4 v[20:23], v1, s[4:7], s64 offen
    s_add_u32 s64, s25, 0x800
    buffer_load_dwordx4 v[24:27], v1, s[4:7], s64 offen
    s_add_u32 s64, s25, 0xc00
    buffer_load_dwordx4 v[28:31], v1, s[4:7], s64 offen
    s_add_u32 s64, s25, 0x1000
    buffer_load_dwordx4 v[32:35], v1, s[4:7], s64 offen
    s_add_u32 s64, s25, 0x1400
    buffer_load_dwordx4 v[36:39], v1, s[4:7], s64 offen
    s_add_u32 s64, s25, 0x1800
    buffer_load_dwordx4 v[40:43], v1, s[4:7], s64 offen
    s_add_u32 s64, s25, 0x1c00
    buffer_load_dwordx4 v[44:47], v1, s[4:7], s64 offen
    s_add_u32 s64, s25, 0x2000
    buffer_load_dwordx4 v[48:51], v1, s[4:7], s64 offen
    s_add_u32 s64, s25, 0x2400
    buffer_load_dwordx4 v[52:55], v1, s[4:7], s64 offen
    s_add_u32 s64, s25, 0x2800
    buffer_load_dwordx4 v[56:59], v1, s[4:7], s64 offen
    s_add_u32 s64, s25, 0x2c00
    buffer_load_dwordx4 v[60:63], v1, s[4:7], s64 offen
    s_add_u32 s64, s25, 0x3000
    buffer_load_dwordx4 v[64:67], v1, s[4:7], s64 offen
    s_add_u32 s64, s25, 0x3400
    buffer_load_dwordx4 v[68:71], v1, s[4:7], s64 offen
    s_add_u32 s64, s25, 0x3800
    buffer_load_dwordx4 v[72:75], v1, s[4:7], s64 offen
    s_add_u32 s64, s25, 0x3c00
    buffer_load_dwordx4 v[76:79], v1, s[4:7], s64 offen
    s_add_u32 s64, s25, 0x4000
    buffer_load_dwordx4 v[80:83], v1, s[4:7], s64 offen
    s_add_u32 s64, s25, 0x4400
    buffer_load_dwordx4 v[84:87], v1, s[4:7], s64 offen
    s_add_u32 s64, s25, 0x4800
    buffer_load_dwordx4 v[88:91], v1, s[4:7], s64 offen
    s_add_u32 s64, s25, 0x4c00
    buffer_load_dwordx4 v[92:95], v1, s[4:7], s64 offen
    s_add_u32 s64, s25, 0x5000
    buffer_load_dwordx4 v[96:99], v1, s[4:7], s64 offen
    s_add_u32 s64, s25, 0x5400
    buffer_load_dwordx4 v[100:103], v1, s[4:7], s64 offen
    s_add_u32 s64, s25, 0x5800
    buffer_load_dwordx4 v[104:107], v1, s[4:7], s64 offen
    s_add_u32 s64, s25, 0x5c00
    buffer_load_dwordx4 v[108:111], v1, s[4:7], s64 offen
    s_add_u32 s64, s25, 0x6000
    buffer_load_dwordx4 v[112:115], v1, s[4:7], s64 offen
    s_add_u32 s64, s25, 0x6400
    buffer_load_dwordx4 v[116:119], v1, s[4:7], s64 offen
    s_add_u32 s64, s25, 0x6800
    buffer_load_dwordx4 v[120:123], v1, s[4:7], s64 offen
    s_add_u32 s64, s25, 0x6c00
    buffer_load_dwordx4 v[124:127], v1, s[4:7], s64 offen
    s_add_u32 s64, s25, 0x7000
    buffer_load_dwordx4 v[128:131], v1, s[4:7], s64 offen
    s_add_u32 s64, s25, 0x7400
    buffer_load_dwordx4 v[132:135], v1, s[4:7], s64 offen
    s_add_u32 s64, s25, 0x7800
    buffer_load_dwordx4 v[136:139], v1, s[4:7], s64 offen
    s_add_u32 s64, s25, 0x7c00
    buffer_load_dwordx4 v[140:143], v1, s[4:7], s64 offen
    s_waitcnt vmcnt(31)
    v_mfma_f32_16x16x32_bf16 v[144:147], a[0:3], v[16:19], 0
    v_mfma_f32_16x16x32_bf16 v[148:151], a[4:7], v[16:19], 0
    s_waitcnt vmcnt(30)
    v_mfma_f32_16x16x32_bf16 v[144:147], a[8:11], v[20:23], v[144:147]
    v_mfma_f32_16x16x32_bf16 v[148:151], a[12:15], v[20:23], v[148:151]
    s_waitcnt vmcnt(29)
    v_mfma_f32_16x16x32_bf16 v[144:147], a[16:19], v[24:27], v[144:147]
    v_mfma_f32_16x16x32_bf16 v[148:151], a[20:23], v[24:27], v[148:151]
    s_waitcnt vmcnt(28)
    v_mfma_f32_16x16x32_bf16 v[144:147], a[24:27], v[28:31], v[144:147]
    v_mfma_f32_16x16x32_bf16 v[148:151], a[28:31], v[28:31], v[148:151]
    s_waitcnt vmcnt(27)
    v_mfma_f32_16x16x32_bf16 v[144:147], a[32:35], v[32:35], v[144:147]
    v_mfma_f32_16x16x32_bf16 v[148:151], a[36:39], v[32:35], v[148:151]
    s_waitcnt vmcnt(26)
    v_mfma_f32_16x16x32_bf16 v[144:147], a[40:43], v[36:39], v[144:147]
    v_mfma_f32_16x16x32_bf16 v[148:151], a[44:47], v[36:39], v[148:151]
    s_waitcnt vmcnt(25)
    v_mfma_f32_16x16x32_bf16 v[144:147], a[48:51], v[40:43], v[144:147]
    v_mfma_f32_16x16x32_bf16 v[148:151], a[52:55], v[40:43], v[148:151]
    s_waitcnt vmcnt(24)
    v_mfma_f32_16x16x32_bf16 v[144:147], a[56:59], v[44:47], v[144:147]
    v_mfma_f32_16x16x32_bf16 v[148:151], a[60:63], v[44:47], v[148:151]
    s_waitcnt vmcnt(23)
    v_mfma_f32_16x16x32_bf16 v[144:147], a[64:67], v[48:51], v[144:147]
    v_mfma_f32_16x16x32_bf16 v[148:151], a[68:71], v[48:51], v[148:151]
    buffer_load_dwordx2 v[160:161], v5, s[48:51], s67 offen
    s_add_u32 s65, s67, 0x0
    buffer_load_dwordx2 v[162:163], v5, s[4:7], s65 offen
    s_waitcnt vmcnt(24)
    v_mfma_f32_16x16x32_bf16 v[144:147], a[72:75], v[52:55], v[144:147]
    v_mfma_f32_16x16x32_bf16 v[148:151], a[76:79], v[52:55], v[148:151]
    s_waitcnt vmcnt(23)
    v_mfma_f32_16x16x32_bf16 v[144:147], a[80:83], v[56:59], v[144:147]
    v_mfma_f32_16x16x32_bf16 v[148:151], a[84:87], v[56:59], v[148:151]
    s_waitcnt vmcnt(22)
    v_mfma_f32_16x16x32_bf16 v[144:147], a[88:91], v[60:63], v[144:147]
    v_mfma_f32_16x16x32_bf16 v[148:151], a[92:95], v[60:63], v[148:151]
    s_waitcnt vmcnt(21)
    v_mfma_f32_16x16x32_bf16 v[144:147], a[96:99], v[64:67], v[144:147]
    v_mfma_f32_16x16x32_bf16 v[148:151], a[100:103], v[64:67], v[148:151]
    s_waitcnt vmcnt(20)
    v_mfma_f32_16x16x32_bf16 v[144:147], a[104:107], v[68:71], v[144:147]
    v_mfma_f32_16x16x32_bf16 v[148:151], a[108:111], v[68:71], v[148:151]
    s_waitcnt vmcnt(19)
    v_mfma_f32_16x16x32_bf16 v[144:147], a[112:115], v[72:75], v[144:147]
    v_mfma_f32_16x16x32_bf16 v[148:151], a[116:119], v[72:75], v[148:151]
    s_waitcnt vmcnt(18)
    v_mfma_f32_16x16x32_bf16 v[144:147], a[120:123], v[76:79], v[144:147]
    v_mfma_f32_16x16x32_bf16 v[148:151], a[124:127], v[76:79], v[148:151]
    s_waitcnt vmcnt(17)
    v_mfma_f32_16x16x32_bf16 v[144:147], a[128:131], v[80:83], v[144:147]
    v_mfma_f32_16x16x32_bf16 v[148:151], a[132:135], v[80:83], v[148:151]
    s_waitcnt vmcnt(16)
    v_mfma_f32_16x16x32_bf16 v[144:147], a[136:139], v[84:87], v[144:147]
    v_mfma_f32_16x16x32_bf16 v[148:151], a[140:143], v[84:87], v[148:151]
    s_waitcnt vmcnt(15)
    v_mfma_f32_16x16x32_bf16 v[144:147], a[144:147], v[88:91], v[144:147]
    v_mfma_f32_16x16x32_bf16 v[148:151], a[148:151], v[88:91], v[148:151]
    s_waitcnt vmcnt(14)
    v_mfma_f32_16x16x32_bf16 v[144:147], a[152:155], v[92:95], v[144:147]
    v_mfma_f32_16x16x32_bf16 v[148:151], a[156:159], v[92:95], v[148:151]
    s_waitcnt vmcnt(13)
    v_mfma_f32_16x16x32_bf16 v[144:147], a[160:163], v[96:99], v[144:147]
    v_mfma_f32_16x16x32_bf16 v[148:151], a[164:167], v[96:99], v[148:151]
    s_waitcnt vmcnt(12)
    v_mfma_f32_16x16x32_bf16 v[144:147], a[168:171], v[100:103], v[144:147]
    v_mfma_f32_16x16x32_bf16 v[148:151], a[172:175], v[100:103], v[148:151]
    s_waitcnt vmcnt(11)
    v_mfma_f32_16x16x32_bf16 v[144:147], a[176:179], v[104:107], v[144:147]
    v_mfma_f32_16x16x32_bf16 v[148:151], a[180:183], v[104:107], v[148:151]
    s_waitcnt vmcnt(10)
    v_mfma_f32_16x16x32_bf16 v[144:147], a[184:187], v[108:111], v[144:147]
    v_mfma_f32_16x16x32_bf16 v[148:151], a[188:191], v[108:111], v[148:151]
    s_waitcnt vmcnt(9)
    v_mfma_f32_16x16x32_bf16 v[144:147], a[192:195], v[112:115], v[144:147]
    v_mfma_f32_16x16x32_bf16 v[148:151], a[196:199], v[112:115], v[148:151]
    s_waitcnt vmcnt(8)
    v_mfma_f32_16x16x32_bf16 v[144:147], a[200:203], v[116:119], v[144:147]
    v_mfma_f32_16x16x32_bf16 v[148:151], a[204:207], v[116:119], v[148:151]
    s_waitcnt vmcnt(7)
    v_mfma_f32_16x16x32_bf16 v[144:147], a[208:211], v[120:123], v[144:147]
    v_mfma_f32_16x16x32_bf16 v[148:151], a[212:215], v[120:123], v[148:151]
    s_waitcnt vmcnt(6)
    v_mfma_f32_16x16x32_bf16 v[144:147], a[216:219], v[124:127], v[144:147]
    v_mfma_f32_16x16x32_bf16 v[148:151], a[220:223], v[124:127], v[148:151]
    s_waitcnt vmcnt(5)
    v_mfma_f32_16x16x32_bf16 v[144:147], a[224:227], v[128:131], v[144:147]
    v_mfma_f32_16x16x32_bf16 v[148:151], a[228:231], v[128:131], v[148:151]
    s_waitcnt vmcnt(4)
    v_mfma_f32_16x16x32_bf16 v[144:147], a[232:235], v[132:135], v[144:147]
    v_mfma_f32_16x16x32_bf16 v[148:151], a[236:239], v[132:135], v[148:151]
    s_waitcnt vmcnt(3)
    v_mfma_f32_16x16x32_bf16 v[144:147], a[240:243], v[136:139], v[144:147]
    v_mfma_f32_16x16x32_bf16 v[148:151], a[244:247], v[136:139], v[148:151]
    s_waitcnt vmcnt(2)
    v_mfma_f32_16x16x32_bf16 v[144:147], a[248:251], v[140:143], v[144:147]
    v_mfma_f32_16x16x32_bf16 v[148:151], a[252:255], v[140:143], v[148:151]
    s_waitcnt vmcnt(0)
    s_lshl_b32 s64, s14, 12
    v_add_u32 v7, s64, v1
    s_barrier
    s_nop 3
    ds_write_b128 v7, v[144:147] offset:0
    ds_write_b128 v7, v[148:151] offset:1024
    s_waitcnt lgkmcnt(0)
    s_barrier
    s_cmp_ge_u32 s14, 2
    s_cbranch_scc1 OTD_176
    s_lshl_b32 s64, s14, 10
    v_add_u32 v7, s64, v1
    ds_read_b128 v[16:19], v7 offset:0
    ds_read_b128 v[20:23], v7 offset:4096
    ds_read_b128 v[24:27], v7 offset:8192
    ds_read_b128 v[28:31], v7 offset:12288
    s_waitcnt lgkmcnt(0)
    v_add_f32 v16, v16, v20
    v_add_f32 v24, v24, v28
    v_add_f32 v16, v16, v24
    v_add_f32 v17, v17, v21
    v_add_f32 v25, v25, v29
    v_add_f32 v17, v17, v25
    v_add_f32 v18, v18, v22
    v_add_f32 v26, v26, v30
    v_add_f32 v18, v18, v26
    v_add_f32 v19, v19, v23
    v_add_f32 v27, v27, v31
    v_add_f32 v19, v19, v27
    v_cvt_pk_bf16_f32 v16, v16, v16
    v_lshlrev_b32 v16, 16, v16
    v_cvt_pk_bf16_f32 v17, v17, v17
    v_lshlrev_b32 v17, 16, v17
    v_cvt_pk_bf16_f32 v18, v18, v18
    v_lshlrev_b32 v18, 16, v18
    v_cvt_pk_bf16_f32 v19, v19, v19
    v_lshlrev_b32 v19, 16, v19
    v_lshlrev_b32 v20, 16, v162
    v_and_b32 v21, 0xffff0000, v162
    v_lshlrev_b32 v24, 16, v160
    v_and_b32 v25, 0xffff0000, v160
    v_lshlrev_b32 v22, 16, v163
    v_and_b32 v23, 0xffff0000, v163
    v_lshlrev_b32 v26, 16, v161
    v_and_b32 v27, 0xffff0000, v161
    s_lshl_b32 s64, s24, 5
    v_add_u32 v8, s64, v9
    v_mov_b32 v10, -1
    v_cmp_eq_u32 vcc, s72, v8
    s_nop 1
    v_cndmask_b32 v10, v10, 0, vcc
    v_cmp_eq_u32 vcc, s73, v8
    s_nop 1
    v_cndmask_b32 v10, v10, 1, vcc
    v_cmp_eq_u32 vcc, s74, v8
    s_nop 1
    v_cndmask_b32 v10, v10, 2, vcc
    v_cmp_eq_u32 vcc, s75, v8
    s_nop 1
    v_cndmask_b32 v10, v10, 3, vcc
    v_cmp_eq_u32 vcc, s76, v8
    s_nop 1
    v_cndmask_b32 v10, v10, 4, vcc
    v_cmp_eq_u32 vcc, s77, v8
    s_nop 1
    v_cndmask_b32 v10, v10, 5, vcc
    v_cmp_eq_u32 vcc, s78, v8
    s_nop 1
    v_cndmask_b32 v10, v10, 6, vcc
    v_cmp_eq_u32 vcc, s79, v8
    s_nop 1
    v_cndmask_b32 v10, v10, 7, vcc
    v_cmp_le_i32 vcc, 0, v10
    s_and_saveexec_b64 s[68:69], vcc
    s_cbranch_execz NOUPD_177
    v_mul_u32_u24 v10, 2560, v10
    v_lshrrev_b32 v11, 4, v0
    v_lshl_add_u32 v10, v11, 4, v10
    s_lshl_b32 s64, s86, 6
    s_lshl_b32 s65, s13, 7
    s_add_u32 s64, s64, s65
    s_add_u32 s64, s64, 0x5410000
    buffer_load_dwordx4 v[164:167], v10, s[4:7], s64 offen sc1
    s_waitcnt vmcnt(0)
    v_add_f32 v20, v20, v164
    v_cvt_pk_bf16_f32 v20, v20, v20
    v_lshlrev_b32 v20, 16, v20
    v_add_f32 v21, v21, v165
    v_cvt_pk_bf16_f32 v21, v21, v21
    v_lshlrev_b32 v21, 16, v21
    v_add_f32 v22, v22, v166
    v_cvt_pk_bf16_f32 v22, v22, v22
    v_lshlrev_b32 v22, 16, v22
    v_add_f32 v23, v23, v167
    v_cvt_pk_bf16_f32 v23, v23, v23
    v_lshlrev_b32 v23, 16, v23
NOUPD_177:
    s_mov_b64 exec, -1
    v_mul_f32 v28, 0xbfb8aa3b, v20
    v_exp_f32 v28, v28
    s_nop 0
    v_add_f32 v28, 1.0, v28
    v_rcp_f32 v28, v28
    s_nop 0
    v_mul_f32 v28, v28, v20
    v_cvt_pk_bf16_f32 v28, v28, v28
    v_lshlrev_b32 v28, 16, v28
    v_mul_f32 v28, v28, v16
    v_cvt_pk_bf16_f32 v28, v28, v28
    v_lshlrev_b32 v28, 16, v28
    v_add_f32 v28, v28, v24
    v_mul_f32 v29, 0xbfb8aa3b, v21
    v_exp_f32 v29, v29
    s_nop 0
    v_add_f32 v29, 1.0, v29
    v_rcp_f32 v29, v29
    s_nop 0
    v_mul_f32 v29, v29, v21
    v_cvt_pk_bf16_f32 v29, v29, v29
    v_lshlrev_b32 v29, 16, v29
    v_mul_f32 v29, v29, v17
    v_cvt_pk_bf16_f32 v29, v29, v29
    v_lshlrev_b32 v29, 16, v29
    v_add_f32 v29, v29, v25
    v_mul_f32 v30, 0xbfb8aa3b, v22
    v_exp_f32 v30, v30
    s_nop 0
    v_add_f32 v30, 1.0, v30
    v_rcp_f32 v30, v30
    s_nop 0
    v_mul_f32 v30, v30, v22
    v_cvt_pk_bf16_f32 v30, v30, v30
    v_lshlrev_b32 v30, 16, v30
    v_mul_f32 v30, v30, v18
    v_cvt_pk_bf16_f32 v30, v30, v30
    v_lshlrev_b32 v30, 16, v30
    v_add_f32 v30, v30, v26
    v_mul_f32 v31, 0xbfb8aa3b, v23
    v_exp_f32 v31, v31
    s_nop 0
    v_add_f32 v31, 1.0, v31
    v_rcp_f32 v31, v31
    s_nop 0
    v_mul_f32 v31, v31, v23
    v_cvt_pk_bf16_f32 v31, v31, v31
    v_lshlrev_b32 v31, 16, v31
    v_mul_f32 v31, v31, v19
    v_cvt_pk_bf16_f32 v31, v31, v31
    v_lshlrev_b32 v31, 16, v31
    v_add_f32 v31, v31, v27
    v_cvt_pk_bf16_f32 v164, v28, v29
    v_cvt_pk_bf16_f32 v165, v30, v31
    buffer_store_dwordx2 v[164:165], v5, s[52:55], s67 offen
OTD_176:
OU_X:
    s_branch M_EXIT
H_EXTRA:
    s_mul_hi_u32 s12, s88, 0xccccccd
    s_mul_i32 s65, s12, 20
    s_sub_u32 s13, s88, s65
    s_add_u32 s12, s12, 3
    s_load_dwordx2 s[48:49], s[0:1], 0
    s_mov_b32 s50, 0x280000
    s_mov_b32 s51, 0x00020000
    s_load_dwordx2 s[52:53], s[0:1], 96
    s_mov_b32 s54, 0x280000
    s_mov_b32 s55, 0x00020000
    s_mov_b32 s36, -1
    s_mov_b32 s37, 0
    s_waitcnt lgkmcnt(0)
    v_mbcnt_lo_u32_b32 v0, -1, 0
    v_mbcnt_hi_u32_b32 v0, -1, v0
    s_mov_b32 s29, 0
    v_lshlrev_b32 v1, 4, v0
    v_lshlrev_b32 v6, 2, v0
    v_mov_b32 v8, 0
    s_mov_b32 s64, 0x298100
OXW_178:
    buffer_load_dword v7, v8, s[4:7], s64 offen sc1
    s_add_u32 s29, s29, 1
    s_waitcnt vmcnt(0)
    v_cmp_gt_u32 vcc, 40, v7
    s_cbranch_vccz OXWD_179
    s_cmp_gt_u32 s29, 262144
    s_cbranch_scc1 OXWD_179
    s_sleep 8
    s_branch OXW_178
OXWD_179:
    v_lshlrev_b32 v6, 2, v0
    s_mov_b32 s64, 0x5400000
    buffer_load_dword v7, v6, s[4:7], s64 offen sc1
    s_waitcnt vmcnt(0)
    v_readlane_b32 s72, v7, 0
    v_readlane_b32 s73, v7, 1
    v_readlane_b32 s74, v7, 2
    v_readlane_b32 s75, v7, 3
    v_readlane_b32 s76, v7, 4
    v_readlane_b32 s77, v7, 5
    v_readlane_b32 s78, v7, 6
    v_readlane_b32 s79, v7, 7
    s_cmp_eq_u32 s12, 3
    s_cselect_b32 s24, 62, 63
    s_cmp_eq_u32 s12, 4
    s_cselect_b32 s87, 0, 1
    s_and_b32 s86, s14, 1
    s_lshl_b32 s64, s87, 4
    v_and_b32 v6, 15, v0
    v_add_u32 v6, s64, v6
    v_mov_b32 v9, v6
    v_mul_u32_u24 v5, 1280, v6
    v_lshrrev_b32 v6, 4, v0
    v_lshl_add_u32 v5, v6, 3, v5
    s_and_b32 s64, s14, 1
    s_lshl_b32 s64, s64, 5
    s_lshl_b32 s65, s13, 6
    s_add_u32 s64, s64, s65
    v_add_u32 v5, s64, v5
    v_lshlrev_b32 v6, 2, v0
    s_mul_i32 s67, s24, 40960
    s_lshl_b32 s64, s24, 7
    s_add_u32 s64, s64, 0x296000
    s_mov_b64 exec, s[36:37]
OX_F_180:
    buffer_load_dword v7, v6, s[4:7], s64 offen sc1
    s_add_u32 s29, s29, 1
    s_waitcnt vmcnt(0)
    v_cmp_eq_u32 vcc, 0, v7
    s_cbranch_vccz OX_FD_181
    s_cmp_gt_u32 s29, 262144
    s_cbranch_scc1 OX_FD_181
    s_sleep 1
    s_branch OX_F_180
OX_FD_181:
    s_mov_b64 exec, -1
    s_lshl_b32 s25, s24, 18
    s_lshl_b32 s64, s14, 15
    s_add_u32 s25, s25, s64
    s_add_u32 s25, s25, 0x4400000
    s_lshl_b32 s64, s87, 17
    s_add_u32 s25, s25, s64
    s_add_u32 s64, s25, 0x0
    buffer_load_dwordx4 v[16:19], v1, s[4:7], s64 offen
    s_add_u32 s64, s25, 0x400
    buffer_load_dwordx4 v[20:23], v1, s[4:7], s64 offen
    s_add_u32 s64, s25, 0x800
    buffer_load_dwordx4 v[24:27], v1, s[4:7], s64 offen
    s_add_u32 s64, s25, 0xc00
    buffer_load_dwordx4 v[28:31], v1, s[4:7], s64 offen
    s_add_u32 s64, s25, 0x1000
    buffer_load_dwordx4 v[32:35], v1, s[4:7], s64 offen
    s_add_u32 s64, s25, 0x1400
    buffer_load_dwordx4 v[36:39], v1, s[4:7], s64 offen
    s_add_u32 s64, s25, 0x1800
    buffer_load_dwordx4 v[40:43], v1, s[4:7], s64 offen
    s_add_u32 s64, s25, 0x1c00
    buffer_load_dwordx4 v[44:47], v1, s[4:7], s64 offen
    s_add_u32 s64, s25, 0x2000
    buffer_load_dwordx4 v[48:51], v1, s[4:7], s64 offen
    s_add_u32 s64, s25, 0x2400
    buffer_load_dwordx4 v[52:55], v1, s[4:7], s64 offen
    s_add_u32 s64, s25, 0x2800
    buffer_load_dwordx4 v[56:59], v1, s[4:7], s64 offen
    s_add_u32 s64, s25, 0x2c00
    buffer_load_dwordx4 v[60:63], v1, s[4:7], s64 offen
    s_add_u32 s64, s25, 0x3000
    buffer_load_dwordx4 v[64:67], v1, s[4:7], s64 offen
    s_add_u32 s64, s25, 0x3400
    buffer_load_dwordx4 v[68:71], v1, s[4:7], s64 offen
    s_add_u32 s64, s25, 0x3800
    buffer_load_dwordx4 v[72:75], v1, s[4:7], s64 offen
    s_add_u32 s64, s25, 0x3c00
    buffer_load_dwordx4 v[76:79], v1, s[4:7], s64 offen
    s_add_u32 s64, s25, 0x4000
    buffer_load_dwordx4 v[80:83], v1, s[4:7], s64 offen
    s_add_u32 s64, s25, 0x4400
    buffer_load_dwordx4 v[84:87], v1, s[4:7], s64 offen
    s_add_u32 s64, s25, 0x4800
    buffer_load_dwordx4 v[88:91], v1, s[4:7], s64 offen
    s_add_u32 s64, s25, 0x4c00
    buffer_load_dwordx4 v[92:95], v1, s[4:7], s64 offen
    s_add_u32 s64, s25, 0x5000
    buffer_load_dwordx4 v[96:99], v1, s[4:7], s64 offen
    s_add_u32 s64, s25, 0x5400
    buffer_load_dwordx4 v[100:103], v1, s[4:7], s64 offen
    s_add_u32 s64, s25, 0x5800
    buffer_load_dwordx4 v[104:107], v1, s[4:7], s64 offen
    s_add_u32 s64, s25, 0x5c00
    buffer_load_dwordx4 v[108:111], v1, s[4:7], s64 offen
    s_add_u32 s64, s25, 0x6000
    buffer_load_dwordx4 v[112:115], v1, s[4:7], s64 offen
    s_add_u32 s64, s25, 0x6400
    buffer_load_dwordx4 v[116:119], v1, s[4:7], s64 offen
    s_add_u32 s64, s25, 0x6800
    buffer_load_dwordx4 v[120:123], v1, s[4:7], s64 offen
    s_add_u32 s64, s25, 0x6c00
    buffer_load_dwordx4 v[124:127], v1, s[4:7], s64 offen
    s_add_u32 s64, s25, 0x7000
    buffer_load_dwordx4 v[128:131], v1, s[4:7], s64 offen
    s_add_u32 s64, s25, 0x7400
    buffer_load_dwordx4 v[132:135], v1, s[4:7], s64 offen
    s_add_u32 s64, s25, 0x7800
    buffer_load_dwordx4 v[136:139], v1, s[4:7], s64 offen
    s_add_u32 s64, s25, 0x7c00
    buffer_load_dwordx4 v[140:143], v1, s[4:7], s64 offen
    s_waitcnt vmcnt(31)
    v_mfma_f32_16x16x32_bf16 v[144:147], a[0:3], v[16:19], 0
    v_mfma_f32_16x16x32_bf16 v[148:151], a[4:7], v[16:19], 0
    s_waitcnt vmcnt(30)
    v_mfma_f32_16x16x32_bf16 v[144:147], a[8:11], v[20:23], v[144:147]
    v_mfma_f32_16x16x32_bf16 v[148:151], a[12:15], v[20:23], v[148:151]
    s_waitcnt vmcnt(29)
    v_mfma_f32_16x16x32_bf16 v[144:147], a[16:19], v[24:27], v[144:147]
    v_mfma_f32_16x16x32_bf16 v[148:151], a[20:23], v[24:27], v[148:151]
    s_waitcnt vmcnt(28)
    v_mfma_f32_16x16x32_bf16 v[144:147], a[24:27], v[28:31], v[144:147]
    v_mfma_f32_16x16x32_bf16 v[148:151], a[28:31], v[28:31], v[148:151]
    s_waitcnt vmcnt(27)
    v_mfma_f32_16x16x32_bf16 v[144:147], a[32:35], v[32:35], v[144:147]
    v_mfma_f32_16x16x32_bf16 v[148:151], a[36:39], v[32:35], v[148:151]
    s_waitcnt vmcnt(26)
    v_mfma_f32_16x16x32_bf16 v[144:147], a[40:43], v[36:39], v[144:147]
    v_mfma_f32_16x16x32_bf16 v[148:151], a[44:47], v[36:39], v[148:151]
    s_waitcnt vmcnt(25)
    v_mfma_f32_16x16x32_bf16 v[144:147], a[48:51], v[40:43], v[144:147]
    v_mfma_f32_16x16x32_bf16 v[148:151], a[52:55], v[40:43], v[148:151]
    s_waitcnt vmcnt(24)
    v_mfma_f32_16x16x32_bf16 v[144:147], a[56:59], v[44:47], v[144:147]
    v_mfma_f32_16x16x32_bf16 v[148:151], a[60:63], v[44:47], v[148:151]
    s_waitcnt vmcnt(23)
    v_mfma_f32_16x16x32_bf16 v[144:147], a[64:67], v[48:51], v[144:147]
    v_mfma_f32_16x16x32_bf16 v[148:151], a[68:71], v[48:51], v[148:151]
    buffer_load_dwordx2 v[160:161], v5, s[48:51], s67 offen
    s_add_u32 s65, s67, 0x0
    buffer_load_dwordx2 v[162:163], v5, s[4:7], s65 offen
    s_waitcnt vmcnt(24)
    v_mfma_f32_16x16x32_bf16 v[144:147], a[72:75], v[52:55], v[144:147]
    v_mfma_f32_16x16x32_bf16 v[148:151], a[76:79], v[52:55], v[148:151]
    s_waitcnt vmcnt(23)
    v_mfma_f32_16x16x32_bf16 v[144:147], a[80:83], v[56:59], v[144:147]
    v_mfma_f32_16x16x32_bf16 v[148:151], a[84:87], v[56:59], v[148:151]
    s_waitcnt vmcnt(22)
    v_mfma_f32_16x16x32_bf16 v[144:147], a[88:91], v[60:63], v[144:147]
    v_mfma_f32_16x16x32_bf16 v[148:151], a[92:95], v[60:63], v[148:151]
    s_waitcnt vmcnt(21)
    v_mfma_f32_16x16x32_bf16 v[144:147], a[96:99], v[64:67], v[144:147]
    v_mfma_f32_16x16x32_bf16 v[148:151], a[100:103], v[64:67], v[148:151]
    s_waitcnt vmcnt(20)
    v_mfma_f32_16x16x32_bf16 v[144:147], a[104:107], v[68:71], v[144:147]
    v_mfma_f32_16x16x32_bf16 v[148:151], a[108:111], v[68:71], v[148:151]
    s_waitcnt vmcnt(19)
    v_mfma_f32_16x16x32_bf16 v[144:147], a[112:115], v[72:75], v[144:147]
    v_mfma_f32_16x16x32_bf16 v[148:151], a[116:119], v[72:75], v[148:151]
    s_waitcnt vmcnt(18)
    v_mfma_f32_16x16x32_bf16 v[144:147], a[120:123], v[76:79], v[144:147]
    v_mfma_f32_16x16x32_bf16 v[148:151], a[124:127], v[76:79], v[148:151]
    s_waitcnt vmcnt(17)
    v_mfma_f32_16x16x32_bf16 v[144:147], a[128:131], v[80:83], v[144:147]
    v_mfma_f32_16x16x32_bf16 v[148:151], a[132:135], v[80:83], v[148:151]
    s_waitcnt vmcnt(16)
    v_mfma_f32_16x16x32_bf16 v[144:147], a[136:139], v[84:87], v[144:147]
    v_mfma_f32_16x16x32_bf16 v[148:151], a[140:143], v[84:87], v[148:151]
    s_waitcnt vmcnt(15)
    v_mfma_f32_16x16x32_bf16 v[144:147], a[144:147], v[88:91], v[144:147]
    v_mfma_f32_16x16x32_bf16 v[148:151], a[148:151], v[88:91], v[148:151]
    s_waitcnt vmcnt(14)
    v_mfma_f32_16x16x32_bf16 v[144:147], a[152:155], v[92:95], v[144:147]
    v_mfma_f32_16x16x32_bf16 v[148:151], a[156:159], v[92:95], v[148:151]
    s_waitcnt vmcnt(13)
    v_mfma_f32_16x16x32_bf16 v[144:147], a[160:163], v[96:99], v[144:147]
    v_mfma_f32_16x16x32_bf16 v[148:151], a[164:167], v[96:99], v[148:151]
    s_waitcnt vmcnt(12)
    v_mfma_f32_16x16x32_bf16 v[144:147], a[168:171], v[100:103], v[144:147]
    v_mfma_f32_16x16x32_bf16 v[148:151], a[172:175], v[100:103], v[148:151]
    s_waitcnt vmcnt(11)
    v_mfma_f32_16x16x32_bf16 v[144:147], a[176:179], v[104:107], v[144:147]
    v_mfma_f32_16x16x32_bf16 v[148:151], a[180:183], v[104:107], v[148:151]
    s_waitcnt vmcnt(10)
    v_mfma_f32_16x16x32_bf16 v[144:147], a[184:187], v[108:111], v[144:147]
    v_mfma_f32_16x16x32_bf16 v[148:151], a[188:191], v[108:111], v[148:151]
    s_waitcnt vmcnt(9)
    v_mfma_f32_16x16x32_bf16 v[144:147], a[192:195], v[112:115], v[144:147]
    v_mfma_f32_16x16x32_bf16 v[148:151], a[196:199], v[112:115], v[148:151]
    s_waitcnt vmcnt(8)
    v_mfma_f32_16x16x32_bf16 v[144:147], a[200:203], v[116:119], v[144:147]
    v_mfma_f32_16x16x32_bf16 v[148:151], a[204:207], v[116:119], v[148:151]
    s_waitcnt vmcnt(7)
    v_mfma_f32_16x16x32_bf16 v[144:147], a[208:211], v[120:123], v[144:147]
    v_mfma_f32_16x16x32_bf16 v[148:151], a[212:215], v[120:123], v[148:151]
    s_waitcnt vmcnt(6)
    v_mfma_f32_16x16x32_bf16 v[144:147], a[216:219], v[124:127], v[144:147]
    v_mfma_f32_16x16x32_bf16 v[148:151], a[220:223], v[124:127], v[148:151]
    s_waitcnt vmcnt(5)
    v_mfma_f32_16x16x32_bf16 v[144:147], a[224:227], v[128:131], v[144:147]
    v_mfma_f32_16x16x32_bf16 v[148:151], a[228:231], v[128:131], v[148:151]
    s_waitcnt vmcnt(4)
    v_mfma_f32_16x16x32_bf16 v[144:147], a[232:235], v[132:135], v[144:147]
    v_mfma_f32_16x16x32_bf16 v[148:151], a[236:239], v[132:135], v[148:151]
    s_waitcnt vmcnt(3)
    v_mfma_f32_16x16x32_bf16 v[144:147], a[240:243], v[136:139], v[144:147]
    v_mfma_f32_16x16x32_bf16 v[148:151], a[244:247], v[136:139], v[148:151]
    s_waitcnt vmcnt(2)
    v_mfma_f32_16x16x32_bf16 v[144:147], a[248:251], v[140:143], v[144:147]
    v_mfma_f32_16x16x32_bf16 v[148:151], a[252:255], v[140:143], v[148:151]
    s_waitcnt vmcnt(0)
    s_lshl_b32 s64, s14, 12
    v_add_u32 v7, s64, v1
    s_barrier
    s_nop 3
    ds_write_b128 v7, v[144:147] offset:0
    ds_write_b128 v7, v[148:151] offset:1024
    s_waitcnt lgkmcnt(0)
    s_barrier
    s_cmp_ge_u32 s14, 2
    s_cbranch_scc1 OTD_182
    s_lshl_b32 s64, s14, 10
    v_add_u32 v7, s64, v1
    ds_read_b128 v[16:19], v7 offset:0
    ds_read_b128 v[20:23], v7 offset:4096
    ds_read_b128 v[24:27], v7 offset:8192
    ds_read_b128 v[28:31], v7 offset:12288
    s_waitcnt lgkmcnt(0)
    v_add_f32 v16, v16, v20
    v_add_f32 v24, v24, v28
    v_add_f32 v16, v16, v24
    v_add_f32 v17, v17, v21
    v_add_f32 v25, v25, v29
    v_add_f32 v17, v17, v25
    v_add_f32 v18, v18, v22
    v_add_f32 v26, v26, v30
    v_add_f32 v18, v18, v26
    v_add_f32 v19, v19, v23
    v_add_f32 v27, v27, v31
    v_add_f32 v19, v19, v27
    v_cvt_pk_bf16_f32 v16, v16, v16
    v_lshlrev_b32 v16, 16, v16
    v_cvt_pk_bf16_f32 v17, v17, v17
    v_lshlrev_b32 v17, 16, v17
    v_cvt_pk_bf16_f32 v18, v18, v18
    v_lshlrev_b32 v18, 16, v18
    v_cvt_pk_bf16_f32 v19, v19, v19
    v_lshlrev_b32 v19, 16, v19
    v_lshlrev_b32 v20, 16, v162
    v_and_b32 v21, 0xffff0000, v162
    v_lshlrev_b32 v24, 16, v160
    v_and_b32 v25, 0xffff0000, v160
    v_lshlrev_b32 v22, 16, v163
    v_and_b32 v23, 0xffff0000, v163
    v_lshlrev_b32 v26, 16, v161
    v_and_b32 v27, 0xffff0000, v161
    s_lshl_b32 s64, s24, 5
    v_add_u32 v8, s64, v9
    v_mov_b32 v10, -1
    v_cmp_eq_u32 vcc, s72, v8
    s_nop 1
    v_cndmask_b32 v10, v10, 0, vcc
    v_cmp_eq_u32 vcc, s73, v8
    s_nop 1
    v_cndmask_b32 v10, v10, 1, vcc
    v_cmp_eq_u32 vcc, s74, v8
    s_nop 1
    v_cndmask_b32 v10, v10, 2, vcc
    v_cmp_eq_u32 vcc, s75, v8
    s_nop 1
    v_cndmask_b32 v10, v10, 3, vcc
    v_cmp_eq_u32 vcc, s76, v8
    s_nop 1
    v_cndmask_b32 v10, v10, 4, vcc
    v_cmp_eq_u32 vcc, s77, v8
    s_nop 1
    v_cndmask_b32 v10, v10, 5, vcc
    v_cmp_eq_u32 vcc, s78, v8
    s_nop 1
    v_cndmask_b32 v10, v10, 6, vcc
    v_cmp_eq_u32 vcc, s79, v8
    s_nop 1
    v_cndmask_b32 v10, v10, 7, vcc
    v_cmp_le_i32 vcc, 0, v10
    s_and_saveexec_b64 s[68:69], vcc
    s_cbranch_execz NOUPD_183
    v_mul_u32_u24 v10, 2560, v10
    v_lshrrev_b32 v11, 4, v0
    v_lshl_add_u32 v10, v11, 4, v10
    s_lshl_b32 s64, s86, 6
    s_lshl_b32 s65, s13, 7
    s_add_u32 s64, s64, s65
    s_add_u32 s64, s64, 0x5410000
    buffer_load_dwordx4 v[164:167], v10, s[4:7], s64 offen sc1
    s_waitcnt vmcnt(0)
    v_add_f32 v20, v20, v164
    v_cvt_pk_bf16_f32 v20, v20, v20
    v_lshlrev_b32 v20, 16, v20
    v_add_f32 v21, v21, v165
    v_cvt_pk_bf16_f32 v21, v21, v21
    v_lshlrev_b32 v21, 16, v21
    v_add_f32 v22, v22, v166
    v_cvt_pk_bf16_f32 v22, v22, v22
    v_lshlrev_b32 v22, 16, v22
    v_add_f32 v23, v23, v167
    v_cvt_pk_bf16_f32 v23, v23, v23
    v_lshlrev_b32 v23, 16, v23
NOUPD_183:
    s_mov_b64 exec, -1
    v_mul_f32 v28, 0xbfb8aa3b, v20
    v_exp_f32 v28, v28
    s_nop 0
    v_add_f32 v28, 1.0, v28
    v_rcp_f32 v28, v28
    s_nop 0
    v_mul_f32 v28, v28, v20
    v_cvt_pk_bf16_f32 v28, v28, v28
    v_lshlrev_b32 v28, 16, v28
    v_mul_f32 v28, v28, v16
    v_cvt_pk_bf16_f32 v28, v28, v28
    v_lshlrev_b32 v28, 16, v28
    v_add_f32 v28, v28, v24
    v_mul_f32 v29, 0xbfb8aa3b, v21
    v_exp_f32 v29, v29
    s_nop 0
    v_add_f32 v29, 1.0, v29
    v_rcp_f32 v29, v29
    s_nop 0
    v_mul_f32 v29, v29, v21
    v_cvt_pk_bf16_f32 v29, v29, v29
    v_lshlrev_b32 v29, 16, v29
    v_mul_f32 v29, v29, v17
    v_cvt_pk_bf16_f32 v29, v29, v29
    v_lshlrev_b32 v29, 16, v29
    v_add_f32 v29, v29, v25
    v_mul_f32 v30, 0xbfb8aa3b, v22
    v_exp_f32 v30, v30
    s_nop 0
    v_add_f32 v30, 1.0, v30
    v_rcp_f32 v30, v30
    s_nop 0
    v_mul_f32 v30, v30, v22
    v_cvt_pk_bf16_f32 v30, v30, v30
    v_lshlrev_b32 v30, 16, v30
    v_mul_f32 v30, v30, v18
    v_cvt_pk_bf16_f32 v30, v30, v30
    v_lshlrev_b32 v30, 16, v30
    v_add_f32 v30, v30, v26
    v_mul_f32 v31, 0xbfb8aa3b, v23
    v_exp_f32 v31, v31
    s_nop 0
    v_add_f32 v31, 1.0, v31
    v_rcp_f32 v31, v31
    s_nop 0
    v_mul_f32 v31, v31, v23
    v_cvt_pk_bf16_f32 v31, v31, v31
    v_lshlrev_b32 v31, 16, v31
    v_mul_f32 v31, v31, v19
    v_cvt_pk_bf16_f32 v31, v31, v31
    v_lshlrev_b32 v31, 16, v31
    v_add_f32 v31, v31, v27
    v_cvt_pk_bf16_f32 v164, v28, v29
    v_cvt_pk_bf16_f32 v165, v30, v31
    buffer_store_dwordx2 v[164:165], v5, s[52:55], s67 offen
OTD_182:
    s_branch M_EXIT
H_Q:
    s_lshl_b32 s70, s13, 1
    s_add_u32 s70, s70, s12
    s_load_dwordx2 s[44:45], s[0:1], 72
    s_mov_b32 s46, 0x21c000
    s_mov_b32 s47, 0x00020000
    s_load_dwordx2 s[48:49], s[0:1], 80
    s_mov_b32 s50, 0x21c000
    s_mov_b32 s51, 0x00020000
    s_load_dwordx2 s[52:53], s[0:1], 88
    s_mov_b32 s54, 0x21c000
    s_mov_b32 s55, 0x00020000
    s_mov_b32 s29, 0
    s_waitcnt lgkmcnt(0)
    v_mbcnt_lo_u32_b32 v0, -1, 0
    v_mbcnt_hi_u32_b32 v0, -1, v0
    s_lshl_b32 s24, s70, 2
    s_add_u32 s24, s24, s14
    s_cmp_ge_u32 s24, 108
    s_cbranch_scc1 H_A0
    v_mov_b32 v8, 0
    s_mov_b32 s64, 0x298000
F1W_184:
    buffer_load_dword v7, v8, s[4:7], s64 offen sc1
    s_add_u32 s29, s29, 1
    s_waitcnt vmcnt(0)
    v_cmp_gt_u32 vcc, 1, v7
    s_cbranch_vccz F1WD_185
    s_cmp_gt_u32 s29, 262144
    s_cbranch_scc1 F1WD_185
    s_sleep 8
    s_branch F1W_184
F1WD_185:
    s_mul_i32 s25, s14, 40960
    v_lshrrev_b32 v7, 1, v0
    v_mul_u32_u24 v2, 3456, v7
    v_and_b32 v7, 1, v0
    v_lshl_add_u32 v2, v7, 4, v2
    v_lshrrev_b32 v7, 4, v0
    v_lshlrev_b32 v3, 8, v7
    v_bfe_u32 v7, v0, 2, 2
    v_lshl_add_u32 v3, v7, 5, v3
    v_and_b32 v7, 3, v0
    v_lshl_add_u32 v3, v7, 3, v3
    v_add_u32 v3, s25, v3
    v_and_b32 v7, 7, v0
    v_lshlrev_b32 v7, 2, v7
    s_mov_b32 s65, 0x5400000
    buffer_load_dword v4, v7, s[4:7], s65 offen sc1
    s_lshl_b32 s26, s24, 5
    s_add_u32 m0, s25, 0
    s_add_u32 s64, s26, 0x0
    buffer_load_dwordx4 v2, s[44:47], s64 offen lds
    s_add_u32 m0, s25, 1024
    s_add_u32 s64, s26, 0x1b000
    buffer_load_dwordx4 v2, s[44:47], s64 offen lds
    s_add_u32 m0, s25, 2048
    s_add_u32 s64, s26, 0x36000
    buffer_load_dwordx4 v2, s[44:47], s64 offen lds
    s_add_u32 m0, s25, 3072
    s_add_u32 s64, s26, 0x51000
    buffer_load_dwordx4 v2, s[44:47], s64 offen lds
    s_add_u32 m0, s25, 4096
    s_add_u32 s64, s26, 0x6c000
    buffer_load_dwordx4 v2, s[44:47], s64 offen lds
    s_add_u32 m0, s25, 5120
    s_add_u32 s64, s26, 0x87000
    buffer_load_dwordx4 v2, s[44:47], s64 offen lds
    s_add_u32 m0, s25, 6144
    s_add_u32 s64, s26, 0xa2000
    buffer_load_dwordx4 v2, s[44:47], s64 offen lds
    s_add_u32 m0, s25, 7168
    s_add_u32 s64, s26, 0xbd000
    buffer_load_dwordx4 v2, s[44:47], s64 offen lds
    s_add_u32 m0, s25, 8192
    s_add_u32 s64, s26, 0xd8000
    buffer_load_dwordx4 v2, s[44:47], s64 offen lds
    s_add_u32 m0, s25, 9216
    s_add_u32 s64, s26, 0xf3000
    buffer_load_dwordx4 v2, s[44:47], s64 offen lds
    s_add_u32 m0, s25, 10240
    s_add_u32 s64, s26, 0x10e000
    buffer_load_dwordx4 v2, s[44:47], s64 offen lds
    s_add_u32 m0, s25, 11264
    s_add_u32 s64, s26, 0x129000
    buffer_load_dwordx4 v2, s[44:47], s64 offen lds
    s_add_u32 m0, s25, 12288
    s_add_u32 s64, s26, 0x144000
    buffer_load_dwordx4 v2, s[44:47], s64 offen lds
    s_add_u32 m0, s25, 13312
    s_add_u32 s64, s26, 0x15f000
    buffer_load_dwordx4 v2, s[44:47], s64 offen lds
    s_add_u32 m0, s25, 14336
    s_add_u32 s64, s26, 0x17a000
    buffer_load_dwordx4 v2, s[44:47], s64 offen lds
    s_add_u32 m0, s25, 15360
    s_add_u32 s64, s26, 0x195000
    buffer_load_dwordx4 v2, s[44:47], s64 offen lds
    s_add_u32 m0, s25, 16384
    s_add_u32 s64, s26, 0x1b0000
    buffer_load_dwordx4 v2, s[44:47], s64 offen lds
    s_add_u32 m0, s25, 17408
    s_add_u32 s64, s26, 0x1cb000
    buffer_load_dwordx4 v2, s[44:47], s64 offen lds
    s_add_u32 m0, s25, 18432
    s_add_u32 s64, s26, 0x1e6000
    buffer_load_dwordx4 v2, s[44:47], s64 offen lds
    s_add_u32 m0, s25, 19456
    s_add_u32 s64, s26, 0x201000
    buffer_load_dwordx4 v2, s[44:47], s64 offen lds
    s_add_u32 m0, s25, 20480
    s_add_u32 s64, s26, 0x0
    buffer_load_dwordx4 v2, s[48:51], s64 offen lds
    s_add_u32 m0, s25, 21504
    s_add_u32 s64, s26, 0x1b000
    buffer_load_dwordx4 v2, s[48:51], s64 offen lds
    s_add_u32 m0, s25, 22528
    s_add_u32 s64, s26, 0x36000
    buffer_load_dwordx4 v2, s[48:51], s64 offen lds
    s_add_u32 m0, s25, 23552
    s_add_u32 s64, s26, 0x51000
    buffer_load_dwordx4 v2, s[48:51], s64 offen lds
    s_add_u32 m0, s25, 24576
    s_add_u32 s64, s26, 0x6c000
    buffer_load_dwordx4 v2, s[48:51], s64 offen lds
    s_add_u32 m0, s25, 25600
    s_add_u32 s64, s26, 0x87000
    buffer_load_dwordx4 v2, s[48:51], s64 offen lds
    s_add_u32 m0, s25, 26624
    s_add_u32 s64, s26, 0xa2000
    buffer_load_dwordx4 v2, s[48:51], s64 offen lds
    s_add_u32 m0, s25, 27648
    s_add_u32 s64, s26, 0xbd000
    buffer_load_dwordx4 v2, s[48:51], s64 offen lds
    s_add_u32 m0, s25, 28672
    s_add_u32 s64, s26, 0xd8000
    buffer_load_dwordx4 v2, s[48:51], s64 offen lds
    s_add_u32 m0, s25, 29696
    s_add_u32 s64, s26, 0xf3000
    buffer_load_dwordx4 v2, s[48:51], s64 offen lds
    s_add_u32 m0, s25, 30720
    s_add_u32 s64, s26, 0x10e000
    buffer_load_dwordx4 v2, s[48:51], s64 offen lds
    s_add_u32 m0, s25, 31744
    s_add_u32 s64, s26, 0x129000
    buffer_load_dwordx4 v2, s[48:51], s64 offen lds
    s_add_u32 m0, s25, 32768
    s_add_u32 s64, s26, 0x144000
    buffer_load_dwordx4 v2, s[48:51], s64 offen lds
    s_add_u32 m0, s25, 33792
    s_add_u32 s64, s26, 0x15f000
    buffer_load_dwordx4 v2, s[48:51], s64 offen lds
    s_add_u32 m0, s25, 34816
    s_add_u32 s64, s26, 0x17a000
    buffer_load_dwordx4 v2, s[48:51], s64 offen lds
    s_add_u32 m0, s25, 35840
    s_add_u32 s64, s26, 0x195000
    buffer_load_dwordx4 v2, s[48:51], s64 offen lds
    s_add_u32 m0, s25, 36864
    s_add_u32 s64, s26, 0x1b0000
    buffer_load_dwordx4 v2, s[48:51], s64 offen lds
    s_add_u32 m0, s25, 37888
    s_add_u32 s64, s26, 0x1cb000
    buffer_load_dwordx4 v2, s[48:51], s64 offen lds
    s_add_u32 m0, s25, 38912
    s_add_u32 s64, s26, 0x1e6000
    buffer_load_dwordx4 v2, s[48:51], s64 offen lds
    s_add_u32 m0, s25, 39936
    s_add_u32 s64, s26, 0x201000
    buffer_load_dwordx4 v2, s[48:51], s64 offen lds
    s_waitcnt vmcnt(40)
    v_mul_u32_u24 v4, 1280, v4
    v_lshrrev_b32 v7, 4, v0
    v_lshl_add_u32 v4, v7, 4, v4
    s_mov_b32 s65, 0x0
    buffer_load_dwordx4 v[16:19], v4, s[4:7], s65 offen offset:0 sc1
    buffer_load_dwordx4 v[20:23], v4, s[4:7], s65 offen offset:64 sc1
    buffer_load_dwordx4 v[24:27], v4, s[4:7], s65 offen offset:128 sc1
    buffer_load_dwordx4 v[28:31], v4, s[4:7], s65 offen offset:192 sc1
    buffer_load_dwordx4 v[32:35], v4, s[4:7], s65 offen offset:256 sc1
    buffer_load_dwordx4 v[36:39], v4, s[4:7], s65 offen offset:320 sc1
    buffer_load_dwordx4 v[40:43], v4, s[4:7], s65 offen offset:384 sc1
    buffer_load_dwordx4 v[44:47], v4, s[4:7], s65 offen offset:448 sc1
    buffer_load_dwordx4 v[48:51], v4, s[4:7], s65 offen offset:512 sc1
    buffer_load_dwordx4 v[52:55], v4, s[4:7], s65 offen offset:576 sc1
    buffer_load_dwordx4 v[56:59], v4, s[4:7], s65 offen offset:640 sc1
    buffer_load_dwordx4 v[60:63], v4, s[4:7], s65 offen offset:704 sc1
    buffer_load_dwordx4 v[64:67], v4, s[4:7], s65 offen offset:768 sc1
    buffer_load_dwordx4 v[68:71], v4, s[4:7], s65 offen offset:832 sc1
    buffer_load_dwordx4 v[72:75], v4, s[4:7], s65 offen offset:896 sc1
    buffer_load_dwordx4 v[76:79], v4, s[4:7], s65 offen offset:960 sc1
    buffer_load_dwordx4 v[80:83], v4, s[4:7], s65 offen offset:1024 sc1
    buffer_load_dwordx4 v[84:87], v4, s[4:7], s65 offen offset:1088 sc1
    buffer_load_dwordx4 v[88:91], v4, s[4:7], s65 offen offset:1152 sc1
    buffer_load_dwordx4 v[92:95], v4, s[4:7], s65 offen offset:1216 sc1
    s_waitcnt vmcnt(0)
    ds_read_b64_tr_b16 v[96:97], v3 offset:0
    ds_read_b64_tr_b16 v[98:99], v3 offset:128
    ds_read_b64_tr_b16 v[100:101], v3 offset:1024
    ds_read_b64_tr_b16 v[102:103], v3 offset:1152
    ds_read_b64_tr_b16 v[104:105], v3 offset:2048
    ds_read_b64_tr_b16 v[106:107], v3 offset:2176
    ds_read_b64_tr_b16 v[108:109], v3 offset:3072
    ds_read_b64_tr_b16 v[110:111], v3 offset:3200
    ds_read_b64_tr_b16 v[112:113], v3 offset:4096
    ds_read_b64_tr_b16 v[114:115], v3 offset:4224
    ds_read_b64_tr_b16 v[116:117], v3 offset:5120
    ds_read_b64_tr_b16 v[118:119], v3 offset:5248
    s_waitcnt lgkmcnt(4)
    ds_read_b64_tr_b16 v[120:121], v3 offset:6144
    ds_read_b64_tr_b16 v[122:123], v3 offset:6272
    ds_read_b64_tr_b16 v[124:125], v3 offset:7168
    ds_read_b64_tr_b16 v[126:127], v3 offset:7296
    ds_read_b64_tr_b16 v[128:129], v3 offset:8192
    ds_read_b64_tr_b16 v[130:131], v3 offset:8320
    ds_read_b64_tr_b16 v[132:133], v3 offset:9216
    ds_read_b64_tr_b16 v[134:135], v3 offset:9344
    ds_read_b64_tr_b16 v[136:137], v3 offset:10240
    ds_read_b64_tr_b16 v[138:139], v3 offset:10368
    ds_read_b64_tr_b16 v[140:141], v3 offset:11264
    ds_read_b64_tr_b16 v[142:143], v3 offset:11392
    s_waitcnt lgkmcnt(4)
    ds_read_b64_tr_b16 v[144:145], v3 offset:12288
    ds_read_b64_tr_b16 v[146:147], v3 offset:12416
    ds_read_b64_tr_b16 v[148:149], v3 offset:13312
    ds_read_b64_tr_b16 v[150:151], v3 offset:13440
    ds_read_b64_tr_b16 v[152:153], v3 offset:14336
    ds_read_b64_tr_b16 v[154:155], v3 offset:14464
    ds_read_b64_tr_b16 v[156:157], v3 offset:15360
    ds_read_b64_tr_b16 v[158:159], v3 offset:15488
    ds_read_b64_tr_b16 v[160:161], v3 offset:16384
    ds_read_b64_tr_b16 v[162:163], v3 offset:16512
    ds_read_b64_tr_b16 v[164:165], v3 offset:17408
    ds_read_b64_tr_b16 v[166:167], v3 offset:17536
    s_waitcnt lgkmcnt(4)
    ds_read_b64_tr_b16 v[168:169], v3 offset:18432
    ds_read_b64_tr_b16 v[170:171], v3 offset:18560
    ds_read_b64_tr_b16 v[172:173], v3 offset:19456
    ds_read_b64_tr_b16 v[174:175], v3 offset:19584
    ds_read_b64_tr_b16 v[176:177], v3 offset:20480
    ds_read_b64_tr_b16 v[178:179], v3 offset:20608
    ds_read_b64_tr_b16 v[180:181], v3 offset:21504
    ds_read_b64_tr_b16 v[182:183], v3 offset:21632
    ds_read_b64_tr_b16 v[184:185], v3 offset:22528
    ds_read_b64_tr_b16 v[186:187], v3 offset:22656
    ds_read_b64_tr_b16 v[188:189], v3 offset:23552
    ds_read_b64_tr_b16 v[190:191], v3 offset:23680
    s_waitcnt lgkmcnt(4)
    ds_read_b64_tr_b16 v[192:193], v3 offset:24576
    ds_read_b64_tr_b16 v[194:195], v3 offset:24704
    ds_read_b64_tr_b16 v[196:197], v3 offset:25600
    ds_read_b64_tr_b16 v[198:199], v3 offset:25728
    ds_read_b64_tr_b16 v[200:201], v3 offset:26624
    ds_read_b64_tr_b16 v[202:203], v3 offset:26752
    ds_read_b64_tr_b16 v[204:205], v3 offset:27648
    ds_read_b64_tr_b16 v[206:207], v3 offset:27776
    ds_read_b64_tr_b16 v[208:209], v3 offset:28672
    ds_read_b64_tr_b16 v[210:211], v3 offset:28800
    ds_read_b64_tr_b16 v[212:213], v3 offset:29696
    ds_read_b64_tr_b16 v[214:215], v3 offset:29824
    s_waitcnt lgkmcnt(4)
    ds_read_b64_tr_b16 v[216:217], v3 offset:30720
    ds_read_b64_tr_b16 v[218:219], v3 offset:30848
    ds_read_b64_tr_b16 v[220:221], v3 offset:31744
    ds_read_b64_tr_b16 v[222:223], v3 offset:31872
    ds_read_b64_tr_b16 v[224:225], v3 offset:32768
    ds_read_b64_tr_b16 v[226:227], v3 offset:32896
    ds_read_b64_tr_b16 v[228:229], v3 offset:33792
    ds_read_b64_tr_b16 v[230:231], v3 offset:33920
    ds_read_b64_tr_b16 v[232:233], v3 offset:34816
    ds_read_b64_tr_b16 v[234:235], v3 offset:34944
    ds_read_b64_tr_b16 v[236:237], v3 offset:35840
    ds_read_b64_tr_b16 v[238:239], v3 offset:35968
    s_waitcnt lgkmcnt(4)
    ds_read_b64_tr_b16 v[240:241], v3 offset:36864
    ds_read_b64_tr_b16 v[242:243], v3 offset:36992
    ds_read_b64_tr_b16 v[244:245], v3 offset:37888
    ds_read_b64_tr_b16 v[246:247], v3 offset:38016
    ds_read_b64_tr_b16 v[248:249], v3 offset:38912
    ds_read_b64_tr_b16 v[250:251], v3 offset:39040
    ds_read_b64_tr_b16 v[252:253], v3 offset:39936
    ds_read_b64_tr_b16 v[254:255], v3 offset:40064
    s_waitcnt lgkmcnt(0)
    v_mfma_f32_16x16x32_bf16 v[8:11], v[96:99], v[16:19], 0
    v_mfma_f32_16x16x32_bf16 v[12:15], v[176:179], v[16:19], 0
    v_mfma_f32_16x16x32_bf16 v[8:11], v[100:103], v[20:23], v[8:11]
    v_mfma_f32_16x16x32_bf16 v[12:15], v[180:183], v[20:23], v[12:15]
    v_mfma_f32_16x16x32_bf16 v[8:11], v[104:107], v[24:27], v[8:11]
    v_mfma_f32_16x16x32_bf16 v[12:15], v[184:187], v[24:27], v[12:15]
    v_mfma_f32_16x16x32_bf16 v[8:11], v[108:111], v[28:31], v[8:11]
    v_mfma_f32_16x16x32_bf16 v[12:15], v[188:191], v[28:31], v[12:15]
    v_mfma_f32_16x16x32_bf16 v[8:11], v[112:115], v[32:35], v[8:11]
    v_mfma_f32_16x16x32_bf16 v[12:15], v[192:195], v[32:35], v[12:15]
    v_mfma_f32_16x16x32_bf16 v[8:11], v[116:119], v[36:39], v[8:11]
    v_mfma_f32_16x16x32_bf16 v[12:15], v[196:199], v[36:39], v[12:15]
    v_mfma_f32_16x16x32_bf16 v[8:11], v[120:123], v[40:43], v[8:11]
    v_mfma_f32_16x16x32_bf16 v[12:15], v[200:203], v[40:43], v[12:15]
    v_mfma_f32_16x16x32_bf16 v[8:11], v[124:127], v[44:47], v[8:11]
    v_mfma_f32_16x16x32_bf16 v[12:15], v[204:207], v[44:47], v[12:15]
    v_mfma_f32_16x16x32_bf16 v[8:11], v[128:131], v[48:51], v[8:11]
    v_mfma_f32_16x16x32_bf16 v[12:15], v[208:211], v[48:51], v[12:15]
    v_mfma_f32_16x16x32_bf16 v[8:11], v[132:135], v[52:55], v[8:11]
    v_mfma_f32_16x16x32_bf16 v[12:15], v[212:215], v[52:55], v[12:15]
    v_mfma_f32_16x16x32_bf16 v[8:11], v[136:139], v[56:59], v[8:11]
    v_mfma_f32_16x16x32_bf16 v[12:15], v[216:219], v[56:59], v[12:15]
    v_mfma_f32_16x16x32_bf16 v[8:11], v[140:143], v[60:63], v[8:11]
    v_mfma_f32_16x16x32_bf16 v[12:15], v[220:223], v[60:63], v[12:15]
    v_mfma_f32_16x16x32_bf16 v[8:11], v[144:147], v[64:67], v[8:11]
    v_mfma_f32_16x16x32_bf16 v[12:15], v[224:227], v[64:67], v[12:15]
    v_mfma_f32_16x16x32_bf16 v[8:11], v[148:151], v[68:71], v[8:11]
    v_mfma_f32_16x16x32_bf16 v[12:15], v[228:231], v[68:71], v[12:15]
    v_mfma_f32_16x16x32_bf16 v[8:11], v[152:155], v[72:75], v[8:11]
    v_mfma_f32_16x16x32_bf16 v[12:15], v[232:235], v[72:75], v[12:15]
    v_mfma_f32_16x16x32_bf16 v[8:11], v[156:159], v[76:79], v[8:11]
    v_mfma_f32_16x16x32_bf16 v[12:15], v[236:239], v[76:79], v[12:15]
    v_mfma_f32_16x16x32_bf16 v[8:11], v[160:163], v[80:83], v[8:11]
    v_mfma_f32_16x16x32_bf16 v[12:15], v[240:243], v[80:83], v[12:15]
    v_mfma_f32_16x16x32_bf16 v[8:11], v[164:167], v[84:87], v[8:11]
    v_mfma_f32_16x16x32_bf16 v[12:15], v[244:247], v[84:87], v[12:15]
    v_mfma_f32_16x16x32_bf16 v[8:11], v[168:171], v[88:91], v[8:11]
    v_mfma_f32_16x16x32_bf16 v[12:15], v[248:251], v[88:91], v[12:15]
    v_mfma_f32_16x16x32_bf16 v[8:11], v[172:175], v[92:95], v[8:11]
    v_mfma_f32_16x16x32_bf16 v[12:15], v[252:255], v[92:95], v[12:15]
    s_nop 7
    v_cvt_pk_bf16_f32 v8, v8, v8
    v_lshlrev_b32 v8, 16, v8
    v_cvt_pk_bf16_f32 v12, v12, v12
    v_lshlrev_b32 v12, 16, v12
    v_mul_f32 v16, 0xbfb8aa3b, v8
    v_exp_f32 v16, v16
    s_nop 0
    v_add_f32 v16, 1.0, v16
    v_rcp_f32 v16, v16
    s_nop 0
    v_mul_f32 v8, v8, v16
    v_cvt_pk_bf16_f32 v8, v8, v8
    v_lshlrev_b32 v8, 16, v8
    v_mul_f32 v8, v8, v12
    v_cvt_pk_bf16_f32 v9, v9, v9
    v_lshlrev_b32 v9, 16, v9
    v_cvt_pk_bf16_f32 v13, v13, v13
    v_lshlrev_b32 v13, 16, v13
    v_mul_f32 v17, 0xbfb8aa3b, v9
    v_exp_f32 v17, v17
    s_nop 0
    v_add_f32 v17, 1.0, v17
    v_rcp_f32 v17, v17
    s_nop 0
    v_mul_f32 v9, v9, v17
    v_cvt_pk_bf16_f32 v9, v9, v9
    v_lshlrev_b32 v9, 16, v9
    v_mul_f32 v9, v9, v13
    v_cvt_pk_bf16_f32 v10, v10, v10
    v_lshlrev_b32 v10, 16, v10
    v_cvt_pk_bf16_f32 v14, v14, v14
    v_lshlrev_b32 v14, 16, v14
    v_mul_f32 v18, 0xbfb8aa3b, v10
    v_exp_f32 v18, v18
    s_nop 0
    v_add_f32 v18, 1.0, v18
    v_rcp_f32 v18, v18
    s_nop 0
    v_mul_f32 v10, v10, v18
    v_cvt_pk_bf16_f32 v10, v10, v10
    v_lshlrev_b32 v10, 16, v10
    v_mul_f32 v10, v10, v14
    v_cvt_pk_bf16_f32 v11, v11, v11
    v_lshlrev_b32 v11, 16, v11
    v_cvt_pk_bf16_f32 v15, v15, v15
    v_lshlrev_b32 v15, 16, v15
    v_mul_f32 v19, 0xbfb8aa3b, v11
    v_exp_f32 v19, v19
    s_nop 0
    v_add_f32 v19, 1.0, v19
    v_rcp_f32 v19, v19
    s_nop 0
    v_mul_f32 v11, v11, v19
    v_cvt_pk_bf16_f32 v11, v11, v11
    v_lshlrev_b32 v11, 16, v11
    v_mul_f32 v11, v11, v15
    v_cvt_pk_bf16_f32 v16, v8, v9
    v_cvt_pk_bf16_f32 v17, v10, v11
    s_lshr_b32 s65, s24, 1
    s_lshl_b32 s65, s65, 10
    s_and_b32 s66, s24, 1
    s_lshl_b32 s66, s66, 3
    s_add_u32 s65, s65, s66
    s_add_u32 s65, s65, 0x5401000
    v_lshlrev_b32 v4, 4, v0
    buffer_store_dwordx2 v[16:17], v4, s[4:7], s65 offen sc1
    s_waitcnt vmcnt(0)
    v_mov_b32 v7, 1
    v_mov_b32 v8, 0
    s_mov_b32 s64, 0x298080
    s_mov_b64 exec, 1
    buffer_atomic_add v7, v8, s[4:7], s64 offen sc1
    s_mov_b64 exec, -1
H_A0:
    v_mbcnt_lo_u32_b32 v0, -1, 0
    v_mbcnt_hi_u32_b32 v0, -1, v0
    s_mov_b32 s29, 0
    v_lshlrev_b32 v1, 4, v0
    v_lshrrev_b32 v5, 4, v0
    v_lshlrev_b32 v2, 7, v5
    v_and_b32 v5, 7, v0
    v_lshl_add_u32 v2, v5, 4, v2
    v_bfe_u32 v5, v0, 4, 1
    v_lshlrev_b32 v3, 7, v5
    v_and_b32 v5, 15, v0
    v_lshl_add_u32 v3, v5, 3, v3
    s_mov_b32 s34, 0x3e0293ee
    s_mov_b32 s35, 0x3e0293ee
    s_mov_b32 s36, -1
    s_mov_b32 s37, 0
    v_lshrrev_b32 v5, 4, v0
    v_lshlrev_b32 v5, 2, v5
    v_and_b32 v6, 15, v0
    v_add_u32 v7, 0, v5
    v_cmp_le_u32 s[38:39], v7, v6
    v_add_u32 v7, 1, v5
    v_cmp_le_u32 s[40:41], v7, v6
    v_add_u32 v7, 2, v5
    v_cmp_le_u32 s[42:43], v7, v6
    v_add_u32 v7, 3, v5
    v_cmp_le_u32 s[44:45], v7, v6
    v_mov_b32 v248, 0x3f803f80
    v_mov_b32 v249, 0x3f803f80
    v_mov_b32 v250, 0x3f803f80
    v_mov_b32 v251, 0x3f803f80
    s_lshl_b32 s24, s12, 2
    s_add_u32 s24, s24, s14
    s_mov_b32 s25, 0
AT0_LOOP:
    s_cmp_eq_u32 s24, 63
    s_cbranch_scc1 AT0_END
    s_lshl_b32 s64, s24, 5
    s_add_u32 s64, s64, s13
    s_lshl_b32 s26, s64, 13
    s_add_u32 s26, s26, 0x3400000
    s_lshl_b32 s27, s64, 14
    s_add_u32 s27, s27, 0x1400000
    s_lshl_b32 s65, s64, 11
    s_add_u32 s30, s65, 0x640000
    s_add_u32 s31, s65, 0xa40000
    s_lshl_b32 s33, s64, 2
    s_add_u32 s33, s33, 0x296000
    s_lshl_b32 s32, s24, 18
    s_lshl_b32 s65, s13, 12
    s_add_u32 s32, s32, s65
    s_add_u32 s32, s32, 0x4400000
    s_lshr_b32 s65, s24, 2
    s_lshl_b32 s65, s65, 9
    s_lshl_b32 s66, s13, 4
    s_add_u32 s65, s65, s66
    s_add_u32 s65, s65, 0x291000
    s_lshr_b32 s66, s24, 1
    s_lshl_b32 s66, s66, 8
    s_lshl_b32 s64, s13, 3
    s_add_u32 s66, s66, s64
    s_add_u32 s66, s66, 0x293ff4
    v_lshlrev_b32 v5, 2, v0
    v_mov_b32 v6, s65
    v_mov_b32 v7, s66
    v_cmp_gt_u32 vcc, 3, v0
    s_nop 1
    v_cndmask_b32 v6, v7, v6, vcc
    v_add_u32 v4, v5, v6
    s_mov_b32 s64, 0
    s_mov_b64 exec, 7
AT0_F_186:
    buffer_load_dword v5, v4, s[4:7], s64 offen sc1
    s_add_u32 s29, s29, 1
    s_waitcnt vmcnt(0)
    v_cmp_eq_u32 vcc, 0, v5
    s_cbranch_vccz AT0_FD_187
    s_cmp_gt_u32 s29, 262144
    s_cbranch_scc1 AT0_FD_187
    s_sleep 1
    s_branch AT0_F_186
AT0_FD_187:
    s_mov_b64 exec, -1
    buffer_load_dwordx4 v[16:19], v1, s[4:7], s26 offen offset:0
    buffer_load_dwordx4 v[20:23], v1, s[4:7], s26 offen offset:1024
    buffer_load_dwordx4 v[24:27], v1, s[4:7], s26 offen offset:2048
    buffer_load_dwordx4 v[28:31], v1, s[4:7], s26 offen offset:3072
    s_add_u32 s26, s26, 4096
    buffer_load_dwordx4 v[32:35], v1, s[4:7], s26 offen offset:0
    buffer_load_dwordx4 v[36:39], v1, s[4:7], s26 offen offset:1024
    buffer_load_dwordx4 v[40:43], v1, s[4:7], s26 offen offset:2048
    buffer_load_dwordx4 v[44:47], v1, s[4:7], s26 offen offset:3072
    buffer_load_dwordx4 v[48:51], v1, s[4:7], s27 offen offset:0
    buffer_load_dwordx4 v[52:55], v1, s[4:7], s27 offen offset:1024
    buffer_load_dwordx4 v[56:59], v1, s[4:7], s27 offen offset:2048
    buffer_load_dwordx4 v[60:63], v1, s[4:7], s27 offen offset:3072
    s_add_u32 s27, s27, 4096
    buffer_load_dwordx4 v[64:67], v1, s[4:7], s27 offen offset:0
    buffer_load_dwordx4 v[68:71], v1, s[4:7], s27 offen offset:1024
    buffer_load_dwordx4 v[72:75], v1, s[4:7], s27 offen offset:2048
    buffer_load_dwordx4 v[76:79], v1, s[4:7], s27 offen offset:3072
    s_add_u32 s27, s27, 4096
    buffer_load_dwordx4 v[80:83], v1, s[4:7], s27 offen offset:0
    buffer_load_dwordx4 v[84:87], v1, s[4:7], s27 offen offset:1024
    buffer_load_dwordx4 v[88:91], v1, s[4:7], s27 offen offset:2048
    buffer_load_dwordx4 v[92:95], v1, s[4:7], s27 offen offset:3072
    s_add_u32 s27, s27, 4096
    buffer_load_dwordx4 v[96:99], v1, s[4:7], s27 offen offset:0
    buffer_load_dwordx4 v[100:103], v1, s[4:7], s27 offen offset:1024
    buffer_load_dwordx4 v[104:107], v1, s[4:7], s27 offen offset:2048
    buffer_load_dwordx4 v[108:111], v1, s[4:7], s27 offen offset:3072
    s_mov_b64 exec, 0x18
AT0_G_188:
    buffer_load_dword v5, v4, s[4:7], s64 offen sc1
    s_add_u32 s29, s29, 1
    s_waitcnt vmcnt(0)
    v_cmp_eq_u32 vcc, 0, v5
    s_cbranch_vccz AT0_GD_189
    s_cmp_gt_u32 s29, 262144
    s_cbranch_scc1 AT0_GD_189
    s_sleep 1
    s_branch AT0_G_188
AT0_GD_189:
    s_mov_b64 exec, -1
    buffer_load_dwordx4 v[112:115], v2, s[4:7], s30 offen offset:0
    buffer_load_dwordx4 v[116:119], v2, s[4:7], s30 offen offset:512
    buffer_load_dwordx4 v[120:123], v2, s[4:7], s30 offen offset:1024
    buffer_load_dwordx4 v[124:127], v2, s[4:7], s30 offen offset:1536
    buffer_load_dwordx2 v[128:129], v3, s[4:7], s31 offen offset:0
    buffer_load_dwordx2 v[130:131], v3, s[4:7], s31 offen offset:256
    buffer_load_dwordx2 v[132:133], v3, s[4:7], s31 offen offset:512
    buffer_load_dwordx2 v[134:135], v3, s[4:7], s31 offen offset:768
    buffer_load_dwordx2 v[136:137], v3, s[4:7], s31 offen offset:1024
    buffer_load_dwordx2 v[138:139], v3, s[4:7], s31 offen offset:1280
    buffer_load_dwordx2 v[140:141], v3, s[4:7], s31 offen offset:1536
    buffer_load_dwordx2 v[142:143], v3, s[4:7], s31 offen offset:1792
    v_mfma_f32_16x16x32_bf16 v[148:151], v[48:51], v[16:19], 0
    v_mfma_f32_16x16x32_bf16 v[156:159], v[48:51], v[32:35], 0
    v_mfma_f32_16x16x32_bf16 v[160:163], v[64:67], v[32:35], 0
    v_mfma_f32_16x16x32_bf16 v[148:151], v[52:55], v[20:23], v[148:151]
    v_mfma_f32_16x16x32_bf16 v[156:159], v[52:55], v[36:39], v[156:159]
    v_mfma_f32_16x16x32_bf16 v[160:163], v[68:71], v[36:39], v[160:163]
    v_mfma_f32_16x16x32_bf16 v[148:151], v[56:59], v[24:27], v[148:151]
    v_mfma_f32_16x16x32_bf16 v[156:159], v[56:59], v[40:43], v[156:159]
    v_mfma_f32_16x16x32_bf16 v[160:163], v[72:75], v[40:43], v[160:163]
    v_mfma_f32_16x16x32_bf16 v[148:151], v[60:63], v[28:31], v[148:151]
    v_mfma_f32_16x16x32_bf16 v[156:159], v[60:63], v[44:47], v[156:159]
    v_mfma_f32_16x16x32_bf16 v[160:163], v[76:79], v[44:47], v[160:163]
    s_waitcnt vmcnt(8)
    v_mfma_f32_16x16x32_bf16 v[144:147], v[112:115], v[16:19], 0
    v_mfma_f32_16x16x32_bf16 v[152:155], v[112:115], v[32:35], 0
    v_mfma_f32_16x16x32_bf16 v[144:147], v[116:119], v[20:23], v[144:147]
    v_mfma_f32_16x16x32_bf16 v[152:155], v[116:119], v[36:39], v[152:155]
    v_mfma_f32_16x16x32_bf16 v[144:147], v[120:123], v[24:27], v[144:147]
    v_mfma_f32_16x16x32_bf16 v[152:155], v[120:123], v[40:43], v[152:155]
    v_mfma_f32_16x16x32_bf16 v[144:147], v[124:127], v[28:31], v[144:147]
    v_mfma_f32_16x16x32_bf16 v[152:155], v[124:127], v[44:47], v[152:155]
    v_mov_b32 v11, 0xff800000
    s_nop 7
    v_cndmask_b32 v148, v11, v148, s[38:39]
    v_cndmask_b32 v160, v11, v160, s[38:39]
    v_cndmask_b32 v144, v11, v144, s[36:37]
    v_cndmask_b32 v152, v11, v152, s[36:37]
    v_cndmask_b32 v149, v11, v149, s[40:41]
    v_cndmask_b32 v161, v11, v161, s[40:41]
    v_cndmask_b32 v145, v11, v145, s[36:37]
    v_cndmask_b32 v153, v11, v153, s[36:37]
    v_cndmask_b32 v150, v11, v150, s[42:43]
    v_cndmask_b32 v162, v11, v162, s[42:43]
    v_cndmask_b32 v146, v11, v146, s[36:37]
    v_cndmask_b32 v154, v11, v154, s[36:37]
    v_cndmask_b32 v151, v11, v151, s[44:45]
    v_cndmask_b32 v163, v11, v163, s[44:45]
    v_cndmask_b32 v147, v11, v147, s[36:37]
    v_cndmask_b32 v155, v11, v155, s[36:37]
    v_max3_f32 v8, v144, v145, v146
    v_max3_f32 v8, v8, v147, v148
    v_max3_f32 v8, v8, v149, v150
    v_max_f32 v8, v8, v151
    v_mov_b32 v9, v8
    s_nop 1
    v_permlane16_swap_b32 v8, v9
    v_max_f32 v8, v8, v9
    v_mov_b32 v9, v8
    s_nop 1
    v_permlane32_swap_b32 v8, v9
    v_max_f32 v8, v8, v9
    v_mul_f32 v8, s34, v8
    v_fma_f32 v144, v144, s34, -v8
    v_fma_f32 v145, v145, s34, -v8
    v_fma_f32 v146, v146, s34, -v8
    v_fma_f32 v147, v147, s34, -v8
    v_fma_f32 v148, v148, s34, -v8
    v_fma_f32 v149, v149, s34, -v8
    v_fma_f32 v150, v150, s34, -v8
    v_fma_f32 v151, v151, s34, -v8
    v_exp_f32 v144, v144
    v_exp_f32 v145, v145
    v_exp_f32 v146, v146
    v_exp_f32 v147, v147
    v_exp_f32 v148, v148
    v_exp_f32 v149, v149
    v_exp_f32 v150, v150
    v_exp_f32 v151, v151
    s_nop 0
    v_cvt_pk_bf16_f32 v164, v148, v149
    v_cvt_pk_bf16_f32 v165, v150, v151
    v_mov_b32 v166, 0
    v_mov_b32 v167, 0
    v_cvt_pk_bf16_f32 v168, v144, v145
    v_cvt_pk_bf16_f32 v169, v146, v147
    v_max3_f32 v8, v152, v153, v154
    v_max3_f32 v8, v8, v155, v156
    v_max3_f32 v8, v8, v157, v158
    v_max3_f32 v8, v8, v159, v160
    v_max3_f32 v8, v8, v161, v162
    v_max_f32 v8, v8, v163
    v_mov_b32 v9, v8
    s_nop 1
    v_permlane16_swap_b32 v8, v9
    v_max_f32 v8, v8, v9
    v_mov_b32 v9, v8
    s_nop 1
    v_permlane32_swap_b32 v8, v9
    v_max_f32 v8, v8, v9
    v_mul_f32 v8, s34, v8
    v_fma_f32 v152, v152, s34, -v8
    v_fma_f32 v153, v153, s34, -v8
    v_fma_f32 v154, v154, s34, -v8
    v_fma_f32 v155, v155, s34, -v8
    v_fma_f32 v156, v156, s34, -v8
    v_fma_f32 v157, v157, s34, -v8
    v_fma_f32 v158, v158, s34, -v8
    v_fma_f32 v159, v159, s34, -v8
    v_fma_f32 v160, v160, s34, -v8
    v_fma_f32 v161, v161, s34, -v8
    v_fma_f32 v162, v162, s34, -v8
    v_fma_f32 v163, v163, s34, -v8
    v_exp_f32 v152, v152
    v_exp_f32 v153, v153
    v_exp_f32 v154, v154
    v_exp_f32 v155, v155
    v_exp_f32 v156, v156
    v_exp_f32 v157, v157
    v_exp_f32 v158, v158
    v_exp_f32 v159, v159
    v_exp_f32 v160, v160
    v_exp_f32 v161, v161
    v_exp_f32 v162, v162
    v_exp_f32 v163, v163
    s_nop 0
    v_cvt_pk_bf16_f32 v170, v156, v157
    v_cvt_pk_bf16_f32 v171, v158, v159
    v_cvt_pk_bf16_f32 v172, v160, v161
    v_cvt_pk_bf16_f32 v173, v162, v163
    v_cvt_pk_bf16_f32 v174, v152, v153
    v_cvt_pk_bf16_f32 v175, v154, v155
    s_waitcnt vmcnt(0)
    v_mfma_f32_16x16x32_bf16 v[240:243], v[248:251], v[164:167], 0
    v_mfma_f32_16x16x32_bf16 v[244:247], v[248:251], v[170:173], 0
    v_mfma_f32_16x16x32_bf16 v[176:179], v[80:83], v[164:167], 0
    v_mfma_f32_16x16x32_bf16 v[180:183], v[80:83], v[170:173], 0
    v_mfma_f32_16x16x32_bf16 v[184:187], v[84:87], v[164:167], 0
    v_mfma_f32_16x16x32_bf16 v[188:191], v[84:87], v[170:173], 0
    v_mfma_f32_16x16x32_bf16 v[192:195], v[88:91], v[164:167], 0
    v_mfma_f32_16x16x32_bf16 v[196:199], v[88:91], v[170:173], 0
    v_mfma_f32_16x16x32_bf16 v[200:203], v[92:95], v[164:167], 0
    v_mfma_f32_16x16x32_bf16 v[204:207], v[92:95], v[170:173], 0
    v_mfma_f32_16x16x32_bf16 v[208:211], v[96:99], v[164:167], 0
    v_mfma_f32_16x16x32_bf16 v[212:215], v[96:99], v[170:173], 0
    v_mfma_f32_16x16x32_bf16 v[216:219], v[100:103], v[164:167], 0
    v_mfma_f32_16x16x32_bf16 v[220:223], v[100:103], v[170:173], 0
    v_mfma_f32_16x16x32_bf16 v[224:227], v[104:107], v[164:167], 0
    v_mfma_f32_16x16x32_bf16 v[228:231], v[104:107], v[170:173], 0
    v_mfma_f32_16x16x32_bf16 v[232:235], v[108:111], v[164:167], 0
    v_mfma_f32_16x16x32_bf16 v[236:239], v[108:111], v[170:173], 0
    v_mfma_f32_16x16x16_bf16 v[240:243], v[248:249], v[168:169], v[240:243]
    v_mfma_f32_16x16x16_bf16 v[244:247], v[248:249], v[174:175], v[244:247]
    v_mfma_f32_16x16x16_bf16 v[176:179], v[128:129], v[168:169], v[176:179]
    v_mfma_f32_16x16x16_bf16 v[180:183], v[128:129], v[174:175], v[180:183]
    v_mfma_f32_16x16x16_bf16 v[184:187], v[130:131], v[168:169], v[184:187]
    v_mfma_f32_16x16x16_bf16 v[188:191], v[130:131], v[174:175], v[188:191]
    v_mfma_f32_16x16x16_bf16 v[192:195], v[132:133], v[168:169], v[192:195]
    v_mfma_f32_16x16x16_bf16 v[196:199], v[132:133], v[174:175], v[196:199]
    v_mfma_f32_16x16x16_bf16 v[200:203], v[134:135], v[168:169], v[200:203]
    v_mfma_f32_16x16x16_bf16 v[204:207], v[134:135], v[174:175], v[204:207]
    v_mfma_f32_16x16x16_bf16 v[208:211], v[136:137], v[168:169], v[208:211]
    v_mfma_f32_16x16x16_bf16 v[212:215], v[136:137], v[174:175], v[212:215]
    v_mfma_f32_16x16x16_bf16 v[216:219], v[138:139], v[168:169], v[216:219]
    v_mfma_f32_16x16x16_bf16 v[220:223], v[138:139], v[174:175], v[220:223]
    v_mfma_f32_16x16x16_bf16 v[224:227], v[140:141], v[168:169], v[224:227]
    v_mfma_f32_16x16x16_bf16 v[228:231], v[140:141], v[174:175], v[228:231]
    v_mfma_f32_16x16x16_bf16 v[232:235], v[142:143], v[168:169], v[232:235]
    v_mfma_f32_16x16x16_bf16 v[236:239], v[142:143], v[174:175], v[236:239]
    v_rcp_f32 v8, v240
    v_rcp_f32 v9, v244
    s_nop 7
    v_mul_f32 v176, v176, v8
    v_mul_f32 v177, v177, v8
    v_mul_f32 v178, v178, v8
    v_mul_f32 v179, v179, v8
    v_cvt_pk_bf16_f32 v16, v176, v177
    v_cvt_pk_bf16_f32 v17, v178, v179
    v_mul_f32 v184, v184, v8
    v_mul_f32 v185, v185, v8
    v_mul_f32 v186, v186, v8
    v_mul_f32 v187, v187, v8
    v_cvt_pk_bf16_f32 v18, v184, v185
    v_cvt_pk_bf16_f32 v19, v186, v187
    s_add_u32 s64, s32, 0x0
    buffer_store_dwordx4 v[16:19], v1, s[4:7], s64 offen offset:0 sc1
    v_mul_f32 v192, v192, v8
    v_mul_f32 v193, v193, v8
    v_mul_f32 v194, v194, v8
    v_mul_f32 v195, v195, v8
    v_cvt_pk_bf16_f32 v20, v192, v193
    v_cvt_pk_bf16_f32 v21, v194, v195
    v_mul_f32 v200, v200, v8
    v_mul_f32 v201, v201, v8
    v_mul_f32 v202, v202, v8
    v_mul_f32 v203, v203, v8
    v_cvt_pk_bf16_f32 v22, v200, v201
    v_cvt_pk_bf16_f32 v23, v202, v203
    s_add_u32 s64, s32, 0x0
    buffer_store_dwordx4 v[20:23], v1, s[4:7], s64 offen offset:1024 sc1
    v_mul_f32 v208, v208, v8
    v_mul_f32 v209, v209, v8
    v_mul_f32 v210, v210, v8
    v_mul_f32 v211, v211, v8
    v_cvt_pk_bf16_f32 v24, v208, v209
    v_cvt_pk_bf16_f32 v25, v210, v211
    v_mul_f32 v216, v216, v8
    v_mul_f32 v217, v217, v8
    v_mul_f32 v218, v218, v8
    v_mul_f32 v219, v219, v8
    v_cvt_pk_bf16_f32 v26, v216, v217
    v_cvt_pk_bf16_f32 v27, v218, v219
    s_add_u32 s64, s32, 0x0
    buffer_store_dwordx4 v[24:27], v1, s[4:7], s64 offen offset:2048 sc1
    v_mul_f32 v224, v224, v8
    v_mul_f32 v225, v225, v8
    v_mul_f32 v226, v226, v8
    v_mul_f32 v227, v227, v8
    v_cvt_pk_bf16_f32 v28, v224, v225
    v_cvt_pk_bf16_f32 v29, v226, v227
    v_mul_f32 v232, v232, v8
    v_mul_f32 v233, v233, v8
    v_mul_f32 v234, v234, v8
    v_mul_f32 v235, v235, v8
    v_cvt_pk_bf16_f32 v30, v232, v233
    v_cvt_pk_bf16_f32 v31, v234, v235
    s_add_u32 s64, s32, 0x0
    buffer_store_dwordx4 v[28:31], v1, s[4:7], s64 offen offset:3072 sc1
    v_mul_f32 v180, v180, v9
    v_mul_f32 v181, v181, v9
    v_mul_f32 v182, v182, v9
    v_mul_f32 v183, v183, v9
    v_cvt_pk_bf16_f32 v32, v180, v181
    v_cvt_pk_bf16_f32 v33, v182, v183
    v_mul_f32 v188, v188, v9
    v_mul_f32 v189, v189, v9
    v_mul_f32 v190, v190, v9
    v_mul_f32 v191, v191, v9
    v_cvt_pk_bf16_f32 v34, v188, v189
    v_cvt_pk_bf16_f32 v35, v190, v191
    s_add_u32 s64, s32, 0x20000
    buffer_store_dwordx4 v[32:35], v1, s[4:7], s64 offen offset:0 sc1
    v_mul_f32 v196, v196, v9
    v_mul_f32 v197, v197, v9
    v_mul_f32 v198, v198, v9
    v_mul_f32 v199, v199, v9
    v_cvt_pk_bf16_f32 v36, v196, v197
    v_cvt_pk_bf16_f32 v37, v198, v199
    v_mul_f32 v204, v204, v9
    v_mul_f32 v205, v205, v9
    v_mul_f32 v206, v206, v9
    v_mul_f32 v207, v207, v9
    v_cvt_pk_bf16_f32 v38, v204, v205
    v_cvt_pk_bf16_f32 v39, v206, v207
    s_add_u32 s64, s32, 0x20000
    buffer_store_dwordx4 v[36:39], v1, s[4:7], s64 offen offset:1024 sc1
    v_mul_f32 v212, v212, v9
    v_mul_f32 v213, v213, v9
    v_mul_f32 v214, v214, v9
    v_mul_f32 v215, v215, v9
    v_cvt_pk_bf16_f32 v40, v212, v213
    v_cvt_pk_bf16_f32 v41, v214, v215
    v_mul_f32 v220, v220, v9
    v_mul_f32 v221, v221, v9
    v_mul_f32 v222, v222, v9
    v_mul_f32 v223, v223, v9
    v_cvt_pk_bf16_f32 v42, v220, v221
    v_cvt_pk_bf16_f32 v43, v222, v223
    s_add_u32 s64, s32, 0x20000
    buffer_store_dwordx4 v[40:43], v1, s[4:7], s64 offen offset:2048 sc1
    v_mul_f32 v228, v228, v9
    v_mul_f32 v229, v229, v9
    v_mul_f32 v230, v230, v9
    v_mul_f32 v231, v231, v9
    v_cvt_pk_bf16_f32 v44, v228, v229
    v_cvt_pk_bf16_f32 v45, v230, v231
    v_mul_f32 v236, v236, v9
    v_mul_f32 v237, v237, v9
    v_mul_f32 v238, v238, v9
    v_mul_f32 v239, v239, v9
    v_cvt_pk_bf16_f32 v46, v236, v237
    v_cvt_pk_bf16_f32 v47, v238, v239
    s_add_u32 s64, s32, 0x20000
    buffer_store_dwordx4 v[44:47], v1, s[4:7], s64 offen offset:3072 sc1
    s_waitcnt vmcnt(0)
    v_mov_b32 v7, 1
    v_mov_b32 v8, 0
    s_mov_b64 exec, 1
    buffer_store_dword v7, v8, s[4:7], s33 offen sc1
    s_mov_b64 exec, -1
    s_add_u32 s24, s24, 8
    s_add_u32 s25, s25, 1
    s_cmp_lt_u32 s25, 1
    s_cbranch_scc1 AT0_LOOP
AT0_END:
    s_lshl_b32 s70, s13, 1
    s_add_u32 s70, s70, s12
    s_load_dwordx2 s[44:45], s[0:1], 72
    s_mov_b32 s46, 0x21c000
    s_mov_b32 s47, 0x00020000
    s_load_dwordx2 s[48:49], s[0:1], 80
    s_mov_b32 s50, 0x21c000
    s_mov_b32 s51, 0x00020000
    s_load_dwordx2 s[52:53], s[0:1], 88
    s_mov_b32 s54, 0x21c000
    s_mov_b32 s55, 0x00020000
    s_mov_b32 s29, 0
    s_waitcnt lgkmcnt(0)
    v_mbcnt_lo_u32_b32 v0, -1, 0
    v_mbcnt_hi_u32_b32 v0, -1, v0
    s_cmp_lg_u32 s14, 0
    s_cbranch_scc1 H_ATT
    s_cmp_ge_u32 s70, 40
    s_cbranch_scc1 H_ATT
    s_mov_b32 s24, s70
    s_mov_b32 s25, 0
    v_lshrrev_b32 v7, 1, v0
    v_mul_u32_u24 v2, 1280, v7
    v_and_b32 v7, 1, v0
    v_lshl_add_u32 v2, v7, 4, v2
    v_lshrrev_b32 v7, 4, v0
    v_lshlrev_b32 v3, 7, v7
    v_bfe_u32 v7, v0, 2, 2
    v_lshl_add_u32 v3, v7, 5, v3
    v_and_b32 v7, 3, v0
    v_lshl_add_u32 v3, v7, 3, v3
    v_add_u32 v3, s25, v3
    s_lshl_b32 s26, s24, 5
    s_add_u32 m0, s25, 0
    s_add_u32 s64, s26, 0x0
    buffer_load_dwordx4 v2, s[52:55], s64 offen lds
    s_add_u32 m0, s25, 1024
    s_add_u32 s64, s26, 0xa000
    buffer_load_dwordx4 v2, s[52:55], s64 offen lds
    s_add_u32 m0, s25, 2048
    s_add_u32 s64, s26, 0x14000
    buffer_load_dwordx4 v2, s[52:55], s64 offen lds
    s_add_u32 m0, s25, 3072
    s_add_u32 s64, s26, 0x1e000
    buffer_load_dwordx4 v2, s[52:55], s64 offen lds
    s_add_u32 m0, s25, 4096
    s_add_u32 s64, s26, 0x28000
    buffer_load_dwordx4 v2, s[52:55], s64 offen lds
    s_add_u32 m0, s25, 5120
    s_add_u32 s64, s26, 0x32000
    buffer_load_dwordx4 v2, s[52:55], s64 offen lds
    s_add_u32 m0, s25, 6144
    s_add_u32 s64, s26, 0x3c000
    buffer_load_dwordx4 v2, s[52:55], s64 offen lds
    s_add_u32 m0, s25, 7168
    s_add_u32 s64, s26, 0x46000
    buffer_load_dwordx4 v2, s[52:55], s64 offen lds
    s_add_u32 m0, s25, 8192
    s_add_u32 s64, s26, 0x50000
    buffer_load_dwordx4 v2, s[52:55], s64 offen lds
    s_add_u32 m0, s25, 9216
    s_add_u32 s64, s26, 0x5a000
    buffer_load_dwordx4 v2, s[52:55], s64 offen lds
    s_add_u32 m0, s25, 10240
    s_add_u32 s64, s26, 0x64000
    buffer_load_dwordx4 v2, s[52:55], s64 offen lds
    s_add_u32 m0, s25, 11264
    s_add_u32 s64, s26, 0x6e000
    buffer_load_dwordx4 v2, s[52:55], s64 offen lds
    s_add_u32 m0, s25, 12288
    s_add_u32 s64, s26, 0x78000
    buffer_load_dwordx4 v2, s[52:55], s64 offen lds
    s_add_u32 m0, s25, 13312
    s_add_u32 s64, s26, 0x82000
    buffer_load_dwordx4 v2, s[52:55], s64 offen lds
    s_add_u32 m0, s25, 14336
    s_add_u32 s64, s26, 0x8c000
    buffer_load_dwordx4 v2, s[52:55], s64 offen lds
    s_add_u32 m0, s25, 15360
    s_add_u32 s64, s26, 0x96000
    buffer_load_dwordx4 v2, s[52:55], s64 offen lds
    s_add_u32 m0, s25, 16384
    s_add_u32 s64, s26, 0xa0000
    buffer_load_dwordx4 v2, s[52:55], s64 offen lds
    s_add_u32 m0, s25, 17408
    s_add_u32 s64, s26, 0xaa000
    buffer_load_dwordx4 v2, s[52:55], s64 offen lds
    s_add_u32 m0, s25, 18432
    s_add_u32 s64, s26, 0xb4000
    buffer_load_dwordx4 v2, s[52:55], s64 offen lds
    s_add_u32 m0, s25, 19456
    s_add_u32 s64, s26, 0xbe000
    buffer_load_dwordx4 v2, s[52:55], s64 offen lds
    s_add_u32 m0, s25, 20480
    s_add_u32 s64, s26, 0xc8000
    buffer_load_dwordx4 v2, s[52:55], s64 offen lds
    s_add_u32 m0, s25, 21504
    s_add_u32 s64, s26, 0xd2000
    buffer_load_dwordx4 v2, s[52:55], s64 offen lds
    s_add_u32 m0, s25, 22528
    s_add_u32 s64, s26, 0xdc000
    buffer_load_dwordx4 v2, s[52:55], s64 offen lds
    s_add_u32 m0, s25, 23552
    s_add_u32 s64, s26, 0xe6000
    buffer_load_dwordx4 v2, s[52:55], s64 offen lds
    s_add_u32 m0, s25, 24576
    s_add_u32 s64, s26, 0xf0000
    buffer_load_dwordx4 v2, s[52:55], s64 offen lds
    s_add_u32 m0, s25, 25600
    s_add_u32 s64, s26, 0xfa000
    buffer_load_dwordx4 v2, s[52:55], s64 offen lds
    s_add_u32 m0, s25, 26624
    s_add_u32 s64, s26, 0x104000
    buffer_load_dwordx4 v2, s[52:55], s64 offen lds
    s_add_u32 m0, s25, 27648
    s_add_u32 s64, s26, 0x10e000
    buffer_load_dwordx4 v2, s[52:55], s64 offen lds
    s_add_u32 m0, s25, 28672
    s_add_u32 s64, s26, 0x118000
    buffer_load_dwordx4 v2, s[52:55], s64 offen lds
    s_add_u32 m0, s25, 29696
    s_add_u32 s64, s26, 0x122000
    buffer_load_dwordx4 v2, s[52:55], s64 offen lds
    s_add_u32 m0, s25, 30720
    s_add_u32 s64, s26, 0x12c000
    buffer_load_dwordx4 v2, s[52:55], s64 offen lds
    s_add_u32 m0, s25, 31744
    s_add_u32 s64, s26, 0x136000
    buffer_load_dwordx4 v2, s[52:55], s64 offen lds
    s_add_u32 m0, s25, 32768
    s_add_u32 s64, s26, 0x140000
    buffer_load_dwordx4 v2, s[52:55], s64 offen lds
    s_add_u32 m0, s25, 33792
    s_add_u32 s64, s26, 0x14a000
    buffer_load_dwordx4 v2, s[52:55], s64 offen lds
    s_add_u32 m0, s25, 34816
    s_add_u32 s64, s26, 0x154000
    buffer_load_dwordx4 v2, s[52:55], s64 offen lds
    s_add_u32 m0, s25, 35840
    s_add_u32 s64, s26, 0x15e000
    buffer_load_dwordx4 v2, s[52:55], s64 offen lds
    s_add_u32 m0, s25, 36864
    s_add_u32 s64, s26, 0x168000
    buffer_load_dwordx4 v2, s[52:55], s64 offen lds
    s_add_u32 m0, s25, 37888
    s_add_u32 s64, s26, 0x172000
    buffer_load_dwordx4 v2, s[52:55], s64 offen lds
    s_add_u32 m0, s25, 38912
    s_add_u32 s64, s26, 0x17c000
    buffer_load_dwordx4 v2, s[52:55], s64 offen lds
    s_add_u32 m0, s25, 39936
    s_add_u32 s64, s26, 0x186000
    buffer_load_dwordx4 v2, s[52:55], s64 offen lds
    v_mov_b32 v8, 0
    s_mov_b32 s64, 0x298080
F2W_190:
    buffer_load_dword v7, v8, s[4:7], s64 offen sc1
    s_add_u32 s29, s29, 1
    s_waitcnt vmcnt(0)
    v_mov_b32 v9, 108
    v_cmp_gt_u32 vcc, v9, v7
    s_cbranch_vccz F2WD_191
    s_cmp_gt_u32 s29, 262144
    s_cbranch_scc1 F2WD_191
    s_sleep 8
    s_branch F2W_190
F2WD_191:
    s_add_u32 m0, s25, 40960
    s_add_u32 s64, s26, 0x190000
    buffer_load_dwordx4 v2, s[52:55], s64 offen lds
    s_add_u32 m0, s25, 41984
    s_add_u32 s64, s26, 0x19a000
    buffer_load_dwordx4 v2, s[52:55], s64 offen lds
    s_add_u32 m0, s25, 43008
    s_add_u32 s64, s26, 0x1a4000
    buffer_load_dwordx4 v2, s[52:55], s64 offen lds
    s_add_u32 m0, s25, 44032
    s_add_u32 s64, s26, 0x1ae000
    buffer_load_dwordx4 v2, s[52:55], s64 offen lds
    s_add_u32 m0, s25, 45056
    s_add_u32 s64, s26, 0x1b8000
    buffer_load_dwordx4 v2, s[52:55], s64 offen lds
    s_add_u32 m0, s25, 46080
    s_add_u32 s64, s26, 0x1c2000
    buffer_load_dwordx4 v2, s[52:55], s64 offen lds
    s_add_u32 m0, s25, 47104
    s_add_u32 s64, s26, 0x1cc000
    buffer_load_dwordx4 v2, s[52:55], s64 offen lds
    s_add_u32 m0, s25, 48128
    s_add_u32 s64, s26, 0x1d6000
    buffer_load_dwordx4 v2, s[52:55], s64 offen lds
    s_add_u32 m0, s25, 49152
    s_add_u32 s64, s26, 0x1e0000
    buffer_load_dwordx4 v2, s[52:55], s64 offen lds
    s_add_u32 m0, s25, 50176
    s_add_u32 s64, s26, 0x1ea000
    buffer_load_dwordx4 v2, s[52:55], s64 offen lds
    s_add_u32 m0, s25, 51200
    s_add_u32 s64, s26, 0x1f4000
    buffer_load_dwordx4 v2, s[52:55], s64 offen lds
    s_add_u32 m0, s25, 52224
    s_add_u32 s64, s26, 0x1fe000
    buffer_load_dwordx4 v2, s[52:55], s64 offen lds
    s_add_u32 m0, s25, 53248
    s_add_u32 s64, s26, 0x208000
    buffer_load_dwordx4 v2, s[52:55], s64 offen lds
    s_add_u32 m0, s25, 54272
    s_add_u32 s64, s26, 0x212000
    buffer_load_dwordx4 v2, s[52:55], s64 offen lds
    v_lshlrev_b32 v4, 4, v0
    s_mov_b32 s65, 0x5401000
    buffer_load_dwordx4 v[16:19], v4, s[4:7], s65 offen offset:0 sc1
    buffer_load_dwordx4 v[20:23], v4, s[4:7], s65 offen offset:1024 sc1
    buffer_load_dwordx4 v[24:27], v4, s[4:7], s65 offen offset:2048 sc1
    buffer_load_dwordx4 v[28:31], v4, s[4:7], s65 offen offset:3072 sc1
    s_add_u32 s65, s65, 4096
    buffer_load_dwordx4 v[32:35], v4, s[4:7], s65 offen offset:0 sc1
    buffer_load_dwordx4 v[36:39], v4, s[4:7], s65 offen offset:1024 sc1
    buffer_load_dwordx4 v[40:43], v4, s[4:7], s65 offen offset:2048 sc1
    buffer_load_dwordx4 v[44:47], v4, s[4:7], s65 offen offset:3072 sc1
    s_add_u32 s65, s65, 4096
    buffer_load_dwordx4 v[48:51], v4, s[4:7], s65 offen offset:0 sc1
    buffer_load_dwordx4 v[52:55], v4, s[4:7], s65 offen offset:1024 sc1
    buffer_load_dwordx4 v[56:59], v4, s[4:7], s65 offen offset:2048 sc1
    buffer_load_dwordx4 v[60:63], v4, s[4:7], s65 offen offset:3072 sc1
    s_add_u32 s65, s65, 4096
    buffer_load_dwordx4 v[64:67], v4, s[4:7], s65 offen offset:0 sc1
    buffer_load_dwordx4 v[68:71], v4, s[4:7], s65 offen offset:1024 sc1
    buffer_load_dwordx4 v[72:75], v4, s[4:7], s65 offen offset:2048 sc1
    buffer_load_dwordx4 v[76:79], v4, s[4:7], s65 offen offset:3072 sc1
    s_add_u32 s65, s65, 4096
    buffer_load_dwordx4 v[80:83], v4, s[4:7], s65 offen offset:0 sc1
    buffer_load_dwordx4 v[84:87], v4, s[4:7], s65 offen offset:1024 sc1
    buffer_load_dwordx4 v[88:91], v4, s[4:7], s65 offen offset:2048 sc1
    buffer_load_dwordx4 v[92:95], v4, s[4:7], s65 offen offset:3072 sc1
    s_add_u32 s65, s65, 4096
    buffer_load_dwordx4 v[96:99], v4, s[4:7], s65 offen offset:0 sc1
    buffer_load_dwordx4 v[100:103], v4, s[4:7], s65 offen offset:1024 sc1
    buffer_load_dwordx4 v[104:107], v4, s[4:7], s65 offen offset:2048 sc1
    buffer_load_dwordx4 v[108:111], v4, s[4:7], s65 offen offset:3072 sc1
    s_add_u32 s65, s65, 4096
    buffer_load_dwordx4 v[112:115], v4, s[4:7], s65 offen offset:0 sc1
    buffer_load_dwordx4 v[116:119], v4, s[4:7], s65 offen offset:1024 sc1
    buffer_load_dwordx4 v[120:123], v4, s[4:7], s65 offen offset:2048 sc1
    buffer_load_dwordx4 v[124:127], v4, s[4:7], s65 offen offset:3072 sc1
    s_add_u32 s65, s65, 4096
    buffer_load_dwordx4 v[128:131], v4, s[4:7], s65 offen offset:0 sc1
    buffer_load_dwordx4 v[132:135], v4, s[4:7], s65 offen offset:1024 sc1
    buffer_load_dwordx4 v[136:139], v4, s[4:7], s65 offen offset:2048 sc1
    buffer_load_dwordx4 v[140:143], v4, s[4:7], s65 offen offset:3072 sc1
    s_add_u32 s65, s65, 4096
    buffer_load_dwordx4 v[144:147], v4, s[4:7], s65 offen offset:0 sc1
    buffer_load_dwordx4 v[148:151], v4, s[4:7], s65 offen offset:1024 sc1
    buffer_load_dwordx4 v[152:155], v4, s[4:7], s65 offen offset:2048 sc1
    buffer_load_dwordx4 v[156:159], v4, s[4:7], s65 offen offset:3072 sc1
    s_add_u32 s65, s65, 4096
    buffer_load_dwordx4 v[160:163], v4, s[4:7], s65 offen offset:0 sc1
    buffer_load_dwordx4 v[164:167], v4, s[4:7], s65 offen offset:1024 sc1
    buffer_load_dwordx4 v[168:171], v4, s[4:7], s65 offen offset:2048 sc1
    buffer_load_dwordx4 v[172:175], v4, s[4:7], s65 offen offset:3072 sc1
    s_add_u32 s65, s65, 4096
    buffer_load_dwordx4 v[176:179], v4, s[4:7], s65 offen offset:0 sc1
    s_waitcnt vmcnt(41)
    buffer_load_dwordx4 v[180:183], v4, s[4:7], s65 offen offset:1024 sc1
    buffer_load_dwordx4 v[184:187], v4, s[4:7], s65 offen offset:2048 sc1
    buffer_load_dwordx4 v[188:191], v4, s[4:7], s65 offen offset:3072 sc1
    s_add_u32 s65, s65, 4096
    buffer_load_dwordx4 v[192:195], v4, s[4:7], s65 offen offset:0 sc1
    buffer_load_dwordx4 v[196:199], v4, s[4:7], s65 offen offset:1024 sc1
    buffer_load_dwordx4 v[200:203], v4, s[4:7], s65 offen offset:2048 sc1
    buffer_load_dwordx4 v[204:207], v4, s[4:7], s65 offen offset:3072 sc1
    s_add_u32 s65, s65, 4096
    buffer_load_dwordx4 v[208:211], v4, s[4:7], s65 offen offset:0 sc1
    buffer_load_dwordx4 v[212:215], v4, s[4:7], s65 offen offset:1024 sc1
    buffer_load_dwordx4 v[216:219], v4, s[4:7], s65 offen offset:2048 sc1
    buffer_load_dwordx4 v[220:223], v4, s[4:7], s65 offen offset:3072 sc1
    s_add_u32 s65, s65, 4096
    buffer_load_dwordx4 v[224:227], v4, s[4:7], s65 offen offset:0 sc1
    buffer_load_dwordx4 v[228:231], v4, s[4:7], s65 offen offset:1024 sc1
    v_and_b32 v7, 7, v0
    v_lshlrev_b32 v7, 2, v7
    s_mov_b32 s64, 0x5400020
    buffer_load_dword v12, v7, s[4:7], s64 offen sc1
    s_waitcnt vmcnt(0)
    ds_read_b64_tr_b16 v[232:233], v3 offset:0
    ds_read_b64_tr_b16 v[234:235], v3 offset:512
    ds_read_b64_tr_b16 v[236:237], v3 offset:1024
    ds_read_b64_tr_b16 v[238:239], v3 offset:1536
    ds_read_b64_tr_b16 v[240:241], v3 offset:2048
    ds_read_b64_tr_b16 v[242:243], v3 offset:2560
    ds_read_b64_tr_b16 v[244:245], v3 offset:3072
    ds_read_b64_tr_b16 v[246:247], v3 offset:3584
    s_waitcnt lgkmcnt(6)
    v_mfma_f32_16x16x32_bf16 v[8:11], v[232:235], v[16:19], 0
    ds_read_b64_tr_b16 v[232:233], v3 offset:4096
    ds_read_b64_tr_b16 v[234:235], v3 offset:4608
    s_waitcnt lgkmcnt(6)
    v_mfma_f32_16x16x32_bf16 v[8:11], v[236:239], v[20:23], v[8:11]
    ds_read_b64_tr_b16 v[236:237], v3 offset:5120
    ds_read_b64_tr_b16 v[238:239], v3 offset:5632
    s_waitcnt lgkmcnt(6)
    v_mfma_f32_16x16x32_bf16 v[8:11], v[240:243], v[24:27], v[8:11]
    ds_read_b64_tr_b16 v[240:241], v3 offset:6144
    ds_read_b64_tr_b16 v[242:243], v3 offset:6656
    s_waitcnt lgkmcnt(6)
    v_mfma_f32_16x16x32_bf16 v[8:11], v[244:247], v[28:31], v[8:11]
    ds_read_b64_tr_b16 v[244:245], v3 offset:7168
    ds_read_b64_tr_b16 v[246:247], v3 offset:7680
    s_waitcnt lgkmcnt(6)
    v_mfma_f32_16x16x32_bf16 v[8:11], v[232:235], v[32:35], v[8:11]
    ds_read_b64_tr_b16 v[232:233], v3 offset:8192
    ds_read_b64_tr_b16 v[234:235], v3 offset:8704
    s_waitcnt lgkmcnt(6)
    v_mfma_f32_16x16x32_bf16 v[8:11], v[236:239], v[36:39], v[8:11]
    ds_read_b64_tr_b16 v[236:237], v3 offset:9216
    ds_read_b64_tr_b16 v[238:239], v3 offset:9728
    s_waitcnt lgkmcnt(6)
    v_mfma_f32_16x16x32_bf16 v[8:11], v[240:243], v[40:43], v[8:11]
    ds_read_b64_tr_b16 v[240:241], v3 offset:10240
    ds_read_b64_tr_b16 v[242:243], v3 offset:10752
    s_waitcnt lgkmcnt(6)
    v_mfma_f32_16x16x32_bf16 v[8:11], v[244:247], v[44:47], v[8:11]
    ds_read_b64_tr_b16 v[244:245], v3 offset:11264
    ds_read_b64_tr_b16 v[246:247], v3 offset:11776
    s_waitcnt lgkmcnt(6)
    v_mfma_f32_16x16x32_bf16 v[8:11], v[232:235], v[48:51], v[8:11]
    ds_read_b64_tr_b16 v[232:233], v3 offset:12288
    ds_read_b64_tr_b16 v[234:235], v3 offset:12800
    s_waitcnt lgkmcnt(6)
    v_mfma_f32_16x16x32_bf16 v[8:11], v[236:239], v[52:55], v[8:11]
    ds_read_b64_tr_b16 v[236:237], v3 offset:13312
    ds_read_b64_tr_b16 v[238:239], v3 offset:13824
    s_waitcnt lgkmcnt(6)
    v_mfma_f32_16x16x32_bf16 v[8:11], v[240:243], v[56:59], v[8:11]
    ds_read_b64_tr_b16 v[240:241], v3 offset:14336
    ds_read_b64_tr_b16 v[242:243], v3 offset:14848
    s_waitcnt lgkmcnt(6)
    v_mfma_f32_16x16x32_bf16 v[8:11], v[244:247], v[60:63], v[8:11]
    ds_read_b64_tr_b16 v[244:245], v3 offset:15360
    ds_read_b64_tr_b16 v[246:247], v3 offset:15872
    s_waitcnt lgkmcnt(6)
    v_mfma_f32_16x16x32_bf16 v[8:11], v[232:235], v[64:67], v[8:11]
    ds_read_b64_tr_b16 v[232:233], v3 offset:16384
    ds_read_b64_tr_b16 v[234:235], v3 offset:16896
    s_waitcnt lgkmcnt(6)
    v_mfma_f32_16x16x32_bf16 v[8:11], v[236:239], v[68:71], v[8:11]
    ds_read_b64_tr_b16 v[236:237], v3 offset:17408
    ds_read_b64_tr_b16 v[238:239], v3 offset:17920
    s_waitcnt lgkmcnt(6)
    v_mfma_f32_16x16x32_bf16 v[8:11], v[240:243], v[72:75], v[8:11]
    ds_read_b64_tr_b16 v[240:241], v3 offset:18432
    ds_read_b64_tr_b16 v[242:243], v3 offset:18944
    s_waitcnt lgkmcnt(6)
    v_mfma_f32_16x16x32_bf16 v[8:11], v[244:247], v[76:79], v[8:11]
    ds_read_b64_tr_b16 v[244:245], v3 offset:19456
    ds_read_b64_tr_b16 v[246:247], v3 offset:19968
    s_waitcnt lgkmcnt(6)
    v_mfma_f32_16x16x32_bf16 v[8:11], v[232:235], v[80:83], v[8:11]
    ds_read_b64_tr_b16 v[232:233], v3 offset:20480
    ds_read_b64_tr_b16 v[234:235], v3 offset:20992
    s_waitcnt lgkmcnt(6)
    v_mfma_f32_16x16x32_bf16 v[8:11], v[236:239], v[84:87], v[8:11]
    ds_read_b64_tr_b16 v[236:237], v3 offset:21504
    ds_read_b64_tr_b16 v[238:239], v3 offset:22016
    s_waitcnt lgkmcnt(6)
    v_mfma_f32_16x16x32_bf16 v[8:11], v[240:243], v[88:91], v[8:11]
    ds_read_b64_tr_b16 v[240:241], v3 offset:22528
    ds_read_b64_tr_b16 v[242:243], v3 offset:23040
    s_waitcnt lgkmcnt(6)
    v_mfma_f32_16x16x32_bf16 v[8:11], v[244:247], v[92:95], v[8:11]
    ds_read_b64_tr_b16 v[244:245], v3 offset:23552
    ds_read_b64_tr_b16 v[246:247], v3 offset:24064
    s_waitcnt lgkmcnt(6)
    v_mfma_f32_16x16x32_bf16 v[8:11], v[232:235], v[96:99], v[8:11]
    ds_read_b64_tr_b16 v[232:233], v3 offset:24576
    ds_read_b64_tr_b16 v[234:235], v3 offset:25088
    s_waitcnt lgkmcnt(6)
    v_mfma_f32_16x16x32_bf16 v[8:11], v[236:239], v[100:103], v[8:11]
    ds_read_b64_tr_b16 v[236:237], v3 offset:25600
    ds_read_b64_tr_b16 v[238:239], v3 offset:26112
    s_waitcnt lgkmcnt(6)
    v_mfma_f32_16x16x32_bf16 v[8:11], v[240:243], v[104:107], v[8:11]
    ds_read_b64_tr_b16 v[240:241], v3 offset:26624
    ds_read_b64_tr_b16 v[242:243], v3 offset:27136
    s_waitcnt lgkmcnt(6)
    v_mfma_f32_16x16x32_bf16 v[8:11], v[244:247], v[108:111], v[8:11]
    ds_read_b64_tr_b16 v[244:245], v3 offset:27648
    ds_read_b64_tr_b16 v[246:247], v3 offset:28160
    s_waitcnt lgkmcnt(6)
    v_mfma_f32_16x16x32_bf16 v[8:11], v[232:235], v[112:115], v[8:11]
    ds_read_b64_tr_b16 v[232:233], v3 offset:28672
    ds_read_b64_tr_b16 v[234:235], v3 offset:29184
    s_waitcnt lgkmcnt(6)
    v_mfma_f32_16x16x32_bf16 v[8:11], v[236:239], v[116:119], v[8:11]
    ds_read_b64_tr_b16 v[236:237], v3 offset:29696
    ds_read_b64_tr_b16 v[238:239], v3 offset:30208
    s_waitcnt lgkmcnt(6)
    v_mfma_f32_16x16x32_bf16 v[8:11], v[240:243], v[120:123], v[8:11]
    ds_read_b64_tr_b16 v[240:241], v3 offset:30720
    ds_read_b64_tr_b16 v[242:243], v3 offset:31232
    s_waitcnt lgkmcnt(6)
    v_mfma_f32_16x16x32_bf16 v[8:11], v[244:247], v[124:127], v[8:11]
    ds_read_b64_tr_b16 v[244:245], v3 offset:31744
    ds_read_b64_tr_b16 v[246:247], v3 offset:32256
    s_waitcnt lgkmcnt(6)
    v_mfma_f32_16x16x32_bf16 v[8:11], v[232:235], v[128:131], v[8:11]
    ds_read_b64_tr_b16 v[232:233], v3 offset:32768
    ds_read_b64_tr_b16 v[234:235], v3 offset:33280
    s_waitcnt lgkmcnt(6)
    v_mfma_f32_16x16x32_bf16 v[8:11], v[236:239], v[132:135], v[8:11]
    ds_read_b64_tr_b16 v[236:237], v3 offset:33792
    ds_read_b64_tr_b16 v[238:239], v3 offset:34304
    s_waitcnt lgkmcnt(6)
    v_mfma_f32_16x16x32_bf16 v[8:11], v[240:243], v[136:139], v[8:11]
    ds_read_b64_tr_b16 v[240:241], v3 offset:34816
    ds_read_b64_tr_b16 v[242:243], v3 offset:35328
    s_waitcnt lgkmcnt(6)
    v_mfma_f32_16x16x32_bf16 v[8:11], v[244:247], v[140:143], v[8:11]
    ds_read_b64_tr_b16 v[244:245], v3 offset:35840
    ds_read_b64_tr_b16 v[246:247], v3 offset:36352
    s_waitcnt lgkmcnt(6)
    v_mfma_f32_16x16x32_bf16 v[8:11], v[232:235], v[144:147], v[8:11]
    ds_read_b64_tr_b16 v[232:233], v3 offset:36864
    ds_read_b64_tr_b16 v[234:235], v3 offset:37376
    s_waitcnt lgkmcnt(6)
    v_mfma_f32_16x16x32_bf16 v[8:11], v[236:239], v[148:151], v[8:11]
    ds_read_b64_tr_b16 v[236:237], v3 offset:37888
    ds_read_b64_tr_b16 v[238:239], v3 offset:38400
    s_waitcnt lgkmcnt(6)
    v_mfma_f32_16x16x32_bf16 v[8:11], v[240:243], v[152:155], v[8:11]
    ds_read_b64_tr_b16 v[240:241], v3 offset:38912
    ds_read_b64_tr_b16 v[242:243], v3 offset:39424
    s_waitcnt lgkmcnt(6)
    v_mfma_f32_16x16x32_bf16 v[8:11], v[244:247], v[156:159], v[8:11]
    ds_read_b64_tr_b16 v[244:245], v3 offset:39936
    ds_read_b64_tr_b16 v[246:247], v3 offset:40448
    s_waitcnt lgkmcnt(6)
    v_mfma_f32_16x16x32_bf16 v[8:11], v[232:235], v[160:163], v[8:11]
    ds_read_b64_tr_b16 v[232:233], v3 offset:40960
    ds_read_b64_tr_b16 v[234:235], v3 offset:41472
    s_waitcnt lgkmcnt(6)
    v_mfma_f32_16x16x32_bf16 v[8:11], v[236:239], v[164:167], v[8:11]
    ds_read_b64_tr_b16 v[236:237], v3 offset:41984
    ds_read_b64_tr_b16 v[238:239], v3 offset:42496
    s_waitcnt lgkmcnt(6)
    v_mfma_f32_16x16x32_bf16 v[8:11], v[240:243], v[168:171], v[8:11]
    ds_read_b64_tr_b16 v[240:241], v3 offset:43008
    ds_read_b64_tr_b16 v[242:243], v3 offset:43520
    s_waitcnt lgkmcnt(6)
    v_mfma_f32_16x16x32_bf16 v[8:11], v[244:247], v[172:175], v[8:11]
    ds_read_b64_tr_b16 v[244:245], v3 offset:44032
    ds_read_b64_tr_b16 v[246:247], v3 offset:44544
    s_waitcnt lgkmcnt(6)
    v_mfma_f32_16x16x32_bf16 v[8:11], v[232:235], v[176:179], v[8:11]
    ds_read_b64_tr_b16 v[232:233], v3 offset:45056
    ds_read_b64_tr_b16 v[234:235], v3 offset:45568
    s_waitcnt lgkmcnt(6)
    v_mfma_f32_16x16x32_bf16 v[8:11], v[236:239], v[180:183], v[8:11]
    ds_read_b64_tr_b16 v[236:237], v3 offset:46080
    ds_read_b64_tr_b16 v[238:239], v3 offset:46592
    s_waitcnt lgkmcnt(6)
    v_mfma_f32_16x16x32_bf16 v[8:11], v[240:243], v[184:187], v[8:11]
    ds_read_b64_tr_b16 v[240:241], v3 offset:47104
    ds_read_b64_tr_b16 v[242:243], v3 offset:47616
    s_waitcnt lgkmcnt(6)
    v_mfma_f32_16x16x32_bf16 v[8:11], v[244:247], v[188:191], v[8:11]
    ds_read_b64_tr_b16 v[244:245], v3 offset:48128
    ds_read_b64_tr_b16 v[246:247], v3 offset:48640
    s_waitcnt lgkmcnt(6)
    v_mfma_f32_16x16x32_bf16 v[8:11], v[232:235], v[192:195], v[8:11]
    ds_read_b64_tr_b16 v[232:233], v3 offset:49152
    ds_read_b64_tr_b16 v[234:235], v3 offset:49664
    s_waitcnt lgkmcnt(6)
    v_mfma_f32_16x16x32_bf16 v[8:11], v[236:239], v[196:199], v[8:11]
    ds_read_b64_tr_b16 v[236:237], v3 offset:50176
    ds_read_b64_tr_b16 v[238:239], v3 offset:50688
    s_waitcnt lgkmcnt(6)
    v_mfma_f32_16x16x32_bf16 v[8:11], v[240:243], v[200:203], v[8:11]
    ds_read_b64_tr_b16 v[240:241], v3 offset:51200
    ds_read_b64_tr_b16 v[242:243], v3 offset:51712
    s_waitcnt lgkmcnt(6)
    v_mfma_f32_16x16x32_bf16 v[8:11], v[244:247], v[204:207], v[8:11]
    ds_read_b64_tr_b16 v[244:245], v3 offset:52224
    ds_read_b64_tr_b16 v[246:247], v3 offset:52736
    s_waitcnt lgkmcnt(6)
    v_mfma_f32_16x16x32_bf16 v[8:11], v[232:235], v[208:211], v[8:11]
    ds_read_b64_tr_b16 v[232:233], v3 offset:53248
    ds_read_b64_tr_b16 v[234:235], v3 offset:53760
    s_waitcnt lgkmcnt(6)
    v_mfma_f32_16x16x32_bf16 v[8:11], v[236:239], v[212:215], v[8:11]
    ds_read_b64_tr_b16 v[236:237], v3 offset:54272
    ds_read_b64_tr_b16 v[238:239], v3 offset:54784
    s_waitcnt lgkmcnt(6)
    v_mfma_f32_16x16x32_bf16 v[8:11], v[240:243], v[216:219], v[8:11]
    s_waitcnt lgkmcnt(4)
    v_mfma_f32_16x16x32_bf16 v[8:11], v[244:247], v[220:223], v[8:11]
    s_waitcnt lgkmcnt(2)
    v_mfma_f32_16x16x32_bf16 v[8:11], v[232:235], v[224:227], v[8:11]
    s_waitcnt lgkmcnt(0)
    v_mfma_f32_16x16x32_bf16 v[8:11], v[236:239], v[228:231], v[8:11]
    s_nop 7
    v_cvt_pk_bf16_f32 v8, v8, v8
    v_lshlrev_b32 v8, 16, v8
    v_mul_f32 v8, v8, v12
    v_cvt_pk_bf16_f32 v8, v8, v8
    v_lshlrev_b32 v8, 16, v8
    v_cvt_pk_bf16_f32 v9, v9, v9
    v_lshlrev_b32 v9, 16, v9
    v_mul_f32 v9, v9, v12
    v_cvt_pk_bf16_f32 v9, v9, v9
    v_lshlrev_b32 v9, 16, v9
    v_cvt_pk_bf16_f32 v10, v10, v10
    v_lshlrev_b32 v10, 16, v10
    v_mul_f32 v10, v10, v12
    v_cvt_pk_bf16_f32 v10, v10, v10
    v_lshlrev_b32 v10, 16, v10
    v_cvt_pk_bf16_f32 v11, v11, v11
    v_lshlrev_b32 v11, 16, v11
    v_mul_f32 v11, v11, v12
    v_cvt_pk_bf16_f32 v11, v11, v11
    v_lshlrev_b32 v11, 16, v11
    v_and_b32 v7, 7, v0
    v_mul_u32_u24 v7, 2560, v7
    v_lshrrev_b32 v13, 4, v0
    v_lshl_add_u32 v7, v13, 4, v7
    s_lshl_b32 s64, s24, 6
    s_add_u32 s64, s64, 0x5410000
    s_mov_b32 s68, 0x00ff00ff
    s_mov_b32 s69, 0x00ff00ff
    s_mov_b64 exec, s[68:69]
    buffer_store_dwordx4 v[8:11], v7, s[4:7], s64 offen sc1
    s_mov_b64 exec, -1
    s_waitcnt vmcnt(0)
    v_mov_b32 v7, 1
    v_mov_b32 v8, 0
    s_mov_b32 s64, 0x298100
    s_mov_b64 exec, 1
    buffer_atomic_add v7, v8, s[4:7], s64 offen sc1
    s_mov_b64 exec, -1
H_ATT:
    v_mbcnt_lo_u32_b32 v0, -1, 0
    v_mbcnt_hi_u32_b32 v0, -1, v0
    s_mov_b32 s29, 0
    v_lshlrev_b32 v1, 4, v0
    v_lshrrev_b32 v5, 4, v0
    v_lshlrev_b32 v2, 7, v5
    v_and_b32 v5, 7, v0
    v_lshl_add_u32 v2, v5, 4, v2
    v_bfe_u32 v5, v0, 4, 1
    v_lshlrev_b32 v3, 7, v5
    v_and_b32 v5, 15, v0
    v_lshl_add_u32 v3, v5, 3, v3
    s_mov_b32 s34, 0x3e0293ee
    s_mov_b32 s35, 0x3e0293ee
    s_mov_b32 s36, -1
    s_mov_b32 s37, 0
    v_lshrrev_b32 v5, 4, v0
    v_lshlrev_b32 v5, 2, v5
    v_and_b32 v6, 15, v0
    v_add_u32 v7, 0, v5
    v_cmp_le_u32 s[38:39], v7, v6
    v_add_u32 v7, 1, v5
    v_cmp_le_u32 s[40:41], v7, v6
    v_add_u32 v7, 2, v5
    v_cmp_le_u32 s[42:43], v7, v6
    v_add_u32 v7, 3, v5
    v_cmp_le_u32 s[44:45], v7, v6
    v_mov_b32 v248, 0x3f803f80
    v_mov_b32 v249, 0x3f803f80
    v_mov_b32 v250, 0x3f803f80
    v_mov_b32 v251, 0x3f803f80
    s_lshl_b32 s24, s12, 2
    s_add_u32 s24, s24, s14
    s_add_u32 s24, s24, 8
    s_mov_b32 s25, 1
AT2_LOOP:
    s_cmp_eq_u32 s24, 63
    s_cbranch_scc1 AT2_END
    s_lshl_b32 s64, s24, 5
    s_add_u32 s64, s64, s13
    s_lshl_b32 s26, s64, 13
    s_add_u32 s26, s26, 0x3400000
    s_lshl_b32 s27, s64, 14
    s_add_u32 s27, s27, 0x1400000
    s_lshl_b32 s65, s64, 11
    s_add_u32 s30, s65, 0x640000
    s_add_u32 s31, s65, 0xa40000
    s_lshl_b32 s33, s64, 2
    s_add_u32 s33, s33, 0x296000
    s_lshl_b32 s32, s24, 18
    s_lshl_b32 s65, s13, 12
    s_add_u32 s32, s32, s65
    s_add_u32 s32, s32, 0x4400000
    s_lshr_b32 s65, s24, 2
    s_lshl_b32 s65, s65, 9
    s_lshl_b32 s66, s13, 4
    s_add_u32 s65, s65, s66
    s_add_u32 s65, s65, 0x291000
    s_lshr_b32 s66, s24, 1
    s_lshl_b32 s66, s66, 8
    s_lshl_b32 s64, s13, 3
    s_add_u32 s66, s66, s64
    s_add_u32 s66, s66, 0x293ff4
    v_lshlrev_b32 v5, 2, v0
    v_mov_b32 v6, s65
    v_mov_b32 v7, s66
    v_cmp_gt_u32 vcc, 3, v0
    s_nop 1
    v_cndmask_b32 v6, v7, v6, vcc
    v_add_u32 v4, v5, v6
    s_mov_b32 s64, 0
    s_mov_b64 exec, 7
AT2_F_192:
    buffer_load_dword v5, v4, s[4:7], s64 offen sc1
    s_add_u32 s29, s29, 1
    s_waitcnt vmcnt(0)
    v_cmp_eq_u32 vcc, 0, v5
    s_cbranch_vccz AT2_FD_193
    s_cmp_gt_u32 s29, 262144
    s_cbranch_scc1 AT2_FD_193
    s_sleep 1
    s_branch AT2_F_192
AT2_FD_193:
    s_mov_b64 exec, -1
    buffer_load_dwordx4 v[16:19], v1, s[4:7], s26 offen offset:0
    buffer_load_dwordx4 v[20:23], v1, s[4:7], s26 offen offset:1024
    buffer_load_dwordx4 v[24:27], v1, s[4:7], s26 offen offset:2048
    buffer_load_dwordx4 v[28:31], v1, s[4:7], s26 offen offset:3072
    s_add_u32 s26, s26, 4096
    buffer_load_dwordx4 v[32:35], v1, s[4:7], s26 offen offset:0
    buffer_load_dwordx4 v[36:39], v1, s[4:7], s26 offen offset:1024
    buffer_load_dwordx4 v[40:43], v1, s[4:7], s26 offen offset:2048
    buffer_load_dwordx4 v[44:47], v1, s[4:7], s26 offen offset:3072
    buffer_load_dwordx4 v[48:51], v1, s[4:7], s27 offen offset:0
    buffer_load_dwordx4 v[52:55], v1, s[4:7], s27 offen offset:1024
    buffer_load_dwordx4 v[56:59], v1, s[4:7], s27 offen offset:2048
    buffer_load_dwordx4 v[60:63], v1, s[4:7], s27 offen offset:3072
    s_add_u32 s27, s27, 4096
    buffer_load_dwordx4 v[64:67], v1, s[4:7], s27 offen offset:0
    buffer_load_dwordx4 v[68:71], v1, s[4:7], s27 offen offset:1024
    buffer_load_dwordx4 v[72:75], v1, s[4:7], s27 offen offset:2048
    buffer_load_dwordx4 v[76:79], v1, s[4:7], s27 offen offset:3072
    s_add_u32 s27, s27, 4096
    buffer_load_dwordx4 v[80:83], v1, s[4:7], s27 offen offset:0
    buffer_load_dwordx4 v[84:87], v1, s[4:7], s27 offen offset:1024
    buffer_load_dwordx4 v[88:91], v1, s[4:7], s27 offen offset:2048
    buffer_load_dwordx4 v[92:95], v1, s[4:7], s27 offen offset:3072
    s_add_u32 s27, s27, 4096
    buffer_load_dwordx4 v[96:99], v1, s[4:7], s27 offen offset:0
    buffer_load_dwordx4 v[100:103], v1, s[4:7], s27 offen offset:1024
    buffer_load_dwordx4 v[104:107], v1, s[4:7], s27 offen offset:2048
    buffer_load_dwordx4 v[108:111], v1, s[4:7], s27 offen offset:3072
    s_mov_b64 exec, 0x18
AT2_G_194:
    buffer_load_dword v5, v4, s[4:7], s64 offen sc1
    s_add_u32 s29, s29, 1
    s_waitcnt vmcnt(0)
    v_cmp_eq_u32 vcc, 0, v5
    s_cbranch_vccz AT2_GD_195
    s_cmp_gt_u32 s29, 262144
    s_cbranch_scc1 AT2_GD_195
    s_sleep 1
    s_branch AT2_G_194
AT2_GD_195:
    s_mov_b64 exec, -1
    buffer_load_dwordx4 v[112:115], v2, s[4:7], s30 offen offset:0
    buffer_load_dwordx4 v[116:119], v2, s[4:7], s30 offen offset:512
    buffer_load_dwordx4 v[120:123], v2, s[4:7], s30 offen offset:1024
    buffer_load_dwordx4 v[124:127], v2, s[4:7], s30 offen offset:1536
    buffer_load_dwordx2 v[128:129], v3, s[4:7], s31 offen offset:0
    buffer_load_dwordx2 v[130:131], v3, s[4:7], s31 offen offset:256
    buffer_load_dwordx2 v[132:133], v3, s[4:7], s31 offen offset:512
    buffer_load_dwordx2 v[134:135], v3, s[4:7], s31 offen offset:768
    buffer_load_dwordx2 v[136:137], v3, s[4:7], s31 offen offset:1024
    buffer_load_dwordx2 v[138:139], v3, s[4:7], s31 offen offset:1280
    buffer_load_dwordx2 v[140:141], v3, s[4:7], s31 offen offset:1536
    buffer_load_dwordx2 v[142:143], v3, s[4:7], s31 offen offset:1792
    v_mfma_f32_16x16x32_bf16 v[148:151], v[48:51], v[16:19], 0
    v_mfma_f32_16x16x32_bf16 v[156:159], v[48:51], v[32:35], 0
    v_mfma_f32_16x16x32_bf16 v[160:163], v[64:67], v[32:35], 0
    v_mfma_f32_16x16x32_bf16 v[148:151], v[52:55], v[20:23], v[148:151]
    v_mfma_f32_16x16x32_bf16 v[156:159], v[52:55], v[36:39], v[156:159]
    v_mfma_f32_16x16x32_bf16 v[160:163], v[68:71], v[36:39], v[160:163]
    v_mfma_f32_16x16x32_bf16 v[148:151], v[56:59], v[24:27], v[148:151]
    v_mfma_f32_16x16x32_bf16 v[156:159], v[56:59], v[40:43], v[156:159]
    v_mfma_f32_16x16x32_bf16 v[160:163], v[72:75], v[40:43], v[160:163]
    v_mfma_f32_16x16x32_bf16 v[148:151], v[60:63], v[28:31], v[148:151]
    v_mfma_f32_16x16x32_bf16 v[156:159], v[60:63], v[44:47], v[156:159]
    v_mfma_f32_16x16x32_bf16 v[160:163], v[76:79], v[44:47], v[160:163]
    s_waitcnt vmcnt(8)
    v_mfma_f32_16x16x32_bf16 v[144:147], v[112:115], v[16:19], 0
    v_mfma_f32_16x16x32_bf16 v[152:155], v[112:115], v[32:35], 0
    v_mfma_f32_16x16x32_bf16 v[144:147], v[116:119], v[20:23], v[144:147]
    v_mfma_f32_16x16x32_bf16 v[152:155], v[116:119], v[36:39], v[152:155]
    v_mfma_f32_16x16x32_bf16 v[144:147], v[120:123], v[24:27], v[144:147]
    v_mfma_f32_16x16x32_bf16 v[152:155], v[120:123], v[40:43], v[152:155]
    v_mfma_f32_16x16x32_bf16 v[144:147], v[124:127], v[28:31], v[144:147]
    v_mfma_f32_16x16x32_bf16 v[152:155], v[124:127], v[44:47], v[152:155]
    v_mov_b32 v11, 0xff800000
    s_nop 7
    v_cndmask_b32 v148, v11, v148, s[38:39]
    v_cndmask_b32 v160, v11, v160, s[38:39]
    v_cndmask_b32 v144, v11, v144, s[36:37]
    v_cndmask_b32 v152, v11, v152, s[36:37]
    v_cndmask_b32 v149, v11, v149, s[40:41]
    v_cndmask_b32 v161, v11, v161, s[40:41]
    v_cndmask_b32 v145, v11, v145, s[36:37]
    v_cndmask_b32 v153, v11, v153, s[36:37]
    v_cndmask_b32 v150, v11, v150, s[42:43]
    v_cndmask_b32 v162, v11, v162, s[42:43]
    v_cndmask_b32 v146, v11, v146, s[36:37]
    v_cndmask_b32 v154, v11, v154, s[36:37]
    v_cndmask_b32 v151, v11, v151, s[44:45]
    v_cndmask_b32 v163, v11, v163, s[44:45]
    v_cndmask_b32 v147, v11, v147, s[36:37]
    v_cndmask_b32 v155, v11, v155, s[36:37]
    v_max3_f32 v8, v144, v145, v146
    v_max3_f32 v8, v8, v147, v148
    v_max3_f32 v8, v8, v149, v150
    v_max_f32 v8, v8, v151
    v_mov_b32 v9, v8
    s_nop 1
    v_permlane16_swap_b32 v8, v9
    v_max_f32 v8, v8, v9
    v_mov_b32 v9, v8
    s_nop 1
    v_permlane32_swap_b32 v8, v9
    v_max_f32 v8, v8, v9
    v_mul_f32 v8, s34, v8
    v_fma_f32 v144, v144, s34, -v8
    v_fma_f32 v145, v145, s34, -v8
    v_fma_f32 v146, v146, s34, -v8
    v_fma_f32 v147, v147, s34, -v8
    v_fma_f32 v148, v148, s34, -v8
    v_fma_f32 v149, v149, s34, -v8
    v_fma_f32 v150, v150, s34, -v8
    v_fma_f32 v151, v151, s34, -v8
    v_exp_f32 v144, v144
    v_exp_f32 v145, v145
    v_exp_f32 v146, v146
    v_exp_f32 v147, v147
    v_exp_f32 v148, v148
    v_exp_f32 v149, v149
    v_exp_f32 v150, v150
    v_exp_f32 v151, v151
    s_nop 0
    v_cvt_pk_bf16_f32 v164, v148, v149
    v_cvt_pk_bf16_f32 v165, v150, v151
    v_mov_b32 v166, 0
    v_mov_b32 v167, 0
    v_cvt_pk_bf16_f32 v168, v144, v145
    v_cvt_pk_bf16_f32 v169, v146, v147
    v_max3_f32 v8, v152, v153, v154
    v_max3_f32 v8, v8, v155, v156
    v_max3_f32 v8, v8, v157, v158
    v_max3_f32 v8, v8, v159, v160
    v_max3_f32 v8, v8, v161, v162
    v_max_f32 v8, v8, v163
    v_mov_b32 v9, v8
    s_nop 1
    v_permlane16_swap_b32 v8, v9
    v_max_f32 v8, v8, v9
    v_mov_b32 v9, v8
    s_nop 1
    v_permlane32_swap_b32 v8, v9
    v_max_f32 v8, v8, v9
    v_mul_f32 v8, s34, v8
    v_fma_f32 v152, v152, s34, -v8
    v_fma_f32 v153, v153, s34, -v8
    v_fma_f32 v154, v154, s34, -v8
    v_fma_f32 v155, v155, s34, -v8
    v_fma_f32 v156, v156, s34, -v8
    v_fma_f32 v157, v157, s34, -v8
    v_fma_f32 v158, v158, s34, -v8
    v_fma_f32 v159, v159, s34, -v8
    v_fma_f32 v160, v160, s34, -v8
    v_fma_f32 v161, v161, s34, -v8
    v_fma_f32 v162, v162, s34, -v8
    v_fma_f32 v163, v163, s34, -v8
    v_exp_f32 v152, v152
    v_exp_f32 v153, v153
    v_exp_f32 v154, v154
    v_exp_f32 v155, v155
    v_exp_f32 v156, v156
    v_exp_f32 v157, v157
    v_exp_f32 v158, v158
    v_exp_f32 v159, v159
    v_exp_f32 v160, v160
    v_exp_f32 v161, v161
    v_exp_f32 v162, v162
    v_exp_f32 v163, v163
    s_nop 0
    v_cvt_pk_bf16_f32 v170, v156, v157
    v_cvt_pk_bf16_f32 v171, v158, v159
    v_cvt_pk_bf16_f32 v172, v160, v161
    v_cvt_pk_bf16_f32 v173, v162, v163
    v_cvt_pk_bf16_f32 v174, v152, v153
    v_cvt_pk_bf16_f32 v175, v154, v155
    s_waitcnt vmcnt(0)
    v_mfma_f32_16x16x32_bf16 v[240:243], v[248:251], v[164:167], 0
    v_mfma_f32_16x16x32_bf16 v[244:247], v[248:251], v[170:173], 0
    v_mfma_f32_16x16x32_bf16 v[176:179], v[80:83], v[164:167], 0
    v_mfma_f32_16x16x32_bf16 v[180:183], v[80:83], v[170:173], 0
    v_mfma_f32_16x16x32_bf16 v[184:187], v[84:87], v[164:167], 0
    v_mfma_f32_16x16x32_bf16 v[188:191], v[84:87], v[170:173], 0
    v_mfma_f32_16x16x32_bf16 v[192:195], v[88:91], v[164:167], 0
    v_mfma_f32_16x16x32_bf16 v[196:199], v[88:91], v[170:173], 0
    v_mfma_f32_16x16x32_bf16 v[200:203], v[92:95], v[164:167], 0
    v_mfma_f32_16x16x32_bf16 v[204:207], v[92:95], v[170:173], 0
    v_mfma_f32_16x16x32_bf16 v[208:211], v[96:99], v[164:167], 0
    v_mfma_f32_16x16x32_bf16 v[212:215], v[96:99], v[170:173], 0
    v_mfma_f32_16x16x32_bf16 v[216:219], v[100:103], v[164:167], 0
    v_mfma_f32_16x16x32_bf16 v[220:223], v[100:103], v[170:173], 0
    v_mfma_f32_16x16x32_bf16 v[224:227], v[104:107], v[164:167], 0
    v_mfma_f32_16x16x32_bf16 v[228:231], v[104:107], v[170:173], 0
    v_mfma_f32_16x16x32_bf16 v[232:235], v[108:111], v[164:167], 0
    v_mfma_f32_16x16x32_bf16 v[236:239], v[108:111], v[170:173], 0
    v_mfma_f32_16x16x16_bf16 v[240:243], v[248:249], v[168:169], v[240:243]
    v_mfma_f32_16x16x16_bf16 v[244:247], v[248:249], v[174:175], v[244:247]
    v_mfma_f32_16x16x16_bf16 v[176:179], v[128:129], v[168:169], v[176:179]
    v_mfma_f32_16x16x16_bf16 v[180:183], v[128:129], v[174:175], v[180:183]
    v_mfma_f32_16x16x16_bf16 v[184:187], v[130:131], v[168:169], v[184:187]
    v_mfma_f32_16x16x16_bf16 v[188:191], v[130:131], v[174:175], v[188:191]
    v_mfma_f32_16x16x16_bf16 v[192:195], v[132:133], v[168:169], v[192:195]
    v_mfma_f32_16x16x16_bf16 v[196:199], v[132:133], v[174:175], v[196:199]
    v_mfma_f32_16x16x16_bf16 v[200:203], v[134:135], v[168:169], v[200:203]
    v_mfma_f32_16x16x16_bf16 v[204:207], v[134:135], v[174:175], v[204:207]
    v_mfma_f32_16x16x16_bf16 v[208:211], v[136:137], v[168:169], v[208:211]
    v_mfma_f32_16x16x16_bf16 v[212:215], v[136:137], v[174:175], v[212:215]
    v_mfma_f32_16x16x16_bf16 v[216:219], v[138:139], v[168:169], v[216:219]
    v_mfma_f32_16x16x16_bf16 v[220:223], v[138:139], v[174:175], v[220:223]
    v_mfma_f32_16x16x16_bf16 v[224:227], v[140:141], v[168:169], v[224:227]
    v_mfma_f32_16x16x16_bf16 v[228:231], v[140:141], v[174:175], v[228:231]
    v_mfma_f32_16x16x16_bf16 v[232:235], v[142:143], v[168:169], v[232:235]
    v_mfma_f32_16x16x16_bf16 v[236:239], v[142:143], v[174:175], v[236:239]
    v_rcp_f32 v8, v240
    v_rcp_f32 v9, v244
    s_nop 7
    v_mul_f32 v176, v176, v8
    v_mul_f32 v177, v177, v8
    v_mul_f32 v178, v178, v8
    v_mul_f32 v179, v179, v8
    v_cvt_pk_bf16_f32 v16, v176, v177
    v_cvt_pk_bf16_f32 v17, v178, v179
    v_mul_f32 v184, v184, v8
    v_mul_f32 v185, v185, v8
    v_mul_f32 v186, v186, v8
    v_mul_f32 v187, v187, v8
    v_cvt_pk_bf16_f32 v18, v184, v185
    v_cvt_pk_bf16_f32 v19, v186, v187
    s_add_u32 s64, s32, 0x0
    buffer_store_dwordx4 v[16:19], v1, s[4:7], s64 offen offset:0 sc1
    v_mul_f32 v192, v192, v8
    v_mul_f32 v193, v193, v8
    v_mul_f32 v194, v194, v8
    v_mul_f32 v195, v195, v8
    v_cvt_pk_bf16_f32 v20, v192, v193
    v_cvt_pk_bf16_f32 v21, v194, v195
    v_mul_f32 v200, v200, v8
    v_mul_f32 v201, v201, v8
    v_mul_f32 v202, v202, v8
    v_mul_f32 v203, v203, v8
    v_cvt_pk_bf16_f32 v22, v200, v201
    v_cvt_pk_bf16_f32 v23, v202, v203
    s_add_u32 s64, s32, 0x0
    buffer_store_dwordx4 v[20:23], v1, s[4:7], s64 offen offset:1024 sc1
    v_mul_f32 v208, v208, v8
    v_mul_f32 v209, v209, v8
    v_mul_f32 v210, v210, v8
    v_mul_f32 v211, v211, v8
    v_cvt_pk_bf16_f32 v24, v208, v209
    v_cvt_pk_bf16_f32 v25, v210, v211
    v_mul_f32 v216, v216, v8
    v_mul_f32 v217, v217, v8
    v_mul_f32 v218, v218, v8
    v_mul_f32 v219, v219, v8
    v_cvt_pk_bf16_f32 v26, v216, v217
    v_cvt_pk_bf16_f32 v27, v218, v219
    s_add_u32 s64, s32, 0x0
    buffer_store_dwordx4 v[24:27], v1, s[4:7], s64 offen offset:2048 sc1
    v_mul_f32 v224, v224, v8
    v_mul_f32 v225, v225, v8
    v_mul_f32 v226, v226, v8
    v_mul_f32 v227, v227, v8
    v_cvt_pk_bf16_f32 v28, v224, v225
    v_cvt_pk_bf16_f32 v29, v226, v227
    v_mul_f32 v232, v232, v8
    v_mul_f32 v233, v233, v8
    v_mul_f32 v234, v234, v8
    v_mul_f32 v235, v235, v8
    v_cvt_pk_bf16_f32 v30, v232, v233
    v_cvt_pk_bf16_f32 v31, v234, v235
    s_add_u32 s64, s32, 0x0
    buffer_store_dwordx4 v[28:31], v1, s[4:7], s64 offen offset:3072 sc1
    v_mul_f32 v180, v180, v9
    v_mul_f32 v181, v181, v9
    v_mul_f32 v182, v182, v9
    v_mul_f32 v183, v183, v9
    v_cvt_pk_bf16_f32 v32, v180, v181
    v_cvt_pk_bf16_f32 v33, v182, v183
    v_mul_f32 v188, v188, v9
    v_mul_f32 v189, v189, v9
    v_mul_f32 v190, v190, v9
    v_mul_f32 v191, v191, v9
    v_cvt_pk_bf16_f32 v34, v188, v189
    v_cvt_pk_bf16_f32 v35, v190, v191
    s_add_u32 s64, s32, 0x20000
    buffer_store_dwordx4 v[32:35], v1, s[4:7], s64 offen offset:0 sc1
    v_mul_f32 v196, v196, v9
    v_mul_f32 v197, v197, v9
    v_mul_f32 v198, v198, v9
    v_mul_f32 v199, v199, v9
    v_cvt_pk_bf16_f32 v36, v196, v197
    v_cvt_pk_bf16_f32 v37, v198, v199
    v_mul_f32 v204, v204, v9
    v_mul_f32 v205, v205, v9
    v_mul_f32 v206, v206, v9
    v_mul_f32 v207, v207, v9
    v_cvt_pk_bf16_f32 v38, v204, v205
    v_cvt_pk_bf16_f32 v39, v206, v207
    s_add_u32 s64, s32, 0x20000
    buffer_store_dwordx4 v[36:39], v1, s[4:7], s64 offen offset:1024 sc1
    v_mul_f32 v212, v212, v9
    v_mul_f32 v213, v213, v9
    v_mul_f32 v214, v214, v9
    v_mul_f32 v215, v215, v9
    v_cvt_pk_bf16_f32 v40, v212, v213
    v_cvt_pk_bf16_f32 v41, v214, v215
    v_mul_f32 v220, v220, v9
    v_mul_f32 v221, v221, v9
    v_mul_f32 v222, v222, v9
    v_mul_f32 v223, v223, v9
    v_cvt_pk_bf16_f32 v42, v220, v221
    v_cvt_pk_bf16_f32 v43, v222, v223
    s_add_u32 s64, s32, 0x20000
    buffer_store_dwordx4 v[40:43], v1, s[4:7], s64 offen offset:2048 sc1
    v_mul_f32 v228, v228, v9
    v_mul_f32 v229, v229, v9
    v_mul_f32 v230, v230, v9
    v_mul_f32 v231, v231, v9
    v_cvt_pk_bf16_f32 v44, v228, v229
    v_cvt_pk_bf16_f32 v45, v230, v231
    v_mul_f32 v236, v236, v9
    v_mul_f32 v237, v237, v9
    v_mul_f32 v238, v238, v9
    v_mul_f32 v239, v239, v9
    v_cvt_pk_bf16_f32 v46, v236, v237
    v_cvt_pk_bf16_f32 v47, v238, v239
    s_add_u32 s64, s32, 0x20000
    buffer_store_dwordx4 v[44:47], v1, s[4:7], s64 offen offset:3072 sc1
    s_waitcnt vmcnt(0)
    v_mov_b32 v7, 1
    v_mov_b32 v8, 0
    s_mov_b64 exec, 1
    buffer_store_dword v7, v8, s[4:7], s33 offen sc1
    s_mov_b64 exec, -1
    s_add_u32 s24, s24, 8
    s_add_u32 s25, s25, 1
    s_cmp_lt_u32 s25, 8
    s_cbranch_scc1 AT2_LOOP
AT2_END:
M_EXIT:
    s_endpgm
.section .rodata,"a"
.p2align 6
.amdhsa_kernel recurrent_scan__memory_aug_recurrent_mem_tr__moe_arch_mod__prompt_kernel
  .amdhsa_next_free_vgpr 512
  .amdhsa_next_free_sgpr 102
  .amdhsa_accum_offset 256
  .amdhsa_group_segment_fixed_size 0
  .amdhsa_kernarg_size 120
  .amdhsa_user_sgpr_count 2
  .amdhsa_user_sgpr_kernarg_segment_ptr 1
  .amdhsa_system_sgpr_workgroup_id_x 1
.end_amdhsa_kernel
```
